```python
import torch

def _softmax(x, axis=-1):
    return torch.softmax(x, dim=axis)

def _gelu(x):
    return torch.nn.functional.gelu(x, approximate='tanh')

def _silu(x):
    return torch.nn.functional.silu(x)

def _sigmoid(x):
    return torch.sigmoid(x)

def _layernorm(x, axis=-1, eps=1e-05):
    m = x.mean(dim=axis, keepdim=True)
    v = x.var(dim=axis, keepdim=True, unbiased=False)
    return (x - m) / torch.sqrt(v + eps)

def _scatter_add(tgt, idx, src, axis=0):
    return tgt.clone().index_add_(axis, idx, src)

def _segment_sum(src, seg, n):
    out = torch.zeros((n,) + src.shape[1:], dtype=src.dtype)
    return out.index_add_(0, seg, src)

def _pad(x, pw):
    flat = tuple((v for pair in reversed(pw) for v in pair))
    return torch.nn.functional.pad(x, flat)
kernel_name = 'concat_heads__memory_aug_recurrent_mem_tr__sliding_block__prompt'

def setup_inputs():

    _w = lambda a: (lambda t: t.to(torch.bfloat16) if t.is_floating_point() else t)(torch.as_tensor(a))

    def _A_setup():
        B, S, Dm = (1, 2048, 640)
        H, Dh = (32, 192)
        M, seg = (8, 32)
        seg = min(seg, S)
        S = S // seg * seg
        return {'x': _w((lambda *s: torch.randn(*s, dtype=torch.bfloat16) * 0.05)(B, S, Dm)), 'mem0': _w((lambda *s: torch.randn(*s, dtype=torch.bfloat16) * 1.6)(B, M, Dm)), 'Wq': _w((lambda *s: torch.randn(*s, dtype=torch.bfloat16) * 0.8)(Dm, H, Dh) * Dm ** (-0.5)), 'Wk': _w((lambda *s: torch.randn(*s, dtype=torch.bfloat16) * 0.8)(Dm, H, Dh) * Dm ** (-0.5)), 'Wv': _w((lambda *s: torch.randn(*s, dtype=torch.bfloat16) * 1.6)(Dm, H, Dh) * Dm ** (-0.5)), 'Wo': _w((lambda *s: torch.randn(*s, dtype=torch.bfloat16) * 1.6)(H, Dh, Dm) * (H * Dh) ** (-0.5)), 'seg_len': seg}
    _A_in = _A_setup()

    def _B_setup():
        B, S, D = (1, 2048, 640)
        return {'x': _w((lambda *s: torch.randn(*s, dtype=torch.bfloat16) * 0.2)(B, S, D)), 'wqkv': _w((lambda *s: torch.randn(*s, dtype=torch.bfloat16) * 0.2)(D, 3 * D)), 'wo': _w((lambda *s: torch.randn(*s, dtype=torch.bfloat16) * 0.05)(D, D))}
    _B_in = _B_setup()
    return {'A_x': _A_in['x'], 'A_mem0': _A_in['mem0'], 'A_Wq': _A_in['Wq'], 'A_Wk': _A_in['Wk'], 'A_Wv': _A_in['Wv'], 'A_Wo': _A_in['Wo'], 'A_seg_len': _A_in['seg_len'], 'B_x': _B_in['x'], 'B_wqkv': _B_in['wqkv'], 'B_wo': _B_in['wo']}

def reference(A_x, A_mem0, A_Wq, A_Wk, A_Wv, A_Wo, A_seg_len, B_x, B_wqkv, B_wo):

    def _A_ref(x, mem0, Wq, Wk, Wv, Wo, seg_len):
        B, S, Dm = x.shape
        H, Dh = (Wq.shape[1], Wq.shape[2])
        M = mem0.shape[1]
        scale = Dh ** (-0.5)
        n_seg = S // seg_len
        L = M + seg_len
        idx = torch.arange(L)
        mask = (idx[:, None] < M) | (idx[:, None] >= idx[None, :])
        mem = mem0
        outs = []
        for s in range(n_seg):
            xs = x[:, s * seg_len:(s + 1) * seg_len, :].clone()
            h = torch.concatenate([mem, xs], axis=1)
            q = torch.einsum('btd,dhe->bhte', h, Wq)
            k = torch.einsum('btd,dhe->bhte', h, Wk)
            v = torch.einsum('btd,dhe->bhte', h, Wv)
            scores = torch.einsum('bhqe,bhke->bhqk', q, k) * scale
            scores = torch.where(mask[None, None], scores, -1000000000.0)
            p = _softmax(scores, axis=-1)
            o = torch.einsum('bhqk,bhke->bhqe', p, v)
            o = torch.einsum('bhte,hed->btd', o, Wo)
            mem = o[:, :M, :].clone()
            outs.append(o[:, M:, :])
        return torch.concatenate(outs, axis=1)

    def _B_ref(x, wqkv, wo):
        B, S, D = x.shape
        H = 32
        Dh = D // H
        W = 256
        qkv = (lambda x, *d: x.permute(*d))((x @ wqkv).reshape(B, S, 3, H, Dh), 2, 0, 3, 1, 4)
        q, k, v = (qkv[0], qkv[1], qkv[2])
        scores = torch.einsum('bhqd,bhkd->bhqk', q, k) * Dh ** (-0.5)
        idx = torch.arange(S)
        mask = (idx[:, None] - idx[None, :] >= 0) & (idx[:, None] - idx[None, :] < W)
        scores = torch.where(mask[None, None], scores, -1000000000.0)
        p = _softmax(scores, axis=-1)
        o = torch.einsum('bhqk,bhkd->bhqd', p, v)
        return (lambda x, *d: x.permute(*d))(o, 0, 2, 1, 3).reshape(B, S, D) @ wo
    a = _A_ref(A_x, A_mem0, A_Wq, A_Wk, A_Wv, A_Wo, A_seg_len)
    b = _B_ref(B_x, B_wqkv, B_wo)
    return torch.concatenate([a, b], axis=-1)
```

```asm
; @launch grid=(256,1,1) block=(256,1,1) lds=163840
.amdgcn_target "amdgcn-amd-amdhsa--gfx950"
.text
.globl concat_heads__memory_aug_recurrent_mem_tr__sliding_block__prompt_kernel
.p2align 8
.type concat_heads__memory_aug_recurrent_mem_tr__sliding_block__prompt_kernel,@function
concat_heads__memory_aug_recurrent_mem_tr__sliding_block__prompt_kernel:
  s_cmp_ge_u32 s2, 256
  s_cbranch_scc1 W_abort
  s_load_dwordx2 s[8:9], s[0:1], 96
  s_load_dwordx2 s[4:5], s[0:1], 88
  s_getreg_b32 s3, hwreg(HW_REG_XCC_ID)
  s_and_b32 s3, s3, 7
  v_lshrrev_b32 v1, 6, v0
  s_nop 0
  v_readfirstlane_b32 s24, v1
  s_waitcnt lgkmcnt(0)
  s_add_u32 s8, s8, 0
  s_addc_u32 s9, s9, 0
  s_mov_b32 s10, 268435456
  s_mov_b32 s11, 0x20000
  s_mov_b32 s6, 256
  s_mov_b32 s7, 0x20000
  s_mov_b32 s82, 4194304
  s_and_b32 s25, s3, 1
  s_lshl_b32 s25, s25, 7
  s_lshl_b32 s26, s3, 2
  s_add_u32 s95, s25, s26
  s_cmp_ge_u32 s3, 2
  s_cbranch_scc1 M_late
  s_cmp_lg_u32 s24, 0
  s_cbranch_scc1 M_e1
  v_mov_b32 v3, 1
  v_mov_b32 v8, s95
  s_mov_b64 exec, 1
  buffer_atomic_add v3, v8, s[4:7], 0 offen sc0 sc1
  s_mov_b64 exec, -1
  s_waitcnt vmcnt(0)
  v_mov_b32 v4, 0
  s_mov_b64 exec, 1
  ds_write_b32 v4, v3
  s_mov_b64 exec, -1
  s_waitcnt lgkmcnt(0)
  s_branch M_e2
M_e1:
M_e2:
  s_barrier
  v_mov_b32 v4, 0
  ds_read_b32 v8, v4
  s_waitcnt lgkmcnt(0)
  v_readfirstlane_b32 s80, v8
  s_barrier
  s_cmp_lt_u32 s80, 32
  s_cbranch_scc0 M_e3
  s_mov_b32 s25, s3
  s_mov_b32 s26, s80
  s_mov_b32 s81, 1
  s_branch M_chain
M_e3:
  v_and_b32 v1, 63, v0
  v_lshlrev_b32 v4, 4, v1
  v_mov_b32 v28, -1
  v_mov_b32 v32, 0
  v_mov_b32 v29, -1
  v_mov_b32 v33, 0
  v_mov_b32 v30, -1
  v_mov_b32 v34, 0
  v_mov_b32 v31, -1
  v_mov_b32 v35, 0
  s_lshr_b32 s28, s2, 2
  s_lshl_b32 s29, s28, 17
  s_and_b32 s28, s2, 1
  s_lshl_b32 s28, s28, 13
  s_add_u32 s29, s29, s28
  s_add_u32 s29, s29, 201326592
  s_and_b32 s28, s2, 2
  s_lshl_b32 s28, s28, 14
  s_add_u32 s30, s29, s28
  s_lshl_b32 s28, s24, 11
  s_add_u32 s30, s30, s28
  buffer_store_dwordx4 v[28:31], v4, s[8:11], s30 offen offset:0 sc1
  buffer_store_dwordx4 v[28:31], v4, s[8:11], s30 offen offset:1024 sc1
  s_lshr_b32 s28, s24, 1
  s_lshl_b32 s28, s28, 12
  s_add_u32 s29, s29, s28
  s_and_b32 s28, s24, 1
  s_lshl_b32 s28, s28, 10
  s_add_u32 s29, s29, s28
  s_add_u32 s29, s29, 65536
  buffer_store_dwordx4 v[28:31], v4, s[8:11], s29 offen sc1
  s_cmp_eq_u32 s24, 3
  s_cbranch_scc1 J_w3
  s_mul_i32 s28, s2, 3
  s_add_u32 s28, s28, s24
  s_cmp_ge_u32 s28, 384
  s_cselect_b32 s29, 384, 0
  s_cselect_b32 s30, 1048576, 0
  s_add_u32 s30, s30, 4194304
  s_sub_u32 s28, s28, s29
  s_lshl_b32 s29, s28, 10
  s_add_u32 s29, s29, s30
  s_lshr_b32 s28, s28, 3
  s_cmp_eq_u32 s28, 2
  s_cbranch_scc1 J_z
  buffer_store_dwordx4 v[28:31], v4, s[8:11], s29 offen sc1
  s_branch J_d
J_w3:
  s_cmp_ge_u32 s2, 128
  s_cbranch_scc1 J_d
  s_lshl_b32 s29, s2, 10
  s_add_u32 s29, s29, 6291456
J_z:
  buffer_store_dwordx4 v[32:35], v4, s[8:11], s29 offen sc1
J_d:
  s_waitcnt vmcnt(0)
  s_barrier
  s_cmp_lg_u32 s24, 1
  s_cbranch_scc1 M_e4
  v_mov_b32 v5, 1
  s_mov_b64 exec, 1
  buffer_atomic_add v5, off, s[4:7], 0 offset:32 sc1
  s_mov_b64 exec, -1
M_e4:
  s_branch M_worker
M_late:
  v_and_b32 v1, 63, v0
  v_lshlrev_b32 v4, 4, v1
  v_mov_b32 v28, -1
  v_mov_b32 v32, 0
  v_mov_b32 v29, -1
  v_mov_b32 v33, 0
  v_mov_b32 v30, -1
  v_mov_b32 v34, 0
  v_mov_b32 v31, -1
  v_mov_b32 v35, 0
  s_lshr_b32 s28, s2, 2
  s_lshl_b32 s29, s28, 17
  s_and_b32 s28, s2, 1
  s_lshl_b32 s28, s28, 13
  s_add_u32 s29, s29, s28
  s_add_u32 s29, s29, 201326592
  s_and_b32 s28, s2, 2
  s_lshl_b32 s28, s28, 14
  s_add_u32 s30, s29, s28
  s_lshl_b32 s28, s24, 11
  s_add_u32 s30, s30, s28
  buffer_store_dwordx4 v[28:31], v4, s[8:11], s30 offen offset:0 sc1
  buffer_store_dwordx4 v[28:31], v4, s[8:11], s30 offen offset:1024 sc1
  s_lshr_b32 s28, s24, 1
  s_lshl_b32 s28, s28, 12
  s_add_u32 s29, s29, s28
  s_and_b32 s28, s24, 1
  s_lshl_b32 s28, s28, 10
  s_add_u32 s29, s29, s28
  s_add_u32 s29, s29, 65536
  buffer_store_dwordx4 v[28:31], v4, s[8:11], s29 offen sc1
  s_cmp_eq_u32 s24, 3
  s_cbranch_scc1 I_w3
  s_mul_i32 s28, s2, 3
  s_add_u32 s28, s28, s24
  s_cmp_ge_u32 s28, 384
  s_cselect_b32 s29, 384, 0
  s_cselect_b32 s30, 1048576, 0
  s_add_u32 s30, s30, 4194304
  s_sub_u32 s28, s28, s29
  s_lshl_b32 s29, s28, 10
  s_add_u32 s29, s29, s30
  s_lshr_b32 s28, s28, 3
  s_cmp_eq_u32 s28, 2
  s_cbranch_scc1 I_z
  buffer_store_dwordx4 v[28:31], v4, s[8:11], s29 offen sc1
  s_branch I_d
I_w3:
  s_cmp_ge_u32 s2, 128
  s_cbranch_scc1 I_d
  s_lshl_b32 s29, s2, 10
  s_add_u32 s29, s29, 6291456
I_z:
  buffer_store_dwordx4 v[32:35], v4, s[8:11], s29 offen sc1
I_d:
  s_mov_b32 s25, s95
  s_cmp_lg_u32 s24, 0
  s_cbranch_scc1 M_a1
  v_mov_b32 v3, 1
  v_mov_b32 v4, s25
  s_mov_b64 exec, 1
  buffer_atomic_add v3, v4, s[4:7], 0 offen sc0 sc1
  s_waitcnt vmcnt(0)
  v_mov_b32 v4, 0
  ds_write_b32 v4, v3
  s_waitcnt lgkmcnt(0)
  s_mov_b64 exec, -1
M_a1:
  s_waitcnt vmcnt(0)
  s_barrier
  v_mov_b32 v4, 0
  ds_read_b32 v8, v4
  s_cmp_lg_u32 s24, 1
  s_cbranch_scc1 M_a1b
  v_mov_b32 v5, 1
  v_mov_b32 v6, 32
  s_mov_b64 exec, 1
  buffer_atomic_add v5, v6, s[4:7], 0 offen sc1
  s_mov_b64 exec, -1
M_a1b:
  s_waitcnt lgkmcnt(0)
  v_readfirstlane_b32 s80, v8
  s_barrier
  s_cmp_ge_u32 s80, 32
  s_cbranch_scc1 M_worker
  s_sub_u32 s79, s3, 2
  s_lshl_b32 s79, s79, 5
  s_add_u32 s79, s79, s80
  s_mov_b32 s81, 1
  s_cmp_lg_u32 s79, 31
  s_cbranch_scc1 C_skip
  s_cmp_lg_u32 s24, 0
  s_cbranch_scc1 C_skip
  s_mov_b32 s25, 7340032
  s_load_dword s27, s[8:9], s25 glc
  s_waitcnt lgkmcnt(0)
  s_mov_b32 s32, -1
  s_mov_b32 s33, -1
  s_add_u32 s25, s25, 8192
  s_memtime s[28:29]
  s_waitcnt lgkmcnt(0)
  s_load_dword s27, s[8:9], s25 glc
  s_waitcnt lgkmcnt(0)
  s_memtime s[30:31]
  s_waitcnt lgkmcnt(0)
  s_sub_u32 s30, s30, s28
  s_min_u32 s33, s33, s30
  s_add_u32 s25, s25, 8192
  s_memtime s[28:29]
  s_waitcnt lgkmcnt(0)
  s_load_dword s27, s[8:9], s25 glc
  s_waitcnt lgkmcnt(0)
  s_memtime s[30:31]
  s_waitcnt lgkmcnt(0)
  s_sub_u32 s30, s30, s28
  s_min_u32 s32, s32, s30
  s_add_u32 s25, s25, 8192
  s_memtime s[28:29]
  s_waitcnt lgkmcnt(0)
  s_load_dword s27, s[8:9], s25 glc
  s_waitcnt lgkmcnt(0)
  s_memtime s[30:31]
  s_waitcnt lgkmcnt(0)
  s_sub_u32 s30, s30, s28
  s_min_u32 s33, s33, s30
  s_add_u32 s25, s25, 8192
  s_memtime s[28:29]
  s_waitcnt lgkmcnt(0)
  s_load_dword s27, s[8:9], s25 glc
  s_waitcnt lgkmcnt(0)
  s_memtime s[30:31]
  s_waitcnt lgkmcnt(0)
  s_sub_u32 s30, s30, s28
  s_min_u32 s32, s32, s30
  s_add_u32 s25, s25, 8192
  s_memtime s[28:29]
  s_waitcnt lgkmcnt(0)
  s_load_dword s27, s[8:9], s25 glc
  s_waitcnt lgkmcnt(0)
  s_memtime s[30:31]
  s_waitcnt lgkmcnt(0)
  s_sub_u32 s30, s30, s28
  s_min_u32 s33, s33, s30
  s_add_u32 s25, s25, 8192
  s_memtime s[28:29]
  s_waitcnt lgkmcnt(0)
  s_load_dword s27, s[8:9], s25 glc
  s_waitcnt lgkmcnt(0)
  s_memtime s[30:31]
  s_waitcnt lgkmcnt(0)
  s_sub_u32 s30, s30, s28
  s_min_u32 s32, s32, s30
  s_add_u32 s25, s25, 8192
  s_memtime s[28:29]
  s_waitcnt lgkmcnt(0)
  s_load_dword s27, s[8:9], s25 glc
  s_waitcnt lgkmcnt(0)
  s_memtime s[30:31]
  s_waitcnt lgkmcnt(0)
  s_sub_u32 s30, s30, s28
  s_min_u32 s33, s33, s30
  s_add_u32 s25, s25, 8192
  s_memtime s[28:29]
  s_waitcnt lgkmcnt(0)
  s_load_dword s27, s[8:9], s25 glc
  s_waitcnt lgkmcnt(0)
  s_memtime s[30:31]
  s_waitcnt lgkmcnt(0)
  s_sub_u32 s30, s30, s28
  s_min_u32 s32, s32, s30
  s_cmp_le_u32 s33, s32
  s_cselect_b32 s27, 1, 0x2001
  v_mov_b32 v2, s27
  buffer_store_dword v2, off, s[4:7], 0 offset:64 sc1
C_skip:
  s_branch M_go
M_worker:
  v_mbcnt_lo_u32_b32 v3, -1, 0
  v_and_b32 v3, 15, v3
  v_min_u32 v3, 8, v3
  v_and_b32 v4, 1, v3
  v_lshlrev_b32 v3, 2, v3
  v_lshl_add_u32 v3, v4, 7, v3
M_cw:
  buffer_load_dword v2, v3, s[4:7], 0 offen sc1
  s_sub_u32 s82, s82, 1
  s_cbranch_scc1 W_abort
  s_waitcnt vmcnt(0)
  v_readlane_b32 s84, v2, 0
  v_readlane_b32 s85, v2, 1
  v_readlane_b32 s86, v2, 2
  v_readlane_b32 s87, v2, 3
  v_readlane_b32 s88, v2, 4
  v_readlane_b32 s89, v2, 5
  v_readlane_b32 s90, v2, 6
  v_readlane_b32 s91, v2, 7
  v_readlane_b32 s92, v2, 8
  s_cmp_eq_u32 s92, 256
  s_cbranch_scc1 M_cw_ok
  s_sleep 8
  s_branch M_cw
M_cw_ok:
  s_mov_b32 s79, s80
  s_cmp_lt_u32 s3, 2
  s_cselect_b32 s25, 32, 0
  s_sub_u32 s79, s79, s25
  s_max_u32 s25, s84, 32
  s_sub_u32 s25, s25, 32
  s_cmp_gt_u32 s3, 0
  s_cselect_b32 s25, s25, 0
  s_add_u32 s79, s79, s25
  s_max_u32 s25, s85, 32
  s_sub_u32 s25, s25, 32
  s_cmp_gt_u32 s3, 1
  s_cselect_b32 s25, s25, 0
  s_add_u32 s79, s79, s25
  s_mov_b32 s25, s86
  s_cmp_gt_u32 s3, 2
  s_cselect_b32 s25, s25, 0
  s_add_u32 s79, s79, s25
  s_mov_b32 s25, s87
  s_cmp_gt_u32 s3, 3
  s_cselect_b32 s25, s25, 0
  s_add_u32 s79, s79, s25
  s_mov_b32 s25, s88
  s_cmp_gt_u32 s3, 4
  s_cselect_b32 s25, s25, 0
  s_add_u32 s79, s79, s25
  s_mov_b32 s25, s89
  s_cmp_gt_u32 s3, 5
  s_cselect_b32 s25, s25, 0
  s_add_u32 s79, s79, s25
  s_mov_b32 s25, s90
  s_cmp_gt_u32 s3, 6
  s_cselect_b32 s25, s25, 0
  s_add_u32 s79, s79, s25
  s_min_u32 s25, s84, 32
  s_sub_u32 s27, 32, s25
  s_min_u32 s26, s85, 32
  s_sub_u32 s28, 32, s26
  s_cmp_lt_u32 s79, s27
  s_cbranch_scc0 M_n0
  s_add_u32 s26, s25, s79
  s_mov_b32 s25, 0
  s_mov_b32 s81, 0
  s_branch M_chain
M_n0:
  s_sub_u32 s79, s79, s27
  s_cmp_lt_u32 s79, s28
  s_cbranch_scc0 M_n1
  s_add_u32 s26, s26, s79
  s_mov_b32 s25, 1
  s_mov_b32 s81, 0
  s_branch M_chain
M_n1:
  s_sub_u32 s79, s79, s28
  s_mov_b32 s81, 0
M_go:
  s_load_dwordx8 s[64:71], s[0:1], 16
  s_load_dwordx4 s[72:75], s[0:1], 64
  s_load_dwordx2 s[20:21], s[0:1], 80
  s_load_dwordx2 s[84:85], s[0:1], 0
  s_load_dwordx2 s[86:87], s[0:1], 56
  s_getpc_b64 s[76:77]
W_pc:
  s_add_u32 s76, s76, W_table-W_pc
  s_addc_u32 s77, s77, 0
  s_mul_i32 s79, s79, 92
  s_waitcnt lgkmcnt(0)
  s_mov_b32 s22, 5242880
  s_mov_b32 s23, 0x20000
  s_mov_b32 s16, s70
  s_mov_b32 s17, s71
  s_mov_b32 s18, 7864320
  s_mov_b32 s19, 0x20000
  s_mov_b32 s12, s64
  s_mov_b32 s13, s65
  s_mov_b32 s14, 7864320
  s_mov_b32 s15, 0x20000
  v_and_b32 v1, 63, v0
  s_branch W_next
W_abort:
  s_endpgm
W_warm:
  s_mov_b32 s78, s63
  s_mov_b32 s63, s55
  s_add_u32 s79, s79, 4
  s_nop 0
  s_and_b32 s47, s78, 255
  s_bfe_u32 s44, s78, 0x80008
  s_bfe_u32 s45, s78, 0x80010
  s_lshr_b32 s46, s78, 24
  s_mov_b32 s12, s56
  s_mov_b32 s13, s57
  s_mov_b32 s26, s60
  s_mov_b32 s27, s61
  s_and_b32 s25, s63, 255
  s_cmp_eq_u32 s25, 1
  s_cselect_b32 s56, s66, s64
  s_cselect_b32 s57, s67, s65
  s_cmp_eq_u32 s25, 3
  s_cselect_b32 s56, s68, s56
  s_cselect_b32 s57, s69, s57
  s_mov_b32 s58, 7864320
  s_mov_b32 s59, 0x20000
  s_sub_u32 s25, s25, 1
  s_cmp_lt_u32 s25, 3
  s_cselect_b32 s62, 1, 0
  s_bitcmp1_b32 s63, 26
  s_cselect_b32 s62, 0, s62
  s_bfe_u32 s60, s63, 0x80008
  s_mul_i32 s60, s60, 327680
  s_bfe_u32 s61, s63, 0x80010
  s_mul_i32 s61, s61, 384
  s_lshl_b32 s36, s44, 5
  s_add_u32 s36, s36, s45
  s_lshl_b32 s36, s36, 4
  s_lshl_b32 s31, s44, 3
  s_bitcmp1_b32 s46, 2
  s_cselect_b32 s25, 0, 1
  s_lshl_b32 s25, s24, s25
  s_add_u32 s31, s31, s25
  s_bfe_u32 s25, s46, 0x10003
  s_lshl_b32 s25, s25, 2
  s_add_u32 s31, s31, s25
  s_lshl_b32 s31, s31, 5
  s_add_u32 s31, s31, s45
  s_cmp_eq_u32 s47, 3
  s_cbranch_scc1 W_ao_v0
  s_mul_i32 s31, s31, 12288
  s_mov_b32 s35, 393216
  s_cmp_eq_u32 s47, 1
  s_cselect_b32 s25, 0, 25165824
  s_add_u32 s31, s31, s25
  s_add_u32 s31, s31, 8388608
  s_cmp_eq_u32 s47, 1
  s_cselect_b32 s25, 0, 8192
  s_add_u32 s36, s36, s25
  s_add_u32 s36, s36, 6336512
  s_bfe_u32 s25, s46, 0x10003
  s_lshl_b32 s39, 1, s25
  s_bitcmp1_b32 s46, 2
  s_cselect_b32 s39, s39, 3
  s_branch W_ao_d0
W_ao_v0:
  s_mul_i32 s31, s31, 40960
  s_add_u32 s31, s31, 58720256
  s_add_u32 s36, s36, 6340608
  s_mul_i32 s37, s45, 245760
  s_and_b32 s25, s46, 3
  s_cmp_eq_u32 s25, 0
  s_cselect_b32 s38, 4, 2
  s_cselect_b32 s39, 3, s25
  s_cmp_eq_u32 s25, 2
  s_cselect_b32 s25, 640, 0
  s_add_u32 s37, s37, s25
  s_lshl_b32 s25, s25, 5
  s_add_u32 s31, s31, s25
  s_bfe_u32 s25, s46, 0x10003
  s_lshl_b32 s25, s25, 1
  s_lshl_b32 s25, s39, s25
  s_mul_i32 s39, s39, 5
  s_bitcmp1_b32 s46, 2
  s_cselect_b32 s39, s25, s39
W_ao_d0:
  s_cmp_eq_u32 s47, 3
  s_cbranch_scc1 W_vu_warm
  s_branch W_kq_warm
W_next:
  s_load_dword s78, s[76:77], s79
  s_add_u32 s79, s79, 4
  s_load_dword s63, s[76:77], s79
  s_waitcnt lgkmcnt(0)
  s_nop 0
  s_and_b32 s47, s78, 255
  s_bfe_u32 s44, s78, 0x80008
  s_bfe_u32 s45, s78, 0x80010
  s_lshr_b32 s46, s78, 24
  s_cmp_eq_u32 s47, 7
  s_cbranch_scc1 W_tp
  s_cmp_eq_u32 s47, 8
  s_cbranch_scc1 W_pz
  s_cmp_eq_u32 s47, 5
  s_cbranch_scc1 W_ba
  s_cmp_eq_u32 s47, 4
  s_cbranch_scc1 W_bq
  s_cmp_eq_u32 s47, 6
  s_cbranch_scc1 W_bo
  s_cmp_eq_u32 s47, 9
  s_cbranch_scc1 W_w
  s_cmp_eq_u32 s47, 0
  s_cbranch_scc1 W_done
  s_cmp_eq_u32 s47, 1
  s_cselect_b32 s12, s66, s64
  s_cselect_b32 s13, s67, s65
  s_cmp_eq_u32 s47, 3
  s_cselect_b32 s12, s68, s12
  s_cselect_b32 s13, s69, s13
  s_mov_b32 s14, 7864320
  s_mul_i32 s26, s44, 327680
  s_bfe_u32 s25, s46, 0x10003
  s_mul_i32 s25, s25, 163840
  s_add_u32 s26, s26, s25
  s_mov_b32 s48, s84
  s_mov_b32 s49, s85
  s_mov_b32 s50, 2621440
  s_mov_b32 s51, 0x20000
  s_mul_i32 s27, s45, 384
  s_mov_b32 s33, 12288
  s_and_b32 s25, s63, 255
  s_cmp_eq_u32 s25, 1
  s_cselect_b32 s56, s66, s64
  s_cselect_b32 s57, s67, s65
  s_cmp_eq_u32 s25, 3
  s_cselect_b32 s56, s68, s56
  s_cselect_b32 s57, s69, s57
  s_mov_b32 s58, 7864320
  s_mov_b32 s59, 0x20000
  s_sub_u32 s25, s25, 1
  s_cmp_lt_u32 s25, 3
  s_cselect_b32 s62, 1, 0
  s_bitcmp1_b32 s63, 26
  s_cselect_b32 s62, 0, s62
  s_bfe_u32 s60, s63, 0x80008
  s_mul_i32 s60, s60, 327680
  s_bfe_u32 s61, s63, 0x80010
  s_mul_i32 s61, s61, 384
  s_lshl_b32 s36, s44, 5
  s_add_u32 s36, s36, s45
  s_lshl_b32 s36, s36, 4
  s_lshl_b32 s31, s44, 3
  s_bitcmp1_b32 s46, 2
  s_cselect_b32 s25, 0, 1
  s_lshl_b32 s25, s24, s25
  s_add_u32 s31, s31, s25
  s_bfe_u32 s25, s46, 0x10003
  s_lshl_b32 s25, s25, 2
  s_add_u32 s31, s31, s25
  s_lshl_b32 s31, s31, 5
  s_add_u32 s31, s31, s45
  s_cmp_eq_u32 s47, 3
  s_cbranch_scc1 W_ao_v1
  s_mul_i32 s31, s31, 12288
  s_mov_b32 s35, 393216
  s_cmp_eq_u32 s47, 1
  s_cselect_b32 s25, 0, 25165824
  s_add_u32 s31, s31, s25
  s_add_u32 s31, s31, 8388608
  s_cmp_eq_u32 s47, 1
  s_cselect_b32 s25, 0, 8192
  s_add_u32 s36, s36, s25
  s_add_u32 s36, s36, 6336512
  s_bfe_u32 s25, s46, 0x10003
  s_lshl_b32 s39, 1, s25
  s_bitcmp1_b32 s46, 2
  s_cselect_b32 s39, s39, 3
  s_branch W_ao_d1
W_ao_v1:
  s_mul_i32 s31, s31, 40960
  s_add_u32 s31, s31, 58720256
  s_add_u32 s36, s36, 6340608
  s_mul_i32 s37, s45, 245760
  s_and_b32 s25, s46, 3
  s_cmp_eq_u32 s25, 0
  s_cselect_b32 s38, 4, 2
  s_cselect_b32 s39, 3, s25
  s_cmp_eq_u32 s25, 2
  s_cselect_b32 s25, 640, 0
  s_add_u32 s37, s37, s25
  s_lshl_b32 s25, s25, 5
  s_add_u32 s31, s31, s25
  s_bfe_u32 s25, s46, 0x10003
  s_lshl_b32 s25, s25, 1
  s_lshl_b32 s25, s39, s25
  s_mul_i32 s39, s39, 5
  s_bitcmp1_b32 s46, 2
  s_cselect_b32 s39, s25, s39
W_ao_d1:
  s_bitcmp1_b32 s46, 2
  s_cbranch_scc1 W_mb1
  s_cmp_eq_u32 s47, 3
  s_cbranch_scc1 W_vu
  s_branch W_kq
W_mb1:
  s_mov_b32 s62, 0
  s_cmp_eq_u32 s47, 3
  s_cbranch_scc1 W_vu1
  v_lshrrev_b32 v4, 3, v1
  s_mul_i32 s25, s24, 32
  v_add_u32 v4, s25, v4
  v_mul_u32_u24 v4, 1280, v4
  v_lshrrev_b32 v5, 4, v1
  v_and_b32 v6, 7, v1
  v_xor_b32 v5, v5, v6
  v_lshl_add_u32 v24, v5, 4, v4
  v_xor_b32 v5, 4, v5
  v_lshl_add_u32 v25, v5, 4, v4
  v_add_u32 v25, 10240, v25
  v_add_u32 v26, 20480, v24
  v_add_u32 v27, 20480, v25
  s_mul_i32 s52, s24, 4096
  s_add_u32 s52, s52, 98304
  s_mul_i32 s25, s24, 384
  s_add_u32 s25, s25, 0
  v_add_u32 v4, s25, v1
  v_mul_u32_u24 v5, 2731, v4
  v_lshrrev_b32 v5, 16, v5
  v_mul_u32_u24 v6, 24, v5
  v_sub_u32 v6, v4, v6
  v_lshlrev_b32 v7, 1, v5
  v_and_b32 v7, 4, v7
  v_xor_b32 v6, v6, v7
  v_mul_lo_u32 v5, v5, s33
  v_lshl_add_u32 v8, v6, 4, v5
  s_mul_i32 s25, s24, 384
  s_add_u32 s25, s25, 64
  v_add_u32 v4, s25, v1
  v_mul_u32_u24 v5, 2731, v4
  v_lshrrev_b32 v5, 16, v5
  v_mul_u32_u24 v6, 24, v5
  v_sub_u32 v6, v4, v6
  v_lshlrev_b32 v7, 1, v5
  v_and_b32 v7, 4, v7
  v_xor_b32 v6, v6, v7
  v_mul_lo_u32 v5, v5, s33
  v_lshl_add_u32 v9, v6, 4, v5
  s_mul_i32 s25, s24, 384
  s_add_u32 s25, s25, 128
  v_add_u32 v4, s25, v1
  v_mul_u32_u24 v5, 2731, v4
  v_lshrrev_b32 v5, 16, v5
  v_mul_u32_u24 v6, 24, v5
  v_sub_u32 v6, v4, v6
  v_lshlrev_b32 v7, 1, v5
  v_and_b32 v7, 4, v7
  v_xor_b32 v6, v6, v7
  v_mul_lo_u32 v5, v5, s33
  v_lshl_add_u32 v10, v6, 4, v5
  s_mul_i32 s25, s24, 384
  s_add_u32 s25, s25, 192
  v_add_u32 v4, s25, v1
  v_mul_u32_u24 v5, 2731, v4
  v_lshrrev_b32 v5, 16, v5
  v_mul_u32_u24 v6, 24, v5
  v_sub_u32 v6, v4, v6
  v_lshlrev_b32 v7, 1, v5
  v_and_b32 v7, 4, v7
  v_xor_b32 v6, v6, v7
  v_mul_lo_u32 v5, v5, s33
  v_lshl_add_u32 v11, v6, 4, v5
  s_mul_i32 s25, s24, 384
  s_add_u32 s25, s25, 256
  v_add_u32 v4, s25, v1
  v_mul_u32_u24 v5, 2731, v4
  v_lshrrev_b32 v5, 16, v5
  v_mul_u32_u24 v6, 24, v5
  v_sub_u32 v6, v4, v6
  v_lshlrev_b32 v7, 1, v5
  v_and_b32 v7, 4, v7
  v_xor_b32 v6, v6, v7
  v_mul_lo_u32 v5, v5, s33
  v_lshl_add_u32 v12, v6, 4, v5
  s_mul_i32 s25, s24, 384
  s_add_u32 s25, s25, 320
  v_add_u32 v4, s25, v1
  v_mul_u32_u24 v5, 2731, v4
  v_lshrrev_b32 v5, 16, v5
  v_mul_u32_u24 v6, 24, v5
  v_sub_u32 v6, v4, v6
  v_lshlrev_b32 v7, 1, v5
  v_and_b32 v7, 4, v7
  v_xor_b32 v6, v6, v7
  v_mul_lo_u32 v5, v5, s33
  v_lshl_add_u32 v13, v6, 4, v5
  s_lshl_b32 s28, s33, 6
  s_mul_i32 s32, s24, 6144
  s_mov_b32 s29, 0
  s_add_u32 m0, s29, s32
  s_nop 0
  buffer_load_dwordx4 v8, s[12:15], s27 offen lds
  s_add_u32 m0, m0, 1024
  s_nop 0
  buffer_load_dwordx4 v9, s[12:15], s27 offen lds
  s_add_u32 m0, m0, 1024
  s_nop 0
  buffer_load_dwordx4 v10, s[12:15], s27 offen lds
  s_add_u32 m0, m0, 1024
  s_nop 0
  buffer_load_dwordx4 v11, s[12:15], s27 offen lds
  s_add_u32 m0, m0, 1024
  s_nop 0
  buffer_load_dwordx4 v12, s[12:15], s27 offen lds
  s_add_u32 m0, m0, 1024
  s_nop 0
  buffer_load_dwordx4 v13, s[12:15], s27 offen lds
  s_add_u32 s27, s27, s28
  s_add_u32 s29, s29, 24576
  s_cmp_eq_u32 s29, 98304
  s_cselect_b32 s29, 0, s29
  s_add_u32 m0, s52, 0
  s_nop 0
  buffer_load_dwordx4 v24, s[48:51], s26 offen lds
  s_add_u32 m0, s52, 1024
  s_nop 0
  buffer_load_dwordx4 v25, s[48:51], s26 offen lds
  s_add_u32 m0, s52, 2048
  s_nop 0
  buffer_load_dwordx4 v26, s[48:51], s26 offen lds
  s_add_u32 m0, s52, 3072
  s_nop 0
  buffer_load_dwordx4 v27, s[48:51], s26 offen lds
  s_add_u32 s26, s26, 128
  s_add_u32 m0, s29, s32
  s_nop 0
  buffer_load_dwordx4 v8, s[12:15], s27 offen lds
  s_add_u32 m0, m0, 1024
  s_nop 0
  buffer_load_dwordx4 v9, s[12:15], s27 offen lds
  s_add_u32 m0, m0, 1024
  s_nop 0
  buffer_load_dwordx4 v10, s[12:15], s27 offen lds
  s_add_u32 m0, m0, 1024
  s_nop 0
  buffer_load_dwordx4 v11, s[12:15], s27 offen lds
  s_add_u32 m0, m0, 1024
  s_nop 0
  buffer_load_dwordx4 v12, s[12:15], s27 offen lds
  s_add_u32 m0, m0, 1024
  s_nop 0
  buffer_load_dwordx4 v13, s[12:15], s27 offen lds
  s_add_u32 s27, s27, s28
  s_add_u32 s29, s29, 24576
  s_cmp_eq_u32 s29, 98304
  s_cselect_b32 s29, 0, s29
  s_add_u32 m0, s52, 16384
  s_nop 0
  buffer_load_dwordx4 v24, s[48:51], s26 offen lds
  s_add_u32 m0, s52, 17408
  s_nop 0
  buffer_load_dwordx4 v25, s[48:51], s26 offen lds
  s_add_u32 m0, s52, 18432
  s_nop 0
  buffer_load_dwordx4 v26, s[48:51], s26 offen lds
  s_add_u32 m0, s52, 19456
  s_nop 0
  buffer_load_dwordx4 v27, s[48:51], s26 offen lds
  s_add_u32 s26, s26, 128
  s_add_u32 m0, s29, s32
  s_nop 0
  buffer_load_dwordx4 v8, s[12:15], s27 offen lds
  s_add_u32 m0, m0, 1024
  s_nop 0
  buffer_load_dwordx4 v9, s[12:15], s27 offen lds
  s_add_u32 m0, m0, 1024
  s_nop 0
  buffer_load_dwordx4 v10, s[12:15], s27 offen lds
  s_add_u32 m0, m0, 1024
  s_nop 0
  buffer_load_dwordx4 v11, s[12:15], s27 offen lds
  s_add_u32 m0, m0, 1024
  s_nop 0
  buffer_load_dwordx4 v12, s[12:15], s27 offen lds
  s_add_u32 m0, m0, 1024
  s_nop 0
  buffer_load_dwordx4 v13, s[12:15], s27 offen lds
  s_add_u32 s27, s27, s28
  s_add_u32 s29, s29, 24576
  s_cmp_eq_u32 s29, 98304
  s_cselect_b32 s29, 0, s29
  s_mul_i32 s25, s24, 32
  v_and_b32 v4, 31, v1
  v_bfe_u32 v5, v1, 1, 3
  v_lshrrev_b32 v6, 5, v1
  v_lshlrev_b32 v6, 2, v6
  v_xor_b32 v5, v5, v6
  v_add_u32 v4, s25, v4
  v_lshlrev_b32 v4, 7, v4
  v_add_u32 v4, 98304, v4
  v_xor_b32 v6, 0, v5
  v_lshl_add_u32 v32, v6, 4, v4
  v_xor_b32 v6, 1, v5
  v_lshl_add_u32 v33, v6, 4, v4
  v_xor_b32 v6, 2, v5
  v_lshl_add_u32 v34, v6, 4, v4
  v_xor_b32 v6, 3, v5
  v_lshl_add_u32 v35, v6, 4, v4
  v_lshrrev_b32 v4, 5, v1
  v_bfe_u32 v5, v1, 2, 2
  v_mul_u32_u24 v4, 32, v4
  v_add_u32 v4, v4, v5
  v_mul_u32_u24 v4, 384, v4
  v_bfe_u32 v6, v1, 4, 1
  v_lshl_add_u32 v4, v6, 5, v4
  v_and_b32 v6, 3, v1
  v_lshl_add_u32 v4, v6, 3, v4
  v_bfe_u32 v5, v1, 3, 1
  v_lshlrev_b32 v5, 6, v5
  v_add_u32 v14, v4, v5
  v_sub_u32 v15, v4, v5
  v_lshlrev_b32 v36, 4, v1
  s_mov_b32 s54, 0
  s_waitcnt vmcnt(16)
  s_barrier
  v_mov_b32 v16, v14
  v_mov_b32 v17, v15
  s_mov_b32 s30, 0
  ds_read_b128 a[48:51], v32 offset:0
  ds_read_b64_tr_b16 a[0:1], v16 offset:0
  ds_read_b64_tr_b16 a[2:3], v16 offset:1536
  ds_read_b64_tr_b16 a[4:5], v17 offset:64
  ds_read_b64_tr_b16 a[6:7], v17 offset:1600
  ds_read_b64_tr_b16 a[8:9], v16 offset:128
  ds_read_b64_tr_b16 a[10:11], v16 offset:1664
  ds_read_b64_tr_b16 a[12:13], v17 offset:192
  ds_read_b64_tr_b16 a[14:15], v17 offset:1728
  ds_read_b64_tr_b16 a[16:17], v16 offset:256
  ds_read_b64_tr_b16 a[18:19], v16 offset:1792
  ds_read_b64_tr_b16 a[20:21], v17 offset:320
  ds_read_b64_tr_b16 a[22:23], v17 offset:1856
  s_waitcnt lgkmcnt(0)
  v_mfma_f32_32x32x16_bf16 v[64:79], a[0:3], a[48:51], 0
  ds_read_b128 a[56:59], v33 offset:0
  ds_read_b64_tr_b16 a[24:25], v16 offset:3072
  ds_read_b64_tr_b16 a[26:27], v16 offset:4608
  s_add_u32 m0, s52, 32768
  s_nop 0
  buffer_load_dwordx4 v24, s[48:51], s26 offen lds
  v_mfma_f32_32x32x16_bf16 v[80:95], a[4:7], a[48:51], 0
  ds_read_b64_tr_b16 a[28:29], v17 offset:3136
  ds_read_b64_tr_b16 a[30:31], v17 offset:4672
  ds_read_b64_tr_b16 a[32:33], v16 offset:3200
  ds_read_b64_tr_b16 a[34:35], v16 offset:4736
  v_mfma_f32_32x32x16_bf16 v[96:111], a[8:11], a[48:51], 0
  ds_read_b64_tr_b16 a[36:37], v17 offset:3264
  ds_read_b64_tr_b16 a[38:39], v17 offset:4800
  ds_read_b64_tr_b16 a[40:41], v16 offset:3328
  ds_read_b64_tr_b16 a[42:43], v16 offset:4864
  s_add_u32 m0, s52, 33792
  s_nop 0
  buffer_load_dwordx4 v25, s[48:51], s26 offen lds
  v_mfma_f32_32x32x16_bf16 v[112:127], a[12:15], a[48:51], 0
  ds_read_b64_tr_b16 a[44:45], v17 offset:3392
  ds_read_b64_tr_b16 a[46:47], v17 offset:4928
  v_mfma_f32_32x32x16_bf16 v[128:143], a[16:19], a[48:51], 0
  s_add_u32 m0, s52, 34816
  s_nop 0
  buffer_load_dwordx4 v26, s[48:51], s26 offen lds
  v_mfma_f32_32x32x16_bf16 v[144:159], a[20:23], a[48:51], 0
  s_waitcnt lgkmcnt(0)
  v_mfma_f32_32x32x16_bf16 v[64:79], a[24:27], a[56:59], v[64:79]
  ds_read_b128 a[48:51], v34 offset:0
  ds_read_b64_tr_b16 a[0:1], v16 offset:6144
  ds_read_b64_tr_b16 a[2:3], v16 offset:7680
  s_add_u32 m0, s52, 35840
  s_nop 0
  buffer_load_dwordx4 v27, s[48:51], s26 offen lds
  s_add_u32 s26, s26, 128
  v_mfma_f32_32x32x16_bf16 v[80:95], a[28:31], a[56:59], v[80:95]
  ds_read_b64_tr_b16 a[4:5], v17 offset:6208
  ds_read_b64_tr_b16 a[6:7], v17 offset:7744
  ds_read_b64_tr_b16 a[8:9], v16 offset:6272
  ds_read_b64_tr_b16 a[10:11], v16 offset:7808
  v_mfma_f32_32x32x16_bf16 v[96:111], a[32:35], a[56:59], v[96:111]
  ds_read_b64_tr_b16 a[12:13], v17 offset:6336
  ds_read_b64_tr_b16 a[14:15], v17 offset:7872
  ds_read_b64_tr_b16 a[16:17], v16 offset:6400
  ds_read_b64_tr_b16 a[18:19], v16 offset:7936
  s_add_u32 m0, s29, s32
  s_nop 0
  buffer_load_dwordx4 v8, s[12:15], s27 offen lds
  v_mfma_f32_32x32x16_bf16 v[112:127], a[36:39], a[56:59], v[112:127]
  ds_read_b64_tr_b16 a[20:21], v17 offset:6464
  ds_read_b64_tr_b16 a[22:23], v17 offset:8000
  v_mfma_f32_32x32x16_bf16 v[128:143], a[40:43], a[56:59], v[128:143]
  s_add_u32 m0, m0, 1024
  s_nop 0
  buffer_load_dwordx4 v9, s[12:15], s27 offen lds
  v_mfma_f32_32x32x16_bf16 v[144:159], a[44:47], a[56:59], v[144:159]
  s_waitcnt lgkmcnt(0)
  v_mfma_f32_32x32x16_bf16 v[64:79], a[0:3], a[48:51], v[64:79]
  ds_read_b128 a[56:59], v35 offset:0
  ds_read_b64_tr_b16 a[24:25], v16 offset:9216
  ds_read_b64_tr_b16 a[26:27], v16 offset:10752
  s_add_u32 m0, m0, 1024
  s_nop 0
  buffer_load_dwordx4 v10, s[12:15], s27 offen lds
  v_mfma_f32_32x32x16_bf16 v[80:95], a[4:7], a[48:51], v[80:95]
  ds_read_b64_tr_b16 a[28:29], v17 offset:9280
  ds_read_b64_tr_b16 a[30:31], v17 offset:10816
  ds_read_b64_tr_b16 a[32:33], v16 offset:9344
  ds_read_b64_tr_b16 a[34:35], v16 offset:10880
  v_mfma_f32_32x32x16_bf16 v[96:111], a[8:11], a[48:51], v[96:111]
  ds_read_b64_tr_b16 a[36:37], v17 offset:9408
  ds_read_b64_tr_b16 a[38:39], v17 offset:10944
  ds_read_b64_tr_b16 a[40:41], v16 offset:9472
  ds_read_b64_tr_b16 a[42:43], v16 offset:11008
  s_add_u32 m0, m0, 1024
  s_nop 0
  buffer_load_dwordx4 v11, s[12:15], s27 offen lds
  v_mfma_f32_32x32x16_bf16 v[112:127], a[12:15], a[48:51], v[112:127]
  ds_read_b64_tr_b16 a[44:45], v17 offset:9536
  ds_read_b64_tr_b16 a[46:47], v17 offset:11072
  v_mfma_f32_32x32x16_bf16 v[128:143], a[16:19], a[48:51], v[128:143]
  s_add_u32 m0, m0, 1024
  s_nop 0
  buffer_load_dwordx4 v12, s[12:15], s27 offen lds
  v_mfma_f32_32x32x16_bf16 v[144:159], a[20:23], a[48:51], v[144:159]
  s_waitcnt vmcnt(15) lgkmcnt(0)
  s_barrier
  s_add_u32 s30, s30, 24576
  s_cmp_eq_u32 s30, 98304
  s_cselect_b32 s30, 0, s30
  v_add_u32 v16, s30, v14
  v_add_u32 v17, s30, v15
  v_mfma_f32_32x32x16_bf16 v[64:79], a[24:27], a[56:59], v[64:79]
  ds_read_b128 a[48:51], v32 offset:16384
  ds_read_b64_tr_b16 a[0:1], v16 offset:0
  ds_read_b64_tr_b16 a[2:3], v16 offset:1536
  s_add_u32 m0, m0, 1024
  s_nop 0
  buffer_load_dwordx4 v13, s[12:15], s27 offen lds
  s_add_u32 s27, s27, s28
  s_add_u32 s29, s29, 24576
  s_cmp_eq_u32 s29, 98304
  s_cselect_b32 s29, 0, s29
  v_mfma_f32_32x32x16_bf16 v[80:95], a[28:31], a[56:59], v[80:95]
  ds_read_b64_tr_b16 a[4:5], v17 offset:64
  ds_read_b64_tr_b16 a[6:7], v17 offset:1600
  ds_read_b64_tr_b16 a[8:9], v16 offset:128
  ds_read_b64_tr_b16 a[10:11], v16 offset:1664
  v_mfma_f32_32x32x16_bf16 v[96:111], a[32:35], a[56:59], v[96:111]
  ds_read_b64_tr_b16 a[12:13], v17 offset:192
  ds_read_b64_tr_b16 a[14:15], v17 offset:1728
  ds_read_b64_tr_b16 a[16:17], v16 offset:256
  ds_read_b64_tr_b16 a[18:19], v16 offset:1792
  v_mfma_f32_32x32x16_bf16 v[112:127], a[36:39], a[56:59], v[112:127]
  ds_read_b64_tr_b16 a[20:21], v17 offset:320
  ds_read_b64_tr_b16 a[22:23], v17 offset:1856
  v_mfma_f32_32x32x16_bf16 v[128:143], a[40:43], a[56:59], v[128:143]
  v_mfma_f32_32x32x16_bf16 v[144:159], a[44:47], a[56:59], v[144:159]
  s_waitcnt lgkmcnt(0)
  v_mfma_f32_32x32x16_bf16 v[64:79], a[0:3], a[48:51], v[64:79]
  ds_read_b128 a[56:59], v33 offset:16384
  ds_read_b64_tr_b16 a[24:25], v16 offset:3072
  ds_read_b64_tr_b16 a[26:27], v16 offset:4608
  s_add_u32 m0, s52, 0
  s_nop 0
  buffer_load_dwordx4 v24, s[48:51], s26 offen lds
  v_mfma_f32_32x32x16_bf16 v[80:95], a[4:7], a[48:51], v[80:95]
  ds_read_b64_tr_b16 a[28:29], v17 offset:3136
  ds_read_b64_tr_b16 a[30:31], v17 offset:4672
  ds_read_b64_tr_b16 a[32:33], v16 offset:3200
  ds_read_b64_tr_b16 a[34:35], v16 offset:4736
  v_mfma_f32_32x32x16_bf16 v[96:111], a[8:11], a[48:51], v[96:111]
  ds_read_b64_tr_b16 a[36:37], v17 offset:3264
  ds_read_b64_tr_b16 a[38:39], v17 offset:4800
  ds_read_b64_tr_b16 a[40:41], v16 offset:3328
  ds_read_b64_tr_b16 a[42:43], v16 offset:4864
  s_add_u32 m0, s52, 1024
  s_nop 0
  buffer_load_dwordx4 v25, s[48:51], s26 offen lds
  v_mfma_f32_32x32x16_bf16 v[112:127], a[12:15], a[48:51], v[112:127]
  ds_read_b64_tr_b16 a[44:45], v17 offset:3392
  ds_read_b64_tr_b16 a[46:47], v17 offset:4928
  v_mfma_f32_32x32x16_bf16 v[128:143], a[16:19], a[48:51], v[128:143]
  s_add_u32 m0, s52, 2048
  s_nop 0
  buffer_load_dwordx4 v26, s[48:51], s26 offen lds
  v_mfma_f32_32x32x16_bf16 v[144:159], a[20:23], a[48:51], v[144:159]
  s_waitcnt lgkmcnt(0)
  v_mfma_f32_32x32x16_bf16 v[64:79], a[24:27], a[56:59], v[64:79]
  ds_read_b128 a[48:51], v34 offset:16384
  ds_read_b64_tr_b16 a[0:1], v16 offset:6144
  ds_read_b64_tr_b16 a[2:3], v16 offset:7680
  s_add_u32 m0, s52, 3072
  s_nop 0
  buffer_load_dwordx4 v27, s[48:51], s26 offen lds
  s_add_u32 s26, s26, 128
  v_mfma_f32_32x32x16_bf16 v[80:95], a[28:31], a[56:59], v[80:95]
  ds_read_b64_tr_b16 a[4:5], v17 offset:6208
  ds_read_b64_tr_b16 a[6:7], v17 offset:7744
  ds_read_b64_tr_b16 a[8:9], v16 offset:6272
  ds_read_b64_tr_b16 a[10:11], v16 offset:7808
  v_mfma_f32_32x32x16_bf16 v[96:111], a[32:35], a[56:59], v[96:111]
  ds_read_b64_tr_b16 a[12:13], v17 offset:6336
  ds_read_b64_tr_b16 a[14:15], v17 offset:7872
  ds_read_b64_tr_b16 a[16:17], v16 offset:6400
  ds_read_b64_tr_b16 a[18:19], v16 offset:7936
  s_add_u32 m0, s29, s32
  s_nop 0
  buffer_load_dwordx4 v8, s[12:15], s27 offen lds
  v_mfma_f32_32x32x16_bf16 v[112:127], a[36:39], a[56:59], v[112:127]
  ds_read_b64_tr_b16 a[20:21], v17 offset:6464
  ds_read_b64_tr_b16 a[22:23], v17 offset:8000
  v_mfma_f32_32x32x16_bf16 v[128:143], a[40:43], a[56:59], v[128:143]
  s_add_u32 m0, m0, 1024
  s_nop 0
  buffer_load_dwordx4 v9, s[12:15], s27 offen lds
  v_mfma_f32_32x32x16_bf16 v[144:159], a[44:47], a[56:59], v[144:159]
  s_waitcnt lgkmcnt(0)
  v_mfma_f32_32x32x16_bf16 v[64:79], a[0:3], a[48:51], v[64:79]
  ds_read_b128 a[56:59], v35 offset:16384
  ds_read_b64_tr_b16 a[24:25], v16 offset:9216
  ds_read_b64_tr_b16 a[26:27], v16 offset:10752
  s_add_u32 m0, m0, 1024
  s_nop 0
  buffer_load_dwordx4 v10, s[12:15], s27 offen lds
  v_mfma_f32_32x32x16_bf16 v[80:95], a[4:7], a[48:51], v[80:95]
  ds_read_b64_tr_b16 a[28:29], v17 offset:9280
  ds_read_b64_tr_b16 a[30:31], v17 offset:10816
  ds_read_b64_tr_b16 a[32:33], v16 offset:9344
  ds_read_b64_tr_b16 a[34:35], v16 offset:10880
  v_mfma_f32_32x32x16_bf16 v[96:111], a[8:11], a[48:51], v[96:111]
  ds_read_b64_tr_b16 a[36:37], v17 offset:9408
  ds_read_b64_tr_b16 a[38:39], v17 offset:10944
  ds_read_b64_tr_b16 a[40:41], v16 offset:9472
  ds_read_b64_tr_b16 a[42:43], v16 offset:11008
  s_add_u32 m0, m0, 1024
  s_nop 0
  buffer_load_dwordx4 v11, s[12:15], s27 offen lds
  v_mfma_f32_32x32x16_bf16 v[112:127], a[12:15], a[48:51], v[112:127]
  ds_read_b64_tr_b16 a[44:45], v17 offset:9536
  ds_read_b64_tr_b16 a[46:47], v17 offset:11072
  v_mfma_f32_32x32x16_bf16 v[128:143], a[16:19], a[48:51], v[128:143]
  s_add_u32 m0, m0, 1024
  s_nop 0
  buffer_load_dwordx4 v12, s[12:15], s27 offen lds
  v_mfma_f32_32x32x16_bf16 v[144:159], a[20:23], a[48:51], v[144:159]
  s_waitcnt vmcnt(15) lgkmcnt(0)
  s_barrier
  s_add_u32 s30, s30, 24576
  s_cmp_eq_u32 s30, 98304
  s_cselect_b32 s30, 0, s30
  v_add_u32 v16, s30, v14
  v_add_u32 v17, s30, v15
  v_mfma_f32_32x32x16_bf16 v[64:79], a[24:27], a[56:59], v[64:79]
  ds_read_b128 a[48:51], v32 offset:32768
  ds_read_b64_tr_b16 a[0:1], v16 offset:0
  ds_read_b64_tr_b16 a[2:3], v16 offset:1536
  s_add_u32 m0, m0, 1024
  s_nop 0
  buffer_load_dwordx4 v13, s[12:15], s27 offen lds
  s_add_u32 s27, s27, s28
  s_add_u32 s29, s29, 24576
  s_cmp_eq_u32 s29, 98304
  s_cselect_b32 s29, 0, s29
  v_mfma_f32_32x32x16_bf16 v[80:95], a[28:31], a[56:59], v[80:95]
  ds_read_b64_tr_b16 a[4:5], v17 offset:64
  ds_read_b64_tr_b16 a[6:7], v17 offset:1600
  ds_read_b64_tr_b16 a[8:9], v16 offset:128
  ds_read_b64_tr_b16 a[10:11], v16 offset:1664
  v_mfma_f32_32x32x16_bf16 v[96:111], a[32:35], a[56:59], v[96:111]
  ds_read_b64_tr_b16 a[12:13], v17 offset:192
  ds_read_b64_tr_b16 a[14:15], v17 offset:1728
  ds_read_b64_tr_b16 a[16:17], v16 offset:256
  ds_read_b64_tr_b16 a[18:19], v16 offset:1792
  v_mfma_f32_32x32x16_bf16 v[112:127], a[36:39], a[56:59], v[112:127]
  ds_read_b64_tr_b16 a[20:21], v17 offset:320
  ds_read_b64_tr_b16 a[22:23], v17 offset:1856
  v_mfma_f32_32x32x16_bf16 v[128:143], a[40:43], a[56:59], v[128:143]
  v_mfma_f32_32x32x16_bf16 v[144:159], a[44:47], a[56:59], v[144:159]
  s_waitcnt lgkmcnt(0)
  v_mfma_f32_32x32x16_bf16 v[64:79], a[0:3], a[48:51], v[64:79]
  ds_read_b128 a[56:59], v33 offset:32768
  ds_read_b64_tr_b16 a[24:25], v16 offset:3072
  ds_read_b64_tr_b16 a[26:27], v16 offset:4608
  s_add_u32 m0, s52, 16384
  s_nop 0
  buffer_load_dwordx4 v24, s[48:51], s26 offen lds
  v_mfma_f32_32x32x16_bf16 v[80:95], a[4:7], a[48:51], v[80:95]
  ds_read_b64_tr_b16 a[28:29], v17 offset:3136
  ds_read_b64_tr_b16 a[30:31], v17 offset:4672
  ds_read_b64_tr_b16 a[32:33], v16 offset:3200
  ds_read_b64_tr_b16 a[34:35], v16 offset:4736
  v_mfma_f32_32x32x16_bf16 v[96:111], a[8:11], a[48:51], v[96:111]
  ds_read_b64_tr_b16 a[36:37], v17 offset:3264
  ds_read_b64_tr_b16 a[38:39], v17 offset:4800
  ds_read_b64_tr_b16 a[40:41], v16 offset:3328
  ds_read_b64_tr_b16 a[42:43], v16 offset:4864
  s_add_u32 m0, s52, 17408
  s_nop 0
  buffer_load_dwordx4 v25, s[48:51], s26 offen lds
  v_mfma_f32_32x32x16_bf16 v[112:127], a[12:15], a[48:51], v[112:127]
  ds_read_b64_tr_b16 a[44:45], v17 offset:3392
  ds_read_b64_tr_b16 a[46:47], v17 offset:4928
  v_mfma_f32_32x32x16_bf16 v[128:143], a[16:19], a[48:51], v[128:143]
  s_add_u32 m0, s52, 18432
  s_nop 0
  buffer_load_dwordx4 v26, s[48:51], s26 offen lds
  v_mfma_f32_32x32x16_bf16 v[144:159], a[20:23], a[48:51], v[144:159]
  s_waitcnt lgkmcnt(0)
  v_mfma_f32_32x32x16_bf16 v[64:79], a[24:27], a[56:59], v[64:79]
  ds_read_b128 a[48:51], v34 offset:32768
  ds_read_b64_tr_b16 a[0:1], v16 offset:6144
  ds_read_b64_tr_b16 a[2:3], v16 offset:7680
  s_add_u32 m0, s52, 19456
  s_nop 0
  buffer_load_dwordx4 v27, s[48:51], s26 offen lds
  s_add_u32 s26, s26, 128
  v_mfma_f32_32x32x16_bf16 v[80:95], a[28:31], a[56:59], v[80:95]
  ds_read_b64_tr_b16 a[4:5], v17 offset:6208
  ds_read_b64_tr_b16 a[6:7], v17 offset:7744
  ds_read_b64_tr_b16 a[8:9], v16 offset:6272
  ds_read_b64_tr_b16 a[10:11], v16 offset:7808
  v_mfma_f32_32x32x16_bf16 v[96:111], a[32:35], a[56:59], v[96:111]
  ds_read_b64_tr_b16 a[12:13], v17 offset:6336
  ds_read_b64_tr_b16 a[14:15], v17 offset:7872
  ds_read_b64_tr_b16 a[16:17], v16 offset:6400
  ds_read_b64_tr_b16 a[18:19], v16 offset:7936
  s_add_u32 m0, s29, s32
  s_nop 0
  buffer_load_dwordx4 v8, s[12:15], s27 offen lds
  v_mfma_f32_32x32x16_bf16 v[112:127], a[36:39], a[56:59], v[112:127]
  ds_read_b64_tr_b16 a[20:21], v17 offset:6464
  ds_read_b64_tr_b16 a[22:23], v17 offset:8000
  v_mfma_f32_32x32x16_bf16 v[128:143], a[40:43], a[56:59], v[128:143]
  s_add_u32 m0, m0, 1024
  s_nop 0
  buffer_load_dwordx4 v9, s[12:15], s27 offen lds
  v_mfma_f32_32x32x16_bf16 v[144:159], a[44:47], a[56:59], v[144:159]
  s_waitcnt lgkmcnt(0)
  v_mfma_f32_32x32x16_bf16 v[64:79], a[0:3], a[48:51], v[64:79]
  ds_read_b128 a[56:59], v35 offset:32768
  ds_read_b64_tr_b16 a[24:25], v16 offset:9216
  ds_read_b64_tr_b16 a[26:27], v16 offset:10752
  s_add_u32 m0, m0, 1024
  s_nop 0
  buffer_load_dwordx4 v10, s[12:15], s27 offen lds
  v_mfma_f32_32x32x16_bf16 v[80:95], a[4:7], a[48:51], v[80:95]
  ds_read_b64_tr_b16 a[28:29], v17 offset:9280
  ds_read_b64_tr_b16 a[30:31], v17 offset:10816
  ds_read_b64_tr_b16 a[32:33], v16 offset:9344
  ds_read_b64_tr_b16 a[34:35], v16 offset:10880
  v_mfma_f32_32x32x16_bf16 v[96:111], a[8:11], a[48:51], v[96:111]
  ds_read_b64_tr_b16 a[36:37], v17 offset:9408
  ds_read_b64_tr_b16 a[38:39], v17 offset:10944
  ds_read_b64_tr_b16 a[40:41], v16 offset:9472
  ds_read_b64_tr_b16 a[42:43], v16 offset:11008
  s_add_u32 m0, m0, 1024
  s_nop 0
  buffer_load_dwordx4 v11, s[12:15], s27 offen lds
  v_mfma_f32_32x32x16_bf16 v[112:127], a[12:15], a[48:51], v[112:127]
  ds_read_b64_tr_b16 a[44:45], v17 offset:9536
  ds_read_b64_tr_b16 a[46:47], v17 offset:11072
  v_mfma_f32_32x32x16_bf16 v[128:143], a[16:19], a[48:51], v[128:143]
  s_add_u32 m0, m0, 1024
  s_nop 0
  buffer_load_dwordx4 v12, s[12:15], s27 offen lds
  v_mfma_f32_32x32x16_bf16 v[144:159], a[20:23], a[48:51], v[144:159]
  s_waitcnt vmcnt(15) lgkmcnt(0)
  s_barrier
  s_add_u32 s30, s30, 24576
  s_cmp_eq_u32 s30, 98304
  s_cselect_b32 s30, 0, s30
  v_add_u32 v16, s30, v14
  v_add_u32 v17, s30, v15
  v_mfma_f32_32x32x16_bf16 v[64:79], a[24:27], a[56:59], v[64:79]
  ds_read_b128 a[48:51], v32 offset:0
  ds_read_b64_tr_b16 a[0:1], v16 offset:0
  ds_read_b64_tr_b16 a[2:3], v16 offset:1536
  s_add_u32 m0, m0, 1024
  s_nop 0
  buffer_load_dwordx4 v13, s[12:15], s27 offen lds
  s_add_u32 s27, s27, s28
  s_add_u32 s29, s29, 24576
  s_cmp_eq_u32 s29, 98304
  s_cselect_b32 s29, 0, s29
  v_mfma_f32_32x32x16_bf16 v[80:95], a[28:31], a[56:59], v[80:95]
  ds_read_b64_tr_b16 a[4:5], v17 offset:64
  ds_read_b64_tr_b16 a[6:7], v17 offset:1600
  ds_read_b64_tr_b16 a[8:9], v16 offset:128
  ds_read_b64_tr_b16 a[10:11], v16 offset:1664
  v_mfma_f32_32x32x16_bf16 v[96:111], a[32:35], a[56:59], v[96:111]
  ds_read_b64_tr_b16 a[12:13], v17 offset:192
  ds_read_b64_tr_b16 a[14:15], v17 offset:1728
  ds_read_b64_tr_b16 a[16:17], v16 offset:256
  ds_read_b64_tr_b16 a[18:19], v16 offset:1792
  v_mfma_f32_32x32x16_bf16 v[112:127], a[36:39], a[56:59], v[112:127]
  ds_read_b64_tr_b16 a[20:21], v17 offset:320
  ds_read_b64_tr_b16 a[22:23], v17 offset:1856
  v_mfma_f32_32x32x16_bf16 v[128:143], a[40:43], a[56:59], v[128:143]
  v_mfma_f32_32x32x16_bf16 v[144:159], a[44:47], a[56:59], v[144:159]
  s_waitcnt lgkmcnt(0)
  v_mfma_f32_32x32x16_bf16 v[64:79], a[0:3], a[48:51], v[64:79]
  ds_read_b128 a[56:59], v33 offset:0
  ds_read_b64_tr_b16 a[24:25], v16 offset:3072
  ds_read_b64_tr_b16 a[26:27], v16 offset:4608
  s_add_u32 m0, s52, 32768
  s_nop 0
  buffer_load_dwordx4 v24, s[48:51], s26 offen lds
  v_mfma_f32_32x32x16_bf16 v[80:95], a[4:7], a[48:51], v[80:95]
  ds_read_b64_tr_b16 a[28:29], v17 offset:3136
  ds_read_b64_tr_b16 a[30:31], v17 offset:4672
  ds_read_b64_tr_b16 a[32:33], v16 offset:3200
  ds_read_b64_tr_b16 a[34:35], v16 offset:4736
  v_mfma_f32_32x32x16_bf16 v[96:111], a[8:11], a[48:51], v[96:111]
  ds_read_b64_tr_b16 a[36:37], v17 offset:3264
  ds_read_b64_tr_b16 a[38:39], v17 offset:4800
  ds_read_b64_tr_b16 a[40:41], v16 offset:3328
  ds_read_b64_tr_b16 a[42:43], v16 offset:4864
  s_add_u32 m0, s52, 33792
  s_nop 0
  buffer_load_dwordx4 v25, s[48:51], s26 offen lds
  v_mfma_f32_32x32x16_bf16 v[112:127], a[12:15], a[48:51], v[112:127]
  ds_read_b64_tr_b16 a[44:45], v17 offset:3392
  ds_read_b64_tr_b16 a[46:47], v17 offset:4928
  v_mfma_f32_32x32x16_bf16 v[128:143], a[16:19], a[48:51], v[128:143]
  s_add_u32 m0, s52, 34816
  s_nop 0
  buffer_load_dwordx4 v26, s[48:51], s26 offen lds
  v_mfma_f32_32x32x16_bf16 v[144:159], a[20:23], a[48:51], v[144:159]
  s_waitcnt lgkmcnt(0)
  v_mfma_f32_32x32x16_bf16 v[64:79], a[24:27], a[56:59], v[64:79]
  ds_read_b128 a[48:51], v34 offset:0
  ds_read_b64_tr_b16 a[0:1], v16 offset:6144
  ds_read_b64_tr_b16 a[2:3], v16 offset:7680
  s_add_u32 m0, s52, 35840
  s_nop 0
  buffer_load_dwordx4 v27, s[48:51], s26 offen lds
  s_add_u32 s26, s26, 128
  v_mfma_f32_32x32x16_bf16 v[80:95], a[28:31], a[56:59], v[80:95]
  ds_read_b64_tr_b16 a[4:5], v17 offset:6208
  ds_read_b64_tr_b16 a[6:7], v17 offset:7744
  ds_read_b64_tr_b16 a[8:9], v16 offset:6272
  ds_read_b64_tr_b16 a[10:11], v16 offset:7808
  v_mfma_f32_32x32x16_bf16 v[96:111], a[32:35], a[56:59], v[96:111]
  ds_read_b64_tr_b16 a[12:13], v17 offset:6336
  ds_read_b64_tr_b16 a[14:15], v17 offset:7872
  ds_read_b64_tr_b16 a[16:17], v16 offset:6400
  ds_read_b64_tr_b16 a[18:19], v16 offset:7936
  s_add_u32 m0, s29, s32
  s_nop 0
  buffer_load_dwordx4 v8, s[12:15], s27 offen lds
  v_mfma_f32_32x32x16_bf16 v[112:127], a[36:39], a[56:59], v[112:127]
  ds_read_b64_tr_b16 a[20:21], v17 offset:6464
  ds_read_b64_tr_b16 a[22:23], v17 offset:8000
  v_mfma_f32_32x32x16_bf16 v[128:143], a[40:43], a[56:59], v[128:143]
  s_add_u32 m0, m0, 1024
  s_nop 0
  buffer_load_dwordx4 v9, s[12:15], s27 offen lds
  v_mfma_f32_32x32x16_bf16 v[144:159], a[44:47], a[56:59], v[144:159]
  s_waitcnt lgkmcnt(0)
  v_mfma_f32_32x32x16_bf16 v[64:79], a[0:3], a[48:51], v[64:79]
  ds_read_b128 a[56:59], v35 offset:0
  ds_read_b64_tr_b16 a[24:25], v16 offset:9216
  ds_read_b64_tr_b16 a[26:27], v16 offset:10752
  s_add_u32 m0, m0, 1024
  s_nop 0
  buffer_load_dwordx4 v10, s[12:15], s27 offen lds
  v_mfma_f32_32x32x16_bf16 v[80:95], a[4:7], a[48:51], v[80:95]
  ds_read_b64_tr_b16 a[28:29], v17 offset:9280
  ds_read_b64_tr_b16 a[30:31], v17 offset:10816
  ds_read_b64_tr_b16 a[32:33], v16 offset:9344
  ds_read_b64_tr_b16 a[34:35], v16 offset:10880
  v_mfma_f32_32x32x16_bf16 v[96:111], a[8:11], a[48:51], v[96:111]
  ds_read_b64_tr_b16 a[36:37], v17 offset:9408
  ds_read_b64_tr_b16 a[38:39], v17 offset:10944
  ds_read_b64_tr_b16 a[40:41], v16 offset:9472
  ds_read_b64_tr_b16 a[42:43], v16 offset:11008
  s_add_u32 m0, m0, 1024
  s_nop 0
  buffer_load_dwordx4 v11, s[12:15], s27 offen lds
  v_mfma_f32_32x32x16_bf16 v[112:127], a[12:15], a[48:51], v[112:127]
  ds_read_b64_tr_b16 a[44:45], v17 offset:9536
  ds_read_b64_tr_b16 a[46:47], v17 offset:11072
  v_mfma_f32_32x32x16_bf16 v[128:143], a[16:19], a[48:51], v[128:143]
  s_add_u32 m0, m0, 1024
  s_nop 0
  buffer_load_dwordx4 v12, s[12:15], s27 offen lds
  v_mfma_f32_32x32x16_bf16 v[144:159], a[20:23], a[48:51], v[144:159]
  s_waitcnt vmcnt(15) lgkmcnt(0)
  s_barrier
  s_add_u32 s30, s30, 24576
  s_cmp_eq_u32 s30, 98304
  s_cselect_b32 s30, 0, s30
  v_add_u32 v16, s30, v14
  v_add_u32 v17, s30, v15
  v_mfma_f32_32x32x16_bf16 v[64:79], a[24:27], a[56:59], v[64:79]
  ds_read_b128 a[48:51], v32 offset:16384
  ds_read_b64_tr_b16 a[0:1], v16 offset:0
  ds_read_b64_tr_b16 a[2:3], v16 offset:1536
  s_add_u32 m0, m0, 1024
  s_nop 0
  buffer_load_dwordx4 v13, s[12:15], s27 offen lds
  s_add_u32 s27, s27, s28
  s_add_u32 s29, s29, 24576
  s_cmp_eq_u32 s29, 98304
  s_cselect_b32 s29, 0, s29
  v_mfma_f32_32x32x16_bf16 v[80:95], a[28:31], a[56:59], v[80:95]
  ds_read_b64_tr_b16 a[4:5], v17 offset:64
  ds_read_b64_tr_b16 a[6:7], v17 offset:1600
  ds_read_b64_tr_b16 a[8:9], v16 offset:128
  ds_read_b64_tr_b16 a[10:11], v16 offset:1664
  v_mfma_f32_32x32x16_bf16 v[96:111], a[32:35], a[56:59], v[96:111]
  ds_read_b64_tr_b16 a[12:13], v17 offset:192
  ds_read_b64_tr_b16 a[14:15], v17 offset:1728
  ds_read_b64_tr_b16 a[16:17], v16 offset:256
  ds_read_b64_tr_b16 a[18:19], v16 offset:1792
  v_mfma_f32_32x32x16_bf16 v[112:127], a[36:39], a[56:59], v[112:127]
  ds_read_b64_tr_b16 a[20:21], v17 offset:320
  ds_read_b64_tr_b16 a[22:23], v17 offset:1856
  v_mfma_f32_32x32x16_bf16 v[128:143], a[40:43], a[56:59], v[128:143]
  v_mfma_f32_32x32x16_bf16 v[144:159], a[44:47], a[56:59], v[144:159]
  s_waitcnt lgkmcnt(0)
  v_mfma_f32_32x32x16_bf16 v[64:79], a[0:3], a[48:51], v[64:79]
  ds_read_b128 a[56:59], v33 offset:16384
  ds_read_b64_tr_b16 a[24:25], v16 offset:3072
  ds_read_b64_tr_b16 a[26:27], v16 offset:4608
  s_add_u32 m0, s52, 0
  s_nop 0
  buffer_load_dwordx4 v24, s[48:51], s26 offen lds
  v_mfma_f32_32x32x16_bf16 v[80:95], a[4:7], a[48:51], v[80:95]
  ds_read_b64_tr_b16 a[28:29], v17 offset:3136
  ds_read_b64_tr_b16 a[30:31], v17 offset:4672
  ds_read_b64_tr_b16 a[32:33], v16 offset:3200
  ds_read_b64_tr_b16 a[34:35], v16 offset:4736
  v_mfma_f32_32x32x16_bf16 v[96:111], a[8:11], a[48:51], v[96:111]
  ds_read_b64_tr_b16 a[36:37], v17 offset:3264
  ds_read_b64_tr_b16 a[38:39], v17 offset:4800
  ds_read_b64_tr_b16 a[40:41], v16 offset:3328
  ds_read_b64_tr_b16 a[42:43], v16 offset:4864
  s_add_u32 m0, s52, 1024
  s_nop 0
  buffer_load_dwordx4 v25, s[48:51], s26 offen lds
  v_mfma_f32_32x32x16_bf16 v[112:127], a[12:15], a[48:51], v[112:127]
  ds_read_b64_tr_b16 a[44:45], v17 offset:3392
  ds_read_b64_tr_b16 a[46:47], v17 offset:4928
  v_mfma_f32_32x32x16_bf16 v[128:143], a[16:19], a[48:51], v[128:143]
  s_add_u32 m0, s52, 2048
  s_nop 0
  buffer_load_dwordx4 v26, s[48:51], s26 offen lds
  v_mfma_f32_32x32x16_bf16 v[144:159], a[20:23], a[48:51], v[144:159]
  s_waitcnt lgkmcnt(0)
  v_mfma_f32_32x32x16_bf16 v[64:79], a[24:27], a[56:59], v[64:79]
  ds_read_b128 a[48:51], v34 offset:16384
  ds_read_b64_tr_b16 a[0:1], v16 offset:6144
  ds_read_b64_tr_b16 a[2:3], v16 offset:7680
  s_add_u32 m0, s52, 3072
  s_nop 0
  buffer_load_dwordx4 v27, s[48:51], s26 offen lds
  s_add_u32 s26, s26, 128
  v_mfma_f32_32x32x16_bf16 v[80:95], a[28:31], a[56:59], v[80:95]
  ds_read_b64_tr_b16 a[4:5], v17 offset:6208
  ds_read_b64_tr_b16 a[6:7], v17 offset:7744
  ds_read_b64_tr_b16 a[8:9], v16 offset:6272
  ds_read_b64_tr_b16 a[10:11], v16 offset:7808
  v_mfma_f32_32x32x16_bf16 v[96:111], a[32:35], a[56:59], v[96:111]
  ds_read_b64_tr_b16 a[12:13], v17 offset:6336
  ds_read_b64_tr_b16 a[14:15], v17 offset:7872
  ds_read_b64_tr_b16 a[16:17], v16 offset:6400
  ds_read_b64_tr_b16 a[18:19], v16 offset:7936
  s_add_u32 m0, s29, s32
  s_nop 0
  buffer_load_dwordx4 v8, s[12:15], s27 offen lds
  v_mfma_f32_32x32x16_bf16 v[112:127], a[36:39], a[56:59], v[112:127]
  ds_read_b64_tr_b16 a[20:21], v17 offset:6464
  ds_read_b64_tr_b16 a[22:23], v17 offset:8000
  v_mfma_f32_32x32x16_bf16 v[128:143], a[40:43], a[56:59], v[128:143]
  s_add_u32 m0, m0, 1024
  s_nop 0
  buffer_load_dwordx4 v9, s[12:15], s27 offen lds
  v_mfma_f32_32x32x16_bf16 v[144:159], a[44:47], a[56:59], v[144:159]
  s_waitcnt lgkmcnt(0)
  v_mfma_f32_32x32x16_bf16 v[64:79], a[0:3], a[48:51], v[64:79]
  ds_read_b128 a[56:59], v35 offset:16384
  ds_read_b64_tr_b16 a[24:25], v16 offset:9216
  ds_read_b64_tr_b16 a[26:27], v16 offset:10752
  s_add_u32 m0, m0, 1024
  s_nop 0
  buffer_load_dwordx4 v10, s[12:15], s27 offen lds
  v_mfma_f32_32x32x16_bf16 v[80:95], a[4:7], a[48:51], v[80:95]
  ds_read_b64_tr_b16 a[28:29], v17 offset:9280
  ds_read_b64_tr_b16 a[30:31], v17 offset:10816
  ds_read_b64_tr_b16 a[32:33], v16 offset:9344
  ds_read_b64_tr_b16 a[34:35], v16 offset:10880
  v_mfma_f32_32x32x16_bf16 v[96:111], a[8:11], a[48:51], v[96:111]
  ds_read_b64_tr_b16 a[36:37], v17 offset:9408
  ds_read_b64_tr_b16 a[38:39], v17 offset:10944
  ds_read_b64_tr_b16 a[40:41], v16 offset:9472
  ds_read_b64_tr_b16 a[42:43], v16 offset:11008
  s_add_u32 m0, m0, 1024
  s_nop 0
  buffer_load_dwordx4 v11, s[12:15], s27 offen lds
  v_mfma_f32_32x32x16_bf16 v[112:127], a[12:15], a[48:51], v[112:127]
  ds_read_b64_tr_b16 a[44:45], v17 offset:9536
  ds_read_b64_tr_b16 a[46:47], v17 offset:11072
  v_mfma_f32_32x32x16_bf16 v[128:143], a[16:19], a[48:51], v[128:143]
  s_add_u32 m0, m0, 1024
  s_nop 0
  buffer_load_dwordx4 v12, s[12:15], s27 offen lds
  v_mfma_f32_32x32x16_bf16 v[144:159], a[20:23], a[48:51], v[144:159]
  s_waitcnt vmcnt(15) lgkmcnt(0)
  s_barrier
  s_add_u32 s30, s30, 24576
  s_cmp_eq_u32 s30, 98304
  s_cselect_b32 s30, 0, s30
  v_add_u32 v16, s30, v14
  v_add_u32 v17, s30, v15
  v_mfma_f32_32x32x16_bf16 v[64:79], a[24:27], a[56:59], v[64:79]
  ds_read_b128 a[48:51], v32 offset:32768
  ds_read_b64_tr_b16 a[0:1], v16 offset:0
  ds_read_b64_tr_b16 a[2:3], v16 offset:1536
  s_add_u32 m0, m0, 1024
  s_nop 0
  buffer_load_dwordx4 v13, s[12:15], s27 offen lds
  s_add_u32 s27, s27, s28
  s_add_u32 s29, s29, 24576
  s_cmp_eq_u32 s29, 98304
  s_cselect_b32 s29, 0, s29
  v_mfma_f32_32x32x16_bf16 v[80:95], a[28:31], a[56:59], v[80:95]
  ds_read_b64_tr_b16 a[4:5], v17 offset:64
  ds_read_b64_tr_b16 a[6:7], v17 offset:1600
  ds_read_b64_tr_b16 a[8:9], v16 offset:128
  ds_read_b64_tr_b16 a[10:11], v16 offset:1664
  v_mfma_f32_32x32x16_bf16 v[96:111], a[32:35], a[56:59], v[96:111]
  ds_read_b64_tr_b16 a[12:13], v17 offset:192
  ds_read_b64_tr_b16 a[14:15], v17 offset:1728
  ds_read_b64_tr_b16 a[16:17], v16 offset:256
  ds_read_b64_tr_b16 a[18:19], v16 offset:1792
  v_mfma_f32_32x32x16_bf16 v[112:127], a[36:39], a[56:59], v[112:127]
  ds_read_b64_tr_b16 a[20:21], v17 offset:320
  ds_read_b64_tr_b16 a[22:23], v17 offset:1856
  v_mfma_f32_32x32x16_bf16 v[128:143], a[40:43], a[56:59], v[128:143]
  v_mfma_f32_32x32x16_bf16 v[144:159], a[44:47], a[56:59], v[144:159]
  s_waitcnt lgkmcnt(0)
  v_mfma_f32_32x32x16_bf16 v[64:79], a[0:3], a[48:51], v[64:79]
  ds_read_b128 a[56:59], v33 offset:32768
  ds_read_b64_tr_b16 a[24:25], v16 offset:3072
  ds_read_b64_tr_b16 a[26:27], v16 offset:4608
  s_add_u32 m0, s52, 16384
  s_nop 0
  buffer_load_dwordx4 v24, s[48:51], s26 offen lds
  v_mfma_f32_32x32x16_bf16 v[80:95], a[4:7], a[48:51], v[80:95]
  ds_read_b64_tr_b16 a[28:29], v17 offset:3136
  ds_read_b64_tr_b16 a[30:31], v17 offset:4672
  ds_read_b64_tr_b16 a[32:33], v16 offset:3200
  ds_read_b64_tr_b16 a[34:35], v16 offset:4736
  v_mfma_f32_32x32x16_bf16 v[96:111], a[8:11], a[48:51], v[96:111]
  ds_read_b64_tr_b16 a[36:37], v17 offset:3264
  ds_read_b64_tr_b16 a[38:39], v17 offset:4800
  ds_read_b64_tr_b16 a[40:41], v16 offset:3328
  ds_read_b64_tr_b16 a[42:43], v16 offset:4864
  s_add_u32 m0, s52, 17408
  s_nop 0
  buffer_load_dwordx4 v25, s[48:51], s26 offen lds
  v_mfma_f32_32x32x16_bf16 v[112:127], a[12:15], a[48:51], v[112:127]
  ds_read_b64_tr_b16 a[44:45], v17 offset:3392
  ds_read_b64_tr_b16 a[46:47], v17 offset:4928
  v_mfma_f32_32x32x16_bf16 v[128:143], a[16:19], a[48:51], v[128:143]
  s_add_u32 m0, s52, 18432
  s_nop 0
  buffer_load_dwordx4 v26, s[48:51], s26 offen lds
  v_mfma_f32_32x32x16_bf16 v[144:159], a[20:23], a[48:51], v[144:159]
  s_waitcnt lgkmcnt(0)
  v_mfma_f32_32x32x16_bf16 v[64:79], a[24:27], a[56:59], v[64:79]
  ds_read_b128 a[48:51], v34 offset:32768
  ds_read_b64_tr_b16 a[0:1], v16 offset:6144
  ds_read_b64_tr_b16 a[2:3], v16 offset:7680
  s_add_u32 m0, s52, 19456
  s_nop 0
  buffer_load_dwordx4 v27, s[48:51], s26 offen lds
  s_add_u32 s26, s26, 128
  v_mfma_f32_32x32x16_bf16 v[80:95], a[28:31], a[56:59], v[80:95]
  ds_read_b64_tr_b16 a[4:5], v17 offset:6208
  ds_read_b64_tr_b16 a[6:7], v17 offset:7744
  ds_read_b64_tr_b16 a[8:9], v16 offset:6272
  ds_read_b64_tr_b16 a[10:11], v16 offset:7808
  v_mfma_f32_32x32x16_bf16 v[96:111], a[32:35], a[56:59], v[96:111]
  ds_read_b64_tr_b16 a[12:13], v17 offset:6336
  ds_read_b64_tr_b16 a[14:15], v17 offset:7872
  ds_read_b64_tr_b16 a[16:17], v16 offset:6400
  ds_read_b64_tr_b16 a[18:19], v16 offset:7936
  s_add_u32 m0, s29, s32
  s_nop 0
  buffer_load_dwordx4 v8, s[12:15], s27 offen lds
  v_mfma_f32_32x32x16_bf16 v[112:127], a[36:39], a[56:59], v[112:127]
  ds_read_b64_tr_b16 a[20:21], v17 offset:6464
  ds_read_b64_tr_b16 a[22:23], v17 offset:8000
  v_mfma_f32_32x32x16_bf16 v[128:143], a[40:43], a[56:59], v[128:143]
  s_add_u32 m0, m0, 1024
  s_nop 0
  buffer_load_dwordx4 v9, s[12:15], s27 offen lds
  v_mfma_f32_32x32x16_bf16 v[144:159], a[44:47], a[56:59], v[144:159]
  s_waitcnt lgkmcnt(0)
  v_mfma_f32_32x32x16_bf16 v[64:79], a[0:3], a[48:51], v[64:79]
  ds_read_b128 a[56:59], v35 offset:32768
  ds_read_b64_tr_b16 a[24:25], v16 offset:9216
  ds_read_b64_tr_b16 a[26:27], v16 offset:10752
  s_add_u32 m0, m0, 1024
  s_nop 0
  buffer_load_dwordx4 v10, s[12:15], s27 offen lds
  v_mfma_f32_32x32x16_bf16 v[80:95], a[4:7], a[48:51], v[80:95]
  ds_read_b64_tr_b16 a[28:29], v17 offset:9280
  ds_read_b64_tr_b16 a[30:31], v17 offset:10816
  ds_read_b64_tr_b16 a[32:33], v16 offset:9344
  ds_read_b64_tr_b16 a[34:35], v16 offset:10880
  v_mfma_f32_32x32x16_bf16 v[96:111], a[8:11], a[48:51], v[96:111]
  ds_read_b64_tr_b16 a[36:37], v17 offset:9408
  ds_read_b64_tr_b16 a[38:39], v17 offset:10944
  ds_read_b64_tr_b16 a[40:41], v16 offset:9472
  ds_read_b64_tr_b16 a[42:43], v16 offset:11008
  s_add_u32 m0, m0, 1024
  s_nop 0
  buffer_load_dwordx4 v11, s[12:15], s27 offen lds
  v_mfma_f32_32x32x16_bf16 v[112:127], a[12:15], a[48:51], v[112:127]
  ds_read_b64_tr_b16 a[44:45], v17 offset:9536
  ds_read_b64_tr_b16 a[46:47], v17 offset:11072
  v_mfma_f32_32x32x16_bf16 v[128:143], a[16:19], a[48:51], v[128:143]
  s_add_u32 m0, m0, 1024
  s_nop 0
  buffer_load_dwordx4 v12, s[12:15], s27 offen lds
  v_mfma_f32_32x32x16_bf16 v[144:159], a[20:23], a[48:51], v[144:159]
  s_waitcnt vmcnt(15) lgkmcnt(0)
  s_barrier
  s_add_u32 s30, s30, 24576
  s_cmp_eq_u32 s30, 98304
  s_cselect_b32 s30, 0, s30
  v_add_u32 v16, s30, v14
  v_add_u32 v17, s30, v15
  v_mfma_f32_32x32x16_bf16 v[64:79], a[24:27], a[56:59], v[64:79]
  ds_read_b128 a[48:51], v32 offset:0
  ds_read_b64_tr_b16 a[0:1], v16 offset:0
  ds_read_b64_tr_b16 a[2:3], v16 offset:1536
  s_add_u32 m0, m0, 1024
  s_nop 0
  buffer_load_dwordx4 v13, s[12:15], s27 offen lds
  s_add_u32 s27, s27, s28
  s_add_u32 s29, s29, 24576
  s_cmp_eq_u32 s29, 98304
  s_cselect_b32 s29, 0, s29
  v_mfma_f32_32x32x16_bf16 v[80:95], a[28:31], a[56:59], v[80:95]
  ds_read_b64_tr_b16 a[4:5], v17 offset:64
  ds_read_b64_tr_b16 a[6:7], v17 offset:1600
  ds_read_b64_tr_b16 a[8:9], v16 offset:128
  ds_read_b64_tr_b16 a[10:11], v16 offset:1664
  v_mfma_f32_32x32x16_bf16 v[96:111], a[32:35], a[56:59], v[96:111]
  ds_read_b64_tr_b16 a[12:13], v17 offset:192
  ds_read_b64_tr_b16 a[14:15], v17 offset:1728
  ds_read_b64_tr_b16 a[16:17], v16 offset:256
  ds_read_b64_tr_b16 a[18:19], v16 offset:1792
  v_mfma_f32_32x32x16_bf16 v[112:127], a[36:39], a[56:59], v[112:127]
  ds_read_b64_tr_b16 a[20:21], v17 offset:320
  ds_read_b64_tr_b16 a[22:23], v17 offset:1856
  v_mfma_f32_32x32x16_bf16 v[128:143], a[40:43], a[56:59], v[128:143]
  v_mfma_f32_32x32x16_bf16 v[144:159], a[44:47], a[56:59], v[144:159]
  s_waitcnt lgkmcnt(0)
  v_mfma_f32_32x32x16_bf16 v[64:79], a[0:3], a[48:51], v[64:79]
  ds_read_b128 a[56:59], v33 offset:0
  ds_read_b64_tr_b16 a[24:25], v16 offset:3072
  ds_read_b64_tr_b16 a[26:27], v16 offset:4608
  s_add_u32 m0, s52, 32768
  s_nop 0
  buffer_load_dwordx4 v24, s[48:51], s26 offen lds
  v_mfma_f32_32x32x16_bf16 v[80:95], a[4:7], a[48:51], v[80:95]
  ds_read_b64_tr_b16 a[28:29], v17 offset:3136
  ds_read_b64_tr_b16 a[30:31], v17 offset:4672
  ds_read_b64_tr_b16 a[32:33], v16 offset:3200
  ds_read_b64_tr_b16 a[34:35], v16 offset:4736
  v_mfma_f32_32x32x16_bf16 v[96:111], a[8:11], a[48:51], v[96:111]
  ds_read_b64_tr_b16 a[36:37], v17 offset:3264
  ds_read_b64_tr_b16 a[38:39], v17 offset:4800
  ds_read_b64_tr_b16 a[40:41], v16 offset:3328
  ds_read_b64_tr_b16 a[42:43], v16 offset:4864
  s_add_u32 m0, s52, 33792
  s_nop 0
  buffer_load_dwordx4 v25, s[48:51], s26 offen lds
  v_mfma_f32_32x32x16_bf16 v[112:127], a[12:15], a[48:51], v[112:127]
  ds_read_b64_tr_b16 a[44:45], v17 offset:3392
  ds_read_b64_tr_b16 a[46:47], v17 offset:4928
  v_mfma_f32_32x32x16_bf16 v[128:143], a[16:19], a[48:51], v[128:143]
  s_add_u32 m0, s52, 34816
  s_nop 0
  buffer_load_dwordx4 v26, s[48:51], s26 offen lds
  v_mfma_f32_32x32x16_bf16 v[144:159], a[20:23], a[48:51], v[144:159]
  s_waitcnt lgkmcnt(0)
  v_mfma_f32_32x32x16_bf16 v[64:79], a[24:27], a[56:59], v[64:79]
  ds_read_b128 a[48:51], v34 offset:0
  ds_read_b64_tr_b16 a[0:1], v16 offset:6144
  ds_read_b64_tr_b16 a[2:3], v16 offset:7680
  s_add_u32 m0, s52, 35840
  s_nop 0
  buffer_load_dwordx4 v27, s[48:51], s26 offen lds
  s_add_u32 s26, s26, 128
  v_mfma_f32_32x32x16_bf16 v[80:95], a[28:31], a[56:59], v[80:95]
  ds_read_b64_tr_b16 a[4:5], v17 offset:6208
  ds_read_b64_tr_b16 a[6:7], v17 offset:7744
  ds_read_b64_tr_b16 a[8:9], v16 offset:6272
  ds_read_b64_tr_b16 a[10:11], v16 offset:7808
  v_mfma_f32_32x32x16_bf16 v[96:111], a[32:35], a[56:59], v[96:111]
  ds_read_b64_tr_b16 a[12:13], v17 offset:6336
  ds_read_b64_tr_b16 a[14:15], v17 offset:7872
  ds_read_b64_tr_b16 a[16:17], v16 offset:6400
  ds_read_b64_tr_b16 a[18:19], v16 offset:7936
  s_add_u32 m0, s29, s32
  s_nop 0
  buffer_load_dwordx4 v8, s[12:15], s27 offen lds
  v_mfma_f32_32x32x16_bf16 v[112:127], a[36:39], a[56:59], v[112:127]
  ds_read_b64_tr_b16 a[20:21], v17 offset:6464
  ds_read_b64_tr_b16 a[22:23], v17 offset:8000
  v_mfma_f32_32x32x16_bf16 v[128:143], a[40:43], a[56:59], v[128:143]
  s_add_u32 m0, m0, 1024
  s_nop 0
  buffer_load_dwordx4 v9, s[12:15], s27 offen lds
  v_mfma_f32_32x32x16_bf16 v[144:159], a[44:47], a[56:59], v[144:159]
  s_waitcnt lgkmcnt(0)
  v_mfma_f32_32x32x16_bf16 v[64:79], a[0:3], a[48:51], v[64:79]
  ds_read_b128 a[56:59], v35 offset:0
  ds_read_b64_tr_b16 a[24:25], v16 offset:9216
  ds_read_b64_tr_b16 a[26:27], v16 offset:10752
  s_add_u32 m0, m0, 1024
  s_nop 0
  buffer_load_dwordx4 v10, s[12:15], s27 offen lds
  v_mfma_f32_32x32x16_bf16 v[80:95], a[4:7], a[48:51], v[80:95]
  ds_read_b64_tr_b16 a[28:29], v17 offset:9280
  ds_read_b64_tr_b16 a[30:31], v17 offset:10816
  ds_read_b64_tr_b16 a[32:33], v16 offset:9344
  ds_read_b64_tr_b16 a[34:35], v16 offset:10880
  v_mfma_f32_32x32x16_bf16 v[96:111], a[8:11], a[48:51], v[96:111]
  ds_read_b64_tr_b16 a[36:37], v17 offset:9408
  ds_read_b64_tr_b16 a[38:39], v17 offset:10944
  ds_read_b64_tr_b16 a[40:41], v16 offset:9472
  ds_read_b64_tr_b16 a[42:43], v16 offset:11008
  s_add_u32 m0, m0, 1024
  s_nop 0
  buffer_load_dwordx4 v11, s[12:15], s27 offen lds
  v_mfma_f32_32x32x16_bf16 v[112:127], a[12:15], a[48:51], v[112:127]
  ds_read_b64_tr_b16 a[44:45], v17 offset:9536
  ds_read_b64_tr_b16 a[46:47], v17 offset:11072
  v_mfma_f32_32x32x16_bf16 v[128:143], a[16:19], a[48:51], v[128:143]
  s_add_u32 m0, m0, 1024
  s_nop 0
  buffer_load_dwordx4 v12, s[12:15], s27 offen lds
  v_mfma_f32_32x32x16_bf16 v[144:159], a[20:23], a[48:51], v[144:159]
  s_waitcnt vmcnt(15) lgkmcnt(0)
  s_barrier
  s_add_u32 s30, s30, 24576
  s_cmp_eq_u32 s30, 98304
  s_cselect_b32 s30, 0, s30
  v_add_u32 v16, s30, v14
  v_add_u32 v17, s30, v15
  v_mfma_f32_32x32x16_bf16 v[64:79], a[24:27], a[56:59], v[64:79]
  ds_read_b128 a[48:51], v32 offset:16384
  ds_read_b64_tr_b16 a[0:1], v16 offset:0
  ds_read_b64_tr_b16 a[2:3], v16 offset:1536
  s_add_u32 m0, m0, 1024
  s_nop 0
  buffer_load_dwordx4 v13, s[12:15], s27 offen lds
  s_add_u32 s27, s27, s28
  s_add_u32 s29, s29, 24576
  s_cmp_eq_u32 s29, 98304
  s_cselect_b32 s29, 0, s29
  v_mfma_f32_32x32x16_bf16 v[80:95], a[28:31], a[56:59], v[80:95]
  ds_read_b64_tr_b16 a[4:5], v17 offset:64
  ds_read_b64_tr_b16 a[6:7], v17 offset:1600
  ds_read_b64_tr_b16 a[8:9], v16 offset:128
  ds_read_b64_tr_b16 a[10:11], v16 offset:1664
  v_mfma_f32_32x32x16_bf16 v[96:111], a[32:35], a[56:59], v[96:111]
  ds_read_b64_tr_b16 a[12:13], v17 offset:192
  ds_read_b64_tr_b16 a[14:15], v17 offset:1728
  ds_read_b64_tr_b16 a[16:17], v16 offset:256
  ds_read_b64_tr_b16 a[18:19], v16 offset:1792
  v_mfma_f32_32x32x16_bf16 v[112:127], a[36:39], a[56:59], v[112:127]
  ds_read_b64_tr_b16 a[20:21], v17 offset:320
  ds_read_b64_tr_b16 a[22:23], v17 offset:1856
  v_mfma_f32_32x32x16_bf16 v[128:143], a[40:43], a[56:59], v[128:143]
  v_mfma_f32_32x32x16_bf16 v[144:159], a[44:47], a[56:59], v[144:159]
  s_waitcnt lgkmcnt(0)
  v_mfma_f32_32x32x16_bf16 v[64:79], a[0:3], a[48:51], v[64:79]
  ds_read_b128 a[56:59], v33 offset:16384
  ds_read_b64_tr_b16 a[24:25], v16 offset:3072
  ds_read_b64_tr_b16 a[26:27], v16 offset:4608
  s_add_u32 m0, s52, 0
  s_nop 0
  buffer_load_dwordx4 v24, s[48:51], s26 offen lds
  v_mfma_f32_32x32x16_bf16 v[80:95], a[4:7], a[48:51], v[80:95]
  ds_read_b64_tr_b16 a[28:29], v17 offset:3136
  ds_read_b64_tr_b16 a[30:31], v17 offset:4672
  ds_read_b64_tr_b16 a[32:33], v16 offset:3200
  ds_read_b64_tr_b16 a[34:35], v16 offset:4736
  v_mfma_f32_32x32x16_bf16 v[96:111], a[8:11], a[48:51], v[96:111]
  ds_read_b64_tr_b16 a[36:37], v17 offset:3264
  ds_read_b64_tr_b16 a[38:39], v17 offset:4800
  ds_read_b64_tr_b16 a[40:41], v16 offset:3328
  ds_read_b64_tr_b16 a[42:43], v16 offset:4864
  s_add_u32 m0, s52, 1024
  s_nop 0
  buffer_load_dwordx4 v25, s[48:51], s26 offen lds
  v_mfma_f32_32x32x16_bf16 v[112:127], a[12:15], a[48:51], v[112:127]
  ds_read_b64_tr_b16 a[44:45], v17 offset:3392
  ds_read_b64_tr_b16 a[46:47], v17 offset:4928
  v_mfma_f32_32x32x16_bf16 v[128:143], a[16:19], a[48:51], v[128:143]
  s_add_u32 m0, s52, 2048
  s_nop 0
  buffer_load_dwordx4 v26, s[48:51], s26 offen lds
  v_mfma_f32_32x32x16_bf16 v[144:159], a[20:23], a[48:51], v[144:159]
  s_waitcnt lgkmcnt(0)
  v_mfma_f32_32x32x16_bf16 v[64:79], a[24:27], a[56:59], v[64:79]
  ds_read_b128 a[48:51], v34 offset:16384
  ds_read_b64_tr_b16 a[0:1], v16 offset:6144
  ds_read_b64_tr_b16 a[2:3], v16 offset:7680
  s_add_u32 m0, s52, 3072
  s_nop 0
  buffer_load_dwordx4 v27, s[48:51], s26 offen lds
  s_add_u32 s26, s26, 128
  v_mfma_f32_32x32x16_bf16 v[80:95], a[28:31], a[56:59], v[80:95]
  ds_read_b64_tr_b16 a[4:5], v17 offset:6208
  ds_read_b64_tr_b16 a[6:7], v17 offset:7744
  ds_read_b64_tr_b16 a[8:9], v16 offset:6272
  ds_read_b64_tr_b16 a[10:11], v16 offset:7808
  v_mfma_f32_32x32x16_bf16 v[96:111], a[32:35], a[56:59], v[96:111]
  ds_read_b64_tr_b16 a[12:13], v17 offset:6336
  ds_read_b64_tr_b16 a[14:15], v17 offset:7872
  ds_read_b64_tr_b16 a[16:17], v16 offset:6400
  ds_read_b64_tr_b16 a[18:19], v16 offset:7936
  v_mfma_f32_32x32x16_bf16 v[112:127], a[36:39], a[56:59], v[112:127]
  ds_read_b64_tr_b16 a[20:21], v17 offset:6464
  ds_read_b64_tr_b16 a[22:23], v17 offset:8000
  v_mfma_f32_32x32x16_bf16 v[128:143], a[40:43], a[56:59], v[128:143]
  v_mfma_f32_32x32x16_bf16 v[144:159], a[44:47], a[56:59], v[144:159]
  s_waitcnt lgkmcnt(0)
  v_mfma_f32_32x32x16_bf16 v[64:79], a[0:3], a[48:51], v[64:79]
  ds_read_b128 a[56:59], v35 offset:16384
  ds_read_b64_tr_b16 a[24:25], v16 offset:9216
  ds_read_b64_tr_b16 a[26:27], v16 offset:10752
  v_mfma_f32_32x32x16_bf16 v[80:95], a[4:7], a[48:51], v[80:95]
  ds_read_b64_tr_b16 a[28:29], v17 offset:9280
  ds_read_b64_tr_b16 a[30:31], v17 offset:10816
  ds_read_b64_tr_b16 a[32:33], v16 offset:9344
  ds_read_b64_tr_b16 a[34:35], v16 offset:10880
  v_mfma_f32_32x32x16_bf16 v[96:111], a[8:11], a[48:51], v[96:111]
  ds_read_b64_tr_b16 a[36:37], v17 offset:9408
  ds_read_b64_tr_b16 a[38:39], v17 offset:10944
  ds_read_b64_tr_b16 a[40:41], v16 offset:9472
  ds_read_b64_tr_b16 a[42:43], v16 offset:11008
  v_mfma_f32_32x32x16_bf16 v[112:127], a[12:15], a[48:51], v[112:127]
  ds_read_b64_tr_b16 a[44:45], v17 offset:9536
  ds_read_b64_tr_b16 a[46:47], v17 offset:11072
  v_mfma_f32_32x32x16_bf16 v[128:143], a[16:19], a[48:51], v[128:143]
  v_mfma_f32_32x32x16_bf16 v[144:159], a[20:23], a[48:51], v[144:159]
  s_waitcnt vmcnt(10) lgkmcnt(0)
  s_barrier
  s_add_u32 s30, s30, 24576
  s_cmp_eq_u32 s30, 98304
  s_cselect_b32 s30, 0, s30
  v_add_u32 v16, s30, v14
  v_add_u32 v17, s30, v15
  v_mfma_f32_32x32x16_bf16 v[64:79], a[24:27], a[56:59], v[64:79]
  ds_read_b128 a[48:51], v32 offset:32768
  ds_read_b64_tr_b16 a[0:1], v16 offset:0
  ds_read_b64_tr_b16 a[2:3], v16 offset:1536
  v_mfma_f32_32x32x16_bf16 v[80:95], a[28:31], a[56:59], v[80:95]
  ds_read_b64_tr_b16 a[4:5], v17 offset:64
  ds_read_b64_tr_b16 a[6:7], v17 offset:1600
  ds_read_b64_tr_b16 a[8:9], v16 offset:128
  ds_read_b64_tr_b16 a[10:11], v16 offset:1664
  v_mfma_f32_32x32x16_bf16 v[96:111], a[32:35], a[56:59], v[96:111]
  ds_read_b64_tr_b16 a[12:13], v17 offset:192
  ds_read_b64_tr_b16 a[14:15], v17 offset:1728
  ds_read_b64_tr_b16 a[16:17], v16 offset:256
  ds_read_b64_tr_b16 a[18:19], v16 offset:1792
  v_mfma_f32_32x32x16_bf16 v[112:127], a[36:39], a[56:59], v[112:127]
  ds_read_b64_tr_b16 a[20:21], v17 offset:320
  ds_read_b64_tr_b16 a[22:23], v17 offset:1856
  v_mfma_f32_32x32x16_bf16 v[128:143], a[40:43], a[56:59], v[128:143]
  v_mfma_f32_32x32x16_bf16 v[144:159], a[44:47], a[56:59], v[144:159]
  s_waitcnt lgkmcnt(0)
  v_mfma_f32_32x32x16_bf16 v[64:79], a[0:3], a[48:51], v[64:79]
  ds_read_b128 a[56:59], v33 offset:32768
  ds_read_b64_tr_b16 a[24:25], v16 offset:3072
  ds_read_b64_tr_b16 a[26:27], v16 offset:4608
  v_mfma_f32_32x32x16_bf16 v[80:95], a[4:7], a[48:51], v[80:95]
  ds_read_b64_tr_b16 a[28:29], v17 offset:3136
  ds_read_b64_tr_b16 a[30:31], v17 offset:4672
  ds_read_b64_tr_b16 a[32:33], v16 offset:3200
  ds_read_b64_tr_b16 a[34:35], v16 offset:4736
  v_mfma_f32_32x32x16_bf16 v[96:111], a[8:11], a[48:51], v[96:111]
  ds_read_b64_tr_b16 a[36:37], v17 offset:3264
  ds_read_b64_tr_b16 a[38:39], v17 offset:4800
  ds_read_b64_tr_b16 a[40:41], v16 offset:3328
  ds_read_b64_tr_b16 a[42:43], v16 offset:4864
  v_mfma_f32_32x32x16_bf16 v[112:127], a[12:15], a[48:51], v[112:127]
  ds_read_b64_tr_b16 a[44:45], v17 offset:3392
  ds_read_b64_tr_b16 a[46:47], v17 offset:4928
  v_mfma_f32_32x32x16_bf16 v[128:143], a[16:19], a[48:51], v[128:143]
  v_mfma_f32_32x32x16_bf16 v[144:159], a[20:23], a[48:51], v[144:159]
  s_waitcnt lgkmcnt(0)
  v_mfma_f32_32x32x16_bf16 v[64:79], a[24:27], a[56:59], v[64:79]
  ds_read_b128 a[48:51], v34 offset:32768
  ds_read_b64_tr_b16 a[0:1], v16 offset:6144
  ds_read_b64_tr_b16 a[2:3], v16 offset:7680
  v_mfma_f32_32x32x16_bf16 v[80:95], a[28:31], a[56:59], v[80:95]
  ds_read_b64_tr_b16 a[4:5], v17 offset:6208
  ds_read_b64_tr_b16 a[6:7], v17 offset:7744
  ds_read_b64_tr_b16 a[8:9], v16 offset:6272
  ds_read_b64_tr_b16 a[10:11], v16 offset:7808
  v_mfma_f32_32x32x16_bf16 v[96:111], a[32:35], a[56:59], v[96:111]
  ds_read_b64_tr_b16 a[12:13], v17 offset:6336
  ds_read_b64_tr_b16 a[14:15], v17 offset:7872
  ds_read_b64_tr_b16 a[16:17], v16 offset:6400
  ds_read_b64_tr_b16 a[18:19], v16 offset:7936
  v_mfma_f32_32x32x16_bf16 v[112:127], a[36:39], a[56:59], v[112:127]
  ds_read_b64_tr_b16 a[20:21], v17 offset:6464
  ds_read_b64_tr_b16 a[22:23], v17 offset:8000
  v_mfma_f32_32x32x16_bf16 v[128:143], a[40:43], a[56:59], v[128:143]
  v_mfma_f32_32x32x16_bf16 v[144:159], a[44:47], a[56:59], v[144:159]
  s_waitcnt lgkmcnt(0)
  v_mfma_f32_32x32x16_bf16 v[64:79], a[0:3], a[48:51], v[64:79]
  ds_read_b128 a[56:59], v35 offset:32768
  ds_read_b64_tr_b16 a[24:25], v16 offset:9216
  ds_read_b64_tr_b16 a[26:27], v16 offset:10752
  v_mfma_f32_32x32x16_bf16 v[80:95], a[4:7], a[48:51], v[80:95]
  ds_read_b64_tr_b16 a[28:29], v17 offset:9280
  ds_read_b64_tr_b16 a[30:31], v17 offset:10816
  ds_read_b64_tr_b16 a[32:33], v16 offset:9344
  ds_read_b64_tr_b16 a[34:35], v16 offset:10880
  v_mfma_f32_32x32x16_bf16 v[96:111], a[8:11], a[48:51], v[96:111]
  ds_read_b64_tr_b16 a[36:37], v17 offset:9408
  ds_read_b64_tr_b16 a[38:39], v17 offset:10944
  ds_read_b64_tr_b16 a[40:41], v16 offset:9472
  ds_read_b64_tr_b16 a[42:43], v16 offset:11008
  v_mfma_f32_32x32x16_bf16 v[112:127], a[12:15], a[48:51], v[112:127]
  ds_read_b64_tr_b16 a[44:45], v17 offset:9536
  ds_read_b64_tr_b16 a[46:47], v17 offset:11072
  v_mfma_f32_32x32x16_bf16 v[128:143], a[16:19], a[48:51], v[128:143]
  v_mfma_f32_32x32x16_bf16 v[144:159], a[20:23], a[48:51], v[144:159]
  s_waitcnt vmcnt(0) lgkmcnt(0)
  s_barrier
  s_add_u32 s30, s30, 24576
  s_cmp_eq_u32 s30, 98304
  s_cselect_b32 s30, 0, s30
  v_add_u32 v16, s30, v14
  v_add_u32 v17, s30, v15
  v_mfma_f32_32x32x16_bf16 v[64:79], a[24:27], a[56:59], v[64:79]
  ds_read_b128 a[48:51], v32 offset:0
  ds_read_b64_tr_b16 a[0:1], v16 offset:0
  ds_read_b64_tr_b16 a[2:3], v16 offset:1536
  v_mfma_f32_32x32x16_bf16 v[80:95], a[28:31], a[56:59], v[80:95]
  ds_read_b64_tr_b16 a[4:5], v17 offset:64
  ds_read_b64_tr_b16 a[6:7], v17 offset:1600
  ds_read_b64_tr_b16 a[8:9], v16 offset:128
  ds_read_b64_tr_b16 a[10:11], v16 offset:1664
  v_mfma_f32_32x32x16_bf16 v[96:111], a[32:35], a[56:59], v[96:111]
  ds_read_b64_tr_b16 a[12:13], v17 offset:192
  ds_read_b64_tr_b16 a[14:15], v17 offset:1728
  ds_read_b64_tr_b16 a[16:17], v16 offset:256
  ds_read_b64_tr_b16 a[18:19], v16 offset:1792
  v_mfma_f32_32x32x16_bf16 v[112:127], a[36:39], a[56:59], v[112:127]
  ds_read_b64_tr_b16 a[20:21], v17 offset:320
  ds_read_b64_tr_b16 a[22:23], v17 offset:1856
  v_mfma_f32_32x32x16_bf16 v[128:143], a[40:43], a[56:59], v[128:143]
  v_mfma_f32_32x32x16_bf16 v[144:159], a[44:47], a[56:59], v[144:159]
  s_waitcnt lgkmcnt(0)
  v_mfma_f32_32x32x16_bf16 v[64:79], a[0:3], a[48:51], v[64:79]
  ds_read_b128 a[56:59], v33 offset:0
  ds_read_b64_tr_b16 a[24:25], v16 offset:3072
  ds_read_b64_tr_b16 a[26:27], v16 offset:4608
  v_mfma_f32_32x32x16_bf16 v[80:95], a[4:7], a[48:51], v[80:95]
  ds_read_b64_tr_b16 a[28:29], v17 offset:3136
  ds_read_b64_tr_b16 a[30:31], v17 offset:4672
  ds_read_b64_tr_b16 a[32:33], v16 offset:3200
  ds_read_b64_tr_b16 a[34:35], v16 offset:4736
  v_mfma_f32_32x32x16_bf16 v[96:111], a[8:11], a[48:51], v[96:111]
  ds_read_b64_tr_b16 a[36:37], v17 offset:3264
  ds_read_b64_tr_b16 a[38:39], v17 offset:4800
  ds_read_b64_tr_b16 a[40:41], v16 offset:3328
  ds_read_b64_tr_b16 a[42:43], v16 offset:4864
  v_mfma_f32_32x32x16_bf16 v[112:127], a[12:15], a[48:51], v[112:127]
  ds_read_b64_tr_b16 a[44:45], v17 offset:3392
  ds_read_b64_tr_b16 a[46:47], v17 offset:4928
  v_mfma_f32_32x32x16_bf16 v[128:143], a[16:19], a[48:51], v[128:143]
  v_mfma_f32_32x32x16_bf16 v[144:159], a[20:23], a[48:51], v[144:159]
  s_waitcnt lgkmcnt(0)
  v_mfma_f32_32x32x16_bf16 v[64:79], a[24:27], a[56:59], v[64:79]
  ds_read_b128 a[48:51], v34 offset:0
  ds_read_b64_tr_b16 a[0:1], v16 offset:6144
  ds_read_b64_tr_b16 a[2:3], v16 offset:7680
  v_mfma_f32_32x32x16_bf16 v[80:95], a[28:31], a[56:59], v[80:95]
  ds_read_b64_tr_b16 a[4:5], v17 offset:6208
  ds_read_b64_tr_b16 a[6:7], v17 offset:7744
  ds_read_b64_tr_b16 a[8:9], v16 offset:6272
  ds_read_b64_tr_b16 a[10:11], v16 offset:7808
  v_mfma_f32_32x32x16_bf16 v[96:111], a[32:35], a[56:59], v[96:111]
  ds_read_b64_tr_b16 a[12:13], v17 offset:6336
  ds_read_b64_tr_b16 a[14:15], v17 offset:7872
  ds_read_b64_tr_b16 a[16:17], v16 offset:6400
  ds_read_b64_tr_b16 a[18:19], v16 offset:7936
  v_mfma_f32_32x32x16_bf16 v[112:127], a[36:39], a[56:59], v[112:127]
  ds_read_b64_tr_b16 a[20:21], v17 offset:6464
  ds_read_b64_tr_b16 a[22:23], v17 offset:8000
  v_mfma_f32_32x32x16_bf16 v[128:143], a[40:43], a[56:59], v[128:143]
  v_mfma_f32_32x32x16_bf16 v[144:159], a[44:47], a[56:59], v[144:159]
  s_waitcnt lgkmcnt(0)
  v_mfma_f32_32x32x16_bf16 v[64:79], a[0:3], a[48:51], v[64:79]
  ds_read_b128 a[56:59], v35 offset:0
  ds_read_b64_tr_b16 a[24:25], v16 offset:9216
  ds_read_b64_tr_b16 a[26:27], v16 offset:10752
  v_mfma_f32_32x32x16_bf16 v[80:95], a[4:7], a[48:51], v[80:95]
  ds_read_b64_tr_b16 a[28:29], v17 offset:9280
  ds_read_b64_tr_b16 a[30:31], v17 offset:10816
  ds_read_b64_tr_b16 a[32:33], v16 offset:9344
  ds_read_b64_tr_b16 a[34:35], v16 offset:10880
  v_mfma_f32_32x32x16_bf16 v[96:111], a[8:11], a[48:51], v[96:111]
  ds_read_b64_tr_b16 a[36:37], v17 offset:9408
  ds_read_b64_tr_b16 a[38:39], v17 offset:10944
  ds_read_b64_tr_b16 a[40:41], v16 offset:9472
  ds_read_b64_tr_b16 a[42:43], v16 offset:11008
  v_mfma_f32_32x32x16_bf16 v[112:127], a[12:15], a[48:51], v[112:127]
  ds_read_b64_tr_b16 a[44:45], v17 offset:9536
  ds_read_b64_tr_b16 a[46:47], v17 offset:11072
  v_mfma_f32_32x32x16_bf16 v[128:143], a[16:19], a[48:51], v[128:143]
  v_mfma_f32_32x32x16_bf16 v[144:159], a[20:23], a[48:51], v[144:159]
  s_waitcnt lgkmcnt(0)
  v_mfma_f32_32x32x16_bf16 v[64:79], a[24:27], a[56:59], v[64:79]
  v_mfma_f32_32x32x16_bf16 v[80:95], a[28:31], a[56:59], v[80:95]
  v_mfma_f32_32x32x16_bf16 v[96:111], a[32:35], a[56:59], v[96:111]
  v_mfma_f32_32x32x16_bf16 v[112:127], a[36:39], a[56:59], v[112:127]
  v_mfma_f32_32x32x16_bf16 v[128:143], a[40:43], a[56:59], v[128:143]
  v_mfma_f32_32x32x16_bf16 v[144:159], a[44:47], a[56:59], v[144:159]
  s_nop 7
  v_cvt_pk_bf16_f32 v40, v64, v65
  v_cvt_pk_bf16_f32 v41, v66, v67
  v_cvt_pk_bf16_f32 v42, v68, v69
  v_cvt_pk_bf16_f32 v43, v70, v71
  s_add_u32 s25, s31, 0
  buffer_store_dwordx4 v[40:43], v36, s[8:11], s25 offen offset:0 sc1
  v_cvt_pk_bf16_f32 v44, v72, v73
  v_cvt_pk_bf16_f32 v45, v74, v75
  v_cvt_pk_bf16_f32 v46, v76, v77
  v_cvt_pk_bf16_f32 v47, v78, v79
  buffer_store_dwordx4 v[44:47], v36, s[8:11], s25 offen offset:1024 sc1
  v_cvt_pk_bf16_f32 v48, v80, v81
  v_cvt_pk_bf16_f32 v49, v82, v83
  v_cvt_pk_bf16_f32 v50, v84, v85
  v_cvt_pk_bf16_f32 v51, v86, v87
  buffer_store_dwordx4 v[48:51], v36, s[8:11], s25 offen offset:2048 sc1
  v_cvt_pk_bf16_f32 v52, v88, v89
  v_cvt_pk_bf16_f32 v53, v90, v91
  v_cvt_pk_bf16_f32 v54, v92, v93
  v_cvt_pk_bf16_f32 v55, v94, v95
  buffer_store_dwordx4 v[52:55], v36, s[8:11], s25 offen offset:3072 sc1
  v_cvt_pk_bf16_f32 v56, v96, v97
  v_cvt_pk_bf16_f32 v57, v98, v99
  v_cvt_pk_bf16_f32 v58, v100, v101
  v_cvt_pk_bf16_f32 v59, v102, v103
  s_add_u32 s25, s31, 4096
  buffer_store_dwordx4 v[56:59], v36, s[8:11], s25 offen offset:0 sc1
  v_cvt_pk_bf16_f32 v60, v104, v105
  v_cvt_pk_bf16_f32 v61, v106, v107
  v_cvt_pk_bf16_f32 v62, v108, v109
  v_cvt_pk_bf16_f32 v63, v110, v111
  buffer_store_dwordx4 v[60:63], v36, s[8:11], s25 offen offset:1024 sc1
  v_cvt_pk_bf16_f32 v40, v112, v113
  v_cvt_pk_bf16_f32 v41, v114, v115
  v_cvt_pk_bf16_f32 v42, v116, v117
  v_cvt_pk_bf16_f32 v43, v118, v119
  buffer_store_dwordx4 v[40:43], v36, s[8:11], s25 offen offset:2048 sc1
  v_cvt_pk_bf16_f32 v44, v120, v121
  v_cvt_pk_bf16_f32 v45, v122, v123
  v_cvt_pk_bf16_f32 v46, v124, v125
  v_cvt_pk_bf16_f32 v47, v126, v127
  buffer_store_dwordx4 v[44:47], v36, s[8:11], s25 offen offset:3072 sc1
  v_cvt_pk_bf16_f32 v48, v128, v129
  v_cvt_pk_bf16_f32 v49, v130, v131
  v_cvt_pk_bf16_f32 v50, v132, v133
  v_cvt_pk_bf16_f32 v51, v134, v135
  s_add_u32 s25, s31, 8192
  buffer_store_dwordx4 v[48:51], v36, s[8:11], s25 offen offset:0 sc1
  v_cvt_pk_bf16_f32 v52, v136, v137
  v_cvt_pk_bf16_f32 v53, v138, v139
  v_cvt_pk_bf16_f32 v54, v140, v141
  v_cvt_pk_bf16_f32 v55, v142, v143
  buffer_store_dwordx4 v[52:55], v36, s[8:11], s25 offen offset:1024 sc1
  v_cvt_pk_bf16_f32 v56, v144, v145
  v_cvt_pk_bf16_f32 v57, v146, v147
  v_cvt_pk_bf16_f32 v58, v148, v149
  v_cvt_pk_bf16_f32 v59, v150, v151
  buffer_store_dwordx4 v[56:59], v36, s[8:11], s25 offen offset:2048 sc1
  v_cvt_pk_bf16_f32 v60, v152, v153
  v_cvt_pk_bf16_f32 v61, v154, v155
  v_cvt_pk_bf16_f32 v62, v156, v157
  v_cvt_pk_bf16_f32 v63, v158, v159
  buffer_store_dwordx4 v[60:63], v36, s[8:11], s25 offen offset:3072 sc1
  s_cmp_eq_u32 s81, 0
  s_cbranch_scc1 W_sp_4
  v_mbcnt_lo_u32_b32 v3, -1, 0
  v_and_b32 v3, 15, v3
  v_min_u32 v3, 8, v3
  v_and_b32 v4, 1, v3
  v_lshlrev_b32 v3, 2, v3
  v_lshl_add_u32 v3, v4, 7, v3
W_sp_4c:
  buffer_load_dword v2, v3, s[4:7], 0 offen sc1
  s_sub_u32 s82, s82, 1
  s_cbranch_scc1 W_abort
  s_waitcnt vmcnt(0)
  v_readlane_b32 s84, v2, 0
  v_readlane_b32 s85, v2, 1
  v_readlane_b32 s86, v2, 2
  v_readlane_b32 s87, v2, 3
  v_readlane_b32 s88, v2, 4
  v_readlane_b32 s89, v2, 5
  v_readlane_b32 s90, v2, 6
  v_readlane_b32 s91, v2, 7
  v_readlane_b32 s92, v2, 8
  s_cmp_eq_u32 s92, 256
  s_cbranch_scc1 W_sp_4c_ok
  s_sleep 8
  s_branch W_sp_4c
W_sp_4c_ok:
  s_mov_b32 s81, 0
  s_and_b32 s25, s84, s85
  s_and_b32 s25, s25, s86
  s_and_b32 s25, s25, s87
  s_and_b32 s25, s25, s88
  s_and_b32 s25, s25, s89
  s_and_b32 s25, s25, s90
  s_and_b32 s25, s25, s91
  s_cmp_eq_u32 s25, 32
  s_cbranch_scc1 W_sp_4r
  s_waitcnt vmcnt(0) lgkmcnt(0)
  s_barrier
  s_branch M_worker
W_sp_4r:
  s_load_dwordx2 s[84:85], s[0:1], 0
  s_load_dwordx2 s[86:87], s[0:1], 56
  s_waitcnt lgkmcnt(0)
W_sp_4:
  s_cmp_eq_u32 s62, 0
  s_cbranch_scc1 W_fin_3
  s_mov_b32 s53, s36
  s_cmp_eq_u32 s24, 0
  s_cselect_b32 s54, s39, 0
  s_branch W_warm
W_fin_3:
  s_waitcnt vmcnt(0)
  s_barrier
  s_mov_b32 s53, s36
  s_cmp_eq_u32 s24, 0
  s_cselect_b32 s54, s39, 0
  s_cmp_eq_u32 s54, 0
  s_cbranch_scc1 W_pf_5
  v_mov_b32 v2, 1
  v_lshlrev_b32 v3, 2, v1
  s_mov_b32 exec_hi, 0
  s_mov_b32 exec_lo, s54
  buffer_store_dword v2, v3, s[8:11], s53 offen sc1
  s_mov_b64 exec, -1
  s_mov_b32 s54, 0
W_pf_5:
  s_branch W_next
W_vu1:
  v_lshrrev_b32 v4, 3, v1
  s_mul_i32 s25, s24, 32
  v_add_u32 v4, s25, v4
  v_mul_u32_u24 v4, 1280, v4
  v_lshrrev_b32 v5, 4, v1
  v_and_b32 v6, 7, v1
  v_xor_b32 v5, v5, v6
  v_lshl_add_u32 v24, v5, 4, v4
  v_xor_b32 v5, 4, v5
  v_lshl_add_u32 v25, v5, 4, v4
  v_add_u32 v25, 10240, v25
  v_add_u32 v26, 20480, v24
  v_add_u32 v27, 20480, v25
  s_mul_i32 s52, s24, 4096
  s_add_u32 s52, s52, 98304
  s_mul_i32 s25, s24, 384
  s_add_u32 s25, s25, 0
  v_add_u32 v4, s25, v1
  v_mul_u32_u24 v5, 2731, v4
  v_lshrrev_b32 v5, 16, v5
  v_mul_u32_u24 v6, 24, v5
  v_sub_u32 v6, v4, v6
  v_lshlrev_b32 v7, 1, v5
  v_and_b32 v7, 4, v7
  v_xor_b32 v6, v6, v7
  v_mul_lo_u32 v5, v5, s33
  v_lshl_add_u32 v8, v6, 4, v5
  s_mul_i32 s25, s24, 384
  s_add_u32 s25, s25, 64
  v_add_u32 v4, s25, v1
  v_mul_u32_u24 v5, 2731, v4
  v_lshrrev_b32 v5, 16, v5
  v_mul_u32_u24 v6, 24, v5
  v_sub_u32 v6, v4, v6
  v_lshlrev_b32 v7, 1, v5
  v_and_b32 v7, 4, v7
  v_xor_b32 v6, v6, v7
  v_mul_lo_u32 v5, v5, s33
  v_lshl_add_u32 v9, v6, 4, v5
  s_mul_i32 s25, s24, 384
  s_add_u32 s25, s25, 128
  v_add_u32 v4, s25, v1
  v_mul_u32_u24 v5, 2731, v4
  v_lshrrev_b32 v5, 16, v5
  v_mul_u32_u24 v6, 24, v5
  v_sub_u32 v6, v4, v6
  v_lshlrev_b32 v7, 1, v5
  v_and_b32 v7, 4, v7
  v_xor_b32 v6, v6, v7
  v_mul_lo_u32 v5, v5, s33
  v_lshl_add_u32 v10, v6, 4, v5
  s_mul_i32 s25, s24, 384
  s_add_u32 s25, s25, 192
  v_add_u32 v4, s25, v1
  v_mul_u32_u24 v5, 2731, v4
  v_lshrrev_b32 v5, 16, v5
  v_mul_u32_u24 v6, 24, v5
  v_sub_u32 v6, v4, v6
  v_lshlrev_b32 v7, 1, v5
  v_and_b32 v7, 4, v7
  v_xor_b32 v6, v6, v7
  v_mul_lo_u32 v5, v5, s33
  v_lshl_add_u32 v11, v6, 4, v5
  s_mul_i32 s25, s24, 384
  s_add_u32 s25, s25, 256
  v_add_u32 v4, s25, v1
  v_mul_u32_u24 v5, 2731, v4
  v_lshrrev_b32 v5, 16, v5
  v_mul_u32_u24 v6, 24, v5
  v_sub_u32 v6, v4, v6
  v_lshlrev_b32 v7, 1, v5
  v_and_b32 v7, 4, v7
  v_xor_b32 v6, v6, v7
  v_mul_lo_u32 v5, v5, s33
  v_lshl_add_u32 v12, v6, 4, v5
  s_mul_i32 s25, s24, 384
  s_add_u32 s25, s25, 320
  v_add_u32 v4, s25, v1
  v_mul_u32_u24 v5, 2731, v4
  v_lshrrev_b32 v5, 16, v5
  v_mul_u32_u24 v6, 24, v5
  v_sub_u32 v6, v4, v6
  v_lshlrev_b32 v7, 1, v5
  v_and_b32 v7, 4, v7
  v_xor_b32 v6, v6, v7
  v_mul_lo_u32 v5, v5, s33
  v_lshl_add_u32 v13, v6, 4, v5
  s_lshl_b32 s28, s33, 6
  s_mul_i32 s32, s24, 6144
  s_mov_b32 s29, 0
  s_add_u32 m0, s29, s32
  s_nop 0
  buffer_load_dwordx4 v8, s[12:15], s27 offen lds
  s_add_u32 m0, m0, 1024
  s_nop 0
  buffer_load_dwordx4 v9, s[12:15], s27 offen lds
  s_add_u32 m0, m0, 1024
  s_nop 0
  buffer_load_dwordx4 v10, s[12:15], s27 offen lds
  s_add_u32 m0, m0, 1024
  s_nop 0
  buffer_load_dwordx4 v11, s[12:15], s27 offen lds
  s_add_u32 m0, m0, 1024
  s_nop 0
  buffer_load_dwordx4 v12, s[12:15], s27 offen lds
  s_add_u32 m0, m0, 1024
  s_nop 0
  buffer_load_dwordx4 v13, s[12:15], s27 offen lds
  s_add_u32 s27, s27, s28
  s_add_u32 s29, s29, 24576
  s_cmp_eq_u32 s29, 98304
  s_cselect_b32 s29, 0, s29
  s_add_u32 m0, s52, 0
  s_nop 0
  buffer_load_dwordx4 v24, s[48:51], s26 offen lds
  s_add_u32 m0, s52, 1024
  s_nop 0
  buffer_load_dwordx4 v25, s[48:51], s26 offen lds
  s_add_u32 m0, s52, 2048
  s_nop 0
  buffer_load_dwordx4 v26, s[48:51], s26 offen lds
  s_add_u32 m0, s52, 3072
  s_nop 0
  buffer_load_dwordx4 v27, s[48:51], s26 offen lds
  s_add_u32 s26, s26, 128
  s_add_u32 m0, s29, s32
  s_nop 0
  buffer_load_dwordx4 v8, s[12:15], s27 offen lds
  s_add_u32 m0, m0, 1024
  s_nop 0
  buffer_load_dwordx4 v9, s[12:15], s27 offen lds
  s_add_u32 m0, m0, 1024
  s_nop 0
  buffer_load_dwordx4 v10, s[12:15], s27 offen lds
  s_add_u32 m0, m0, 1024
  s_nop 0
  buffer_load_dwordx4 v11, s[12:15], s27 offen lds
  s_add_u32 m0, m0, 1024
  s_nop 0
  buffer_load_dwordx4 v12, s[12:15], s27 offen lds
  s_add_u32 m0, m0, 1024
  s_nop 0
  buffer_load_dwordx4 v13, s[12:15], s27 offen lds
  s_add_u32 s27, s27, s28
  s_add_u32 s29, s29, 24576
  s_cmp_eq_u32 s29, 98304
  s_cselect_b32 s29, 0, s29
  s_add_u32 m0, s52, 16384
  s_nop 0
  buffer_load_dwordx4 v24, s[48:51], s26 offen lds
  s_add_u32 m0, s52, 17408
  s_nop 0
  buffer_load_dwordx4 v25, s[48:51], s26 offen lds
  s_add_u32 m0, s52, 18432
  s_nop 0
  buffer_load_dwordx4 v26, s[48:51], s26 offen lds
  s_add_u32 m0, s52, 19456
  s_nop 0
  buffer_load_dwordx4 v27, s[48:51], s26 offen lds
  s_add_u32 s26, s26, 128
  s_add_u32 m0, s29, s32
  s_nop 0
  buffer_load_dwordx4 v8, s[12:15], s27 offen lds
  s_add_u32 m0, m0, 1024
  s_nop 0
  buffer_load_dwordx4 v9, s[12:15], s27 offen lds
  s_add_u32 m0, m0, 1024
  s_nop 0
  buffer_load_dwordx4 v10, s[12:15], s27 offen lds
  s_add_u32 m0, m0, 1024
  s_nop 0
  buffer_load_dwordx4 v11, s[12:15], s27 offen lds
  s_add_u32 m0, m0, 1024
  s_nop 0
  buffer_load_dwordx4 v12, s[12:15], s27 offen lds
  s_add_u32 m0, m0, 1024
  s_nop 0
  buffer_load_dwordx4 v13, s[12:15], s27 offen lds
  s_add_u32 s27, s27, s28
  s_add_u32 s29, s29, 24576
  s_cmp_eq_u32 s29, 98304
  s_cselect_b32 s29, 0, s29
  s_mul_i32 s25, s24, 32
  v_and_b32 v4, 31, v1
  v_bfe_u32 v5, v1, 1, 3
  v_lshrrev_b32 v6, 5, v1
  v_lshlrev_b32 v6, 2, v6
  v_xor_b32 v5, v5, v6
  v_add_u32 v4, s25, v4
  v_lshlrev_b32 v4, 7, v4
  v_add_u32 v4, 98304, v4
  v_xor_b32 v6, 0, v5
  v_lshl_add_u32 v32, v6, 4, v4
  v_xor_b32 v6, 1, v5
  v_lshl_add_u32 v33, v6, 4, v4
  v_xor_b32 v6, 2, v5
  v_lshl_add_u32 v34, v6, 4, v4
  v_xor_b32 v6, 3, v5
  v_lshl_add_u32 v35, v6, 4, v4
  v_lshrrev_b32 v4, 5, v1
  v_bfe_u32 v5, v1, 2, 2
  v_mul_u32_u24 v4, 32, v4
  v_add_u32 v4, v4, v5
  v_mul_u32_u24 v4, 384, v4
  v_bfe_u32 v6, v1, 4, 1
  v_lshl_add_u32 v4, v6, 5, v4
  v_and_b32 v6, 3, v1
  v_lshl_add_u32 v4, v6, 3, v4
  v_bfe_u32 v5, v1, 3, 1
  v_lshlrev_b32 v5, 6, v5
  v_add_u32 v14, v4, v5
  v_sub_u32 v15, v4, v5
  v_lshlrev_b32 v36, 4, v1
  s_mul_i32 s25, s24, 320
  s_add_u32 s25, s25, 0
  v_add_u32 v4, s25, v1
  v_mul_u32_u24 v5, 3277, v4
  v_lshrrev_b32 v5, 16, v5
  v_mul_u32_u24 v6, 20, v5
  v_sub_u32 v6, v4, v6
  v_mul_u32_u24 v5, 1280, v5
  v_lshl_add_u32 v18, v6, 4, v5
  s_mul_i32 s25, s24, 320
  s_add_u32 s25, s25, 64
  v_add_u32 v4, s25, v1
  v_mul_u32_u24 v5, 3277, v4
  v_lshrrev_b32 v5, 16, v5
  v_mul_u32_u24 v6, 20, v5
  v_sub_u32 v6, v4, v6
  v_mul_u32_u24 v5, 1280, v5
  v_lshl_add_u32 v19, v6, 4, v5
  s_mul_i32 s25, s24, 320
  s_add_u32 s25, s25, 128
  v_add_u32 v4, s25, v1
  v_mul_u32_u24 v5, 3277, v4
  v_lshrrev_b32 v5, 16, v5
  v_mul_u32_u24 v6, 20, v5
  v_sub_u32 v6, v4, v6
  v_mul_u32_u24 v5, 1280, v5
  v_lshl_add_u32 v20, v6, 4, v5
  s_mul_i32 s25, s24, 320
  s_add_u32 s25, s25, 192
  v_add_u32 v4, s25, v1
  v_mul_u32_u24 v5, 3277, v4
  v_lshrrev_b32 v5, 16, v5
  v_mul_u32_u24 v6, 20, v5
  v_sub_u32 v6, v4, v6
  v_mul_u32_u24 v5, 1280, v5
  v_lshl_add_u32 v21, v6, 4, v5
  s_mul_i32 s25, s24, 320
  s_add_u32 s25, s25, 256
  v_add_u32 v4, s25, v1
  v_mul_u32_u24 v5, 3277, v4
  v_lshrrev_b32 v5, 16, v5
  v_mul_u32_u24 v6, 20, v5
  v_sub_u32 v6, v4, v6
  v_mul_u32_u24 v5, 1280, v5
  v_lshl_add_u32 v22, v6, 4, v5
  v_lshrrev_b32 v4, 5, v1
  v_bfe_u32 v5, v1, 2, 2
  v_mul_u32_u24 v4, 4, v4
  v_add_u32 v4, v4, v5
  v_mul_u32_u24 v4, 320, v4
  v_bfe_u32 v6, v1, 4, 1
  v_lshl_add_u32 v4, v6, 5, v4
  v_and_b32 v6, 3, v1
  v_lshl_add_u32 v4, v6, 3, v4
  v_mov_b32 v23, v4
  s_mul_i32 s34, s24, 5120
  s_mov_b32 s54, 0
  s_waitcnt vmcnt(16)
  s_barrier
  v_mov_b32 v16, v14
  v_mov_b32 v17, v15
  s_mov_b32 s30, 0
  ds_read_b128 a[48:51], v32 offset:0
  ds_read_b64_tr_b16 a[0:1], v16 offset:0
  ds_read_b64_tr_b16 a[2:3], v16 offset:1536
  ds_read_b64_tr_b16 a[4:5], v17 offset:64
  ds_read_b64_tr_b16 a[6:7], v17 offset:1600
  ds_read_b64_tr_b16 a[8:9], v16 offset:128
  ds_read_b64_tr_b16 a[10:11], v16 offset:1664
  ds_read_b64_tr_b16 a[12:13], v17 offset:192
  ds_read_b64_tr_b16 a[14:15], v17 offset:1728
  ds_read_b64_tr_b16 a[16:17], v16 offset:256
  ds_read_b64_tr_b16 a[18:19], v16 offset:1792
  ds_read_b64_tr_b16 a[20:21], v17 offset:320
  ds_read_b64_tr_b16 a[22:23], v17 offset:1856
  s_mov_b32 s40, 0
  s_waitcnt lgkmcnt(0)
  v_mfma_f32_32x32x16_bf16 v[64:79], a[0:3], a[48:51], 0
  ds_read_b128 a[56:59], v33 offset:0
  ds_read_b64_tr_b16 a[24:25], v16 offset:3072
  ds_read_b64_tr_b16 a[26:27], v16 offset:4608
  s_add_u32 m0, s52, 32768
  s_nop 0
  buffer_load_dwordx4 v24, s[48:51], s26 offen lds
  v_mfma_f32_32x32x16_bf16 v[80:95], a[4:7], a[48:51], 0
  ds_read_b64_tr_b16 a[28:29], v17 offset:3136
  ds_read_b64_tr_b16 a[30:31], v17 offset:4672
  ds_read_b64_tr_b16 a[32:33], v16 offset:3200
  ds_read_b64_tr_b16 a[34:35], v16 offset:4736
  v_mfma_f32_32x32x16_bf16 v[96:111], a[8:11], a[48:51], 0
  ds_read_b64_tr_b16 a[36:37], v17 offset:3264
  ds_read_b64_tr_b16 a[38:39], v17 offset:4800
  ds_read_b64_tr_b16 a[40:41], v16 offset:3328
  ds_read_b64_tr_b16 a[42:43], v16 offset:4864
  s_add_u32 m0, s52, 33792
  s_nop 0
  buffer_load_dwordx4 v25, s[48:51], s26 offen lds
  v_mfma_f32_32x32x16_bf16 v[112:127], a[12:15], a[48:51], 0
  ds_read_b64_tr_b16 a[44:45], v17 offset:3392
  ds_read_b64_tr_b16 a[46:47], v17 offset:4928
  v_mfma_f32_32x32x16_bf16 v[128:143], a[16:19], a[48:51], 0
  s_add_u32 m0, s52, 34816
  s_nop 0
  buffer_load_dwordx4 v26, s[48:51], s26 offen lds
  v_mfma_f32_32x32x16_bf16 v[144:159], a[20:23], a[48:51], 0
  s_waitcnt lgkmcnt(0)
  v_mfma_f32_32x32x16_bf16 v[64:79], a[24:27], a[56:59], v[64:79]
  ds_read_b128 a[48:51], v34 offset:0
  ds_read_b64_tr_b16 a[0:1], v16 offset:6144
  ds_read_b64_tr_b16 a[2:3], v16 offset:7680
  s_add_u32 m0, s52, 35840
  s_nop 0
  buffer_load_dwordx4 v27, s[48:51], s26 offen lds
  s_add_u32 s26, s26, 128
  v_mfma_f32_32x32x16_bf16 v[80:95], a[28:31], a[56:59], v[80:95]
  ds_read_b64_tr_b16 a[4:5], v17 offset:6208
  ds_read_b64_tr_b16 a[6:7], v17 offset:7744
  ds_read_b64_tr_b16 a[8:9], v16 offset:6272
  ds_read_b64_tr_b16 a[10:11], v16 offset:7808
  v_mfma_f32_32x32x16_bf16 v[96:111], a[32:35], a[56:59], v[96:111]
  ds_read_b64_tr_b16 a[12:13], v17 offset:6336
  ds_read_b64_tr_b16 a[14:15], v17 offset:7872
  ds_read_b64_tr_b16 a[16:17], v16 offset:6400
  ds_read_b64_tr_b16 a[18:19], v16 offset:7936
  s_add_u32 m0, s29, s32
  s_nop 0
  buffer_load_dwordx4 v8, s[12:15], s27 offen lds
  v_mfma_f32_32x32x16_bf16 v[112:127], a[36:39], a[56:59], v[112:127]
  ds_read_b64_tr_b16 a[20:21], v17 offset:6464
  ds_read_b64_tr_b16 a[22:23], v17 offset:8000
  v_mfma_f32_32x32x16_bf16 v[128:143], a[40:43], a[56:59], v[128:143]
  s_add_u32 m0, m0, 1024
  s_nop 0
  buffer_load_dwordx4 v9, s[12:15], s27 offen lds
  v_mfma_f32_32x32x16_bf16 v[144:159], a[44:47], a[56:59], v[144:159]
  s_waitcnt lgkmcnt(0)
  v_mfma_f32_32x32x16_bf16 v[64:79], a[0:3], a[48:51], v[64:79]
  ds_read_b128 a[56:59], v35 offset:0
  ds_read_b64_tr_b16 a[24:25], v16 offset:9216
  ds_read_b64_tr_b16 a[26:27], v16 offset:10752
  s_add_u32 m0, m0, 1024
  s_nop 0
  buffer_load_dwordx4 v10, s[12:15], s27 offen lds
  v_mfma_f32_32x32x16_bf16 v[80:95], a[4:7], a[48:51], v[80:95]
  ds_read_b64_tr_b16 a[28:29], v17 offset:9280
  ds_read_b64_tr_b16 a[30:31], v17 offset:10816
  ds_read_b64_tr_b16 a[32:33], v16 offset:9344
  ds_read_b64_tr_b16 a[34:35], v16 offset:10880
  v_mfma_f32_32x32x16_bf16 v[96:111], a[8:11], a[48:51], v[96:111]
  ds_read_b64_tr_b16 a[36:37], v17 offset:9408
  ds_read_b64_tr_b16 a[38:39], v17 offset:10944
  ds_read_b64_tr_b16 a[40:41], v16 offset:9472
  ds_read_b64_tr_b16 a[42:43], v16 offset:11008
  s_add_u32 m0, m0, 1024
  s_nop 0
  buffer_load_dwordx4 v11, s[12:15], s27 offen lds
  v_mfma_f32_32x32x16_bf16 v[112:127], a[12:15], a[48:51], v[112:127]
  ds_read_b64_tr_b16 a[44:45], v17 offset:9536
  ds_read_b64_tr_b16 a[46:47], v17 offset:11072
  v_mfma_f32_32x32x16_bf16 v[128:143], a[16:19], a[48:51], v[128:143]
  s_add_u32 m0, m0, 1024
  s_nop 0
  buffer_load_dwordx4 v12, s[12:15], s27 offen lds
  v_mfma_f32_32x32x16_bf16 v[144:159], a[20:23], a[48:51], v[144:159]
  s_waitcnt vmcnt(15) lgkmcnt(0)
  s_barrier
  s_add_u32 s30, s30, 24576
  s_cmp_eq_u32 s30, 98304
  s_cselect_b32 s30, 0, s30
  v_add_u32 v16, s30, v14
  v_add_u32 v17, s30, v15
  v_mfma_f32_32x32x16_bf16 v[64:79], a[24:27], a[56:59], v[64:79]
  ds_read_b128 a[48:51], v32 offset:16384
  ds_read_b64_tr_b16 a[0:1], v16 offset:0
  ds_read_b64_tr_b16 a[2:3], v16 offset:1536
  s_add_u32 m0, m0, 1024
  s_nop 0
  buffer_load_dwordx4 v13, s[12:15], s27 offen lds
  s_add_u32 s27, s27, s28
  s_add_u32 s29, s29, 24576
  s_cmp_eq_u32 s29, 98304
  s_cselect_b32 s29, 0, s29
  v_mfma_f32_32x32x16_bf16 v[80:95], a[28:31], a[56:59], v[80:95]
  ds_read_b64_tr_b16 a[4:5], v17 offset:64
  ds_read_b64_tr_b16 a[6:7], v17 offset:1600
  ds_read_b64_tr_b16 a[8:9], v16 offset:128
  ds_read_b64_tr_b16 a[10:11], v16 offset:1664
  v_mfma_f32_32x32x16_bf16 v[96:111], a[32:35], a[56:59], v[96:111]
  ds_read_b64_tr_b16 a[12:13], v17 offset:192
  ds_read_b64_tr_b16 a[14:15], v17 offset:1728
  ds_read_b64_tr_b16 a[16:17], v16 offset:256
  ds_read_b64_tr_b16 a[18:19], v16 offset:1792
  v_mfma_f32_32x32x16_bf16 v[112:127], a[36:39], a[56:59], v[112:127]
  ds_read_b64_tr_b16 a[20:21], v17 offset:320
  ds_read_b64_tr_b16 a[22:23], v17 offset:1856
  v_mfma_f32_32x32x16_bf16 v[128:143], a[40:43], a[56:59], v[128:143]
  v_mfma_f32_32x32x16_bf16 v[144:159], a[44:47], a[56:59], v[144:159]
  s_waitcnt lgkmcnt(0)
  v_mfma_f32_32x32x16_bf16 v[64:79], a[0:3], a[48:51], v[64:79]
  ds_read_b128 a[56:59], v33 offset:16384
  ds_read_b64_tr_b16 a[24:25], v16 offset:3072
  ds_read_b64_tr_b16 a[26:27], v16 offset:4608
  s_add_u32 m0, s52, 0
  s_nop 0
  buffer_load_dwordx4 v24, s[48:51], s26 offen lds
  v_mfma_f32_32x32x16_bf16 v[80:95], a[4:7], a[48:51], v[80:95]
  ds_read_b64_tr_b16 a[28:29], v17 offset:3136
  ds_read_b64_tr_b16 a[30:31], v17 offset:4672
  ds_read_b64_tr_b16 a[32:33], v16 offset:3200
  ds_read_b64_tr_b16 a[34:35], v16 offset:4736
  v_mfma_f32_32x32x16_bf16 v[96:111], a[8:11], a[48:51], v[96:111]
  ds_read_b64_tr_b16 a[36:37], v17 offset:3264
  ds_read_b64_tr_b16 a[38:39], v17 offset:4800
  ds_read_b64_tr_b16 a[40:41], v16 offset:3328
  ds_read_b64_tr_b16 a[42:43], v16 offset:4864
  s_add_u32 m0, s52, 1024
  s_nop 0
  buffer_load_dwordx4 v25, s[48:51], s26 offen lds
  v_mfma_f32_32x32x16_bf16 v[112:127], a[12:15], a[48:51], v[112:127]
  ds_read_b64_tr_b16 a[44:45], v17 offset:3392
  ds_read_b64_tr_b16 a[46:47], v17 offset:4928
  v_mfma_f32_32x32x16_bf16 v[128:143], a[16:19], a[48:51], v[128:143]
  s_add_u32 m0, s52, 2048
  s_nop 0
  buffer_load_dwordx4 v26, s[48:51], s26 offen lds
  v_mfma_f32_32x32x16_bf16 v[144:159], a[20:23], a[48:51], v[144:159]
  s_waitcnt lgkmcnt(0)
  v_mfma_f32_32x32x16_bf16 v[64:79], a[24:27], a[56:59], v[64:79]
  ds_read_b128 a[48:51], v34 offset:16384
  ds_read_b64_tr_b16 a[0:1], v16 offset:6144
  ds_read_b64_tr_b16 a[2:3], v16 offset:7680
  s_add_u32 m0, s52, 3072
  s_nop 0
  buffer_load_dwordx4 v27, s[48:51], s26 offen lds
  s_add_u32 s26, s26, 128
  v_mfma_f32_32x32x16_bf16 v[80:95], a[28:31], a[56:59], v[80:95]
  ds_read_b64_tr_b16 a[4:5], v17 offset:6208
  ds_read_b64_tr_b16 a[6:7], v17 offset:7744
  ds_read_b64_tr_b16 a[8:9], v16 offset:6272
  ds_read_b64_tr_b16 a[10:11], v16 offset:7808
  v_mfma_f32_32x32x16_bf16 v[96:111], a[32:35], a[56:59], v[96:111]
  ds_read_b64_tr_b16 a[12:13], v17 offset:6336
  ds_read_b64_tr_b16 a[14:15], v17 offset:7872
  ds_read_b64_tr_b16 a[16:17], v16 offset:6400
  ds_read_b64_tr_b16 a[18:19], v16 offset:7936
  s_add_u32 m0, s29, s32
  s_nop 0
  buffer_load_dwordx4 v8, s[12:15], s27 offen lds
  v_mfma_f32_32x32x16_bf16 v[112:127], a[36:39], a[56:59], v[112:127]
  ds_read_b64_tr_b16 a[20:21], v17 offset:6464
  ds_read_b64_tr_b16 a[22:23], v17 offset:8000
  v_mfma_f32_32x32x16_bf16 v[128:143], a[40:43], a[56:59], v[128:143]
  s_add_u32 m0, m0, 1024
  s_nop 0
  buffer_load_dwordx4 v9, s[12:15], s27 offen lds
  v_mfma_f32_32x32x16_bf16 v[144:159], a[44:47], a[56:59], v[144:159]
  s_waitcnt lgkmcnt(0)
  v_mfma_f32_32x32x16_bf16 v[64:79], a[0:3], a[48:51], v[64:79]
  ds_read_b128 a[56:59], v35 offset:16384
  ds_read_b64_tr_b16 a[24:25], v16 offset:9216
  ds_read_b64_tr_b16 a[26:27], v16 offset:10752
  s_add_u32 m0, m0, 1024
  s_nop 0
  buffer_load_dwordx4 v10, s[12:15], s27 offen lds
  v_mfma_f32_32x32x16_bf16 v[80:95], a[4:7], a[48:51], v[80:95]
  ds_read_b64_tr_b16 a[28:29], v17 offset:9280
  ds_read_b64_tr_b16 a[30:31], v17 offset:10816
  ds_read_b64_tr_b16 a[32:33], v16 offset:9344
  ds_read_b64_tr_b16 a[34:35], v16 offset:10880
  v_mfma_f32_32x32x16_bf16 v[96:111], a[8:11], a[48:51], v[96:111]
  ds_read_b64_tr_b16 a[36:37], v17 offset:9408
  ds_read_b64_tr_b16 a[38:39], v17 offset:10944
  ds_read_b64_tr_b16 a[40:41], v16 offset:9472
  ds_read_b64_tr_b16 a[42:43], v16 offset:11008
  s_add_u32 m0, m0, 1024
  s_nop 0
  buffer_load_dwordx4 v11, s[12:15], s27 offen lds
  v_mfma_f32_32x32x16_bf16 v[112:127], a[12:15], a[48:51], v[112:127]
  ds_read_b64_tr_b16 a[44:45], v17 offset:9536
  ds_read_b64_tr_b16 a[46:47], v17 offset:11072
  v_mfma_f32_32x32x16_bf16 v[128:143], a[16:19], a[48:51], v[128:143]
  s_add_u32 m0, m0, 1024
  s_nop 0
  buffer_load_dwordx4 v12, s[12:15], s27 offen lds
  v_mfma_f32_32x32x16_bf16 v[144:159], a[20:23], a[48:51], v[144:159]
  s_waitcnt vmcnt(15) lgkmcnt(0)
  s_barrier
  s_add_u32 s30, s30, 24576
  s_cmp_eq_u32 s30, 98304
  s_cselect_b32 s30, 0, s30
  v_add_u32 v16, s30, v14
  v_add_u32 v17, s30, v15
  v_mfma_f32_32x32x16_bf16 v[64:79], a[24:27], a[56:59], v[64:79]
  ds_read_b128 a[48:51], v32 offset:32768
  ds_read_b64_tr_b16 a[0:1], v16 offset:0
  ds_read_b64_tr_b16 a[2:3], v16 offset:1536
  s_add_u32 m0, m0, 1024
  s_nop 0
  buffer_load_dwordx4 v13, s[12:15], s27 offen lds
  s_add_u32 s27, s27, s28
  s_add_u32 s29, s29, 24576
  s_cmp_eq_u32 s29, 98304
  s_cselect_b32 s29, 0, s29
  v_mfma_f32_32x32x16_bf16 v[80:95], a[28:31], a[56:59], v[80:95]
  ds_read_b64_tr_b16 a[4:5], v17 offset:64
  ds_read_b64_tr_b16 a[6:7], v17 offset:1600
  ds_read_b64_tr_b16 a[8:9], v16 offset:128
  ds_read_b64_tr_b16 a[10:11], v16 offset:1664
  v_mfma_f32_32x32x16_bf16 v[96:111], a[32:35], a[56:59], v[96:111]
  ds_read_b64_tr_b16 a[12:13], v17 offset:192
  ds_read_b64_tr_b16 a[14:15], v17 offset:1728
  ds_read_b64_tr_b16 a[16:17], v16 offset:256
  ds_read_b64_tr_b16 a[18:19], v16 offset:1792
  v_mfma_f32_32x32x16_bf16 v[112:127], a[36:39], a[56:59], v[112:127]
  ds_read_b64_tr_b16 a[20:21], v17 offset:320
  ds_read_b64_tr_b16 a[22:23], v17 offset:1856
  v_mfma_f32_32x32x16_bf16 v[128:143], a[40:43], a[56:59], v[128:143]
  v_mfma_f32_32x32x16_bf16 v[144:159], a[44:47], a[56:59], v[144:159]
  s_waitcnt lgkmcnt(0)
  v_mfma_f32_32x32x16_bf16 v[64:79], a[0:3], a[48:51], v[64:79]
  ds_read_b128 a[56:59], v33 offset:32768
  ds_read_b64_tr_b16 a[24:25], v16 offset:3072
  ds_read_b64_tr_b16 a[26:27], v16 offset:4608
  s_add_u32 m0, s52, 16384
  s_nop 0
  buffer_load_dwordx4 v24, s[48:51], s26 offen lds
  v_mfma_f32_32x32x16_bf16 v[80:95], a[4:7], a[48:51], v[80:95]
  ds_read_b64_tr_b16 a[28:29], v17 offset:3136
  ds_read_b64_tr_b16 a[30:31], v17 offset:4672
  ds_read_b64_tr_b16 a[32:33], v16 offset:3200
  ds_read_b64_tr_b16 a[34:35], v16 offset:4736
  v_mfma_f32_32x32x16_bf16 v[96:111], a[8:11], a[48:51], v[96:111]
  ds_read_b64_tr_b16 a[36:37], v17 offset:3264
  ds_read_b64_tr_b16 a[38:39], v17 offset:4800
  ds_read_b64_tr_b16 a[40:41], v16 offset:3328
  ds_read_b64_tr_b16 a[42:43], v16 offset:4864
  s_add_u32 m0, s52, 17408
  s_nop 0
  buffer_load_dwordx4 v25, s[48:51], s26 offen lds
  v_mfma_f32_32x32x16_bf16 v[112:127], a[12:15], a[48:51], v[112:127]
  ds_read_b64_tr_b16 a[44:45], v17 offset:3392
  ds_read_b64_tr_b16 a[46:47], v17 offset:4928
  v_mfma_f32_32x32x16_bf16 v[128:143], a[16:19], a[48:51], v[128:143]
  s_add_u32 m0, s52, 18432
  s_nop 0
  buffer_load_dwordx4 v26, s[48:51], s26 offen lds
  v_mfma_f32_32x32x16_bf16 v[144:159], a[20:23], a[48:51], v[144:159]
  s_waitcnt lgkmcnt(0)
  v_mfma_f32_32x32x16_bf16 v[64:79], a[24:27], a[56:59], v[64:79]
  ds_read_b128 a[48:51], v34 offset:32768
  ds_read_b64_tr_b16 a[0:1], v16 offset:6144
  ds_read_b64_tr_b16 a[2:3], v16 offset:7680
  s_add_u32 m0, s52, 19456
  s_nop 0
  buffer_load_dwordx4 v27, s[48:51], s26 offen lds
  s_add_u32 s26, s26, 128
  v_mfma_f32_32x32x16_bf16 v[80:95], a[28:31], a[56:59], v[80:95]
  ds_read_b64_tr_b16 a[4:5], v17 offset:6208
  ds_read_b64_tr_b16 a[6:7], v17 offset:7744
  ds_read_b64_tr_b16 a[8:9], v16 offset:6272
  ds_read_b64_tr_b16 a[10:11], v16 offset:7808
  v_mfma_f32_32x32x16_bf16 v[96:111], a[32:35], a[56:59], v[96:111]
  ds_read_b64_tr_b16 a[12:13], v17 offset:6336
  ds_read_b64_tr_b16 a[14:15], v17 offset:7872
  ds_read_b64_tr_b16 a[16:17], v16 offset:6400
  ds_read_b64_tr_b16 a[18:19], v16 offset:7936
  s_add_u32 m0, s29, s32
  s_nop 0
  buffer_load_dwordx4 v8, s[12:15], s27 offen lds
  v_mfma_f32_32x32x16_bf16 v[112:127], a[36:39], a[56:59], v[112:127]
  ds_read_b64_tr_b16 a[20:21], v17 offset:6464
  ds_read_b64_tr_b16 a[22:23], v17 offset:8000
  v_mfma_f32_32x32x16_bf16 v[128:143], a[40:43], a[56:59], v[128:143]
  s_add_u32 m0, m0, 1024
  s_nop 0
  buffer_load_dwordx4 v9, s[12:15], s27 offen lds
  v_mfma_f32_32x32x16_bf16 v[144:159], a[44:47], a[56:59], v[144:159]
  s_waitcnt lgkmcnt(0)
  v_mfma_f32_32x32x16_bf16 v[64:79], a[0:3], a[48:51], v[64:79]
  ds_read_b128 a[56:59], v35 offset:32768
  ds_read_b64_tr_b16 a[24:25], v16 offset:9216
  ds_read_b64_tr_b16 a[26:27], v16 offset:10752
  s_add_u32 m0, m0, 1024
  s_nop 0
  buffer_load_dwordx4 v10, s[12:15], s27 offen lds
  v_mfma_f32_32x32x16_bf16 v[80:95], a[4:7], a[48:51], v[80:95]
  ds_read_b64_tr_b16 a[28:29], v17 offset:9280
  ds_read_b64_tr_b16 a[30:31], v17 offset:10816
  ds_read_b64_tr_b16 a[32:33], v16 offset:9344
  ds_read_b64_tr_b16 a[34:35], v16 offset:10880
  v_mfma_f32_32x32x16_bf16 v[96:111], a[8:11], a[48:51], v[96:111]
  ds_read_b64_tr_b16 a[36:37], v17 offset:9408
  ds_read_b64_tr_b16 a[38:39], v17 offset:10944
  ds_read_b64_tr_b16 a[40:41], v16 offset:9472
  ds_read_b64_tr_b16 a[42:43], v16 offset:11008
  s_add_u32 m0, m0, 1024
  s_nop 0
  buffer_load_dwordx4 v11, s[12:15], s27 offen lds
  v_mfma_f32_32x32x16_bf16 v[112:127], a[12:15], a[48:51], v[112:127]
  ds_read_b64_tr_b16 a[44:45], v17 offset:9536
  ds_read_b64_tr_b16 a[46:47], v17 offset:11072
  v_mfma_f32_32x32x16_bf16 v[128:143], a[16:19], a[48:51], v[128:143]
  s_add_u32 m0, m0, 1024
  s_nop 0
  buffer_load_dwordx4 v12, s[12:15], s27 offen lds
  v_mfma_f32_32x32x16_bf16 v[144:159], a[20:23], a[48:51], v[144:159]
  s_waitcnt vmcnt(15) lgkmcnt(0)
  s_barrier
  s_add_u32 s30, s30, 24576
  s_cmp_eq_u32 s30, 98304
  s_cselect_b32 s30, 0, s30
  v_add_u32 v16, s30, v14
  v_add_u32 v17, s30, v15
  v_mfma_f32_32x32x16_bf16 v[64:79], a[24:27], a[56:59], v[64:79]
  ds_read_b128 a[48:51], v32 offset:0
  ds_read_b64_tr_b16 a[0:1], v16 offset:0
  ds_read_b64_tr_b16 a[2:3], v16 offset:1536
  s_add_u32 m0, m0, 1024
  s_nop 0
  buffer_load_dwordx4 v13, s[12:15], s27 offen lds
  s_add_u32 s27, s27, s28
  s_add_u32 s29, s29, 24576
  s_cmp_eq_u32 s29, 98304
  s_cselect_b32 s29, 0, s29
  v_mfma_f32_32x32x16_bf16 v[80:95], a[28:31], a[56:59], v[80:95]
  ds_read_b64_tr_b16 a[4:5], v17 offset:64
  ds_read_b64_tr_b16 a[6:7], v17 offset:1600
  ds_read_b64_tr_b16 a[8:9], v16 offset:128
  ds_read_b64_tr_b16 a[10:11], v16 offset:1664
  v_mfma_f32_32x32x16_bf16 v[96:111], a[32:35], a[56:59], v[96:111]
  ds_read_b64_tr_b16 a[12:13], v17 offset:192
  ds_read_b64_tr_b16 a[14:15], v17 offset:1728
  ds_read_b64_tr_b16 a[16:17], v16 offset:256
  ds_read_b64_tr_b16 a[18:19], v16 offset:1792
  v_mfma_f32_32x32x16_bf16 v[112:127], a[36:39], a[56:59], v[112:127]
  ds_read_b64_tr_b16 a[20:21], v17 offset:320
  ds_read_b64_tr_b16 a[22:23], v17 offset:1856
  v_mfma_f32_32x32x16_bf16 v[128:143], a[40:43], a[56:59], v[128:143]
  v_mfma_f32_32x32x16_bf16 v[144:159], a[44:47], a[56:59], v[144:159]
  s_waitcnt lgkmcnt(0)
  v_mfma_f32_32x32x16_bf16 v[64:79], a[0:3], a[48:51], v[64:79]
  ds_read_b128 a[56:59], v33 offset:0
  ds_read_b64_tr_b16 a[24:25], v16 offset:3072
  ds_read_b64_tr_b16 a[26:27], v16 offset:4608
  s_add_u32 m0, s52, 32768
  s_nop 0
  buffer_load_dwordx4 v24, s[48:51], s26 offen lds
  v_mfma_f32_32x32x16_bf16 v[80:95], a[4:7], a[48:51], v[80:95]
  ds_read_b64_tr_b16 a[28:29], v17 offset:3136
  ds_read_b64_tr_b16 a[30:31], v17 offset:4672
  ds_read_b64_tr_b16 a[32:33], v16 offset:3200
  ds_read_b64_tr_b16 a[34:35], v16 offset:4736
  v_mfma_f32_32x32x16_bf16 v[96:111], a[8:11], a[48:51], v[96:111]
  ds_read_b64_tr_b16 a[36:37], v17 offset:3264
  ds_read_b64_tr_b16 a[38:39], v17 offset:4800
  ds_read_b64_tr_b16 a[40:41], v16 offset:3328
  ds_read_b64_tr_b16 a[42:43], v16 offset:4864
  s_add_u32 m0, s52, 33792
  s_nop 0
  buffer_load_dwordx4 v25, s[48:51], s26 offen lds
  v_mfma_f32_32x32x16_bf16 v[112:127], a[12:15], a[48:51], v[112:127]
  ds_read_b64_tr_b16 a[44:45], v17 offset:3392
  ds_read_b64_tr_b16 a[46:47], v17 offset:4928
  v_mfma_f32_32x32x16_bf16 v[128:143], a[16:19], a[48:51], v[128:143]
  s_add_u32 m0, s52, 34816
  s_nop 0
  buffer_load_dwordx4 v26, s[48:51], s26 offen lds
  v_mfma_f32_32x32x16_bf16 v[144:159], a[20:23], a[48:51], v[144:159]
  s_waitcnt lgkmcnt(0)
  v_mfma_f32_32x32x16_bf16 v[64:79], a[24:27], a[56:59], v[64:79]
  ds_read_b128 a[48:51], v34 offset:0
  ds_read_b64_tr_b16 a[0:1], v16 offset:6144
  ds_read_b64_tr_b16 a[2:3], v16 offset:7680
  s_add_u32 m0, s52, 35840
  s_nop 0
  buffer_load_dwordx4 v27, s[48:51], s26 offen lds
  s_add_u32 s26, s26, 128
  v_mfma_f32_32x32x16_bf16 v[80:95], a[28:31], a[56:59], v[80:95]
  ds_read_b64_tr_b16 a[4:5], v17 offset:6208
  ds_read_b64_tr_b16 a[6:7], v17 offset:7744
  ds_read_b64_tr_b16 a[8:9], v16 offset:6272
  ds_read_b64_tr_b16 a[10:11], v16 offset:7808
  v_mfma_f32_32x32x16_bf16 v[96:111], a[32:35], a[56:59], v[96:111]
  ds_read_b64_tr_b16 a[12:13], v17 offset:6336
  ds_read_b64_tr_b16 a[14:15], v17 offset:7872
  ds_read_b64_tr_b16 a[16:17], v16 offset:6400
  ds_read_b64_tr_b16 a[18:19], v16 offset:7936
  s_add_u32 m0, s29, s32
  s_nop 0
  buffer_load_dwordx4 v8, s[12:15], s27 offen lds
  v_mfma_f32_32x32x16_bf16 v[112:127], a[36:39], a[56:59], v[112:127]
  ds_read_b64_tr_b16 a[20:21], v17 offset:6464
  ds_read_b64_tr_b16 a[22:23], v17 offset:8000
  v_mfma_f32_32x32x16_bf16 v[128:143], a[40:43], a[56:59], v[128:143]
  s_add_u32 m0, m0, 1024
  s_nop 0
  buffer_load_dwordx4 v9, s[12:15], s27 offen lds
  v_mfma_f32_32x32x16_bf16 v[144:159], a[44:47], a[56:59], v[144:159]
  s_waitcnt lgkmcnt(0)
  v_mfma_f32_32x32x16_bf16 v[64:79], a[0:3], a[48:51], v[64:79]
  ds_read_b128 a[56:59], v35 offset:0
  ds_read_b64_tr_b16 a[24:25], v16 offset:9216
  ds_read_b64_tr_b16 a[26:27], v16 offset:10752
  s_add_u32 m0, m0, 1024
  s_nop 0
  buffer_load_dwordx4 v10, s[12:15], s27 offen lds
  v_mfma_f32_32x32x16_bf16 v[80:95], a[4:7], a[48:51], v[80:95]
  ds_read_b64_tr_b16 a[28:29], v17 offset:9280
  ds_read_b64_tr_b16 a[30:31], v17 offset:10816
  ds_read_b64_tr_b16 a[32:33], v16 offset:9344
  ds_read_b64_tr_b16 a[34:35], v16 offset:10880
  v_mfma_f32_32x32x16_bf16 v[96:111], a[8:11], a[48:51], v[96:111]
  ds_read_b64_tr_b16 a[36:37], v17 offset:9408
  ds_read_b64_tr_b16 a[38:39], v17 offset:10944
  ds_read_b64_tr_b16 a[40:41], v16 offset:9472
  ds_read_b64_tr_b16 a[42:43], v16 offset:11008
  s_add_u32 m0, m0, 1024
  s_nop 0
  buffer_load_dwordx4 v11, s[12:15], s27 offen lds
  v_mfma_f32_32x32x16_bf16 v[112:127], a[12:15], a[48:51], v[112:127]
  ds_read_b64_tr_b16 a[44:45], v17 offset:9536
  ds_read_b64_tr_b16 a[46:47], v17 offset:11072
  v_mfma_f32_32x32x16_bf16 v[128:143], a[16:19], a[48:51], v[128:143]
  s_add_u32 m0, m0, 1024
  s_nop 0
  buffer_load_dwordx4 v12, s[12:15], s27 offen lds
  v_mfma_f32_32x32x16_bf16 v[144:159], a[20:23], a[48:51], v[144:159]
  s_waitcnt vmcnt(15) lgkmcnt(0)
  s_barrier
  s_add_u32 s30, s30, 24576
  s_cmp_eq_u32 s30, 98304
  s_cselect_b32 s30, 0, s30
  v_add_u32 v16, s30, v14
  v_add_u32 v17, s30, v15
  v_mfma_f32_32x32x16_bf16 v[64:79], a[24:27], a[56:59], v[64:79]
  ds_read_b128 a[48:51], v32 offset:16384
  ds_read_b64_tr_b16 a[0:1], v16 offset:0
  ds_read_b64_tr_b16 a[2:3], v16 offset:1536
  s_add_u32 m0, m0, 1024
  s_nop 0
  buffer_load_dwordx4 v13, s[12:15], s27 offen lds
  s_add_u32 s27, s27, s28
  s_add_u32 s29, s29, 24576
  s_cmp_eq_u32 s29, 98304
  s_cselect_b32 s29, 0, s29
  v_mfma_f32_32x32x16_bf16 v[80:95], a[28:31], a[56:59], v[80:95]
  ds_read_b64_tr_b16 a[4:5], v17 offset:64
  ds_read_b64_tr_b16 a[6:7], v17 offset:1600
  ds_read_b64_tr_b16 a[8:9], v16 offset:128
  ds_read_b64_tr_b16 a[10:11], v16 offset:1664
  v_mfma_f32_32x32x16_bf16 v[96:111], a[32:35], a[56:59], v[96:111]
  ds_read_b64_tr_b16 a[12:13], v17 offset:192
  ds_read_b64_tr_b16 a[14:15], v17 offset:1728
  ds_read_b64_tr_b16 a[16:17], v16 offset:256
  ds_read_b64_tr_b16 a[18:19], v16 offset:1792
  v_mfma_f32_32x32x16_bf16 v[112:127], a[36:39], a[56:59], v[112:127]
  ds_read_b64_tr_b16 a[20:21], v17 offset:320
  ds_read_b64_tr_b16 a[22:23], v17 offset:1856
  v_mfma_f32_32x32x16_bf16 v[128:143], a[40:43], a[56:59], v[128:143]
  v_mfma_f32_32x32x16_bf16 v[144:159], a[44:47], a[56:59], v[144:159]
  s_waitcnt lgkmcnt(0)
  v_mfma_f32_32x32x16_bf16 v[64:79], a[0:3], a[48:51], v[64:79]
  ds_read_b128 a[56:59], v33 offset:16384
  ds_read_b64_tr_b16 a[24:25], v16 offset:3072
  ds_read_b64_tr_b16 a[26:27], v16 offset:4608
  s_add_u32 m0, s52, 0
  s_nop 0
  buffer_load_dwordx4 v24, s[48:51], s26 offen lds
  v_mfma_f32_32x32x16_bf16 v[80:95], a[4:7], a[48:51], v[80:95]
  ds_read_b64_tr_b16 a[28:29], v17 offset:3136
  ds_read_b64_tr_b16 a[30:31], v17 offset:4672
  ds_read_b64_tr_b16 a[32:33], v16 offset:3200
  ds_read_b64_tr_b16 a[34:35], v16 offset:4736
  v_mfma_f32_32x32x16_bf16 v[96:111], a[8:11], a[48:51], v[96:111]
  ds_read_b64_tr_b16 a[36:37], v17 offset:3264
  ds_read_b64_tr_b16 a[38:39], v17 offset:4800
  ds_read_b64_tr_b16 a[40:41], v16 offset:3328
  ds_read_b64_tr_b16 a[42:43], v16 offset:4864
  s_add_u32 m0, s52, 1024
  s_nop 0
  buffer_load_dwordx4 v25, s[48:51], s26 offen lds
  v_mfma_f32_32x32x16_bf16 v[112:127], a[12:15], a[48:51], v[112:127]
  ds_read_b64_tr_b16 a[44:45], v17 offset:3392
  ds_read_b64_tr_b16 a[46:47], v17 offset:4928
  v_mfma_f32_32x32x16_bf16 v[128:143], a[16:19], a[48:51], v[128:143]
  s_add_u32 m0, s52, 2048
  s_nop 0
  buffer_load_dwordx4 v26, s[48:51], s26 offen lds
  v_mfma_f32_32x32x16_bf16 v[144:159], a[20:23], a[48:51], v[144:159]
  s_waitcnt lgkmcnt(0)
  v_mfma_f32_32x32x16_bf16 v[64:79], a[24:27], a[56:59], v[64:79]
  ds_read_b128 a[48:51], v34 offset:16384
  ds_read_b64_tr_b16 a[0:1], v16 offset:6144
  ds_read_b64_tr_b16 a[2:3], v16 offset:7680
  s_add_u32 m0, s52, 3072
  s_nop 0
  buffer_load_dwordx4 v27, s[48:51], s26 offen lds
  s_add_u32 s26, s26, 128
  v_mfma_f32_32x32x16_bf16 v[80:95], a[28:31], a[56:59], v[80:95]
  ds_read_b64_tr_b16 a[4:5], v17 offset:6208
  ds_read_b64_tr_b16 a[6:7], v17 offset:7744
  ds_read_b64_tr_b16 a[8:9], v16 offset:6272
  ds_read_b64_tr_b16 a[10:11], v16 offset:7808
  v_mfma_f32_32x32x16_bf16 v[96:111], a[32:35], a[56:59], v[96:111]
  ds_read_b64_tr_b16 a[12:13], v17 offset:6336
  ds_read_b64_tr_b16 a[14:15], v17 offset:7872
  ds_read_b64_tr_b16 a[16:17], v16 offset:6400
  ds_read_b64_tr_b16 a[18:19], v16 offset:7936
  s_add_u32 m0, s29, s32
  s_nop 0
  buffer_load_dwordx4 v8, s[12:15], s27 offen lds
  v_mfma_f32_32x32x16_bf16 v[112:127], a[36:39], a[56:59], v[112:127]
  ds_read_b64_tr_b16 a[20:21], v17 offset:6464
  ds_read_b64_tr_b16 a[22:23], v17 offset:8000
  v_mfma_f32_32x32x16_bf16 v[128:143], a[40:43], a[56:59], v[128:143]
  s_add_u32 m0, m0, 1024
  s_nop 0
  buffer_load_dwordx4 v9, s[12:15], s27 offen lds
  v_mfma_f32_32x32x16_bf16 v[144:159], a[44:47], a[56:59], v[144:159]
  s_waitcnt lgkmcnt(0)
  v_mfma_f32_32x32x16_bf16 v[64:79], a[0:3], a[48:51], v[64:79]
  ds_read_b128 a[56:59], v35 offset:16384
  ds_read_b64_tr_b16 a[24:25], v16 offset:9216
  ds_read_b64_tr_b16 a[26:27], v16 offset:10752
  s_add_u32 m0, m0, 1024
  s_nop 0
  buffer_load_dwordx4 v10, s[12:15], s27 offen lds
  v_mfma_f32_32x32x16_bf16 v[80:95], a[4:7], a[48:51], v[80:95]
  ds_read_b64_tr_b16 a[28:29], v17 offset:9280
  ds_read_b64_tr_b16 a[30:31], v17 offset:10816
  ds_read_b64_tr_b16 a[32:33], v16 offset:9344
  ds_read_b64_tr_b16 a[34:35], v16 offset:10880
  v_mfma_f32_32x32x16_bf16 v[96:111], a[8:11], a[48:51], v[96:111]
  ds_read_b64_tr_b16 a[36:37], v17 offset:9408
  ds_read_b64_tr_b16 a[38:39], v17 offset:10944
  ds_read_b64_tr_b16 a[40:41], v16 offset:9472
  ds_read_b64_tr_b16 a[42:43], v16 offset:11008
  s_add_u32 m0, m0, 1024
  s_nop 0
  buffer_load_dwordx4 v11, s[12:15], s27 offen lds
  v_mfma_f32_32x32x16_bf16 v[112:127], a[12:15], a[48:51], v[112:127]
  ds_read_b64_tr_b16 a[44:45], v17 offset:9536
  ds_read_b64_tr_b16 a[46:47], v17 offset:11072
  v_mfma_f32_32x32x16_bf16 v[128:143], a[16:19], a[48:51], v[128:143]
  s_add_u32 m0, m0, 1024
  s_nop 0
  buffer_load_dwordx4 v12, s[12:15], s27 offen lds
  v_mfma_f32_32x32x16_bf16 v[144:159], a[20:23], a[48:51], v[144:159]
  s_waitcnt vmcnt(15) lgkmcnt(0)
  s_barrier
  s_add_u32 s30, s30, 24576
  s_cmp_eq_u32 s30, 98304
  s_cselect_b32 s30, 0, s30
  v_add_u32 v16, s30, v14
  v_add_u32 v17, s30, v15
  v_mfma_f32_32x32x16_bf16 v[64:79], a[24:27], a[56:59], v[64:79]
  ds_read_b128 a[48:51], v32 offset:32768
  ds_read_b64_tr_b16 a[0:1], v16 offset:0
  ds_read_b64_tr_b16 a[2:3], v16 offset:1536
  s_add_u32 m0, m0, 1024
  s_nop 0
  buffer_load_dwordx4 v13, s[12:15], s27 offen lds
  s_add_u32 s27, s27, s28
  s_add_u32 s29, s29, 24576
  s_cmp_eq_u32 s29, 98304
  s_cselect_b32 s29, 0, s29
  v_mfma_f32_32x32x16_bf16 v[80:95], a[28:31], a[56:59], v[80:95]
  ds_read_b64_tr_b16 a[4:5], v17 offset:64
  ds_read_b64_tr_b16 a[6:7], v17 offset:1600
  ds_read_b64_tr_b16 a[8:9], v16 offset:128
  ds_read_b64_tr_b16 a[10:11], v16 offset:1664
  v_mfma_f32_32x32x16_bf16 v[96:111], a[32:35], a[56:59], v[96:111]
  ds_read_b64_tr_b16 a[12:13], v17 offset:192
  ds_read_b64_tr_b16 a[14:15], v17 offset:1728
  ds_read_b64_tr_b16 a[16:17], v16 offset:256
  ds_read_b64_tr_b16 a[18:19], v16 offset:1792
  v_mfma_f32_32x32x16_bf16 v[112:127], a[36:39], a[56:59], v[112:127]
  ds_read_b64_tr_b16 a[20:21], v17 offset:320
  ds_read_b64_tr_b16 a[22:23], v17 offset:1856
  v_mfma_f32_32x32x16_bf16 v[128:143], a[40:43], a[56:59], v[128:143]
  v_mfma_f32_32x32x16_bf16 v[144:159], a[44:47], a[56:59], v[144:159]
  s_waitcnt lgkmcnt(0)
  v_mfma_f32_32x32x16_bf16 v[64:79], a[0:3], a[48:51], v[64:79]
  ds_read_b128 a[56:59], v33 offset:32768
  ds_read_b64_tr_b16 a[24:25], v16 offset:3072
  ds_read_b64_tr_b16 a[26:27], v16 offset:4608
  s_add_u32 m0, s52, 16384
  s_nop 0
  buffer_load_dwordx4 v24, s[48:51], s26 offen lds
  v_mfma_f32_32x32x16_bf16 v[80:95], a[4:7], a[48:51], v[80:95]
  ds_read_b64_tr_b16 a[28:29], v17 offset:3136
  ds_read_b64_tr_b16 a[30:31], v17 offset:4672
  ds_read_b64_tr_b16 a[32:33], v16 offset:3200
  ds_read_b64_tr_b16 a[34:35], v16 offset:4736
  v_mfma_f32_32x32x16_bf16 v[96:111], a[8:11], a[48:51], v[96:111]
  ds_read_b64_tr_b16 a[36:37], v17 offset:3264
  ds_read_b64_tr_b16 a[38:39], v17 offset:4800
  ds_read_b64_tr_b16 a[40:41], v16 offset:3328
  ds_read_b64_tr_b16 a[42:43], v16 offset:4864
  s_add_u32 m0, s52, 17408
  s_nop 0
  buffer_load_dwordx4 v25, s[48:51], s26 offen lds
  v_mfma_f32_32x32x16_bf16 v[112:127], a[12:15], a[48:51], v[112:127]
  ds_read_b64_tr_b16 a[44:45], v17 offset:3392
  ds_read_b64_tr_b16 a[46:47], v17 offset:4928
  v_mfma_f32_32x32x16_bf16 v[128:143], a[16:19], a[48:51], v[128:143]
  s_add_u32 m0, s52, 18432
  s_nop 0
  buffer_load_dwordx4 v26, s[48:51], s26 offen lds
  v_mfma_f32_32x32x16_bf16 v[144:159], a[20:23], a[48:51], v[144:159]
  s_waitcnt lgkmcnt(0)
  v_mfma_f32_32x32x16_bf16 v[64:79], a[24:27], a[56:59], v[64:79]
  ds_read_b128 a[48:51], v34 offset:32768
  ds_read_b64_tr_b16 a[0:1], v16 offset:6144
  ds_read_b64_tr_b16 a[2:3], v16 offset:7680
  s_add_u32 m0, s52, 19456
  s_nop 0
  buffer_load_dwordx4 v27, s[48:51], s26 offen lds
  s_add_u32 s26, s26, 128
  v_mfma_f32_32x32x16_bf16 v[80:95], a[28:31], a[56:59], v[80:95]
  ds_read_b64_tr_b16 a[4:5], v17 offset:6208
  ds_read_b64_tr_b16 a[6:7], v17 offset:7744
  ds_read_b64_tr_b16 a[8:9], v16 offset:6272
  ds_read_b64_tr_b16 a[10:11], v16 offset:7808
  v_mfma_f32_32x32x16_bf16 v[96:111], a[32:35], a[56:59], v[96:111]
  ds_read_b64_tr_b16 a[12:13], v17 offset:6336
  ds_read_b64_tr_b16 a[14:15], v17 offset:7872
  ds_read_b64_tr_b16 a[16:17], v16 offset:6400
  ds_read_b64_tr_b16 a[18:19], v16 offset:7936
  s_add_u32 m0, s29, s32
  s_nop 0
  buffer_load_dwordx4 v8, s[12:15], s27 offen lds
  v_mfma_f32_32x32x16_bf16 v[112:127], a[36:39], a[56:59], v[112:127]
  ds_read_b64_tr_b16 a[20:21], v17 offset:6464
  ds_read_b64_tr_b16 a[22:23], v17 offset:8000
  v_mfma_f32_32x32x16_bf16 v[128:143], a[40:43], a[56:59], v[128:143]
  s_add_u32 m0, m0, 1024
  s_nop 0
  buffer_load_dwordx4 v9, s[12:15], s27 offen lds
  v_mfma_f32_32x32x16_bf16 v[144:159], a[44:47], a[56:59], v[144:159]
  s_waitcnt lgkmcnt(0)
  v_mfma_f32_32x32x16_bf16 v[64:79], a[0:3], a[48:51], v[64:79]
  ds_read_b128 a[56:59], v35 offset:32768
  ds_read_b64_tr_b16 a[24:25], v16 offset:9216
  ds_read_b64_tr_b16 a[26:27], v16 offset:10752
  s_add_u32 m0, m0, 1024
  s_nop 0
  buffer_load_dwordx4 v10, s[12:15], s27 offen lds
  v_mfma_f32_32x32x16_bf16 v[80:95], a[4:7], a[48:51], v[80:95]
  ds_read_b64_tr_b16 a[28:29], v17 offset:9280
  ds_read_b64_tr_b16 a[30:31], v17 offset:10816
  ds_read_b64_tr_b16 a[32:33], v16 offset:9344
  ds_read_b64_tr_b16 a[34:35], v16 offset:10880
  v_mfma_f32_32x32x16_bf16 v[96:111], a[8:11], a[48:51], v[96:111]
  ds_read_b64_tr_b16 a[36:37], v17 offset:9408
  ds_read_b64_tr_b16 a[38:39], v17 offset:10944
  ds_read_b64_tr_b16 a[40:41], v16 offset:9472
  ds_read_b64_tr_b16 a[42:43], v16 offset:11008
  s_add_u32 m0, m0, 1024
  s_nop 0
  buffer_load_dwordx4 v11, s[12:15], s27 offen lds
  v_mfma_f32_32x32x16_bf16 v[112:127], a[12:15], a[48:51], v[112:127]
  ds_read_b64_tr_b16 a[44:45], v17 offset:9536
  ds_read_b64_tr_b16 a[46:47], v17 offset:11072
  v_mfma_f32_32x32x16_bf16 v[128:143], a[16:19], a[48:51], v[128:143]
  s_add_u32 m0, m0, 1024
  s_nop 0
  buffer_load_dwordx4 v12, s[12:15], s27 offen lds
  v_mfma_f32_32x32x16_bf16 v[144:159], a[20:23], a[48:51], v[144:159]
  s_waitcnt vmcnt(15) lgkmcnt(0)
  s_barrier
  s_add_u32 s30, s30, 24576
  s_cmp_eq_u32 s30, 98304
  s_cselect_b32 s30, 0, s30
  v_add_u32 v16, s30, v14
  v_add_u32 v17, s30, v15
  v_mfma_f32_32x32x16_bf16 v[64:79], a[24:27], a[56:59], v[64:79]
  ds_read_b128 a[48:51], v32 offset:0
  ds_read_b64_tr_b16 a[0:1], v16 offset:0
  ds_read_b64_tr_b16 a[2:3], v16 offset:1536
  s_add_u32 m0, m0, 1024
  s_nop 0
  buffer_load_dwordx4 v13, s[12:15], s27 offen lds
  s_add_u32 s27, s27, s28
  s_add_u32 s29, s29, 24576
  s_cmp_eq_u32 s29, 98304
  s_cselect_b32 s29, 0, s29
  v_mfma_f32_32x32x16_bf16 v[80:95], a[28:31], a[56:59], v[80:95]
  ds_read_b64_tr_b16 a[4:5], v17 offset:64
  ds_read_b64_tr_b16 a[6:7], v17 offset:1600
  ds_read_b64_tr_b16 a[8:9], v16 offset:128
  ds_read_b64_tr_b16 a[10:11], v16 offset:1664
  v_mfma_f32_32x32x16_bf16 v[96:111], a[32:35], a[56:59], v[96:111]
  ds_read_b64_tr_b16 a[12:13], v17 offset:192
  ds_read_b64_tr_b16 a[14:15], v17 offset:1728
  ds_read_b64_tr_b16 a[16:17], v16 offset:256
  ds_read_b64_tr_b16 a[18:19], v16 offset:1792
  v_mfma_f32_32x32x16_bf16 v[112:127], a[36:39], a[56:59], v[112:127]
  ds_read_b64_tr_b16 a[20:21], v17 offset:320
  ds_read_b64_tr_b16 a[22:23], v17 offset:1856
  v_mfma_f32_32x32x16_bf16 v[128:143], a[40:43], a[56:59], v[128:143]
  v_mfma_f32_32x32x16_bf16 v[144:159], a[44:47], a[56:59], v[144:159]
  s_waitcnt lgkmcnt(0)
  v_mfma_f32_32x32x16_bf16 v[64:79], a[0:3], a[48:51], v[64:79]
  ds_read_b128 a[56:59], v33 offset:0
  ds_read_b64_tr_b16 a[24:25], v16 offset:3072
  ds_read_b64_tr_b16 a[26:27], v16 offset:4608
  s_add_u32 m0, s52, 32768
  s_nop 0
  buffer_load_dwordx4 v24, s[48:51], s26 offen lds
  v_mfma_f32_32x32x16_bf16 v[80:95], a[4:7], a[48:51], v[80:95]
  ds_read_b64_tr_b16 a[28:29], v17 offset:3136
  ds_read_b64_tr_b16 a[30:31], v17 offset:4672
  ds_read_b64_tr_b16 a[32:33], v16 offset:3200
  ds_read_b64_tr_b16 a[34:35], v16 offset:4736
  v_mfma_f32_32x32x16_bf16 v[96:111], a[8:11], a[48:51], v[96:111]
  ds_read_b64_tr_b16 a[36:37], v17 offset:3264
  ds_read_b64_tr_b16 a[38:39], v17 offset:4800
  ds_read_b64_tr_b16 a[40:41], v16 offset:3328
  ds_read_b64_tr_b16 a[42:43], v16 offset:4864
  s_add_u32 m0, s52, 33792
  s_nop 0
  buffer_load_dwordx4 v25, s[48:51], s26 offen lds
  v_mfma_f32_32x32x16_bf16 v[112:127], a[12:15], a[48:51], v[112:127]
  ds_read_b64_tr_b16 a[44:45], v17 offset:3392
  ds_read_b64_tr_b16 a[46:47], v17 offset:4928
  v_mfma_f32_32x32x16_bf16 v[128:143], a[16:19], a[48:51], v[128:143]
  s_add_u32 m0, s52, 34816
  s_nop 0
  buffer_load_dwordx4 v26, s[48:51], s26 offen lds
  v_mfma_f32_32x32x16_bf16 v[144:159], a[20:23], a[48:51], v[144:159]
  s_waitcnt lgkmcnt(0)
  v_mfma_f32_32x32x16_bf16 v[64:79], a[24:27], a[56:59], v[64:79]
  ds_read_b128 a[48:51], v34 offset:0
  ds_read_b64_tr_b16 a[0:1], v16 offset:6144
  ds_read_b64_tr_b16 a[2:3], v16 offset:7680
  s_add_u32 m0, s52, 35840
  s_nop 0
  buffer_load_dwordx4 v27, s[48:51], s26 offen lds
  s_add_u32 s26, s26, 128
  v_mfma_f32_32x32x16_bf16 v[80:95], a[28:31], a[56:59], v[80:95]
  ds_read_b64_tr_b16 a[4:5], v17 offset:6208
  ds_read_b64_tr_b16 a[6:7], v17 offset:7744
  ds_read_b64_tr_b16 a[8:9], v16 offset:6272
  ds_read_b64_tr_b16 a[10:11], v16 offset:7808
  v_mfma_f32_32x32x16_bf16 v[96:111], a[32:35], a[56:59], v[96:111]
  ds_read_b64_tr_b16 a[12:13], v17 offset:6336
  ds_read_b64_tr_b16 a[14:15], v17 offset:7872
  ds_read_b64_tr_b16 a[16:17], v16 offset:6400
  ds_read_b64_tr_b16 a[18:19], v16 offset:7936
  s_add_u32 m0, s29, s32
  s_nop 0
  buffer_load_dwordx4 v8, s[12:15], s27 offen lds
  v_mfma_f32_32x32x16_bf16 v[112:127], a[36:39], a[56:59], v[112:127]
  ds_read_b64_tr_b16 a[20:21], v17 offset:6464
  ds_read_b64_tr_b16 a[22:23], v17 offset:8000
  v_mfma_f32_32x32x16_bf16 v[128:143], a[40:43], a[56:59], v[128:143]
  s_add_u32 m0, m0, 1024
  s_nop 0
  buffer_load_dwordx4 v9, s[12:15], s27 offen lds
  v_mfma_f32_32x32x16_bf16 v[144:159], a[44:47], a[56:59], v[144:159]
  s_waitcnt lgkmcnt(0)
  v_mfma_f32_32x32x16_bf16 v[64:79], a[0:3], a[48:51], v[64:79]
  ds_read_b128 a[56:59], v35 offset:0
  ds_read_b64_tr_b16 a[24:25], v16 offset:9216
  ds_read_b64_tr_b16 a[26:27], v16 offset:10752
  s_add_u32 m0, m0, 1024
  s_nop 0
  buffer_load_dwordx4 v10, s[12:15], s27 offen lds
  v_mfma_f32_32x32x16_bf16 v[80:95], a[4:7], a[48:51], v[80:95]
  ds_read_b64_tr_b16 a[28:29], v17 offset:9280
  ds_read_b64_tr_b16 a[30:31], v17 offset:10816
  ds_read_b64_tr_b16 a[32:33], v16 offset:9344
  ds_read_b64_tr_b16 a[34:35], v16 offset:10880
  v_mfma_f32_32x32x16_bf16 v[96:111], a[8:11], a[48:51], v[96:111]
  ds_read_b64_tr_b16 a[36:37], v17 offset:9408
  ds_read_b64_tr_b16 a[38:39], v17 offset:10944
  ds_read_b64_tr_b16 a[40:41], v16 offset:9472
  ds_read_b64_tr_b16 a[42:43], v16 offset:11008
  s_add_u32 m0, m0, 1024
  s_nop 0
  buffer_load_dwordx4 v11, s[12:15], s27 offen lds
  v_mfma_f32_32x32x16_bf16 v[112:127], a[12:15], a[48:51], v[112:127]
  ds_read_b64_tr_b16 a[44:45], v17 offset:9536
  ds_read_b64_tr_b16 a[46:47], v17 offset:11072
  v_mfma_f32_32x32x16_bf16 v[128:143], a[16:19], a[48:51], v[128:143]
  s_add_u32 m0, m0, 1024
  s_nop 0
  buffer_load_dwordx4 v12, s[12:15], s27 offen lds
  v_mfma_f32_32x32x16_bf16 v[144:159], a[20:23], a[48:51], v[144:159]
  s_waitcnt vmcnt(15) lgkmcnt(0)
  s_barrier
  s_add_u32 s30, s30, 24576
  s_cmp_eq_u32 s30, 98304
  s_cselect_b32 s30, 0, s30
  v_add_u32 v16, s30, v14
  v_add_u32 v17, s30, v15
  v_mfma_f32_32x32x16_bf16 v[64:79], a[24:27], a[56:59], v[64:79]
  ds_read_b128 a[48:51], v32 offset:16384
  ds_read_b64_tr_b16 a[0:1], v16 offset:0
  ds_read_b64_tr_b16 a[2:3], v16 offset:1536
  s_add_u32 m0, m0, 1024
  s_nop 0
  buffer_load_dwordx4 v13, s[12:15], s27 offen lds
  s_add_u32 s27, s27, s28
  s_add_u32 s29, s29, 24576
  s_cmp_eq_u32 s29, 98304
  s_cselect_b32 s29, 0, s29
  v_mfma_f32_32x32x16_bf16 v[80:95], a[28:31], a[56:59], v[80:95]
  ds_read_b64_tr_b16 a[4:5], v17 offset:64
  ds_read_b64_tr_b16 a[6:7], v17 offset:1600
  ds_read_b64_tr_b16 a[8:9], v16 offset:128
  ds_read_b64_tr_b16 a[10:11], v16 offset:1664
  v_mfma_f32_32x32x16_bf16 v[96:111], a[32:35], a[56:59], v[96:111]
  ds_read_b64_tr_b16 a[12:13], v17 offset:192
  ds_read_b64_tr_b16 a[14:15], v17 offset:1728
  ds_read_b64_tr_b16 a[16:17], v16 offset:256
  ds_read_b64_tr_b16 a[18:19], v16 offset:1792
  v_mfma_f32_32x32x16_bf16 v[112:127], a[36:39], a[56:59], v[112:127]
  ds_read_b64_tr_b16 a[20:21], v17 offset:320
  ds_read_b64_tr_b16 a[22:23], v17 offset:1856
  v_mfma_f32_32x32x16_bf16 v[128:143], a[40:43], a[56:59], v[128:143]
  v_mfma_f32_32x32x16_bf16 v[144:159], a[44:47], a[56:59], v[144:159]
  s_waitcnt lgkmcnt(0)
  v_mfma_f32_32x32x16_bf16 v[64:79], a[0:3], a[48:51], v[64:79]
  ds_read_b128 a[56:59], v33 offset:16384
  ds_read_b64_tr_b16 a[24:25], v16 offset:3072
  ds_read_b64_tr_b16 a[26:27], v16 offset:4608
  s_add_u32 m0, s52, 0
  s_nop 0
  buffer_load_dwordx4 v24, s[48:51], s26 offen lds
  v_mfma_f32_32x32x16_bf16 v[80:95], a[4:7], a[48:51], v[80:95]
  ds_read_b64_tr_b16 a[28:29], v17 offset:3136
  ds_read_b64_tr_b16 a[30:31], v17 offset:4672
  ds_read_b64_tr_b16 a[32:33], v16 offset:3200
  ds_read_b64_tr_b16 a[34:35], v16 offset:4736
  v_mfma_f32_32x32x16_bf16 v[96:111], a[8:11], a[48:51], v[96:111]
  ds_read_b64_tr_b16 a[36:37], v17 offset:3264
  ds_read_b64_tr_b16 a[38:39], v17 offset:4800
  ds_read_b64_tr_b16 a[40:41], v16 offset:3328
  ds_read_b64_tr_b16 a[42:43], v16 offset:4864
  s_add_u32 m0, s52, 1024
  s_nop 0
  buffer_load_dwordx4 v25, s[48:51], s26 offen lds
  v_mfma_f32_32x32x16_bf16 v[112:127], a[12:15], a[48:51], v[112:127]
  ds_read_b64_tr_b16 a[44:45], v17 offset:3392
  ds_read_b64_tr_b16 a[46:47], v17 offset:4928
  v_mfma_f32_32x32x16_bf16 v[128:143], a[16:19], a[48:51], v[128:143]
  s_add_u32 m0, s52, 2048
  s_nop 0
  buffer_load_dwordx4 v26, s[48:51], s26 offen lds
  v_mfma_f32_32x32x16_bf16 v[144:159], a[20:23], a[48:51], v[144:159]
  s_waitcnt lgkmcnt(0)
  v_mfma_f32_32x32x16_bf16 v[64:79], a[24:27], a[56:59], v[64:79]
  ds_read_b128 a[48:51], v34 offset:16384
  ds_read_b64_tr_b16 a[0:1], v16 offset:6144
  ds_read_b64_tr_b16 a[2:3], v16 offset:7680
  s_add_u32 m0, s52, 3072
  s_nop 0
  buffer_load_dwordx4 v27, s[48:51], s26 offen lds
  s_add_u32 s26, s26, 128
  v_mfma_f32_32x32x16_bf16 v[80:95], a[28:31], a[56:59], v[80:95]
  ds_read_b64_tr_b16 a[4:5], v17 offset:6208
  ds_read_b64_tr_b16 a[6:7], v17 offset:7744
  ds_read_b64_tr_b16 a[8:9], v16 offset:6272
  ds_read_b64_tr_b16 a[10:11], v16 offset:7808
  v_mfma_f32_32x32x16_bf16 v[96:111], a[32:35], a[56:59], v[96:111]
  ds_read_b64_tr_b16 a[12:13], v17 offset:6336
  ds_read_b64_tr_b16 a[14:15], v17 offset:7872
  ds_read_b64_tr_b16 a[16:17], v16 offset:6400
  ds_read_b64_tr_b16 a[18:19], v16 offset:7936
  s_add_u32 m0, s29, s34
  s_nop 0
  buffer_load_dwordx4 v18, s[16:19], s37 offen lds
  v_mfma_f32_32x32x16_bf16 v[112:127], a[36:39], a[56:59], v[112:127]
  ds_read_b64_tr_b16 a[20:21], v17 offset:6464
  ds_read_b64_tr_b16 a[22:23], v17 offset:8000
  v_mfma_f32_32x32x16_bf16 v[128:143], a[40:43], a[56:59], v[128:143]
  v_mfma_f32_32x32x16_bf16 v[144:159], a[44:47], a[56:59], v[144:159]
  s_add_u32 m0, m0, 1024
  s_nop 0
  buffer_load_dwordx4 v19, s[16:19], s37 offen lds
  s_waitcnt lgkmcnt(0)
  v_mfma_f32_32x32x16_bf16 v[64:79], a[0:3], a[48:51], v[64:79]
  ds_read_b128 a[56:59], v35 offset:16384
  ds_read_b64_tr_b16 a[24:25], v16 offset:9216
  ds_read_b64_tr_b16 a[26:27], v16 offset:10752
  v_mfma_f32_32x32x16_bf16 v[80:95], a[4:7], a[48:51], v[80:95]
  ds_read_b64_tr_b16 a[28:29], v17 offset:9280
  ds_read_b64_tr_b16 a[30:31], v17 offset:10816
  ds_read_b64_tr_b16 a[32:33], v16 offset:9344
  ds_read_b64_tr_b16 a[34:35], v16 offset:10880
  v_mfma_f32_32x32x16_bf16 v[96:111], a[8:11], a[48:51], v[96:111]
  ds_read_b64_tr_b16 a[36:37], v17 offset:9408
  ds_read_b64_tr_b16 a[38:39], v17 offset:10944
  ds_read_b64_tr_b16 a[40:41], v16 offset:9472
  ds_read_b64_tr_b16 a[42:43], v16 offset:11008
  s_add_u32 m0, m0, 1024
  s_nop 0
  buffer_load_dwordx4 v20, s[16:19], s37 offen lds
  v_mfma_f32_32x32x16_bf16 v[112:127], a[12:15], a[48:51], v[112:127]
  ds_read_b64_tr_b16 a[44:45], v17 offset:9536
  ds_read_b64_tr_b16 a[46:47], v17 offset:11072
  v_mfma_f32_32x32x16_bf16 v[128:143], a[16:19], a[48:51], v[128:143]
  v_mfma_f32_32x32x16_bf16 v[144:159], a[20:23], a[48:51], v[144:159]
  s_add_u32 m0, m0, 1024
  s_nop 0
  buffer_load_dwordx4 v21, s[16:19], s37 offen lds
  s_waitcnt vmcnt(14) lgkmcnt(0)
  s_barrier
  s_add_u32 s30, s30, 24576
  s_cmp_eq_u32 s30, 98304
  s_cselect_b32 s30, 0, s30
  v_add_u32 v16, s30, v14
  v_add_u32 v17, s30, v15
  v_mfma_f32_32x32x16_bf16 v[64:79], a[24:27], a[56:59], v[64:79]
  ds_read_b128 a[48:51], v32 offset:32768
  ds_read_b64_tr_b16 a[0:1], v16 offset:0
  ds_read_b64_tr_b16 a[2:3], v16 offset:1536
  v_mfma_f32_32x32x16_bf16 v[80:95], a[28:31], a[56:59], v[80:95]
  ds_read_b64_tr_b16 a[4:5], v17 offset:64
  ds_read_b64_tr_b16 a[6:7], v17 offset:1600
  ds_read_b64_tr_b16 a[8:9], v16 offset:128
  ds_read_b64_tr_b16 a[10:11], v16 offset:1664
  v_mfma_f32_32x32x16_bf16 v[96:111], a[32:35], a[56:59], v[96:111]
  ds_read_b64_tr_b16 a[12:13], v17 offset:192
  ds_read_b64_tr_b16 a[14:15], v17 offset:1728
  ds_read_b64_tr_b16 a[16:17], v16 offset:256
  ds_read_b64_tr_b16 a[18:19], v16 offset:1792
  s_add_u32 m0, m0, 1024
  s_nop 0
  buffer_load_dwordx4 v22, s[16:19], s37 offen lds
  s_add_u32 s37, s37, 81920
  s_add_u32 s29, s29, 24576
  s_cmp_eq_u32 s29, 98304
  s_cselect_b32 s29, 0, s29
  s_add_u32 s40, s40, 1
  s_cmp_eq_u32 s40, 3
  s_cselect_b32 s40, 0, s40
  s_cselect_b32 s42, 4294721856, 0
  s_add_u32 s37, s37, s42
  v_mfma_f32_32x32x16_bf16 v[112:127], a[36:39], a[56:59], v[112:127]
  ds_read_b64_tr_b16 a[20:21], v17 offset:320
  ds_read_b64_tr_b16 a[22:23], v17 offset:1856
  v_mfma_f32_32x32x16_bf16 v[128:143], a[40:43], a[56:59], v[128:143]
  v_mfma_f32_32x32x16_bf16 v[144:159], a[44:47], a[56:59], v[144:159]
  s_waitcnt lgkmcnt(0)
  v_mfma_f32_32x32x16_bf16 v[64:79], a[0:3], a[48:51], v[64:79]
  ds_read_b128 a[56:59], v33 offset:32768
  ds_read_b64_tr_b16 a[24:25], v16 offset:3072
  ds_read_b64_tr_b16 a[26:27], v16 offset:4608
  s_add_u32 m0, s29, s34
  s_nop 0
  buffer_load_dwordx4 v18, s[16:19], s37 offen lds
  v_mfma_f32_32x32x16_bf16 v[80:95], a[4:7], a[48:51], v[80:95]
  ds_read_b64_tr_b16 a[28:29], v17 offset:3136
  ds_read_b64_tr_b16 a[30:31], v17 offset:4672
  ds_read_b64_tr_b16 a[32:33], v16 offset:3200
  ds_read_b64_tr_b16 a[34:35], v16 offset:4736
  v_mfma_f32_32x32x16_bf16 v[96:111], a[8:11], a[48:51], v[96:111]
  ds_read_b64_tr_b16 a[36:37], v17 offset:3264
  ds_read_b64_tr_b16 a[38:39], v17 offset:4800
  ds_read_b64_tr_b16 a[40:41], v16 offset:3328
  ds_read_b64_tr_b16 a[42:43], v16 offset:4864
  v_mfma_f32_32x32x16_bf16 v[112:127], a[12:15], a[48:51], v[112:127]
  ds_read_b64_tr_b16 a[44:45], v17 offset:3392
  ds_read_b64_tr_b16 a[46:47], v17 offset:4928
  v_mfma_f32_32x32x16_bf16 v[128:143], a[16:19], a[48:51], v[128:143]
  s_add_u32 m0, m0, 1024
  s_nop 0
  buffer_load_dwordx4 v19, s[16:19], s37 offen lds
  v_mfma_f32_32x32x16_bf16 v[144:159], a[20:23], a[48:51], v[144:159]
  s_waitcnt lgkmcnt(0)
  v_mfma_f32_32x32x16_bf16 v[64:79], a[24:27], a[56:59], v[64:79]
  ds_read_b128 a[48:51], v34 offset:32768
  ds_read_b64_tr_b16 a[0:1], v16 offset:6144
  ds_read_b64_tr_b16 a[2:3], v16 offset:7680
  v_mfma_f32_32x32x16_bf16 v[80:95], a[28:31], a[56:59], v[80:95]
  ds_read_b64_tr_b16 a[4:5], v17 offset:6208
  ds_read_b64_tr_b16 a[6:7], v17 offset:7744
  ds_read_b64_tr_b16 a[8:9], v16 offset:6272
  ds_read_b64_tr_b16 a[10:11], v16 offset:7808
  v_mfma_f32_32x32x16_bf16 v[96:111], a[32:35], a[56:59], v[96:111]
  ds_read_b64_tr_b16 a[12:13], v17 offset:6336
  ds_read_b64_tr_b16 a[14:15], v17 offset:7872
  ds_read_b64_tr_b16 a[16:17], v16 offset:6400
  ds_read_b64_tr_b16 a[18:19], v16 offset:7936
  s_add_u32 m0, m0, 1024
  s_nop 0
  buffer_load_dwordx4 v20, s[16:19], s37 offen lds
  v_mfma_f32_32x32x16_bf16 v[112:127], a[36:39], a[56:59], v[112:127]
  ds_read_b64_tr_b16 a[20:21], v17 offset:6464
  ds_read_b64_tr_b16 a[22:23], v17 offset:8000
  v_mfma_f32_32x32x16_bf16 v[128:143], a[40:43], a[56:59], v[128:143]
  v_mfma_f32_32x32x16_bf16 v[144:159], a[44:47], a[56:59], v[144:159]
  s_waitcnt lgkmcnt(0)
  v_mfma_f32_32x32x16_bf16 v[64:79], a[0:3], a[48:51], v[64:79]
  ds_read_b128 a[56:59], v35 offset:32768
  ds_read_b64_tr_b16 a[24:25], v16 offset:9216
  ds_read_b64_tr_b16 a[26:27], v16 offset:10752
  s_add_u32 m0, m0, 1024
  s_nop 0
  buffer_load_dwordx4 v21, s[16:19], s37 offen lds
  v_mfma_f32_32x32x16_bf16 v[80:95], a[4:7], a[48:51], v[80:95]
  ds_read_b64_tr_b16 a[28:29], v17 offset:9280
  ds_read_b64_tr_b16 a[30:31], v17 offset:10816
  ds_read_b64_tr_b16 a[32:33], v16 offset:9344
  ds_read_b64_tr_b16 a[34:35], v16 offset:10880
  v_mfma_f32_32x32x16_bf16 v[96:111], a[8:11], a[48:51], v[96:111]
  ds_read_b64_tr_b16 a[36:37], v17 offset:9408
  ds_read_b64_tr_b16 a[38:39], v17 offset:10944
  ds_read_b64_tr_b16 a[40:41], v16 offset:9472
  ds_read_b64_tr_b16 a[42:43], v16 offset:11008
  v_mfma_f32_32x32x16_bf16 v[112:127], a[12:15], a[48:51], v[112:127]
  ds_read_b64_tr_b16 a[44:45], v17 offset:9536
  ds_read_b64_tr_b16 a[46:47], v17 offset:11072
  v_mfma_f32_32x32x16_bf16 v[128:143], a[16:19], a[48:51], v[128:143]
  s_add_u32 m0, m0, 1024
  s_nop 0
  buffer_load_dwordx4 v22, s[16:19], s37 offen lds
  s_add_u32 s37, s37, 81920
  s_add_u32 s29, s29, 24576
  s_cmp_eq_u32 s29, 98304
  s_cselect_b32 s29, 0, s29
  s_add_u32 s40, s40, 1
  s_cmp_eq_u32 s40, 3
  s_cselect_b32 s40, 0, s40
  s_cselect_b32 s42, 4294721856, 0
  s_add_u32 s37, s37, s42
  v_mfma_f32_32x32x16_bf16 v[144:159], a[20:23], a[48:51], v[144:159]
  s_waitcnt vmcnt(10) lgkmcnt(0)
  s_barrier
  s_add_u32 s30, s30, 24576
  s_cmp_eq_u32 s30, 98304
  s_cselect_b32 s30, 0, s30
  v_add_u32 v16, s30, v14
  v_add_u32 v17, s30, v15
  v_mfma_f32_32x32x16_bf16 v[64:79], a[24:27], a[56:59], v[64:79]
  ds_read_b128 a[48:51], v32 offset:0
  ds_read_b64_tr_b16 a[0:1], v16 offset:0
  ds_read_b64_tr_b16 a[2:3], v16 offset:1536
  v_mfma_f32_32x32x16_bf16 v[80:95], a[28:31], a[56:59], v[80:95]
  ds_read_b64_tr_b16 a[4:5], v17 offset:64
  ds_read_b64_tr_b16 a[6:7], v17 offset:1600
  ds_read_b64_tr_b16 a[8:9], v16 offset:128
  ds_read_b64_tr_b16 a[10:11], v16 offset:1664
  v_mfma_f32_32x32x16_bf16 v[96:111], a[32:35], a[56:59], v[96:111]
  ds_read_b64_tr_b16 a[12:13], v17 offset:192
  ds_read_b64_tr_b16 a[14:15], v17 offset:1728
  ds_read_b64_tr_b16 a[16:17], v16 offset:256
  ds_read_b64_tr_b16 a[18:19], v16 offset:1792
  v_mfma_f32_32x32x16_bf16 v[112:127], a[36:39], a[56:59], v[112:127]
  ds_read_b64_tr_b16 a[20:21], v17 offset:320
  ds_read_b64_tr_b16 a[22:23], v17 offset:1856
  v_mfma_f32_32x32x16_bf16 v[128:143], a[40:43], a[56:59], v[128:143]
  v_mfma_f32_32x32x16_bf16 v[144:159], a[44:47], a[56:59], v[144:159]
  s_waitcnt lgkmcnt(0)
  v_mfma_f32_32x32x16_bf16 v[64:79], a[0:3], a[48:51], v[64:79]
  ds_read_b128 a[56:59], v33 offset:0
  ds_read_b64_tr_b16 a[24:25], v16 offset:3072
  ds_read_b64_tr_b16 a[26:27], v16 offset:4608
  s_add_u32 m0, s29, s34
  s_nop 0
  buffer_load_dwordx4 v18, s[16:19], s37 offen lds
  v_mfma_f32_32x32x16_bf16 v[80:95], a[4:7], a[48:51], v[80:95]
  ds_read_b64_tr_b16 a[28:29], v17 offset:3136
  ds_read_b64_tr_b16 a[30:31], v17 offset:4672
  ds_read_b64_tr_b16 a[32:33], v16 offset:3200
  ds_read_b64_tr_b16 a[34:35], v16 offset:4736
  v_mfma_f32_32x32x16_bf16 v[96:111], a[8:11], a[48:51], v[96:111]
  ds_read_b64_tr_b16 a[36:37], v17 offset:3264
  ds_read_b64_tr_b16 a[38:39], v17 offset:4800
  ds_read_b64_tr_b16 a[40:41], v16 offset:3328
  ds_read_b64_tr_b16 a[42:43], v16 offset:4864
  v_mfma_f32_32x32x16_bf16 v[112:127], a[12:15], a[48:51], v[112:127]
  ds_read_b64_tr_b16 a[44:45], v17 offset:3392
  ds_read_b64_tr_b16 a[46:47], v17 offset:4928
  v_mfma_f32_32x32x16_bf16 v[128:143], a[16:19], a[48:51], v[128:143]
  s_add_u32 m0, m0, 1024
  s_nop 0
  buffer_load_dwordx4 v19, s[16:19], s37 offen lds
  v_mfma_f32_32x32x16_bf16 v[144:159], a[20:23], a[48:51], v[144:159]
  s_waitcnt lgkmcnt(0)
  v_mfma_f32_32x32x16_bf16 v[64:79], a[24:27], a[56:59], v[64:79]
  ds_read_b128 a[48:51], v34 offset:0
  ds_read_b64_tr_b16 a[0:1], v16 offset:6144
  ds_read_b64_tr_b16 a[2:3], v16 offset:7680
  v_mfma_f32_32x32x16_bf16 v[80:95], a[28:31], a[56:59], v[80:95]
  ds_read_b64_tr_b16 a[4:5], v17 offset:6208
  ds_read_b64_tr_b16 a[6:7], v17 offset:7744
  ds_read_b64_tr_b16 a[8:9], v16 offset:6272
  ds_read_b64_tr_b16 a[10:11], v16 offset:7808
  v_mfma_f32_32x32x16_bf16 v[96:111], a[32:35], a[56:59], v[96:111]
  ds_read_b64_tr_b16 a[12:13], v17 offset:6336
  ds_read_b64_tr_b16 a[14:15], v17 offset:7872
  ds_read_b64_tr_b16 a[16:17], v16 offset:6400
  ds_read_b64_tr_b16 a[18:19], v16 offset:7936
  s_add_u32 m0, m0, 1024
  s_nop 0
  buffer_load_dwordx4 v20, s[16:19], s37 offen lds
  v_mfma_f32_32x32x16_bf16 v[112:127], a[36:39], a[56:59], v[112:127]
  ds_read_b64_tr_b16 a[20:21], v17 offset:6464
  ds_read_b64_tr_b16 a[22:23], v17 offset:8000
  v_mfma_f32_32x32x16_bf16 v[128:143], a[40:43], a[56:59], v[128:143]
  v_mfma_f32_32x32x16_bf16 v[144:159], a[44:47], a[56:59], v[144:159]
  s_waitcnt lgkmcnt(0)
  v_mfma_f32_32x32x16_bf16 v[64:79], a[0:3], a[48:51], v[64:79]
  ds_read_b128 a[56:59], v35 offset:0
  ds_read_b64_tr_b16 a[24:25], v16 offset:9216
  ds_read_b64_tr_b16 a[26:27], v16 offset:10752
  s_add_u32 m0, m0, 1024
  s_nop 0
  buffer_load_dwordx4 v21, s[16:19], s37 offen lds
  v_mfma_f32_32x32x16_bf16 v[80:95], a[4:7], a[48:51], v[80:95]
  ds_read_b64_tr_b16 a[28:29], v17 offset:9280
  ds_read_b64_tr_b16 a[30:31], v17 offset:10816
  ds_read_b64_tr_b16 a[32:33], v16 offset:9344
  ds_read_b64_tr_b16 a[34:35], v16 offset:10880
  v_mfma_f32_32x32x16_bf16 v[96:111], a[8:11], a[48:51], v[96:111]
  ds_read_b64_tr_b16 a[36:37], v17 offset:9408
  ds_read_b64_tr_b16 a[38:39], v17 offset:10944
  ds_read_b64_tr_b16 a[40:41], v16 offset:9472
  ds_read_b64_tr_b16 a[42:43], v16 offset:11008
  v_mfma_f32_32x32x16_bf16 v[112:127], a[12:15], a[48:51], v[112:127]
  ds_read_b64_tr_b16 a[44:45], v17 offset:9536
  ds_read_b64_tr_b16 a[46:47], v17 offset:11072
  v_mfma_f32_32x32x16_bf16 v[128:143], a[16:19], a[48:51], v[128:143]
  s_add_u32 m0, m0, 1024
  s_nop 0
  buffer_load_dwordx4 v22, s[16:19], s37 offen lds
  s_add_u32 s37, s37, 81920
  s_add_u32 s29, s29, 24576
  s_cmp_eq_u32 s29, 98304
  s_cselect_b32 s29, 0, s29
  s_add_u32 s40, s40, 1
  s_cmp_eq_u32 s40, 3
  s_cselect_b32 s40, 0, s40
  s_cselect_b32 s42, 4294721856, 0
  s_add_u32 s37, s37, s42
  v_mfma_f32_32x32x16_bf16 v[144:159], a[20:23], a[48:51], v[144:159]
  s_waitcnt lgkmcnt(0)
  v_mfma_f32_32x32x16_bf16 v[64:79], a[24:27], a[56:59], v[64:79]
  v_mfma_f32_32x32x16_bf16 v[80:95], a[28:31], a[56:59], v[80:95]
  v_mfma_f32_32x32x16_bf16 v[96:111], a[32:35], a[56:59], v[96:111]
  v_mfma_f32_32x32x16_bf16 v[112:127], a[36:39], a[56:59], v[112:127]
  v_mfma_f32_32x32x16_bf16 v[128:143], a[40:43], a[56:59], v[128:143]
  v_mfma_f32_32x32x16_bf16 v[144:159], a[44:47], a[56:59], v[144:159]
  s_waitcnt vmcnt(10)
  s_barrier
  s_add_u32 s30, s30, 24576
  s_cmp_eq_u32 s30, 98304
  s_cselect_b32 s30, 0, s30
  v_add_u32 v16, s30, v23
  ds_read_b64_tr_b16 a[0:1], v16 offset:0
  ds_read_b64_tr_b16 a[2:3], v16 offset:2560
  ds_read_b64_tr_b16 a[4:5], v16 offset:64
  ds_read_b64_tr_b16 a[6:7], v16 offset:2624
  ds_read_b64_tr_b16 a[8:9], v16 offset:128
  ds_read_b64_tr_b16 a[10:11], v16 offset:2688
  ds_read_b64_tr_b16 a[12:13], v16 offset:192
  ds_read_b64_tr_b16 a[14:15], v16 offset:2752
  ds_read_b64_tr_b16 a[16:17], v16 offset:256
  ds_read_b64_tr_b16 a[18:19], v16 offset:2816
  v_cvt_pk_bf16_f32 v40, v64, v65
  v_accvgpr_write_b32 a128, v40
  v_cvt_pk_bf16_f32 v41, v66, v67
  v_accvgpr_write_b32 a129, v41
  v_cvt_pk_bf16_f32 v42, v68, v69
  v_accvgpr_write_b32 a130, v42
  v_cvt_pk_bf16_f32 v43, v70, v71
  v_accvgpr_write_b32 a131, v43
  v_cvt_pk_bf16_f32 v44, v72, v73
  v_accvgpr_write_b32 a132, v44
  v_cvt_pk_bf16_f32 v45, v74, v75
  v_accvgpr_write_b32 a133, v45
  v_cvt_pk_bf16_f32 v46, v76, v77
  v_accvgpr_write_b32 a134, v46
  v_cvt_pk_bf16_f32 v47, v78, v79
  v_accvgpr_write_b32 a135, v47
  v_cvt_pk_bf16_f32 v40, v80, v81
  v_accvgpr_write_b32 a136, v40
  v_cvt_pk_bf16_f32 v41, v82, v83
  v_accvgpr_write_b32 a137, v41
  v_cvt_pk_bf16_f32 v42, v84, v85
  v_accvgpr_write_b32 a138, v42
  v_cvt_pk_bf16_f32 v43, v86, v87
  v_accvgpr_write_b32 a139, v43
  v_cvt_pk_bf16_f32 v44, v88, v89
  v_accvgpr_write_b32 a140, v44
  v_cvt_pk_bf16_f32 v45, v90, v91
  v_accvgpr_write_b32 a141, v45
  v_cvt_pk_bf16_f32 v46, v92, v93
  v_accvgpr_write_b32 a142, v46
  v_cvt_pk_bf16_f32 v47, v94, v95
  v_accvgpr_write_b32 a143, v47
  v_cvt_pk_bf16_f32 v40, v96, v97
  v_accvgpr_write_b32 a144, v40
  v_cvt_pk_bf16_f32 v41, v98, v99
  v_accvgpr_write_b32 a145, v41
  v_cvt_pk_bf16_f32 v42, v100, v101
  v_accvgpr_write_b32 a146, v42
  v_cvt_pk_bf16_f32 v43, v102, v103
  v_accvgpr_write_b32 a147, v43
  v_cvt_pk_bf16_f32 v44, v104, v105
  v_accvgpr_write_b32 a148, v44
  v_cvt_pk_bf16_f32 v45, v106, v107
  v_accvgpr_write_b32 a149, v45
  v_cvt_pk_bf16_f32 v46, v108, v109
  v_accvgpr_write_b32 a150, v46
  v_cvt_pk_bf16_f32 v47, v110, v111
  v_accvgpr_write_b32 a151, v47
  v_cvt_pk_bf16_f32 v40, v112, v113
  v_accvgpr_write_b32 a152, v40
  v_cvt_pk_bf16_f32 v41, v114, v115
  v_accvgpr_write_b32 a153, v41
  v_cvt_pk_bf16_f32 v42, v116, v117
  v_accvgpr_write_b32 a154, v42
  v_cvt_pk_bf16_f32 v43, v118, v119
  v_accvgpr_write_b32 a155, v43
  v_cvt_pk_bf16_f32 v44, v120, v121
  v_accvgpr_write_b32 a156, v44
  v_cvt_pk_bf16_f32 v45, v122, v123
  v_accvgpr_write_b32 a157, v45
  v_cvt_pk_bf16_f32 v46, v124, v125
  v_accvgpr_write_b32 a158, v46
  v_cvt_pk_bf16_f32 v47, v126, v127
  v_accvgpr_write_b32 a159, v47
  v_cvt_pk_bf16_f32 v40, v128, v129
  v_accvgpr_write_b32 a160, v40
  v_cvt_pk_bf16_f32 v41, v130, v131
  v_accvgpr_write_b32 a161, v41
  v_cvt_pk_bf16_f32 v42, v132, v133
  v_accvgpr_write_b32 a162, v42
  v_cvt_pk_bf16_f32 v43, v134, v135
  v_accvgpr_write_b32 a163, v43
  v_cvt_pk_bf16_f32 v44, v136, v137
  v_accvgpr_write_b32 a164, v44
  v_cvt_pk_bf16_f32 v45, v138, v139
  v_accvgpr_write_b32 a165, v45
  v_cvt_pk_bf16_f32 v46, v140, v141
  v_accvgpr_write_b32 a166, v46
  v_cvt_pk_bf16_f32 v47, v142, v143
  v_accvgpr_write_b32 a167, v47
  v_cvt_pk_bf16_f32 v40, v144, v145
  v_accvgpr_write_b32 a168, v40
  v_cvt_pk_bf16_f32 v41, v146, v147
  v_accvgpr_write_b32 a169, v41
  v_cvt_pk_bf16_f32 v42, v148, v149
  v_accvgpr_write_b32 a170, v42
  v_cvt_pk_bf16_f32 v43, v150, v151
  v_accvgpr_write_b32 a171, v43
  v_cvt_pk_bf16_f32 v44, v152, v153
  v_accvgpr_write_b32 a172, v44
  v_cvt_pk_bf16_f32 v45, v154, v155
  v_accvgpr_write_b32 a173, v45
  v_cvt_pk_bf16_f32 v46, v156, v157
  v_accvgpr_write_b32 a174, v46
  v_cvt_pk_bf16_f32 v47, v158, v159
  v_accvgpr_write_b32 a175, v47
  s_waitcnt lgkmcnt(0)
  v_mfma_f32_32x32x16_bf16 v[64:79], a[128:131], a[0:3], 0
  ds_read_b64_tr_b16 a[24:25], v16 offset:5120
  ds_read_b64_tr_b16 a[26:27], v16 offset:7680
  s_add_u32 m0, s29, s34
  s_nop 0
  buffer_load_dwordx4 v18, s[16:19], s37 offen lds
  v_mfma_f32_32x32x16_bf16 v[80:95], a[128:131], a[4:7], 0
  ds_read_b64_tr_b16 a[28:29], v16 offset:5184
  ds_read_b64_tr_b16 a[30:31], v16 offset:7744
  v_mfma_f32_32x32x16_bf16 v[96:111], a[128:131], a[8:11], 0
  ds_read_b64_tr_b16 a[32:33], v16 offset:5248
  ds_read_b64_tr_b16 a[34:35], v16 offset:7808
  v_mfma_f32_32x32x16_bf16 v[112:127], a[128:131], a[12:15], 0
  ds_read_b64_tr_b16 a[36:37], v16 offset:5312
  ds_read_b64_tr_b16 a[38:39], v16 offset:7872
  s_add_u32 m0, m0, 1024
  s_nop 0
  buffer_load_dwordx4 v19, s[16:19], s37 offen lds
  v_mfma_f32_32x32x16_bf16 v[128:143], a[128:131], a[16:19], 0
  ds_read_b64_tr_b16 a[40:41], v16 offset:5376
  ds_read_b64_tr_b16 a[42:43], v16 offset:7936
  s_waitcnt lgkmcnt(0)
  v_mfma_f32_32x32x16_bf16 v[64:79], a[132:135], a[24:27], v[64:79]
  ds_read_b64_tr_b16 a[0:1], v16 offset:10240
  ds_read_b64_tr_b16 a[2:3], v16 offset:12800
  v_mfma_f32_32x32x16_bf16 v[80:95], a[132:135], a[28:31], v[80:95]
  ds_read_b64_tr_b16 a[4:5], v16 offset:10304
  ds_read_b64_tr_b16 a[6:7], v16 offset:12864
  s_add_u32 m0, m0, 1024
  s_nop 0
  buffer_load_dwordx4 v20, s[16:19], s37 offen lds
  v_mfma_f32_32x32x16_bf16 v[96:111], a[132:135], a[32:35], v[96:111]
  ds_read_b64_tr_b16 a[8:9], v16 offset:10368
  ds_read_b64_tr_b16 a[10:11], v16 offset:12928
  v_mfma_f32_32x32x16_bf16 v[112:127], a[132:135], a[36:39], v[112:127]
  ds_read_b64_tr_b16 a[12:13], v16 offset:10432
  ds_read_b64_tr_b16 a[14:15], v16 offset:12992
  v_mfma_f32_32x32x16_bf16 v[128:143], a[132:135], a[40:43], v[128:143]
  ds_read_b64_tr_b16 a[16:17], v16 offset:10496
  ds_read_b64_tr_b16 a[18:19], v16 offset:13056
  s_add_u32 m0, m0, 1024
  s_nop 0
  buffer_load_dwordx4 v21, s[16:19], s37 offen lds
  s_waitcnt lgkmcnt(0)
  v_mfma_f32_32x32x16_bf16 v[64:79], a[136:139], a[0:3], v[64:79]
  ds_read_b64_tr_b16 a[24:25], v16 offset:15360
  ds_read_b64_tr_b16 a[26:27], v16 offset:17920
  v_mfma_f32_32x32x16_bf16 v[80:95], a[136:139], a[4:7], v[80:95]
  ds_read_b64_tr_b16 a[28:29], v16 offset:15424
  ds_read_b64_tr_b16 a[30:31], v16 offset:17984
  v_mfma_f32_32x32x16_bf16 v[96:111], a[136:139], a[8:11], v[96:111]
  ds_read_b64_tr_b16 a[32:33], v16 offset:15488
  ds_read_b64_tr_b16 a[34:35], v16 offset:18048
  s_add_u32 m0, m0, 1024
  s_nop 0
  buffer_load_dwordx4 v22, s[16:19], s37 offen lds
  s_add_u32 s37, s37, 81920
  s_add_u32 s29, s29, 24576
  s_cmp_eq_u32 s29, 98304
  s_cselect_b32 s29, 0, s29
  s_add_u32 s40, s40, 1
  s_cmp_eq_u32 s40, 3
  s_cselect_b32 s40, 0, s40
  s_cselect_b32 s42, 4294721856, 0
  s_add_u32 s37, s37, s42
  v_mfma_f32_32x32x16_bf16 v[112:127], a[136:139], a[12:15], v[112:127]
  ds_read_b64_tr_b16 a[36:37], v16 offset:15552
  ds_read_b64_tr_b16 a[38:39], v16 offset:18112
  v_mfma_f32_32x32x16_bf16 v[128:143], a[136:139], a[16:19], v[128:143]
  ds_read_b64_tr_b16 a[40:41], v16 offset:15616
  ds_read_b64_tr_b16 a[42:43], v16 offset:18176
  s_waitcnt vmcnt(10) lgkmcnt(0)
  s_barrier
  s_add_u32 s30, s30, 24576
  s_cmp_eq_u32 s30, 98304
  s_cselect_b32 s30, 0, s30
  v_add_u32 v16, s30, v23
  v_mfma_f32_32x32x16_bf16 v[64:79], a[140:143], a[24:27], v[64:79]
  ds_read_b64_tr_b16 a[0:1], v16 offset:0
  ds_read_b64_tr_b16 a[2:3], v16 offset:2560
  v_mfma_f32_32x32x16_bf16 v[80:95], a[140:143], a[28:31], v[80:95]
  ds_read_b64_tr_b16 a[4:5], v16 offset:64
  ds_read_b64_tr_b16 a[6:7], v16 offset:2624
  v_mfma_f32_32x32x16_bf16 v[96:111], a[140:143], a[32:35], v[96:111]
  ds_read_b64_tr_b16 a[8:9], v16 offset:128
  ds_read_b64_tr_b16 a[10:11], v16 offset:2688
  v_mfma_f32_32x32x16_bf16 v[112:127], a[140:143], a[36:39], v[112:127]
  ds_read_b64_tr_b16 a[12:13], v16 offset:192
  ds_read_b64_tr_b16 a[14:15], v16 offset:2752
  v_mfma_f32_32x32x16_bf16 v[128:143], a[140:143], a[40:43], v[128:143]
  ds_read_b64_tr_b16 a[16:17], v16 offset:256
  ds_read_b64_tr_b16 a[18:19], v16 offset:2816
  s_waitcnt lgkmcnt(0)
  v_mfma_f32_32x32x16_bf16 v[64:79], a[144:147], a[0:3], v[64:79]
  ds_read_b64_tr_b16 a[24:25], v16 offset:5120
  ds_read_b64_tr_b16 a[26:27], v16 offset:7680
  s_add_u32 m0, s29, s34
  s_nop 0
  buffer_load_dwordx4 v18, s[16:19], s37 offen lds
  v_mfma_f32_32x32x16_bf16 v[80:95], a[144:147], a[4:7], v[80:95]
  ds_read_b64_tr_b16 a[28:29], v16 offset:5184
  ds_read_b64_tr_b16 a[30:31], v16 offset:7744
  v_mfma_f32_32x32x16_bf16 v[96:111], a[144:147], a[8:11], v[96:111]
  ds_read_b64_tr_b16 a[32:33], v16 offset:5248
  ds_read_b64_tr_b16 a[34:35], v16 offset:7808
  v_mfma_f32_32x32x16_bf16 v[112:127], a[144:147], a[12:15], v[112:127]
  ds_read_b64_tr_b16 a[36:37], v16 offset:5312
  ds_read_b64_tr_b16 a[38:39], v16 offset:7872
  s_add_u32 m0, m0, 1024
  s_nop 0
  buffer_load_dwordx4 v19, s[16:19], s37 offen lds
  v_mfma_f32_32x32x16_bf16 v[128:143], a[144:147], a[16:19], v[128:143]
  ds_read_b64_tr_b16 a[40:41], v16 offset:5376
  ds_read_b64_tr_b16 a[42:43], v16 offset:7936
  s_waitcnt lgkmcnt(0)
  v_mfma_f32_32x32x16_bf16 v[64:79], a[148:151], a[24:27], v[64:79]
  ds_read_b64_tr_b16 a[0:1], v16 offset:10240
  ds_read_b64_tr_b16 a[2:3], v16 offset:12800
  v_mfma_f32_32x32x16_bf16 v[80:95], a[148:151], a[28:31], v[80:95]
  ds_read_b64_tr_b16 a[4:5], v16 offset:10304
  ds_read_b64_tr_b16 a[6:7], v16 offset:12864
  s_add_u32 m0, m0, 1024
  s_nop 0
  buffer_load_dwordx4 v20, s[16:19], s37 offen lds
  v_mfma_f32_32x32x16_bf16 v[96:111], a[148:151], a[32:35], v[96:111]
  ds_read_b64_tr_b16 a[8:9], v16 offset:10368
  ds_read_b64_tr_b16 a[10:11], v16 offset:12928
  v_mfma_f32_32x32x16_bf16 v[112:127], a[148:151], a[36:39], v[112:127]
  ds_read_b64_tr_b16 a[12:13], v16 offset:10432
  ds_read_b64_tr_b16 a[14:15], v16 offset:12992
  v_mfma_f32_32x32x16_bf16 v[128:143], a[148:151], a[40:43], v[128:143]
  ds_read_b64_tr_b16 a[16:17], v16 offset:10496
  ds_read_b64_tr_b16 a[18:19], v16 offset:13056
  s_add_u32 m0, m0, 1024
  s_nop 0
  buffer_load_dwordx4 v21, s[16:19], s37 offen lds
  s_waitcnt lgkmcnt(0)
  v_mfma_f32_32x32x16_bf16 v[64:79], a[152:155], a[0:3], v[64:79]
  ds_read_b64_tr_b16 a[24:25], v16 offset:15360
  ds_read_b64_tr_b16 a[26:27], v16 offset:17920
  v_mfma_f32_32x32x16_bf16 v[80:95], a[152:155], a[4:7], v[80:95]
  ds_read_b64_tr_b16 a[28:29], v16 offset:15424
  ds_read_b64_tr_b16 a[30:31], v16 offset:17984
  v_mfma_f32_32x32x16_bf16 v[96:111], a[152:155], a[8:11], v[96:111]
  ds_read_b64_tr_b16 a[32:33], v16 offset:15488
  ds_read_b64_tr_b16 a[34:35], v16 offset:18048
  s_add_u32 m0, m0, 1024
  s_nop 0
  buffer_load_dwordx4 v22, s[16:19], s37 offen lds
  s_add_u32 s37, s37, 81920
  s_add_u32 s29, s29, 24576
  s_cmp_eq_u32 s29, 98304
  s_cselect_b32 s29, 0, s29
  s_add_u32 s40, s40, 1
  s_cmp_eq_u32 s40, 3
  s_cselect_b32 s40, 0, s40
  s_cselect_b32 s42, 4294721856, 0
  s_add_u32 s37, s37, s42
  v_mfma_f32_32x32x16_bf16 v[112:127], a[152:155], a[12:15], v[112:127]
  ds_read_b64_tr_b16 a[36:37], v16 offset:15552
  ds_read_b64_tr_b16 a[38:39], v16 offset:18112
  v_mfma_f32_32x32x16_bf16 v[128:143], a[152:155], a[16:19], v[128:143]
  ds_read_b64_tr_b16 a[40:41], v16 offset:15616
  ds_read_b64_tr_b16 a[42:43], v16 offset:18176
  s_waitcnt vmcnt(10) lgkmcnt(0)
  s_barrier
  s_add_u32 s30, s30, 24576
  s_cmp_eq_u32 s30, 98304
  s_cselect_b32 s30, 0, s30
  v_add_u32 v16, s30, v23
  v_mfma_f32_32x32x16_bf16 v[64:79], a[156:159], a[24:27], v[64:79]
  ds_read_b64_tr_b16 a[0:1], v16 offset:0
  ds_read_b64_tr_b16 a[2:3], v16 offset:2560
  v_mfma_f32_32x32x16_bf16 v[80:95], a[156:159], a[28:31], v[80:95]
  ds_read_b64_tr_b16 a[4:5], v16 offset:64
  ds_read_b64_tr_b16 a[6:7], v16 offset:2624
  v_mfma_f32_32x32x16_bf16 v[96:111], a[156:159], a[32:35], v[96:111]
  ds_read_b64_tr_b16 a[8:9], v16 offset:128
  ds_read_b64_tr_b16 a[10:11], v16 offset:2688
  v_mfma_f32_32x32x16_bf16 v[112:127], a[156:159], a[36:39], v[112:127]
  ds_read_b64_tr_b16 a[12:13], v16 offset:192
  ds_read_b64_tr_b16 a[14:15], v16 offset:2752
  v_mfma_f32_32x32x16_bf16 v[128:143], a[156:159], a[40:43], v[128:143]
  ds_read_b64_tr_b16 a[16:17], v16 offset:256
  ds_read_b64_tr_b16 a[18:19], v16 offset:2816
  s_waitcnt lgkmcnt(0)
  v_mfma_f32_32x32x16_bf16 v[64:79], a[160:163], a[0:3], v[64:79]
  ds_read_b64_tr_b16 a[24:25], v16 offset:5120
  ds_read_b64_tr_b16 a[26:27], v16 offset:7680
  s_add_u32 m0, s29, s34
  s_nop 0
  buffer_load_dwordx4 v18, s[16:19], s37 offen lds
  v_mfma_f32_32x32x16_bf16 v[80:95], a[160:163], a[4:7], v[80:95]
  ds_read_b64_tr_b16 a[28:29], v16 offset:5184
  ds_read_b64_tr_b16 a[30:31], v16 offset:7744
  v_mfma_f32_32x32x16_bf16 v[96:111], a[160:163], a[8:11], v[96:111]
  ds_read_b64_tr_b16 a[32:33], v16 offset:5248
  ds_read_b64_tr_b16 a[34:35], v16 offset:7808
  v_mfma_f32_32x32x16_bf16 v[112:127], a[160:163], a[12:15], v[112:127]
  ds_read_b64_tr_b16 a[36:37], v16 offset:5312
  ds_read_b64_tr_b16 a[38:39], v16 offset:7872
  s_add_u32 m0, m0, 1024
  s_nop 0
  buffer_load_dwordx4 v19, s[16:19], s37 offen lds
  v_mfma_f32_32x32x16_bf16 v[128:143], a[160:163], a[16:19], v[128:143]
  ds_read_b64_tr_b16 a[40:41], v16 offset:5376
  ds_read_b64_tr_b16 a[42:43], v16 offset:7936
  s_waitcnt lgkmcnt(0)
  v_mfma_f32_32x32x16_bf16 v[64:79], a[164:167], a[24:27], v[64:79]
  ds_read_b64_tr_b16 a[0:1], v16 offset:10240
  ds_read_b64_tr_b16 a[2:3], v16 offset:12800
  v_mfma_f32_32x32x16_bf16 v[80:95], a[164:167], a[28:31], v[80:95]
  ds_read_b64_tr_b16 a[4:5], v16 offset:10304
  ds_read_b64_tr_b16 a[6:7], v16 offset:12864
  s_add_u32 m0, m0, 1024
  s_nop 0
  buffer_load_dwordx4 v20, s[16:19], s37 offen lds
  v_mfma_f32_32x32x16_bf16 v[96:111], a[164:167], a[32:35], v[96:111]
  ds_read_b64_tr_b16 a[8:9], v16 offset:10368
  ds_read_b64_tr_b16 a[10:11], v16 offset:12928
  v_mfma_f32_32x32x16_bf16 v[112:127], a[164:167], a[36:39], v[112:127]
  ds_read_b64_tr_b16 a[12:13], v16 offset:10432
  ds_read_b64_tr_b16 a[14:15], v16 offset:12992
  v_mfma_f32_32x32x16_bf16 v[128:143], a[164:167], a[40:43], v[128:143]
  ds_read_b64_tr_b16 a[16:17], v16 offset:10496
  ds_read_b64_tr_b16 a[18:19], v16 offset:13056
  s_add_u32 m0, m0, 1024
  s_nop 0
  buffer_load_dwordx4 v21, s[16:19], s37 offen lds
  s_waitcnt lgkmcnt(0)
  v_mfma_f32_32x32x16_bf16 v[64:79], a[168:171], a[0:3], v[64:79]
  ds_read_b64_tr_b16 a[24:25], v16 offset:15360
  ds_read_b64_tr_b16 a[26:27], v16 offset:17920
  v_mfma_f32_32x32x16_bf16 v[80:95], a[168:171], a[4:7], v[80:95]
  ds_read_b64_tr_b16 a[28:29], v16 offset:15424
  ds_read_b64_tr_b16 a[30:31], v16 offset:17984
  v_mfma_f32_32x32x16_bf16 v[96:111], a[168:171], a[8:11], v[96:111]
  ds_read_b64_tr_b16 a[32:33], v16 offset:15488
  ds_read_b64_tr_b16 a[34:35], v16 offset:18048
  s_add_u32 m0, m0, 1024
  s_nop 0
  buffer_load_dwordx4 v22, s[16:19], s37 offen lds
  s_add_u32 s37, s37, 81920
  s_add_u32 s29, s29, 24576
  s_cmp_eq_u32 s29, 98304
  s_cselect_b32 s29, 0, s29
  s_add_u32 s40, s40, 1
  s_cmp_eq_u32 s40, 3
  s_cselect_b32 s40, 0, s40
  s_cselect_b32 s42, 4294721856, 0
  s_add_u32 s37, s37, s42
  v_mfma_f32_32x32x16_bf16 v[112:127], a[168:171], a[12:15], v[112:127]
  ds_read_b64_tr_b16 a[36:37], v16 offset:15552
  ds_read_b64_tr_b16 a[38:39], v16 offset:18112
  v_mfma_f32_32x32x16_bf16 v[128:143], a[168:171], a[16:19], v[128:143]
  ds_read_b64_tr_b16 a[40:41], v16 offset:15616
  ds_read_b64_tr_b16 a[42:43], v16 offset:18176
  s_waitcnt vmcnt(10) lgkmcnt(0)
  s_barrier
  s_add_u32 s30, s30, 24576
  s_cmp_eq_u32 s30, 98304
  s_cselect_b32 s30, 0, s30
  v_add_u32 v16, s30, v23
  v_mfma_f32_32x32x16_bf16 v[64:79], a[172:175], a[24:27], v[64:79]
  ds_read_b64_tr_b16 a[0:1], v16 offset:0
  ds_read_b64_tr_b16 a[2:3], v16 offset:2560
  v_mfma_f32_32x32x16_bf16 v[80:95], a[172:175], a[28:31], v[80:95]
  ds_read_b64_tr_b16 a[4:5], v16 offset:64
  ds_read_b64_tr_b16 a[6:7], v16 offset:2624
  v_mfma_f32_32x32x16_bf16 v[96:111], a[172:175], a[32:35], v[96:111]
  ds_read_b64_tr_b16 a[8:9], v16 offset:128
  ds_read_b64_tr_b16 a[10:11], v16 offset:2688
  v_mfma_f32_32x32x16_bf16 v[112:127], a[172:175], a[36:39], v[112:127]
  ds_read_b64_tr_b16 a[12:13], v16 offset:192
  ds_read_b64_tr_b16 a[14:15], v16 offset:2752
  v_mfma_f32_32x32x16_bf16 v[128:143], a[172:175], a[40:43], v[128:143]
  ds_read_b64_tr_b16 a[16:17], v16 offset:256
  ds_read_b64_tr_b16 a[18:19], v16 offset:2816
  s_cmp_eq_u32 s38, 2
  s_cbranch_scc1 W_pass_6_fin
W_pass_6_fin:
  s_waitcnt lgkmcnt(0)
  v_cvt_pk_bf16_f32 v40, v64, v65
  v_cvt_pk_bf16_f32 v41, v66, v67
  v_cvt_pk_bf16_f32 v42, v68, v69
  v_cvt_pk_bf16_f32 v43, v70, v71
  v_cvt_pk_bf16_f32 v44, v72, v73
  v_cvt_pk_bf16_f32 v45, v74, v75
  v_cvt_pk_bf16_f32 v46, v76, v77
  v_cvt_pk_bf16_f32 v47, v78, v79
  v_mfma_f32_32x32x16_bf16 v[64:79], a[128:131], a[0:3], 0
  ds_read_b64_tr_b16 a[24:25], v16 offset:5120
  ds_read_b64_tr_b16 a[26:27], v16 offset:7680
  v_cvt_pk_bf16_f32 v48, v80, v81
  v_cvt_pk_bf16_f32 v49, v82, v83
  v_cvt_pk_bf16_f32 v50, v84, v85
  v_cvt_pk_bf16_f32 v51, v86, v87
  v_cvt_pk_bf16_f32 v52, v88, v89
  v_cvt_pk_bf16_f32 v53, v90, v91
  v_cvt_pk_bf16_f32 v54, v92, v93
  v_cvt_pk_bf16_f32 v55, v94, v95
  v_mfma_f32_32x32x16_bf16 v[80:95], a[128:131], a[4:7], 0
  ds_read_b64_tr_b16 a[28:29], v16 offset:5184
  ds_read_b64_tr_b16 a[30:31], v16 offset:7744
  v_cvt_pk_bf16_f32 v56, v96, v97
  v_cvt_pk_bf16_f32 v57, v98, v99
  v_cvt_pk_bf16_f32 v58, v100, v101
  v_cvt_pk_bf16_f32 v59, v102, v103
  v_cvt_pk_bf16_f32 v60, v104, v105
  v_cvt_pk_bf16_f32 v61, v106, v107
  v_cvt_pk_bf16_f32 v62, v108, v109
  v_cvt_pk_bf16_f32 v63, v110, v111
  v_mfma_f32_32x32x16_bf16 v[96:111], a[128:131], a[8:11], 0
  ds_read_b64_tr_b16 a[32:33], v16 offset:5248
  ds_read_b64_tr_b16 a[34:35], v16 offset:7808
  v_cvt_pk_bf16_f32 v224, v112, v113
  v_cvt_pk_bf16_f32 v225, v114, v115
  v_cvt_pk_bf16_f32 v226, v116, v117
  v_cvt_pk_bf16_f32 v227, v118, v119
  v_cvt_pk_bf16_f32 v228, v120, v121
  v_cvt_pk_bf16_f32 v229, v122, v123
  v_cvt_pk_bf16_f32 v230, v124, v125
  v_cvt_pk_bf16_f32 v231, v126, v127
  v_mfma_f32_32x32x16_bf16 v[112:127], a[128:131], a[12:15], 0
  ds_read_b64_tr_b16 a[36:37], v16 offset:5312
  ds_read_b64_tr_b16 a[38:39], v16 offset:7872
  v_cvt_pk_bf16_f32 v232, v128, v129
  v_cvt_pk_bf16_f32 v233, v130, v131
  v_cvt_pk_bf16_f32 v234, v132, v133
  v_cvt_pk_bf16_f32 v235, v134, v135
  v_cvt_pk_bf16_f32 v236, v136, v137
  v_cvt_pk_bf16_f32 v237, v138, v139
  v_cvt_pk_bf16_f32 v238, v140, v141
  v_cvt_pk_bf16_f32 v239, v142, v143
  v_mfma_f32_32x32x16_bf16 v[128:143], a[128:131], a[16:19], 0
  ds_read_b64_tr_b16 a[40:41], v16 offset:5376
  ds_read_b64_tr_b16 a[42:43], v16 offset:7936
  s_waitcnt lgkmcnt(0)
  v_mfma_f32_32x32x16_bf16 v[64:79], a[132:135], a[24:27], v[64:79]
  ds_read_b64_tr_b16 a[0:1], v16 offset:10240
  ds_read_b64_tr_b16 a[2:3], v16 offset:12800
  s_add_u32 s25, s31, 0
  buffer_store_dwordx4 v[40:43], v36, s[8:11], s25 offen offset:0 sc1
  v_mfma_f32_32x32x16_bf16 v[80:95], a[132:135], a[28:31], v[80:95]
  ds_read_b64_tr_b16 a[4:5], v16 offset:10304
  ds_read_b64_tr_b16 a[6:7], v16 offset:12864
  v_mfma_f32_32x32x16_bf16 v[96:111], a[132:135], a[32:35], v[96:111]
  ds_read_b64_tr_b16 a[8:9], v16 offset:10368
  ds_read_b64_tr_b16 a[10:11], v16 offset:12928
  buffer_store_dwordx4 v[44:47], v36, s[8:11], s25 offen offset:1024 sc1
  v_mfma_f32_32x32x16_bf16 v[112:127], a[132:135], a[36:39], v[112:127]
  ds_read_b64_tr_b16 a[12:13], v16 offset:10432
  ds_read_b64_tr_b16 a[14:15], v16 offset:12992
  v_mfma_f32_32x32x16_bf16 v[128:143], a[132:135], a[40:43], v[128:143]
  ds_read_b64_tr_b16 a[16:17], v16 offset:10496
  ds_read_b64_tr_b16 a[18:19], v16 offset:13056
  s_waitcnt lgkmcnt(0)
  v_mfma_f32_32x32x16_bf16 v[64:79], a[136:139], a[0:3], v[64:79]
  ds_read_b64_tr_b16 a[24:25], v16 offset:15360
  ds_read_b64_tr_b16 a[26:27], v16 offset:17920
  s_add_u32 s25, s31, 0
  buffer_store_dwordx4 v[48:51], v36, s[8:11], s25 offen offset:2048 sc1
  v_mfma_f32_32x32x16_bf16 v[80:95], a[136:139], a[4:7], v[80:95]
  ds_read_b64_tr_b16 a[28:29], v16 offset:15424
  ds_read_b64_tr_b16 a[30:31], v16 offset:17984
  v_mfma_f32_32x32x16_bf16 v[96:111], a[136:139], a[8:11], v[96:111]
  ds_read_b64_tr_b16 a[32:33], v16 offset:15488
  ds_read_b64_tr_b16 a[34:35], v16 offset:18048
  buffer_store_dwordx4 v[52:55], v36, s[8:11], s25 offen offset:3072 sc1
  v_mfma_f32_32x32x16_bf16 v[112:127], a[136:139], a[12:15], v[112:127]
  ds_read_b64_tr_b16 a[36:37], v16 offset:15552
  ds_read_b64_tr_b16 a[38:39], v16 offset:18112
  v_mfma_f32_32x32x16_bf16 v[128:143], a[136:139], a[16:19], v[128:143]
  ds_read_b64_tr_b16 a[40:41], v16 offset:15616
  ds_read_b64_tr_b16 a[42:43], v16 offset:18176
  s_waitcnt vmcnt(9) lgkmcnt(0)
  s_barrier
  s_add_u32 s30, s30, 24576
  s_cmp_eq_u32 s30, 98304
  s_cselect_b32 s30, 0, s30
  v_add_u32 v16, s30, v23
  v_mfma_f32_32x32x16_bf16 v[64:79], a[140:143], a[24:27], v[64:79]
  ds_read_b64_tr_b16 a[0:1], v16 offset:0
  ds_read_b64_tr_b16 a[2:3], v16 offset:2560
  v_mfma_f32_32x32x16_bf16 v[80:95], a[140:143], a[28:31], v[80:95]
  ds_read_b64_tr_b16 a[4:5], v16 offset:64
  ds_read_b64_tr_b16 a[6:7], v16 offset:2624
  v_mfma_f32_32x32x16_bf16 v[96:111], a[140:143], a[32:35], v[96:111]
  ds_read_b64_tr_b16 a[8:9], v16 offset:128
  ds_read_b64_tr_b16 a[10:11], v16 offset:2688
  v_mfma_f32_32x32x16_bf16 v[112:127], a[140:143], a[36:39], v[112:127]
  ds_read_b64_tr_b16 a[12:13], v16 offset:192
  ds_read_b64_tr_b16 a[14:15], v16 offset:2752
  v_mfma_f32_32x32x16_bf16 v[128:143], a[140:143], a[40:43], v[128:143]
  ds_read_b64_tr_b16 a[16:17], v16 offset:256
  ds_read_b64_tr_b16 a[18:19], v16 offset:2816
  s_waitcnt lgkmcnt(0)
  v_mfma_f32_32x32x16_bf16 v[64:79], a[144:147], a[0:3], v[64:79]
  ds_read_b64_tr_b16 a[24:25], v16 offset:5120
  ds_read_b64_tr_b16 a[26:27], v16 offset:7680
  s_add_u32 s25, s31, 4096
  buffer_store_dwordx4 v[56:59], v36, s[8:11], s25 offen offset:0 sc1
  v_mfma_f32_32x32x16_bf16 v[80:95], a[144:147], a[4:7], v[80:95]
  ds_read_b64_tr_b16 a[28:29], v16 offset:5184
  ds_read_b64_tr_b16 a[30:31], v16 offset:7744
  v_mfma_f32_32x32x16_bf16 v[96:111], a[144:147], a[8:11], v[96:111]
  ds_read_b64_tr_b16 a[32:33], v16 offset:5248
  ds_read_b64_tr_b16 a[34:35], v16 offset:7808
  v_mfma_f32_32x32x16_bf16 v[112:127], a[144:147], a[12:15], v[112:127]
  ds_read_b64_tr_b16 a[36:37], v16 offset:5312
  ds_read_b64_tr_b16 a[38:39], v16 offset:7872
  v_mfma_f32_32x32x16_bf16 v[128:143], a[144:147], a[16:19], v[128:143]
  ds_read_b64_tr_b16 a[40:41], v16 offset:5376
  ds_read_b64_tr_b16 a[42:43], v16 offset:7936
  s_waitcnt lgkmcnt(0)
  v_mfma_f32_32x32x16_bf16 v[64:79], a[148:151], a[24:27], v[64:79]
  ds_read_b64_tr_b16 a[0:1], v16 offset:10240
  ds_read_b64_tr_b16 a[2:3], v16 offset:12800
  buffer_store_dwordx4 v[60:63], v36, s[8:11], s25 offen offset:1024 sc1
  v_mfma_f32_32x32x16_bf16 v[80:95], a[148:151], a[28:31], v[80:95]
  ds_read_b64_tr_b16 a[4:5], v16 offset:10304
  ds_read_b64_tr_b16 a[6:7], v16 offset:12864
  v_mfma_f32_32x32x16_bf16 v[96:111], a[148:151], a[32:35], v[96:111]
  ds_read_b64_tr_b16 a[8:9], v16 offset:10368
  ds_read_b64_tr_b16 a[10:11], v16 offset:12928
  v_mfma_f32_32x32x16_bf16 v[112:127], a[148:151], a[36:39], v[112:127]
  ds_read_b64_tr_b16 a[12:13], v16 offset:10432
  ds_read_b64_tr_b16 a[14:15], v16 offset:12992
  v_mfma_f32_32x32x16_bf16 v[128:143], a[148:151], a[40:43], v[128:143]
  ds_read_b64_tr_b16 a[16:17], v16 offset:10496
  ds_read_b64_tr_b16 a[18:19], v16 offset:13056
  s_waitcnt lgkmcnt(0)
  v_mfma_f32_32x32x16_bf16 v[64:79], a[152:155], a[0:3], v[64:79]
  ds_read_b64_tr_b16 a[24:25], v16 offset:15360
  ds_read_b64_tr_b16 a[26:27], v16 offset:17920
  s_add_u32 s25, s31, 4096
  buffer_store_dwordx4 v[224:227], v36, s[8:11], s25 offen offset:2048 sc1
  v_mfma_f32_32x32x16_bf16 v[80:95], a[152:155], a[4:7], v[80:95]
  ds_read_b64_tr_b16 a[28:29], v16 offset:15424
  ds_read_b64_tr_b16 a[30:31], v16 offset:17984
  v_mfma_f32_32x32x16_bf16 v[96:111], a[152:155], a[8:11], v[96:111]
  ds_read_b64_tr_b16 a[32:33], v16 offset:15488
  ds_read_b64_tr_b16 a[34:35], v16 offset:18048
  v_mfma_f32_32x32x16_bf16 v[112:127], a[152:155], a[12:15], v[112:127]
  ds_read_b64_tr_b16 a[36:37], v16 offset:15552
  ds_read_b64_tr_b16 a[38:39], v16 offset:18112
  v_mfma_f32_32x32x16_bf16 v[128:143], a[152:155], a[16:19], v[128:143]
  ds_read_b64_tr_b16 a[40:41], v16 offset:15616
  ds_read_b64_tr_b16 a[42:43], v16 offset:18176
  s_waitcnt vmcnt(3) lgkmcnt(0)
  s_barrier
  s_add_u32 s30, s30, 24576
  s_cmp_eq_u32 s30, 98304
  s_cselect_b32 s30, 0, s30
  v_add_u32 v16, s30, v23
  v_mfma_f32_32x32x16_bf16 v[64:79], a[156:159], a[24:27], v[64:79]
  ds_read_b64_tr_b16 a[0:1], v16 offset:0
  ds_read_b64_tr_b16 a[2:3], v16 offset:2560
  v_mfma_f32_32x32x16_bf16 v[80:95], a[156:159], a[28:31], v[80:95]
  ds_read_b64_tr_b16 a[4:5], v16 offset:64
  ds_read_b64_tr_b16 a[6:7], v16 offset:2624
  v_mfma_f32_32x32x16_bf16 v[96:111], a[156:159], a[32:35], v[96:111]
  ds_read_b64_tr_b16 a[8:9], v16 offset:128
  ds_read_b64_tr_b16 a[10:11], v16 offset:2688
  v_mfma_f32_32x32x16_bf16 v[112:127], a[156:159], a[36:39], v[112:127]
  ds_read_b64_tr_b16 a[12:13], v16 offset:192
  ds_read_b64_tr_b16 a[14:15], v16 offset:2752
  v_mfma_f32_32x32x16_bf16 v[128:143], a[156:159], a[40:43], v[128:143]
  ds_read_b64_tr_b16 a[16:17], v16 offset:256
  ds_read_b64_tr_b16 a[18:19], v16 offset:2816
  s_waitcnt lgkmcnt(0)
  v_mfma_f32_32x32x16_bf16 v[64:79], a[160:163], a[0:3], v[64:79]
  ds_read_b64_tr_b16 a[24:25], v16 offset:5120
  ds_read_b64_tr_b16 a[26:27], v16 offset:7680
  buffer_store_dwordx4 v[228:231], v36, s[8:11], s25 offen offset:3072 sc1
  v_mfma_f32_32x32x16_bf16 v[80:95], a[160:163], a[4:7], v[80:95]
  ds_read_b64_tr_b16 a[28:29], v16 offset:5184
  ds_read_b64_tr_b16 a[30:31], v16 offset:7744
  v_mfma_f32_32x32x16_bf16 v[96:111], a[160:163], a[8:11], v[96:111]
  ds_read_b64_tr_b16 a[32:33], v16 offset:5248
  ds_read_b64_tr_b16 a[34:35], v16 offset:7808
  v_mfma_f32_32x32x16_bf16 v[112:127], a[160:163], a[12:15], v[112:127]
  ds_read_b64_tr_b16 a[36:37], v16 offset:5312
  ds_read_b64_tr_b16 a[38:39], v16 offset:7872
  v_mfma_f32_32x32x16_bf16 v[128:143], a[160:163], a[16:19], v[128:143]
  ds_read_b64_tr_b16 a[40:41], v16 offset:5376
  ds_read_b64_tr_b16 a[42:43], v16 offset:7936
  s_waitcnt lgkmcnt(0)
  v_mfma_f32_32x32x16_bf16 v[64:79], a[164:167], a[24:27], v[64:79]
  ds_read_b64_tr_b16 a[0:1], v16 offset:10240
  ds_read_b64_tr_b16 a[2:3], v16 offset:12800
  s_add_u32 s25, s31, 8192
  buffer_store_dwordx4 v[232:235], v36, s[8:11], s25 offen offset:0 sc1
  v_mfma_f32_32x32x16_bf16 v[80:95], a[164:167], a[28:31], v[80:95]
  ds_read_b64_tr_b16 a[4:5], v16 offset:10304
  ds_read_b64_tr_b16 a[6:7], v16 offset:12864
  v_mfma_f32_32x32x16_bf16 v[96:111], a[164:167], a[32:35], v[96:111]
  ds_read_b64_tr_b16 a[8:9], v16 offset:10368
  ds_read_b64_tr_b16 a[10:11], v16 offset:12928
  v_mfma_f32_32x32x16_bf16 v[112:127], a[164:167], a[36:39], v[112:127]
  ds_read_b64_tr_b16 a[12:13], v16 offset:10432
  ds_read_b64_tr_b16 a[14:15], v16 offset:12992
  v_mfma_f32_32x32x16_bf16 v[128:143], a[164:167], a[40:43], v[128:143]
  ds_read_b64_tr_b16 a[16:17], v16 offset:10496
  ds_read_b64_tr_b16 a[18:19], v16 offset:13056
  s_waitcnt lgkmcnt(0)
  v_mfma_f32_32x32x16_bf16 v[64:79], a[168:171], a[0:3], v[64:79]
  ds_read_b64_tr_b16 a[24:25], v16 offset:15360
  ds_read_b64_tr_b16 a[26:27], v16 offset:17920
  buffer_store_dwordx4 v[236:239], v36, s[8:11], s25 offen offset:1024 sc1
  v_mfma_f32_32x32x16_bf16 v[80:95], a[168:171], a[4:7], v[80:95]
  ds_read_b64_tr_b16 a[28:29], v16 offset:15424
  ds_read_b64_tr_b16 a[30:31], v16 offset:17984
  v_mfma_f32_32x32x16_bf16 v[96:111], a[168:171], a[8:11], v[96:111]
  ds_read_b64_tr_b16 a[32:33], v16 offset:15488
  ds_read_b64_tr_b16 a[34:35], v16 offset:18048
  v_mfma_f32_32x32x16_bf16 v[112:127], a[168:171], a[12:15], v[112:127]
  ds_read_b64_tr_b16 a[36:37], v16 offset:15552
  ds_read_b64_tr_b16 a[38:39], v16 offset:18112
  v_mfma_f32_32x32x16_bf16 v[128:143], a[168:171], a[16:19], v[128:143]
  ds_read_b64_tr_b16 a[40:41], v16 offset:15616
  ds_read_b64_tr_b16 a[42:43], v16 offset:18176
  s_waitcnt lgkmcnt(0)
  v_mfma_f32_32x32x16_bf16 v[64:79], a[172:175], a[24:27], v[64:79]
  v_mfma_f32_32x32x16_bf16 v[80:95], a[172:175], a[28:31], v[80:95]
  v_mfma_f32_32x32x16_bf16 v[96:111], a[172:175], a[32:35], v[96:111]
  v_mfma_f32_32x32x16_bf16 v[112:127], a[172:175], a[36:39], v[112:127]
  v_mfma_f32_32x32x16_bf16 v[128:143], a[172:175], a[40:43], v[128:143]
  s_add_u32 s31, s31, 10240
  s_nop 7
  v_cvt_pk_bf16_f32 v40, v64, v65
  v_cvt_pk_bf16_f32 v41, v66, v67
  v_cvt_pk_bf16_f32 v42, v68, v69
  v_cvt_pk_bf16_f32 v43, v70, v71
  v_cvt_pk_bf16_f32 v44, v72, v73
  v_cvt_pk_bf16_f32 v45, v74, v75
  v_cvt_pk_bf16_f32 v46, v76, v77
  v_cvt_pk_bf16_f32 v47, v78, v79
  s_add_u32 s25, s31, 0
  buffer_store_dwordx4 v[40:43], v36, s[8:11], s25 offen offset:0 sc1
  buffer_store_dwordx4 v[44:47], v36, s[8:11], s25 offen offset:1024 sc1
  v_cvt_pk_bf16_f32 v48, v80, v81
  v_cvt_pk_bf16_f32 v49, v82, v83
  v_cvt_pk_bf16_f32 v50, v84, v85
  v_cvt_pk_bf16_f32 v51, v86, v87
  v_cvt_pk_bf16_f32 v52, v88, v89
  v_cvt_pk_bf16_f32 v53, v90, v91
  v_cvt_pk_bf16_f32 v54, v92, v93
  v_cvt_pk_bf16_f32 v55, v94, v95
  s_add_u32 s25, s31, 0
  buffer_store_dwordx4 v[48:51], v36, s[8:11], s25 offen offset:2048 sc1
  buffer_store_dwordx4 v[52:55], v36, s[8:11], s25 offen offset:3072 sc1
  v_cvt_pk_bf16_f32 v56, v96, v97
  v_cvt_pk_bf16_f32 v57, v98, v99
  v_cvt_pk_bf16_f32 v58, v100, v101
  v_cvt_pk_bf16_f32 v59, v102, v103
  v_cvt_pk_bf16_f32 v60, v104, v105
  v_cvt_pk_bf16_f32 v61, v106, v107
  v_cvt_pk_bf16_f32 v62, v108, v109
  v_cvt_pk_bf16_f32 v63, v110, v111
  s_add_u32 s25, s31, 4096
  buffer_store_dwordx4 v[56:59], v36, s[8:11], s25 offen offset:0 sc1
  buffer_store_dwordx4 v[60:63], v36, s[8:11], s25 offen offset:1024 sc1
  v_cvt_pk_bf16_f32 v40, v112, v113
  v_cvt_pk_bf16_f32 v41, v114, v115
  v_cvt_pk_bf16_f32 v42, v116, v117
  v_cvt_pk_bf16_f32 v43, v118, v119
  v_cvt_pk_bf16_f32 v44, v120, v121
  v_cvt_pk_bf16_f32 v45, v122, v123
  v_cvt_pk_bf16_f32 v46, v124, v125
  v_cvt_pk_bf16_f32 v47, v126, v127
  s_add_u32 s25, s31, 4096
  buffer_store_dwordx4 v[40:43], v36, s[8:11], s25 offen offset:2048 sc1
  buffer_store_dwordx4 v[44:47], v36, s[8:11], s25 offen offset:3072 sc1
  v_cvt_pk_bf16_f32 v48, v128, v129
  v_cvt_pk_bf16_f32 v49, v130, v131
  v_cvt_pk_bf16_f32 v50, v132, v133
  v_cvt_pk_bf16_f32 v51, v134, v135
  v_cvt_pk_bf16_f32 v52, v136, v137
  v_cvt_pk_bf16_f32 v53, v138, v139
  v_cvt_pk_bf16_f32 v54, v140, v141
  v_cvt_pk_bf16_f32 v55, v142, v143
  s_add_u32 s25, s31, 8192
  buffer_store_dwordx4 v[48:51], v36, s[8:11], s25 offen offset:0 sc1
  buffer_store_dwordx4 v[52:55], v36, s[8:11], s25 offen offset:1024 sc1
  s_cmp_eq_u32 s81, 0
  s_cbranch_scc1 W_sp_8
  v_mbcnt_lo_u32_b32 v3, -1, 0
  v_and_b32 v3, 15, v3
  v_min_u32 v3, 8, v3
  v_and_b32 v4, 1, v3
  v_lshlrev_b32 v3, 2, v3
  v_lshl_add_u32 v3, v4, 7, v3
W_sp_8c:
  buffer_load_dword v2, v3, s[4:7], 0 offen sc1
  s_sub_u32 s82, s82, 1
  s_cbranch_scc1 W_abort
  s_waitcnt vmcnt(0)
  v_readlane_b32 s84, v2, 0
  v_readlane_b32 s85, v2, 1
  v_readlane_b32 s86, v2, 2
  v_readlane_b32 s87, v2, 3
  v_readlane_b32 s88, v2, 4
  v_readlane_b32 s89, v2, 5
  v_readlane_b32 s90, v2, 6
  v_readlane_b32 s91, v2, 7
  v_readlane_b32 s92, v2, 8
  s_cmp_eq_u32 s92, 256
  s_cbranch_scc1 W_sp_8c_ok
  s_sleep 8
  s_branch W_sp_8c
W_sp_8c_ok:
  s_mov_b32 s81, 0
  s_and_b32 s25, s84, s85
  s_and_b32 s25, s25, s86
  s_and_b32 s25, s25, s87
  s_and_b32 s25, s25, s88
  s_and_b32 s25, s25, s89
  s_and_b32 s25, s25, s90
  s_and_b32 s25, s25, s91
  s_cmp_eq_u32 s25, 32
  s_cbranch_scc1 W_sp_8r
  s_waitcnt vmcnt(0) lgkmcnt(0)
  s_barrier
  s_branch M_worker
W_sp_8r:
  s_load_dwordx2 s[84:85], s[0:1], 0
  s_load_dwordx2 s[86:87], s[0:1], 56
  s_waitcnt lgkmcnt(0)
W_sp_8:
  s_cmp_eq_u32 s62, 0
  s_cbranch_scc1 W_fin_7
  s_mov_b32 s53, s36
  s_cmp_eq_u32 s24, 0
  s_cselect_b32 s54, s39, 0
  s_branch W_warm
W_fin_7:
  s_waitcnt vmcnt(0)
  s_barrier
  s_mov_b32 s53, s36
  s_cmp_eq_u32 s24, 0
  s_cselect_b32 s54, s39, 0
  s_cmp_eq_u32 s54, 0
  s_cbranch_scc1 W_pf_9
  v_mov_b32 v2, 1
  v_lshlrev_b32 v3, 2, v1
  s_mov_b32 exec_hi, 0
  s_mov_b32 exec_lo, s54
  buffer_store_dword v2, v3, s[8:11], s53 offen sc1
  s_mov_b64 exec, -1
  s_mov_b32 s54, 0
W_pf_9:
  s_branch W_next
W_bq:
  s_mov_b32 s12, s72
  s_mov_b32 s13, s73
  s_mov_b32 s14, 2457600
  s_mul_i32 s26, s44, 327680
  s_mov_b32 s48, s86
  s_mov_b32 s49, s87
  s_mov_b32 s50, 2621440
  s_mov_b32 s51, 0x20000
  s_mul_i32 s27, s45, 384
  s_mov_b32 s33, 3840
  s_lshl_b32 s36, s44, 4
  s_add_u32 s36, s36, s45
  s_lshl_b32 s36, s36, 2
  s_add_u32 s36, s36, 6307840
  s_lshl_b32 s31, s44, 3
  s_lshl_b32 s25, s24, 1
  s_add_u32 s31, s31, s25
  s_mul_i32 s31, s31, 10
  s_add_u32 s31, s31, s45
  s_mul_i32 s31, s31, 12288
  s_add_u32 s31, s31, 182452224
  s_mov_b32 s35, 122880
  s_mov_b32 s39, 1
  s_mov_b32 s62, 0
  s_mov_b32 s56, s64
  s_mov_b32 s57, s65
  s_mov_b32 s58, 7864320
  s_mov_b32 s59, 0x20000
W_kq:
  v_lshrrev_b32 v4, 3, v1
  s_mul_i32 s25, s24, 64
  v_add_u32 v4, s25, v4
  v_mul_u32_u24 v4, 1280, v4
  v_lshrrev_b32 v5, 4, v1
  v_and_b32 v6, 7, v1
  v_xor_b32 v5, v5, v6
  v_lshl_add_u32 v24, v5, 4, v4
  v_xor_b32 v5, 4, v5
  v_lshl_add_u32 v25, v5, 4, v4
  v_add_u32 v25, 10240, v25
  v_add_u32 v26, 20480, v24
  v_add_u32 v27, 20480, v25
  v_add_u32 v28, 20480, v26
  v_add_u32 v29, 20480, v27
  v_add_u32 v30, 20480, v28
  v_add_u32 v31, 20480, v29
  s_mul_i32 s52, s24, 8192
  s_add_u32 s52, s52, 98304
  s_mul_i32 s25, s24, 384
  s_add_u32 s25, s25, 0
  v_add_u32 v4, s25, v1
  v_mul_u32_u24 v5, 2731, v4
  v_lshrrev_b32 v5, 16, v5
  v_mul_u32_u24 v6, 24, v5
  v_sub_u32 v6, v4, v6
  v_lshlrev_b32 v7, 1, v5
  v_and_b32 v7, 4, v7
  v_xor_b32 v6, v6, v7
  v_mul_lo_u32 v5, v5, s33
  v_lshl_add_u32 v8, v6, 4, v5
  s_mul_i32 s25, s24, 384
  s_add_u32 s25, s25, 64
  v_add_u32 v4, s25, v1
  v_mul_u32_u24 v5, 2731, v4
  v_lshrrev_b32 v5, 16, v5
  v_mul_u32_u24 v6, 24, v5
  v_sub_u32 v6, v4, v6
  v_lshlrev_b32 v7, 1, v5
  v_and_b32 v7, 4, v7
  v_xor_b32 v6, v6, v7
  v_mul_lo_u32 v5, v5, s33
  v_lshl_add_u32 v9, v6, 4, v5
  s_mul_i32 s25, s24, 384
  s_add_u32 s25, s25, 128
  v_add_u32 v4, s25, v1
  v_mul_u32_u24 v5, 2731, v4
  v_lshrrev_b32 v5, 16, v5
  v_mul_u32_u24 v6, 24, v5
  v_sub_u32 v6, v4, v6
  v_lshlrev_b32 v7, 1, v5
  v_and_b32 v7, 4, v7
  v_xor_b32 v6, v6, v7
  v_mul_lo_u32 v5, v5, s33
  v_lshl_add_u32 v10, v6, 4, v5
  s_mul_i32 s25, s24, 384
  s_add_u32 s25, s25, 192
  v_add_u32 v4, s25, v1
  v_mul_u32_u24 v5, 2731, v4
  v_lshrrev_b32 v5, 16, v5
  v_mul_u32_u24 v6, 24, v5
  v_sub_u32 v6, v4, v6
  v_lshlrev_b32 v7, 1, v5
  v_and_b32 v7, 4, v7
  v_xor_b32 v6, v6, v7
  v_mul_lo_u32 v5, v5, s33
  v_lshl_add_u32 v11, v6, 4, v5
  s_mul_i32 s25, s24, 384
  s_add_u32 s25, s25, 256
  v_add_u32 v4, s25, v1
  v_mul_u32_u24 v5, 2731, v4
  v_lshrrev_b32 v5, 16, v5
  v_mul_u32_u24 v6, 24, v5
  v_sub_u32 v6, v4, v6
  v_lshlrev_b32 v7, 1, v5
  v_and_b32 v7, 4, v7
  v_xor_b32 v6, v6, v7
  v_mul_lo_u32 v5, v5, s33
  v_lshl_add_u32 v12, v6, 4, v5
  s_mul_i32 s25, s24, 384
  s_add_u32 s25, s25, 320
  v_add_u32 v4, s25, v1
  v_mul_u32_u24 v5, 2731, v4
  v_lshrrev_b32 v5, 16, v5
  v_mul_u32_u24 v6, 24, v5
  v_sub_u32 v6, v4, v6
  v_lshlrev_b32 v7, 1, v5
  v_and_b32 v7, 4, v7
  v_xor_b32 v6, v6, v7
  v_mul_lo_u32 v5, v5, s33
  v_lshl_add_u32 v13, v6, 4, v5
  s_lshl_b32 s28, s33, 6
  s_mul_i32 s32, s24, 6144
  s_mov_b32 s29, 0
  s_add_u32 m0, s29, s32
  s_nop 0
  buffer_load_dwordx4 v8, s[12:15], s27 offen lds
  s_add_u32 m0, m0, 1024
  s_nop 0
  buffer_load_dwordx4 v9, s[12:15], s27 offen lds
  s_add_u32 m0, m0, 1024
  s_nop 0
  buffer_load_dwordx4 v10, s[12:15], s27 offen lds
  s_add_u32 m0, m0, 1024
  s_nop 0
  buffer_load_dwordx4 v11, s[12:15], s27 offen lds
  s_add_u32 m0, m0, 1024
  s_nop 0
  buffer_load_dwordx4 v12, s[12:15], s27 offen lds
  s_add_u32 m0, m0, 1024
  s_nop 0
  buffer_load_dwordx4 v13, s[12:15], s27 offen lds
  s_add_u32 s27, s27, s28
  s_add_u32 s29, s29, 24576
  s_cmp_eq_u32 s29, 98304
  s_cselect_b32 s29, 0, s29
  s_add_u32 m0, s52, 0
  s_nop 0
  buffer_load_dwordx4 v24, s[48:51], s26 offen lds
  s_add_u32 m0, s52, 1024
  s_nop 0
  buffer_load_dwordx4 v25, s[48:51], s26 offen lds
  s_add_u32 m0, s52, 2048
  s_nop 0
  buffer_load_dwordx4 v26, s[48:51], s26 offen lds
  s_add_u32 m0, s52, 3072
  s_nop 0
  buffer_load_dwordx4 v27, s[48:51], s26 offen lds
  s_add_u32 m0, s52, 4096
  s_nop 0
  buffer_load_dwordx4 v28, s[48:51], s26 offen lds
  s_add_u32 m0, s52, 5120
  s_nop 0
  buffer_load_dwordx4 v29, s[48:51], s26 offen lds
  s_add_u32 m0, s52, 6144
  s_nop 0
  buffer_load_dwordx4 v30, s[48:51], s26 offen lds
  s_add_u32 m0, s52, 7168
  s_nop 0
  buffer_load_dwordx4 v31, s[48:51], s26 offen lds
  s_add_u32 s26, s26, 128
  s_add_u32 m0, s29, s32
  s_nop 0
  buffer_load_dwordx4 v8, s[12:15], s27 offen lds
  s_add_u32 m0, m0, 1024
  s_nop 0
  buffer_load_dwordx4 v9, s[12:15], s27 offen lds
  s_add_u32 m0, m0, 1024
  s_nop 0
  buffer_load_dwordx4 v10, s[12:15], s27 offen lds
  s_add_u32 m0, m0, 1024
  s_nop 0
  buffer_load_dwordx4 v11, s[12:15], s27 offen lds
  s_add_u32 m0, m0, 1024
  s_nop 0
  buffer_load_dwordx4 v12, s[12:15], s27 offen lds
  s_add_u32 m0, m0, 1024
  s_nop 0
  buffer_load_dwordx4 v13, s[12:15], s27 offen lds
  s_add_u32 s27, s27, s28
  s_add_u32 s29, s29, 24576
  s_cmp_eq_u32 s29, 98304
  s_cselect_b32 s29, 0, s29
  s_mul_i32 s25, s24, 64
  v_and_b32 v4, 31, v1
  v_bfe_u32 v5, v1, 1, 3
  v_lshrrev_b32 v6, 5, v1
  v_lshlrev_b32 v6, 2, v6
  v_xor_b32 v5, v5, v6
  v_add_u32 v4, s25, v4
  v_lshlrev_b32 v4, 7, v4
  v_add_u32 v4, 98304, v4
  v_xor_b32 v6, 0, v5
  v_lshl_add_u32 v32, v6, 4, v4
  v_xor_b32 v6, 1, v5
  v_lshl_add_u32 v33, v6, 4, v4
  v_xor_b32 v6, 2, v5
  v_lshl_add_u32 v34, v6, 4, v4
  v_xor_b32 v6, 3, v5
  v_lshl_add_u32 v35, v6, 4, v4
  v_lshrrev_b32 v4, 5, v1
  v_bfe_u32 v5, v1, 2, 2
  v_mul_u32_u24 v4, 32, v4
  v_add_u32 v4, v4, v5
  v_mul_u32_u24 v4, 384, v4
  v_bfe_u32 v6, v1, 4, 1
  v_lshl_add_u32 v4, v6, 5, v4
  v_and_b32 v6, 3, v1
  v_lshl_add_u32 v4, v6, 3, v4
  v_bfe_u32 v5, v1, 3, 1
  v_lshlrev_b32 v5, 6, v5
  v_add_u32 v14, v4, v5
  v_sub_u32 v15, v4, v5
  v_lshlrev_b32 v36, 4, v1
  s_mul_i32 s25, s24, 320
  s_add_u32 s25, s25, 0
  v_add_u32 v4, s25, v1
  v_mul_u32_u24 v5, 3277, v4
  v_lshrrev_b32 v5, 16, v5
  v_mul_u32_u24 v6, 20, v5
  v_sub_u32 v6, v4, v6
  v_mul_u32_u24 v5, 1280, v5
  v_lshl_add_u32 v18, v6, 4, v5
  s_mul_i32 s25, s24, 320
  s_add_u32 s25, s25, 64
  v_add_u32 v4, s25, v1
  v_mul_u32_u24 v5, 3277, v4
  v_lshrrev_b32 v5, 16, v5
  v_mul_u32_u24 v6, 20, v5
  v_sub_u32 v6, v4, v6
  v_mul_u32_u24 v5, 1280, v5
  v_lshl_add_u32 v19, v6, 4, v5
  s_mul_i32 s25, s24, 320
  s_add_u32 s25, s25, 128
  v_add_u32 v4, s25, v1
  v_mul_u32_u24 v5, 3277, v4
  v_lshrrev_b32 v5, 16, v5
  v_mul_u32_u24 v6, 20, v5
  v_sub_u32 v6, v4, v6
  v_mul_u32_u24 v5, 1280, v5
  v_lshl_add_u32 v20, v6, 4, v5
  s_mul_i32 s25, s24, 320
  s_add_u32 s25, s25, 192
  v_add_u32 v4, s25, v1
  v_mul_u32_u24 v5, 3277, v4
  v_lshrrev_b32 v5, 16, v5
  v_mul_u32_u24 v6, 20, v5
  v_sub_u32 v6, v4, v6
  v_mul_u32_u24 v5, 1280, v5
  v_lshl_add_u32 v21, v6, 4, v5
  s_mul_i32 s25, s24, 320
  s_add_u32 s25, s25, 256
  v_add_u32 v4, s25, v1
  v_mul_u32_u24 v5, 3277, v4
  v_lshrrev_b32 v5, 16, v5
  v_mul_u32_u24 v6, 20, v5
  v_sub_u32 v6, v4, v6
  v_mul_u32_u24 v5, 1280, v5
  v_lshl_add_u32 v22, v6, 4, v5
  v_lshrrev_b32 v4, 5, v1
  v_bfe_u32 v5, v1, 2, 2
  v_mul_u32_u24 v4, 4, v4
  v_add_u32 v4, v4, v5
  v_mul_u32_u24 v4, 320, v4
  v_bfe_u32 v6, v1, 4, 1
  v_lshl_add_u32 v4, v6, 5, v4
  v_and_b32 v6, 3, v1
  v_lshl_add_u32 v4, v6, 3, v4
  v_mov_b32 v23, v4
  s_mul_i32 s34, s24, 5120
  s_mov_b32 s54, 0
  s_waitcnt vmcnt(6)
  s_barrier
  v_mov_b32 v16, v14
  v_mov_b32 v17, v15
  s_mov_b32 s30, 0
  ds_read_b128 a[48:51], v32 offset:0
  ds_read_b128 a[52:55], v32 offset:4096
  ds_read_b64_tr_b16 a[0:1], v16 offset:0
  ds_read_b64_tr_b16 a[2:3], v16 offset:1536
  ds_read_b64_tr_b16 a[4:5], v17 offset:64
  ds_read_b64_tr_b16 a[6:7], v17 offset:1600
  ds_read_b64_tr_b16 a[8:9], v16 offset:128
  ds_read_b64_tr_b16 a[10:11], v16 offset:1664
  ds_read_b64_tr_b16 a[12:13], v17 offset:192
  ds_read_b64_tr_b16 a[14:15], v17 offset:1728
  ds_read_b64_tr_b16 a[16:17], v16 offset:256
  ds_read_b64_tr_b16 a[18:19], v16 offset:1792
  ds_read_b64_tr_b16 a[20:21], v17 offset:320
  ds_read_b64_tr_b16 a[22:23], v17 offset:1856
W_kq_warm:
  s_waitcnt lgkmcnt(0)
  v_mfma_f32_32x32x16_bf16 v[64:79], a[0:3], a[48:51], 0
  ds_read_b128 a[56:59], v33 offset:0
  ds_read_b128 a[60:63], v33 offset:4096
  s_add_u32 m0, s52, 32768
  s_nop 0
  buffer_load_dwordx4 v24, s[48:51], s26 offen lds
  v_mfma_f32_32x32x16_bf16 v[160:175], a[0:3], a[52:55], 0
  ds_read_b64_tr_b16 a[24:25], v16 offset:3072
  ds_read_b64_tr_b16 a[26:27], v16 offset:4608
  v_mfma_f32_32x32x16_bf16 v[80:95], a[4:7], a[48:51], 0
  ds_read_b64_tr_b16 a[28:29], v17 offset:3136
  ds_read_b64_tr_b16 a[30:31], v17 offset:4672
  s_add_u32 m0, s52, 33792
  s_nop 0
  buffer_load_dwordx4 v25, s[48:51], s26 offen lds
  v_mfma_f32_32x32x16_bf16 v[176:191], a[4:7], a[52:55], 0
  ds_read_b64_tr_b16 a[32:33], v16 offset:3200
  ds_read_b64_tr_b16 a[34:35], v16 offset:4736
  v_mfma_f32_32x32x16_bf16 v[96:111], a[8:11], a[48:51], 0
  ds_read_b64_tr_b16 a[36:37], v17 offset:3264
  ds_read_b64_tr_b16 a[38:39], v17 offset:4800
  s_add_u32 m0, s52, 34816
  s_nop 0
  buffer_load_dwordx4 v26, s[48:51], s26 offen lds
  v_mfma_f32_32x32x16_bf16 v[192:207], a[8:11], a[52:55], 0
  ds_read_b64_tr_b16 a[40:41], v16 offset:3328
  ds_read_b64_tr_b16 a[42:43], v16 offset:4864
  v_mfma_f32_32x32x16_bf16 v[112:127], a[12:15], a[48:51], 0
  ds_read_b64_tr_b16 a[44:45], v17 offset:3392
  ds_read_b64_tr_b16 a[46:47], v17 offset:4928
  s_add_u32 m0, s52, 35840
  s_nop 0
  buffer_load_dwordx4 v27, s[48:51], s26 offen lds
  v_mfma_f32_32x32x16_bf16 v[208:223], a[12:15], a[52:55], 0
  v_mfma_f32_32x32x16_bf16 v[128:143], a[16:19], a[48:51], 0
  s_add_u32 m0, s52, 36864
  s_nop 0
  buffer_load_dwordx4 v28, s[48:51], s26 offen lds
  v_mfma_f32_32x32x16_bf16 v[224:239], a[16:19], a[52:55], 0
  v_mfma_f32_32x32x16_bf16 v[144:159], a[20:23], a[48:51], 0
  s_add_u32 m0, s52, 37888
  s_nop 0
  buffer_load_dwordx4 v29, s[48:51], s26 offen lds
  v_mfma_f32_32x32x16_bf16 v[240:255], a[20:23], a[52:55], 0
  s_waitcnt lgkmcnt(0)
  v_mfma_f32_32x32x16_bf16 v[64:79], a[24:27], a[56:59], v[64:79]
  ds_read_b128 a[48:51], v34 offset:0
  ds_read_b128 a[52:55], v34 offset:4096
  s_add_u32 m0, s52, 38912
  s_nop 0
  buffer_load_dwordx4 v30, s[48:51], s26 offen lds
  v_mfma_f32_32x32x16_bf16 v[160:175], a[24:27], a[60:63], v[160:175]
  ds_read_b64_tr_b16 a[0:1], v16 offset:6144
  ds_read_b64_tr_b16 a[2:3], v16 offset:7680
  v_mfma_f32_32x32x16_bf16 v[80:95], a[28:31], a[56:59], v[80:95]
  ds_read_b64_tr_b16 a[4:5], v17 offset:6208
  ds_read_b64_tr_b16 a[6:7], v17 offset:7744
  s_add_u32 m0, s52, 39936
  s_nop 0
  buffer_load_dwordx4 v31, s[48:51], s26 offen lds
  s_add_u32 s26, s26, 128
  v_mfma_f32_32x32x16_bf16 v[176:191], a[28:31], a[60:63], v[176:191]
  ds_read_b64_tr_b16 a[8:9], v16 offset:6272
  ds_read_b64_tr_b16 a[10:11], v16 offset:7808
  v_mfma_f32_32x32x16_bf16 v[96:111], a[32:35], a[56:59], v[96:111]
  ds_read_b64_tr_b16 a[12:13], v17 offset:6336
  ds_read_b64_tr_b16 a[14:15], v17 offset:7872
  s_add_u32 m0, s29, s32
  s_nop 0
  buffer_load_dwordx4 v8, s[12:15], s27 offen lds
  v_mfma_f32_32x32x16_bf16 v[192:207], a[32:35], a[60:63], v[192:207]
  ds_read_b64_tr_b16 a[16:17], v16 offset:6400
  ds_read_b64_tr_b16 a[18:19], v16 offset:7936
  v_mfma_f32_32x32x16_bf16 v[112:127], a[36:39], a[56:59], v[112:127]
  ds_read_b64_tr_b16 a[20:21], v17 offset:6464
  ds_read_b64_tr_b16 a[22:23], v17 offset:8000
  v_mfma_f32_32x32x16_bf16 v[208:223], a[36:39], a[60:63], v[208:223]
  v_mfma_f32_32x32x16_bf16 v[128:143], a[40:43], a[56:59], v[128:143]
  v_mfma_f32_32x32x16_bf16 v[224:239], a[40:43], a[60:63], v[224:239]
  s_add_u32 m0, m0, 1024
  s_nop 0
  buffer_load_dwordx4 v9, s[12:15], s27 offen lds
  v_mfma_f32_32x32x16_bf16 v[144:159], a[44:47], a[56:59], v[144:159]
  v_mfma_f32_32x32x16_bf16 v[240:255], a[44:47], a[60:63], v[240:255]
  s_waitcnt lgkmcnt(0)
  v_mfma_f32_32x32x16_bf16 v[64:79], a[0:3], a[48:51], v[64:79]
  ds_read_b128 a[56:59], v35 offset:0
  ds_read_b128 a[60:63], v35 offset:4096
  v_mfma_f32_32x32x16_bf16 v[160:175], a[0:3], a[52:55], v[160:175]
  ds_read_b64_tr_b16 a[24:25], v16 offset:9216
  ds_read_b64_tr_b16 a[26:27], v16 offset:10752
  v_mfma_f32_32x32x16_bf16 v[80:95], a[4:7], a[48:51], v[80:95]
  ds_read_b64_tr_b16 a[28:29], v17 offset:9280
  ds_read_b64_tr_b16 a[30:31], v17 offset:10816
  s_add_u32 m0, m0, 1024
  s_nop 0
  buffer_load_dwordx4 v10, s[12:15], s27 offen lds
  v_mfma_f32_32x32x16_bf16 v[176:191], a[4:7], a[52:55], v[176:191]
  ds_read_b64_tr_b16 a[32:33], v16 offset:9344
  ds_read_b64_tr_b16 a[34:35], v16 offset:10880
  v_mfma_f32_32x32x16_bf16 v[96:111], a[8:11], a[48:51], v[96:111]
  ds_read_b64_tr_b16 a[36:37], v17 offset:9408
  ds_read_b64_tr_b16 a[38:39], v17 offset:10944
  v_mfma_f32_32x32x16_bf16 v[192:207], a[8:11], a[52:55], v[192:207]
  ds_read_b64_tr_b16 a[40:41], v16 offset:9472
  ds_read_b64_tr_b16 a[42:43], v16 offset:11008
  v_mfma_f32_32x32x16_bf16 v[112:127], a[12:15], a[48:51], v[112:127]
  ds_read_b64_tr_b16 a[44:45], v17 offset:9536
  ds_read_b64_tr_b16 a[46:47], v17 offset:11072
  v_mfma_f32_32x32x16_bf16 v[208:223], a[12:15], a[52:55], v[208:223]
  s_add_u32 m0, m0, 1024
  s_nop 0
  buffer_load_dwordx4 v11, s[12:15], s27 offen lds
  v_mfma_f32_32x32x16_bf16 v[128:143], a[16:19], a[48:51], v[128:143]
  v_mfma_f32_32x32x16_bf16 v[224:239], a[16:19], a[52:55], v[224:239]
  v_mfma_f32_32x32x16_bf16 v[144:159], a[20:23], a[48:51], v[144:159]
  v_mfma_f32_32x32x16_bf16 v[240:255], a[20:23], a[52:55], v[240:255]
  s_waitcnt vmcnt(4) lgkmcnt(0)
  s_barrier
  s_add_u32 s30, s30, 24576
  s_cmp_eq_u32 s30, 98304
  s_cselect_b32 s30, 0, s30
  v_add_u32 v16, s30, v14
  v_add_u32 v17, s30, v15
  s_cmp_eq_u32 s54, 0
  s_cbranch_scc1 W_pf_30
  v_mov_b32 v2, 1
  v_lshlrev_b32 v3, 2, v1
  s_mov_b32 exec_hi, 0
  s_mov_b32 exec_lo, s54
  buffer_store_dword v2, v3, s[8:11], s53 offen sc1
  s_mov_b64 exec, -1
  s_mov_b32 s54, 0
W_pf_30:
  s_add_u32 s25, s79, 4
  s_load_dword s55, s[76:77], s25
  v_mfma_f32_32x32x16_bf16 v[64:79], a[24:27], a[56:59], v[64:79]
  ds_read_b128 a[48:51], v32 offset:32768
  ds_read_b128 a[52:55], v32 offset:36864
  s_add_u32 m0, m0, 1024
  s_nop 0
  buffer_load_dwordx4 v12, s[12:15], s27 offen lds
  v_mfma_f32_32x32x16_bf16 v[160:175], a[24:27], a[60:63], v[160:175]
  ds_read_b64_tr_b16 a[0:1], v16 offset:0
  ds_read_b64_tr_b16 a[2:3], v16 offset:1536
  v_mfma_f32_32x32x16_bf16 v[80:95], a[28:31], a[56:59], v[80:95]
  ds_read_b64_tr_b16 a[4:5], v17 offset:64
  ds_read_b64_tr_b16 a[6:7], v17 offset:1600
  v_mfma_f32_32x32x16_bf16 v[176:191], a[28:31], a[60:63], v[176:191]
  ds_read_b64_tr_b16 a[8:9], v16 offset:128
  ds_read_b64_tr_b16 a[10:11], v16 offset:1664
  v_mfma_f32_32x32x16_bf16 v[96:111], a[32:35], a[56:59], v[96:111]
  ds_read_b64_tr_b16 a[12:13], v17 offset:192
  ds_read_b64_tr_b16 a[14:15], v17 offset:1728
  v_mfma_f32_32x32x16_bf16 v[192:207], a[32:35], a[60:63], v[192:207]
  ds_read_b64_tr_b16 a[16:17], v16 offset:256
  ds_read_b64_tr_b16 a[18:19], v16 offset:1792
  s_add_u32 m0, m0, 1024
  s_nop 0
  buffer_load_dwordx4 v13, s[12:15], s27 offen lds
  s_add_u32 s27, s27, s28
  s_add_u32 s29, s29, 24576
  s_cmp_eq_u32 s29, 98304
  s_cselect_b32 s29, 0, s29
  v_mfma_f32_32x32x16_bf16 v[112:127], a[36:39], a[56:59], v[112:127]
  ds_read_b64_tr_b16 a[20:21], v17 offset:320
  ds_read_b64_tr_b16 a[22:23], v17 offset:1856
  v_mfma_f32_32x32x16_bf16 v[208:223], a[36:39], a[60:63], v[208:223]
  v_mfma_f32_32x32x16_bf16 v[128:143], a[40:43], a[56:59], v[128:143]
  v_mfma_f32_32x32x16_bf16 v[224:239], a[40:43], a[60:63], v[224:239]
  v_mfma_f32_32x32x16_bf16 v[144:159], a[44:47], a[56:59], v[144:159]
  v_mfma_f32_32x32x16_bf16 v[240:255], a[44:47], a[60:63], v[240:255]
  s_waitcnt lgkmcnt(0)
  v_mfma_f32_32x32x16_bf16 v[64:79], a[0:3], a[48:51], v[64:79]
  ds_read_b128 a[56:59], v33 offset:32768
  ds_read_b128 a[60:63], v33 offset:36864
  s_add_u32 m0, s52, 0
  s_nop 0
  buffer_load_dwordx4 v24, s[48:51], s26 offen lds
  v_mfma_f32_32x32x16_bf16 v[160:175], a[0:3], a[52:55], v[160:175]
  ds_read_b64_tr_b16 a[24:25], v16 offset:3072
  ds_read_b64_tr_b16 a[26:27], v16 offset:4608
  v_mfma_f32_32x32x16_bf16 v[80:95], a[4:7], a[48:51], v[80:95]
  ds_read_b64_tr_b16 a[28:29], v17 offset:3136
  ds_read_b64_tr_b16 a[30:31], v17 offset:4672
  s_add_u32 m0, s52, 1024
  s_nop 0
  buffer_load_dwordx4 v25, s[48:51], s26 offen lds
  v_mfma_f32_32x32x16_bf16 v[176:191], a[4:7], a[52:55], v[176:191]
  ds_read_b64_tr_b16 a[32:33], v16 offset:3200
  ds_read_b64_tr_b16 a[34:35], v16 offset:4736
  v_mfma_f32_32x32x16_bf16 v[96:111], a[8:11], a[48:51], v[96:111]
  ds_read_b64_tr_b16 a[36:37], v17 offset:3264
  ds_read_b64_tr_b16 a[38:39], v17 offset:4800
  s_add_u32 m0, s52, 2048
  s_nop 0
  buffer_load_dwordx4 v26, s[48:51], s26 offen lds
  v_mfma_f32_32x32x16_bf16 v[192:207], a[8:11], a[52:55], v[192:207]
  ds_read_b64_tr_b16 a[40:41], v16 offset:3328
  ds_read_b64_tr_b16 a[42:43], v16 offset:4864
  v_mfma_f32_32x32x16_bf16 v[112:127], a[12:15], a[48:51], v[112:127]
  ds_read_b64_tr_b16 a[44:45], v17 offset:3392
  ds_read_b64_tr_b16 a[46:47], v17 offset:4928
  s_add_u32 m0, s52, 3072
  s_nop 0
  buffer_load_dwordx4 v27, s[48:51], s26 offen lds
  v_mfma_f32_32x32x16_bf16 v[208:223], a[12:15], a[52:55], v[208:223]
  v_mfma_f32_32x32x16_bf16 v[128:143], a[16:19], a[48:51], v[128:143]
  s_add_u32 m0, s52, 4096
  s_nop 0
  buffer_load_dwordx4 v28, s[48:51], s26 offen lds
  v_mfma_f32_32x32x16_bf16 v[224:239], a[16:19], a[52:55], v[224:239]
  v_mfma_f32_32x32x16_bf16 v[144:159], a[20:23], a[48:51], v[144:159]
  s_add_u32 m0, s52, 5120
  s_nop 0
  buffer_load_dwordx4 v29, s[48:51], s26 offen lds
  v_mfma_f32_32x32x16_bf16 v[240:255], a[20:23], a[52:55], v[240:255]
  s_waitcnt lgkmcnt(0)
  v_mfma_f32_32x32x16_bf16 v[64:79], a[24:27], a[56:59], v[64:79]
  ds_read_b128 a[48:51], v34 offset:32768
  ds_read_b128 a[52:55], v34 offset:36864
  s_add_u32 m0, s52, 6144
  s_nop 0
  buffer_load_dwordx4 v30, s[48:51], s26 offen lds
  v_mfma_f32_32x32x16_bf16 v[160:175], a[24:27], a[60:63], v[160:175]
  ds_read_b64_tr_b16 a[0:1], v16 offset:6144
  ds_read_b64_tr_b16 a[2:3], v16 offset:7680
  v_mfma_f32_32x32x16_bf16 v[80:95], a[28:31], a[56:59], v[80:95]
  ds_read_b64_tr_b16 a[4:5], v17 offset:6208
  ds_read_b64_tr_b16 a[6:7], v17 offset:7744
  s_add_u32 m0, s52, 7168
  s_nop 0
  buffer_load_dwordx4 v31, s[48:51], s26 offen lds
  s_add_u32 s26, s26, 128
  v_mfma_f32_32x32x16_bf16 v[176:191], a[28:31], a[60:63], v[176:191]
  ds_read_b64_tr_b16 a[8:9], v16 offset:6272
  ds_read_b64_tr_b16 a[10:11], v16 offset:7808
  v_mfma_f32_32x32x16_bf16 v[96:111], a[32:35], a[56:59], v[96:111]
  ds_read_b64_tr_b16 a[12:13], v17 offset:6336
  ds_read_b64_tr_b16 a[14:15], v17 offset:7872
  s_add_u32 m0, s29, s32
  s_nop 0
  buffer_load_dwordx4 v8, s[12:15], s27 offen lds
  v_mfma_f32_32x32x16_bf16 v[192:207], a[32:35], a[60:63], v[192:207]
  ds_read_b64_tr_b16 a[16:17], v16 offset:6400
  ds_read_b64_tr_b16 a[18:19], v16 offset:7936
  v_mfma_f32_32x32x16_bf16 v[112:127], a[36:39], a[56:59], v[112:127]
  ds_read_b64_tr_b16 a[20:21], v17 offset:6464
  ds_read_b64_tr_b16 a[22:23], v17 offset:8000
  v_mfma_f32_32x32x16_bf16 v[208:223], a[36:39], a[60:63], v[208:223]
  v_mfma_f32_32x32x16_bf16 v[128:143], a[40:43], a[56:59], v[128:143]
  v_mfma_f32_32x32x16_bf16 v[224:239], a[40:43], a[60:63], v[224:239]
  s_add_u32 m0, m0, 1024
  s_nop 0
  buffer_load_dwordx4 v9, s[12:15], s27 offen lds
  v_mfma_f32_32x32x16_bf16 v[144:159], a[44:47], a[56:59], v[144:159]
  v_mfma_f32_32x32x16_bf16 v[240:255], a[44:47], a[60:63], v[240:255]
  s_waitcnt lgkmcnt(0)
  v_mfma_f32_32x32x16_bf16 v[64:79], a[0:3], a[48:51], v[64:79]
  ds_read_b128 a[56:59], v35 offset:32768
  ds_read_b128 a[60:63], v35 offset:36864
  v_mfma_f32_32x32x16_bf16 v[160:175], a[0:3], a[52:55], v[160:175]
  ds_read_b64_tr_b16 a[24:25], v16 offset:9216
  ds_read_b64_tr_b16 a[26:27], v16 offset:10752
  v_mfma_f32_32x32x16_bf16 v[80:95], a[4:7], a[48:51], v[80:95]
  ds_read_b64_tr_b16 a[28:29], v17 offset:9280
  ds_read_b64_tr_b16 a[30:31], v17 offset:10816
  s_add_u32 m0, m0, 1024
  s_nop 0
  buffer_load_dwordx4 v10, s[12:15], s27 offen lds
  v_mfma_f32_32x32x16_bf16 v[176:191], a[4:7], a[52:55], v[176:191]
  ds_read_b64_tr_b16 a[32:33], v16 offset:9344
  ds_read_b64_tr_b16 a[34:35], v16 offset:10880
  v_mfma_f32_32x32x16_bf16 v[96:111], a[8:11], a[48:51], v[96:111]
  ds_read_b64_tr_b16 a[36:37], v17 offset:9408
  ds_read_b64_tr_b16 a[38:39], v17 offset:10944
  v_mfma_f32_32x32x16_bf16 v[192:207], a[8:11], a[52:55], v[192:207]
  ds_read_b64_tr_b16 a[40:41], v16 offset:9472
  ds_read_b64_tr_b16 a[42:43], v16 offset:11008
  v_mfma_f32_32x32x16_bf16 v[112:127], a[12:15], a[48:51], v[112:127]
  ds_read_b64_tr_b16 a[44:45], v17 offset:9536
  ds_read_b64_tr_b16 a[46:47], v17 offset:11072
  v_mfma_f32_32x32x16_bf16 v[208:223], a[12:15], a[52:55], v[208:223]
  s_add_u32 m0, m0, 1024
  s_nop 0
  buffer_load_dwordx4 v11, s[12:15], s27 offen lds
  v_mfma_f32_32x32x16_bf16 v[128:143], a[16:19], a[48:51], v[128:143]
  v_mfma_f32_32x32x16_bf16 v[224:239], a[16:19], a[52:55], v[224:239]
  v_mfma_f32_32x32x16_bf16 v[144:159], a[20:23], a[48:51], v[144:159]
  v_mfma_f32_32x32x16_bf16 v[240:255], a[20:23], a[52:55], v[240:255]
  s_waitcnt vmcnt(4) lgkmcnt(0)
  s_barrier
  s_add_u32 s30, s30, 24576
  s_cmp_eq_u32 s30, 98304
  s_cselect_b32 s30, 0, s30
  v_add_u32 v16, s30, v14
  v_add_u32 v17, s30, v15
  v_mfma_f32_32x32x16_bf16 v[64:79], a[24:27], a[56:59], v[64:79]
  ds_read_b128 a[48:51], v32 offset:0
  ds_read_b128 a[52:55], v32 offset:4096
  s_add_u32 m0, m0, 1024
  s_nop 0
  buffer_load_dwordx4 v12, s[12:15], s27 offen lds
  v_mfma_f32_32x32x16_bf16 v[160:175], a[24:27], a[60:63], v[160:175]
  ds_read_b64_tr_b16 a[0:1], v16 offset:0
  ds_read_b64_tr_b16 a[2:3], v16 offset:1536
  v_mfma_f32_32x32x16_bf16 v[80:95], a[28:31], a[56:59], v[80:95]
  ds_read_b64_tr_b16 a[4:5], v17 offset:64
  ds_read_b64_tr_b16 a[6:7], v17 offset:1600
  v_mfma_f32_32x32x16_bf16 v[176:191], a[28:31], a[60:63], v[176:191]
  ds_read_b64_tr_b16 a[8:9], v16 offset:128
  ds_read_b64_tr_b16 a[10:11], v16 offset:1664
  v_mfma_f32_32x32x16_bf16 v[96:111], a[32:35], a[56:59], v[96:111]
  ds_read_b64_tr_b16 a[12:13], v17 offset:192
  ds_read_b64_tr_b16 a[14:15], v17 offset:1728
  v_mfma_f32_32x32x16_bf16 v[192:207], a[32:35], a[60:63], v[192:207]
  ds_read_b64_tr_b16 a[16:17], v16 offset:256
  ds_read_b64_tr_b16 a[18:19], v16 offset:1792
  s_add_u32 m0, m0, 1024
  s_nop 0
  buffer_load_dwordx4 v13, s[12:15], s27 offen lds
  s_add_u32 s27, s27, s28
  s_add_u32 s29, s29, 24576
  s_cmp_eq_u32 s29, 98304
  s_cselect_b32 s29, 0, s29
  v_mfma_f32_32x32x16_bf16 v[112:127], a[36:39], a[56:59], v[112:127]
  ds_read_b64_tr_b16 a[20:21], v17 offset:320
  ds_read_b64_tr_b16 a[22:23], v17 offset:1856
  v_mfma_f32_32x32x16_bf16 v[208:223], a[36:39], a[60:63], v[208:223]
  v_mfma_f32_32x32x16_bf16 v[128:143], a[40:43], a[56:59], v[128:143]
  v_mfma_f32_32x32x16_bf16 v[224:239], a[40:43], a[60:63], v[224:239]
  v_mfma_f32_32x32x16_bf16 v[144:159], a[44:47], a[56:59], v[144:159]
  v_mfma_f32_32x32x16_bf16 v[240:255], a[44:47], a[60:63], v[240:255]
  s_waitcnt lgkmcnt(0)
  v_mfma_f32_32x32x16_bf16 v[64:79], a[0:3], a[48:51], v[64:79]
  ds_read_b128 a[56:59], v33 offset:0
  ds_read_b128 a[60:63], v33 offset:4096
  s_add_u32 m0, s52, 32768
  s_nop 0
  buffer_load_dwordx4 v24, s[48:51], s26 offen lds
  v_mfma_f32_32x32x16_bf16 v[160:175], a[0:3], a[52:55], v[160:175]
  ds_read_b64_tr_b16 a[24:25], v16 offset:3072
  ds_read_b64_tr_b16 a[26:27], v16 offset:4608
  v_mfma_f32_32x32x16_bf16 v[80:95], a[4:7], a[48:51], v[80:95]
  ds_read_b64_tr_b16 a[28:29], v17 offset:3136
  ds_read_b64_tr_b16 a[30:31], v17 offset:4672
  s_add_u32 m0, s52, 33792
  s_nop 0
  buffer_load_dwordx4 v25, s[48:51], s26 offen lds
  v_mfma_f32_32x32x16_bf16 v[176:191], a[4:7], a[52:55], v[176:191]
  ds_read_b64_tr_b16 a[32:33], v16 offset:3200
  ds_read_b64_tr_b16 a[34:35], v16 offset:4736
  v_mfma_f32_32x32x16_bf16 v[96:111], a[8:11], a[48:51], v[96:111]
  ds_read_b64_tr_b16 a[36:37], v17 offset:3264
  ds_read_b64_tr_b16 a[38:39], v17 offset:4800
  s_add_u32 m0, s52, 34816
  s_nop 0
  buffer_load_dwordx4 v26, s[48:51], s26 offen lds
  v_mfma_f32_32x32x16_bf16 v[192:207], a[8:11], a[52:55], v[192:207]
  ds_read_b64_tr_b16 a[40:41], v16 offset:3328
  ds_read_b64_tr_b16 a[42:43], v16 offset:4864
  v_mfma_f32_32x32x16_bf16 v[112:127], a[12:15], a[48:51], v[112:127]
  ds_read_b64_tr_b16 a[44:45], v17 offset:3392
  ds_read_b64_tr_b16 a[46:47], v17 offset:4928
  s_add_u32 m0, s52, 35840
  s_nop 0
  buffer_load_dwordx4 v27, s[48:51], s26 offen lds
  v_mfma_f32_32x32x16_bf16 v[208:223], a[12:15], a[52:55], v[208:223]
  v_mfma_f32_32x32x16_bf16 v[128:143], a[16:19], a[48:51], v[128:143]
  s_add_u32 m0, s52, 36864
  s_nop 0
  buffer_load_dwordx4 v28, s[48:51], s26 offen lds
  v_mfma_f32_32x32x16_bf16 v[224:239], a[16:19], a[52:55], v[224:239]
  v_mfma_f32_32x32x16_bf16 v[144:159], a[20:23], a[48:51], v[144:159]
  s_add_u32 m0, s52, 37888
  s_nop 0
  buffer_load_dwordx4 v29, s[48:51], s26 offen lds
  v_mfma_f32_32x32x16_bf16 v[240:255], a[20:23], a[52:55], v[240:255]
  s_waitcnt lgkmcnt(0)
  v_mfma_f32_32x32x16_bf16 v[64:79], a[24:27], a[56:59], v[64:79]
  ds_read_b128 a[48:51], v34 offset:0
  ds_read_b128 a[52:55], v34 offset:4096
  s_add_u32 m0, s52, 38912
  s_nop 0
  buffer_load_dwordx4 v30, s[48:51], s26 offen lds
  v_mfma_f32_32x32x16_bf16 v[160:175], a[24:27], a[60:63], v[160:175]
  ds_read_b64_tr_b16 a[0:1], v16 offset:6144
  ds_read_b64_tr_b16 a[2:3], v16 offset:7680
  v_mfma_f32_32x32x16_bf16 v[80:95], a[28:31], a[56:59], v[80:95]
  ds_read_b64_tr_b16 a[4:5], v17 offset:6208
  ds_read_b64_tr_b16 a[6:7], v17 offset:7744
  s_add_u32 m0, s52, 39936
  s_nop 0
  buffer_load_dwordx4 v31, s[48:51], s26 offen lds
  s_add_u32 s26, s26, 128
  v_mfma_f32_32x32x16_bf16 v[176:191], a[28:31], a[60:63], v[176:191]
  ds_read_b64_tr_b16 a[8:9], v16 offset:6272
  ds_read_b64_tr_b16 a[10:11], v16 offset:7808
  v_mfma_f32_32x32x16_bf16 v[96:111], a[32:35], a[56:59], v[96:111]
  ds_read_b64_tr_b16 a[12:13], v17 offset:6336
  ds_read_b64_tr_b16 a[14:15], v17 offset:7872
  s_add_u32 m0, s29, s32
  s_nop 0
  buffer_load_dwordx4 v8, s[12:15], s27 offen lds
  v_mfma_f32_32x32x16_bf16 v[192:207], a[32:35], a[60:63], v[192:207]
  ds_read_b64_tr_b16 a[16:17], v16 offset:6400
  ds_read_b64_tr_b16 a[18:19], v16 offset:7936
  v_mfma_f32_32x32x16_bf16 v[112:127], a[36:39], a[56:59], v[112:127]
  ds_read_b64_tr_b16 a[20:21], v17 offset:6464
  ds_read_b64_tr_b16 a[22:23], v17 offset:8000
  v_mfma_f32_32x32x16_bf16 v[208:223], a[36:39], a[60:63], v[208:223]
  v_mfma_f32_32x32x16_bf16 v[128:143], a[40:43], a[56:59], v[128:143]
  v_mfma_f32_32x32x16_bf16 v[224:239], a[40:43], a[60:63], v[224:239]
  s_add_u32 m0, m0, 1024
  s_nop 0
  buffer_load_dwordx4 v9, s[12:15], s27 offen lds
  v_mfma_f32_32x32x16_bf16 v[144:159], a[44:47], a[56:59], v[144:159]
  v_mfma_f32_32x32x16_bf16 v[240:255], a[44:47], a[60:63], v[240:255]
  s_waitcnt lgkmcnt(0)
  v_mfma_f32_32x32x16_bf16 v[64:79], a[0:3], a[48:51], v[64:79]
  ds_read_b128 a[56:59], v35 offset:0
  ds_read_b128 a[60:63], v35 offset:4096
  v_mfma_f32_32x32x16_bf16 v[160:175], a[0:3], a[52:55], v[160:175]
  ds_read_b64_tr_b16 a[24:25], v16 offset:9216
  ds_read_b64_tr_b16 a[26:27], v16 offset:10752
  v_mfma_f32_32x32x16_bf16 v[80:95], a[4:7], a[48:51], v[80:95]
  ds_read_b64_tr_b16 a[28:29], v17 offset:9280
  ds_read_b64_tr_b16 a[30:31], v17 offset:10816
  s_add_u32 m0, m0, 1024
  s_nop 0
  buffer_load_dwordx4 v10, s[12:15], s27 offen lds
  v_mfma_f32_32x32x16_bf16 v[176:191], a[4:7], a[52:55], v[176:191]
  ds_read_b64_tr_b16 a[32:33], v16 offset:9344
  ds_read_b64_tr_b16 a[34:35], v16 offset:10880
  v_mfma_f32_32x32x16_bf16 v[96:111], a[8:11], a[48:51], v[96:111]
  ds_read_b64_tr_b16 a[36:37], v17 offset:9408
  ds_read_b64_tr_b16 a[38:39], v17 offset:10944
  v_mfma_f32_32x32x16_bf16 v[192:207], a[8:11], a[52:55], v[192:207]
  ds_read_b64_tr_b16 a[40:41], v16 offset:9472
  ds_read_b64_tr_b16 a[42:43], v16 offset:11008
  v_mfma_f32_32x32x16_bf16 v[112:127], a[12:15], a[48:51], v[112:127]
  ds_read_b64_tr_b16 a[44:45], v17 offset:9536
  ds_read_b64_tr_b16 a[46:47], v17 offset:11072
  v_mfma_f32_32x32x16_bf16 v[208:223], a[12:15], a[52:55], v[208:223]
  s_add_u32 m0, m0, 1024
  s_nop 0
  buffer_load_dwordx4 v11, s[12:15], s27 offen lds
  v_mfma_f32_32x32x16_bf16 v[128:143], a[16:19], a[48:51], v[128:143]
  v_mfma_f32_32x32x16_bf16 v[224:239], a[16:19], a[52:55], v[224:239]
  v_mfma_f32_32x32x16_bf16 v[144:159], a[20:23], a[48:51], v[144:159]
  v_mfma_f32_32x32x16_bf16 v[240:255], a[20:23], a[52:55], v[240:255]
  s_waitcnt vmcnt(4) lgkmcnt(0)
  s_barrier
  s_add_u32 s30, s30, 24576
  s_cmp_eq_u32 s30, 98304
  s_cselect_b32 s30, 0, s30
  v_add_u32 v16, s30, v14
  v_add_u32 v17, s30, v15
  v_mfma_f32_32x32x16_bf16 v[64:79], a[24:27], a[56:59], v[64:79]
  ds_read_b128 a[48:51], v32 offset:32768
  ds_read_b128 a[52:55], v32 offset:36864
  s_add_u32 m0, m0, 1024
  s_nop 0
  buffer_load_dwordx4 v12, s[12:15], s27 offen lds
  v_mfma_f32_32x32x16_bf16 v[160:175], a[24:27], a[60:63], v[160:175]
  ds_read_b64_tr_b16 a[0:1], v16 offset:0
  ds_read_b64_tr_b16 a[2:3], v16 offset:1536
  v_mfma_f32_32x32x16_bf16 v[80:95], a[28:31], a[56:59], v[80:95]
  ds_read_b64_tr_b16 a[4:5], v17 offset:64
  ds_read_b64_tr_b16 a[6:7], v17 offset:1600
  v_mfma_f32_32x32x16_bf16 v[176:191], a[28:31], a[60:63], v[176:191]
  ds_read_b64_tr_b16 a[8:9], v16 offset:128
  ds_read_b64_tr_b16 a[10:11], v16 offset:1664
  v_mfma_f32_32x32x16_bf16 v[96:111], a[32:35], a[56:59], v[96:111]
  ds_read_b64_tr_b16 a[12:13], v17 offset:192
  ds_read_b64_tr_b16 a[14:15], v17 offset:1728
  v_mfma_f32_32x32x16_bf16 v[192:207], a[32:35], a[60:63], v[192:207]
  ds_read_b64_tr_b16 a[16:17], v16 offset:256
  ds_read_b64_tr_b16 a[18:19], v16 offset:1792
  s_add_u32 m0, m0, 1024
  s_nop 0
  buffer_load_dwordx4 v13, s[12:15], s27 offen lds
  s_add_u32 s27, s27, s28
  s_add_u32 s29, s29, 24576
  s_cmp_eq_u32 s29, 98304
  s_cselect_b32 s29, 0, s29
  v_mfma_f32_32x32x16_bf16 v[112:127], a[36:39], a[56:59], v[112:127]
  ds_read_b64_tr_b16 a[20:21], v17 offset:320
  ds_read_b64_tr_b16 a[22:23], v17 offset:1856
  v_mfma_f32_32x32x16_bf16 v[208:223], a[36:39], a[60:63], v[208:223]
  v_mfma_f32_32x32x16_bf16 v[128:143], a[40:43], a[56:59], v[128:143]
  v_mfma_f32_32x32x16_bf16 v[224:239], a[40:43], a[60:63], v[224:239]
  v_mfma_f32_32x32x16_bf16 v[144:159], a[44:47], a[56:59], v[144:159]
  v_mfma_f32_32x32x16_bf16 v[240:255], a[44:47], a[60:63], v[240:255]
  s_waitcnt lgkmcnt(0)
  v_mfma_f32_32x32x16_bf16 v[64:79], a[0:3], a[48:51], v[64:79]
  ds_read_b128 a[56:59], v33 offset:32768
  ds_read_b128 a[60:63], v33 offset:36864
  s_add_u32 m0, s52, 0
  s_nop 0
  buffer_load_dwordx4 v24, s[48:51], s26 offen lds
  v_mfma_f32_32x32x16_bf16 v[160:175], a[0:3], a[52:55], v[160:175]
  ds_read_b64_tr_b16 a[24:25], v16 offset:3072
  ds_read_b64_tr_b16 a[26:27], v16 offset:4608
  v_mfma_f32_32x32x16_bf16 v[80:95], a[4:7], a[48:51], v[80:95]
  ds_read_b64_tr_b16 a[28:29], v17 offset:3136
  ds_read_b64_tr_b16 a[30:31], v17 offset:4672
  s_add_u32 m0, s52, 1024
  s_nop 0
  buffer_load_dwordx4 v25, s[48:51], s26 offen lds
  v_mfma_f32_32x32x16_bf16 v[176:191], a[4:7], a[52:55], v[176:191]
  ds_read_b64_tr_b16 a[32:33], v16 offset:3200
  ds_read_b64_tr_b16 a[34:35], v16 offset:4736
  v_mfma_f32_32x32x16_bf16 v[96:111], a[8:11], a[48:51], v[96:111]
  ds_read_b64_tr_b16 a[36:37], v17 offset:3264
  ds_read_b64_tr_b16 a[38:39], v17 offset:4800
  s_add_u32 m0, s52, 2048
  s_nop 0
  buffer_load_dwordx4 v26, s[48:51], s26 offen lds
  v_mfma_f32_32x32x16_bf16 v[192:207], a[8:11], a[52:55], v[192:207]
  ds_read_b64_tr_b16 a[40:41], v16 offset:3328
  ds_read_b64_tr_b16 a[42:43], v16 offset:4864
  v_mfma_f32_32x32x16_bf16 v[112:127], a[12:15], a[48:51], v[112:127]
  ds_read_b64_tr_b16 a[44:45], v17 offset:3392
  ds_read_b64_tr_b16 a[46:47], v17 offset:4928
  s_add_u32 m0, s52, 3072
  s_nop 0
  buffer_load_dwordx4 v27, s[48:51], s26 offen lds
  v_mfma_f32_32x32x16_bf16 v[208:223], a[12:15], a[52:55], v[208:223]
  v_mfma_f32_32x32x16_bf16 v[128:143], a[16:19], a[48:51], v[128:143]
  s_add_u32 m0, s52, 4096
  s_nop 0
  buffer_load_dwordx4 v28, s[48:51], s26 offen lds
  v_mfma_f32_32x32x16_bf16 v[224:239], a[16:19], a[52:55], v[224:239]
  v_mfma_f32_32x32x16_bf16 v[144:159], a[20:23], a[48:51], v[144:159]
  s_add_u32 m0, s52, 5120
  s_nop 0
  buffer_load_dwordx4 v29, s[48:51], s26 offen lds
  v_mfma_f32_32x32x16_bf16 v[240:255], a[20:23], a[52:55], v[240:255]
  s_waitcnt lgkmcnt(0)
  v_mfma_f32_32x32x16_bf16 v[64:79], a[24:27], a[56:59], v[64:79]
  ds_read_b128 a[48:51], v34 offset:32768
  ds_read_b128 a[52:55], v34 offset:36864
  s_add_u32 m0, s52, 6144
  s_nop 0
  buffer_load_dwordx4 v30, s[48:51], s26 offen lds
  v_mfma_f32_32x32x16_bf16 v[160:175], a[24:27], a[60:63], v[160:175]
  ds_read_b64_tr_b16 a[0:1], v16 offset:6144
  ds_read_b64_tr_b16 a[2:3], v16 offset:7680
  v_mfma_f32_32x32x16_bf16 v[80:95], a[28:31], a[56:59], v[80:95]
  ds_read_b64_tr_b16 a[4:5], v17 offset:6208
  ds_read_b64_tr_b16 a[6:7], v17 offset:7744
  s_add_u32 m0, s52, 7168
  s_nop 0
  buffer_load_dwordx4 v31, s[48:51], s26 offen lds
  s_add_u32 s26, s26, 128
  v_mfma_f32_32x32x16_bf16 v[176:191], a[28:31], a[60:63], v[176:191]
  ds_read_b64_tr_b16 a[8:9], v16 offset:6272
  ds_read_b64_tr_b16 a[10:11], v16 offset:7808
  v_mfma_f32_32x32x16_bf16 v[96:111], a[32:35], a[56:59], v[96:111]
  ds_read_b64_tr_b16 a[12:13], v17 offset:6336
  ds_read_b64_tr_b16 a[14:15], v17 offset:7872
  s_add_u32 m0, s29, s32
  s_nop 0
  buffer_load_dwordx4 v8, s[12:15], s27 offen lds
  v_mfma_f32_32x32x16_bf16 v[192:207], a[32:35], a[60:63], v[192:207]
  ds_read_b64_tr_b16 a[16:17], v16 offset:6400
  ds_read_b64_tr_b16 a[18:19], v16 offset:7936
  v_mfma_f32_32x32x16_bf16 v[112:127], a[36:39], a[56:59], v[112:127]
  ds_read_b64_tr_b16 a[20:21], v17 offset:6464
  ds_read_b64_tr_b16 a[22:23], v17 offset:8000
  v_mfma_f32_32x32x16_bf16 v[208:223], a[36:39], a[60:63], v[208:223]
  v_mfma_f32_32x32x16_bf16 v[128:143], a[40:43], a[56:59], v[128:143]
  v_mfma_f32_32x32x16_bf16 v[224:239], a[40:43], a[60:63], v[224:239]
  s_add_u32 m0, m0, 1024
  s_nop 0
  buffer_load_dwordx4 v9, s[12:15], s27 offen lds
  v_mfma_f32_32x32x16_bf16 v[144:159], a[44:47], a[56:59], v[144:159]
  v_mfma_f32_32x32x16_bf16 v[240:255], a[44:47], a[60:63], v[240:255]
  s_waitcnt lgkmcnt(0)
  v_mfma_f32_32x32x16_bf16 v[64:79], a[0:3], a[48:51], v[64:79]
  ds_read_b128 a[56:59], v35 offset:32768
  ds_read_b128 a[60:63], v35 offset:36864
  v_mfma_f32_32x32x16_bf16 v[160:175], a[0:3], a[52:55], v[160:175]
  ds_read_b64_tr_b16 a[24:25], v16 offset:9216
  ds_read_b64_tr_b16 a[26:27], v16 offset:10752
  v_mfma_f32_32x32x16_bf16 v[80:95], a[4:7], a[48:51], v[80:95]
  ds_read_b64_tr_b16 a[28:29], v17 offset:9280
  ds_read_b64_tr_b16 a[30:31], v17 offset:10816
  s_add_u32 m0, m0, 1024
  s_nop 0
  buffer_load_dwordx4 v10, s[12:15], s27 offen lds
  v_mfma_f32_32x32x16_bf16 v[176:191], a[4:7], a[52:55], v[176:191]
  ds_read_b64_tr_b16 a[32:33], v16 offset:9344
  ds_read_b64_tr_b16 a[34:35], v16 offset:10880
  v_mfma_f32_32x32x16_bf16 v[96:111], a[8:11], a[48:51], v[96:111]
  ds_read_b64_tr_b16 a[36:37], v17 offset:9408
  ds_read_b64_tr_b16 a[38:39], v17 offset:10944
  v_mfma_f32_32x32x16_bf16 v[192:207], a[8:11], a[52:55], v[192:207]
  ds_read_b64_tr_b16 a[40:41], v16 offset:9472
  ds_read_b64_tr_b16 a[42:43], v16 offset:11008
  v_mfma_f32_32x32x16_bf16 v[112:127], a[12:15], a[48:51], v[112:127]
  ds_read_b64_tr_b16 a[44:45], v17 offset:9536
  ds_read_b64_tr_b16 a[46:47], v17 offset:11072
  v_mfma_f32_32x32x16_bf16 v[208:223], a[12:15], a[52:55], v[208:223]
  s_add_u32 m0, m0, 1024
  s_nop 0
  buffer_load_dwordx4 v11, s[12:15], s27 offen lds
  v_mfma_f32_32x32x16_bf16 v[128:143], a[16:19], a[48:51], v[128:143]
  v_mfma_f32_32x32x16_bf16 v[224:239], a[16:19], a[52:55], v[224:239]
  v_mfma_f32_32x32x16_bf16 v[144:159], a[20:23], a[48:51], v[144:159]
  v_mfma_f32_32x32x16_bf16 v[240:255], a[20:23], a[52:55], v[240:255]
  s_waitcnt vmcnt(4) lgkmcnt(0)
  s_barrier
  s_add_u32 s30, s30, 24576
  s_cmp_eq_u32 s30, 98304
  s_cselect_b32 s30, 0, s30
  v_add_u32 v16, s30, v14
  v_add_u32 v17, s30, v15
  v_mfma_f32_32x32x16_bf16 v[64:79], a[24:27], a[56:59], v[64:79]
  ds_read_b128 a[48:51], v32 offset:0
  ds_read_b128 a[52:55], v32 offset:4096
  s_add_u32 m0, m0, 1024
  s_nop 0
  buffer_load_dwordx4 v12, s[12:15], s27 offen lds
  v_mfma_f32_32x32x16_bf16 v[160:175], a[24:27], a[60:63], v[160:175]
  ds_read_b64_tr_b16 a[0:1], v16 offset:0
  ds_read_b64_tr_b16 a[2:3], v16 offset:1536
  v_mfma_f32_32x32x16_bf16 v[80:95], a[28:31], a[56:59], v[80:95]
  ds_read_b64_tr_b16 a[4:5], v17 offset:64
  ds_read_b64_tr_b16 a[6:7], v17 offset:1600
  v_mfma_f32_32x32x16_bf16 v[176:191], a[28:31], a[60:63], v[176:191]
  ds_read_b64_tr_b16 a[8:9], v16 offset:128
  ds_read_b64_tr_b16 a[10:11], v16 offset:1664
  v_mfma_f32_32x32x16_bf16 v[96:111], a[32:35], a[56:59], v[96:111]
  ds_read_b64_tr_b16 a[12:13], v17 offset:192
  ds_read_b64_tr_b16 a[14:15], v17 offset:1728
  v_mfma_f32_32x32x16_bf16 v[192:207], a[32:35], a[60:63], v[192:207]
  ds_read_b64_tr_b16 a[16:17], v16 offset:256
  ds_read_b64_tr_b16 a[18:19], v16 offset:1792
  s_add_u32 m0, m0, 1024
  s_nop 0
  buffer_load_dwordx4 v13, s[12:15], s27 offen lds
  s_add_u32 s27, s27, s28
  s_add_u32 s29, s29, 24576
  s_cmp_eq_u32 s29, 98304
  s_cselect_b32 s29, 0, s29
  v_mfma_f32_32x32x16_bf16 v[112:127], a[36:39], a[56:59], v[112:127]
  ds_read_b64_tr_b16 a[20:21], v17 offset:320
  ds_read_b64_tr_b16 a[22:23], v17 offset:1856
  v_mfma_f32_32x32x16_bf16 v[208:223], a[36:39], a[60:63], v[208:223]
  v_mfma_f32_32x32x16_bf16 v[128:143], a[40:43], a[56:59], v[128:143]
  v_mfma_f32_32x32x16_bf16 v[224:239], a[40:43], a[60:63], v[224:239]
  v_mfma_f32_32x32x16_bf16 v[144:159], a[44:47], a[56:59], v[144:159]
  v_mfma_f32_32x32x16_bf16 v[240:255], a[44:47], a[60:63], v[240:255]
  s_waitcnt lgkmcnt(0)
  v_mfma_f32_32x32x16_bf16 v[64:79], a[0:3], a[48:51], v[64:79]
  ds_read_b128 a[56:59], v33 offset:0
  ds_read_b128 a[60:63], v33 offset:4096
  s_add_u32 m0, s52, 32768
  s_nop 0
  buffer_load_dwordx4 v24, s[48:51], s26 offen lds
  v_mfma_f32_32x32x16_bf16 v[160:175], a[0:3], a[52:55], v[160:175]
  ds_read_b64_tr_b16 a[24:25], v16 offset:3072
  ds_read_b64_tr_b16 a[26:27], v16 offset:4608
  v_mfma_f32_32x32x16_bf16 v[80:95], a[4:7], a[48:51], v[80:95]
  ds_read_b64_tr_b16 a[28:29], v17 offset:3136
  ds_read_b64_tr_b16 a[30:31], v17 offset:4672
  s_add_u32 m0, s52, 33792
  s_nop 0
  buffer_load_dwordx4 v25, s[48:51], s26 offen lds
  v_mfma_f32_32x32x16_bf16 v[176:191], a[4:7], a[52:55], v[176:191]
  ds_read_b64_tr_b16 a[32:33], v16 offset:3200
  ds_read_b64_tr_b16 a[34:35], v16 offset:4736
  v_mfma_f32_32x32x16_bf16 v[96:111], a[8:11], a[48:51], v[96:111]
  ds_read_b64_tr_b16 a[36:37], v17 offset:3264
  ds_read_b64_tr_b16 a[38:39], v17 offset:4800
  s_add_u32 m0, s52, 34816
  s_nop 0
  buffer_load_dwordx4 v26, s[48:51], s26 offen lds
  v_mfma_f32_32x32x16_bf16 v[192:207], a[8:11], a[52:55], v[192:207]
  ds_read_b64_tr_b16 a[40:41], v16 offset:3328
  ds_read_b64_tr_b16 a[42:43], v16 offset:4864
  v_mfma_f32_32x32x16_bf16 v[112:127], a[12:15], a[48:51], v[112:127]
  ds_read_b64_tr_b16 a[44:45], v17 offset:3392
  ds_read_b64_tr_b16 a[46:47], v17 offset:4928
  s_add_u32 m0, s52, 35840
  s_nop 0
  buffer_load_dwordx4 v27, s[48:51], s26 offen lds
  v_mfma_f32_32x32x16_bf16 v[208:223], a[12:15], a[52:55], v[208:223]
  v_mfma_f32_32x32x16_bf16 v[128:143], a[16:19], a[48:51], v[128:143]
  s_add_u32 m0, s52, 36864
  s_nop 0
  buffer_load_dwordx4 v28, s[48:51], s26 offen lds
  v_mfma_f32_32x32x16_bf16 v[224:239], a[16:19], a[52:55], v[224:239]
  v_mfma_f32_32x32x16_bf16 v[144:159], a[20:23], a[48:51], v[144:159]
  s_add_u32 m0, s52, 37888
  s_nop 0
  buffer_load_dwordx4 v29, s[48:51], s26 offen lds
  v_mfma_f32_32x32x16_bf16 v[240:255], a[20:23], a[52:55], v[240:255]
  s_waitcnt lgkmcnt(0)
  v_mfma_f32_32x32x16_bf16 v[64:79], a[24:27], a[56:59], v[64:79]
  ds_read_b128 a[48:51], v34 offset:0
  ds_read_b128 a[52:55], v34 offset:4096
  s_add_u32 m0, s52, 38912
  s_nop 0
  buffer_load_dwordx4 v30, s[48:51], s26 offen lds
  v_mfma_f32_32x32x16_bf16 v[160:175], a[24:27], a[60:63], v[160:175]
  ds_read_b64_tr_b16 a[0:1], v16 offset:6144
  ds_read_b64_tr_b16 a[2:3], v16 offset:7680
  v_mfma_f32_32x32x16_bf16 v[80:95], a[28:31], a[56:59], v[80:95]
  ds_read_b64_tr_b16 a[4:5], v17 offset:6208
  ds_read_b64_tr_b16 a[6:7], v17 offset:7744
  s_add_u32 m0, s52, 39936
  s_nop 0
  buffer_load_dwordx4 v31, s[48:51], s26 offen lds
  s_add_u32 s26, s26, 128
  v_mfma_f32_32x32x16_bf16 v[176:191], a[28:31], a[60:63], v[176:191]
  ds_read_b64_tr_b16 a[8:9], v16 offset:6272
  ds_read_b64_tr_b16 a[10:11], v16 offset:7808
  v_mfma_f32_32x32x16_bf16 v[96:111], a[32:35], a[56:59], v[96:111]
  ds_read_b64_tr_b16 a[12:13], v17 offset:6336
  ds_read_b64_tr_b16 a[14:15], v17 offset:7872
  s_add_u32 m0, s29, s32
  s_nop 0
  buffer_load_dwordx4 v8, s[12:15], s27 offen lds
  v_mfma_f32_32x32x16_bf16 v[192:207], a[32:35], a[60:63], v[192:207]
  ds_read_b64_tr_b16 a[16:17], v16 offset:6400
  ds_read_b64_tr_b16 a[18:19], v16 offset:7936
  v_mfma_f32_32x32x16_bf16 v[112:127], a[36:39], a[56:59], v[112:127]
  ds_read_b64_tr_b16 a[20:21], v17 offset:6464
  ds_read_b64_tr_b16 a[22:23], v17 offset:8000
  v_mfma_f32_32x32x16_bf16 v[208:223], a[36:39], a[60:63], v[208:223]
  v_mfma_f32_32x32x16_bf16 v[128:143], a[40:43], a[56:59], v[128:143]
  v_mfma_f32_32x32x16_bf16 v[224:239], a[40:43], a[60:63], v[224:239]
  s_add_u32 m0, m0, 1024
  s_nop 0
  buffer_load_dwordx4 v9, s[12:15], s27 offen lds
  v_mfma_f32_32x32x16_bf16 v[144:159], a[44:47], a[56:59], v[144:159]
  v_mfma_f32_32x32x16_bf16 v[240:255], a[44:47], a[60:63], v[240:255]
  s_waitcnt lgkmcnt(0)
  v_mfma_f32_32x32x16_bf16 v[64:79], a[0:3], a[48:51], v[64:79]
  ds_read_b128 a[56:59], v35 offset:0
  ds_read_b128 a[60:63], v35 offset:4096
  v_mfma_f32_32x32x16_bf16 v[160:175], a[0:3], a[52:55], v[160:175]
  ds_read_b64_tr_b16 a[24:25], v16 offset:9216
  ds_read_b64_tr_b16 a[26:27], v16 offset:10752
  v_mfma_f32_32x32x16_bf16 v[80:95], a[4:7], a[48:51], v[80:95]
  ds_read_b64_tr_b16 a[28:29], v17 offset:9280
  ds_read_b64_tr_b16 a[30:31], v17 offset:10816
  s_add_u32 m0, m0, 1024
  s_nop 0
  buffer_load_dwordx4 v10, s[12:15], s27 offen lds
  v_mfma_f32_32x32x16_bf16 v[176:191], a[4:7], a[52:55], v[176:191]
  ds_read_b64_tr_b16 a[32:33], v16 offset:9344
  ds_read_b64_tr_b16 a[34:35], v16 offset:10880
  v_mfma_f32_32x32x16_bf16 v[96:111], a[8:11], a[48:51], v[96:111]
  ds_read_b64_tr_b16 a[36:37], v17 offset:9408
  ds_read_b64_tr_b16 a[38:39], v17 offset:10944
  v_mfma_f32_32x32x16_bf16 v[192:207], a[8:11], a[52:55], v[192:207]
  ds_read_b64_tr_b16 a[40:41], v16 offset:9472
  ds_read_b64_tr_b16 a[42:43], v16 offset:11008
  v_mfma_f32_32x32x16_bf16 v[112:127], a[12:15], a[48:51], v[112:127]
  ds_read_b64_tr_b16 a[44:45], v17 offset:9536
  ds_read_b64_tr_b16 a[46:47], v17 offset:11072
  v_mfma_f32_32x32x16_bf16 v[208:223], a[12:15], a[52:55], v[208:223]
  s_add_u32 m0, m0, 1024
  s_nop 0
  buffer_load_dwordx4 v11, s[12:15], s27 offen lds
  v_mfma_f32_32x32x16_bf16 v[128:143], a[16:19], a[48:51], v[128:143]
  v_mfma_f32_32x32x16_bf16 v[224:239], a[16:19], a[52:55], v[224:239]
  v_mfma_f32_32x32x16_bf16 v[144:159], a[20:23], a[48:51], v[144:159]
  v_mfma_f32_32x32x16_bf16 v[240:255], a[20:23], a[52:55], v[240:255]
  s_waitcnt vmcnt(4) lgkmcnt(0)
  s_barrier
  s_add_u32 s30, s30, 24576
  s_cmp_eq_u32 s30, 98304
  s_cselect_b32 s30, 0, s30
  v_add_u32 v16, s30, v14
  v_add_u32 v17, s30, v15
  v_mfma_f32_32x32x16_bf16 v[64:79], a[24:27], a[56:59], v[64:79]
  ds_read_b128 a[48:51], v32 offset:32768
  ds_read_b128 a[52:55], v32 offset:36864
  s_add_u32 m0, m0, 1024
  s_nop 0
  buffer_load_dwordx4 v12, s[12:15], s27 offen lds
  v_mfma_f32_32x32x16_bf16 v[160:175], a[24:27], a[60:63], v[160:175]
  ds_read_b64_tr_b16 a[0:1], v16 offset:0
  ds_read_b64_tr_b16 a[2:3], v16 offset:1536
  v_mfma_f32_32x32x16_bf16 v[80:95], a[28:31], a[56:59], v[80:95]
  ds_read_b64_tr_b16 a[4:5], v17 offset:64
  ds_read_b64_tr_b16 a[6:7], v17 offset:1600
  v_mfma_f32_32x32x16_bf16 v[176:191], a[28:31], a[60:63], v[176:191]
  ds_read_b64_tr_b16 a[8:9], v16 offset:128
  ds_read_b64_tr_b16 a[10:11], v16 offset:1664
  v_mfma_f32_32x32x16_bf16 v[96:111], a[32:35], a[56:59], v[96:111]
  ds_read_b64_tr_b16 a[12:13], v17 offset:192
  ds_read_b64_tr_b16 a[14:15], v17 offset:1728
  v_mfma_f32_32x32x16_bf16 v[192:207], a[32:35], a[60:63], v[192:207]
  ds_read_b64_tr_b16 a[16:17], v16 offset:256
  ds_read_b64_tr_b16 a[18:19], v16 offset:1792
  s_add_u32 m0, m0, 1024
  s_nop 0
  buffer_load_dwordx4 v13, s[12:15], s27 offen lds
  s_add_u32 s27, s27, s28
  s_add_u32 s29, s29, 24576
  s_cmp_eq_u32 s29, 98304
  s_cselect_b32 s29, 0, s29
  v_mfma_f32_32x32x16_bf16 v[112:127], a[36:39], a[56:59], v[112:127]
  ds_read_b64_tr_b16 a[20:21], v17 offset:320
  ds_read_b64_tr_b16 a[22:23], v17 offset:1856
  v_mfma_f32_32x32x16_bf16 v[208:223], a[36:39], a[60:63], v[208:223]
  v_mfma_f32_32x32x16_bf16 v[128:143], a[40:43], a[56:59], v[128:143]
  v_mfma_f32_32x32x16_bf16 v[224:239], a[40:43], a[60:63], v[224:239]
  v_mfma_f32_32x32x16_bf16 v[144:159], a[44:47], a[56:59], v[144:159]
  v_mfma_f32_32x32x16_bf16 v[240:255], a[44:47], a[60:63], v[240:255]
  s_waitcnt lgkmcnt(0)
  v_mfma_f32_32x32x16_bf16 v[64:79], a[0:3], a[48:51], v[64:79]
  ds_read_b128 a[56:59], v33 offset:32768
  ds_read_b128 a[60:63], v33 offset:36864
  s_add_u32 m0, s52, 0
  s_nop 0
  buffer_load_dwordx4 v24, s[48:51], s26 offen lds
  v_mfma_f32_32x32x16_bf16 v[160:175], a[0:3], a[52:55], v[160:175]
  ds_read_b64_tr_b16 a[24:25], v16 offset:3072
  ds_read_b64_tr_b16 a[26:27], v16 offset:4608
  v_mfma_f32_32x32x16_bf16 v[80:95], a[4:7], a[48:51], v[80:95]
  ds_read_b64_tr_b16 a[28:29], v17 offset:3136
  ds_read_b64_tr_b16 a[30:31], v17 offset:4672
  s_add_u32 m0, s52, 1024
  s_nop 0
  buffer_load_dwordx4 v25, s[48:51], s26 offen lds
  v_mfma_f32_32x32x16_bf16 v[176:191], a[4:7], a[52:55], v[176:191]
  ds_read_b64_tr_b16 a[32:33], v16 offset:3200
  ds_read_b64_tr_b16 a[34:35], v16 offset:4736
  v_mfma_f32_32x32x16_bf16 v[96:111], a[8:11], a[48:51], v[96:111]
  ds_read_b64_tr_b16 a[36:37], v17 offset:3264
  ds_read_b64_tr_b16 a[38:39], v17 offset:4800
  s_add_u32 m0, s52, 2048
  s_nop 0
  buffer_load_dwordx4 v26, s[48:51], s26 offen lds
  v_mfma_f32_32x32x16_bf16 v[192:207], a[8:11], a[52:55], v[192:207]
  ds_read_b64_tr_b16 a[40:41], v16 offset:3328
  ds_read_b64_tr_b16 a[42:43], v16 offset:4864
  v_mfma_f32_32x32x16_bf16 v[112:127], a[12:15], a[48:51], v[112:127]
  ds_read_b64_tr_b16 a[44:45], v17 offset:3392
  ds_read_b64_tr_b16 a[46:47], v17 offset:4928
  s_add_u32 m0, s52, 3072
  s_nop 0
  buffer_load_dwordx4 v27, s[48:51], s26 offen lds
  v_mfma_f32_32x32x16_bf16 v[208:223], a[12:15], a[52:55], v[208:223]
  v_mfma_f32_32x32x16_bf16 v[128:143], a[16:19], a[48:51], v[128:143]
  s_add_u32 m0, s52, 4096
  s_nop 0
  buffer_load_dwordx4 v28, s[48:51], s26 offen lds
  v_mfma_f32_32x32x16_bf16 v[224:239], a[16:19], a[52:55], v[224:239]
  v_mfma_f32_32x32x16_bf16 v[144:159], a[20:23], a[48:51], v[144:159]
  s_add_u32 m0, s52, 5120
  s_nop 0
  buffer_load_dwordx4 v29, s[48:51], s26 offen lds
  v_mfma_f32_32x32x16_bf16 v[240:255], a[20:23], a[52:55], v[240:255]
  s_waitcnt lgkmcnt(0)
  v_mfma_f32_32x32x16_bf16 v[64:79], a[24:27], a[56:59], v[64:79]
  ds_read_b128 a[48:51], v34 offset:32768
  ds_read_b128 a[52:55], v34 offset:36864
  s_add_u32 m0, s52, 6144
  s_nop 0
  buffer_load_dwordx4 v30, s[48:51], s26 offen lds
  v_mfma_f32_32x32x16_bf16 v[160:175], a[24:27], a[60:63], v[160:175]
  ds_read_b64_tr_b16 a[0:1], v16 offset:6144
  ds_read_b64_tr_b16 a[2:3], v16 offset:7680
  v_mfma_f32_32x32x16_bf16 v[80:95], a[28:31], a[56:59], v[80:95]
  ds_read_b64_tr_b16 a[4:5], v17 offset:6208
  ds_read_b64_tr_b16 a[6:7], v17 offset:7744
  s_add_u32 m0, s52, 7168
  s_nop 0
  buffer_load_dwordx4 v31, s[48:51], s26 offen lds
  s_add_u32 s26, s26, 128
  v_mfma_f32_32x32x16_bf16 v[176:191], a[28:31], a[60:63], v[176:191]
  ds_read_b64_tr_b16 a[8:9], v16 offset:6272
  ds_read_b64_tr_b16 a[10:11], v16 offset:7808
  v_mfma_f32_32x32x16_bf16 v[96:111], a[32:35], a[56:59], v[96:111]
  ds_read_b64_tr_b16 a[12:13], v17 offset:6336
  ds_read_b64_tr_b16 a[14:15], v17 offset:7872
  s_add_u32 m0, s29, s32
  s_nop 0
  buffer_load_dwordx4 v8, s[12:15], s27 offen lds
  v_mfma_f32_32x32x16_bf16 v[192:207], a[32:35], a[60:63], v[192:207]
  ds_read_b64_tr_b16 a[16:17], v16 offset:6400
  ds_read_b64_tr_b16 a[18:19], v16 offset:7936
  v_mfma_f32_32x32x16_bf16 v[112:127], a[36:39], a[56:59], v[112:127]
  ds_read_b64_tr_b16 a[20:21], v17 offset:6464
  ds_read_b64_tr_b16 a[22:23], v17 offset:8000
  v_mfma_f32_32x32x16_bf16 v[208:223], a[36:39], a[60:63], v[208:223]
  v_mfma_f32_32x32x16_bf16 v[128:143], a[40:43], a[56:59], v[128:143]
  v_mfma_f32_32x32x16_bf16 v[224:239], a[40:43], a[60:63], v[224:239]
  s_add_u32 m0, m0, 1024
  s_nop 0
  buffer_load_dwordx4 v9, s[12:15], s27 offen lds
  v_mfma_f32_32x32x16_bf16 v[144:159], a[44:47], a[56:59], v[144:159]
  v_mfma_f32_32x32x16_bf16 v[240:255], a[44:47], a[60:63], v[240:255]
  s_waitcnt lgkmcnt(0)
  v_mfma_f32_32x32x16_bf16 v[64:79], a[0:3], a[48:51], v[64:79]
  ds_read_b128 a[56:59], v35 offset:32768
  ds_read_b128 a[60:63], v35 offset:36864
  v_mfma_f32_32x32x16_bf16 v[160:175], a[0:3], a[52:55], v[160:175]
  ds_read_b64_tr_b16 a[24:25], v16 offset:9216
  ds_read_b64_tr_b16 a[26:27], v16 offset:10752
  v_mfma_f32_32x32x16_bf16 v[80:95], a[4:7], a[48:51], v[80:95]
  ds_read_b64_tr_b16 a[28:29], v17 offset:9280
  ds_read_b64_tr_b16 a[30:31], v17 offset:10816
  s_add_u32 m0, m0, 1024
  s_nop 0
  buffer_load_dwordx4 v10, s[12:15], s27 offen lds
  v_mfma_f32_32x32x16_bf16 v[176:191], a[4:7], a[52:55], v[176:191]
  ds_read_b64_tr_b16 a[32:33], v16 offset:9344
  ds_read_b64_tr_b16 a[34:35], v16 offset:10880
  v_mfma_f32_32x32x16_bf16 v[96:111], a[8:11], a[48:51], v[96:111]
  ds_read_b64_tr_b16 a[36:37], v17 offset:9408
  ds_read_b64_tr_b16 a[38:39], v17 offset:10944
  v_mfma_f32_32x32x16_bf16 v[192:207], a[8:11], a[52:55], v[192:207]
  ds_read_b64_tr_b16 a[40:41], v16 offset:9472
  ds_read_b64_tr_b16 a[42:43], v16 offset:11008
  v_mfma_f32_32x32x16_bf16 v[112:127], a[12:15], a[48:51], v[112:127]
  ds_read_b64_tr_b16 a[44:45], v17 offset:9536
  ds_read_b64_tr_b16 a[46:47], v17 offset:11072
  v_mfma_f32_32x32x16_bf16 v[208:223], a[12:15], a[52:55], v[208:223]
  s_add_u32 m0, m0, 1024
  s_nop 0
  buffer_load_dwordx4 v11, s[12:15], s27 offen lds
  v_mfma_f32_32x32x16_bf16 v[128:143], a[16:19], a[48:51], v[128:143]
  v_mfma_f32_32x32x16_bf16 v[224:239], a[16:19], a[52:55], v[224:239]
  v_mfma_f32_32x32x16_bf16 v[144:159], a[20:23], a[48:51], v[144:159]
  v_mfma_f32_32x32x16_bf16 v[240:255], a[20:23], a[52:55], v[240:255]
  s_waitcnt vmcnt(4) lgkmcnt(0)
  s_barrier
  s_add_u32 s30, s30, 24576
  s_cmp_eq_u32 s30, 98304
  s_cselect_b32 s30, 0, s30
  v_add_u32 v16, s30, v14
  v_add_u32 v17, s30, v15
  v_mfma_f32_32x32x16_bf16 v[64:79], a[24:27], a[56:59], v[64:79]
  ds_read_b128 a[48:51], v32 offset:0
  ds_read_b128 a[52:55], v32 offset:4096
  s_add_u32 m0, m0, 1024
  s_nop 0
  buffer_load_dwordx4 v12, s[12:15], s27 offen lds
  v_mfma_f32_32x32x16_bf16 v[160:175], a[24:27], a[60:63], v[160:175]
  ds_read_b64_tr_b16 a[0:1], v16 offset:0
  ds_read_b64_tr_b16 a[2:3], v16 offset:1536
  v_mfma_f32_32x32x16_bf16 v[80:95], a[28:31], a[56:59], v[80:95]
  ds_read_b64_tr_b16 a[4:5], v17 offset:64
  ds_read_b64_tr_b16 a[6:7], v17 offset:1600
  v_mfma_f32_32x32x16_bf16 v[176:191], a[28:31], a[60:63], v[176:191]
  ds_read_b64_tr_b16 a[8:9], v16 offset:128
  ds_read_b64_tr_b16 a[10:11], v16 offset:1664
  v_mfma_f32_32x32x16_bf16 v[96:111], a[32:35], a[56:59], v[96:111]
  ds_read_b64_tr_b16 a[12:13], v17 offset:192
  ds_read_b64_tr_b16 a[14:15], v17 offset:1728
  v_mfma_f32_32x32x16_bf16 v[192:207], a[32:35], a[60:63], v[192:207]
  ds_read_b64_tr_b16 a[16:17], v16 offset:256
  ds_read_b64_tr_b16 a[18:19], v16 offset:1792
  s_add_u32 m0, m0, 1024
  s_nop 0
  buffer_load_dwordx4 v13, s[12:15], s27 offen lds
  s_add_u32 s27, s27, s28
  s_add_u32 s29, s29, 24576
  s_cmp_eq_u32 s29, 98304
  s_cselect_b32 s29, 0, s29
  v_mfma_f32_32x32x16_bf16 v[112:127], a[36:39], a[56:59], v[112:127]
  ds_read_b64_tr_b16 a[20:21], v17 offset:320
  ds_read_b64_tr_b16 a[22:23], v17 offset:1856
  v_mfma_f32_32x32x16_bf16 v[208:223], a[36:39], a[60:63], v[208:223]
  v_mfma_f32_32x32x16_bf16 v[128:143], a[40:43], a[56:59], v[128:143]
  v_mfma_f32_32x32x16_bf16 v[224:239], a[40:43], a[60:63], v[224:239]
  v_mfma_f32_32x32x16_bf16 v[144:159], a[44:47], a[56:59], v[144:159]
  v_mfma_f32_32x32x16_bf16 v[240:255], a[44:47], a[60:63], v[240:255]
  s_waitcnt lgkmcnt(0)
  v_mfma_f32_32x32x16_bf16 v[64:79], a[0:3], a[48:51], v[64:79]
  ds_read_b128 a[56:59], v33 offset:0
  ds_read_b128 a[60:63], v33 offset:4096
  s_add_u32 m0, s52, 32768
  s_nop 0
  buffer_load_dwordx4 v24, s[48:51], s26 offen lds
  v_mfma_f32_32x32x16_bf16 v[160:175], a[0:3], a[52:55], v[160:175]
  ds_read_b64_tr_b16 a[24:25], v16 offset:3072
  ds_read_b64_tr_b16 a[26:27], v16 offset:4608
  v_mfma_f32_32x32x16_bf16 v[80:95], a[4:7], a[48:51], v[80:95]
  ds_read_b64_tr_b16 a[28:29], v17 offset:3136
  ds_read_b64_tr_b16 a[30:31], v17 offset:4672
  s_add_u32 m0, s52, 33792
  s_nop 0
  buffer_load_dwordx4 v25, s[48:51], s26 offen lds
  v_mfma_f32_32x32x16_bf16 v[176:191], a[4:7], a[52:55], v[176:191]
  ds_read_b64_tr_b16 a[32:33], v16 offset:3200
  ds_read_b64_tr_b16 a[34:35], v16 offset:4736
  v_mfma_f32_32x32x16_bf16 v[96:111], a[8:11], a[48:51], v[96:111]
  ds_read_b64_tr_b16 a[36:37], v17 offset:3264
  ds_read_b64_tr_b16 a[38:39], v17 offset:4800
  s_add_u32 m0, s52, 34816
  s_nop 0
  buffer_load_dwordx4 v26, s[48:51], s26 offen lds
  v_mfma_f32_32x32x16_bf16 v[192:207], a[8:11], a[52:55], v[192:207]
  ds_read_b64_tr_b16 a[40:41], v16 offset:3328
  ds_read_b64_tr_b16 a[42:43], v16 offset:4864
  v_mfma_f32_32x32x16_bf16 v[112:127], a[12:15], a[48:51], v[112:127]
  ds_read_b64_tr_b16 a[44:45], v17 offset:3392
  ds_read_b64_tr_b16 a[46:47], v17 offset:4928
  s_add_u32 m0, s52, 35840
  s_nop 0
  buffer_load_dwordx4 v27, s[48:51], s26 offen lds
  v_mfma_f32_32x32x16_bf16 v[208:223], a[12:15], a[52:55], v[208:223]
  v_mfma_f32_32x32x16_bf16 v[128:143], a[16:19], a[48:51], v[128:143]
  s_add_u32 m0, s52, 36864
  s_nop 0
  buffer_load_dwordx4 v28, s[48:51], s26 offen lds
  v_mfma_f32_32x32x16_bf16 v[224:239], a[16:19], a[52:55], v[224:239]
  v_mfma_f32_32x32x16_bf16 v[144:159], a[20:23], a[48:51], v[144:159]
  s_add_u32 m0, s52, 37888
  s_nop 0
  buffer_load_dwordx4 v29, s[48:51], s26 offen lds
  v_mfma_f32_32x32x16_bf16 v[240:255], a[20:23], a[52:55], v[240:255]
  s_waitcnt lgkmcnt(0)
  v_mfma_f32_32x32x16_bf16 v[64:79], a[24:27], a[56:59], v[64:79]
  ds_read_b128 a[48:51], v34 offset:0
  ds_read_b128 a[52:55], v34 offset:4096
  s_add_u32 m0, s52, 38912
  s_nop 0
  buffer_load_dwordx4 v30, s[48:51], s26 offen lds
  v_mfma_f32_32x32x16_bf16 v[160:175], a[24:27], a[60:63], v[160:175]
  ds_read_b64_tr_b16 a[0:1], v16 offset:6144
  ds_read_b64_tr_b16 a[2:3], v16 offset:7680
  v_mfma_f32_32x32x16_bf16 v[80:95], a[28:31], a[56:59], v[80:95]
  ds_read_b64_tr_b16 a[4:5], v17 offset:6208
  ds_read_b64_tr_b16 a[6:7], v17 offset:7744
  s_add_u32 m0, s52, 39936
  s_nop 0
  buffer_load_dwordx4 v31, s[48:51], s26 offen lds
  s_add_u32 s26, s26, 128
  v_mfma_f32_32x32x16_bf16 v[176:191], a[28:31], a[60:63], v[176:191]
  ds_read_b64_tr_b16 a[8:9], v16 offset:6272
  ds_read_b64_tr_b16 a[10:11], v16 offset:7808
  v_mfma_f32_32x32x16_bf16 v[96:111], a[32:35], a[56:59], v[96:111]
  ds_read_b64_tr_b16 a[12:13], v17 offset:6336
  ds_read_b64_tr_b16 a[14:15], v17 offset:7872
  s_add_u32 m0, s29, s32
  s_nop 0
  buffer_load_dwordx4 v8, s[12:15], s27 offen lds
  v_mfma_f32_32x32x16_bf16 v[192:207], a[32:35], a[60:63], v[192:207]
  ds_read_b64_tr_b16 a[16:17], v16 offset:6400
  ds_read_b64_tr_b16 a[18:19], v16 offset:7936
  v_mfma_f32_32x32x16_bf16 v[112:127], a[36:39], a[56:59], v[112:127]
  ds_read_b64_tr_b16 a[20:21], v17 offset:6464
  ds_read_b64_tr_b16 a[22:23], v17 offset:8000
  v_mfma_f32_32x32x16_bf16 v[208:223], a[36:39], a[60:63], v[208:223]
  v_mfma_f32_32x32x16_bf16 v[128:143], a[40:43], a[56:59], v[128:143]
  v_mfma_f32_32x32x16_bf16 v[224:239], a[40:43], a[60:63], v[224:239]
  s_add_u32 m0, m0, 1024
  s_nop 0
  buffer_load_dwordx4 v9, s[12:15], s27 offen lds
  v_mfma_f32_32x32x16_bf16 v[144:159], a[44:47], a[56:59], v[144:159]
  v_mfma_f32_32x32x16_bf16 v[240:255], a[44:47], a[60:63], v[240:255]
  s_waitcnt lgkmcnt(0)
  v_mfma_f32_32x32x16_bf16 v[64:79], a[0:3], a[48:51], v[64:79]
  ds_read_b128 a[56:59], v35 offset:0
  ds_read_b128 a[60:63], v35 offset:4096
  v_mfma_f32_32x32x16_bf16 v[160:175], a[0:3], a[52:55], v[160:175]
  ds_read_b64_tr_b16 a[24:25], v16 offset:9216
  ds_read_b64_tr_b16 a[26:27], v16 offset:10752
  v_mfma_f32_32x32x16_bf16 v[80:95], a[4:7], a[48:51], v[80:95]
  ds_read_b64_tr_b16 a[28:29], v17 offset:9280
  ds_read_b64_tr_b16 a[30:31], v17 offset:10816
  s_add_u32 m0, m0, 1024
  s_nop 0
  buffer_load_dwordx4 v10, s[12:15], s27 offen lds
  v_mfma_f32_32x32x16_bf16 v[176:191], a[4:7], a[52:55], v[176:191]
  ds_read_b64_tr_b16 a[32:33], v16 offset:9344
  ds_read_b64_tr_b16 a[34:35], v16 offset:10880
  v_mfma_f32_32x32x16_bf16 v[96:111], a[8:11], a[48:51], v[96:111]
  ds_read_b64_tr_b16 a[36:37], v17 offset:9408
  ds_read_b64_tr_b16 a[38:39], v17 offset:10944
  v_mfma_f32_32x32x16_bf16 v[192:207], a[8:11], a[52:55], v[192:207]
  ds_read_b64_tr_b16 a[40:41], v16 offset:9472
  ds_read_b64_tr_b16 a[42:43], v16 offset:11008
  v_mfma_f32_32x32x16_bf16 v[112:127], a[12:15], a[48:51], v[112:127]
  ds_read_b64_tr_b16 a[44:45], v17 offset:9536
  ds_read_b64_tr_b16 a[46:47], v17 offset:11072
  v_mfma_f32_32x32x16_bf16 v[208:223], a[12:15], a[52:55], v[208:223]
  s_add_u32 m0, m0, 1024
  s_nop 0
  buffer_load_dwordx4 v11, s[12:15], s27 offen lds
  v_mfma_f32_32x32x16_bf16 v[128:143], a[16:19], a[48:51], v[128:143]
  v_mfma_f32_32x32x16_bf16 v[224:239], a[16:19], a[52:55], v[224:239]
  v_mfma_f32_32x32x16_bf16 v[144:159], a[20:23], a[48:51], v[144:159]
  v_mfma_f32_32x32x16_bf16 v[240:255], a[20:23], a[52:55], v[240:255]
  s_waitcnt vmcnt(4) lgkmcnt(0)
  s_barrier
  s_add_u32 s30, s30, 24576
  s_cmp_eq_u32 s30, 98304
  s_cselect_b32 s30, 0, s30
  v_add_u32 v16, s30, v14
  v_add_u32 v17, s30, v15
  v_mfma_f32_32x32x16_bf16 v[64:79], a[24:27], a[56:59], v[64:79]
  ds_read_b128 a[48:51], v32 offset:32768
  ds_read_b128 a[52:55], v32 offset:36864
  s_add_u32 m0, m0, 1024
  s_nop 0
  buffer_load_dwordx4 v12, s[12:15], s27 offen lds
  v_mfma_f32_32x32x16_bf16 v[160:175], a[24:27], a[60:63], v[160:175]
  ds_read_b64_tr_b16 a[0:1], v16 offset:0
  ds_read_b64_tr_b16 a[2:3], v16 offset:1536
  v_mfma_f32_32x32x16_bf16 v[80:95], a[28:31], a[56:59], v[80:95]
  ds_read_b64_tr_b16 a[4:5], v17 offset:64
  ds_read_b64_tr_b16 a[6:7], v17 offset:1600
  v_mfma_f32_32x32x16_bf16 v[176:191], a[28:31], a[60:63], v[176:191]
  ds_read_b64_tr_b16 a[8:9], v16 offset:128
  ds_read_b64_tr_b16 a[10:11], v16 offset:1664
  v_mfma_f32_32x32x16_bf16 v[96:111], a[32:35], a[56:59], v[96:111]
  ds_read_b64_tr_b16 a[12:13], v17 offset:192
  ds_read_b64_tr_b16 a[14:15], v17 offset:1728
  v_mfma_f32_32x32x16_bf16 v[192:207], a[32:35], a[60:63], v[192:207]
  ds_read_b64_tr_b16 a[16:17], v16 offset:256
  ds_read_b64_tr_b16 a[18:19], v16 offset:1792
  s_add_u32 m0, m0, 1024
  s_nop 0
  buffer_load_dwordx4 v13, s[12:15], s27 offen lds
  s_add_u32 s27, s27, s28
  s_add_u32 s29, s29, 24576
  s_cmp_eq_u32 s29, 98304
  s_cselect_b32 s29, 0, s29
  v_mfma_f32_32x32x16_bf16 v[112:127], a[36:39], a[56:59], v[112:127]
  ds_read_b64_tr_b16 a[20:21], v17 offset:320
  ds_read_b64_tr_b16 a[22:23], v17 offset:1856
  v_mfma_f32_32x32x16_bf16 v[208:223], a[36:39], a[60:63], v[208:223]
  v_mfma_f32_32x32x16_bf16 v[128:143], a[40:43], a[56:59], v[128:143]
  v_mfma_f32_32x32x16_bf16 v[224:239], a[40:43], a[60:63], v[224:239]
  v_mfma_f32_32x32x16_bf16 v[144:159], a[44:47], a[56:59], v[144:159]
  v_mfma_f32_32x32x16_bf16 v[240:255], a[44:47], a[60:63], v[240:255]
  s_waitcnt lgkmcnt(0)
  v_mfma_f32_32x32x16_bf16 v[64:79], a[0:3], a[48:51], v[64:79]
  ds_read_b128 a[56:59], v33 offset:32768
  ds_read_b128 a[60:63], v33 offset:36864
  s_add_u32 m0, s52, 0
  s_nop 0
  buffer_load_dwordx4 v24, s[48:51], s26 offen lds
  v_mfma_f32_32x32x16_bf16 v[160:175], a[0:3], a[52:55], v[160:175]
  ds_read_b64_tr_b16 a[24:25], v16 offset:3072
  ds_read_b64_tr_b16 a[26:27], v16 offset:4608
  v_mfma_f32_32x32x16_bf16 v[80:95], a[4:7], a[48:51], v[80:95]
  ds_read_b64_tr_b16 a[28:29], v17 offset:3136
  ds_read_b64_tr_b16 a[30:31], v17 offset:4672
  s_add_u32 m0, s52, 1024
  s_nop 0
  buffer_load_dwordx4 v25, s[48:51], s26 offen lds
  v_mfma_f32_32x32x16_bf16 v[176:191], a[4:7], a[52:55], v[176:191]
  ds_read_b64_tr_b16 a[32:33], v16 offset:3200
  ds_read_b64_tr_b16 a[34:35], v16 offset:4736
  v_mfma_f32_32x32x16_bf16 v[96:111], a[8:11], a[48:51], v[96:111]
  ds_read_b64_tr_b16 a[36:37], v17 offset:3264
  ds_read_b64_tr_b16 a[38:39], v17 offset:4800
  s_add_u32 m0, s52, 2048
  s_nop 0
  buffer_load_dwordx4 v26, s[48:51], s26 offen lds
  v_mfma_f32_32x32x16_bf16 v[192:207], a[8:11], a[52:55], v[192:207]
  ds_read_b64_tr_b16 a[40:41], v16 offset:3328
  ds_read_b64_tr_b16 a[42:43], v16 offset:4864
  v_mfma_f32_32x32x16_bf16 v[112:127], a[12:15], a[48:51], v[112:127]
  ds_read_b64_tr_b16 a[44:45], v17 offset:3392
  ds_read_b64_tr_b16 a[46:47], v17 offset:4928
  s_add_u32 m0, s52, 3072
  s_nop 0
  buffer_load_dwordx4 v27, s[48:51], s26 offen lds
  v_mfma_f32_32x32x16_bf16 v[208:223], a[12:15], a[52:55], v[208:223]
  v_mfma_f32_32x32x16_bf16 v[128:143], a[16:19], a[48:51], v[128:143]
  s_add_u32 m0, s52, 4096
  s_nop 0
  buffer_load_dwordx4 v28, s[48:51], s26 offen lds
  v_mfma_f32_32x32x16_bf16 v[224:239], a[16:19], a[52:55], v[224:239]
  v_mfma_f32_32x32x16_bf16 v[144:159], a[20:23], a[48:51], v[144:159]
  s_add_u32 m0, s52, 5120
  s_nop 0
  buffer_load_dwordx4 v29, s[48:51], s26 offen lds
  v_mfma_f32_32x32x16_bf16 v[240:255], a[20:23], a[52:55], v[240:255]
  s_waitcnt lgkmcnt(0)
  v_mfma_f32_32x32x16_bf16 v[64:79], a[24:27], a[56:59], v[64:79]
  ds_read_b128 a[48:51], v34 offset:32768
  ds_read_b128 a[52:55], v34 offset:36864
  s_add_u32 m0, s52, 6144
  s_nop 0
  buffer_load_dwordx4 v30, s[48:51], s26 offen lds
  v_mfma_f32_32x32x16_bf16 v[160:175], a[24:27], a[60:63], v[160:175]
  ds_read_b64_tr_b16 a[0:1], v16 offset:6144
  ds_read_b64_tr_b16 a[2:3], v16 offset:7680
  v_mfma_f32_32x32x16_bf16 v[80:95], a[28:31], a[56:59], v[80:95]
  ds_read_b64_tr_b16 a[4:5], v17 offset:6208
  ds_read_b64_tr_b16 a[6:7], v17 offset:7744
  s_add_u32 m0, s52, 7168
  s_nop 0
  buffer_load_dwordx4 v31, s[48:51], s26 offen lds
  s_add_u32 s26, s26, 128
  v_mfma_f32_32x32x16_bf16 v[176:191], a[28:31], a[60:63], v[176:191]
  ds_read_b64_tr_b16 a[8:9], v16 offset:6272
  ds_read_b64_tr_b16 a[10:11], v16 offset:7808
  v_mfma_f32_32x32x16_bf16 v[96:111], a[32:35], a[56:59], v[96:111]
  ds_read_b64_tr_b16 a[12:13], v17 offset:6336
  ds_read_b64_tr_b16 a[14:15], v17 offset:7872
  s_add_u32 m0, s29, s32
  s_nop 0
  buffer_load_dwordx4 v8, s[12:15], s27 offen lds
  v_mfma_f32_32x32x16_bf16 v[192:207], a[32:35], a[60:63], v[192:207]
  ds_read_b64_tr_b16 a[16:17], v16 offset:6400
  ds_read_b64_tr_b16 a[18:19], v16 offset:7936
  v_mfma_f32_32x32x16_bf16 v[112:127], a[36:39], a[56:59], v[112:127]
  ds_read_b64_tr_b16 a[20:21], v17 offset:6464
  ds_read_b64_tr_b16 a[22:23], v17 offset:8000
  v_mfma_f32_32x32x16_bf16 v[208:223], a[36:39], a[60:63], v[208:223]
  v_mfma_f32_32x32x16_bf16 v[128:143], a[40:43], a[56:59], v[128:143]
  v_mfma_f32_32x32x16_bf16 v[224:239], a[40:43], a[60:63], v[224:239]
  s_add_u32 m0, m0, 1024
  s_nop 0
  buffer_load_dwordx4 v9, s[12:15], s27 offen lds
  v_mfma_f32_32x32x16_bf16 v[144:159], a[44:47], a[56:59], v[144:159]
  v_mfma_f32_32x32x16_bf16 v[240:255], a[44:47], a[60:63], v[240:255]
  s_waitcnt lgkmcnt(0)
  v_mfma_f32_32x32x16_bf16 v[64:79], a[0:3], a[48:51], v[64:79]
  ds_read_b128 a[56:59], v35 offset:32768
  ds_read_b128 a[60:63], v35 offset:36864
  v_mfma_f32_32x32x16_bf16 v[160:175], a[0:3], a[52:55], v[160:175]
  ds_read_b64_tr_b16 a[24:25], v16 offset:9216
  ds_read_b64_tr_b16 a[26:27], v16 offset:10752
  v_mfma_f32_32x32x16_bf16 v[80:95], a[4:7], a[48:51], v[80:95]
  ds_read_b64_tr_b16 a[28:29], v17 offset:9280
  ds_read_b64_tr_b16 a[30:31], v17 offset:10816
  s_add_u32 m0, m0, 1024
  s_nop 0
  buffer_load_dwordx4 v10, s[12:15], s27 offen lds
  v_mfma_f32_32x32x16_bf16 v[176:191], a[4:7], a[52:55], v[176:191]
  ds_read_b64_tr_b16 a[32:33], v16 offset:9344
  ds_read_b64_tr_b16 a[34:35], v16 offset:10880
  v_mfma_f32_32x32x16_bf16 v[96:111], a[8:11], a[48:51], v[96:111]
  ds_read_b64_tr_b16 a[36:37], v17 offset:9408
  ds_read_b64_tr_b16 a[38:39], v17 offset:10944
  v_mfma_f32_32x32x16_bf16 v[192:207], a[8:11], a[52:55], v[192:207]
  ds_read_b64_tr_b16 a[40:41], v16 offset:9472
  ds_read_b64_tr_b16 a[42:43], v16 offset:11008
  v_mfma_f32_32x32x16_bf16 v[112:127], a[12:15], a[48:51], v[112:127]
  ds_read_b64_tr_b16 a[44:45], v17 offset:9536
  ds_read_b64_tr_b16 a[46:47], v17 offset:11072
  v_mfma_f32_32x32x16_bf16 v[208:223], a[12:15], a[52:55], v[208:223]
  s_add_u32 m0, m0, 1024
  s_nop 0
  buffer_load_dwordx4 v11, s[12:15], s27 offen lds
  v_mfma_f32_32x32x16_bf16 v[128:143], a[16:19], a[48:51], v[128:143]
  v_mfma_f32_32x32x16_bf16 v[224:239], a[16:19], a[52:55], v[224:239]
  v_mfma_f32_32x32x16_bf16 v[144:159], a[20:23], a[48:51], v[144:159]
  v_mfma_f32_32x32x16_bf16 v[240:255], a[20:23], a[52:55], v[240:255]
  s_waitcnt vmcnt(4) lgkmcnt(0)
  s_barrier
  s_add_u32 s30, s30, 24576
  s_cmp_eq_u32 s30, 98304
  s_cselect_b32 s30, 0, s30
  v_add_u32 v16, s30, v14
  v_add_u32 v17, s30, v15
  v_mfma_f32_32x32x16_bf16 v[64:79], a[24:27], a[56:59], v[64:79]
  ds_read_b128 a[48:51], v32 offset:0
  ds_read_b128 a[52:55], v32 offset:4096
  s_add_u32 m0, m0, 1024
  s_nop 0
  buffer_load_dwordx4 v12, s[12:15], s27 offen lds
  v_mfma_f32_32x32x16_bf16 v[160:175], a[24:27], a[60:63], v[160:175]
  ds_read_b64_tr_b16 a[0:1], v16 offset:0
  ds_read_b64_tr_b16 a[2:3], v16 offset:1536
  v_mfma_f32_32x32x16_bf16 v[80:95], a[28:31], a[56:59], v[80:95]
  ds_read_b64_tr_b16 a[4:5], v17 offset:64
  ds_read_b64_tr_b16 a[6:7], v17 offset:1600
  v_mfma_f32_32x32x16_bf16 v[176:191], a[28:31], a[60:63], v[176:191]
  ds_read_b64_tr_b16 a[8:9], v16 offset:128
  ds_read_b64_tr_b16 a[10:11], v16 offset:1664
  v_mfma_f32_32x32x16_bf16 v[96:111], a[32:35], a[56:59], v[96:111]
  ds_read_b64_tr_b16 a[12:13], v17 offset:192
  ds_read_b64_tr_b16 a[14:15], v17 offset:1728
  v_mfma_f32_32x32x16_bf16 v[192:207], a[32:35], a[60:63], v[192:207]
  ds_read_b64_tr_b16 a[16:17], v16 offset:256
  ds_read_b64_tr_b16 a[18:19], v16 offset:1792
  s_add_u32 m0, m0, 1024
  s_nop 0
  buffer_load_dwordx4 v13, s[12:15], s27 offen lds
  s_add_u32 s27, s27, s28
  s_add_u32 s29, s29, 24576
  s_cmp_eq_u32 s29, 98304
  s_cselect_b32 s29, 0, s29
  v_mfma_f32_32x32x16_bf16 v[112:127], a[36:39], a[56:59], v[112:127]
  ds_read_b64_tr_b16 a[20:21], v17 offset:320
  ds_read_b64_tr_b16 a[22:23], v17 offset:1856
  v_mfma_f32_32x32x16_bf16 v[208:223], a[36:39], a[60:63], v[208:223]
  v_mfma_f32_32x32x16_bf16 v[128:143], a[40:43], a[56:59], v[128:143]
  v_mfma_f32_32x32x16_bf16 v[224:239], a[40:43], a[60:63], v[224:239]
  v_mfma_f32_32x32x16_bf16 v[144:159], a[44:47], a[56:59], v[144:159]
  v_mfma_f32_32x32x16_bf16 v[240:255], a[44:47], a[60:63], v[240:255]
  s_waitcnt lgkmcnt(0)
  v_mfma_f32_32x32x16_bf16 v[64:79], a[0:3], a[48:51], v[64:79]
  ds_read_b128 a[56:59], v33 offset:0
  ds_read_b128 a[60:63], v33 offset:4096
  s_add_u32 m0, s52, 32768
  s_nop 0
  buffer_load_dwordx4 v24, s[48:51], s26 offen lds
  v_mfma_f32_32x32x16_bf16 v[160:175], a[0:3], a[52:55], v[160:175]
  ds_read_b64_tr_b16 a[24:25], v16 offset:3072
  ds_read_b64_tr_b16 a[26:27], v16 offset:4608
  v_mfma_f32_32x32x16_bf16 v[80:95], a[4:7], a[48:51], v[80:95]
  ds_read_b64_tr_b16 a[28:29], v17 offset:3136
  ds_read_b64_tr_b16 a[30:31], v17 offset:4672
  s_add_u32 m0, s52, 33792
  s_nop 0
  buffer_load_dwordx4 v25, s[48:51], s26 offen lds
  v_mfma_f32_32x32x16_bf16 v[176:191], a[4:7], a[52:55], v[176:191]
  ds_read_b64_tr_b16 a[32:33], v16 offset:3200
  ds_read_b64_tr_b16 a[34:35], v16 offset:4736
  v_mfma_f32_32x32x16_bf16 v[96:111], a[8:11], a[48:51], v[96:111]
  ds_read_b64_tr_b16 a[36:37], v17 offset:3264
  ds_read_b64_tr_b16 a[38:39], v17 offset:4800
  s_add_u32 m0, s52, 34816
  s_nop 0
  buffer_load_dwordx4 v26, s[48:51], s26 offen lds
  v_mfma_f32_32x32x16_bf16 v[192:207], a[8:11], a[52:55], v[192:207]
  ds_read_b64_tr_b16 a[40:41], v16 offset:3328
  ds_read_b64_tr_b16 a[42:43], v16 offset:4864
  v_mfma_f32_32x32x16_bf16 v[112:127], a[12:15], a[48:51], v[112:127]
  ds_read_b64_tr_b16 a[44:45], v17 offset:3392
  ds_read_b64_tr_b16 a[46:47], v17 offset:4928
  s_add_u32 m0, s52, 35840
  s_nop 0
  buffer_load_dwordx4 v27, s[48:51], s26 offen lds
  v_mfma_f32_32x32x16_bf16 v[208:223], a[12:15], a[52:55], v[208:223]
  v_mfma_f32_32x32x16_bf16 v[128:143], a[16:19], a[48:51], v[128:143]
  s_add_u32 m0, s52, 36864
  s_nop 0
  buffer_load_dwordx4 v28, s[48:51], s26 offen lds
  v_mfma_f32_32x32x16_bf16 v[224:239], a[16:19], a[52:55], v[224:239]
  v_mfma_f32_32x32x16_bf16 v[144:159], a[20:23], a[48:51], v[144:159]
  s_add_u32 m0, s52, 37888
  s_nop 0
  buffer_load_dwordx4 v29, s[48:51], s26 offen lds
  v_mfma_f32_32x32x16_bf16 v[240:255], a[20:23], a[52:55], v[240:255]
  s_waitcnt lgkmcnt(0)
  v_mfma_f32_32x32x16_bf16 v[64:79], a[24:27], a[56:59], v[64:79]
  ds_read_b128 a[48:51], v34 offset:0
  ds_read_b128 a[52:55], v34 offset:4096
  s_add_u32 m0, s52, 38912
  s_nop 0
  buffer_load_dwordx4 v30, s[48:51], s26 offen lds
  v_mfma_f32_32x32x16_bf16 v[160:175], a[24:27], a[60:63], v[160:175]
  ds_read_b64_tr_b16 a[0:1], v16 offset:6144
  ds_read_b64_tr_b16 a[2:3], v16 offset:7680
  v_mfma_f32_32x32x16_bf16 v[80:95], a[28:31], a[56:59], v[80:95]
  ds_read_b64_tr_b16 a[4:5], v17 offset:6208
  ds_read_b64_tr_b16 a[6:7], v17 offset:7744
  s_add_u32 m0, s52, 39936
  s_nop 0
  buffer_load_dwordx4 v31, s[48:51], s26 offen lds
  s_add_u32 s26, s26, 128
  v_mfma_f32_32x32x16_bf16 v[176:191], a[28:31], a[60:63], v[176:191]
  ds_read_b64_tr_b16 a[8:9], v16 offset:6272
  ds_read_b64_tr_b16 a[10:11], v16 offset:7808
  v_mfma_f32_32x32x16_bf16 v[96:111], a[32:35], a[56:59], v[96:111]
  ds_read_b64_tr_b16 a[12:13], v17 offset:6336
  ds_read_b64_tr_b16 a[14:15], v17 offset:7872
  v_mfma_f32_32x32x16_bf16 v[192:207], a[32:35], a[60:63], v[192:207]
  ds_read_b64_tr_b16 a[16:17], v16 offset:6400
  ds_read_b64_tr_b16 a[18:19], v16 offset:7936
  v_mfma_f32_32x32x16_bf16 v[112:127], a[36:39], a[56:59], v[112:127]
  ds_read_b64_tr_b16 a[20:21], v17 offset:6464
  ds_read_b64_tr_b16 a[22:23], v17 offset:8000
  v_mfma_f32_32x32x16_bf16 v[208:223], a[36:39], a[60:63], v[208:223]
  v_mfma_f32_32x32x16_bf16 v[128:143], a[40:43], a[56:59], v[128:143]
  v_mfma_f32_32x32x16_bf16 v[224:239], a[40:43], a[60:63], v[224:239]
  v_mfma_f32_32x32x16_bf16 v[144:159], a[44:47], a[56:59], v[144:159]
  v_mfma_f32_32x32x16_bf16 v[240:255], a[44:47], a[60:63], v[240:255]
  s_waitcnt lgkmcnt(0)
  v_mfma_f32_32x32x16_bf16 v[64:79], a[0:3], a[48:51], v[64:79]
  ds_read_b128 a[56:59], v35 offset:0
  ds_read_b128 a[60:63], v35 offset:4096
  v_mfma_f32_32x32x16_bf16 v[160:175], a[0:3], a[52:55], v[160:175]
  ds_read_b64_tr_b16 a[24:25], v16 offset:9216
  ds_read_b64_tr_b16 a[26:27], v16 offset:10752
  v_mfma_f32_32x32x16_bf16 v[80:95], a[4:7], a[48:51], v[80:95]
  ds_read_b64_tr_b16 a[28:29], v17 offset:9280
  ds_read_b64_tr_b16 a[30:31], v17 offset:10816
  v_mfma_f32_32x32x16_bf16 v[176:191], a[4:7], a[52:55], v[176:191]
  ds_read_b64_tr_b16 a[32:33], v16 offset:9344
  ds_read_b64_tr_b16 a[34:35], v16 offset:10880
  v_mfma_f32_32x32x16_bf16 v[96:111], a[8:11], a[48:51], v[96:111]
  ds_read_b64_tr_b16 a[36:37], v17 offset:9408
  ds_read_b64_tr_b16 a[38:39], v17 offset:10944
  v_mfma_f32_32x32x16_bf16 v[192:207], a[8:11], a[52:55], v[192:207]
  ds_read_b64_tr_b16 a[40:41], v16 offset:9472
  ds_read_b64_tr_b16 a[42:43], v16 offset:11008
  v_mfma_f32_32x32x16_bf16 v[112:127], a[12:15], a[48:51], v[112:127]
  ds_read_b64_tr_b16 a[44:45], v17 offset:9536
  ds_read_b64_tr_b16 a[46:47], v17 offset:11072
  v_mfma_f32_32x32x16_bf16 v[208:223], a[12:15], a[52:55], v[208:223]
  v_mfma_f32_32x32x16_bf16 v[128:143], a[16:19], a[48:51], v[128:143]
  v_mfma_f32_32x32x16_bf16 v[224:239], a[16:19], a[52:55], v[224:239]
  v_mfma_f32_32x32x16_bf16 v[144:159], a[20:23], a[48:51], v[144:159]
  v_mfma_f32_32x32x16_bf16 v[240:255], a[20:23], a[52:55], v[240:255]
  s_waitcnt vmcnt(0) lgkmcnt(0)
  s_barrier
  s_add_u32 s30, s30, 24576
  s_cmp_eq_u32 s30, 98304
  s_cselect_b32 s30, 0, s30
  v_add_u32 v16, s30, v14
  v_add_u32 v17, s30, v15
  v_mfma_f32_32x32x16_bf16 v[64:79], a[24:27], a[56:59], v[64:79]
  ds_read_b128 a[48:51], v32 offset:32768
  ds_read_b128 a[52:55], v32 offset:36864
  s_cmp_eq_u32 s62, 0
  s_cbranch_scc1 W_c_10
  s_add_u32 m0, s29, s32
  s_nop 0
  buffer_load_dwordx4 v8, s[56:59], s61 offen lds
W_c_10:
  v_mfma_f32_32x32x16_bf16 v[160:175], a[24:27], a[60:63], v[160:175]
  ds_read_b64_tr_b16 a[0:1], v16 offset:0
  ds_read_b64_tr_b16 a[2:3], v16 offset:1536
  v_mfma_f32_32x32x16_bf16 v[80:95], a[28:31], a[56:59], v[80:95]
  ds_read_b64_tr_b16 a[4:5], v17 offset:64
  ds_read_b64_tr_b16 a[6:7], v17 offset:1600
  s_cmp_eq_u32 s62, 0
  s_cbranch_scc1 W_c_11
  s_add_u32 m0, m0, 1024
  s_nop 0
  buffer_load_dwordx4 v9, s[56:59], s61 offen lds
W_c_11:
  v_mfma_f32_32x32x16_bf16 v[176:191], a[28:31], a[60:63], v[176:191]
  ds_read_b64_tr_b16 a[8:9], v16 offset:128
  ds_read_b64_tr_b16 a[10:11], v16 offset:1664
  v_mfma_f32_32x32x16_bf16 v[96:111], a[32:35], a[56:59], v[96:111]
  ds_read_b64_tr_b16 a[12:13], v17 offset:192
  ds_read_b64_tr_b16 a[14:15], v17 offset:1728
  s_cmp_eq_u32 s62, 0
  s_cbranch_scc1 W_c_12
  s_add_u32 m0, m0, 1024
  s_nop 0
  buffer_load_dwordx4 v10, s[56:59], s61 offen lds
W_c_12:
  v_mfma_f32_32x32x16_bf16 v[192:207], a[32:35], a[60:63], v[192:207]
  ds_read_b64_tr_b16 a[16:17], v16 offset:256
  ds_read_b64_tr_b16 a[18:19], v16 offset:1792
  v_mfma_f32_32x32x16_bf16 v[112:127], a[36:39], a[56:59], v[112:127]
  ds_read_b64_tr_b16 a[20:21], v17 offset:320
  ds_read_b64_tr_b16 a[22:23], v17 offset:1856
  s_cmp_eq_u32 s62, 0
  s_cbranch_scc1 W_c_13
  s_add_u32 m0, m0, 1024
  s_nop 0
  buffer_load_dwordx4 v11, s[56:59], s61 offen lds
W_c_13:
  v_mfma_f32_32x32x16_bf16 v[208:223], a[36:39], a[60:63], v[208:223]
  v_mfma_f32_32x32x16_bf16 v[128:143], a[40:43], a[56:59], v[128:143]
  s_cmp_eq_u32 s62, 0
  s_cbranch_scc1 W_c_14
  s_add_u32 m0, m0, 1024
  s_nop 0
  buffer_load_dwordx4 v12, s[56:59], s61 offen lds
W_c_14:
  v_mfma_f32_32x32x16_bf16 v[224:239], a[40:43], a[60:63], v[224:239]
  v_mfma_f32_32x32x16_bf16 v[144:159], a[44:47], a[56:59], v[144:159]
  s_cmp_eq_u32 s62, 0
  s_cbranch_scc1 W_c_15
  s_add_u32 m0, m0, 1024
  s_nop 0
  buffer_load_dwordx4 v13, s[56:59], s61 offen lds
  s_add_u32 s61, s61, s28
  s_add_u32 s29, s29, 24576
  s_cmp_eq_u32 s29, 98304
  s_cselect_b32 s29, 0, s29
W_c_15:
  v_mfma_f32_32x32x16_bf16 v[240:255], a[44:47], a[60:63], v[240:255]
  s_waitcnt lgkmcnt(0)
  v_mfma_f32_32x32x16_bf16 v[64:79], a[0:3], a[48:51], v[64:79]
  ds_read_b128 a[56:59], v33 offset:32768
  ds_read_b128 a[60:63], v33 offset:36864
  s_cmp_eq_u32 s62, 0
  s_cbranch_scc1 W_c_16
  s_add_u32 m0, s52, 0
  s_nop 0
  buffer_load_dwordx4 v24, s[48:51], s60 offen lds
W_c_16:
  v_mfma_f32_32x32x16_bf16 v[160:175], a[0:3], a[52:55], v[160:175]
  ds_read_b64_tr_b16 a[24:25], v16 offset:3072
  ds_read_b64_tr_b16 a[26:27], v16 offset:4608
  v_mfma_f32_32x32x16_bf16 v[80:95], a[4:7], a[48:51], v[80:95]
  ds_read_b64_tr_b16 a[28:29], v17 offset:3136
  ds_read_b64_tr_b16 a[30:31], v17 offset:4672
  v_mfma_f32_32x32x16_bf16 v[176:191], a[4:7], a[52:55], v[176:191]
  ds_read_b64_tr_b16 a[32:33], v16 offset:3200
  ds_read_b64_tr_b16 a[34:35], v16 offset:4736
  s_cmp_eq_u32 s62, 0
  s_cbranch_scc1 W_c_17
  s_add_u32 m0, s52, 1024
  s_nop 0
  buffer_load_dwordx4 v25, s[48:51], s60 offen lds
W_c_17:
  v_mfma_f32_32x32x16_bf16 v[96:111], a[8:11], a[48:51], v[96:111]
  ds_read_b64_tr_b16 a[36:37], v17 offset:3264
  ds_read_b64_tr_b16 a[38:39], v17 offset:4800
  v_mfma_f32_32x32x16_bf16 v[192:207], a[8:11], a[52:55], v[192:207]
  ds_read_b64_tr_b16 a[40:41], v16 offset:3328
  ds_read_b64_tr_b16 a[42:43], v16 offset:4864
  v_mfma_f32_32x32x16_bf16 v[112:127], a[12:15], a[48:51], v[112:127]
  ds_read_b64_tr_b16 a[44:45], v17 offset:3392
  ds_read_b64_tr_b16 a[46:47], v17 offset:4928
  s_cmp_eq_u32 s62, 0
  s_cbranch_scc1 W_c_18
  s_add_u32 m0, s52, 2048
  s_nop 0
  buffer_load_dwordx4 v26, s[48:51], s60 offen lds
W_c_18:
  v_mfma_f32_32x32x16_bf16 v[208:223], a[12:15], a[52:55], v[208:223]
  v_mfma_f32_32x32x16_bf16 v[128:143], a[16:19], a[48:51], v[128:143]
  v_mfma_f32_32x32x16_bf16 v[224:239], a[16:19], a[52:55], v[224:239]
  s_cmp_eq_u32 s62, 0
  s_cbranch_scc1 W_c_19
  s_add_u32 m0, s52, 3072
  s_nop 0
  buffer_load_dwordx4 v27, s[48:51], s60 offen lds
W_c_19:
  v_mfma_f32_32x32x16_bf16 v[144:159], a[20:23], a[48:51], v[144:159]
  v_mfma_f32_32x32x16_bf16 v[240:255], a[20:23], a[52:55], v[240:255]
  s_waitcnt lgkmcnt(0)
  v_mfma_f32_32x32x16_bf16 v[64:79], a[24:27], a[56:59], v[64:79]
  ds_read_b128 a[48:51], v34 offset:32768
  ds_read_b128 a[52:55], v34 offset:36864
  s_cmp_eq_u32 s62, 0
  s_cbranch_scc1 W_c_20
  s_add_u32 m0, s52, 4096
  s_nop 0
  buffer_load_dwordx4 v28, s[48:51], s60 offen lds
W_c_20:
  v_mfma_f32_32x32x16_bf16 v[160:175], a[24:27], a[60:63], v[160:175]
  ds_read_b64_tr_b16 a[0:1], v16 offset:6144
  ds_read_b64_tr_b16 a[2:3], v16 offset:7680
  v_mfma_f32_32x32x16_bf16 v[80:95], a[28:31], a[56:59], v[80:95]
  ds_read_b64_tr_b16 a[4:5], v17 offset:6208
  ds_read_b64_tr_b16 a[6:7], v17 offset:7744
  v_mfma_f32_32x32x16_bf16 v[176:191], a[28:31], a[60:63], v[176:191]
  ds_read_b64_tr_b16 a[8:9], v16 offset:6272
  ds_read_b64_tr_b16 a[10:11], v16 offset:7808
  s_cmp_eq_u32 s62, 0
  s_cbranch_scc1 W_c_21
  s_add_u32 m0, s52, 5120
  s_nop 0
  buffer_load_dwordx4 v29, s[48:51], s60 offen lds
W_c_21:
  v_mfma_f32_32x32x16_bf16 v[96:111], a[32:35], a[56:59], v[96:111]
  ds_read_b64_tr_b16 a[12:13], v17 offset:6336
  ds_read_b64_tr_b16 a[14:15], v17 offset:7872
  v_mfma_f32_32x32x16_bf16 v[192:207], a[32:35], a[60:63], v[192:207]
  ds_read_b64_tr_b16 a[16:17], v16 offset:6400
  ds_read_b64_tr_b16 a[18:19], v16 offset:7936
  v_mfma_f32_32x32x16_bf16 v[112:127], a[36:39], a[56:59], v[112:127]
  ds_read_b64_tr_b16 a[20:21], v17 offset:6464
  ds_read_b64_tr_b16 a[22:23], v17 offset:8000
  s_cmp_eq_u32 s62, 0
  s_cbranch_scc1 W_c_22
  s_add_u32 m0, s52, 6144
  s_nop 0
  buffer_load_dwordx4 v30, s[48:51], s60 offen lds
W_c_22:
  v_mfma_f32_32x32x16_bf16 v[208:223], a[36:39], a[60:63], v[208:223]
  v_mfma_f32_32x32x16_bf16 v[128:143], a[40:43], a[56:59], v[128:143]
  v_mfma_f32_32x32x16_bf16 v[224:239], a[40:43], a[60:63], v[224:239]
  s_cmp_eq_u32 s62, 0
  s_cbranch_scc1 W_c_23
  s_add_u32 m0, s52, 7168
  s_nop 0
  buffer_load_dwordx4 v31, s[48:51], s60 offen lds
  s_add_u32 s60, s60, 128
W_c_23:
  v_mfma_f32_32x32x16_bf16 v[144:159], a[44:47], a[56:59], v[144:159]
  v_mfma_f32_32x32x16_bf16 v[240:255], a[44:47], a[60:63], v[240:255]
  s_waitcnt lgkmcnt(0)
  v_mfma_f32_32x32x16_bf16 v[64:79], a[0:3], a[48:51], v[64:79]
  ds_read_b128 a[56:59], v35 offset:32768
  ds_read_b128 a[60:63], v35 offset:36864
  s_cmp_eq_u32 s62, 0
  s_cbranch_scc1 W_c_24
  s_add_u32 m0, s29, s32
  s_nop 0
  buffer_load_dwordx4 v8, s[56:59], s61 offen lds
W_c_24:
  v_mfma_f32_32x32x16_bf16 v[160:175], a[0:3], a[52:55], v[160:175]
  ds_read_b64_tr_b16 a[24:25], v16 offset:9216
  ds_read_b64_tr_b16 a[26:27], v16 offset:10752
  v_mfma_f32_32x32x16_bf16 v[80:95], a[4:7], a[48:51], v[80:95]
  ds_read_b64_tr_b16 a[28:29], v17 offset:9280
  ds_read_b64_tr_b16 a[30:31], v17 offset:10816
  v_mfma_f32_32x32x16_bf16 v[176:191], a[4:7], a[52:55], v[176:191]
  ds_read_b64_tr_b16 a[32:33], v16 offset:9344
  ds_read_b64_tr_b16 a[34:35], v16 offset:10880
  s_cmp_eq_u32 s62, 0
  s_cbranch_scc1 W_c_25
  s_add_u32 m0, m0, 1024
  s_nop 0
  buffer_load_dwordx4 v9, s[56:59], s61 offen lds
W_c_25:
  v_mfma_f32_32x32x16_bf16 v[96:111], a[8:11], a[48:51], v[96:111]
  ds_read_b64_tr_b16 a[36:37], v17 offset:9408
  ds_read_b64_tr_b16 a[38:39], v17 offset:10944
  v_mfma_f32_32x32x16_bf16 v[192:207], a[8:11], a[52:55], v[192:207]
  ds_read_b64_tr_b16 a[40:41], v16 offset:9472
  ds_read_b64_tr_b16 a[42:43], v16 offset:11008
  v_mfma_f32_32x32x16_bf16 v[112:127], a[12:15], a[48:51], v[112:127]
  ds_read_b64_tr_b16 a[44:45], v17 offset:9536
  ds_read_b64_tr_b16 a[46:47], v17 offset:11072
  s_cmp_eq_u32 s62, 0
  s_cbranch_scc1 W_c_26
  s_add_u32 m0, m0, 1024
  s_nop 0
  buffer_load_dwordx4 v10, s[56:59], s61 offen lds
W_c_26:
  v_mfma_f32_32x32x16_bf16 v[208:223], a[12:15], a[52:55], v[208:223]
  v_mfma_f32_32x32x16_bf16 v[128:143], a[16:19], a[48:51], v[128:143]
  v_mfma_f32_32x32x16_bf16 v[224:239], a[16:19], a[52:55], v[224:239]
  s_cmp_eq_u32 s62, 0
  s_cbranch_scc1 W_c_27
  s_add_u32 m0, m0, 1024
  s_nop 0
  buffer_load_dwordx4 v11, s[56:59], s61 offen lds
W_c_27:
  v_mfma_f32_32x32x16_bf16 v[144:159], a[20:23], a[48:51], v[144:159]
  v_mfma_f32_32x32x16_bf16 v[240:255], a[20:23], a[52:55], v[240:255]
  s_waitcnt lgkmcnt(0)
  v_mfma_f32_32x32x16_bf16 v[64:79], a[24:27], a[56:59], v[64:79]
  s_cmp_eq_u32 s62, 0
  s_cbranch_scc1 W_c_28
  s_add_u32 m0, m0, 1024
  s_nop 0
  buffer_load_dwordx4 v12, s[56:59], s61 offen lds
W_c_28:
  v_mfma_f32_32x32x16_bf16 v[160:175], a[24:27], a[60:63], v[160:175]
  v_mfma_f32_32x32x16_bf16 v[80:95], a[28:31], a[56:59], v[80:95]
  v_mfma_f32_32x32x16_bf16 v[176:191], a[28:31], a[60:63], v[176:191]
  s_cmp_eq_u32 s62, 0
  s_cbranch_scc1 W_c_29
  s_add_u32 m0, m0, 1024
  s_nop 0
  buffer_load_dwordx4 v13, s[56:59], s61 offen lds
  s_add_u32 s61, s61, s28
  s_add_u32 s29, s29, 24576
  s_cmp_eq_u32 s29, 98304
  s_cselect_b32 s29, 0, s29
W_c_29:
  v_mfma_f32_32x32x16_bf16 v[96:111], a[32:35], a[56:59], v[96:111]
  v_mfma_f32_32x32x16_bf16 v[192:207], a[32:35], a[60:63], v[192:207]
  v_mfma_f32_32x32x16_bf16 v[112:127], a[36:39], a[56:59], v[112:127]
  v_mfma_f32_32x32x16_bf16 v[208:223], a[36:39], a[60:63], v[208:223]
  v_mfma_f32_32x32x16_bf16 v[128:143], a[40:43], a[56:59], v[128:143]
  v_mfma_f32_32x32x16_bf16 v[224:239], a[40:43], a[60:63], v[224:239]
  v_mfma_f32_32x32x16_bf16 v[144:159], a[44:47], a[56:59], v[144:159]
  v_mfma_f32_32x32x16_bf16 v[240:255], a[44:47], a[60:63], v[240:255]
  s_cmp_eq_u32 s62, 0
  s_cbranch_scc1 W_wh_31
  s_waitcnt vmcnt(6)
  s_barrier
  s_add_u32 s30, s30, 24576
  s_cmp_eq_u32 s30, 98304
  s_cselect_b32 s30, 0, s30
  v_add_u32 v16, s30, v14
  v_add_u32 v17, s30, v15
  ds_read_b128 a[48:51], v32 offset:0
  ds_read_b128 a[52:55], v32 offset:4096
  ds_read_b64_tr_b16 a[0:1], v16 offset:0
  ds_read_b64_tr_b16 a[2:3], v16 offset:1536
  ds_read_b64_tr_b16 a[4:5], v17 offset:64
  ds_read_b64_tr_b16 a[6:7], v17 offset:1600
  ds_read_b64_tr_b16 a[8:9], v16 offset:128
  ds_read_b64_tr_b16 a[10:11], v16 offset:1664
  ds_read_b64_tr_b16 a[12:13], v17 offset:192
  ds_read_b64_tr_b16 a[14:15], v17 offset:1728
  ds_read_b64_tr_b16 a[16:17], v16 offset:256
  ds_read_b64_tr_b16 a[18:19], v16 offset:1792
  ds_read_b64_tr_b16 a[20:21], v17 offset:320
  ds_read_b64_tr_b16 a[22:23], v17 offset:1856
W_wh_31:
  s_nop 7
  v_cvt_pk_bf16_f32 v40, v64, v65
  v_cvt_pk_bf16_f32 v41, v66, v67
  v_cvt_pk_bf16_f32 v42, v68, v69
  v_cvt_pk_bf16_f32 v43, v70, v71
  s_add_u32 s25, s31, 0
  buffer_store_dwordx4 v[40:43], v36, s[8:11], s25 offen offset:0 sc1
  v_cvt_pk_bf16_f32 v44, v72, v73
  v_cvt_pk_bf16_f32 v45, v74, v75
  v_cvt_pk_bf16_f32 v46, v76, v77
  v_cvt_pk_bf16_f32 v47, v78, v79
  buffer_store_dwordx4 v[44:47], v36, s[8:11], s25 offen offset:1024 sc1
  v_cvt_pk_bf16_f32 v48, v80, v81
  v_cvt_pk_bf16_f32 v49, v82, v83
  v_cvt_pk_bf16_f32 v50, v84, v85
  v_cvt_pk_bf16_f32 v51, v86, v87
  buffer_store_dwordx4 v[48:51], v36, s[8:11], s25 offen offset:2048 sc1
  v_cvt_pk_bf16_f32 v52, v88, v89
  v_cvt_pk_bf16_f32 v53, v90, v91
  v_cvt_pk_bf16_f32 v54, v92, v93
  v_cvt_pk_bf16_f32 v55, v94, v95
  buffer_store_dwordx4 v[52:55], v36, s[8:11], s25 offen offset:3072 sc1
  v_cvt_pk_bf16_f32 v56, v96, v97
  v_cvt_pk_bf16_f32 v57, v98, v99
  v_cvt_pk_bf16_f32 v58, v100, v101
  v_cvt_pk_bf16_f32 v59, v102, v103
  s_add_u32 s25, s31, 4096
  buffer_store_dwordx4 v[56:59], v36, s[8:11], s25 offen offset:0 sc1
  v_cvt_pk_bf16_f32 v60, v104, v105
  v_cvt_pk_bf16_f32 v61, v106, v107
  v_cvt_pk_bf16_f32 v62, v108, v109
  v_cvt_pk_bf16_f32 v63, v110, v111
  buffer_store_dwordx4 v[60:63], v36, s[8:11], s25 offen offset:1024 sc1
  v_cvt_pk_bf16_f32 v40, v112, v113
  v_cvt_pk_bf16_f32 v41, v114, v115
  v_cvt_pk_bf16_f32 v42, v116, v117
  v_cvt_pk_bf16_f32 v43, v118, v119
  buffer_store_dwordx4 v[40:43], v36, s[8:11], s25 offen offset:2048 sc1
  v_cvt_pk_bf16_f32 v44, v120, v121
  v_cvt_pk_bf16_f32 v45, v122, v123
  v_cvt_pk_bf16_f32 v46, v124, v125
  v_cvt_pk_bf16_f32 v47, v126, v127
  buffer_store_dwordx4 v[44:47], v36, s[8:11], s25 offen offset:3072 sc1
  v_cvt_pk_bf16_f32 v48, v128, v129
  v_cvt_pk_bf16_f32 v49, v130, v131
  v_cvt_pk_bf16_f32 v50, v132, v133
  v_cvt_pk_bf16_f32 v51, v134, v135
  s_add_u32 s25, s31, 8192
  buffer_store_dwordx4 v[48:51], v36, s[8:11], s25 offen offset:0 sc1
  v_cvt_pk_bf16_f32 v52, v136, v137
  v_cvt_pk_bf16_f32 v53, v138, v139
  v_cvt_pk_bf16_f32 v54, v140, v141
  v_cvt_pk_bf16_f32 v55, v142, v143
  buffer_store_dwordx4 v[52:55], v36, s[8:11], s25 offen offset:1024 sc1
  v_cvt_pk_bf16_f32 v56, v144, v145
  v_cvt_pk_bf16_f32 v57, v146, v147
  v_cvt_pk_bf16_f32 v58, v148, v149
  v_cvt_pk_bf16_f32 v59, v150, v151
  buffer_store_dwordx4 v[56:59], v36, s[8:11], s25 offen offset:2048 sc1
  v_cvt_pk_bf16_f32 v60, v152, v153
  v_cvt_pk_bf16_f32 v61, v154, v155
  v_cvt_pk_bf16_f32 v62, v156, v157
  v_cvt_pk_bf16_f32 v63, v158, v159
  buffer_store_dwordx4 v[60:63], v36, s[8:11], s25 offen offset:3072 sc1
  v_cvt_pk_bf16_f32 v40, v160, v161
  v_cvt_pk_bf16_f32 v41, v162, v163
  v_cvt_pk_bf16_f32 v42, v164, v165
  v_cvt_pk_bf16_f32 v43, v166, v167
  s_add_u32 s25, s35, s31
  s_add_u32 s25, s25, 0
  buffer_store_dwordx4 v[40:43], v36, s[8:11], s25 offen offset:0 sc1
  v_cvt_pk_bf16_f32 v44, v168, v169
  v_cvt_pk_bf16_f32 v45, v170, v171
  v_cvt_pk_bf16_f32 v46, v172, v173
  v_cvt_pk_bf16_f32 v47, v174, v175
  buffer_store_dwordx4 v[44:47], v36, s[8:11], s25 offen offset:1024 sc1
  v_cvt_pk_bf16_f32 v48, v176, v177
  v_cvt_pk_bf16_f32 v49, v178, v179
  v_cvt_pk_bf16_f32 v50, v180, v181
  v_cvt_pk_bf16_f32 v51, v182, v183
  buffer_store_dwordx4 v[48:51], v36, s[8:11], s25 offen offset:2048 sc1
  v_cvt_pk_bf16_f32 v52, v184, v185
  v_cvt_pk_bf16_f32 v53, v186, v187
  v_cvt_pk_bf16_f32 v54, v188, v189
  v_cvt_pk_bf16_f32 v55, v190, v191
  buffer_store_dwordx4 v[52:55], v36, s[8:11], s25 offen offset:3072 sc1
  v_cvt_pk_bf16_f32 v56, v192, v193
  v_cvt_pk_bf16_f32 v57, v194, v195
  v_cvt_pk_bf16_f32 v58, v196, v197
  v_cvt_pk_bf16_f32 v59, v198, v199
  s_add_u32 s25, s35, s31
  s_add_u32 s25, s25, 4096
  buffer_store_dwordx4 v[56:59], v36, s[8:11], s25 offen offset:0 sc1
  v_cvt_pk_bf16_f32 v60, v200, v201
  v_cvt_pk_bf16_f32 v61, v202, v203
  v_cvt_pk_bf16_f32 v62, v204, v205
  v_cvt_pk_bf16_f32 v63, v206, v207
  buffer_store_dwordx4 v[60:63], v36, s[8:11], s25 offen offset:1024 sc1
  v_cvt_pk_bf16_f32 v40, v208, v209
  v_cvt_pk_bf16_f32 v41, v210, v211
  v_cvt_pk_bf16_f32 v42, v212, v213
  v_cvt_pk_bf16_f32 v43, v214, v215
  buffer_store_dwordx4 v[40:43], v36, s[8:11], s25 offen offset:2048 sc1
  v_cvt_pk_bf16_f32 v44, v216, v217
  v_cvt_pk_bf16_f32 v45, v218, v219
  v_cvt_pk_bf16_f32 v46, v220, v221
  v_cvt_pk_bf16_f32 v47, v222, v223
  buffer_store_dwordx4 v[44:47], v36, s[8:11], s25 offen offset:3072 sc1
  v_cvt_pk_bf16_f32 v48, v224, v225
  v_cvt_pk_bf16_f32 v49, v226, v227
  v_cvt_pk_bf16_f32 v50, v228, v229
  v_cvt_pk_bf16_f32 v51, v230, v231
  s_add_u32 s25, s35, s31
  s_add_u32 s25, s25, 8192
  buffer_store_dwordx4 v[48:51], v36, s[8:11], s25 offen offset:0 sc1
  v_cvt_pk_bf16_f32 v52, v232, v233
  v_cvt_pk_bf16_f32 v53, v234, v235
  v_cvt_pk_bf16_f32 v54, v236, v237
  v_cvt_pk_bf16_f32 v55, v238, v239
  buffer_store_dwordx4 v[52:55], v36, s[8:11], s25 offen offset:1024 sc1
  v_cvt_pk_bf16_f32 v56, v240, v241
  v_cvt_pk_bf16_f32 v57, v242, v243
  v_cvt_pk_bf16_f32 v58, v244, v245
  v_cvt_pk_bf16_f32 v59, v246, v247
  buffer_store_dwordx4 v[56:59], v36, s[8:11], s25 offen offset:2048 sc1
  v_cvt_pk_bf16_f32 v60, v248, v249
  v_cvt_pk_bf16_f32 v61, v250, v251
  v_cvt_pk_bf16_f32 v62, v252, v253
  v_cvt_pk_bf16_f32 v63, v254, v255
  buffer_store_dwordx4 v[60:63], v36, s[8:11], s25 offen offset:3072 sc1
  s_cmp_eq_u32 s81, 0
  s_cbranch_scc1 W_sp_33
  v_mbcnt_lo_u32_b32 v3, -1, 0
  v_and_b32 v3, 15, v3
  v_min_u32 v3, 8, v3
  v_and_b32 v4, 1, v3
  v_lshlrev_b32 v3, 2, v3
  v_lshl_add_u32 v3, v4, 7, v3
W_sp_33c:
  buffer_load_dword v2, v3, s[4:7], 0 offen sc1
  s_sub_u32 s82, s82, 1
  s_cbranch_scc1 W_abort
  s_waitcnt vmcnt(0)
  v_readlane_b32 s84, v2, 0
  v_readlane_b32 s85, v2, 1
  v_readlane_b32 s86, v2, 2
  v_readlane_b32 s87, v2, 3
  v_readlane_b32 s88, v2, 4
  v_readlane_b32 s89, v2, 5
  v_readlane_b32 s90, v2, 6
  v_readlane_b32 s91, v2, 7
  v_readlane_b32 s92, v2, 8
  s_cmp_eq_u32 s92, 256
  s_cbranch_scc1 W_sp_33c_ok
  s_sleep 8
  s_branch W_sp_33c
W_sp_33c_ok:
  s_mov_b32 s81, 0
  s_and_b32 s25, s84, s85
  s_and_b32 s25, s25, s86
  s_and_b32 s25, s25, s87
  s_and_b32 s25, s25, s88
  s_and_b32 s25, s25, s89
  s_and_b32 s25, s25, s90
  s_and_b32 s25, s25, s91
  s_cmp_eq_u32 s25, 32
  s_cbranch_scc1 W_sp_33r
  s_waitcnt vmcnt(0) lgkmcnt(0)
  s_barrier
  s_branch M_worker
W_sp_33r:
  s_load_dwordx2 s[84:85], s[0:1], 0
  s_load_dwordx2 s[86:87], s[0:1], 56
  s_waitcnt lgkmcnt(0)
W_sp_33:
  s_cmp_eq_u32 s62, 0
  s_cbranch_scc1 W_fin_32
  s_mov_b32 s53, s36
  s_cmp_eq_u32 s24, 0
  s_cselect_b32 s54, s39, 0
  s_branch W_warm
W_fin_32:
  s_waitcnt vmcnt(0)
  s_barrier
  s_mov_b32 s53, s36
  s_cmp_eq_u32 s24, 0
  s_cselect_b32 s54, s39, 0
  s_cmp_eq_u32 s54, 0
  s_cbranch_scc1 W_pf_34
  v_mov_b32 v2, 1
  v_lshlrev_b32 v3, 2, v1
  s_mov_b32 exec_hi, 0
  s_mov_b32 exec_lo, s54
  buffer_store_dword v2, v3, s[8:11], s53 offen sc1
  s_mov_b64 exec, -1
  s_mov_b32 s54, 0
W_pf_34:
  s_branch W_next
W_vu:
  v_lshrrev_b32 v4, 3, v1
  s_mul_i32 s25, s24, 64
  v_add_u32 v4, s25, v4
  v_mul_u32_u24 v4, 1280, v4
  v_lshrrev_b32 v5, 4, v1
  v_and_b32 v6, 7, v1
  v_xor_b32 v5, v5, v6
  v_lshl_add_u32 v24, v5, 4, v4
  v_xor_b32 v5, 4, v5
  v_lshl_add_u32 v25, v5, 4, v4
  v_add_u32 v25, 10240, v25
  v_add_u32 v26, 20480, v24
  v_add_u32 v27, 20480, v25
  v_add_u32 v28, 20480, v26
  v_add_u32 v29, 20480, v27
  v_add_u32 v30, 20480, v28
  v_add_u32 v31, 20480, v29
  s_mul_i32 s52, s24, 8192
  s_add_u32 s52, s52, 98304
  s_mul_i32 s25, s24, 384
  s_add_u32 s25, s25, 0
  v_add_u32 v4, s25, v1
  v_mul_u32_u24 v5, 2731, v4
  v_lshrrev_b32 v5, 16, v5
  v_mul_u32_u24 v6, 24, v5
  v_sub_u32 v6, v4, v6
  v_lshlrev_b32 v7, 1, v5
  v_and_b32 v7, 4, v7
  v_xor_b32 v6, v6, v7
  v_mul_lo_u32 v5, v5, s33
  v_lshl_add_u32 v8, v6, 4, v5
  s_mul_i32 s25, s24, 384
  s_add_u32 s25, s25, 64
  v_add_u32 v4, s25, v1
  v_mul_u32_u24 v5, 2731, v4
  v_lshrrev_b32 v5, 16, v5
  v_mul_u32_u24 v6, 24, v5
  v_sub_u32 v6, v4, v6
  v_lshlrev_b32 v7, 1, v5
  v_and_b32 v7, 4, v7
  v_xor_b32 v6, v6, v7
  v_mul_lo_u32 v5, v5, s33
  v_lshl_add_u32 v9, v6, 4, v5
  s_mul_i32 s25, s24, 384
  s_add_u32 s25, s25, 128
  v_add_u32 v4, s25, v1
  v_mul_u32_u24 v5, 2731, v4
  v_lshrrev_b32 v5, 16, v5
  v_mul_u32_u24 v6, 24, v5
  v_sub_u32 v6, v4, v6
  v_lshlrev_b32 v7, 1, v5
  v_and_b32 v7, 4, v7
  v_xor_b32 v6, v6, v7
  v_mul_lo_u32 v5, v5, s33
  v_lshl_add_u32 v10, v6, 4, v5
  s_mul_i32 s25, s24, 384
  s_add_u32 s25, s25, 192
  v_add_u32 v4, s25, v1
  v_mul_u32_u24 v5, 2731, v4
  v_lshrrev_b32 v5, 16, v5
  v_mul_u32_u24 v6, 24, v5
  v_sub_u32 v6, v4, v6
  v_lshlrev_b32 v7, 1, v5
  v_and_b32 v7, 4, v7
  v_xor_b32 v6, v6, v7
  v_mul_lo_u32 v5, v5, s33
  v_lshl_add_u32 v11, v6, 4, v5
  s_mul_i32 s25, s24, 384
  s_add_u32 s25, s25, 256
  v_add_u32 v4, s25, v1
  v_mul_u32_u24 v5, 2731, v4
  v_lshrrev_b32 v5, 16, v5
  v_mul_u32_u24 v6, 24, v5
  v_sub_u32 v6, v4, v6
  v_lshlrev_b32 v7, 1, v5
  v_and_b32 v7, 4, v7
  v_xor_b32 v6, v6, v7
  v_mul_lo_u32 v5, v5, s33
  v_lshl_add_u32 v12, v6, 4, v5
  s_mul_i32 s25, s24, 384
  s_add_u32 s25, s25, 320
  v_add_u32 v4, s25, v1
  v_mul_u32_u24 v5, 2731, v4
  v_lshrrev_b32 v5, 16, v5
  v_mul_u32_u24 v6, 24, v5
  v_sub_u32 v6, v4, v6
  v_lshlrev_b32 v7, 1, v5
  v_and_b32 v7, 4, v7
  v_xor_b32 v6, v6, v7
  v_mul_lo_u32 v5, v5, s33
  v_lshl_add_u32 v13, v6, 4, v5
  s_lshl_b32 s28, s33, 6
  s_mul_i32 s32, s24, 6144
  s_mov_b32 s29, 0
  s_add_u32 m0, s29, s32
  s_nop 0
  buffer_load_dwordx4 v8, s[12:15], s27 offen lds
  s_add_u32 m0, m0, 1024
  s_nop 0
  buffer_load_dwordx4 v9, s[12:15], s27 offen lds
  s_add_u32 m0, m0, 1024
  s_nop 0
  buffer_load_dwordx4 v10, s[12:15], s27 offen lds
  s_add_u32 m0, m0, 1024
  s_nop 0
  buffer_load_dwordx4 v11, s[12:15], s27 offen lds
  s_add_u32 m0, m0, 1024
  s_nop 0
  buffer_load_dwordx4 v12, s[12:15], s27 offen lds
  s_add_u32 m0, m0, 1024
  s_nop 0
  buffer_load_dwordx4 v13, s[12:15], s27 offen lds
  s_add_u32 s27, s27, s28
  s_add_u32 s29, s29, 24576
  s_cmp_eq_u32 s29, 98304
  s_cselect_b32 s29, 0, s29
  s_add_u32 m0, s52, 0
  s_nop 0
  buffer_load_dwordx4 v24, s[48:51], s26 offen lds
  s_add_u32 m0, s52, 1024
  s_nop 0
  buffer_load_dwordx4 v25, s[48:51], s26 offen lds
  s_add_u32 m0, s52, 2048
  s_nop 0
  buffer_load_dwordx4 v26, s[48:51], s26 offen lds
  s_add_u32 m0, s52, 3072
  s_nop 0
  buffer_load_dwordx4 v27, s[48:51], s26 offen lds
  s_add_u32 m0, s52, 4096
  s_nop 0
  buffer_load_dwordx4 v28, s[48:51], s26 offen lds
  s_add_u32 m0, s52, 5120
  s_nop 0
  buffer_load_dwordx4 v29, s[48:51], s26 offen lds
  s_add_u32 m0, s52, 6144
  s_nop 0
  buffer_load_dwordx4 v30, s[48:51], s26 offen lds
  s_add_u32 m0, s52, 7168
  s_nop 0
  buffer_load_dwordx4 v31, s[48:51], s26 offen lds
  s_add_u32 s26, s26, 128
  s_add_u32 m0, s29, s32
  s_nop 0
  buffer_load_dwordx4 v8, s[12:15], s27 offen lds
  s_add_u32 m0, m0, 1024
  s_nop 0
  buffer_load_dwordx4 v9, s[12:15], s27 offen lds
  s_add_u32 m0, m0, 1024
  s_nop 0
  buffer_load_dwordx4 v10, s[12:15], s27 offen lds
  s_add_u32 m0, m0, 1024
  s_nop 0
  buffer_load_dwordx4 v11, s[12:15], s27 offen lds
  s_add_u32 m0, m0, 1024
  s_nop 0
  buffer_load_dwordx4 v12, s[12:15], s27 offen lds
  s_add_u32 m0, m0, 1024
  s_nop 0
  buffer_load_dwordx4 v13, s[12:15], s27 offen lds
  s_add_u32 s27, s27, s28
  s_add_u32 s29, s29, 24576
  s_cmp_eq_u32 s29, 98304
  s_cselect_b32 s29, 0, s29
  s_mul_i32 s25, s24, 64
  v_and_b32 v4, 31, v1
  v_bfe_u32 v5, v1, 1, 3
  v_lshrrev_b32 v6, 5, v1
  v_lshlrev_b32 v6, 2, v6
  v_xor_b32 v5, v5, v6
  v_add_u32 v4, s25, v4
  v_lshlrev_b32 v4, 7, v4
  v_add_u32 v4, 98304, v4
  v_xor_b32 v6, 0, v5
  v_lshl_add_u32 v32, v6, 4, v4
  v_xor_b32 v6, 1, v5
  v_lshl_add_u32 v33, v6, 4, v4
  v_xor_b32 v6, 2, v5
  v_lshl_add_u32 v34, v6, 4, v4
  v_xor_b32 v6, 3, v5
  v_lshl_add_u32 v35, v6, 4, v4
  v_lshrrev_b32 v4, 5, v1
  v_bfe_u32 v5, v1, 2, 2
  v_mul_u32_u24 v4, 32, v4
  v_add_u32 v4, v4, v5
  v_mul_u32_u24 v4, 384, v4
  v_bfe_u32 v6, v1, 4, 1
  v_lshl_add_u32 v4, v6, 5, v4
  v_and_b32 v6, 3, v1
  v_lshl_add_u32 v4, v6, 3, v4
  v_bfe_u32 v5, v1, 3, 1
  v_lshlrev_b32 v5, 6, v5
  v_add_u32 v14, v4, v5
  v_sub_u32 v15, v4, v5
  v_lshlrev_b32 v36, 4, v1
  s_mul_i32 s25, s24, 320
  s_add_u32 s25, s25, 0
  v_add_u32 v4, s25, v1
  v_mul_u32_u24 v5, 3277, v4
  v_lshrrev_b32 v5, 16, v5
  v_mul_u32_u24 v6, 20, v5
  v_sub_u32 v6, v4, v6
  v_mul_u32_u24 v5, 1280, v5
  v_lshl_add_u32 v18, v6, 4, v5
  s_mul_i32 s25, s24, 320
  s_add_u32 s25, s25, 64
  v_add_u32 v4, s25, v1
  v_mul_u32_u24 v5, 3277, v4
  v_lshrrev_b32 v5, 16, v5
  v_mul_u32_u24 v6, 20, v5
  v_sub_u32 v6, v4, v6
  v_mul_u32_u24 v5, 1280, v5
  v_lshl_add_u32 v19, v6, 4, v5
  s_mul_i32 s25, s24, 320
  s_add_u32 s25, s25, 128
  v_add_u32 v4, s25, v1
  v_mul_u32_u24 v5, 3277, v4
  v_lshrrev_b32 v5, 16, v5
  v_mul_u32_u24 v6, 20, v5
  v_sub_u32 v6, v4, v6
  v_mul_u32_u24 v5, 1280, v5
  v_lshl_add_u32 v20, v6, 4, v5
  s_mul_i32 s25, s24, 320
  s_add_u32 s25, s25, 192
  v_add_u32 v4, s25, v1
  v_mul_u32_u24 v5, 3277, v4
  v_lshrrev_b32 v5, 16, v5
  v_mul_u32_u24 v6, 20, v5
  v_sub_u32 v6, v4, v6
  v_mul_u32_u24 v5, 1280, v5
  v_lshl_add_u32 v21, v6, 4, v5
  s_mul_i32 s25, s24, 320
  s_add_u32 s25, s25, 256
  v_add_u32 v4, s25, v1
  v_mul_u32_u24 v5, 3277, v4
  v_lshrrev_b32 v5, 16, v5
  v_mul_u32_u24 v6, 20, v5
  v_sub_u32 v6, v4, v6
  v_mul_u32_u24 v5, 1280, v5
  v_lshl_add_u32 v22, v6, 4, v5
  v_lshrrev_b32 v4, 5, v1
  v_bfe_u32 v5, v1, 2, 2
  v_mul_u32_u24 v4, 4, v4
  v_add_u32 v4, v4, v5
  v_mul_u32_u24 v4, 320, v4
  v_bfe_u32 v6, v1, 4, 1
  v_lshl_add_u32 v4, v6, 5, v4
  v_and_b32 v6, 3, v1
  v_lshl_add_u32 v4, v6, 3, v4
  v_mov_b32 v23, v4
  s_mul_i32 s34, s24, 5120
  s_mov_b32 s54, 0
  s_waitcnt vmcnt(6)
  s_barrier
  v_mov_b32 v16, v14
  v_mov_b32 v17, v15
  s_mov_b32 s30, 0
  ds_read_b128 a[48:51], v32 offset:0
  ds_read_b128 a[52:55], v32 offset:4096
  ds_read_b64_tr_b16 a[0:1], v16 offset:0
  ds_read_b64_tr_b16 a[2:3], v16 offset:1536
  ds_read_b64_tr_b16 a[4:5], v17 offset:64
  ds_read_b64_tr_b16 a[6:7], v17 offset:1600
  ds_read_b64_tr_b16 a[8:9], v16 offset:128
  ds_read_b64_tr_b16 a[10:11], v16 offset:1664
  ds_read_b64_tr_b16 a[12:13], v17 offset:192
  ds_read_b64_tr_b16 a[14:15], v17 offset:1728
  ds_read_b64_tr_b16 a[16:17], v16 offset:256
  ds_read_b64_tr_b16 a[18:19], v16 offset:1792
  ds_read_b64_tr_b16 a[20:21], v17 offset:320
  ds_read_b64_tr_b16 a[22:23], v17 offset:1856
W_vu_warm:
  s_mov_b32 s40, 0
  s_waitcnt lgkmcnt(0)
  v_mfma_f32_32x32x16_bf16 v[64:79], a[0:3], a[48:51], 0
  ds_read_b128 a[56:59], v33 offset:0
  ds_read_b128 a[60:63], v33 offset:4096
  s_add_u32 m0, s52, 32768
  s_nop 0
  buffer_load_dwordx4 v24, s[48:51], s26 offen lds
  v_mfma_f32_32x32x16_bf16 v[160:175], a[0:3], a[52:55], 0
  ds_read_b64_tr_b16 a[24:25], v16 offset:3072
  ds_read_b64_tr_b16 a[26:27], v16 offset:4608
  v_mfma_f32_32x32x16_bf16 v[80:95], a[4:7], a[48:51], 0
  ds_read_b64_tr_b16 a[28:29], v17 offset:3136
  ds_read_b64_tr_b16 a[30:31], v17 offset:4672
  s_add_u32 m0, s52, 33792
  s_nop 0
  buffer_load_dwordx4 v25, s[48:51], s26 offen lds
  v_mfma_f32_32x32x16_bf16 v[176:191], a[4:7], a[52:55], 0
  ds_read_b64_tr_b16 a[32:33], v16 offset:3200
  ds_read_b64_tr_b16 a[34:35], v16 offset:4736
  v_mfma_f32_32x32x16_bf16 v[96:111], a[8:11], a[48:51], 0
  ds_read_b64_tr_b16 a[36:37], v17 offset:3264
  ds_read_b64_tr_b16 a[38:39], v17 offset:4800
  s_add_u32 m0, s52, 34816
  s_nop 0
  buffer_load_dwordx4 v26, s[48:51], s26 offen lds
  v_mfma_f32_32x32x16_bf16 v[192:207], a[8:11], a[52:55], 0
  ds_read_b64_tr_b16 a[40:41], v16 offset:3328
  ds_read_b64_tr_b16 a[42:43], v16 offset:4864
  v_mfma_f32_32x32x16_bf16 v[112:127], a[12:15], a[48:51], 0
  ds_read_b64_tr_b16 a[44:45], v17 offset:3392
  ds_read_b64_tr_b16 a[46:47], v17 offset:4928
  s_add_u32 m0, s52, 35840
  s_nop 0
  buffer_load_dwordx4 v27, s[48:51], s26 offen lds
  v_mfma_f32_32x32x16_bf16 v[208:223], a[12:15], a[52:55], 0
  v_mfma_f32_32x32x16_bf16 v[128:143], a[16:19], a[48:51], 0
  s_add_u32 m0, s52, 36864
  s_nop 0
  buffer_load_dwordx4 v28, s[48:51], s26 offen lds
  v_mfma_f32_32x32x16_bf16 v[224:239], a[16:19], a[52:55], 0
  v_mfma_f32_32x32x16_bf16 v[144:159], a[20:23], a[48:51], 0
  s_add_u32 m0, s52, 37888
  s_nop 0
  buffer_load_dwordx4 v29, s[48:51], s26 offen lds
  v_mfma_f32_32x32x16_bf16 v[240:255], a[20:23], a[52:55], 0
  s_waitcnt lgkmcnt(0)
  v_mfma_f32_32x32x16_bf16 v[64:79], a[24:27], a[56:59], v[64:79]
  ds_read_b128 a[48:51], v34 offset:0
  ds_read_b128 a[52:55], v34 offset:4096
  s_add_u32 m0, s52, 38912
  s_nop 0
  buffer_load_dwordx4 v30, s[48:51], s26 offen lds
  v_mfma_f32_32x32x16_bf16 v[160:175], a[24:27], a[60:63], v[160:175]
  ds_read_b64_tr_b16 a[0:1], v16 offset:6144
  ds_read_b64_tr_b16 a[2:3], v16 offset:7680
  v_mfma_f32_32x32x16_bf16 v[80:95], a[28:31], a[56:59], v[80:95]
  ds_read_b64_tr_b16 a[4:5], v17 offset:6208
  ds_read_b64_tr_b16 a[6:7], v17 offset:7744
  s_add_u32 m0, s52, 39936
  s_nop 0
  buffer_load_dwordx4 v31, s[48:51], s26 offen lds
  s_add_u32 s26, s26, 128
  v_mfma_f32_32x32x16_bf16 v[176:191], a[28:31], a[60:63], v[176:191]
  ds_read_b64_tr_b16 a[8:9], v16 offset:6272
  ds_read_b64_tr_b16 a[10:11], v16 offset:7808
  v_mfma_f32_32x32x16_bf16 v[96:111], a[32:35], a[56:59], v[96:111]
  ds_read_b64_tr_b16 a[12:13], v17 offset:6336
  ds_read_b64_tr_b16 a[14:15], v17 offset:7872
  s_add_u32 m0, s29, s32
  s_nop 0
  buffer_load_dwordx4 v8, s[12:15], s27 offen lds
  v_mfma_f32_32x32x16_bf16 v[192:207], a[32:35], a[60:63], v[192:207]
  ds_read_b64_tr_b16 a[16:17], v16 offset:6400
  ds_read_b64_tr_b16 a[18:19], v16 offset:7936
  v_mfma_f32_32x32x16_bf16 v[112:127], a[36:39], a[56:59], v[112:127]
  ds_read_b64_tr_b16 a[20:21], v17 offset:6464
  ds_read_b64_tr_b16 a[22:23], v17 offset:8000
  v_mfma_f32_32x32x16_bf16 v[208:223], a[36:39], a[60:63], v[208:223]
  v_mfma_f32_32x32x16_bf16 v[128:143], a[40:43], a[56:59], v[128:143]
  v_mfma_f32_32x32x16_bf16 v[224:239], a[40:43], a[60:63], v[224:239]
  s_add_u32 m0, m0, 1024
  s_nop 0
  buffer_load_dwordx4 v9, s[12:15], s27 offen lds
  v_mfma_f32_32x32x16_bf16 v[144:159], a[44:47], a[56:59], v[144:159]
  v_mfma_f32_32x32x16_bf16 v[240:255], a[44:47], a[60:63], v[240:255]
  s_waitcnt lgkmcnt(0)
  v_mfma_f32_32x32x16_bf16 v[64:79], a[0:3], a[48:51], v[64:79]
  ds_read_b128 a[56:59], v35 offset:0
  ds_read_b128 a[60:63], v35 offset:4096
  v_mfma_f32_32x32x16_bf16 v[160:175], a[0:3], a[52:55], v[160:175]
  ds_read_b64_tr_b16 a[24:25], v16 offset:9216
  ds_read_b64_tr_b16 a[26:27], v16 offset:10752
  v_mfma_f32_32x32x16_bf16 v[80:95], a[4:7], a[48:51], v[80:95]
  ds_read_b64_tr_b16 a[28:29], v17 offset:9280
  ds_read_b64_tr_b16 a[30:31], v17 offset:10816
  s_add_u32 m0, m0, 1024
  s_nop 0
  buffer_load_dwordx4 v10, s[12:15], s27 offen lds
  v_mfma_f32_32x32x16_bf16 v[176:191], a[4:7], a[52:55], v[176:191]
  ds_read_b64_tr_b16 a[32:33], v16 offset:9344
  ds_read_b64_tr_b16 a[34:35], v16 offset:10880
  v_mfma_f32_32x32x16_bf16 v[96:111], a[8:11], a[48:51], v[96:111]
  ds_read_b64_tr_b16 a[36:37], v17 offset:9408
  ds_read_b64_tr_b16 a[38:39], v17 offset:10944
  v_mfma_f32_32x32x16_bf16 v[192:207], a[8:11], a[52:55], v[192:207]
  ds_read_b64_tr_b16 a[40:41], v16 offset:9472
  ds_read_b64_tr_b16 a[42:43], v16 offset:11008
  v_mfma_f32_32x32x16_bf16 v[112:127], a[12:15], a[48:51], v[112:127]
  ds_read_b64_tr_b16 a[44:45], v17 offset:9536
  ds_read_b64_tr_b16 a[46:47], v17 offset:11072
  v_mfma_f32_32x32x16_bf16 v[208:223], a[12:15], a[52:55], v[208:223]
  s_add_u32 m0, m0, 1024
  s_nop 0
  buffer_load_dwordx4 v11, s[12:15], s27 offen lds
  v_mfma_f32_32x32x16_bf16 v[128:143], a[16:19], a[48:51], v[128:143]
  v_mfma_f32_32x32x16_bf16 v[224:239], a[16:19], a[52:55], v[224:239]
  v_mfma_f32_32x32x16_bf16 v[144:159], a[20:23], a[48:51], v[144:159]
  v_mfma_f32_32x32x16_bf16 v[240:255], a[20:23], a[52:55], v[240:255]
  s_waitcnt vmcnt(4) lgkmcnt(0)
  s_barrier
  s_add_u32 s30, s30, 24576
  s_cmp_eq_u32 s30, 98304
  s_cselect_b32 s30, 0, s30
  v_add_u32 v16, s30, v14
  v_add_u32 v17, s30, v15
  s_cmp_eq_u32 s54, 0
  s_cbranch_scc1 W_pf_35
  v_mov_b32 v2, 1
  v_lshlrev_b32 v3, 2, v1
  s_mov_b32 exec_hi, 0
  s_mov_b32 exec_lo, s54
  buffer_store_dword v2, v3, s[8:11], s53 offen sc1
  s_mov_b64 exec, -1
  s_mov_b32 s54, 0
W_pf_35:
  s_add_u32 s25, s79, 4
  s_load_dword s55, s[76:77], s25
  v_mfma_f32_32x32x16_bf16 v[64:79], a[24:27], a[56:59], v[64:79]
  ds_read_b128 a[48:51], v32 offset:32768
  ds_read_b128 a[52:55], v32 offset:36864
  s_add_u32 m0, m0, 1024
  s_nop 0
  buffer_load_dwordx4 v12, s[12:15], s27 offen lds
  v_mfma_f32_32x32x16_bf16 v[160:175], a[24:27], a[60:63], v[160:175]
  ds_read_b64_tr_b16 a[0:1], v16 offset:0
  ds_read_b64_tr_b16 a[2:3], v16 offset:1536
  v_mfma_f32_32x32x16_bf16 v[80:95], a[28:31], a[56:59], v[80:95]
  ds_read_b64_tr_b16 a[4:5], v17 offset:64
  ds_read_b64_tr_b16 a[6:7], v17 offset:1600
  v_mfma_f32_32x32x16_bf16 v[176:191], a[28:31], a[60:63], v[176:191]
  ds_read_b64_tr_b16 a[8:9], v16 offset:128
  ds_read_b64_tr_b16 a[10:11], v16 offset:1664
  v_mfma_f32_32x32x16_bf16 v[96:111], a[32:35], a[56:59], v[96:111]
  ds_read_b64_tr_b16 a[12:13], v17 offset:192
  ds_read_b64_tr_b16 a[14:15], v17 offset:1728
  v_mfma_f32_32x32x16_bf16 v[192:207], a[32:35], a[60:63], v[192:207]
  ds_read_b64_tr_b16 a[16:17], v16 offset:256
  ds_read_b64_tr_b16 a[18:19], v16 offset:1792
  s_add_u32 m0, m0, 1024
  s_nop 0
  buffer_load_dwordx4 v13, s[12:15], s27 offen lds
  s_add_u32 s27, s27, s28
  s_add_u32 s29, s29, 24576
  s_cmp_eq_u32 s29, 98304
  s_cselect_b32 s29, 0, s29
  v_mfma_f32_32x32x16_bf16 v[112:127], a[36:39], a[56:59], v[112:127]
  ds_read_b64_tr_b16 a[20:21], v17 offset:320
  ds_read_b64_tr_b16 a[22:23], v17 offset:1856
  v_mfma_f32_32x32x16_bf16 v[208:223], a[36:39], a[60:63], v[208:223]
  v_mfma_f32_32x32x16_bf16 v[128:143], a[40:43], a[56:59], v[128:143]
  v_mfma_f32_32x32x16_bf16 v[224:239], a[40:43], a[60:63], v[224:239]
  v_mfma_f32_32x32x16_bf16 v[144:159], a[44:47], a[56:59], v[144:159]
  v_mfma_f32_32x32x16_bf16 v[240:255], a[44:47], a[60:63], v[240:255]
  s_waitcnt lgkmcnt(0)
  v_mfma_f32_32x32x16_bf16 v[64:79], a[0:3], a[48:51], v[64:79]
  ds_read_b128 a[56:59], v33 offset:32768
  ds_read_b128 a[60:63], v33 offset:36864
  s_add_u32 m0, s52, 0
  s_nop 0
  buffer_load_dwordx4 v24, s[48:51], s26 offen lds
  v_mfma_f32_32x32x16_bf16 v[160:175], a[0:3], a[52:55], v[160:175]
  ds_read_b64_tr_b16 a[24:25], v16 offset:3072
  ds_read_b64_tr_b16 a[26:27], v16 offset:4608
  v_mfma_f32_32x32x16_bf16 v[80:95], a[4:7], a[48:51], v[80:95]
  ds_read_b64_tr_b16 a[28:29], v17 offset:3136
  ds_read_b64_tr_b16 a[30:31], v17 offset:4672
  s_add_u32 m0, s52, 1024
  s_nop 0
  buffer_load_dwordx4 v25, s[48:51], s26 offen lds
  v_mfma_f32_32x32x16_bf16 v[176:191], a[4:7], a[52:55], v[176:191]
  ds_read_b64_tr_b16 a[32:33], v16 offset:3200
  ds_read_b64_tr_b16 a[34:35], v16 offset:4736
  v_mfma_f32_32x32x16_bf16 v[96:111], a[8:11], a[48:51], v[96:111]
  ds_read_b64_tr_b16 a[36:37], v17 offset:3264
  ds_read_b64_tr_b16 a[38:39], v17 offset:4800
  s_add_u32 m0, s52, 2048
  s_nop 0
  buffer_load_dwordx4 v26, s[48:51], s26 offen lds
  v_mfma_f32_32x32x16_bf16 v[192:207], a[8:11], a[52:55], v[192:207]
  ds_read_b64_tr_b16 a[40:41], v16 offset:3328
  ds_read_b64_tr_b16 a[42:43], v16 offset:4864
  v_mfma_f32_32x32x16_bf16 v[112:127], a[12:15], a[48:51], v[112:127]
  ds_read_b64_tr_b16 a[44:45], v17 offset:3392
  ds_read_b64_tr_b16 a[46:47], v17 offset:4928
  s_add_u32 m0, s52, 3072
  s_nop 0
  buffer_load_dwordx4 v27, s[48:51], s26 offen lds
  v_mfma_f32_32x32x16_bf16 v[208:223], a[12:15], a[52:55], v[208:223]
  v_mfma_f32_32x32x16_bf16 v[128:143], a[16:19], a[48:51], v[128:143]
  s_add_u32 m0, s52, 4096
  s_nop 0
  buffer_load_dwordx4 v28, s[48:51], s26 offen lds
  v_mfma_f32_32x32x16_bf16 v[224:239], a[16:19], a[52:55], v[224:239]
  v_mfma_f32_32x32x16_bf16 v[144:159], a[20:23], a[48:51], v[144:159]
  s_add_u32 m0, s52, 5120
  s_nop 0
  buffer_load_dwordx4 v29, s[48:51], s26 offen lds
  v_mfma_f32_32x32x16_bf16 v[240:255], a[20:23], a[52:55], v[240:255]
  s_waitcnt lgkmcnt(0)
  v_mfma_f32_32x32x16_bf16 v[64:79], a[24:27], a[56:59], v[64:79]
  ds_read_b128 a[48:51], v34 offset:32768
  ds_read_b128 a[52:55], v34 offset:36864
  s_add_u32 m0, s52, 6144
  s_nop 0
  buffer_load_dwordx4 v30, s[48:51], s26 offen lds
  v_mfma_f32_32x32x16_bf16 v[160:175], a[24:27], a[60:63], v[160:175]
  ds_read_b64_tr_b16 a[0:1], v16 offset:6144
  ds_read_b64_tr_b16 a[2:3], v16 offset:7680
  v_mfma_f32_32x32x16_bf16 v[80:95], a[28:31], a[56:59], v[80:95]
  ds_read_b64_tr_b16 a[4:5], v17 offset:6208
  ds_read_b64_tr_b16 a[6:7], v17 offset:7744
  s_add_u32 m0, s52, 7168
  s_nop 0
  buffer_load_dwordx4 v31, s[48:51], s26 offen lds
  s_add_u32 s26, s26, 128
  v_mfma_f32_32x32x16_bf16 v[176:191], a[28:31], a[60:63], v[176:191]
  ds_read_b64_tr_b16 a[8:9], v16 offset:6272
  ds_read_b64_tr_b16 a[10:11], v16 offset:7808
  v_mfma_f32_32x32x16_bf16 v[96:111], a[32:35], a[56:59], v[96:111]
  ds_read_b64_tr_b16 a[12:13], v17 offset:6336
  ds_read_b64_tr_b16 a[14:15], v17 offset:7872
  s_add_u32 m0, s29, s32
  s_nop 0
  buffer_load_dwordx4 v8, s[12:15], s27 offen lds
  v_mfma_f32_32x32x16_bf16 v[192:207], a[32:35], a[60:63], v[192:207]
  ds_read_b64_tr_b16 a[16:17], v16 offset:6400
  ds_read_b64_tr_b16 a[18:19], v16 offset:7936
  v_mfma_f32_32x32x16_bf16 v[112:127], a[36:39], a[56:59], v[112:127]
  ds_read_b64_tr_b16 a[20:21], v17 offset:6464
  ds_read_b64_tr_b16 a[22:23], v17 offset:8000
  v_mfma_f32_32x32x16_bf16 v[208:223], a[36:39], a[60:63], v[208:223]
  v_mfma_f32_32x32x16_bf16 v[128:143], a[40:43], a[56:59], v[128:143]
  v_mfma_f32_32x32x16_bf16 v[224:239], a[40:43], a[60:63], v[224:239]
  s_add_u32 m0, m0, 1024
  s_nop 0
  buffer_load_dwordx4 v9, s[12:15], s27 offen lds
  v_mfma_f32_32x32x16_bf16 v[144:159], a[44:47], a[56:59], v[144:159]
  v_mfma_f32_32x32x16_bf16 v[240:255], a[44:47], a[60:63], v[240:255]
  s_waitcnt lgkmcnt(0)
  v_mfma_f32_32x32x16_bf16 v[64:79], a[0:3], a[48:51], v[64:79]
  ds_read_b128 a[56:59], v35 offset:32768
  ds_read_b128 a[60:63], v35 offset:36864
  v_mfma_f32_32x32x16_bf16 v[160:175], a[0:3], a[52:55], v[160:175]
  ds_read_b64_tr_b16 a[24:25], v16 offset:9216
  ds_read_b64_tr_b16 a[26:27], v16 offset:10752
  v_mfma_f32_32x32x16_bf16 v[80:95], a[4:7], a[48:51], v[80:95]
  ds_read_b64_tr_b16 a[28:29], v17 offset:9280
  ds_read_b64_tr_b16 a[30:31], v17 offset:10816
  s_add_u32 m0, m0, 1024
  s_nop 0
  buffer_load_dwordx4 v10, s[12:15], s27 offen lds
  v_mfma_f32_32x32x16_bf16 v[176:191], a[4:7], a[52:55], v[176:191]
  ds_read_b64_tr_b16 a[32:33], v16 offset:9344
  ds_read_b64_tr_b16 a[34:35], v16 offset:10880
  v_mfma_f32_32x32x16_bf16 v[96:111], a[8:11], a[48:51], v[96:111]
  ds_read_b64_tr_b16 a[36:37], v17 offset:9408
  ds_read_b64_tr_b16 a[38:39], v17 offset:10944
  v_mfma_f32_32x32x16_bf16 v[192:207], a[8:11], a[52:55], v[192:207]
  ds_read_b64_tr_b16 a[40:41], v16 offset:9472
  ds_read_b64_tr_b16 a[42:43], v16 offset:11008
  v_mfma_f32_32x32x16_bf16 v[112:127], a[12:15], a[48:51], v[112:127]
  ds_read_b64_tr_b16 a[44:45], v17 offset:9536
  ds_read_b64_tr_b16 a[46:47], v17 offset:11072
  v_mfma_f32_32x32x16_bf16 v[208:223], a[12:15], a[52:55], v[208:223]
  s_add_u32 m0, m0, 1024
  s_nop 0
  buffer_load_dwordx4 v11, s[12:15], s27 offen lds
  v_mfma_f32_32x32x16_bf16 v[128:143], a[16:19], a[48:51], v[128:143]
  v_mfma_f32_32x32x16_bf16 v[224:239], a[16:19], a[52:55], v[224:239]
  v_mfma_f32_32x32x16_bf16 v[144:159], a[20:23], a[48:51], v[144:159]
  v_mfma_f32_32x32x16_bf16 v[240:255], a[20:23], a[52:55], v[240:255]
  s_waitcnt vmcnt(4) lgkmcnt(0)
  s_barrier
  s_add_u32 s30, s30, 24576
  s_cmp_eq_u32 s30, 98304
  s_cselect_b32 s30, 0, s30
  v_add_u32 v16, s30, v14
  v_add_u32 v17, s30, v15
  v_mfma_f32_32x32x16_bf16 v[64:79], a[24:27], a[56:59], v[64:79]
  ds_read_b128 a[48:51], v32 offset:0
  ds_read_b128 a[52:55], v32 offset:4096
  s_add_u32 m0, m0, 1024
  s_nop 0
  buffer_load_dwordx4 v12, s[12:15], s27 offen lds
  v_mfma_f32_32x32x16_bf16 v[160:175], a[24:27], a[60:63], v[160:175]
  ds_read_b64_tr_b16 a[0:1], v16 offset:0
  ds_read_b64_tr_b16 a[2:3], v16 offset:1536
  v_mfma_f32_32x32x16_bf16 v[80:95], a[28:31], a[56:59], v[80:95]
  ds_read_b64_tr_b16 a[4:5], v17 offset:64
  ds_read_b64_tr_b16 a[6:7], v17 offset:1600
  v_mfma_f32_32x32x16_bf16 v[176:191], a[28:31], a[60:63], v[176:191]
  ds_read_b64_tr_b16 a[8:9], v16 offset:128
  ds_read_b64_tr_b16 a[10:11], v16 offset:1664
  v_mfma_f32_32x32x16_bf16 v[96:111], a[32:35], a[56:59], v[96:111]
  ds_read_b64_tr_b16 a[12:13], v17 offset:192
  ds_read_b64_tr_b16 a[14:15], v17 offset:1728
  v_mfma_f32_32x32x16_bf16 v[192:207], a[32:35], a[60:63], v[192:207]
  ds_read_b64_tr_b16 a[16:17], v16 offset:256
  ds_read_b64_tr_b16 a[18:19], v16 offset:1792
  s_add_u32 m0, m0, 1024
  s_nop 0
  buffer_load_dwordx4 v13, s[12:15], s27 offen lds
  s_add_u32 s27, s27, s28
  s_add_u32 s29, s29, 24576
  s_cmp_eq_u32 s29, 98304
  s_cselect_b32 s29, 0, s29
  v_mfma_f32_32x32x16_bf16 v[112:127], a[36:39], a[56:59], v[112:127]
  ds_read_b64_tr_b16 a[20:21], v17 offset:320
  ds_read_b64_tr_b16 a[22:23], v17 offset:1856
  v_mfma_f32_32x32x16_bf16 v[208:223], a[36:39], a[60:63], v[208:223]
  v_mfma_f32_32x32x16_bf16 v[128:143], a[40:43], a[56:59], v[128:143]
  v_mfma_f32_32x32x16_bf16 v[224:239], a[40:43], a[60:63], v[224:239]
  v_mfma_f32_32x32x16_bf16 v[144:159], a[44:47], a[56:59], v[144:159]
  v_mfma_f32_32x32x16_bf16 v[240:255], a[44:47], a[60:63], v[240:255]
  s_waitcnt lgkmcnt(0)
  v_mfma_f32_32x32x16_bf16 v[64:79], a[0:3], a[48:51], v[64:79]
  ds_read_b128 a[56:59], v33 offset:0
  ds_read_b128 a[60:63], v33 offset:4096
  s_add_u32 m0, s52, 32768
  s_nop 0
  buffer_load_dwordx4 v24, s[48:51], s26 offen lds
  v_mfma_f32_32x32x16_bf16 v[160:175], a[0:3], a[52:55], v[160:175]
  ds_read_b64_tr_b16 a[24:25], v16 offset:3072
  ds_read_b64_tr_b16 a[26:27], v16 offset:4608
  v_mfma_f32_32x32x16_bf16 v[80:95], a[4:7], a[48:51], v[80:95]
  ds_read_b64_tr_b16 a[28:29], v17 offset:3136
  ds_read_b64_tr_b16 a[30:31], v17 offset:4672
  s_add_u32 m0, s52, 33792
  s_nop 0
  buffer_load_dwordx4 v25, s[48:51], s26 offen lds
  v_mfma_f32_32x32x16_bf16 v[176:191], a[4:7], a[52:55], v[176:191]
  ds_read_b64_tr_b16 a[32:33], v16 offset:3200
  ds_read_b64_tr_b16 a[34:35], v16 offset:4736
  v_mfma_f32_32x32x16_bf16 v[96:111], a[8:11], a[48:51], v[96:111]
  ds_read_b64_tr_b16 a[36:37], v17 offset:3264
  ds_read_b64_tr_b16 a[38:39], v17 offset:4800
  s_add_u32 m0, s52, 34816
  s_nop 0
  buffer_load_dwordx4 v26, s[48:51], s26 offen lds
  v_mfma_f32_32x32x16_bf16 v[192:207], a[8:11], a[52:55], v[192:207]
  ds_read_b64_tr_b16 a[40:41], v16 offset:3328
  ds_read_b64_tr_b16 a[42:43], v16 offset:4864
  v_mfma_f32_32x32x16_bf16 v[112:127], a[12:15], a[48:51], v[112:127]
  ds_read_b64_tr_b16 a[44:45], v17 offset:3392
  ds_read_b64_tr_b16 a[46:47], v17 offset:4928
  s_add_u32 m0, s52, 35840
  s_nop 0
  buffer_load_dwordx4 v27, s[48:51], s26 offen lds
  v_mfma_f32_32x32x16_bf16 v[208:223], a[12:15], a[52:55], v[208:223]
  v_mfma_f32_32x32x16_bf16 v[128:143], a[16:19], a[48:51], v[128:143]
  s_add_u32 m0, s52, 36864
  s_nop 0
  buffer_load_dwordx4 v28, s[48:51], s26 offen lds
  v_mfma_f32_32x32x16_bf16 v[224:239], a[16:19], a[52:55], v[224:239]
  v_mfma_f32_32x32x16_bf16 v[144:159], a[20:23], a[48:51], v[144:159]
  s_add_u32 m0, s52, 37888
  s_nop 0
  buffer_load_dwordx4 v29, s[48:51], s26 offen lds
  v_mfma_f32_32x32x16_bf16 v[240:255], a[20:23], a[52:55], v[240:255]
  s_waitcnt lgkmcnt(0)
  v_mfma_f32_32x32x16_bf16 v[64:79], a[24:27], a[56:59], v[64:79]
  ds_read_b128 a[48:51], v34 offset:0
  ds_read_b128 a[52:55], v34 offset:4096
  s_add_u32 m0, s52, 38912
  s_nop 0
  buffer_load_dwordx4 v30, s[48:51], s26 offen lds
  v_mfma_f32_32x32x16_bf16 v[160:175], a[24:27], a[60:63], v[160:175]
  ds_read_b64_tr_b16 a[0:1], v16 offset:6144
  ds_read_b64_tr_b16 a[2:3], v16 offset:7680
  v_mfma_f32_32x32x16_bf16 v[80:95], a[28:31], a[56:59], v[80:95]
  ds_read_b64_tr_b16 a[4:5], v17 offset:6208
  ds_read_b64_tr_b16 a[6:7], v17 offset:7744
  s_add_u32 m0, s52, 39936
  s_nop 0
  buffer_load_dwordx4 v31, s[48:51], s26 offen lds
  s_add_u32 s26, s26, 128
  v_mfma_f32_32x32x16_bf16 v[176:191], a[28:31], a[60:63], v[176:191]
  ds_read_b64_tr_b16 a[8:9], v16 offset:6272
  ds_read_b64_tr_b16 a[10:11], v16 offset:7808
  v_mfma_f32_32x32x16_bf16 v[96:111], a[32:35], a[56:59], v[96:111]
  ds_read_b64_tr_b16 a[12:13], v17 offset:6336
  ds_read_b64_tr_b16 a[14:15], v17 offset:7872
  s_add_u32 m0, s29, s32
  s_nop 0
  buffer_load_dwordx4 v8, s[12:15], s27 offen lds
  v_mfma_f32_32x32x16_bf16 v[192:207], a[32:35], a[60:63], v[192:207]
  ds_read_b64_tr_b16 a[16:17], v16 offset:6400
  ds_read_b64_tr_b16 a[18:19], v16 offset:7936
  v_mfma_f32_32x32x16_bf16 v[112:127], a[36:39], a[56:59], v[112:127]
  ds_read_b64_tr_b16 a[20:21], v17 offset:6464
  ds_read_b64_tr_b16 a[22:23], v17 offset:8000
  v_mfma_f32_32x32x16_bf16 v[208:223], a[36:39], a[60:63], v[208:223]
  v_mfma_f32_32x32x16_bf16 v[128:143], a[40:43], a[56:59], v[128:143]
  v_mfma_f32_32x32x16_bf16 v[224:239], a[40:43], a[60:63], v[224:239]
  s_add_u32 m0, m0, 1024
  s_nop 0
  buffer_load_dwordx4 v9, s[12:15], s27 offen lds
  v_mfma_f32_32x32x16_bf16 v[144:159], a[44:47], a[56:59], v[144:159]
  v_mfma_f32_32x32x16_bf16 v[240:255], a[44:47], a[60:63], v[240:255]
  s_waitcnt lgkmcnt(0)
  v_mfma_f32_32x32x16_bf16 v[64:79], a[0:3], a[48:51], v[64:79]
  ds_read_b128 a[56:59], v35 offset:0
  ds_read_b128 a[60:63], v35 offset:4096
  v_mfma_f32_32x32x16_bf16 v[160:175], a[0:3], a[52:55], v[160:175]
  ds_read_b64_tr_b16 a[24:25], v16 offset:9216
  ds_read_b64_tr_b16 a[26:27], v16 offset:10752
  v_mfma_f32_32x32x16_bf16 v[80:95], a[4:7], a[48:51], v[80:95]
  ds_read_b64_tr_b16 a[28:29], v17 offset:9280
  ds_read_b64_tr_b16 a[30:31], v17 offset:10816
  s_add_u32 m0, m0, 1024
  s_nop 0
  buffer_load_dwordx4 v10, s[12:15], s27 offen lds
  v_mfma_f32_32x32x16_bf16 v[176:191], a[4:7], a[52:55], v[176:191]
  ds_read_b64_tr_b16 a[32:33], v16 offset:9344
  ds_read_b64_tr_b16 a[34:35], v16 offset:10880
  v_mfma_f32_32x32x16_bf16 v[96:111], a[8:11], a[48:51], v[96:111]
  ds_read_b64_tr_b16 a[36:37], v17 offset:9408
  ds_read_b64_tr_b16 a[38:39], v17 offset:10944
  v_mfma_f32_32x32x16_bf16 v[192:207], a[8:11], a[52:55], v[192:207]
  ds_read_b64_tr_b16 a[40:41], v16 offset:9472
  ds_read_b64_tr_b16 a[42:43], v16 offset:11008
  v_mfma_f32_32x32x16_bf16 v[112:127], a[12:15], a[48:51], v[112:127]
  ds_read_b64_tr_b16 a[44:45], v17 offset:9536
  ds_read_b64_tr_b16 a[46:47], v17 offset:11072
  v_mfma_f32_32x32x16_bf16 v[208:223], a[12:15], a[52:55], v[208:223]
  s_add_u32 m0, m0, 1024
  s_nop 0
  buffer_load_dwordx4 v11, s[12:15], s27 offen lds
  v_mfma_f32_32x32x16_bf16 v[128:143], a[16:19], a[48:51], v[128:143]
  v_mfma_f32_32x32x16_bf16 v[224:239], a[16:19], a[52:55], v[224:239]
  v_mfma_f32_32x32x16_bf16 v[144:159], a[20:23], a[48:51], v[144:159]
  v_mfma_f32_32x32x16_bf16 v[240:255], a[20:23], a[52:55], v[240:255]
  s_waitcnt vmcnt(4) lgkmcnt(0)
  s_barrier
  s_add_u32 s30, s30, 24576
  s_cmp_eq_u32 s30, 98304
  s_cselect_b32 s30, 0, s30
  v_add_u32 v16, s30, v14
  v_add_u32 v17, s30, v15
  v_mfma_f32_32x32x16_bf16 v[64:79], a[24:27], a[56:59], v[64:79]
  ds_read_b128 a[48:51], v32 offset:32768
  ds_read_b128 a[52:55], v32 offset:36864
  s_add_u32 m0, m0, 1024
  s_nop 0
  buffer_load_dwordx4 v12, s[12:15], s27 offen lds
  v_mfma_f32_32x32x16_bf16 v[160:175], a[24:27], a[60:63], v[160:175]
  ds_read_b64_tr_b16 a[0:1], v16 offset:0
  ds_read_b64_tr_b16 a[2:3], v16 offset:1536
  v_mfma_f32_32x32x16_bf16 v[80:95], a[28:31], a[56:59], v[80:95]
  ds_read_b64_tr_b16 a[4:5], v17 offset:64
  ds_read_b64_tr_b16 a[6:7], v17 offset:1600
  v_mfma_f32_32x32x16_bf16 v[176:191], a[28:31], a[60:63], v[176:191]
  ds_read_b64_tr_b16 a[8:9], v16 offset:128
  ds_read_b64_tr_b16 a[10:11], v16 offset:1664
  v_mfma_f32_32x32x16_bf16 v[96:111], a[32:35], a[56:59], v[96:111]
  ds_read_b64_tr_b16 a[12:13], v17 offset:192
  ds_read_b64_tr_b16 a[14:15], v17 offset:1728
  v_mfma_f32_32x32x16_bf16 v[192:207], a[32:35], a[60:63], v[192:207]
  ds_read_b64_tr_b16 a[16:17], v16 offset:256
  ds_read_b64_tr_b16 a[18:19], v16 offset:1792
  s_add_u32 m0, m0, 1024
  s_nop 0
  buffer_load_dwordx4 v13, s[12:15], s27 offen lds
  s_add_u32 s27, s27, s28
  s_add_u32 s29, s29, 24576
  s_cmp_eq_u32 s29, 98304
  s_cselect_b32 s29, 0, s29
  v_mfma_f32_32x32x16_bf16 v[112:127], a[36:39], a[56:59], v[112:127]
  ds_read_b64_tr_b16 a[20:21], v17 offset:320
  ds_read_b64_tr_b16 a[22:23], v17 offset:1856
  v_mfma_f32_32x32x16_bf16 v[208:223], a[36:39], a[60:63], v[208:223]
  v_mfma_f32_32x32x16_bf16 v[128:143], a[40:43], a[56:59], v[128:143]
  v_mfma_f32_32x32x16_bf16 v[224:239], a[40:43], a[60:63], v[224:239]
  v_mfma_f32_32x32x16_bf16 v[144:159], a[44:47], a[56:59], v[144:159]
  v_mfma_f32_32x32x16_bf16 v[240:255], a[44:47], a[60:63], v[240:255]
  s_waitcnt lgkmcnt(0)
  v_mfma_f32_32x32x16_bf16 v[64:79], a[0:3], a[48:51], v[64:79]
  ds_read_b128 a[56:59], v33 offset:32768
  ds_read_b128 a[60:63], v33 offset:36864
  s_add_u32 m0, s52, 0
  s_nop 0
  buffer_load_dwordx4 v24, s[48:51], s26 offen lds
  v_mfma_f32_32x32x16_bf16 v[160:175], a[0:3], a[52:55], v[160:175]
  ds_read_b64_tr_b16 a[24:25], v16 offset:3072
  ds_read_b64_tr_b16 a[26:27], v16 offset:4608
  v_mfma_f32_32x32x16_bf16 v[80:95], a[4:7], a[48:51], v[80:95]
  ds_read_b64_tr_b16 a[28:29], v17 offset:3136
  ds_read_b64_tr_b16 a[30:31], v17 offset:4672
  s_add_u32 m0, s52, 1024
  s_nop 0
  buffer_load_dwordx4 v25, s[48:51], s26 offen lds
  v_mfma_f32_32x32x16_bf16 v[176:191], a[4:7], a[52:55], v[176:191]
  ds_read_b64_tr_b16 a[32:33], v16 offset:3200
  ds_read_b64_tr_b16 a[34:35], v16 offset:4736
  v_mfma_f32_32x32x16_bf16 v[96:111], a[8:11], a[48:51], v[96:111]
  ds_read_b64_tr_b16 a[36:37], v17 offset:3264
  ds_read_b64_tr_b16 a[38:39], v17 offset:4800
  s_add_u32 m0, s52, 2048
  s_nop 0
  buffer_load_dwordx4 v26, s[48:51], s26 offen lds
  v_mfma_f32_32x32x16_bf16 v[192:207], a[8:11], a[52:55], v[192:207]
  ds_read_b64_tr_b16 a[40:41], v16 offset:3328
  ds_read_b64_tr_b16 a[42:43], v16 offset:4864
  v_mfma_f32_32x32x16_bf16 v[112:127], a[12:15], a[48:51], v[112:127]
  ds_read_b64_tr_b16 a[44:45], v17 offset:3392
  ds_read_b64_tr_b16 a[46:47], v17 offset:4928
  s_add_u32 m0, s52, 3072
  s_nop 0
  buffer_load_dwordx4 v27, s[48:51], s26 offen lds
  v_mfma_f32_32x32x16_bf16 v[208:223], a[12:15], a[52:55], v[208:223]
  v_mfma_f32_32x32x16_bf16 v[128:143], a[16:19], a[48:51], v[128:143]
  s_add_u32 m0, s52, 4096
  s_nop 0
  buffer_load_dwordx4 v28, s[48:51], s26 offen lds
  v_mfma_f32_32x32x16_bf16 v[224:239], a[16:19], a[52:55], v[224:239]
  v_mfma_f32_32x32x16_bf16 v[144:159], a[20:23], a[48:51], v[144:159]
  s_add_u32 m0, s52, 5120
  s_nop 0
  buffer_load_dwordx4 v29, s[48:51], s26 offen lds
  v_mfma_f32_32x32x16_bf16 v[240:255], a[20:23], a[52:55], v[240:255]
  s_waitcnt lgkmcnt(0)
  v_mfma_f32_32x32x16_bf16 v[64:79], a[24:27], a[56:59], v[64:79]
  ds_read_b128 a[48:51], v34 offset:32768
  ds_read_b128 a[52:55], v34 offset:36864
  s_add_u32 m0, s52, 6144
  s_nop 0
  buffer_load_dwordx4 v30, s[48:51], s26 offen lds
  v_mfma_f32_32x32x16_bf16 v[160:175], a[24:27], a[60:63], v[160:175]
  ds_read_b64_tr_b16 a[0:1], v16 offset:6144
  ds_read_b64_tr_b16 a[2:3], v16 offset:7680
  v_mfma_f32_32x32x16_bf16 v[80:95], a[28:31], a[56:59], v[80:95]
  ds_read_b64_tr_b16 a[4:5], v17 offset:6208
  ds_read_b64_tr_b16 a[6:7], v17 offset:7744
  s_add_u32 m0, s52, 7168
  s_nop 0
  buffer_load_dwordx4 v31, s[48:51], s26 offen lds
  s_add_u32 s26, s26, 128
  v_mfma_f32_32x32x16_bf16 v[176:191], a[28:31], a[60:63], v[176:191]
  ds_read_b64_tr_b16 a[8:9], v16 offset:6272
  ds_read_b64_tr_b16 a[10:11], v16 offset:7808
  v_mfma_f32_32x32x16_bf16 v[96:111], a[32:35], a[56:59], v[96:111]
  ds_read_b64_tr_b16 a[12:13], v17 offset:6336
  ds_read_b64_tr_b16 a[14:15], v17 offset:7872
  s_add_u32 m0, s29, s32
  s_nop 0
  buffer_load_dwordx4 v8, s[12:15], s27 offen lds
  v_mfma_f32_32x32x16_bf16 v[192:207], a[32:35], a[60:63], v[192:207]
  ds_read_b64_tr_b16 a[16:17], v16 offset:6400
  ds_read_b64_tr_b16 a[18:19], v16 offset:7936
  v_mfma_f32_32x32x16_bf16 v[112:127], a[36:39], a[56:59], v[112:127]
  ds_read_b64_tr_b16 a[20:21], v17 offset:6464
  ds_read_b64_tr_b16 a[22:23], v17 offset:8000
  v_mfma_f32_32x32x16_bf16 v[208:223], a[36:39], a[60:63], v[208:223]
  v_mfma_f32_32x32x16_bf16 v[128:143], a[40:43], a[56:59], v[128:143]
  v_mfma_f32_32x32x16_bf16 v[224:239], a[40:43], a[60:63], v[224:239]
  s_add_u32 m0, m0, 1024
  s_nop 0
  buffer_load_dwordx4 v9, s[12:15], s27 offen lds
  v_mfma_f32_32x32x16_bf16 v[144:159], a[44:47], a[56:59], v[144:159]
  v_mfma_f32_32x32x16_bf16 v[240:255], a[44:47], a[60:63], v[240:255]
  s_waitcnt lgkmcnt(0)
  v_mfma_f32_32x32x16_bf16 v[64:79], a[0:3], a[48:51], v[64:79]
  ds_read_b128 a[56:59], v35 offset:32768
  ds_read_b128 a[60:63], v35 offset:36864
  v_mfma_f32_32x32x16_bf16 v[160:175], a[0:3], a[52:55], v[160:175]
  ds_read_b64_tr_b16 a[24:25], v16 offset:9216
  ds_read_b64_tr_b16 a[26:27], v16 offset:10752
  v_mfma_f32_32x32x16_bf16 v[80:95], a[4:7], a[48:51], v[80:95]
  ds_read_b64_tr_b16 a[28:29], v17 offset:9280
  ds_read_b64_tr_b16 a[30:31], v17 offset:10816
  s_add_u32 m0, m0, 1024
  s_nop 0
  buffer_load_dwordx4 v10, s[12:15], s27 offen lds
  v_mfma_f32_32x32x16_bf16 v[176:191], a[4:7], a[52:55], v[176:191]
  ds_read_b64_tr_b16 a[32:33], v16 offset:9344
  ds_read_b64_tr_b16 a[34:35], v16 offset:10880
  v_mfma_f32_32x32x16_bf16 v[96:111], a[8:11], a[48:51], v[96:111]
  ds_read_b64_tr_b16 a[36:37], v17 offset:9408
  ds_read_b64_tr_b16 a[38:39], v17 offset:10944
  v_mfma_f32_32x32x16_bf16 v[192:207], a[8:11], a[52:55], v[192:207]
  ds_read_b64_tr_b16 a[40:41], v16 offset:9472
  ds_read_b64_tr_b16 a[42:43], v16 offset:11008
  v_mfma_f32_32x32x16_bf16 v[112:127], a[12:15], a[48:51], v[112:127]
  ds_read_b64_tr_b16 a[44:45], v17 offset:9536
  ds_read_b64_tr_b16 a[46:47], v17 offset:11072
  v_mfma_f32_32x32x16_bf16 v[208:223], a[12:15], a[52:55], v[208:223]
  s_add_u32 m0, m0, 1024
  s_nop 0
  buffer_load_dwordx4 v11, s[12:15], s27 offen lds
  v_mfma_f32_32x32x16_bf16 v[128:143], a[16:19], a[48:51], v[128:143]
  v_mfma_f32_32x32x16_bf16 v[224:239], a[16:19], a[52:55], v[224:239]
  v_mfma_f32_32x32x16_bf16 v[144:159], a[20:23], a[48:51], v[144:159]
  v_mfma_f32_32x32x16_bf16 v[240:255], a[20:23], a[52:55], v[240:255]
  s_waitcnt vmcnt(4) lgkmcnt(0)
  s_barrier
  s_add_u32 s30, s30, 24576
  s_cmp_eq_u32 s30, 98304
  s_cselect_b32 s30, 0, s30
  v_add_u32 v16, s30, v14
  v_add_u32 v17, s30, v15
  v_mfma_f32_32x32x16_bf16 v[64:79], a[24:27], a[56:59], v[64:79]
  ds_read_b128 a[48:51], v32 offset:0
  ds_read_b128 a[52:55], v32 offset:4096
  s_add_u32 m0, m0, 1024
  s_nop 0
  buffer_load_dwordx4 v12, s[12:15], s27 offen lds
  v_mfma_f32_32x32x16_bf16 v[160:175], a[24:27], a[60:63], v[160:175]
  ds_read_b64_tr_b16 a[0:1], v16 offset:0
  ds_read_b64_tr_b16 a[2:3], v16 offset:1536
  v_mfma_f32_32x32x16_bf16 v[80:95], a[28:31], a[56:59], v[80:95]
  ds_read_b64_tr_b16 a[4:5], v17 offset:64
  ds_read_b64_tr_b16 a[6:7], v17 offset:1600
  v_mfma_f32_32x32x16_bf16 v[176:191], a[28:31], a[60:63], v[176:191]
  ds_read_b64_tr_b16 a[8:9], v16 offset:128
  ds_read_b64_tr_b16 a[10:11], v16 offset:1664
  v_mfma_f32_32x32x16_bf16 v[96:111], a[32:35], a[56:59], v[96:111]
  ds_read_b64_tr_b16 a[12:13], v17 offset:192
  ds_read_b64_tr_b16 a[14:15], v17 offset:1728
  v_mfma_f32_32x32x16_bf16 v[192:207], a[32:35], a[60:63], v[192:207]
  ds_read_b64_tr_b16 a[16:17], v16 offset:256
  ds_read_b64_tr_b16 a[18:19], v16 offset:1792
  s_add_u32 m0, m0, 1024
  s_nop 0
  buffer_load_dwordx4 v13, s[12:15], s27 offen lds
  s_add_u32 s27, s27, s28
  s_add_u32 s29, s29, 24576
  s_cmp_eq_u32 s29, 98304
  s_cselect_b32 s29, 0, s29
  v_mfma_f32_32x32x16_bf16 v[112:127], a[36:39], a[56:59], v[112:127]
  ds_read_b64_tr_b16 a[20:21], v17 offset:320
  ds_read_b64_tr_b16 a[22:23], v17 offset:1856
  v_mfma_f32_32x32x16_bf16 v[208:223], a[36:39], a[60:63], v[208:223]
  v_mfma_f32_32x32x16_bf16 v[128:143], a[40:43], a[56:59], v[128:143]
  v_mfma_f32_32x32x16_bf16 v[224:239], a[40:43], a[60:63], v[224:239]
  v_mfma_f32_32x32x16_bf16 v[144:159], a[44:47], a[56:59], v[144:159]
  v_mfma_f32_32x32x16_bf16 v[240:255], a[44:47], a[60:63], v[240:255]
  s_waitcnt lgkmcnt(0)
  v_mfma_f32_32x32x16_bf16 v[64:79], a[0:3], a[48:51], v[64:79]
  ds_read_b128 a[56:59], v33 offset:0
  ds_read_b128 a[60:63], v33 offset:4096
  s_add_u32 m0, s52, 32768
  s_nop 0
  buffer_load_dwordx4 v24, s[48:51], s26 offen lds
  v_mfma_f32_32x32x16_bf16 v[160:175], a[0:3], a[52:55], v[160:175]
  ds_read_b64_tr_b16 a[24:25], v16 offset:3072
  ds_read_b64_tr_b16 a[26:27], v16 offset:4608
  v_mfma_f32_32x32x16_bf16 v[80:95], a[4:7], a[48:51], v[80:95]
  ds_read_b64_tr_b16 a[28:29], v17 offset:3136
  ds_read_b64_tr_b16 a[30:31], v17 offset:4672
  s_add_u32 m0, s52, 33792
  s_nop 0
  buffer_load_dwordx4 v25, s[48:51], s26 offen lds
  v_mfma_f32_32x32x16_bf16 v[176:191], a[4:7], a[52:55], v[176:191]
  ds_read_b64_tr_b16 a[32:33], v16 offset:3200
  ds_read_b64_tr_b16 a[34:35], v16 offset:4736
  v_mfma_f32_32x32x16_bf16 v[96:111], a[8:11], a[48:51], v[96:111]
  ds_read_b64_tr_b16 a[36:37], v17 offset:3264
  ds_read_b64_tr_b16 a[38:39], v17 offset:4800
  s_add_u32 m0, s52, 34816
  s_nop 0
  buffer_load_dwordx4 v26, s[48:51], s26 offen lds
  v_mfma_f32_32x32x16_bf16 v[192:207], a[8:11], a[52:55], v[192:207]
  ds_read_b64_tr_b16 a[40:41], v16 offset:3328
  ds_read_b64_tr_b16 a[42:43], v16 offset:4864
  v_mfma_f32_32x32x16_bf16 v[112:127], a[12:15], a[48:51], v[112:127]
  ds_read_b64_tr_b16 a[44:45], v17 offset:3392
  ds_read_b64_tr_b16 a[46:47], v17 offset:4928
  s_add_u32 m0, s52, 35840
  s_nop 0
  buffer_load_dwordx4 v27, s[48:51], s26 offen lds
  v_mfma_f32_32x32x16_bf16 v[208:223], a[12:15], a[52:55], v[208:223]
  v_mfma_f32_32x32x16_bf16 v[128:143], a[16:19], a[48:51], v[128:143]
  s_add_u32 m0, s52, 36864
  s_nop 0
  buffer_load_dwordx4 v28, s[48:51], s26 offen lds
  v_mfma_f32_32x32x16_bf16 v[224:239], a[16:19], a[52:55], v[224:239]
  v_mfma_f32_32x32x16_bf16 v[144:159], a[20:23], a[48:51], v[144:159]
  s_add_u32 m0, s52, 37888
  s_nop 0
  buffer_load_dwordx4 v29, s[48:51], s26 offen lds
  v_mfma_f32_32x32x16_bf16 v[240:255], a[20:23], a[52:55], v[240:255]
  s_waitcnt lgkmcnt(0)
  v_mfma_f32_32x32x16_bf16 v[64:79], a[24:27], a[56:59], v[64:79]
  ds_read_b128 a[48:51], v34 offset:0
  ds_read_b128 a[52:55], v34 offset:4096
  s_add_u32 m0, s52, 38912
  s_nop 0
  buffer_load_dwordx4 v30, s[48:51], s26 offen lds
  v_mfma_f32_32x32x16_bf16 v[160:175], a[24:27], a[60:63], v[160:175]
  ds_read_b64_tr_b16 a[0:1], v16 offset:6144
  ds_read_b64_tr_b16 a[2:3], v16 offset:7680
  v_mfma_f32_32x32x16_bf16 v[80:95], a[28:31], a[56:59], v[80:95]
  ds_read_b64_tr_b16 a[4:5], v17 offset:6208
  ds_read_b64_tr_b16 a[6:7], v17 offset:7744
  s_add_u32 m0, s52, 39936
  s_nop 0
  buffer_load_dwordx4 v31, s[48:51], s26 offen lds
  s_add_u32 s26, s26, 128
  v_mfma_f32_32x32x16_bf16 v[176:191], a[28:31], a[60:63], v[176:191]
  ds_read_b64_tr_b16 a[8:9], v16 offset:6272
  ds_read_b64_tr_b16 a[10:11], v16 offset:7808
  v_mfma_f32_32x32x16_bf16 v[96:111], a[32:35], a[56:59], v[96:111]
  ds_read_b64_tr_b16 a[12:13], v17 offset:6336
  ds_read_b64_tr_b16 a[14:15], v17 offset:7872
  s_add_u32 m0, s29, s32
  s_nop 0
  buffer_load_dwordx4 v8, s[12:15], s27 offen lds
  v_mfma_f32_32x32x16_bf16 v[192:207], a[32:35], a[60:63], v[192:207]
  ds_read_b64_tr_b16 a[16:17], v16 offset:6400
  ds_read_b64_tr_b16 a[18:19], v16 offset:7936
  v_mfma_f32_32x32x16_bf16 v[112:127], a[36:39], a[56:59], v[112:127]
  ds_read_b64_tr_b16 a[20:21], v17 offset:6464
  ds_read_b64_tr_b16 a[22:23], v17 offset:8000
  v_mfma_f32_32x32x16_bf16 v[208:223], a[36:39], a[60:63], v[208:223]
  v_mfma_f32_32x32x16_bf16 v[128:143], a[40:43], a[56:59], v[128:143]
  v_mfma_f32_32x32x16_bf16 v[224:239], a[40:43], a[60:63], v[224:239]
  s_add_u32 m0, m0, 1024
  s_nop 0
  buffer_load_dwordx4 v9, s[12:15], s27 offen lds
  v_mfma_f32_32x32x16_bf16 v[144:159], a[44:47], a[56:59], v[144:159]
  v_mfma_f32_32x32x16_bf16 v[240:255], a[44:47], a[60:63], v[240:255]
  s_waitcnt lgkmcnt(0)
  v_mfma_f32_32x32x16_bf16 v[64:79], a[0:3], a[48:51], v[64:79]
  ds_read_b128 a[56:59], v35 offset:0
  ds_read_b128 a[60:63], v35 offset:4096
  v_mfma_f32_32x32x16_bf16 v[160:175], a[0:3], a[52:55], v[160:175]
  ds_read_b64_tr_b16 a[24:25], v16 offset:9216
  ds_read_b64_tr_b16 a[26:27], v16 offset:10752
  v_mfma_f32_32x32x16_bf16 v[80:95], a[4:7], a[48:51], v[80:95]
  ds_read_b64_tr_b16 a[28:29], v17 offset:9280
  ds_read_b64_tr_b16 a[30:31], v17 offset:10816
  s_add_u32 m0, m0, 1024
  s_nop 0
  buffer_load_dwordx4 v10, s[12:15], s27 offen lds
  v_mfma_f32_32x32x16_bf16 v[176:191], a[4:7], a[52:55], v[176:191]
  ds_read_b64_tr_b16 a[32:33], v16 offset:9344
  ds_read_b64_tr_b16 a[34:35], v16 offset:10880
  v_mfma_f32_32x32x16_bf16 v[96:111], a[8:11], a[48:51], v[96:111]
  ds_read_b64_tr_b16 a[36:37], v17 offset:9408
  ds_read_b64_tr_b16 a[38:39], v17 offset:10944
  v_mfma_f32_32x32x16_bf16 v[192:207], a[8:11], a[52:55], v[192:207]
  ds_read_b64_tr_b16 a[40:41], v16 offset:9472
  ds_read_b64_tr_b16 a[42:43], v16 offset:11008
  v_mfma_f32_32x32x16_bf16 v[112:127], a[12:15], a[48:51], v[112:127]
  ds_read_b64_tr_b16 a[44:45], v17 offset:9536
  ds_read_b64_tr_b16 a[46:47], v17 offset:11072
  v_mfma_f32_32x32x16_bf16 v[208:223], a[12:15], a[52:55], v[208:223]
  s_add_u32 m0, m0, 1024
  s_nop 0
  buffer_load_dwordx4 v11, s[12:15], s27 offen lds
  v_mfma_f32_32x32x16_bf16 v[128:143], a[16:19], a[48:51], v[128:143]
  v_mfma_f32_32x32x16_bf16 v[224:239], a[16:19], a[52:55], v[224:239]
  v_mfma_f32_32x32x16_bf16 v[144:159], a[20:23], a[48:51], v[144:159]
  v_mfma_f32_32x32x16_bf16 v[240:255], a[20:23], a[52:55], v[240:255]
  s_waitcnt vmcnt(4) lgkmcnt(0)
  s_barrier
  s_add_u32 s30, s30, 24576
  s_cmp_eq_u32 s30, 98304
  s_cselect_b32 s30, 0, s30
  v_add_u32 v16, s30, v14
  v_add_u32 v17, s30, v15
  v_mfma_f32_32x32x16_bf16 v[64:79], a[24:27], a[56:59], v[64:79]
  ds_read_b128 a[48:51], v32 offset:32768
  ds_read_b128 a[52:55], v32 offset:36864
  s_add_u32 m0, m0, 1024
  s_nop 0
  buffer_load_dwordx4 v12, s[12:15], s27 offen lds
  v_mfma_f32_32x32x16_bf16 v[160:175], a[24:27], a[60:63], v[160:175]
  ds_read_b64_tr_b16 a[0:1], v16 offset:0
  ds_read_b64_tr_b16 a[2:3], v16 offset:1536
  v_mfma_f32_32x32x16_bf16 v[80:95], a[28:31], a[56:59], v[80:95]
  ds_read_b64_tr_b16 a[4:5], v17 offset:64
  ds_read_b64_tr_b16 a[6:7], v17 offset:1600
  v_mfma_f32_32x32x16_bf16 v[176:191], a[28:31], a[60:63], v[176:191]
  ds_read_b64_tr_b16 a[8:9], v16 offset:128
  ds_read_b64_tr_b16 a[10:11], v16 offset:1664
  v_mfma_f32_32x32x16_bf16 v[96:111], a[32:35], a[56:59], v[96:111]
  ds_read_b64_tr_b16 a[12:13], v17 offset:192
  ds_read_b64_tr_b16 a[14:15], v17 offset:1728
  v_mfma_f32_32x32x16_bf16 v[192:207], a[32:35], a[60:63], v[192:207]
  ds_read_b64_tr_b16 a[16:17], v16 offset:256
  ds_read_b64_tr_b16 a[18:19], v16 offset:1792
  s_add_u32 m0, m0, 1024
  s_nop 0
  buffer_load_dwordx4 v13, s[12:15], s27 offen lds
  s_add_u32 s27, s27, s28
  s_add_u32 s29, s29, 24576
  s_cmp_eq_u32 s29, 98304
  s_cselect_b32 s29, 0, s29
  v_mfma_f32_32x32x16_bf16 v[112:127], a[36:39], a[56:59], v[112:127]
  ds_read_b64_tr_b16 a[20:21], v17 offset:320
  ds_read_b64_tr_b16 a[22:23], v17 offset:1856
  v_mfma_f32_32x32x16_bf16 v[208:223], a[36:39], a[60:63], v[208:223]
  v_mfma_f32_32x32x16_bf16 v[128:143], a[40:43], a[56:59], v[128:143]
  v_mfma_f32_32x32x16_bf16 v[224:239], a[40:43], a[60:63], v[224:239]
  v_mfma_f32_32x32x16_bf16 v[144:159], a[44:47], a[56:59], v[144:159]
  v_mfma_f32_32x32x16_bf16 v[240:255], a[44:47], a[60:63], v[240:255]
  s_waitcnt lgkmcnt(0)
  v_mfma_f32_32x32x16_bf16 v[64:79], a[0:3], a[48:51], v[64:79]
  ds_read_b128 a[56:59], v33 offset:32768
  ds_read_b128 a[60:63], v33 offset:36864
  s_add_u32 m0, s52, 0
  s_nop 0
  buffer_load_dwordx4 v24, s[48:51], s26 offen lds
  v_mfma_f32_32x32x16_bf16 v[160:175], a[0:3], a[52:55], v[160:175]
  ds_read_b64_tr_b16 a[24:25], v16 offset:3072
  ds_read_b64_tr_b16 a[26:27], v16 offset:4608
  v_mfma_f32_32x32x16_bf16 v[80:95], a[4:7], a[48:51], v[80:95]
  ds_read_b64_tr_b16 a[28:29], v17 offset:3136
  ds_read_b64_tr_b16 a[30:31], v17 offset:4672
  s_add_u32 m0, s52, 1024
  s_nop 0
  buffer_load_dwordx4 v25, s[48:51], s26 offen lds
  v_mfma_f32_32x32x16_bf16 v[176:191], a[4:7], a[52:55], v[176:191]
  ds_read_b64_tr_b16 a[32:33], v16 offset:3200
  ds_read_b64_tr_b16 a[34:35], v16 offset:4736
  v_mfma_f32_32x32x16_bf16 v[96:111], a[8:11], a[48:51], v[96:111]
  ds_read_b64_tr_b16 a[36:37], v17 offset:3264
  ds_read_b64_tr_b16 a[38:39], v17 offset:4800
  s_add_u32 m0, s52, 2048
  s_nop 0
  buffer_load_dwordx4 v26, s[48:51], s26 offen lds
  v_mfma_f32_32x32x16_bf16 v[192:207], a[8:11], a[52:55], v[192:207]
  ds_read_b64_tr_b16 a[40:41], v16 offset:3328
  ds_read_b64_tr_b16 a[42:43], v16 offset:4864
  v_mfma_f32_32x32x16_bf16 v[112:127], a[12:15], a[48:51], v[112:127]
  ds_read_b64_tr_b16 a[44:45], v17 offset:3392
  ds_read_b64_tr_b16 a[46:47], v17 offset:4928
  s_add_u32 m0, s52, 3072
  s_nop 0
  buffer_load_dwordx4 v27, s[48:51], s26 offen lds
  v_mfma_f32_32x32x16_bf16 v[208:223], a[12:15], a[52:55], v[208:223]
  v_mfma_f32_32x32x16_bf16 v[128:143], a[16:19], a[48:51], v[128:143]
  s_add_u32 m0, s52, 4096
  s_nop 0
  buffer_load_dwordx4 v28, s[48:51], s26 offen lds
  v_mfma_f32_32x32x16_bf16 v[224:239], a[16:19], a[52:55], v[224:239]
  v_mfma_f32_32x32x16_bf16 v[144:159], a[20:23], a[48:51], v[144:159]
  s_add_u32 m0, s52, 5120
  s_nop 0
  buffer_load_dwordx4 v29, s[48:51], s26 offen lds
  v_mfma_f32_32x32x16_bf16 v[240:255], a[20:23], a[52:55], v[240:255]
  s_waitcnt lgkmcnt(0)
  v_mfma_f32_32x32x16_bf16 v[64:79], a[24:27], a[56:59], v[64:79]
  ds_read_b128 a[48:51], v34 offset:32768
  ds_read_b128 a[52:55], v34 offset:36864
  s_add_u32 m0, s52, 6144
  s_nop 0
  buffer_load_dwordx4 v30, s[48:51], s26 offen lds
  v_mfma_f32_32x32x16_bf16 v[160:175], a[24:27], a[60:63], v[160:175]
  ds_read_b64_tr_b16 a[0:1], v16 offset:6144
  ds_read_b64_tr_b16 a[2:3], v16 offset:7680
  v_mfma_f32_32x32x16_bf16 v[80:95], a[28:31], a[56:59], v[80:95]
  ds_read_b64_tr_b16 a[4:5], v17 offset:6208
  ds_read_b64_tr_b16 a[6:7], v17 offset:7744
  s_add_u32 m0, s52, 7168
  s_nop 0
  buffer_load_dwordx4 v31, s[48:51], s26 offen lds
  s_add_u32 s26, s26, 128
  v_mfma_f32_32x32x16_bf16 v[176:191], a[28:31], a[60:63], v[176:191]
  ds_read_b64_tr_b16 a[8:9], v16 offset:6272
  ds_read_b64_tr_b16 a[10:11], v16 offset:7808
  v_mfma_f32_32x32x16_bf16 v[96:111], a[32:35], a[56:59], v[96:111]
  ds_read_b64_tr_b16 a[12:13], v17 offset:6336
  ds_read_b64_tr_b16 a[14:15], v17 offset:7872
  s_add_u32 m0, s29, s32
  s_nop 0
  buffer_load_dwordx4 v8, s[12:15], s27 offen lds
  v_mfma_f32_32x32x16_bf16 v[192:207], a[32:35], a[60:63], v[192:207]
  ds_read_b64_tr_b16 a[16:17], v16 offset:6400
  ds_read_b64_tr_b16 a[18:19], v16 offset:7936
  v_mfma_f32_32x32x16_bf16 v[112:127], a[36:39], a[56:59], v[112:127]
  ds_read_b64_tr_b16 a[20:21], v17 offset:6464
  ds_read_b64_tr_b16 a[22:23], v17 offset:8000
  v_mfma_f32_32x32x16_bf16 v[208:223], a[36:39], a[60:63], v[208:223]
  v_mfma_f32_32x32x16_bf16 v[128:143], a[40:43], a[56:59], v[128:143]
  v_mfma_f32_32x32x16_bf16 v[224:239], a[40:43], a[60:63], v[224:239]
  s_add_u32 m0, m0, 1024
  s_nop 0
  buffer_load_dwordx4 v9, s[12:15], s27 offen lds
  v_mfma_f32_32x32x16_bf16 v[144:159], a[44:47], a[56:59], v[144:159]
  v_mfma_f32_32x32x16_bf16 v[240:255], a[44:47], a[60:63], v[240:255]
  s_waitcnt lgkmcnt(0)
  v_mfma_f32_32x32x16_bf16 v[64:79], a[0:3], a[48:51], v[64:79]
  ds_read_b128 a[56:59], v35 offset:32768
  ds_read_b128 a[60:63], v35 offset:36864
  v_mfma_f32_32x32x16_bf16 v[160:175], a[0:3], a[52:55], v[160:175]
  ds_read_b64_tr_b16 a[24:25], v16 offset:9216
  ds_read_b64_tr_b16 a[26:27], v16 offset:10752
  v_mfma_f32_32x32x16_bf16 v[80:95], a[4:7], a[48:51], v[80:95]
  ds_read_b64_tr_b16 a[28:29], v17 offset:9280
  ds_read_b64_tr_b16 a[30:31], v17 offset:10816
  s_add_u32 m0, m0, 1024
  s_nop 0
  buffer_load_dwordx4 v10, s[12:15], s27 offen lds
  v_mfma_f32_32x32x16_bf16 v[176:191], a[4:7], a[52:55], v[176:191]
  ds_read_b64_tr_b16 a[32:33], v16 offset:9344
  ds_read_b64_tr_b16 a[34:35], v16 offset:10880
  v_mfma_f32_32x32x16_bf16 v[96:111], a[8:11], a[48:51], v[96:111]
  ds_read_b64_tr_b16 a[36:37], v17 offset:9408
  ds_read_b64_tr_b16 a[38:39], v17 offset:10944
  v_mfma_f32_32x32x16_bf16 v[192:207], a[8:11], a[52:55], v[192:207]
  ds_read_b64_tr_b16 a[40:41], v16 offset:9472
  ds_read_b64_tr_b16 a[42:43], v16 offset:11008
  v_mfma_f32_32x32x16_bf16 v[112:127], a[12:15], a[48:51], v[112:127]
  ds_read_b64_tr_b16 a[44:45], v17 offset:9536
  ds_read_b64_tr_b16 a[46:47], v17 offset:11072
  v_mfma_f32_32x32x16_bf16 v[208:223], a[12:15], a[52:55], v[208:223]
  s_add_u32 m0, m0, 1024
  s_nop 0
  buffer_load_dwordx4 v11, s[12:15], s27 offen lds
  v_mfma_f32_32x32x16_bf16 v[128:143], a[16:19], a[48:51], v[128:143]
  v_mfma_f32_32x32x16_bf16 v[224:239], a[16:19], a[52:55], v[224:239]
  v_mfma_f32_32x32x16_bf16 v[144:159], a[20:23], a[48:51], v[144:159]
  v_mfma_f32_32x32x16_bf16 v[240:255], a[20:23], a[52:55], v[240:255]
  s_waitcnt vmcnt(4) lgkmcnt(0)
  s_barrier
  s_add_u32 s30, s30, 24576
  s_cmp_eq_u32 s30, 98304
  s_cselect_b32 s30, 0, s30
  v_add_u32 v16, s30, v14
  v_add_u32 v17, s30, v15
  v_mfma_f32_32x32x16_bf16 v[64:79], a[24:27], a[56:59], v[64:79]
  ds_read_b128 a[48:51], v32 offset:0
  ds_read_b128 a[52:55], v32 offset:4096
  s_add_u32 m0, m0, 1024
  s_nop 0
  buffer_load_dwordx4 v12, s[12:15], s27 offen lds
  v_mfma_f32_32x32x16_bf16 v[160:175], a[24:27], a[60:63], v[160:175]
  ds_read_b64_tr_b16 a[0:1], v16 offset:0
  ds_read_b64_tr_b16 a[2:3], v16 offset:1536
  v_mfma_f32_32x32x16_bf16 v[80:95], a[28:31], a[56:59], v[80:95]
  ds_read_b64_tr_b16 a[4:5], v17 offset:64
  ds_read_b64_tr_b16 a[6:7], v17 offset:1600
  v_mfma_f32_32x32x16_bf16 v[176:191], a[28:31], a[60:63], v[176:191]
  ds_read_b64_tr_b16 a[8:9], v16 offset:128
  ds_read_b64_tr_b16 a[10:11], v16 offset:1664
  v_mfma_f32_32x32x16_bf16 v[96:111], a[32:35], a[56:59], v[96:111]
  ds_read_b64_tr_b16 a[12:13], v17 offset:192
  ds_read_b64_tr_b16 a[14:15], v17 offset:1728
  v_mfma_f32_32x32x16_bf16 v[192:207], a[32:35], a[60:63], v[192:207]
  ds_read_b64_tr_b16 a[16:17], v16 offset:256
  ds_read_b64_tr_b16 a[18:19], v16 offset:1792
  s_add_u32 m0, m0, 1024
  s_nop 0
  buffer_load_dwordx4 v13, s[12:15], s27 offen lds
  s_add_u32 s27, s27, s28
  s_add_u32 s29, s29, 24576
  s_cmp_eq_u32 s29, 98304
  s_cselect_b32 s29, 0, s29
  v_mfma_f32_32x32x16_bf16 v[112:127], a[36:39], a[56:59], v[112:127]
  ds_read_b64_tr_b16 a[20:21], v17 offset:320
  ds_read_b64_tr_b16 a[22:23], v17 offset:1856
  v_mfma_f32_32x32x16_bf16 v[208:223], a[36:39], a[60:63], v[208:223]
  v_mfma_f32_32x32x16_bf16 v[128:143], a[40:43], a[56:59], v[128:143]
  v_mfma_f32_32x32x16_bf16 v[224:239], a[40:43], a[60:63], v[224:239]
  v_mfma_f32_32x32x16_bf16 v[144:159], a[44:47], a[56:59], v[144:159]
  v_mfma_f32_32x32x16_bf16 v[240:255], a[44:47], a[60:63], v[240:255]
  s_waitcnt lgkmcnt(0)
  v_mfma_f32_32x32x16_bf16 v[64:79], a[0:3], a[48:51], v[64:79]
  ds_read_b128 a[56:59], v33 offset:0
  ds_read_b128 a[60:63], v33 offset:4096
  s_add_u32 m0, s52, 32768
  s_nop 0
  buffer_load_dwordx4 v24, s[48:51], s26 offen lds
  v_mfma_f32_32x32x16_bf16 v[160:175], a[0:3], a[52:55], v[160:175]
  ds_read_b64_tr_b16 a[24:25], v16 offset:3072
  ds_read_b64_tr_b16 a[26:27], v16 offset:4608
  v_mfma_f32_32x32x16_bf16 v[80:95], a[4:7], a[48:51], v[80:95]
  ds_read_b64_tr_b16 a[28:29], v17 offset:3136
  ds_read_b64_tr_b16 a[30:31], v17 offset:4672
  s_add_u32 m0, s52, 33792
  s_nop 0
  buffer_load_dwordx4 v25, s[48:51], s26 offen lds
  v_mfma_f32_32x32x16_bf16 v[176:191], a[4:7], a[52:55], v[176:191]
  ds_read_b64_tr_b16 a[32:33], v16 offset:3200
  ds_read_b64_tr_b16 a[34:35], v16 offset:4736
  v_mfma_f32_32x32x16_bf16 v[96:111], a[8:11], a[48:51], v[96:111]
  ds_read_b64_tr_b16 a[36:37], v17 offset:3264
  ds_read_b64_tr_b16 a[38:39], v17 offset:4800
  s_add_u32 m0, s52, 34816
  s_nop 0
  buffer_load_dwordx4 v26, s[48:51], s26 offen lds
  v_mfma_f32_32x32x16_bf16 v[192:207], a[8:11], a[52:55], v[192:207]
  ds_read_b64_tr_b16 a[40:41], v16 offset:3328
  ds_read_b64_tr_b16 a[42:43], v16 offset:4864
  v_mfma_f32_32x32x16_bf16 v[112:127], a[12:15], a[48:51], v[112:127]
  ds_read_b64_tr_b16 a[44:45], v17 offset:3392
  ds_read_b64_tr_b16 a[46:47], v17 offset:4928
  s_add_u32 m0, s52, 35840
  s_nop 0
  buffer_load_dwordx4 v27, s[48:51], s26 offen lds
  v_mfma_f32_32x32x16_bf16 v[208:223], a[12:15], a[52:55], v[208:223]
  v_mfma_f32_32x32x16_bf16 v[128:143], a[16:19], a[48:51], v[128:143]
  s_add_u32 m0, s52, 36864
  s_nop 0
  buffer_load_dwordx4 v28, s[48:51], s26 offen lds
  v_mfma_f32_32x32x16_bf16 v[224:239], a[16:19], a[52:55], v[224:239]
  v_mfma_f32_32x32x16_bf16 v[144:159], a[20:23], a[48:51], v[144:159]
  s_add_u32 m0, s52, 37888
  s_nop 0
  buffer_load_dwordx4 v29, s[48:51], s26 offen lds
  v_mfma_f32_32x32x16_bf16 v[240:255], a[20:23], a[52:55], v[240:255]
  s_waitcnt lgkmcnt(0)
  v_mfma_f32_32x32x16_bf16 v[64:79], a[24:27], a[56:59], v[64:79]
  ds_read_b128 a[48:51], v34 offset:0
  ds_read_b128 a[52:55], v34 offset:4096
  s_add_u32 m0, s52, 38912
  s_nop 0
  buffer_load_dwordx4 v30, s[48:51], s26 offen lds
  v_mfma_f32_32x32x16_bf16 v[160:175], a[24:27], a[60:63], v[160:175]
  ds_read_b64_tr_b16 a[0:1], v16 offset:6144
  ds_read_b64_tr_b16 a[2:3], v16 offset:7680
  v_mfma_f32_32x32x16_bf16 v[80:95], a[28:31], a[56:59], v[80:95]
  ds_read_b64_tr_b16 a[4:5], v17 offset:6208
  ds_read_b64_tr_b16 a[6:7], v17 offset:7744
  s_add_u32 m0, s52, 39936
  s_nop 0
  buffer_load_dwordx4 v31, s[48:51], s26 offen lds
  s_add_u32 s26, s26, 128
  v_mfma_f32_32x32x16_bf16 v[176:191], a[28:31], a[60:63], v[176:191]
  ds_read_b64_tr_b16 a[8:9], v16 offset:6272
  ds_read_b64_tr_b16 a[10:11], v16 offset:7808
  v_mfma_f32_32x32x16_bf16 v[96:111], a[32:35], a[56:59], v[96:111]
  ds_read_b64_tr_b16 a[12:13], v17 offset:6336
  ds_read_b64_tr_b16 a[14:15], v17 offset:7872
  s_add_u32 m0, s29, s32
  s_nop 0
  buffer_load_dwordx4 v8, s[12:15], s27 offen lds
  v_mfma_f32_32x32x16_bf16 v[192:207], a[32:35], a[60:63], v[192:207]
  ds_read_b64_tr_b16 a[16:17], v16 offset:6400
  ds_read_b64_tr_b16 a[18:19], v16 offset:7936
  v_mfma_f32_32x32x16_bf16 v[112:127], a[36:39], a[56:59], v[112:127]
  ds_read_b64_tr_b16 a[20:21], v17 offset:6464
  ds_read_b64_tr_b16 a[22:23], v17 offset:8000
  v_mfma_f32_32x32x16_bf16 v[208:223], a[36:39], a[60:63], v[208:223]
  v_mfma_f32_32x32x16_bf16 v[128:143], a[40:43], a[56:59], v[128:143]
  v_mfma_f32_32x32x16_bf16 v[224:239], a[40:43], a[60:63], v[224:239]
  s_add_u32 m0, m0, 1024
  s_nop 0
  buffer_load_dwordx4 v9, s[12:15], s27 offen lds
  v_mfma_f32_32x32x16_bf16 v[144:159], a[44:47], a[56:59], v[144:159]
  v_mfma_f32_32x32x16_bf16 v[240:255], a[44:47], a[60:63], v[240:255]
  s_waitcnt lgkmcnt(0)
  v_mfma_f32_32x32x16_bf16 v[64:79], a[0:3], a[48:51], v[64:79]
  ds_read_b128 a[56:59], v35 offset:0
  ds_read_b128 a[60:63], v35 offset:4096
  v_mfma_f32_32x32x16_bf16 v[160:175], a[0:3], a[52:55], v[160:175]
  ds_read_b64_tr_b16 a[24:25], v16 offset:9216
  ds_read_b64_tr_b16 a[26:27], v16 offset:10752
  v_mfma_f32_32x32x16_bf16 v[80:95], a[4:7], a[48:51], v[80:95]
  ds_read_b64_tr_b16 a[28:29], v17 offset:9280
  ds_read_b64_tr_b16 a[30:31], v17 offset:10816
  s_add_u32 m0, m0, 1024
  s_nop 0
  buffer_load_dwordx4 v10, s[12:15], s27 offen lds
  v_mfma_f32_32x32x16_bf16 v[176:191], a[4:7], a[52:55], v[176:191]
  ds_read_b64_tr_b16 a[32:33], v16 offset:9344
  ds_read_b64_tr_b16 a[34:35], v16 offset:10880
  v_mfma_f32_32x32x16_bf16 v[96:111], a[8:11], a[48:51], v[96:111]
  ds_read_b64_tr_b16 a[36:37], v17 offset:9408
  ds_read_b64_tr_b16 a[38:39], v17 offset:10944
  v_mfma_f32_32x32x16_bf16 v[192:207], a[8:11], a[52:55], v[192:207]
  ds_read_b64_tr_b16 a[40:41], v16 offset:9472
  ds_read_b64_tr_b16 a[42:43], v16 offset:11008
  v_mfma_f32_32x32x16_bf16 v[112:127], a[12:15], a[48:51], v[112:127]
  ds_read_b64_tr_b16 a[44:45], v17 offset:9536
  ds_read_b64_tr_b16 a[46:47], v17 offset:11072
  v_mfma_f32_32x32x16_bf16 v[208:223], a[12:15], a[52:55], v[208:223]
  s_add_u32 m0, m0, 1024
  s_nop 0
  buffer_load_dwordx4 v11, s[12:15], s27 offen lds
  v_mfma_f32_32x32x16_bf16 v[128:143], a[16:19], a[48:51], v[128:143]
  v_mfma_f32_32x32x16_bf16 v[224:239], a[16:19], a[52:55], v[224:239]
  v_mfma_f32_32x32x16_bf16 v[144:159], a[20:23], a[48:51], v[144:159]
  v_mfma_f32_32x32x16_bf16 v[240:255], a[20:23], a[52:55], v[240:255]
  s_waitcnt vmcnt(4) lgkmcnt(0)
  s_barrier
  s_add_u32 s30, s30, 24576
  s_cmp_eq_u32 s30, 98304
  s_cselect_b32 s30, 0, s30
  v_add_u32 v16, s30, v14
  v_add_u32 v17, s30, v15
  v_mfma_f32_32x32x16_bf16 v[64:79], a[24:27], a[56:59], v[64:79]
  ds_read_b128 a[48:51], v32 offset:32768
  ds_read_b128 a[52:55], v32 offset:36864
  s_add_u32 m0, m0, 1024
  s_nop 0
  buffer_load_dwordx4 v12, s[12:15], s27 offen lds
  v_mfma_f32_32x32x16_bf16 v[160:175], a[24:27], a[60:63], v[160:175]
  ds_read_b64_tr_b16 a[0:1], v16 offset:0
  ds_read_b64_tr_b16 a[2:3], v16 offset:1536
  v_mfma_f32_32x32x16_bf16 v[80:95], a[28:31], a[56:59], v[80:95]
  ds_read_b64_tr_b16 a[4:5], v17 offset:64
  ds_read_b64_tr_b16 a[6:7], v17 offset:1600
  v_mfma_f32_32x32x16_bf16 v[176:191], a[28:31], a[60:63], v[176:191]
  ds_read_b64_tr_b16 a[8:9], v16 offset:128
  ds_read_b64_tr_b16 a[10:11], v16 offset:1664
  v_mfma_f32_32x32x16_bf16 v[96:111], a[32:35], a[56:59], v[96:111]
  ds_read_b64_tr_b16 a[12:13], v17 offset:192
  ds_read_b64_tr_b16 a[14:15], v17 offset:1728
  v_mfma_f32_32x32x16_bf16 v[192:207], a[32:35], a[60:63], v[192:207]
  ds_read_b64_tr_b16 a[16:17], v16 offset:256
  ds_read_b64_tr_b16 a[18:19], v16 offset:1792
  s_add_u32 m0, m0, 1024
  s_nop 0
  buffer_load_dwordx4 v13, s[12:15], s27 offen lds
  s_add_u32 s27, s27, s28
  s_add_u32 s29, s29, 24576
  s_cmp_eq_u32 s29, 98304
  s_cselect_b32 s29, 0, s29
  v_mfma_f32_32x32x16_bf16 v[112:127], a[36:39], a[56:59], v[112:127]
  ds_read_b64_tr_b16 a[20:21], v17 offset:320
  ds_read_b64_tr_b16 a[22:23], v17 offset:1856
  v_mfma_f32_32x32x16_bf16 v[208:223], a[36:39], a[60:63], v[208:223]
  v_mfma_f32_32x32x16_bf16 v[128:143], a[40:43], a[56:59], v[128:143]
  v_mfma_f32_32x32x16_bf16 v[224:239], a[40:43], a[60:63], v[224:239]
  v_mfma_f32_32x32x16_bf16 v[144:159], a[44:47], a[56:59], v[144:159]
  v_mfma_f32_32x32x16_bf16 v[240:255], a[44:47], a[60:63], v[240:255]
  s_waitcnt lgkmcnt(0)
  v_mfma_f32_32x32x16_bf16 v[64:79], a[0:3], a[48:51], v[64:79]
  ds_read_b128 a[56:59], v33 offset:32768
  ds_read_b128 a[60:63], v33 offset:36864
  s_add_u32 m0, s52, 0
  s_nop 0
  buffer_load_dwordx4 v24, s[48:51], s26 offen lds
  v_mfma_f32_32x32x16_bf16 v[160:175], a[0:3], a[52:55], v[160:175]
  ds_read_b64_tr_b16 a[24:25], v16 offset:3072
  ds_read_b64_tr_b16 a[26:27], v16 offset:4608
  v_mfma_f32_32x32x16_bf16 v[80:95], a[4:7], a[48:51], v[80:95]
  ds_read_b64_tr_b16 a[28:29], v17 offset:3136
  ds_read_b64_tr_b16 a[30:31], v17 offset:4672
  s_add_u32 m0, s52, 1024
  s_nop 0
  buffer_load_dwordx4 v25, s[48:51], s26 offen lds
  v_mfma_f32_32x32x16_bf16 v[176:191], a[4:7], a[52:55], v[176:191]
  ds_read_b64_tr_b16 a[32:33], v16 offset:3200
  ds_read_b64_tr_b16 a[34:35], v16 offset:4736
  v_mfma_f32_32x32x16_bf16 v[96:111], a[8:11], a[48:51], v[96:111]
  ds_read_b64_tr_b16 a[36:37], v17 offset:3264
  ds_read_b64_tr_b16 a[38:39], v17 offset:4800
  s_add_u32 m0, s52, 2048
  s_nop 0
  buffer_load_dwordx4 v26, s[48:51], s26 offen lds
  v_mfma_f32_32x32x16_bf16 v[192:207], a[8:11], a[52:55], v[192:207]
  ds_read_b64_tr_b16 a[40:41], v16 offset:3328
  ds_read_b64_tr_b16 a[42:43], v16 offset:4864
  v_mfma_f32_32x32x16_bf16 v[112:127], a[12:15], a[48:51], v[112:127]
  ds_read_b64_tr_b16 a[44:45], v17 offset:3392
  ds_read_b64_tr_b16 a[46:47], v17 offset:4928
  s_add_u32 m0, s52, 3072
  s_nop 0
  buffer_load_dwordx4 v27, s[48:51], s26 offen lds
  v_mfma_f32_32x32x16_bf16 v[208:223], a[12:15], a[52:55], v[208:223]
  v_mfma_f32_32x32x16_bf16 v[128:143], a[16:19], a[48:51], v[128:143]
  s_add_u32 m0, s52, 4096
  s_nop 0
  buffer_load_dwordx4 v28, s[48:51], s26 offen lds
  v_mfma_f32_32x32x16_bf16 v[224:239], a[16:19], a[52:55], v[224:239]
  v_mfma_f32_32x32x16_bf16 v[144:159], a[20:23], a[48:51], v[144:159]
  s_add_u32 m0, s52, 5120
  s_nop 0
  buffer_load_dwordx4 v29, s[48:51], s26 offen lds
  v_mfma_f32_32x32x16_bf16 v[240:255], a[20:23], a[52:55], v[240:255]
  s_waitcnt lgkmcnt(0)
  v_mfma_f32_32x32x16_bf16 v[64:79], a[24:27], a[56:59], v[64:79]
  ds_read_b128 a[48:51], v34 offset:32768
  ds_read_b128 a[52:55], v34 offset:36864
  s_add_u32 m0, s52, 6144
  s_nop 0
  buffer_load_dwordx4 v30, s[48:51], s26 offen lds
  v_mfma_f32_32x32x16_bf16 v[160:175], a[24:27], a[60:63], v[160:175]
  ds_read_b64_tr_b16 a[0:1], v16 offset:6144
  ds_read_b64_tr_b16 a[2:3], v16 offset:7680
  v_mfma_f32_32x32x16_bf16 v[80:95], a[28:31], a[56:59], v[80:95]
  ds_read_b64_tr_b16 a[4:5], v17 offset:6208
  ds_read_b64_tr_b16 a[6:7], v17 offset:7744
  s_add_u32 m0, s52, 7168
  s_nop 0
  buffer_load_dwordx4 v31, s[48:51], s26 offen lds
  s_add_u32 s26, s26, 128
  v_mfma_f32_32x32x16_bf16 v[176:191], a[28:31], a[60:63], v[176:191]
  ds_read_b64_tr_b16 a[8:9], v16 offset:6272
  ds_read_b64_tr_b16 a[10:11], v16 offset:7808
  v_mfma_f32_32x32x16_bf16 v[96:111], a[32:35], a[56:59], v[96:111]
  ds_read_b64_tr_b16 a[12:13], v17 offset:6336
  ds_read_b64_tr_b16 a[14:15], v17 offset:7872
  s_add_u32 m0, s29, s32
  s_nop 0
  buffer_load_dwordx4 v8, s[12:15], s27 offen lds
  v_mfma_f32_32x32x16_bf16 v[192:207], a[32:35], a[60:63], v[192:207]
  ds_read_b64_tr_b16 a[16:17], v16 offset:6400
  ds_read_b64_tr_b16 a[18:19], v16 offset:7936
  v_mfma_f32_32x32x16_bf16 v[112:127], a[36:39], a[56:59], v[112:127]
  ds_read_b64_tr_b16 a[20:21], v17 offset:6464
  ds_read_b64_tr_b16 a[22:23], v17 offset:8000
  v_mfma_f32_32x32x16_bf16 v[208:223], a[36:39], a[60:63], v[208:223]
  v_mfma_f32_32x32x16_bf16 v[128:143], a[40:43], a[56:59], v[128:143]
  v_mfma_f32_32x32x16_bf16 v[224:239], a[40:43], a[60:63], v[224:239]
  s_add_u32 m0, m0, 1024
  s_nop 0
  buffer_load_dwordx4 v9, s[12:15], s27 offen lds
  v_mfma_f32_32x32x16_bf16 v[144:159], a[44:47], a[56:59], v[144:159]
  v_mfma_f32_32x32x16_bf16 v[240:255], a[44:47], a[60:63], v[240:255]
  s_waitcnt lgkmcnt(0)
  v_mfma_f32_32x32x16_bf16 v[64:79], a[0:3], a[48:51], v[64:79]
  ds_read_b128 a[56:59], v35 offset:32768
  ds_read_b128 a[60:63], v35 offset:36864
  v_mfma_f32_32x32x16_bf16 v[160:175], a[0:3], a[52:55], v[160:175]
  ds_read_b64_tr_b16 a[24:25], v16 offset:9216
  ds_read_b64_tr_b16 a[26:27], v16 offset:10752
  v_mfma_f32_32x32x16_bf16 v[80:95], a[4:7], a[48:51], v[80:95]
  ds_read_b64_tr_b16 a[28:29], v17 offset:9280
  ds_read_b64_tr_b16 a[30:31], v17 offset:10816
  s_add_u32 m0, m0, 1024
  s_nop 0
  buffer_load_dwordx4 v10, s[12:15], s27 offen lds
  v_mfma_f32_32x32x16_bf16 v[176:191], a[4:7], a[52:55], v[176:191]
  ds_read_b64_tr_b16 a[32:33], v16 offset:9344
  ds_read_b64_tr_b16 a[34:35], v16 offset:10880
  v_mfma_f32_32x32x16_bf16 v[96:111], a[8:11], a[48:51], v[96:111]
  ds_read_b64_tr_b16 a[36:37], v17 offset:9408
  ds_read_b64_tr_b16 a[38:39], v17 offset:10944
  v_mfma_f32_32x32x16_bf16 v[192:207], a[8:11], a[52:55], v[192:207]
  ds_read_b64_tr_b16 a[40:41], v16 offset:9472
  ds_read_b64_tr_b16 a[42:43], v16 offset:11008
  v_mfma_f32_32x32x16_bf16 v[112:127], a[12:15], a[48:51], v[112:127]
  ds_read_b64_tr_b16 a[44:45], v17 offset:9536
  ds_read_b64_tr_b16 a[46:47], v17 offset:11072
  v_mfma_f32_32x32x16_bf16 v[208:223], a[12:15], a[52:55], v[208:223]
  s_add_u32 m0, m0, 1024
  s_nop 0
  buffer_load_dwordx4 v11, s[12:15], s27 offen lds
  v_mfma_f32_32x32x16_bf16 v[128:143], a[16:19], a[48:51], v[128:143]
  v_mfma_f32_32x32x16_bf16 v[224:239], a[16:19], a[52:55], v[224:239]
  v_mfma_f32_32x32x16_bf16 v[144:159], a[20:23], a[48:51], v[144:159]
  v_mfma_f32_32x32x16_bf16 v[240:255], a[20:23], a[52:55], v[240:255]
  s_waitcnt vmcnt(4) lgkmcnt(0)
  s_barrier
  s_add_u32 s30, s30, 24576
  s_cmp_eq_u32 s30, 98304
  s_cselect_b32 s30, 0, s30
  v_add_u32 v16, s30, v14
  v_add_u32 v17, s30, v15
  v_mfma_f32_32x32x16_bf16 v[64:79], a[24:27], a[56:59], v[64:79]
  ds_read_b128 a[48:51], v32 offset:0
  ds_read_b128 a[52:55], v32 offset:4096
  s_add_u32 m0, m0, 1024
  s_nop 0
  buffer_load_dwordx4 v12, s[12:15], s27 offen lds
  v_mfma_f32_32x32x16_bf16 v[160:175], a[24:27], a[60:63], v[160:175]
  ds_read_b64_tr_b16 a[0:1], v16 offset:0
  ds_read_b64_tr_b16 a[2:3], v16 offset:1536
  v_mfma_f32_32x32x16_bf16 v[80:95], a[28:31], a[56:59], v[80:95]
  ds_read_b64_tr_b16 a[4:5], v17 offset:64
  ds_read_b64_tr_b16 a[6:7], v17 offset:1600
  v_mfma_f32_32x32x16_bf16 v[176:191], a[28:31], a[60:63], v[176:191]
  ds_read_b64_tr_b16 a[8:9], v16 offset:128
  ds_read_b64_tr_b16 a[10:11], v16 offset:1664
  v_mfma_f32_32x32x16_bf16 v[96:111], a[32:35], a[56:59], v[96:111]
  ds_read_b64_tr_b16 a[12:13], v17 offset:192
  ds_read_b64_tr_b16 a[14:15], v17 offset:1728
  v_mfma_f32_32x32x16_bf16 v[192:207], a[32:35], a[60:63], v[192:207]
  ds_read_b64_tr_b16 a[16:17], v16 offset:256
  ds_read_b64_tr_b16 a[18:19], v16 offset:1792
  s_add_u32 m0, m0, 1024
  s_nop 0
  buffer_load_dwordx4 v13, s[12:15], s27 offen lds
  s_add_u32 s27, s27, s28
  s_add_u32 s29, s29, 24576
  s_cmp_eq_u32 s29, 98304
  s_cselect_b32 s29, 0, s29
  v_mfma_f32_32x32x16_bf16 v[112:127], a[36:39], a[56:59], v[112:127]
  ds_read_b64_tr_b16 a[20:21], v17 offset:320
  ds_read_b64_tr_b16 a[22:23], v17 offset:1856
  v_mfma_f32_32x32x16_bf16 v[208:223], a[36:39], a[60:63], v[208:223]
  v_mfma_f32_32x32x16_bf16 v[128:143], a[40:43], a[56:59], v[128:143]
  v_mfma_f32_32x32x16_bf16 v[224:239], a[40:43], a[60:63], v[224:239]
  v_mfma_f32_32x32x16_bf16 v[144:159], a[44:47], a[56:59], v[144:159]
  v_mfma_f32_32x32x16_bf16 v[240:255], a[44:47], a[60:63], v[240:255]
  s_waitcnt lgkmcnt(0)
  v_mfma_f32_32x32x16_bf16 v[64:79], a[0:3], a[48:51], v[64:79]
  ds_read_b128 a[56:59], v33 offset:0
  ds_read_b128 a[60:63], v33 offset:4096
  s_add_u32 m0, s52, 32768
  s_nop 0
  buffer_load_dwordx4 v24, s[48:51], s26 offen lds
  v_mfma_f32_32x32x16_bf16 v[160:175], a[0:3], a[52:55], v[160:175]
  ds_read_b64_tr_b16 a[24:25], v16 offset:3072
  ds_read_b64_tr_b16 a[26:27], v16 offset:4608
  v_mfma_f32_32x32x16_bf16 v[80:95], a[4:7], a[48:51], v[80:95]
  ds_read_b64_tr_b16 a[28:29], v17 offset:3136
  ds_read_b64_tr_b16 a[30:31], v17 offset:4672
  s_add_u32 m0, s52, 33792
  s_nop 0
  buffer_load_dwordx4 v25, s[48:51], s26 offen lds
  v_mfma_f32_32x32x16_bf16 v[176:191], a[4:7], a[52:55], v[176:191]
  ds_read_b64_tr_b16 a[32:33], v16 offset:3200
  ds_read_b64_tr_b16 a[34:35], v16 offset:4736
  v_mfma_f32_32x32x16_bf16 v[96:111], a[8:11], a[48:51], v[96:111]
  ds_read_b64_tr_b16 a[36:37], v17 offset:3264
  ds_read_b64_tr_b16 a[38:39], v17 offset:4800
  s_add_u32 m0, s52, 34816
  s_nop 0
  buffer_load_dwordx4 v26, s[48:51], s26 offen lds
  v_mfma_f32_32x32x16_bf16 v[192:207], a[8:11], a[52:55], v[192:207]
  ds_read_b64_tr_b16 a[40:41], v16 offset:3328
  ds_read_b64_tr_b16 a[42:43], v16 offset:4864
  v_mfma_f32_32x32x16_bf16 v[112:127], a[12:15], a[48:51], v[112:127]
  ds_read_b64_tr_b16 a[44:45], v17 offset:3392
  ds_read_b64_tr_b16 a[46:47], v17 offset:4928
  s_add_u32 m0, s52, 35840
  s_nop 0
  buffer_load_dwordx4 v27, s[48:51], s26 offen lds
  v_mfma_f32_32x32x16_bf16 v[208:223], a[12:15], a[52:55], v[208:223]
  v_mfma_f32_32x32x16_bf16 v[128:143], a[16:19], a[48:51], v[128:143]
  s_add_u32 m0, s52, 36864
  s_nop 0
  buffer_load_dwordx4 v28, s[48:51], s26 offen lds
  v_mfma_f32_32x32x16_bf16 v[224:239], a[16:19], a[52:55], v[224:239]
  v_mfma_f32_32x32x16_bf16 v[144:159], a[20:23], a[48:51], v[144:159]
  s_add_u32 m0, s52, 37888
  s_nop 0
  buffer_load_dwordx4 v29, s[48:51], s26 offen lds
  v_mfma_f32_32x32x16_bf16 v[240:255], a[20:23], a[52:55], v[240:255]
  s_waitcnt lgkmcnt(0)
  v_mfma_f32_32x32x16_bf16 v[64:79], a[24:27], a[56:59], v[64:79]
  ds_read_b128 a[48:51], v34 offset:0
  ds_read_b128 a[52:55], v34 offset:4096
  s_add_u32 m0, s52, 38912
  s_nop 0
  buffer_load_dwordx4 v30, s[48:51], s26 offen lds
  v_mfma_f32_32x32x16_bf16 v[160:175], a[24:27], a[60:63], v[160:175]
  ds_read_b64_tr_b16 a[0:1], v16 offset:6144
  ds_read_b64_tr_b16 a[2:3], v16 offset:7680
  v_mfma_f32_32x32x16_bf16 v[80:95], a[28:31], a[56:59], v[80:95]
  ds_read_b64_tr_b16 a[4:5], v17 offset:6208
  ds_read_b64_tr_b16 a[6:7], v17 offset:7744
  s_add_u32 m0, s52, 39936
  s_nop 0
  buffer_load_dwordx4 v31, s[48:51], s26 offen lds
  s_add_u32 s26, s26, 128
  v_mfma_f32_32x32x16_bf16 v[176:191], a[28:31], a[60:63], v[176:191]
  ds_read_b64_tr_b16 a[8:9], v16 offset:6272
  ds_read_b64_tr_b16 a[10:11], v16 offset:7808
  v_mfma_f32_32x32x16_bf16 v[96:111], a[32:35], a[56:59], v[96:111]
  ds_read_b64_tr_b16 a[12:13], v17 offset:6336
  ds_read_b64_tr_b16 a[14:15], v17 offset:7872
  s_add_u32 m0, s29, s34
  s_nop 0
  buffer_load_dwordx4 v18, s[16:19], s37 offen lds
  v_mfma_f32_32x32x16_bf16 v[192:207], a[32:35], a[60:63], v[192:207]
  ds_read_b64_tr_b16 a[16:17], v16 offset:6400
  ds_read_b64_tr_b16 a[18:19], v16 offset:7936
  v_mfma_f32_32x32x16_bf16 v[112:127], a[36:39], a[56:59], v[112:127]
  ds_read_b64_tr_b16 a[20:21], v17 offset:6464
  ds_read_b64_tr_b16 a[22:23], v17 offset:8000
  v_mfma_f32_32x32x16_bf16 v[208:223], a[36:39], a[60:63], v[208:223]
  v_mfma_f32_32x32x16_bf16 v[128:143], a[40:43], a[56:59], v[128:143]
  v_mfma_f32_32x32x16_bf16 v[224:239], a[40:43], a[60:63], v[224:239]
  v_mfma_f32_32x32x16_bf16 v[144:159], a[44:47], a[56:59], v[144:159]
  s_add_u32 m0, m0, 1024
  s_nop 0
  buffer_load_dwordx4 v19, s[16:19], s37 offen lds
  v_mfma_f32_32x32x16_bf16 v[240:255], a[44:47], a[60:63], v[240:255]
  s_waitcnt lgkmcnt(0)
  v_mfma_f32_32x32x16_bf16 v[64:79], a[0:3], a[48:51], v[64:79]
  ds_read_b128 a[56:59], v35 offset:0
  ds_read_b128 a[60:63], v35 offset:4096
  v_mfma_f32_32x32x16_bf16 v[160:175], a[0:3], a[52:55], v[160:175]
  ds_read_b64_tr_b16 a[24:25], v16 offset:9216
  ds_read_b64_tr_b16 a[26:27], v16 offset:10752
  v_mfma_f32_32x32x16_bf16 v[80:95], a[4:7], a[48:51], v[80:95]
  ds_read_b64_tr_b16 a[28:29], v17 offset:9280
  ds_read_b64_tr_b16 a[30:31], v17 offset:10816
  v_mfma_f32_32x32x16_bf16 v[176:191], a[4:7], a[52:55], v[176:191]
  ds_read_b64_tr_b16 a[32:33], v16 offset:9344
  ds_read_b64_tr_b16 a[34:35], v16 offset:10880
  v_mfma_f32_32x32x16_bf16 v[96:111], a[8:11], a[48:51], v[96:111]
  ds_read_b64_tr_b16 a[36:37], v17 offset:9408
  ds_read_b64_tr_b16 a[38:39], v17 offset:10944
  s_add_u32 m0, m0, 1024
  s_nop 0
  buffer_load_dwordx4 v20, s[16:19], s37 offen lds
  v_mfma_f32_32x32x16_bf16 v[192:207], a[8:11], a[52:55], v[192:207]
  ds_read_b64_tr_b16 a[40:41], v16 offset:9472
  ds_read_b64_tr_b16 a[42:43], v16 offset:11008
  v_mfma_f32_32x32x16_bf16 v[112:127], a[12:15], a[48:51], v[112:127]
  ds_read_b64_tr_b16 a[44:45], v17 offset:9536
  ds_read_b64_tr_b16 a[46:47], v17 offset:11072
  v_mfma_f32_32x32x16_bf16 v[208:223], a[12:15], a[52:55], v[208:223]
  v_mfma_f32_32x32x16_bf16 v[128:143], a[16:19], a[48:51], v[128:143]
  v_mfma_f32_32x32x16_bf16 v[224:239], a[16:19], a[52:55], v[224:239]
  v_mfma_f32_32x32x16_bf16 v[144:159], a[20:23], a[48:51], v[144:159]
  s_add_u32 m0, m0, 1024
  s_nop 0
  buffer_load_dwordx4 v21, s[16:19], s37 offen lds
  v_mfma_f32_32x32x16_bf16 v[240:255], a[20:23], a[52:55], v[240:255]
  s_waitcnt vmcnt(4) lgkmcnt(0)
  s_barrier
  s_add_u32 s30, s30, 24576
  s_cmp_eq_u32 s30, 98304
  s_cselect_b32 s30, 0, s30
  v_add_u32 v16, s30, v14
  v_add_u32 v17, s30, v15
  v_mfma_f32_32x32x16_bf16 v[64:79], a[24:27], a[56:59], v[64:79]
  ds_read_b128 a[48:51], v32 offset:32768
  ds_read_b128 a[52:55], v32 offset:36864
  v_mfma_f32_32x32x16_bf16 v[160:175], a[24:27], a[60:63], v[160:175]
  ds_read_b64_tr_b16 a[0:1], v16 offset:0
  ds_read_b64_tr_b16 a[2:3], v16 offset:1536
  v_mfma_f32_32x32x16_bf16 v[80:95], a[28:31], a[56:59], v[80:95]
  ds_read_b64_tr_b16 a[4:5], v17 offset:64
  ds_read_b64_tr_b16 a[6:7], v17 offset:1600
  v_mfma_f32_32x32x16_bf16 v[176:191], a[28:31], a[60:63], v[176:191]
  ds_read_b64_tr_b16 a[8:9], v16 offset:128
  ds_read_b64_tr_b16 a[10:11], v16 offset:1664
  v_mfma_f32_32x32x16_bf16 v[96:111], a[32:35], a[56:59], v[96:111]
  ds_read_b64_tr_b16 a[12:13], v17 offset:192
  ds_read_b64_tr_b16 a[14:15], v17 offset:1728
  s_add_u32 m0, m0, 1024
  s_nop 0
  buffer_load_dwordx4 v22, s[16:19], s37 offen lds
  s_add_u32 s37, s37, 81920
  s_add_u32 s29, s29, 24576
  s_cmp_eq_u32 s29, 98304
  s_cselect_b32 s29, 0, s29
  s_add_u32 s40, s40, 1
  s_cmp_eq_u32 s40, 3
  s_cselect_b32 s40, 0, s40
  s_cselect_b32 s42, 4294721856, 0
  s_add_u32 s37, s37, s42
  v_mfma_f32_32x32x16_bf16 v[192:207], a[32:35], a[60:63], v[192:207]
  ds_read_b64_tr_b16 a[16:17], v16 offset:256
  ds_read_b64_tr_b16 a[18:19], v16 offset:1792
  v_mfma_f32_32x32x16_bf16 v[112:127], a[36:39], a[56:59], v[112:127]
  ds_read_b64_tr_b16 a[20:21], v17 offset:320
  ds_read_b64_tr_b16 a[22:23], v17 offset:1856
  v_mfma_f32_32x32x16_bf16 v[208:223], a[36:39], a[60:63], v[208:223]
  v_mfma_f32_32x32x16_bf16 v[128:143], a[40:43], a[56:59], v[128:143]
  v_mfma_f32_32x32x16_bf16 v[224:239], a[40:43], a[60:63], v[224:239]
  v_mfma_f32_32x32x16_bf16 v[144:159], a[44:47], a[56:59], v[144:159]
  v_mfma_f32_32x32x16_bf16 v[240:255], a[44:47], a[60:63], v[240:255]
  s_waitcnt lgkmcnt(0)
  v_mfma_f32_32x32x16_bf16 v[64:79], a[0:3], a[48:51], v[64:79]
  ds_read_b128 a[56:59], v33 offset:32768
  ds_read_b128 a[60:63], v33 offset:36864
  s_add_u32 m0, s29, s34
  s_nop 0
  buffer_load_dwordx4 v18, s[16:19], s37 offen lds
  v_mfma_f32_32x32x16_bf16 v[160:175], a[0:3], a[52:55], v[160:175]
  ds_read_b64_tr_b16 a[24:25], v16 offset:3072
  ds_read_b64_tr_b16 a[26:27], v16 offset:4608
  v_mfma_f32_32x32x16_bf16 v[80:95], a[4:7], a[48:51], v[80:95]
  ds_read_b64_tr_b16 a[28:29], v17 offset:3136
  ds_read_b64_tr_b16 a[30:31], v17 offset:4672
  v_mfma_f32_32x32x16_bf16 v[176:191], a[4:7], a[52:55], v[176:191]
  ds_read_b64_tr_b16 a[32:33], v16 offset:3200
  ds_read_b64_tr_b16 a[34:35], v16 offset:4736
  v_mfma_f32_32x32x16_bf16 v[96:111], a[8:11], a[48:51], v[96:111]
  ds_read_b64_tr_b16 a[36:37], v17 offset:3264
  ds_read_b64_tr_b16 a[38:39], v17 offset:4800
  v_mfma_f32_32x32x16_bf16 v[192:207], a[8:11], a[52:55], v[192:207]
  ds_read_b64_tr_b16 a[40:41], v16 offset:3328
  ds_read_b64_tr_b16 a[42:43], v16 offset:4864
  v_mfma_f32_32x32x16_bf16 v[112:127], a[12:15], a[48:51], v[112:127]
  ds_read_b64_tr_b16 a[44:45], v17 offset:3392
  ds_read_b64_tr_b16 a[46:47], v17 offset:4928
  v_mfma_f32_32x32x16_bf16 v[208:223], a[12:15], a[52:55], v[208:223]
  v_mfma_f32_32x32x16_bf16 v[128:143], a[16:19], a[48:51], v[128:143]
  v_mfma_f32_32x32x16_bf16 v[224:239], a[16:19], a[52:55], v[224:239]
  s_add_u32 m0, m0, 1024
  s_nop 0
  buffer_load_dwordx4 v19, s[16:19], s37 offen lds
  v_mfma_f32_32x32x16_bf16 v[144:159], a[20:23], a[48:51], v[144:159]
  v_mfma_f32_32x32x16_bf16 v[240:255], a[20:23], a[52:55], v[240:255]
  s_waitcnt lgkmcnt(0)
  v_mfma_f32_32x32x16_bf16 v[64:79], a[24:27], a[56:59], v[64:79]
  ds_read_b128 a[48:51], v34 offset:32768
  ds_read_b128 a[52:55], v34 offset:36864
  v_mfma_f32_32x32x16_bf16 v[160:175], a[24:27], a[60:63], v[160:175]
  ds_read_b64_tr_b16 a[0:1], v16 offset:6144
  ds_read_b64_tr_b16 a[2:3], v16 offset:7680
  v_mfma_f32_32x32x16_bf16 v[80:95], a[28:31], a[56:59], v[80:95]
  ds_read_b64_tr_b16 a[4:5], v17 offset:6208
  ds_read_b64_tr_b16 a[6:7], v17 offset:7744
  v_mfma_f32_32x32x16_bf16 v[176:191], a[28:31], a[60:63], v[176:191]
  ds_read_b64_tr_b16 a[8:9], v16 offset:6272
  ds_read_b64_tr_b16 a[10:11], v16 offset:7808
  v_mfma_f32_32x32x16_bf16 v[96:111], a[32:35], a[56:59], v[96:111]
  ds_read_b64_tr_b16 a[12:13], v17 offset:6336
  ds_read_b64_tr_b16 a[14:15], v17 offset:7872
  v_mfma_f32_32x32x16_bf16 v[192:207], a[32:35], a[60:63], v[192:207]
  ds_read_b64_tr_b16 a[16:17], v16 offset:6400
  ds_read_b64_tr_b16 a[18:19], v16 offset:7936
  v_mfma_f32_32x32x16_bf16 v[112:127], a[36:39], a[56:59], v[112:127]
  ds_read_b64_tr_b16 a[20:21], v17 offset:6464
  ds_read_b64_tr_b16 a[22:23], v17 offset:8000
  s_add_u32 m0, m0, 1024
  s_nop 0
  buffer_load_dwordx4 v20, s[16:19], s37 offen lds
  v_mfma_f32_32x32x16_bf16 v[208:223], a[36:39], a[60:63], v[208:223]
  v_mfma_f32_32x32x16_bf16 v[128:143], a[40:43], a[56:59], v[128:143]
  v_mfma_f32_32x32x16_bf16 v[224:239], a[40:43], a[60:63], v[224:239]
  v_mfma_f32_32x32x16_bf16 v[144:159], a[44:47], a[56:59], v[144:159]
  v_mfma_f32_32x32x16_bf16 v[240:255], a[44:47], a[60:63], v[240:255]
  s_waitcnt lgkmcnt(0)
  v_mfma_f32_32x32x16_bf16 v[64:79], a[0:3], a[48:51], v[64:79]
  ds_read_b128 a[56:59], v35 offset:32768
  ds_read_b128 a[60:63], v35 offset:36864
  v_mfma_f32_32x32x16_bf16 v[160:175], a[0:3], a[52:55], v[160:175]
  ds_read_b64_tr_b16 a[24:25], v16 offset:9216
  ds_read_b64_tr_b16 a[26:27], v16 offset:10752
  v_mfma_f32_32x32x16_bf16 v[80:95], a[4:7], a[48:51], v[80:95]
  ds_read_b64_tr_b16 a[28:29], v17 offset:9280
  ds_read_b64_tr_b16 a[30:31], v17 offset:10816
  v_mfma_f32_32x32x16_bf16 v[176:191], a[4:7], a[52:55], v[176:191]
  ds_read_b64_tr_b16 a[32:33], v16 offset:9344
  ds_read_b64_tr_b16 a[34:35], v16 offset:10880
  s_add_u32 m0, m0, 1024
  s_nop 0
  buffer_load_dwordx4 v21, s[16:19], s37 offen lds
  v_mfma_f32_32x32x16_bf16 v[96:111], a[8:11], a[48:51], v[96:111]
  ds_read_b64_tr_b16 a[36:37], v17 offset:9408
  ds_read_b64_tr_b16 a[38:39], v17 offset:10944
  v_mfma_f32_32x32x16_bf16 v[192:207], a[8:11], a[52:55], v[192:207]
  ds_read_b64_tr_b16 a[40:41], v16 offset:9472
  ds_read_b64_tr_b16 a[42:43], v16 offset:11008
  v_mfma_f32_32x32x16_bf16 v[112:127], a[12:15], a[48:51], v[112:127]
  ds_read_b64_tr_b16 a[44:45], v17 offset:9536
  ds_read_b64_tr_b16 a[46:47], v17 offset:11072
  v_mfma_f32_32x32x16_bf16 v[208:223], a[12:15], a[52:55], v[208:223]
  v_mfma_f32_32x32x16_bf16 v[128:143], a[16:19], a[48:51], v[128:143]
  v_mfma_f32_32x32x16_bf16 v[224:239], a[16:19], a[52:55], v[224:239]
  v_mfma_f32_32x32x16_bf16 v[144:159], a[20:23], a[48:51], v[144:159]
  v_mfma_f32_32x32x16_bf16 v[240:255], a[20:23], a[52:55], v[240:255]
  s_waitcnt lgkmcnt(0)
  v_mfma_f32_32x32x16_bf16 v[64:79], a[24:27], a[56:59], v[64:79]
  s_add_u32 m0, m0, 1024
  s_nop 0
  buffer_load_dwordx4 v22, s[16:19], s37 offen lds
  s_add_u32 s37, s37, 81920
  s_add_u32 s29, s29, 24576
  s_cmp_eq_u32 s29, 98304
  s_cselect_b32 s29, 0, s29
  s_add_u32 s40, s40, 1
  s_cmp_eq_u32 s40, 3
  s_cselect_b32 s40, 0, s40
  s_cselect_b32 s42, 4294721856, 0
  s_add_u32 s37, s37, s42
  v_mfma_f32_32x32x16_bf16 v[160:175], a[24:27], a[60:63], v[160:175]
  v_mfma_f32_32x32x16_bf16 v[80:95], a[28:31], a[56:59], v[80:95]
  v_mfma_f32_32x32x16_bf16 v[176:191], a[28:31], a[60:63], v[176:191]
  v_mfma_f32_32x32x16_bf16 v[96:111], a[32:35], a[56:59], v[96:111]
  v_mfma_f32_32x32x16_bf16 v[192:207], a[32:35], a[60:63], v[192:207]
  v_mfma_f32_32x32x16_bf16 v[112:127], a[36:39], a[56:59], v[112:127]
  v_mfma_f32_32x32x16_bf16 v[208:223], a[36:39], a[60:63], v[208:223]
  v_mfma_f32_32x32x16_bf16 v[128:143], a[40:43], a[56:59], v[128:143]
  v_mfma_f32_32x32x16_bf16 v[224:239], a[40:43], a[60:63], v[224:239]
  v_mfma_f32_32x32x16_bf16 v[144:159], a[44:47], a[56:59], v[144:159]
  v_mfma_f32_32x32x16_bf16 v[240:255], a[44:47], a[60:63], v[240:255]
  s_waitcnt vmcnt(5)
  s_barrier
  s_add_u32 s30, s30, 24576
  s_cmp_eq_u32 s30, 98304
  s_cselect_b32 s30, 0, s30
  v_add_u32 v16, s30, v23
  ds_read_b64_tr_b16 a[0:1], v16 offset:0
  ds_read_b64_tr_b16 a[2:3], v16 offset:2560
  ds_read_b64_tr_b16 a[4:5], v16 offset:64
  ds_read_b64_tr_b16 a[6:7], v16 offset:2624
  ds_read_b64_tr_b16 a[8:9], v16 offset:128
  ds_read_b64_tr_b16 a[10:11], v16 offset:2688
  ds_read_b64_tr_b16 a[12:13], v16 offset:192
  ds_read_b64_tr_b16 a[14:15], v16 offset:2752
  ds_read_b64_tr_b16 a[16:17], v16 offset:256
  ds_read_b64_tr_b16 a[18:19], v16 offset:2816
  v_cvt_pk_bf16_f32 v40, v64, v65
  v_accvgpr_write_b32 a128, v40
  v_cvt_pk_bf16_f32 v41, v66, v67
  v_accvgpr_write_b32 a129, v41
  v_cvt_pk_bf16_f32 v42, v68, v69
  v_accvgpr_write_b32 a130, v42
  v_cvt_pk_bf16_f32 v43, v70, v71
  v_accvgpr_write_b32 a131, v43
  v_cvt_pk_bf16_f32 v44, v72, v73
  v_accvgpr_write_b32 a132, v44
  v_cvt_pk_bf16_f32 v45, v74, v75
  v_accvgpr_write_b32 a133, v45
  v_cvt_pk_bf16_f32 v46, v76, v77
  v_accvgpr_write_b32 a134, v46
  v_cvt_pk_bf16_f32 v47, v78, v79
  v_accvgpr_write_b32 a135, v47
  v_cvt_pk_bf16_f32 v40, v80, v81
  v_accvgpr_write_b32 a136, v40
  v_cvt_pk_bf16_f32 v41, v82, v83
  v_accvgpr_write_b32 a137, v41
  v_cvt_pk_bf16_f32 v42, v84, v85
  v_accvgpr_write_b32 a138, v42
  v_cvt_pk_bf16_f32 v43, v86, v87
  v_accvgpr_write_b32 a139, v43
  v_cvt_pk_bf16_f32 v44, v88, v89
  v_accvgpr_write_b32 a140, v44
  v_cvt_pk_bf16_f32 v45, v90, v91
  v_accvgpr_write_b32 a141, v45
  v_cvt_pk_bf16_f32 v46, v92, v93
  v_accvgpr_write_b32 a142, v46
  v_cvt_pk_bf16_f32 v47, v94, v95
  v_accvgpr_write_b32 a143, v47
  v_cvt_pk_bf16_f32 v40, v96, v97
  v_accvgpr_write_b32 a144, v40
  v_cvt_pk_bf16_f32 v41, v98, v99
  v_accvgpr_write_b32 a145, v41
  v_cvt_pk_bf16_f32 v42, v100, v101
  v_accvgpr_write_b32 a146, v42
  v_cvt_pk_bf16_f32 v43, v102, v103
  v_accvgpr_write_b32 a147, v43
  v_cvt_pk_bf16_f32 v44, v104, v105
  v_accvgpr_write_b32 a148, v44
  v_cvt_pk_bf16_f32 v45, v106, v107
  v_accvgpr_write_b32 a149, v45
  v_cvt_pk_bf16_f32 v46, v108, v109
  v_accvgpr_write_b32 a150, v46
  v_cvt_pk_bf16_f32 v47, v110, v111
  v_accvgpr_write_b32 a151, v47
  v_cvt_pk_bf16_f32 v40, v112, v113
  v_accvgpr_write_b32 a152, v40
  v_cvt_pk_bf16_f32 v41, v114, v115
  v_accvgpr_write_b32 a153, v41
  v_cvt_pk_bf16_f32 v42, v116, v117
  v_accvgpr_write_b32 a154, v42
  v_cvt_pk_bf16_f32 v43, v118, v119
  v_accvgpr_write_b32 a155, v43
  v_cvt_pk_bf16_f32 v44, v120, v121
  v_accvgpr_write_b32 a156, v44
  v_cvt_pk_bf16_f32 v45, v122, v123
  v_accvgpr_write_b32 a157, v45
  v_cvt_pk_bf16_f32 v46, v124, v125
  v_accvgpr_write_b32 a158, v46
  v_cvt_pk_bf16_f32 v47, v126, v127
  v_accvgpr_write_b32 a159, v47
  v_cvt_pk_bf16_f32 v40, v128, v129
  v_accvgpr_write_b32 a160, v40
  v_cvt_pk_bf16_f32 v41, v130, v131
  v_accvgpr_write_b32 a161, v41
  v_cvt_pk_bf16_f32 v42, v132, v133
  v_accvgpr_write_b32 a162, v42
  v_cvt_pk_bf16_f32 v43, v134, v135
  v_accvgpr_write_b32 a163, v43
  v_cvt_pk_bf16_f32 v44, v136, v137
  v_accvgpr_write_b32 a164, v44
  v_cvt_pk_bf16_f32 v45, v138, v139
  v_accvgpr_write_b32 a165, v45
  v_cvt_pk_bf16_f32 v46, v140, v141
  v_accvgpr_write_b32 a166, v46
  v_cvt_pk_bf16_f32 v47, v142, v143
  v_accvgpr_write_b32 a167, v47
  v_cvt_pk_bf16_f32 v40, v144, v145
  v_accvgpr_write_b32 a168, v40
  v_cvt_pk_bf16_f32 v41, v146, v147
  v_accvgpr_write_b32 a169, v41
  v_cvt_pk_bf16_f32 v42, v148, v149
  v_accvgpr_write_b32 a170, v42
  v_cvt_pk_bf16_f32 v43, v150, v151
  v_accvgpr_write_b32 a171, v43
  v_cvt_pk_bf16_f32 v44, v152, v153
  v_accvgpr_write_b32 a172, v44
  v_cvt_pk_bf16_f32 v45, v154, v155
  v_accvgpr_write_b32 a173, v45
  v_cvt_pk_bf16_f32 v46, v156, v157
  v_accvgpr_write_b32 a174, v46
  v_cvt_pk_bf16_f32 v47, v158, v159
  v_accvgpr_write_b32 a175, v47
  v_cvt_pk_bf16_f32 v40, v160, v161
  v_accvgpr_write_b32 a176, v40
  v_cvt_pk_bf16_f32 v41, v162, v163
  v_accvgpr_write_b32 a177, v41
  v_cvt_pk_bf16_f32 v42, v164, v165
  v_accvgpr_write_b32 a178, v42
  v_cvt_pk_bf16_f32 v43, v166, v167
  v_accvgpr_write_b32 a179, v43
  v_cvt_pk_bf16_f32 v44, v168, v169
  v_accvgpr_write_b32 a180, v44
  v_cvt_pk_bf16_f32 v45, v170, v171
  v_accvgpr_write_b32 a181, v45
  v_cvt_pk_bf16_f32 v46, v172, v173
  v_accvgpr_write_b32 a182, v46
  v_cvt_pk_bf16_f32 v47, v174, v175
  v_accvgpr_write_b32 a183, v47
  v_cvt_pk_bf16_f32 v40, v176, v177
  v_accvgpr_write_b32 a184, v40
  v_cvt_pk_bf16_f32 v41, v178, v179
  v_accvgpr_write_b32 a185, v41
  v_cvt_pk_bf16_f32 v42, v180, v181
  v_accvgpr_write_b32 a186, v42
  v_cvt_pk_bf16_f32 v43, v182, v183
  v_accvgpr_write_b32 a187, v43
  v_cvt_pk_bf16_f32 v44, v184, v185
  v_accvgpr_write_b32 a188, v44
  v_cvt_pk_bf16_f32 v45, v186, v187
  v_accvgpr_write_b32 a189, v45
  v_cvt_pk_bf16_f32 v46, v188, v189
  v_accvgpr_write_b32 a190, v46
  v_cvt_pk_bf16_f32 v47, v190, v191
  v_accvgpr_write_b32 a191, v47
  v_cvt_pk_bf16_f32 v40, v192, v193
  v_accvgpr_write_b32 a192, v40
  v_cvt_pk_bf16_f32 v41, v194, v195
  v_accvgpr_write_b32 a193, v41
  v_cvt_pk_bf16_f32 v42, v196, v197
  v_accvgpr_write_b32 a194, v42
  v_cvt_pk_bf16_f32 v43, v198, v199
  v_accvgpr_write_b32 a195, v43
  v_cvt_pk_bf16_f32 v44, v200, v201
  v_accvgpr_write_b32 a196, v44
  v_cvt_pk_bf16_f32 v45, v202, v203
  v_accvgpr_write_b32 a197, v45
  v_cvt_pk_bf16_f32 v46, v204, v205
  v_accvgpr_write_b32 a198, v46
  v_cvt_pk_bf16_f32 v47, v206, v207
  v_accvgpr_write_b32 a199, v47
  v_cvt_pk_bf16_f32 v40, v208, v209
  v_accvgpr_write_b32 a200, v40
  v_cvt_pk_bf16_f32 v41, v210, v211
  v_accvgpr_write_b32 a201, v41
  v_cvt_pk_bf16_f32 v42, v212, v213
  v_accvgpr_write_b32 a202, v42
  v_cvt_pk_bf16_f32 v43, v214, v215
  v_accvgpr_write_b32 a203, v43
  v_cvt_pk_bf16_f32 v44, v216, v217
  v_accvgpr_write_b32 a204, v44
  v_cvt_pk_bf16_f32 v45, v218, v219
  v_accvgpr_write_b32 a205, v45
  v_cvt_pk_bf16_f32 v46, v220, v221
  v_accvgpr_write_b32 a206, v46
  v_cvt_pk_bf16_f32 v47, v222, v223
  v_accvgpr_write_b32 a207, v47
  v_cvt_pk_bf16_f32 v40, v224, v225
  v_accvgpr_write_b32 a208, v40
  v_cvt_pk_bf16_f32 v41, v226, v227
  v_accvgpr_write_b32 a209, v41
  v_cvt_pk_bf16_f32 v42, v228, v229
  v_accvgpr_write_b32 a210, v42
  v_cvt_pk_bf16_f32 v43, v230, v231
  v_accvgpr_write_b32 a211, v43
  v_cvt_pk_bf16_f32 v44, v232, v233
  v_accvgpr_write_b32 a212, v44
  v_cvt_pk_bf16_f32 v45, v234, v235
  v_accvgpr_write_b32 a213, v45
  v_cvt_pk_bf16_f32 v46, v236, v237
  v_accvgpr_write_b32 a214, v46
  v_cvt_pk_bf16_f32 v47, v238, v239
  v_accvgpr_write_b32 a215, v47
  v_cvt_pk_bf16_f32 v40, v240, v241
  v_accvgpr_write_b32 a216, v40
  v_cvt_pk_bf16_f32 v41, v242, v243
  v_accvgpr_write_b32 a217, v41
  v_cvt_pk_bf16_f32 v42, v244, v245
  v_accvgpr_write_b32 a218, v42
  v_cvt_pk_bf16_f32 v43, v246, v247
  v_accvgpr_write_b32 a219, v43
  v_cvt_pk_bf16_f32 v44, v248, v249
  v_accvgpr_write_b32 a220, v44
  v_cvt_pk_bf16_f32 v45, v250, v251
  v_accvgpr_write_b32 a221, v45
  v_cvt_pk_bf16_f32 v46, v252, v253
  v_accvgpr_write_b32 a222, v46
  v_cvt_pk_bf16_f32 v47, v254, v255
  v_accvgpr_write_b32 a223, v47
  s_waitcnt lgkmcnt(0)
  v_mfma_f32_32x32x16_bf16 v[64:79], a[128:131], a[0:3], 0
  ds_read_b64_tr_b16 a[24:25], v16 offset:5120
  ds_read_b64_tr_b16 a[26:27], v16 offset:7680
  s_add_u32 m0, s29, s34
  s_nop 0
  buffer_load_dwordx4 v18, s[16:19], s37 offen lds
  v_mfma_f32_32x32x16_bf16 v[80:95], a[128:131], a[4:7], 0
  ds_read_b64_tr_b16 a[28:29], v16 offset:5184
  ds_read_b64_tr_b16 a[30:31], v16 offset:7744
  v_mfma_f32_32x32x16_bf16 v[96:111], a[128:131], a[8:11], 0
  ds_read_b64_tr_b16 a[32:33], v16 offset:5248
  ds_read_b64_tr_b16 a[34:35], v16 offset:7808
  v_mfma_f32_32x32x16_bf16 v[112:127], a[128:131], a[12:15], 0
  ds_read_b64_tr_b16 a[36:37], v16 offset:5312
  ds_read_b64_tr_b16 a[38:39], v16 offset:7872
  v_mfma_f32_32x32x16_bf16 v[128:143], a[128:131], a[16:19], 0
  ds_read_b64_tr_b16 a[40:41], v16 offset:5376
  ds_read_b64_tr_b16 a[42:43], v16 offset:7936
  v_mfma_f32_32x32x16_bf16 v[144:159], a[176:179], a[0:3], 0
  v_mfma_f32_32x32x16_bf16 v[160:175], a[176:179], a[4:7], 0
  s_add_u32 m0, m0, 1024
  s_nop 0
  buffer_load_dwordx4 v19, s[16:19], s37 offen lds
  v_mfma_f32_32x32x16_bf16 v[176:191], a[176:179], a[8:11], 0
  v_mfma_f32_32x32x16_bf16 v[192:207], a[176:179], a[12:15], 0
  v_mfma_f32_32x32x16_bf16 v[208:223], a[176:179], a[16:19], 0
  s_waitcnt lgkmcnt(0)
  v_mfma_f32_32x32x16_bf16 v[64:79], a[132:135], a[24:27], v[64:79]
  ds_read_b64_tr_b16 a[0:1], v16 offset:10240
  ds_read_b64_tr_b16 a[2:3], v16 offset:12800
  v_mfma_f32_32x32x16_bf16 v[80:95], a[132:135], a[28:31], v[80:95]
  ds_read_b64_tr_b16 a[4:5], v16 offset:10304
  ds_read_b64_tr_b16 a[6:7], v16 offset:12864
  v_mfma_f32_32x32x16_bf16 v[96:111], a[132:135], a[32:35], v[96:111]
  ds_read_b64_tr_b16 a[8:9], v16 offset:10368
  ds_read_b64_tr_b16 a[10:11], v16 offset:12928
  s_add_u32 m0, m0, 1024
  s_nop 0
  buffer_load_dwordx4 v20, s[16:19], s37 offen lds
  v_mfma_f32_32x32x16_bf16 v[112:127], a[132:135], a[36:39], v[112:127]
  ds_read_b64_tr_b16 a[12:13], v16 offset:10432
  ds_read_b64_tr_b16 a[14:15], v16 offset:12992
  v_mfma_f32_32x32x16_bf16 v[128:143], a[132:135], a[40:43], v[128:143]
  ds_read_b64_tr_b16 a[16:17], v16 offset:10496
  ds_read_b64_tr_b16 a[18:19], v16 offset:13056
  v_mfma_f32_32x32x16_bf16 v[144:159], a[180:183], a[24:27], v[144:159]
  v_mfma_f32_32x32x16_bf16 v[160:175], a[180:183], a[28:31], v[160:175]
  v_mfma_f32_32x32x16_bf16 v[176:191], a[180:183], a[32:35], v[176:191]
  v_mfma_f32_32x32x16_bf16 v[192:207], a[180:183], a[36:39], v[192:207]
  s_add_u32 m0, m0, 1024
  s_nop 0
  buffer_load_dwordx4 v21, s[16:19], s37 offen lds
  v_mfma_f32_32x32x16_bf16 v[208:223], a[180:183], a[40:43], v[208:223]
  s_waitcnt lgkmcnt(0)
  v_mfma_f32_32x32x16_bf16 v[64:79], a[136:139], a[0:3], v[64:79]
  ds_read_b64_tr_b16 a[24:25], v16 offset:15360
  ds_read_b64_tr_b16 a[26:27], v16 offset:17920
  v_mfma_f32_32x32x16_bf16 v[80:95], a[136:139], a[4:7], v[80:95]
  ds_read_b64_tr_b16 a[28:29], v16 offset:15424
  ds_read_b64_tr_b16 a[30:31], v16 offset:17984
  v_mfma_f32_32x32x16_bf16 v[96:111], a[136:139], a[8:11], v[96:111]
  ds_read_b64_tr_b16 a[32:33], v16 offset:15488
  ds_read_b64_tr_b16 a[34:35], v16 offset:18048
  v_mfma_f32_32x32x16_bf16 v[112:127], a[136:139], a[12:15], v[112:127]
  ds_read_b64_tr_b16 a[36:37], v16 offset:15552
  ds_read_b64_tr_b16 a[38:39], v16 offset:18112
  v_mfma_f32_32x32x16_bf16 v[128:143], a[136:139], a[16:19], v[128:143]
  ds_read_b64_tr_b16 a[40:41], v16 offset:15616
  ds_read_b64_tr_b16 a[42:43], v16 offset:18176
  s_add_u32 m0, m0, 1024
  s_nop 0
  buffer_load_dwordx4 v22, s[16:19], s37 offen lds
  s_add_u32 s37, s37, 81920
  s_add_u32 s29, s29, 24576
  s_cmp_eq_u32 s29, 98304
  s_cselect_b32 s29, 0, s29
  s_add_u32 s40, s40, 1
  s_cmp_eq_u32 s40, 3
  s_cselect_b32 s40, 0, s40
  s_cselect_b32 s42, 4294721856, 0
  s_add_u32 s37, s37, s42
  v_mfma_f32_32x32x16_bf16 v[144:159], a[184:187], a[0:3], v[144:159]
  v_mfma_f32_32x32x16_bf16 v[160:175], a[184:187], a[4:7], v[160:175]
  v_mfma_f32_32x32x16_bf16 v[176:191], a[184:187], a[8:11], v[176:191]
  v_mfma_f32_32x32x16_bf16 v[192:207], a[184:187], a[12:15], v[192:207]
  v_mfma_f32_32x32x16_bf16 v[208:223], a[184:187], a[16:19], v[208:223]
  s_waitcnt vmcnt(5) lgkmcnt(0)
  s_barrier
  s_add_u32 s30, s30, 24576
  s_cmp_eq_u32 s30, 98304
  s_cselect_b32 s30, 0, s30
  v_add_u32 v16, s30, v23
  v_mfma_f32_32x32x16_bf16 v[64:79], a[140:143], a[24:27], v[64:79]
  ds_read_b64_tr_b16 a[0:1], v16 offset:0
  ds_read_b64_tr_b16 a[2:3], v16 offset:2560
  v_mfma_f32_32x32x16_bf16 v[80:95], a[140:143], a[28:31], v[80:95]
  ds_read_b64_tr_b16 a[4:5], v16 offset:64
  ds_read_b64_tr_b16 a[6:7], v16 offset:2624
  v_mfma_f32_32x32x16_bf16 v[96:111], a[140:143], a[32:35], v[96:111]
  ds_read_b64_tr_b16 a[8:9], v16 offset:128
  ds_read_b64_tr_b16 a[10:11], v16 offset:2688
  v_mfma_f32_32x32x16_bf16 v[112:127], a[140:143], a[36:39], v[112:127]
  ds_read_b64_tr_b16 a[12:13], v16 offset:192
  ds_read_b64_tr_b16 a[14:15], v16 offset:2752
  v_mfma_f32_32x32x16_bf16 v[128:143], a[140:143], a[40:43], v[128:143]
  ds_read_b64_tr_b16 a[16:17], v16 offset:256
  ds_read_b64_tr_b16 a[18:19], v16 offset:2816
  v_mfma_f32_32x32x16_bf16 v[144:159], a[188:191], a[24:27], v[144:159]
  v_mfma_f32_32x32x16_bf16 v[160:175], a[188:191], a[28:31], v[160:175]
  v_mfma_f32_32x32x16_bf16 v[176:191], a[188:191], a[32:35], v[176:191]
  v_mfma_f32_32x32x16_bf16 v[192:207], a[188:191], a[36:39], v[192:207]
  v_mfma_f32_32x32x16_bf16 v[208:223], a[188:191], a[40:43], v[208:223]
  s_waitcnt lgkmcnt(0)
  v_mfma_f32_32x32x16_bf16 v[64:79], a[144:147], a[0:3], v[64:79]
  ds_read_b64_tr_b16 a[24:25], v16 offset:5120
  ds_read_b64_tr_b16 a[26:27], v16 offset:7680
  s_add_u32 m0, s29, s34
  s_nop 0
  buffer_load_dwordx4 v18, s[16:19], s37 offen lds
  v_mfma_f32_32x32x16_bf16 v[80:95], a[144:147], a[4:7], v[80:95]
  ds_read_b64_tr_b16 a[28:29], v16 offset:5184
  ds_read_b64_tr_b16 a[30:31], v16 offset:7744
  v_mfma_f32_32x32x16_bf16 v[96:111], a[144:147], a[8:11], v[96:111]
  ds_read_b64_tr_b16 a[32:33], v16 offset:5248
  ds_read_b64_tr_b16 a[34:35], v16 offset:7808
  v_mfma_f32_32x32x16_bf16 v[112:127], a[144:147], a[12:15], v[112:127]
  ds_read_b64_tr_b16 a[36:37], v16 offset:5312
  ds_read_b64_tr_b16 a[38:39], v16 offset:7872
  v_mfma_f32_32x32x16_bf16 v[128:143], a[144:147], a[16:19], v[128:143]
  ds_read_b64_tr_b16 a[40:41], v16 offset:5376
  ds_read_b64_tr_b16 a[42:43], v16 offset:7936
  v_mfma_f32_32x32x16_bf16 v[144:159], a[192:195], a[0:3], v[144:159]
  v_mfma_f32_32x32x16_bf16 v[160:175], a[192:195], a[4:7], v[160:175]
  s_add_u32 m0, m0, 1024
  s_nop 0
  buffer_load_dwordx4 v19, s[16:19], s37 offen lds
  v_mfma_f32_32x32x16_bf16 v[176:191], a[192:195], a[8:11], v[176:191]
  v_mfma_f32_32x32x16_bf16 v[192:207], a[192:195], a[12:15], v[192:207]
  v_mfma_f32_32x32x16_bf16 v[208:223], a[192:195], a[16:19], v[208:223]
  s_waitcnt lgkmcnt(0)
  v_mfma_f32_32x32x16_bf16 v[64:79], a[148:151], a[24:27], v[64:79]
  ds_read_b64_tr_b16 a[0:1], v16 offset:10240
  ds_read_b64_tr_b16 a[2:3], v16 offset:12800
  v_mfma_f32_32x32x16_bf16 v[80:95], a[148:151], a[28:31], v[80:95]
  ds_read_b64_tr_b16 a[4:5], v16 offset:10304
  ds_read_b64_tr_b16 a[6:7], v16 offset:12864
  v_mfma_f32_32x32x16_bf16 v[96:111], a[148:151], a[32:35], v[96:111]
  ds_read_b64_tr_b16 a[8:9], v16 offset:10368
  ds_read_b64_tr_b16 a[10:11], v16 offset:12928
  s_add_u32 m0, m0, 1024
  s_nop 0
  buffer_load_dwordx4 v20, s[16:19], s37 offen lds
  v_mfma_f32_32x32x16_bf16 v[112:127], a[148:151], a[36:39], v[112:127]
  ds_read_b64_tr_b16 a[12:13], v16 offset:10432
  ds_read_b64_tr_b16 a[14:15], v16 offset:12992
  v_mfma_f32_32x32x16_bf16 v[128:143], a[148:151], a[40:43], v[128:143]
  ds_read_b64_tr_b16 a[16:17], v16 offset:10496
  ds_read_b64_tr_b16 a[18:19], v16 offset:13056
  v_mfma_f32_32x32x16_bf16 v[144:159], a[196:199], a[24:27], v[144:159]
  v_mfma_f32_32x32x16_bf16 v[160:175], a[196:199], a[28:31], v[160:175]
  v_mfma_f32_32x32x16_bf16 v[176:191], a[196:199], a[32:35], v[176:191]
  v_mfma_f32_32x32x16_bf16 v[192:207], a[196:199], a[36:39], v[192:207]
  s_add_u32 m0, m0, 1024
  s_nop 0
  buffer_load_dwordx4 v21, s[16:19], s37 offen lds
  v_mfma_f32_32x32x16_bf16 v[208:223], a[196:199], a[40:43], v[208:223]
  s_waitcnt lgkmcnt(0)
  v_mfma_f32_32x32x16_bf16 v[64:79], a[152:155], a[0:3], v[64:79]
  ds_read_b64_tr_b16 a[24:25], v16 offset:15360
  ds_read_b64_tr_b16 a[26:27], v16 offset:17920
  v_mfma_f32_32x32x16_bf16 v[80:95], a[152:155], a[4:7], v[80:95]
  ds_read_b64_tr_b16 a[28:29], v16 offset:15424
  ds_read_b64_tr_b16 a[30:31], v16 offset:17984
  v_mfma_f32_32x32x16_bf16 v[96:111], a[152:155], a[8:11], v[96:111]
  ds_read_b64_tr_b16 a[32:33], v16 offset:15488
  ds_read_b64_tr_b16 a[34:35], v16 offset:18048
  v_mfma_f32_32x32x16_bf16 v[112:127], a[152:155], a[12:15], v[112:127]
  ds_read_b64_tr_b16 a[36:37], v16 offset:15552
  ds_read_b64_tr_b16 a[38:39], v16 offset:18112
  v_mfma_f32_32x32x16_bf16 v[128:143], a[152:155], a[16:19], v[128:143]
  ds_read_b64_tr_b16 a[40:41], v16 offset:15616
  ds_read_b64_tr_b16 a[42:43], v16 offset:18176
  s_add_u32 m0, m0, 1024
  s_nop 0
  buffer_load_dwordx4 v22, s[16:19], s37 offen lds
  s_add_u32 s37, s37, 81920
  s_add_u32 s29, s29, 24576
  s_cmp_eq_u32 s29, 98304
  s_cselect_b32 s29, 0, s29
  s_add_u32 s40, s40, 1
  s_cmp_eq_u32 s40, 3
  s_cselect_b32 s40, 0, s40
  s_cselect_b32 s42, 4294721856, 0
  s_add_u32 s37, s37, s42
  v_mfma_f32_32x32x16_bf16 v[144:159], a[200:203], a[0:3], v[144:159]
  v_mfma_f32_32x32x16_bf16 v[160:175], a[200:203], a[4:7], v[160:175]
  v_mfma_f32_32x32x16_bf16 v[176:191], a[200:203], a[8:11], v[176:191]
  v_mfma_f32_32x32x16_bf16 v[192:207], a[200:203], a[12:15], v[192:207]
  v_mfma_f32_32x32x16_bf16 v[208:223], a[200:203], a[16:19], v[208:223]
  s_waitcnt vmcnt(5) lgkmcnt(0)
  s_barrier
  s_add_u32 s30, s30, 24576
  s_cmp_eq_u32 s30, 98304
  s_cselect_b32 s30, 0, s30
  v_add_u32 v16, s30, v23
  v_mfma_f32_32x32x16_bf16 v[64:79], a[156:159], a[24:27], v[64:79]
  ds_read_b64_tr_b16 a[0:1], v16 offset:0
  ds_read_b64_tr_b16 a[2:3], v16 offset:2560
  v_mfma_f32_32x32x16_bf16 v[80:95], a[156:159], a[28:31], v[80:95]
  ds_read_b64_tr_b16 a[4:5], v16 offset:64
  ds_read_b64_tr_b16 a[6:7], v16 offset:2624
  v_mfma_f32_32x32x16_bf16 v[96:111], a[156:159], a[32:35], v[96:111]
  ds_read_b64_tr_b16 a[8:9], v16 offset:128
  ds_read_b64_tr_b16 a[10:11], v16 offset:2688
  v_mfma_f32_32x32x16_bf16 v[112:127], a[156:159], a[36:39], v[112:127]
  ds_read_b64_tr_b16 a[12:13], v16 offset:192
  ds_read_b64_tr_b16 a[14:15], v16 offset:2752
  v_mfma_f32_32x32x16_bf16 v[128:143], a[156:159], a[40:43], v[128:143]
  ds_read_b64_tr_b16 a[16:17], v16 offset:256
  ds_read_b64_tr_b16 a[18:19], v16 offset:2816
  v_mfma_f32_32x32x16_bf16 v[144:159], a[204:207], a[24:27], v[144:159]
  v_mfma_f32_32x32x16_bf16 v[160:175], a[204:207], a[28:31], v[160:175]
  v_mfma_f32_32x32x16_bf16 v[176:191], a[204:207], a[32:35], v[176:191]
  v_mfma_f32_32x32x16_bf16 v[192:207], a[204:207], a[36:39], v[192:207]
  v_mfma_f32_32x32x16_bf16 v[208:223], a[204:207], a[40:43], v[208:223]
  s_waitcnt lgkmcnt(0)
  v_mfma_f32_32x32x16_bf16 v[64:79], a[160:163], a[0:3], v[64:79]
  ds_read_b64_tr_b16 a[24:25], v16 offset:5120
  ds_read_b64_tr_b16 a[26:27], v16 offset:7680
  s_add_u32 m0, s29, s34
  s_nop 0
  buffer_load_dwordx4 v18, s[16:19], s37 offen lds
  v_mfma_f32_32x32x16_bf16 v[80:95], a[160:163], a[4:7], v[80:95]
  ds_read_b64_tr_b16 a[28:29], v16 offset:5184
  ds_read_b64_tr_b16 a[30:31], v16 offset:7744
  v_mfma_f32_32x32x16_bf16 v[96:111], a[160:163], a[8:11], v[96:111]
  ds_read_b64_tr_b16 a[32:33], v16 offset:5248
  ds_read_b64_tr_b16 a[34:35], v16 offset:7808
  v_mfma_f32_32x32x16_bf16 v[112:127], a[160:163], a[12:15], v[112:127]
  ds_read_b64_tr_b16 a[36:37], v16 offset:5312
  ds_read_b64_tr_b16 a[38:39], v16 offset:7872
  v_mfma_f32_32x32x16_bf16 v[128:143], a[160:163], a[16:19], v[128:143]
  ds_read_b64_tr_b16 a[40:41], v16 offset:5376
  ds_read_b64_tr_b16 a[42:43], v16 offset:7936
  v_mfma_f32_32x32x16_bf16 v[144:159], a[208:211], a[0:3], v[144:159]
  v_mfma_f32_32x32x16_bf16 v[160:175], a[208:211], a[4:7], v[160:175]
  s_add_u32 m0, m0, 1024
  s_nop 0
  buffer_load_dwordx4 v19, s[16:19], s37 offen lds
  v_mfma_f32_32x32x16_bf16 v[176:191], a[208:211], a[8:11], v[176:191]
  v_mfma_f32_32x32x16_bf16 v[192:207], a[208:211], a[12:15], v[192:207]
  v_mfma_f32_32x32x16_bf16 v[208:223], a[208:211], a[16:19], v[208:223]
  s_waitcnt lgkmcnt(0)
  v_mfma_f32_32x32x16_bf16 v[64:79], a[164:167], a[24:27], v[64:79]
  ds_read_b64_tr_b16 a[0:1], v16 offset:10240
  ds_read_b64_tr_b16 a[2:3], v16 offset:12800
  v_mfma_f32_32x32x16_bf16 v[80:95], a[164:167], a[28:31], v[80:95]
  ds_read_b64_tr_b16 a[4:5], v16 offset:10304
  ds_read_b64_tr_b16 a[6:7], v16 offset:12864
  v_mfma_f32_32x32x16_bf16 v[96:111], a[164:167], a[32:35], v[96:111]
  ds_read_b64_tr_b16 a[8:9], v16 offset:10368
  ds_read_b64_tr_b16 a[10:11], v16 offset:12928
  s_add_u32 m0, m0, 1024
  s_nop 0
  buffer_load_dwordx4 v20, s[16:19], s37 offen lds
  v_mfma_f32_32x32x16_bf16 v[112:127], a[164:167], a[36:39], v[112:127]
  ds_read_b64_tr_b16 a[12:13], v16 offset:10432
  ds_read_b64_tr_b16 a[14:15], v16 offset:12992
  v_mfma_f32_32x32x16_bf16 v[128:143], a[164:167], a[40:43], v[128:143]
  ds_read_b64_tr_b16 a[16:17], v16 offset:10496
  ds_read_b64_tr_b16 a[18:19], v16 offset:13056
  v_mfma_f32_32x32x16_bf16 v[144:159], a[212:215], a[24:27], v[144:159]
  v_mfma_f32_32x32x16_bf16 v[160:175], a[212:215], a[28:31], v[160:175]
  v_mfma_f32_32x32x16_bf16 v[176:191], a[212:215], a[32:35], v[176:191]
  v_mfma_f32_32x32x16_bf16 v[192:207], a[212:215], a[36:39], v[192:207]
  s_add_u32 m0, m0, 1024
  s_nop 0
  buffer_load_dwordx4 v21, s[16:19], s37 offen lds
  v_mfma_f32_32x32x16_bf16 v[208:223], a[212:215], a[40:43], v[208:223]
  s_waitcnt lgkmcnt(0)
  v_mfma_f32_32x32x16_bf16 v[64:79], a[168:171], a[0:3], v[64:79]
  ds_read_b64_tr_b16 a[24:25], v16 offset:15360
  ds_read_b64_tr_b16 a[26:27], v16 offset:17920
  v_mfma_f32_32x32x16_bf16 v[80:95], a[168:171], a[4:7], v[80:95]
  ds_read_b64_tr_b16 a[28:29], v16 offset:15424
  ds_read_b64_tr_b16 a[30:31], v16 offset:17984
  v_mfma_f32_32x32x16_bf16 v[96:111], a[168:171], a[8:11], v[96:111]
  ds_read_b64_tr_b16 a[32:33], v16 offset:15488
  ds_read_b64_tr_b16 a[34:35], v16 offset:18048
  v_mfma_f32_32x32x16_bf16 v[112:127], a[168:171], a[12:15], v[112:127]
  ds_read_b64_tr_b16 a[36:37], v16 offset:15552
  ds_read_b64_tr_b16 a[38:39], v16 offset:18112
  v_mfma_f32_32x32x16_bf16 v[128:143], a[168:171], a[16:19], v[128:143]
  ds_read_b64_tr_b16 a[40:41], v16 offset:15616
  ds_read_b64_tr_b16 a[42:43], v16 offset:18176
  s_add_u32 m0, m0, 1024
  s_nop 0
  buffer_load_dwordx4 v22, s[16:19], s37 offen lds
  s_add_u32 s37, s37, 81920
  s_add_u32 s29, s29, 24576
  s_cmp_eq_u32 s29, 98304
  s_cselect_b32 s29, 0, s29
  s_add_u32 s40, s40, 1
  s_cmp_eq_u32 s40, 3
  s_cselect_b32 s40, 0, s40
  s_cselect_b32 s42, 4294721856, 0
  s_add_u32 s37, s37, s42
  v_mfma_f32_32x32x16_bf16 v[144:159], a[216:219], a[0:3], v[144:159]
  v_mfma_f32_32x32x16_bf16 v[160:175], a[216:219], a[4:7], v[160:175]
  v_mfma_f32_32x32x16_bf16 v[176:191], a[216:219], a[8:11], v[176:191]
  v_mfma_f32_32x32x16_bf16 v[192:207], a[216:219], a[12:15], v[192:207]
  v_mfma_f32_32x32x16_bf16 v[208:223], a[216:219], a[16:19], v[208:223]
  s_waitcnt vmcnt(5) lgkmcnt(0)
  s_barrier
  s_add_u32 s30, s30, 24576
  s_cmp_eq_u32 s30, 98304
  s_cselect_b32 s30, 0, s30
  v_add_u32 v16, s30, v23
  v_mfma_f32_32x32x16_bf16 v[64:79], a[172:175], a[24:27], v[64:79]
  ds_read_b64_tr_b16 a[0:1], v16 offset:0
  ds_read_b64_tr_b16 a[2:3], v16 offset:2560
  v_mfma_f32_32x32x16_bf16 v[80:95], a[172:175], a[28:31], v[80:95]
  ds_read_b64_tr_b16 a[4:5], v16 offset:64
  ds_read_b64_tr_b16 a[6:7], v16 offset:2624
  v_mfma_f32_32x32x16_bf16 v[96:111], a[172:175], a[32:35], v[96:111]
  ds_read_b64_tr_b16 a[8:9], v16 offset:128
  ds_read_b64_tr_b16 a[10:11], v16 offset:2688
  v_mfma_f32_32x32x16_bf16 v[112:127], a[172:175], a[36:39], v[112:127]
  ds_read_b64_tr_b16 a[12:13], v16 offset:192
  ds_read_b64_tr_b16 a[14:15], v16 offset:2752
  v_mfma_f32_32x32x16_bf16 v[128:143], a[172:175], a[40:43], v[128:143]
  ds_read_b64_tr_b16 a[16:17], v16 offset:256
  ds_read_b64_tr_b16 a[18:19], v16 offset:2816
  v_mfma_f32_32x32x16_bf16 v[144:159], a[220:223], a[24:27], v[144:159]
  v_mfma_f32_32x32x16_bf16 v[160:175], a[220:223], a[28:31], v[160:175]
  v_mfma_f32_32x32x16_bf16 v[176:191], a[220:223], a[32:35], v[176:191]
  v_mfma_f32_32x32x16_bf16 v[192:207], a[220:223], a[36:39], v[192:207]
  v_mfma_f32_32x32x16_bf16 v[208:223], a[220:223], a[40:43], v[208:223]
  s_cmp_eq_u32 s38, 2
  s_cbranch_scc1 W_pass_36_fin
W_pass_36:
  s_waitcnt lgkmcnt(0)
  v_cvt_pk_bf16_f32 v40, v64, v65
  v_cvt_pk_bf16_f32 v41, v66, v67
  v_cvt_pk_bf16_f32 v42, v68, v69
  v_cvt_pk_bf16_f32 v43, v70, v71
  v_cvt_pk_bf16_f32 v44, v72, v73
  v_cvt_pk_bf16_f32 v45, v74, v75
  v_cvt_pk_bf16_f32 v46, v76, v77
  v_cvt_pk_bf16_f32 v47, v78, v79
  s_add_u32 s25, s31, 0
  buffer_store_dwordx4 v[40:43], v36, s[8:11], s25 offen offset:0 sc1
  buffer_store_dwordx4 v[44:47], v36, s[8:11], s25 offen offset:1024 sc1
  v_mfma_f32_32x32x16_bf16 v[64:79], a[128:131], a[0:3], 0
  ds_read_b64_tr_b16 a[24:25], v16 offset:5120
  ds_read_b64_tr_b16 a[26:27], v16 offset:7680
  v_cvt_pk_bf16_f32 v40, v80, v81
  v_cvt_pk_bf16_f32 v41, v82, v83
  v_cvt_pk_bf16_f32 v42, v84, v85
  v_cvt_pk_bf16_f32 v43, v86, v87
  v_cvt_pk_bf16_f32 v44, v88, v89
  v_cvt_pk_bf16_f32 v45, v90, v91
  v_cvt_pk_bf16_f32 v46, v92, v93
  v_cvt_pk_bf16_f32 v47, v94, v95
  s_add_u32 s25, s31, 0
  buffer_store_dwordx4 v[40:43], v36, s[8:11], s25 offen offset:2048 sc1
  buffer_store_dwordx4 v[44:47], v36, s[8:11], s25 offen offset:3072 sc1
  v_mfma_f32_32x32x16_bf16 v[80:95], a[128:131], a[4:7], 0
  ds_read_b64_tr_b16 a[28:29], v16 offset:5184
  ds_read_b64_tr_b16 a[30:31], v16 offset:7744
  v_cvt_pk_bf16_f32 v40, v96, v97
  v_cvt_pk_bf16_f32 v41, v98, v99
  v_cvt_pk_bf16_f32 v42, v100, v101
  v_cvt_pk_bf16_f32 v43, v102, v103
  v_cvt_pk_bf16_f32 v44, v104, v105
  v_cvt_pk_bf16_f32 v45, v106, v107
  v_cvt_pk_bf16_f32 v46, v108, v109
  v_cvt_pk_bf16_f32 v47, v110, v111
  s_add_u32 s25, s31, 4096
  buffer_store_dwordx4 v[40:43], v36, s[8:11], s25 offen offset:0 sc1
  buffer_store_dwordx4 v[44:47], v36, s[8:11], s25 offen offset:1024 sc1
  v_mfma_f32_32x32x16_bf16 v[96:111], a[128:131], a[8:11], 0
  ds_read_b64_tr_b16 a[32:33], v16 offset:5248
  ds_read_b64_tr_b16 a[34:35], v16 offset:7808
  v_cvt_pk_bf16_f32 v40, v112, v113
  v_cvt_pk_bf16_f32 v41, v114, v115
  v_cvt_pk_bf16_f32 v42, v116, v117
  v_cvt_pk_bf16_f32 v43, v118, v119
  v_cvt_pk_bf16_f32 v44, v120, v121
  v_cvt_pk_bf16_f32 v45, v122, v123
  v_cvt_pk_bf16_f32 v46, v124, v125
  v_cvt_pk_bf16_f32 v47, v126, v127
  v_mfma_f32_32x32x16_bf16 v[112:127], a[128:131], a[12:15], 0
  ds_read_b64_tr_b16 a[36:37], v16 offset:5312
  ds_read_b64_tr_b16 a[38:39], v16 offset:7872
  v_cvt_pk_bf16_f32 v48, v128, v129
  v_cvt_pk_bf16_f32 v49, v130, v131
  v_cvt_pk_bf16_f32 v50, v132, v133
  v_cvt_pk_bf16_f32 v51, v134, v135
  v_cvt_pk_bf16_f32 v52, v136, v137
  v_cvt_pk_bf16_f32 v53, v138, v139
  v_cvt_pk_bf16_f32 v54, v140, v141
  v_cvt_pk_bf16_f32 v55, v142, v143
  v_mfma_f32_32x32x16_bf16 v[128:143], a[128:131], a[16:19], 0
  ds_read_b64_tr_b16 a[40:41], v16 offset:5376
  ds_read_b64_tr_b16 a[42:43], v16 offset:7936
  v_cvt_pk_bf16_f32 v56, v144, v145
  v_cvt_pk_bf16_f32 v57, v146, v147
  v_cvt_pk_bf16_f32 v58, v148, v149
  v_cvt_pk_bf16_f32 v59, v150, v151
  v_cvt_pk_bf16_f32 v60, v152, v153
  v_cvt_pk_bf16_f32 v61, v154, v155
  v_cvt_pk_bf16_f32 v62, v156, v157
  v_cvt_pk_bf16_f32 v63, v158, v159
  v_mfma_f32_32x32x16_bf16 v[144:159], a[176:179], a[0:3], 0
  v_cvt_pk_bf16_f32 v224, v160, v161
  v_cvt_pk_bf16_f32 v225, v162, v163
  v_cvt_pk_bf16_f32 v226, v164, v165
  v_cvt_pk_bf16_f32 v227, v166, v167
  v_cvt_pk_bf16_f32 v228, v168, v169
  v_cvt_pk_bf16_f32 v229, v170, v171
  v_cvt_pk_bf16_f32 v230, v172, v173
  v_cvt_pk_bf16_f32 v231, v174, v175
  v_mfma_f32_32x32x16_bf16 v[160:175], a[176:179], a[4:7], 0
  v_cvt_pk_bf16_f32 v232, v176, v177
  v_cvt_pk_bf16_f32 v233, v178, v179
  v_cvt_pk_bf16_f32 v234, v180, v181
  v_cvt_pk_bf16_f32 v235, v182, v183
  v_cvt_pk_bf16_f32 v236, v184, v185
  v_cvt_pk_bf16_f32 v237, v186, v187
  v_cvt_pk_bf16_f32 v238, v188, v189
  v_cvt_pk_bf16_f32 v239, v190, v191
  v_mfma_f32_32x32x16_bf16 v[176:191], a[176:179], a[8:11], 0
  v_cvt_pk_bf16_f32 v240, v192, v193
  v_cvt_pk_bf16_f32 v241, v194, v195
  v_cvt_pk_bf16_f32 v242, v196, v197
  v_cvt_pk_bf16_f32 v243, v198, v199
  v_cvt_pk_bf16_f32 v244, v200, v201
  v_cvt_pk_bf16_f32 v245, v202, v203
  v_cvt_pk_bf16_f32 v246, v204, v205
  v_cvt_pk_bf16_f32 v247, v206, v207
  v_mfma_f32_32x32x16_bf16 v[192:207], a[176:179], a[12:15], 0
  v_cvt_pk_bf16_f32 v248, v208, v209
  v_cvt_pk_bf16_f32 v249, v210, v211
  v_cvt_pk_bf16_f32 v250, v212, v213
  v_cvt_pk_bf16_f32 v251, v214, v215
  v_cvt_pk_bf16_f32 v252, v216, v217
  v_cvt_pk_bf16_f32 v253, v218, v219
  v_cvt_pk_bf16_f32 v254, v220, v221
  v_cvt_pk_bf16_f32 v255, v222, v223
  v_mfma_f32_32x32x16_bf16 v[208:223], a[176:179], a[16:19], 0
  s_waitcnt lgkmcnt(0)
  v_mfma_f32_32x32x16_bf16 v[64:79], a[132:135], a[24:27], v[64:79]
  ds_read_b64_tr_b16 a[0:1], v16 offset:10240
  ds_read_b64_tr_b16 a[2:3], v16 offset:12800
  s_add_u32 m0, s29, s34
  s_nop 0
  buffer_load_dwordx4 v18, s[16:19], s37 offen lds
  v_mfma_f32_32x32x16_bf16 v[80:95], a[132:135], a[28:31], v[80:95]
  ds_read_b64_tr_b16 a[4:5], v16 offset:10304
  ds_read_b64_tr_b16 a[6:7], v16 offset:12864
  v_mfma_f32_32x32x16_bf16 v[96:111], a[132:135], a[32:35], v[96:111]
  ds_read_b64_tr_b16 a[8:9], v16 offset:10368
  ds_read_b64_tr_b16 a[10:11], v16 offset:12928
  s_add_u32 s25, s31, 4096
  buffer_store_dwordx4 v[40:43], v36, s[8:11], s25 offen offset:2048 sc1
  v_mfma_f32_32x32x16_bf16 v[112:127], a[132:135], a[36:39], v[112:127]
  ds_read_b64_tr_b16 a[12:13], v16 offset:10432
  ds_read_b64_tr_b16 a[14:15], v16 offset:12992
  v_mfma_f32_32x32x16_bf16 v[128:143], a[132:135], a[40:43], v[128:143]
  ds_read_b64_tr_b16 a[16:17], v16 offset:10496
  ds_read_b64_tr_b16 a[18:19], v16 offset:13056
  s_add_u32 m0, m0, 1024
  s_nop 0
  buffer_load_dwordx4 v19, s[16:19], s37 offen lds
  v_mfma_f32_32x32x16_bf16 v[144:159], a[180:183], a[24:27], v[144:159]
  v_mfma_f32_32x32x16_bf16 v[160:175], a[180:183], a[28:31], v[160:175]
  buffer_store_dwordx4 v[44:47], v36, s[8:11], s25 offen offset:3072 sc1
  v_mfma_f32_32x32x16_bf16 v[176:191], a[180:183], a[32:35], v[176:191]
  v_mfma_f32_32x32x16_bf16 v[192:207], a[180:183], a[36:39], v[192:207]
  s_add_u32 m0, m0, 1024
  s_nop 0
  buffer_load_dwordx4 v20, s[16:19], s37 offen lds
  v_mfma_f32_32x32x16_bf16 v[208:223], a[180:183], a[40:43], v[208:223]
  s_waitcnt lgkmcnt(0)
  v_mfma_f32_32x32x16_bf16 v[64:79], a[136:139], a[0:3], v[64:79]
  ds_read_b64_tr_b16 a[24:25], v16 offset:15360
  ds_read_b64_tr_b16 a[26:27], v16 offset:17920
  s_add_u32 s25, s31, 8192
  buffer_store_dwordx4 v[48:51], v36, s[8:11], s25 offen offset:0 sc1
  v_mfma_f32_32x32x16_bf16 v[80:95], a[136:139], a[4:7], v[80:95]
  ds_read_b64_tr_b16 a[28:29], v16 offset:15424
  ds_read_b64_tr_b16 a[30:31], v16 offset:17984
  v_mfma_f32_32x32x16_bf16 v[96:111], a[136:139], a[8:11], v[96:111]
  ds_read_b64_tr_b16 a[32:33], v16 offset:15488
  ds_read_b64_tr_b16 a[34:35], v16 offset:18048
  s_add_u32 m0, m0, 1024
  s_nop 0
  buffer_load_dwordx4 v21, s[16:19], s37 offen lds
  v_mfma_f32_32x32x16_bf16 v[112:127], a[136:139], a[12:15], v[112:127]
  ds_read_b64_tr_b16 a[36:37], v16 offset:15552
  ds_read_b64_tr_b16 a[38:39], v16 offset:18112
  v_mfma_f32_32x32x16_bf16 v[128:143], a[136:139], a[16:19], v[128:143]
  ds_read_b64_tr_b16 a[40:41], v16 offset:15616
  ds_read_b64_tr_b16 a[42:43], v16 offset:18176
  buffer_store_dwordx4 v[52:55], v36, s[8:11], s25 offen offset:1024 sc1
  v_mfma_f32_32x32x16_bf16 v[144:159], a[184:187], a[0:3], v[144:159]
  v_mfma_f32_32x32x16_bf16 v[160:175], a[184:187], a[4:7], v[160:175]
  s_add_u32 m0, m0, 1024
  s_nop 0
  buffer_load_dwordx4 v22, s[16:19], s37 offen lds
  s_add_u32 s37, s37, 81920
  s_add_u32 s29, s29, 24576
  s_cmp_eq_u32 s29, 98304
  s_cselect_b32 s29, 0, s29
  s_add_u32 s40, s40, 1
  s_cmp_eq_u32 s40, 3
  s_cselect_b32 s40, 0, s40
  s_cselect_b32 s42, 4294721856, 0
  s_add_u32 s37, s37, s42
  v_mfma_f32_32x32x16_bf16 v[176:191], a[184:187], a[8:11], v[176:191]
  v_mfma_f32_32x32x16_bf16 v[192:207], a[184:187], a[12:15], v[192:207]
  s_add_u32 s25, s31, 1310720
  buffer_store_dwordx4 v[56:59], v36, s[8:11], s25 offen offset:0 sc1
  v_mfma_f32_32x32x16_bf16 v[208:223], a[184:187], a[16:19], v[208:223]
  s_waitcnt vmcnt(10) lgkmcnt(0)
  s_barrier
  s_add_u32 s30, s30, 24576
  s_cmp_eq_u32 s30, 98304
  s_cselect_b32 s30, 0, s30
  v_add_u32 v16, s30, v23
  v_mfma_f32_32x32x16_bf16 v[64:79], a[140:143], a[24:27], v[64:79]
  ds_read_b64_tr_b16 a[0:1], v16 offset:0
  ds_read_b64_tr_b16 a[2:3], v16 offset:2560
  v_mfma_f32_32x32x16_bf16 v[80:95], a[140:143], a[28:31], v[80:95]
  ds_read_b64_tr_b16 a[4:5], v16 offset:64
  ds_read_b64_tr_b16 a[6:7], v16 offset:2624
  v_mfma_f32_32x32x16_bf16 v[96:111], a[140:143], a[32:35], v[96:111]
  ds_read_b64_tr_b16 a[8:9], v16 offset:128
  ds_read_b64_tr_b16 a[10:11], v16 offset:2688
  v_mfma_f32_32x32x16_bf16 v[112:127], a[140:143], a[36:39], v[112:127]
  ds_read_b64_tr_b16 a[12:13], v16 offset:192
  ds_read_b64_tr_b16 a[14:15], v16 offset:2752
  v_mfma_f32_32x32x16_bf16 v[128:143], a[140:143], a[40:43], v[128:143]
  ds_read_b64_tr_b16 a[16:17], v16 offset:256
  ds_read_b64_tr_b16 a[18:19], v16 offset:2816
  v_mfma_f32_32x32x16_bf16 v[144:159], a[188:191], a[24:27], v[144:159]
  v_mfma_f32_32x32x16_bf16 v[160:175], a[188:191], a[28:31], v[160:175]
  v_mfma_f32_32x32x16_bf16 v[176:191], a[188:191], a[32:35], v[176:191]
  v_mfma_f32_32x32x16_bf16 v[192:207], a[188:191], a[36:39], v[192:207]
  v_mfma_f32_32x32x16_bf16 v[208:223], a[188:191], a[40:43], v[208:223]
  s_waitcnt lgkmcnt(0)
  v_mfma_f32_32x32x16_bf16 v[64:79], a[144:147], a[0:3], v[64:79]
  ds_read_b64_tr_b16 a[24:25], v16 offset:5120
  ds_read_b64_tr_b16 a[26:27], v16 offset:7680
  s_add_u32 m0, s29, s34
  s_nop 0
  buffer_load_dwordx4 v18, s[16:19], s37 offen lds
  v_mfma_f32_32x32x16_bf16 v[80:95], a[144:147], a[4:7], v[80:95]
  ds_read_b64_tr_b16 a[28:29], v16 offset:5184
  ds_read_b64_tr_b16 a[30:31], v16 offset:7744
  v_mfma_f32_32x32x16_bf16 v[96:111], a[144:147], a[8:11], v[96:111]
  ds_read_b64_tr_b16 a[32:33], v16 offset:5248
  ds_read_b64_tr_b16 a[34:35], v16 offset:7808
  v_mfma_f32_32x32x16_bf16 v[112:127], a[144:147], a[12:15], v[112:127]
  ds_read_b64_tr_b16 a[36:37], v16 offset:5312
  ds_read_b64_tr_b16 a[38:39], v16 offset:7872
  buffer_store_dwordx4 v[60:63], v36, s[8:11], s25 offen offset:1024 sc1
  v_mfma_f32_32x32x16_bf16 v[128:143], a[144:147], a[16:19], v[128:143]
  ds_read_b64_tr_b16 a[40:41], v16 offset:5376
  ds_read_b64_tr_b16 a[42:43], v16 offset:7936
  v_mfma_f32_32x32x16_bf16 v[144:159], a[192:195], a[0:3], v[144:159]
  v_mfma_f32_32x32x16_bf16 v[160:175], a[192:195], a[4:7], v[160:175]
  s_add_u32 m0, m0, 1024
  s_nop 0
  buffer_load_dwordx4 v19, s[16:19], s37 offen lds
  v_mfma_f32_32x32x16_bf16 v[176:191], a[192:195], a[8:11], v[176:191]
  v_mfma_f32_32x32x16_bf16 v[192:207], a[192:195], a[12:15], v[192:207]
  v_mfma_f32_32x32x16_bf16 v[208:223], a[192:195], a[16:19], v[208:223]
  s_add_u32 s25, s31, 1310720
  buffer_store_dwordx4 v[224:227], v36, s[8:11], s25 offen offset:2048 sc1
  s_waitcnt lgkmcnt(0)
  v_mfma_f32_32x32x16_bf16 v[64:79], a[148:151], a[24:27], v[64:79]
  ds_read_b64_tr_b16 a[0:1], v16 offset:10240
  ds_read_b64_tr_b16 a[2:3], v16 offset:12800
  v_mfma_f32_32x32x16_bf16 v[80:95], a[148:151], a[28:31], v[80:95]
  ds_read_b64_tr_b16 a[4:5], v16 offset:10304
  ds_read_b64_tr_b16 a[6:7], v16 offset:12864
  v_mfma_f32_32x32x16_bf16 v[96:111], a[148:151], a[32:35], v[96:111]
  ds_read_b64_tr_b16 a[8:9], v16 offset:10368
  ds_read_b64_tr_b16 a[10:11], v16 offset:12928
  s_add_u32 m0, m0, 1024
  s_nop 0
  buffer_load_dwordx4 v20, s[16:19], s37 offen lds
  v_mfma_f32_32x32x16_bf16 v[112:127], a[148:151], a[36:39], v[112:127]
  ds_read_b64_tr_b16 a[12:13], v16 offset:10432
  ds_read_b64_tr_b16 a[14:15], v16 offset:12992
  v_mfma_f32_32x32x16_bf16 v[128:143], a[148:151], a[40:43], v[128:143]
  ds_read_b64_tr_b16 a[16:17], v16 offset:10496
  ds_read_b64_tr_b16 a[18:19], v16 offset:13056
  v_mfma_f32_32x32x16_bf16 v[144:159], a[196:199], a[24:27], v[144:159]
  buffer_store_dwordx4 v[228:231], v36, s[8:11], s25 offen offset:3072 sc1
  v_mfma_f32_32x32x16_bf16 v[160:175], a[196:199], a[28:31], v[160:175]
  v_mfma_f32_32x32x16_bf16 v[176:191], a[196:199], a[32:35], v[176:191]
  v_mfma_f32_32x32x16_bf16 v[192:207], a[196:199], a[36:39], v[192:207]
  s_add_u32 m0, m0, 1024
  s_nop 0
  buffer_load_dwordx4 v21, s[16:19], s37 offen lds
  v_mfma_f32_32x32x16_bf16 v[208:223], a[196:199], a[40:43], v[208:223]
  s_waitcnt lgkmcnt(0)
  v_mfma_f32_32x32x16_bf16 v[64:79], a[152:155], a[0:3], v[64:79]
  ds_read_b64_tr_b16 a[24:25], v16 offset:15360
  ds_read_b64_tr_b16 a[26:27], v16 offset:17920
  v_mfma_f32_32x32x16_bf16 v[80:95], a[152:155], a[4:7], v[80:95]
  ds_read_b64_tr_b16 a[28:29], v16 offset:15424
  ds_read_b64_tr_b16 a[30:31], v16 offset:17984
  s_add_u32 s25, s31, 1314816
  buffer_store_dwordx4 v[232:235], v36, s[8:11], s25 offen offset:0 sc1
  v_mfma_f32_32x32x16_bf16 v[96:111], a[152:155], a[8:11], v[96:111]
  ds_read_b64_tr_b16 a[32:33], v16 offset:15488
  ds_read_b64_tr_b16 a[34:35], v16 offset:18048
  v_mfma_f32_32x32x16_bf16 v[112:127], a[152:155], a[12:15], v[112:127]
  ds_read_b64_tr_b16 a[36:37], v16 offset:15552
  ds_read_b64_tr_b16 a[38:39], v16 offset:18112
  v_mfma_f32_32x32x16_bf16 v[128:143], a[152:155], a[16:19], v[128:143]
  ds_read_b64_tr_b16 a[40:41], v16 offset:15616
  ds_read_b64_tr_b16 a[42:43], v16 offset:18176
  s_add_u32 m0, m0, 1024
  s_nop 0
  buffer_load_dwordx4 v22, s[16:19], s37 offen lds
  s_add_u32 s37, s37, 81920
  s_add_u32 s29, s29, 24576
  s_cmp_eq_u32 s29, 98304
  s_cselect_b32 s29, 0, s29
  s_add_u32 s40, s40, 1
  s_cmp_eq_u32 s40, 3
  s_cselect_b32 s40, 0, s40
  s_cselect_b32 s42, 4294721856, 0
  s_add_u32 s37, s37, s42
  v_mfma_f32_32x32x16_bf16 v[144:159], a[200:203], a[0:3], v[144:159]
  v_mfma_f32_32x32x16_bf16 v[160:175], a[200:203], a[4:7], v[160:175]
  v_mfma_f32_32x32x16_bf16 v[176:191], a[200:203], a[8:11], v[176:191]
  buffer_store_dwordx4 v[236:239], v36, s[8:11], s25 offen offset:1024 sc1
  v_mfma_f32_32x32x16_bf16 v[192:207], a[200:203], a[12:15], v[192:207]
  v_mfma_f32_32x32x16_bf16 v[208:223], a[200:203], a[16:19], v[208:223]
  s_waitcnt vmcnt(10) lgkmcnt(0)
  s_barrier
  s_add_u32 s30, s30, 24576
  s_cmp_eq_u32 s30, 98304
  s_cselect_b32 s30, 0, s30
  v_add_u32 v16, s30, v23
  v_mfma_f32_32x32x16_bf16 v[64:79], a[156:159], a[24:27], v[64:79]
  ds_read_b64_tr_b16 a[0:1], v16 offset:0
  ds_read_b64_tr_b16 a[2:3], v16 offset:2560
  v_mfma_f32_32x32x16_bf16 v[80:95], a[156:159], a[28:31], v[80:95]
  ds_read_b64_tr_b16 a[4:5], v16 offset:64
  ds_read_b64_tr_b16 a[6:7], v16 offset:2624
  v_mfma_f32_32x32x16_bf16 v[96:111], a[156:159], a[32:35], v[96:111]
  ds_read_b64_tr_b16 a[8:9], v16 offset:128
  ds_read_b64_tr_b16 a[10:11], v16 offset:2688
  v_mfma_f32_32x32x16_bf16 v[112:127], a[156:159], a[36:39], v[112:127]
  ds_read_b64_tr_b16 a[12:13], v16 offset:192
  ds_read_b64_tr_b16 a[14:15], v16 offset:2752
  v_mfma_f32_32x32x16_bf16 v[128:143], a[156:159], a[40:43], v[128:143]
  ds_read_b64_tr_b16 a[16:17], v16 offset:256
  ds_read_b64_tr_b16 a[18:19], v16 offset:2816
  v_mfma_f32_32x32x16_bf16 v[144:159], a[204:207], a[24:27], v[144:159]
  v_mfma_f32_32x32x16_bf16 v[160:175], a[204:207], a[28:31], v[160:175]
  v_mfma_f32_32x32x16_bf16 v[176:191], a[204:207], a[32:35], v[176:191]
  v_mfma_f32_32x32x16_bf16 v[192:207], a[204:207], a[36:39], v[192:207]
  v_mfma_f32_32x32x16_bf16 v[208:223], a[204:207], a[40:43], v[208:223]
  s_waitcnt lgkmcnt(0)
  v_mfma_f32_32x32x16_bf16 v[64:79], a[160:163], a[0:3], v[64:79]
  ds_read_b64_tr_b16 a[24:25], v16 offset:5120
  ds_read_b64_tr_b16 a[26:27], v16 offset:7680
  s_add_u32 m0, s29, s34
  s_nop 0
  buffer_load_dwordx4 v18, s[16:19], s37 offen lds
  v_mfma_f32_32x32x16_bf16 v[80:95], a[160:163], a[4:7], v[80:95]
  ds_read_b64_tr_b16 a[28:29], v16 offset:5184
  ds_read_b64_tr_b16 a[30:31], v16 offset:7744
  v_mfma_f32_32x32x16_bf16 v[96:111], a[160:163], a[8:11], v[96:111]
  ds_read_b64_tr_b16 a[32:33], v16 offset:5248
  ds_read_b64_tr_b16 a[34:35], v16 offset:7808
  v_mfma_f32_32x32x16_bf16 v[112:127], a[160:163], a[12:15], v[112:127]
  ds_read_b64_tr_b16 a[36:37], v16 offset:5312
  ds_read_b64_tr_b16 a[38:39], v16 offset:7872
  s_add_u32 s25, s31, 1314816
  buffer_store_dwordx4 v[240:243], v36, s[8:11], s25 offen offset:2048 sc1
  v_mfma_f32_32x32x16_bf16 v[128:143], a[160:163], a[16:19], v[128:143]
  ds_read_b64_tr_b16 a[40:41], v16 offset:5376
  ds_read_b64_tr_b16 a[42:43], v16 offset:7936
  v_mfma_f32_32x32x16_bf16 v[144:159], a[208:211], a[0:3], v[144:159]
  v_mfma_f32_32x32x16_bf16 v[160:175], a[208:211], a[4:7], v[160:175]
  s_add_u32 m0, m0, 1024
  s_nop 0
  buffer_load_dwordx4 v19, s[16:19], s37 offen lds
  v_mfma_f32_32x32x16_bf16 v[176:191], a[208:211], a[8:11], v[176:191]
  v_mfma_f32_32x32x16_bf16 v[192:207], a[208:211], a[12:15], v[192:207]
  v_mfma_f32_32x32x16_bf16 v[208:223], a[208:211], a[16:19], v[208:223]
  s_waitcnt lgkmcnt(0)
  v_mfma_f32_32x32x16_bf16 v[64:79], a[164:167], a[24:27], v[64:79]
  ds_read_b64_tr_b16 a[0:1], v16 offset:10240
  ds_read_b64_tr_b16 a[2:3], v16 offset:12800
  buffer_store_dwordx4 v[244:247], v36, s[8:11], s25 offen offset:3072 sc1
  v_mfma_f32_32x32x16_bf16 v[80:95], a[164:167], a[28:31], v[80:95]
  ds_read_b64_tr_b16 a[4:5], v16 offset:10304
  ds_read_b64_tr_b16 a[6:7], v16 offset:12864
  v_mfma_f32_32x32x16_bf16 v[96:111], a[164:167], a[32:35], v[96:111]
  ds_read_b64_tr_b16 a[8:9], v16 offset:10368
  ds_read_b64_tr_b16 a[10:11], v16 offset:12928
  v_mfma_f32_32x32x16_bf16 v[112:127], a[164:167], a[36:39], v[112:127]
  ds_read_b64_tr_b16 a[12:13], v16 offset:10432
  ds_read_b64_tr_b16 a[14:15], v16 offset:12992
  s_add_u32 m0, m0, 1024
  s_nop 0
  buffer_load_dwordx4 v20, s[16:19], s37 offen lds
  v_mfma_f32_32x32x16_bf16 v[128:143], a[164:167], a[40:43], v[128:143]
  ds_read_b64_tr_b16 a[16:17], v16 offset:10496
  ds_read_b64_tr_b16 a[18:19], v16 offset:13056
  v_mfma_f32_32x32x16_bf16 v[144:159], a[212:215], a[24:27], v[144:159]
  v_mfma_f32_32x32x16_bf16 v[160:175], a[212:215], a[28:31], v[160:175]
  s_add_u32 s25, s31, 1318912
  buffer_store_dwordx4 v[248:251], v36, s[8:11], s25 offen offset:0 sc1
  v_mfma_f32_32x32x16_bf16 v[176:191], a[212:215], a[32:35], v[176:191]
  v_mfma_f32_32x32x16_bf16 v[192:207], a[212:215], a[36:39], v[192:207]
  v_mfma_f32_32x32x16_bf16 v[208:223], a[212:215], a[40:43], v[208:223]
  s_waitcnt lgkmcnt(0)
  v_mfma_f32_32x32x16_bf16 v[64:79], a[168:171], a[0:3], v[64:79]
  ds_read_b64_tr_b16 a[24:25], v16 offset:15360
  ds_read_b64_tr_b16 a[26:27], v16 offset:17920
  s_add_u32 m0, m0, 1024
  s_nop 0
  buffer_load_dwordx4 v21, s[16:19], s37 offen lds
  v_mfma_f32_32x32x16_bf16 v[80:95], a[168:171], a[4:7], v[80:95]
  ds_read_b64_tr_b16 a[28:29], v16 offset:15424
  ds_read_b64_tr_b16 a[30:31], v16 offset:17984
  v_mfma_f32_32x32x16_bf16 v[96:111], a[168:171], a[8:11], v[96:111]
  ds_read_b64_tr_b16 a[32:33], v16 offset:15488
  ds_read_b64_tr_b16 a[34:35], v16 offset:18048
  v_mfma_f32_32x32x16_bf16 v[112:127], a[168:171], a[12:15], v[112:127]
  ds_read_b64_tr_b16 a[36:37], v16 offset:15552
  ds_read_b64_tr_b16 a[38:39], v16 offset:18112
  buffer_store_dwordx4 v[252:255], v36, s[8:11], s25 offen offset:1024 sc1
  v_mfma_f32_32x32x16_bf16 v[128:143], a[168:171], a[16:19], v[128:143]
  ds_read_b64_tr_b16 a[40:41], v16 offset:15616
  ds_read_b64_tr_b16 a[42:43], v16 offset:18176
  v_mfma_f32_32x32x16_bf16 v[144:159], a[216:219], a[0:3], v[144:159]
  v_mfma_f32_32x32x16_bf16 v[160:175], a[216:219], a[4:7], v[160:175]
  s_add_u32 m0, m0, 1024
  s_nop 0
  buffer_load_dwordx4 v22, s[16:19], s37 offen lds
  s_add_u32 s37, s37, 81920
  s_add_u32 s29, s29, 24576
  s_cmp_eq_u32 s29, 98304
  s_cselect_b32 s29, 0, s29
  s_add_u32 s40, s40, 1
  s_cmp_eq_u32 s40, 3
  s_cselect_b32 s40, 0, s40
  s_cselect_b32 s42, 4294721856, 0
  s_add_u32 s37, s37, s42
  v_mfma_f32_32x32x16_bf16 v[176:191], a[216:219], a[8:11], v[176:191]
  v_mfma_f32_32x32x16_bf16 v[192:207], a[216:219], a[12:15], v[192:207]
  v_mfma_f32_32x32x16_bf16 v[208:223], a[216:219], a[16:19], v[208:223]
  s_waitcnt vmcnt(9) lgkmcnt(0)
  s_barrier
  s_add_u32 s30, s30, 24576
  s_cmp_eq_u32 s30, 98304
  s_cselect_b32 s30, 0, s30
  v_add_u32 v16, s30, v23
  v_mfma_f32_32x32x16_bf16 v[64:79], a[172:175], a[24:27], v[64:79]
  ds_read_b64_tr_b16 a[0:1], v16 offset:0
  ds_read_b64_tr_b16 a[2:3], v16 offset:2560
  v_mfma_f32_32x32x16_bf16 v[80:95], a[172:175], a[28:31], v[80:95]
  ds_read_b64_tr_b16 a[4:5], v16 offset:64
  ds_read_b64_tr_b16 a[6:7], v16 offset:2624
  v_mfma_f32_32x32x16_bf16 v[96:111], a[172:175], a[32:35], v[96:111]
  ds_read_b64_tr_b16 a[8:9], v16 offset:128
  ds_read_b64_tr_b16 a[10:11], v16 offset:2688
  v_mfma_f32_32x32x16_bf16 v[112:127], a[172:175], a[36:39], v[112:127]
  ds_read_b64_tr_b16 a[12:13], v16 offset:192
  ds_read_b64_tr_b16 a[14:15], v16 offset:2752
  v_mfma_f32_32x32x16_bf16 v[128:143], a[172:175], a[40:43], v[128:143]
  ds_read_b64_tr_b16 a[16:17], v16 offset:256
  ds_read_b64_tr_b16 a[18:19], v16 offset:2816
  v_mfma_f32_32x32x16_bf16 v[144:159], a[220:223], a[24:27], v[144:159]
  v_mfma_f32_32x32x16_bf16 v[160:175], a[220:223], a[28:31], v[160:175]
  v_mfma_f32_32x32x16_bf16 v[176:191], a[220:223], a[32:35], v[176:191]
  v_mfma_f32_32x32x16_bf16 v[192:207], a[220:223], a[36:39], v[192:207]
  v_mfma_f32_32x32x16_bf16 v[208:223], a[220:223], a[40:43], v[208:223]
  s_add_u32 s31, s31, 10240
  s_sub_u32 s38, s38, 1
  s_cmp_lg_u32 s38, 2
  s_cbranch_scc1 W_pass_36
W_pass_36_fin:
  s_waitcnt lgkmcnt(0)
  v_cvt_pk_bf16_f32 v40, v64, v65
  v_cvt_pk_bf16_f32 v41, v66, v67
  v_cvt_pk_bf16_f32 v42, v68, v69
  v_cvt_pk_bf16_f32 v43, v70, v71
  v_cvt_pk_bf16_f32 v44, v72, v73
  v_cvt_pk_bf16_f32 v45, v74, v75
  v_cvt_pk_bf16_f32 v46, v76, v77
  v_cvt_pk_bf16_f32 v47, v78, v79
  s_add_u32 s25, s31, 0
  buffer_store_dwordx4 v[40:43], v36, s[8:11], s25 offen offset:0 sc1
  buffer_store_dwordx4 v[44:47], v36, s[8:11], s25 offen offset:1024 sc1
  v_mfma_f32_32x32x16_bf16 v[64:79], a[128:131], a[0:3], 0
  ds_read_b64_tr_b16 a[24:25], v16 offset:5120
  ds_read_b64_tr_b16 a[26:27], v16 offset:7680
  v_cvt_pk_bf16_f32 v40, v80, v81
  v_cvt_pk_bf16_f32 v41, v82, v83
  v_cvt_pk_bf16_f32 v42, v84, v85
  v_cvt_pk_bf16_f32 v43, v86, v87
  v_cvt_pk_bf16_f32 v44, v88, v89
  v_cvt_pk_bf16_f32 v45, v90, v91
  v_cvt_pk_bf16_f32 v46, v92, v93
  v_cvt_pk_bf16_f32 v47, v94, v95
  s_add_u32 s25, s31, 0
  buffer_store_dwordx4 v[40:43], v36, s[8:11], s25 offen offset:2048 sc1
  buffer_store_dwordx4 v[44:47], v36, s[8:11], s25 offen offset:3072 sc1
  v_mfma_f32_32x32x16_bf16 v[80:95], a[128:131], a[4:7], 0
  ds_read_b64_tr_b16 a[28:29], v16 offset:5184
  ds_read_b64_tr_b16 a[30:31], v16 offset:7744
  v_cvt_pk_bf16_f32 v40, v96, v97
  v_cvt_pk_bf16_f32 v41, v98, v99
  v_cvt_pk_bf16_f32 v42, v100, v101
  v_cvt_pk_bf16_f32 v43, v102, v103
  v_cvt_pk_bf16_f32 v44, v104, v105
  v_cvt_pk_bf16_f32 v45, v106, v107
  v_cvt_pk_bf16_f32 v46, v108, v109
  v_cvt_pk_bf16_f32 v47, v110, v111
  s_add_u32 s25, s31, 4096
  buffer_store_dwordx4 v[40:43], v36, s[8:11], s25 offen offset:0 sc1
  buffer_store_dwordx4 v[44:47], v36, s[8:11], s25 offen offset:1024 sc1
  v_mfma_f32_32x32x16_bf16 v[96:111], a[128:131], a[8:11], 0
  ds_read_b64_tr_b16 a[32:33], v16 offset:5248
  ds_read_b64_tr_b16 a[34:35], v16 offset:7808
  v_cvt_pk_bf16_f32 v40, v112, v113
  v_cvt_pk_bf16_f32 v41, v114, v115
  v_cvt_pk_bf16_f32 v42, v116, v117
  v_cvt_pk_bf16_f32 v43, v118, v119
  v_cvt_pk_bf16_f32 v44, v120, v121
  v_cvt_pk_bf16_f32 v45, v122, v123
  v_cvt_pk_bf16_f32 v46, v124, v125
  v_cvt_pk_bf16_f32 v47, v126, v127
  v_mfma_f32_32x32x16_bf16 v[112:127], a[128:131], a[12:15], 0
  ds_read_b64_tr_b16 a[36:37], v16 offset:5312
  ds_read_b64_tr_b16 a[38:39], v16 offset:7872
  v_cvt_pk_bf16_f32 v48, v128, v129
  v_cvt_pk_bf16_f32 v49, v130, v131
  v_cvt_pk_bf16_f32 v50, v132, v133
  v_cvt_pk_bf16_f32 v51, v134, v135
  v_cvt_pk_bf16_f32 v52, v136, v137
  v_cvt_pk_bf16_f32 v53, v138, v139
  v_cvt_pk_bf16_f32 v54, v140, v141
  v_cvt_pk_bf16_f32 v55, v142, v143
  v_mfma_f32_32x32x16_bf16 v[128:143], a[128:131], a[16:19], 0
  ds_read_b64_tr_b16 a[40:41], v16 offset:5376
  ds_read_b64_tr_b16 a[42:43], v16 offset:7936
  v_cvt_pk_bf16_f32 v56, v144, v145
  v_cvt_pk_bf16_f32 v57, v146, v147
  v_cvt_pk_bf16_f32 v58, v148, v149
  v_cvt_pk_bf16_f32 v59, v150, v151
  v_cvt_pk_bf16_f32 v60, v152, v153
  v_cvt_pk_bf16_f32 v61, v154, v155
  v_cvt_pk_bf16_f32 v62, v156, v157
  v_cvt_pk_bf16_f32 v63, v158, v159
  v_mfma_f32_32x32x16_bf16 v[144:159], a[176:179], a[0:3], 0
  v_cvt_pk_bf16_f32 v224, v160, v161
  v_cvt_pk_bf16_f32 v225, v162, v163
  v_cvt_pk_bf16_f32 v226, v164, v165
  v_cvt_pk_bf16_f32 v227, v166, v167
  v_cvt_pk_bf16_f32 v228, v168, v169
  v_cvt_pk_bf16_f32 v229, v170, v171
  v_cvt_pk_bf16_f32 v230, v172, v173
  v_cvt_pk_bf16_f32 v231, v174, v175
  v_mfma_f32_32x32x16_bf16 v[160:175], a[176:179], a[4:7], 0
  v_cvt_pk_bf16_f32 v232, v176, v177
  v_cvt_pk_bf16_f32 v233, v178, v179
  v_cvt_pk_bf16_f32 v234, v180, v181
  v_cvt_pk_bf16_f32 v235, v182, v183
  v_cvt_pk_bf16_f32 v236, v184, v185
  v_cvt_pk_bf16_f32 v237, v186, v187
  v_cvt_pk_bf16_f32 v238, v188, v189
  v_cvt_pk_bf16_f32 v239, v190, v191
  v_mfma_f32_32x32x16_bf16 v[176:191], a[176:179], a[8:11], 0
  v_cvt_pk_bf16_f32 v240, v192, v193
  v_cvt_pk_bf16_f32 v241, v194, v195
  v_cvt_pk_bf16_f32 v242, v196, v197
  v_cvt_pk_bf16_f32 v243, v198, v199
  v_cvt_pk_bf16_f32 v244, v200, v201
  v_cvt_pk_bf16_f32 v245, v202, v203
  v_cvt_pk_bf16_f32 v246, v204, v205
  v_cvt_pk_bf16_f32 v247, v206, v207
  v_mfma_f32_32x32x16_bf16 v[192:207], a[176:179], a[12:15], 0
  v_cvt_pk_bf16_f32 v248, v208, v209
  v_cvt_pk_bf16_f32 v249, v210, v211
  v_cvt_pk_bf16_f32 v250, v212, v213
  v_cvt_pk_bf16_f32 v251, v214, v215
  v_cvt_pk_bf16_f32 v252, v216, v217
  v_cvt_pk_bf16_f32 v253, v218, v219
  v_cvt_pk_bf16_f32 v254, v220, v221
  v_cvt_pk_bf16_f32 v255, v222, v223
  v_mfma_f32_32x32x16_bf16 v[208:223], a[176:179], a[16:19], 0
  s_waitcnt lgkmcnt(0)
  v_mfma_f32_32x32x16_bf16 v[64:79], a[132:135], a[24:27], v[64:79]
  ds_read_b64_tr_b16 a[0:1], v16 offset:10240
  ds_read_b64_tr_b16 a[2:3], v16 offset:12800
  s_add_u32 m0, s29, s34
  s_nop 0
  buffer_load_dwordx4 v18, s[16:19], s37 offen lds
  v_mfma_f32_32x32x16_bf16 v[80:95], a[132:135], a[28:31], v[80:95]
  ds_read_b64_tr_b16 a[4:5], v16 offset:10304
  ds_read_b64_tr_b16 a[6:7], v16 offset:12864
  v_mfma_f32_32x32x16_bf16 v[96:111], a[132:135], a[32:35], v[96:111]
  ds_read_b64_tr_b16 a[8:9], v16 offset:10368
  ds_read_b64_tr_b16 a[10:11], v16 offset:12928
  s_add_u32 s25, s31, 4096
  buffer_store_dwordx4 v[40:43], v36, s[8:11], s25 offen offset:2048 sc1
  v_mfma_f32_32x32x16_bf16 v[112:127], a[132:135], a[36:39], v[112:127]
  ds_read_b64_tr_b16 a[12:13], v16 offset:10432
  ds_read_b64_tr_b16 a[14:15], v16 offset:12992
  v_mfma_f32_32x32x16_bf16 v[128:143], a[132:135], a[40:43], v[128:143]
  ds_read_b64_tr_b16 a[16:17], v16 offset:10496
  ds_read_b64_tr_b16 a[18:19], v16 offset:13056
  s_add_u32 m0, m0, 1024
  s_nop 0
  buffer_load_dwordx4 v19, s[16:19], s37 offen lds
  v_mfma_f32_32x32x16_bf16 v[144:159], a[180:183], a[24:27], v[144:159]
  v_mfma_f32_32x32x16_bf16 v[160:175], a[180:183], a[28:31], v[160:175]
  buffer_store_dwordx4 v[44:47], v36, s[8:11], s25 offen offset:3072 sc1
  v_mfma_f32_32x32x16_bf16 v[176:191], a[180:183], a[32:35], v[176:191]
  v_mfma_f32_32x32x16_bf16 v[192:207], a[180:183], a[36:39], v[192:207]
  s_add_u32 m0, m0, 1024
  s_nop 0
  buffer_load_dwordx4 v20, s[16:19], s37 offen lds
  v_mfma_f32_32x32x16_bf16 v[208:223], a[180:183], a[40:43], v[208:223]
  s_waitcnt lgkmcnt(0)
  v_mfma_f32_32x32x16_bf16 v[64:79], a[136:139], a[0:3], v[64:79]
  ds_read_b64_tr_b16 a[24:25], v16 offset:15360
  ds_read_b64_tr_b16 a[26:27], v16 offset:17920
  s_add_u32 s25, s31, 8192
  buffer_store_dwordx4 v[48:51], v36, s[8:11], s25 offen offset:0 sc1
  v_mfma_f32_32x32x16_bf16 v[80:95], a[136:139], a[4:7], v[80:95]
  ds_read_b64_tr_b16 a[28:29], v16 offset:15424
  ds_read_b64_tr_b16 a[30:31], v16 offset:17984
  v_mfma_f32_32x32x16_bf16 v[96:111], a[136:139], a[8:11], v[96:111]
  ds_read_b64_tr_b16 a[32:33], v16 offset:15488
  ds_read_b64_tr_b16 a[34:35], v16 offset:18048
  s_add_u32 m0, m0, 1024
  s_nop 0
  buffer_load_dwordx4 v21, s[16:19], s37 offen lds
  v_mfma_f32_32x32x16_bf16 v[112:127], a[136:139], a[12:15], v[112:127]
  ds_read_b64_tr_b16 a[36:37], v16 offset:15552
  ds_read_b64_tr_b16 a[38:39], v16 offset:18112
  v_mfma_f32_32x32x16_bf16 v[128:143], a[136:139], a[16:19], v[128:143]
  ds_read_b64_tr_b16 a[40:41], v16 offset:15616
  ds_read_b64_tr_b16 a[42:43], v16 offset:18176
  buffer_store_dwordx4 v[52:55], v36, s[8:11], s25 offen offset:1024 sc1
  v_mfma_f32_32x32x16_bf16 v[144:159], a[184:187], a[0:3], v[144:159]
  v_mfma_f32_32x32x16_bf16 v[160:175], a[184:187], a[4:7], v[160:175]
  s_add_u32 m0, m0, 1024
  s_nop 0
  buffer_load_dwordx4 v22, s[16:19], s37 offen lds
  s_add_u32 s37, s37, 81920
  s_add_u32 s29, s29, 24576
  s_cmp_eq_u32 s29, 98304
  s_cselect_b32 s29, 0, s29
  s_add_u32 s40, s40, 1
  s_cmp_eq_u32 s40, 3
  s_cselect_b32 s40, 0, s40
  s_cselect_b32 s42, 4294721856, 0
  s_add_u32 s37, s37, s42
  v_mfma_f32_32x32x16_bf16 v[176:191], a[184:187], a[8:11], v[176:191]
  v_mfma_f32_32x32x16_bf16 v[192:207], a[184:187], a[12:15], v[192:207]
  s_add_u32 s25, s31, 1310720
  buffer_store_dwordx4 v[56:59], v36, s[8:11], s25 offen offset:0 sc1
  v_mfma_f32_32x32x16_bf16 v[208:223], a[184:187], a[16:19], v[208:223]
  s_waitcnt vmcnt(10) lgkmcnt(0)
  s_barrier
  s_add_u32 s30, s30, 24576
  s_cmp_eq_u32 s30, 98304
  s_cselect_b32 s30, 0, s30
  v_add_u32 v16, s30, v23
  v_mfma_f32_32x32x16_bf16 v[64:79], a[140:143], a[24:27], v[64:79]
  ds_read_b64_tr_b16 a[0:1], v16 offset:0
  ds_read_b64_tr_b16 a[2:3], v16 offset:2560
  v_mfma_f32_32x32x16_bf16 v[80:95], a[140:143], a[28:31], v[80:95]
  ds_read_b64_tr_b16 a[4:5], v16 offset:64
  ds_read_b64_tr_b16 a[6:7], v16 offset:2624
  v_mfma_f32_32x32x16_bf16 v[96:111], a[140:143], a[32:35], v[96:111]
  ds_read_b64_tr_b16 a[8:9], v16 offset:128
  ds_read_b64_tr_b16 a[10:11], v16 offset:2688
  v_mfma_f32_32x32x16_bf16 v[112:127], a[140:143], a[36:39], v[112:127]
  ds_read_b64_tr_b16 a[12:13], v16 offset:192
  ds_read_b64_tr_b16 a[14:15], v16 offset:2752
  v_mfma_f32_32x32x16_bf16 v[128:143], a[140:143], a[40:43], v[128:143]
  ds_read_b64_tr_b16 a[16:17], v16 offset:256
  ds_read_b64_tr_b16 a[18:19], v16 offset:2816
  v_mfma_f32_32x32x16_bf16 v[144:159], a[188:191], a[24:27], v[144:159]
  v_mfma_f32_32x32x16_bf16 v[160:175], a[188:191], a[28:31], v[160:175]
  v_mfma_f32_32x32x16_bf16 v[176:191], a[188:191], a[32:35], v[176:191]
  v_mfma_f32_32x32x16_bf16 v[192:207], a[188:191], a[36:39], v[192:207]
  v_mfma_f32_32x32x16_bf16 v[208:223], a[188:191], a[40:43], v[208:223]
  s_waitcnt lgkmcnt(0)
  v_mfma_f32_32x32x16_bf16 v[64:79], a[144:147], a[0:3], v[64:79]
  ds_read_b64_tr_b16 a[24:25], v16 offset:5120
  ds_read_b64_tr_b16 a[26:27], v16 offset:7680
  buffer_store_dwordx4 v[60:63], v36, s[8:11], s25 offen offset:1024 sc1
  v_mfma_f32_32x32x16_bf16 v[80:95], a[144:147], a[4:7], v[80:95]
  ds_read_b64_tr_b16 a[28:29], v16 offset:5184
  ds_read_b64_tr_b16 a[30:31], v16 offset:7744
  v_mfma_f32_32x32x16_bf16 v[96:111], a[144:147], a[8:11], v[96:111]
  ds_read_b64_tr_b16 a[32:33], v16 offset:5248
  ds_read_b64_tr_b16 a[34:35], v16 offset:7808
  v_mfma_f32_32x32x16_bf16 v[112:127], a[144:147], a[12:15], v[112:127]
  ds_read_b64_tr_b16 a[36:37], v16 offset:5312
  ds_read_b64_tr_b16 a[38:39], v16 offset:7872
  v_mfma_f32_32x32x16_bf16 v[128:143], a[144:147], a[16:19], v[128:143]
  ds_read_b64_tr_b16 a[40:41], v16 offset:5376
  ds_read_b64_tr_b16 a[42:43], v16 offset:7936
  v_mfma_f32_32x32x16_bf16 v[144:159], a[192:195], a[0:3], v[144:159]
  v_mfma_f32_32x32x16_bf16 v[160:175], a[192:195], a[4:7], v[160:175]
  s_add_u32 s25, s31, 1310720
  buffer_store_dwordx4 v[224:227], v36, s[8:11], s25 offen offset:2048 sc1
  v_mfma_f32_32x32x16_bf16 v[176:191], a[192:195], a[8:11], v[176:191]
  v_mfma_f32_32x32x16_bf16 v[192:207], a[192:195], a[12:15], v[192:207]
  v_mfma_f32_32x32x16_bf16 v[208:223], a[192:195], a[16:19], v[208:223]
  s_waitcnt lgkmcnt(0)
  v_mfma_f32_32x32x16_bf16 v[64:79], a[148:151], a[24:27], v[64:79]
  ds_read_b64_tr_b16 a[0:1], v16 offset:10240
  ds_read_b64_tr_b16 a[2:3], v16 offset:12800
  v_mfma_f32_32x32x16_bf16 v[80:95], a[148:151], a[28:31], v[80:95]
  ds_read_b64_tr_b16 a[4:5], v16 offset:10304
  ds_read_b64_tr_b16 a[6:7], v16 offset:12864
  v_mfma_f32_32x32x16_bf16 v[96:111], a[148:151], a[32:35], v[96:111]
  ds_read_b64_tr_b16 a[8:9], v16 offset:10368
  ds_read_b64_tr_b16 a[10:11], v16 offset:12928
  buffer_store_dwordx4 v[228:231], v36, s[8:11], s25 offen offset:3072 sc1
  v_mfma_f32_32x32x16_bf16 v[112:127], a[148:151], a[36:39], v[112:127]
  ds_read_b64_tr_b16 a[12:13], v16 offset:10432
  ds_read_b64_tr_b16 a[14:15], v16 offset:12992
  v_mfma_f32_32x32x16_bf16 v[128:143], a[148:151], a[40:43], v[128:143]
  ds_read_b64_tr_b16 a[16:17], v16 offset:10496
  ds_read_b64_tr_b16 a[18:19], v16 offset:13056
  v_mfma_f32_32x32x16_bf16 v[144:159], a[196:199], a[24:27], v[144:159]
  v_mfma_f32_32x32x16_bf16 v[160:175], a[196:199], a[28:31], v[160:175]
  v_mfma_f32_32x32x16_bf16 v[176:191], a[196:199], a[32:35], v[176:191]
  v_mfma_f32_32x32x16_bf16 v[192:207], a[196:199], a[36:39], v[192:207]
  s_add_u32 s25, s31, 1314816
  buffer_store_dwordx4 v[232:235], v36, s[8:11], s25 offen offset:0 sc1
  v_mfma_f32_32x32x16_bf16 v[208:223], a[196:199], a[40:43], v[208:223]
  s_waitcnt lgkmcnt(0)
  v_mfma_f32_32x32x16_bf16 v[64:79], a[152:155], a[0:3], v[64:79]
  ds_read_b64_tr_b16 a[24:25], v16 offset:15360
  ds_read_b64_tr_b16 a[26:27], v16 offset:17920
  v_mfma_f32_32x32x16_bf16 v[80:95], a[152:155], a[4:7], v[80:95]
  ds_read_b64_tr_b16 a[28:29], v16 offset:15424
  ds_read_b64_tr_b16 a[30:31], v16 offset:17984
  v_mfma_f32_32x32x16_bf16 v[96:111], a[152:155], a[8:11], v[96:111]
  ds_read_b64_tr_b16 a[32:33], v16 offset:15488
  ds_read_b64_tr_b16 a[34:35], v16 offset:18048
  v_mfma_f32_32x32x16_bf16 v[112:127], a[152:155], a[12:15], v[112:127]
  ds_read_b64_tr_b16 a[36:37], v16 offset:15552
  ds_read_b64_tr_b16 a[38:39], v16 offset:18112
  v_mfma_f32_32x32x16_bf16 v[128:143], a[152:155], a[16:19], v[128:143]
  ds_read_b64_tr_b16 a[40:41], v16 offset:15616
  ds_read_b64_tr_b16 a[42:43], v16 offset:18176
  buffer_store_dwordx4 v[236:239], v36, s[8:11], s25 offen offset:1024 sc1
  v_mfma_f32_32x32x16_bf16 v[144:159], a[200:203], a[0:3], v[144:159]
  v_mfma_f32_32x32x16_bf16 v[160:175], a[200:203], a[4:7], v[160:175]
  v_mfma_f32_32x32x16_bf16 v[176:191], a[200:203], a[8:11], v[176:191]
  v_mfma_f32_32x32x16_bf16 v[192:207], a[200:203], a[12:15], v[192:207]
  v_mfma_f32_32x32x16_bf16 v[208:223], a[200:203], a[16:19], v[208:223]
  s_waitcnt vmcnt(5) lgkmcnt(0)
  s_barrier
  s_add_u32 s30, s30, 24576
  s_cmp_eq_u32 s30, 98304
  s_cselect_b32 s30, 0, s30
  v_add_u32 v16, s30, v23
  v_mfma_f32_32x32x16_bf16 v[64:79], a[156:159], a[24:27], v[64:79]
  ds_read_b64_tr_b16 a[0:1], v16 offset:0
  ds_read_b64_tr_b16 a[2:3], v16 offset:2560
  s_cmp_eq_u32 s62, 0
  s_cbranch_scc1 W_c_37
  s_add_u32 m0, s29, s32
  s_nop 0
  buffer_load_dwordx4 v8, s[56:59], s61 offen lds
W_c_37:
  v_mfma_f32_32x32x16_bf16 v[80:95], a[156:159], a[28:31], v[80:95]
  ds_read_b64_tr_b16 a[4:5], v16 offset:64
  ds_read_b64_tr_b16 a[6:7], v16 offset:2624
  s_cmp_eq_u32 s62, 0
  s_cbranch_scc1 W_c_38
  s_add_u32 m0, m0, 1024
  s_nop 0
  buffer_load_dwordx4 v9, s[56:59], s61 offen lds
W_c_38:
  v_mfma_f32_32x32x16_bf16 v[96:111], a[156:159], a[32:35], v[96:111]
  ds_read_b64_tr_b16 a[8:9], v16 offset:128
  ds_read_b64_tr_b16 a[10:11], v16 offset:2688
  v_mfma_f32_32x32x16_bf16 v[112:127], a[156:159], a[36:39], v[112:127]
  ds_read_b64_tr_b16 a[12:13], v16 offset:192
  ds_read_b64_tr_b16 a[14:15], v16 offset:2752
  s_cmp_eq_u32 s62, 0
  s_cbranch_scc1 W_c_39
  s_add_u32 m0, m0, 1024
  s_nop 0
  buffer_load_dwordx4 v10, s[56:59], s61 offen lds
W_c_39:
  v_mfma_f32_32x32x16_bf16 v[128:143], a[156:159], a[40:43], v[128:143]
  ds_read_b64_tr_b16 a[16:17], v16 offset:256
  ds_read_b64_tr_b16 a[18:19], v16 offset:2816
  v_mfma_f32_32x32x16_bf16 v[144:159], a[204:207], a[24:27], v[144:159]
  s_cmp_eq_u32 s62, 0
  s_cbranch_scc1 W_c_40
  s_add_u32 m0, m0, 1024
  s_nop 0
  buffer_load_dwordx4 v11, s[56:59], s61 offen lds
W_c_40:
  v_mfma_f32_32x32x16_bf16 v[160:175], a[204:207], a[28:31], v[160:175]
  s_cmp_eq_u32 s62, 0
  s_cbranch_scc1 W_c_41
  s_add_u32 m0, m0, 1024
  s_nop 0
  buffer_load_dwordx4 v12, s[56:59], s61 offen lds
W_c_41:
  v_mfma_f32_32x32x16_bf16 v[176:191], a[204:207], a[32:35], v[176:191]
  v_mfma_f32_32x32x16_bf16 v[192:207], a[204:207], a[36:39], v[192:207]
  s_cmp_eq_u32 s62, 0
  s_cbranch_scc1 W_c_42
  s_add_u32 m0, m0, 1024
  s_nop 0
  buffer_load_dwordx4 v13, s[56:59], s61 offen lds
  s_add_u32 s61, s61, s28
  s_add_u32 s29, s29, 24576
  s_cmp_eq_u32 s29, 98304
  s_cselect_b32 s29, 0, s29
W_c_42:
  v_mfma_f32_32x32x16_bf16 v[208:223], a[204:207], a[40:43], v[208:223]
  s_waitcnt lgkmcnt(0)
  v_mfma_f32_32x32x16_bf16 v[64:79], a[160:163], a[0:3], v[64:79]
  ds_read_b64_tr_b16 a[24:25], v16 offset:5120
  ds_read_b64_tr_b16 a[26:27], v16 offset:7680
  s_add_u32 s25, s31, 1314816
  buffer_store_dwordx4 v[240:243], v36, s[8:11], s25 offen offset:2048 sc1
  v_mfma_f32_32x32x16_bf16 v[80:95], a[160:163], a[4:7], v[80:95]
  ds_read_b64_tr_b16 a[28:29], v16 offset:5184
  ds_read_b64_tr_b16 a[30:31], v16 offset:7744
  v_mfma_f32_32x32x16_bf16 v[96:111], a[160:163], a[8:11], v[96:111]
  ds_read_b64_tr_b16 a[32:33], v16 offset:5248
  ds_read_b64_tr_b16 a[34:35], v16 offset:7808
  buffer_store_dwordx4 v[244:247], v36, s[8:11], s25 offen offset:3072 sc1
  v_mfma_f32_32x32x16_bf16 v[112:127], a[160:163], a[12:15], v[112:127]
  ds_read_b64_tr_b16 a[36:37], v16 offset:5312
  ds_read_b64_tr_b16 a[38:39], v16 offset:7872
  v_mfma_f32_32x32x16_bf16 v[128:143], a[160:163], a[16:19], v[128:143]
  ds_read_b64_tr_b16 a[40:41], v16 offset:5376
  ds_read_b64_tr_b16 a[42:43], v16 offset:7936
  s_add_u32 s25, s31, 1318912
  buffer_store_dwordx4 v[248:251], v36, s[8:11], s25 offen offset:0 sc1
  v_mfma_f32_32x32x16_bf16 v[144:159], a[208:211], a[0:3], v[144:159]
  v_mfma_f32_32x32x16_bf16 v[160:175], a[208:211], a[4:7], v[160:175]
  buffer_store_dwordx4 v[252:255], v36, s[8:11], s25 offen offset:1024 sc1
  v_mfma_f32_32x32x16_bf16 v[176:191], a[208:211], a[8:11], v[176:191]
  v_mfma_f32_32x32x16_bf16 v[192:207], a[208:211], a[12:15], v[192:207]
  s_cmp_eq_u32 s62, 0
  s_cbranch_scc1 W_c_43
  s_add_u32 m0, s52, 0
  s_nop 0
  buffer_load_dwordx4 v24, s[48:51], s60 offen lds
W_c_43:
  v_mfma_f32_32x32x16_bf16 v[208:223], a[208:211], a[16:19], v[208:223]
  s_waitcnt lgkmcnt(0)
  v_mfma_f32_32x32x16_bf16 v[64:79], a[164:167], a[24:27], v[64:79]
  ds_read_b64_tr_b16 a[0:1], v16 offset:10240
  ds_read_b64_tr_b16 a[2:3], v16 offset:12800
  s_cmp_eq_u32 s62, 0
  s_cbranch_scc1 W_c_44
  s_add_u32 m0, s52, 1024
  s_nop 0
  buffer_load_dwordx4 v25, s[48:51], s60 offen lds
W_c_44:
  v_mfma_f32_32x32x16_bf16 v[80:95], a[164:167], a[28:31], v[80:95]
  ds_read_b64_tr_b16 a[4:5], v16 offset:10304
  ds_read_b64_tr_b16 a[6:7], v16 offset:12864
  v_mfma_f32_32x32x16_bf16 v[96:111], a[164:167], a[32:35], v[96:111]
  ds_read_b64_tr_b16 a[8:9], v16 offset:10368
  ds_read_b64_tr_b16 a[10:11], v16 offset:12928
  s_cmp_eq_u32 s62, 0
  s_cbranch_scc1 W_c_45
  s_add_u32 m0, s52, 2048
  s_nop 0
  buffer_load_dwordx4 v26, s[48:51], s60 offen lds
W_c_45:
  v_mfma_f32_32x32x16_bf16 v[112:127], a[164:167], a[36:39], v[112:127]
  ds_read_b64_tr_b16 a[12:13], v16 offset:10432
  ds_read_b64_tr_b16 a[14:15], v16 offset:12992
  v_mfma_f32_32x32x16_bf16 v[128:143], a[164:167], a[40:43], v[128:143]
  ds_read_b64_tr_b16 a[16:17], v16 offset:10496
  ds_read_b64_tr_b16 a[18:19], v16 offset:13056
  s_cmp_eq_u32 s62, 0
  s_cbranch_scc1 W_c_46
  s_add_u32 m0, s52, 3072
  s_nop 0
  buffer_load_dwordx4 v27, s[48:51], s60 offen lds
W_c_46:
  v_mfma_f32_32x32x16_bf16 v[144:159], a[212:215], a[24:27], v[144:159]
  v_mfma_f32_32x32x16_bf16 v[160:175], a[212:215], a[28:31], v[160:175]
  s_cmp_eq_u32 s62, 0
  s_cbranch_scc1 W_c_47
  s_add_u32 m0, s52, 4096
  s_nop 0
  buffer_load_dwordx4 v28, s[48:51], s60 offen lds
W_c_47:
  v_mfma_f32_32x32x16_bf16 v[176:191], a[212:215], a[32:35], v[176:191]
  v_mfma_f32_32x32x16_bf16 v[192:207], a[212:215], a[36:39], v[192:207]
  s_cmp_eq_u32 s62, 0
  s_cbranch_scc1 W_c_48
  s_add_u32 m0, s52, 5120
  s_nop 0
  buffer_load_dwordx4 v29, s[48:51], s60 offen lds
W_c_48:
  v_mfma_f32_32x32x16_bf16 v[208:223], a[212:215], a[40:43], v[208:223]
  s_waitcnt lgkmcnt(0)
  v_mfma_f32_32x32x16_bf16 v[64:79], a[168:171], a[0:3], v[64:79]
  ds_read_b64_tr_b16 a[24:25], v16 offset:15360
  ds_read_b64_tr_b16 a[26:27], v16 offset:17920
  s_cmp_eq_u32 s62, 0
  s_cbranch_scc1 W_c_49
  s_add_u32 m0, s52, 6144
  s_nop 0
  buffer_load_dwordx4 v30, s[48:51], s60 offen lds
W_c_49:
  v_mfma_f32_32x32x16_bf16 v[80:95], a[168:171], a[4:7], v[80:95]
  ds_read_b64_tr_b16 a[28:29], v16 offset:15424
  ds_read_b64_tr_b16 a[30:31], v16 offset:17984
  v_mfma_f32_32x32x16_bf16 v[96:111], a[168:171], a[8:11], v[96:111]
  ds_read_b64_tr_b16 a[32:33], v16 offset:15488
  ds_read_b64_tr_b16 a[34:35], v16 offset:18048
  s_cmp_eq_u32 s62, 0
  s_cbranch_scc1 W_c_50
  s_add_u32 m0, s52, 7168
  s_nop 0
  buffer_load_dwordx4 v31, s[48:51], s60 offen lds
  s_add_u32 s60, s60, 128
W_c_50:
  v_mfma_f32_32x32x16_bf16 v[112:127], a[168:171], a[12:15], v[112:127]
  ds_read_b64_tr_b16 a[36:37], v16 offset:15552
  ds_read_b64_tr_b16 a[38:39], v16 offset:18112
  v_mfma_f32_32x32x16_bf16 v[128:143], a[168:171], a[16:19], v[128:143]
  ds_read_b64_tr_b16 a[40:41], v16 offset:15616
  ds_read_b64_tr_b16 a[42:43], v16 offset:18176
  s_cmp_eq_u32 s62, 0
  s_cbranch_scc1 W_c_51
  s_add_u32 m0, s29, s32
  s_nop 0
  buffer_load_dwordx4 v8, s[56:59], s61 offen lds
W_c_51:
  v_mfma_f32_32x32x16_bf16 v[144:159], a[216:219], a[0:3], v[144:159]
  v_mfma_f32_32x32x16_bf16 v[160:175], a[216:219], a[4:7], v[160:175]
  s_cmp_eq_u32 s62, 0
  s_cbranch_scc1 W_c_52
  s_add_u32 m0, m0, 1024
  s_nop 0
  buffer_load_dwordx4 v9, s[56:59], s61 offen lds
W_c_52:
  v_mfma_f32_32x32x16_bf16 v[176:191], a[216:219], a[8:11], v[176:191]
  v_mfma_f32_32x32x16_bf16 v[192:207], a[216:219], a[12:15], v[192:207]
  s_cmp_eq_u32 s62, 0
  s_cbranch_scc1 W_c_53
  s_add_u32 m0, m0, 1024
  s_nop 0
  buffer_load_dwordx4 v10, s[56:59], s61 offen lds
W_c_53:
  v_mfma_f32_32x32x16_bf16 v[208:223], a[216:219], a[16:19], v[208:223]
  s_waitcnt lgkmcnt(0)
  v_mfma_f32_32x32x16_bf16 v[64:79], a[172:175], a[24:27], v[64:79]
  s_cmp_eq_u32 s62, 0
  s_cbranch_scc1 W_c_54
  s_add_u32 m0, m0, 1024
  s_nop 0
  buffer_load_dwordx4 v11, s[56:59], s61 offen lds
W_c_54:
  v_mfma_f32_32x32x16_bf16 v[80:95], a[172:175], a[28:31], v[80:95]
  v_mfma_f32_32x32x16_bf16 v[96:111], a[172:175], a[32:35], v[96:111]
  s_cmp_eq_u32 s62, 0
  s_cbranch_scc1 W_c_55
  s_add_u32 m0, m0, 1024
  s_nop 0
  buffer_load_dwordx4 v12, s[56:59], s61 offen lds
W_c_55:
  v_mfma_f32_32x32x16_bf16 v[112:127], a[172:175], a[36:39], v[112:127]
  v_mfma_f32_32x32x16_bf16 v[128:143], a[172:175], a[40:43], v[128:143]
  s_cmp_eq_u32 s62, 0
  s_cbranch_scc1 W_c_56
  s_add_u32 m0, m0, 1024
  s_nop 0
  buffer_load_dwordx4 v13, s[56:59], s61 offen lds
  s_add_u32 s61, s61, s28
  s_add_u32 s29, s29, 24576
  s_cmp_eq_u32 s29, 98304
  s_cselect_b32 s29, 0, s29
W_c_56:
  v_mfma_f32_32x32x16_bf16 v[144:159], a[220:223], a[24:27], v[144:159]
  v_mfma_f32_32x32x16_bf16 v[160:175], a[220:223], a[28:31], v[160:175]
  v_mfma_f32_32x32x16_bf16 v[176:191], a[220:223], a[32:35], v[176:191]
  v_mfma_f32_32x32x16_bf16 v[192:207], a[220:223], a[36:39], v[192:207]
  v_mfma_f32_32x32x16_bf16 v[208:223], a[220:223], a[40:43], v[208:223]
  s_add_u32 s31, s31, 10240
  s_cmp_eq_u32 s62, 0
  s_cbranch_scc1 W_wh_57
  s_waitcnt vmcnt(6)
  s_barrier
  s_add_u32 s30, s30, 24576
  s_cmp_eq_u32 s30, 98304
  s_cselect_b32 s30, 0, s30
  v_add_u32 v16, s30, v14
  v_add_u32 v17, s30, v15
  ds_read_b128 a[48:51], v32 offset:0
  ds_read_b128 a[52:55], v32 offset:4096
  ds_read_b64_tr_b16 a[0:1], v16 offset:0
  ds_read_b64_tr_b16 a[2:3], v16 offset:1536
  ds_read_b64_tr_b16 a[4:5], v17 offset:64
  ds_read_b64_tr_b16 a[6:7], v17 offset:1600
  ds_read_b64_tr_b16 a[8:9], v16 offset:128
  ds_read_b64_tr_b16 a[10:11], v16 offset:1664
  ds_read_b64_tr_b16 a[12:13], v17 offset:192
  ds_read_b64_tr_b16 a[14:15], v17 offset:1728
  ds_read_b64_tr_b16 a[16:17], v16 offset:256
  ds_read_b64_tr_b16 a[18:19], v16 offset:1792
  ds_read_b64_tr_b16 a[20:21], v17 offset:320
  ds_read_b64_tr_b16 a[22:23], v17 offset:1856
W_wh_57:
  s_nop 7
  v_cvt_pk_bf16_f32 v40, v64, v65
  v_cvt_pk_bf16_f32 v41, v66, v67
  v_cvt_pk_bf16_f32 v42, v68, v69
  v_cvt_pk_bf16_f32 v43, v70, v71
  v_cvt_pk_bf16_f32 v44, v72, v73
  v_cvt_pk_bf16_f32 v45, v74, v75
  v_cvt_pk_bf16_f32 v46, v76, v77
  v_cvt_pk_bf16_f32 v47, v78, v79
  s_add_u32 s25, s31, 0
  buffer_store_dwordx4 v[40:43], v36, s[8:11], s25 offen offset:0 sc1
  buffer_store_dwordx4 v[44:47], v36, s[8:11], s25 offen offset:1024 sc1
  v_cvt_pk_bf16_f32 v48, v80, v81
  v_cvt_pk_bf16_f32 v49, v82, v83
  v_cvt_pk_bf16_f32 v50, v84, v85
  v_cvt_pk_bf16_f32 v51, v86, v87
  v_cvt_pk_bf16_f32 v52, v88, v89
  v_cvt_pk_bf16_f32 v53, v90, v91
  v_cvt_pk_bf16_f32 v54, v92, v93
  v_cvt_pk_bf16_f32 v55, v94, v95
  s_add_u32 s25, s31, 0
  buffer_store_dwordx4 v[48:51], v36, s[8:11], s25 offen offset:2048 sc1
  buffer_store_dwordx4 v[52:55], v36, s[8:11], s25 offen offset:3072 sc1
  v_cvt_pk_bf16_f32 v56, v96, v97
  v_cvt_pk_bf16_f32 v57, v98, v99
  v_cvt_pk_bf16_f32 v58, v100, v101
  v_cvt_pk_bf16_f32 v59, v102, v103
  v_cvt_pk_bf16_f32 v60, v104, v105
  v_cvt_pk_bf16_f32 v61, v106, v107
  v_cvt_pk_bf16_f32 v62, v108, v109
  v_cvt_pk_bf16_f32 v63, v110, v111
  s_add_u32 s25, s31, 4096
  buffer_store_dwordx4 v[56:59], v36, s[8:11], s25 offen offset:0 sc1
  buffer_store_dwordx4 v[60:63], v36, s[8:11], s25 offen offset:1024 sc1
  v_cvt_pk_bf16_f32 v40, v112, v113
  v_cvt_pk_bf16_f32 v41, v114, v115
  v_cvt_pk_bf16_f32 v42, v116, v117
  v_cvt_pk_bf16_f32 v43, v118, v119
  v_cvt_pk_bf16_f32 v44, v120, v121
  v_cvt_pk_bf16_f32 v45, v122, v123
  v_cvt_pk_bf16_f32 v46, v124, v125
  v_cvt_pk_bf16_f32 v47, v126, v127
  s_add_u32 s25, s31, 4096
  buffer_store_dwordx4 v[40:43], v36, s[8:11], s25 offen offset:2048 sc1
  buffer_store_dwordx4 v[44:47], v36, s[8:11], s25 offen offset:3072 sc1
  v_cvt_pk_bf16_f32 v48, v128, v129
  v_cvt_pk_bf16_f32 v49, v130, v131
  v_cvt_pk_bf16_f32 v50, v132, v133
  v_cvt_pk_bf16_f32 v51, v134, v135
  v_cvt_pk_bf16_f32 v52, v136, v137
  v_cvt_pk_bf16_f32 v53, v138, v139
  v_cvt_pk_bf16_f32 v54, v140, v141
  v_cvt_pk_bf16_f32 v55, v142, v143
  s_add_u32 s25, s31, 8192
  buffer_store_dwordx4 v[48:51], v36, s[8:11], s25 offen offset:0 sc1
  buffer_store_dwordx4 v[52:55], v36, s[8:11], s25 offen offset:1024 sc1
  v_cvt_pk_bf16_f32 v56, v144, v145
  v_cvt_pk_bf16_f32 v57, v146, v147
  v_cvt_pk_bf16_f32 v58, v148, v149
  v_cvt_pk_bf16_f32 v59, v150, v151
  v_cvt_pk_bf16_f32 v60, v152, v153
  v_cvt_pk_bf16_f32 v61, v154, v155
  v_cvt_pk_bf16_f32 v62, v156, v157
  v_cvt_pk_bf16_f32 v63, v158, v159
  s_add_u32 s25, s31, 1310720
  buffer_store_dwordx4 v[56:59], v36, s[8:11], s25 offen offset:0 sc1
  buffer_store_dwordx4 v[60:63], v36, s[8:11], s25 offen offset:1024 sc1
  v_cvt_pk_bf16_f32 v40, v160, v161
  v_cvt_pk_bf16_f32 v41, v162, v163
  v_cvt_pk_bf16_f32 v42, v164, v165
  v_cvt_pk_bf16_f32 v43, v166, v167
  v_cvt_pk_bf16_f32 v44, v168, v169
  v_cvt_pk_bf16_f32 v45, v170, v171
  v_cvt_pk_bf16_f32 v46, v172, v173
  v_cvt_pk_bf16_f32 v47, v174, v175
  s_add_u32 s25, s31, 1310720
  buffer_store_dwordx4 v[40:43], v36, s[8:11], s25 offen offset:2048 sc1
  buffer_store_dwordx4 v[44:47], v36, s[8:11], s25 offen offset:3072 sc1
  v_cvt_pk_bf16_f32 v48, v176, v177
  v_cvt_pk_bf16_f32 v49, v178, v179
  v_cvt_pk_bf16_f32 v50, v180, v181
  v_cvt_pk_bf16_f32 v51, v182, v183
  v_cvt_pk_bf16_f32 v52, v184, v185
  v_cvt_pk_bf16_f32 v53, v186, v187
  v_cvt_pk_bf16_f32 v54, v188, v189
  v_cvt_pk_bf16_f32 v55, v190, v191
  s_add_u32 s25, s31, 1314816
  buffer_store_dwordx4 v[48:51], v36, s[8:11], s25 offen offset:0 sc1
  buffer_store_dwordx4 v[52:55], v36, s[8:11], s25 offen offset:1024 sc1
  v_cvt_pk_bf16_f32 v56, v192, v193
  v_cvt_pk_bf16_f32 v57, v194, v195
  v_cvt_pk_bf16_f32 v58, v196, v197
  v_cvt_pk_bf16_f32 v59, v198, v199
  v_cvt_pk_bf16_f32 v60, v200, v201
  v_cvt_pk_bf16_f32 v61, v202, v203
  v_cvt_pk_bf16_f32 v62, v204, v205
  v_cvt_pk_bf16_f32 v63, v206, v207
  s_add_u32 s25, s31, 1314816
  buffer_store_dwordx4 v[56:59], v36, s[8:11], s25 offen offset:2048 sc1
  buffer_store_dwordx4 v[60:63], v36, s[8:11], s25 offen offset:3072 sc1
  v_cvt_pk_bf16_f32 v40, v208, v209
  v_cvt_pk_bf16_f32 v41, v210, v211
  v_cvt_pk_bf16_f32 v42, v212, v213
  v_cvt_pk_bf16_f32 v43, v214, v215
  v_cvt_pk_bf16_f32 v44, v216, v217
  v_cvt_pk_bf16_f32 v45, v218, v219
  v_cvt_pk_bf16_f32 v46, v220, v221
  v_cvt_pk_bf16_f32 v47, v222, v223
  s_add_u32 s25, s31, 1318912
  buffer_store_dwordx4 v[40:43], v36, s[8:11], s25 offen offset:0 sc1
  buffer_store_dwordx4 v[44:47], v36, s[8:11], s25 offen offset:1024 sc1
  s_cmp_eq_u32 s81, 0
  s_cbranch_scc1 W_sp_59
  v_mbcnt_lo_u32_b32 v3, -1, 0
  v_and_b32 v3, 15, v3
  v_min_u32 v3, 8, v3
  v_and_b32 v4, 1, v3
  v_lshlrev_b32 v3, 2, v3
  v_lshl_add_u32 v3, v4, 7, v3
W_sp_59c:
  buffer_load_dword v2, v3, s[4:7], 0 offen sc1
  s_sub_u32 s82, s82, 1
  s_cbranch_scc1 W_abort
  s_waitcnt vmcnt(0)
  v_readlane_b32 s84, v2, 0
  v_readlane_b32 s85, v2, 1
  v_readlane_b32 s86, v2, 2
  v_readlane_b32 s87, v2, 3
  v_readlane_b32 s88, v2, 4
  v_readlane_b32 s89, v2, 5
  v_readlane_b32 s90, v2, 6
  v_readlane_b32 s91, v2, 7
  v_readlane_b32 s92, v2, 8
  s_cmp_eq_u32 s92, 256
  s_cbranch_scc1 W_sp_59c_ok
  s_sleep 8
  s_branch W_sp_59c
W_sp_59c_ok:
  s_mov_b32 s81, 0
  s_and_b32 s25, s84, s85
  s_and_b32 s25, s25, s86
  s_and_b32 s25, s25, s87
  s_and_b32 s25, s25, s88
  s_and_b32 s25, s25, s89
  s_and_b32 s25, s25, s90
  s_and_b32 s25, s25, s91
  s_cmp_eq_u32 s25, 32
  s_cbranch_scc1 W_sp_59r
  s_waitcnt vmcnt(0) lgkmcnt(0)
  s_barrier
  s_branch M_worker
W_sp_59r:
  s_load_dwordx2 s[84:85], s[0:1], 0
  s_load_dwordx2 s[86:87], s[0:1], 56
  s_waitcnt lgkmcnt(0)
W_sp_59:
  s_cmp_eq_u32 s62, 0
  s_cbranch_scc1 W_fin_58
  s_mov_b32 s53, s36
  s_cmp_eq_u32 s24, 0
  s_cselect_b32 s54, s39, 0
  s_branch W_warm
W_fin_58:
  s_waitcnt vmcnt(0)
  s_barrier
  s_mov_b32 s53, s36
  s_cmp_eq_u32 s24, 0
  s_cselect_b32 s54, s39, 0
  s_cmp_eq_u32 s54, 0
  s_cbranch_scc1 W_pf_60
  v_mov_b32 v2, 1
  v_lshlrev_b32 v3, 2, v1
  s_mov_b32 exec_hi, 0
  s_mov_b32 exec_lo, s54
  buffer_store_dword v2, v3, s[8:11], s53 offen sc1
  s_mov_b64 exec, -1
  s_mov_b32 s54, 0
W_pf_60:
  s_branch W_next
W_bo:
  s_lshl_b32 s26, s44, 7
  s_add_u32 s26, s26, 6308864
  v_min_u32 v3, 0, v1
  v_lshlrev_b32 v3, 2, v3
W_bow:
  buffer_load_dword v2, v3, s[8:11], s26 offen offset:0 sc1
  s_sub_u32 s82, s82, 1
  s_cbranch_scc1 W_abort
  s_waitcnt vmcnt(0)
  v_cmp_gt_u32 vcc, 64, v2
  s_cbranch_vccz W_bow_ok
  s_sleep 16
  s_branch W_bow
W_bow_ok:
  s_mov_b32 s12, s74
  s_mov_b32 s13, s75
  s_mov_b32 s14, 819200
  s_mul_i32 s26, s44, 327680
  s_add_u32 s26, s26, 190840832
  s_mul_i32 s27, s45, 320
  s_mov_b32 s33, 1280
  s_mul_i32 s31, s44, 655360
  s_add_u32 s31, s31, s27
  s_add_u32 s31, s31, 1280
  v_lshrrev_b32 v4, 3, v1
  s_mul_i32 s25, s24, 64
  v_add_u32 v4, s25, v4
  v_mul_u32_u24 v4, 1280, v4
  v_lshrrev_b32 v5, 4, v1
  v_and_b32 v6, 7, v1
  v_xor_b32 v5, v5, v6
  v_lshl_add_u32 v24, v5, 4, v4
  v_xor_b32 v5, 4, v5
  v_lshl_add_u32 v25, v5, 4, v4
  v_add_u32 v25, 10240, v25
  v_add_u32 v26, 20480, v24
  v_add_u32 v27, 20480, v25
  v_add_u32 v28, 20480, v26
  v_add_u32 v29, 20480, v27
  v_add_u32 v30, 20480, v28
  v_add_u32 v31, 20480, v29
  s_mul_i32 s52, s24, 8192
  s_add_u32 s52, s52, 98304
  s_mul_i32 s25, s24, 320
  s_add_u32 s25, s25, 0
  v_add_u32 v4, s25, v1
  v_mul_u32_u24 v5, 3277, v4
  v_lshrrev_b32 v5, 16, v5
  v_mul_u32_u24 v6, 20, v5
  v_sub_u32 v6, v4, v6
  v_mul_lo_u32 v5, v5, s33
  v_lshl_add_u32 v8, v6, 4, v5
  s_mul_i32 s25, s24, 320
  s_add_u32 s25, s25, 64
  v_add_u32 v4, s25, v1
  v_mul_u32_u24 v5, 3277, v4
  v_lshrrev_b32 v5, 16, v5
  v_mul_u32_u24 v6, 20, v5
  v_sub_u32 v6, v4, v6
  v_mul_lo_u32 v5, v5, s33
  v_lshl_add_u32 v9, v6, 4, v5
  s_mul_i32 s25, s24, 320
  s_add_u32 s25, s25, 128
  v_add_u32 v4, s25, v1
  v_mul_u32_u24 v5, 3277, v4
  v_lshrrev_b32 v5, 16, v5
  v_mul_u32_u24 v6, 20, v5
  v_sub_u32 v6, v4, v6
  v_mul_lo_u32 v5, v5, s33
  v_lshl_add_u32 v10, v6, 4, v5
  s_mul_i32 s25, s24, 320
  s_add_u32 s25, s25, 192
  v_add_u32 v4, s25, v1
  v_mul_u32_u24 v5, 3277, v4
  v_lshrrev_b32 v5, 16, v5
  v_mul_u32_u24 v6, 20, v5
  v_sub_u32 v6, v4, v6
  v_mul_lo_u32 v5, v5, s33
  v_lshl_add_u32 v11, v6, 4, v5
  s_mul_i32 s25, s24, 320
  s_add_u32 s25, s25, 256
  v_add_u32 v4, s25, v1
  v_mul_u32_u24 v5, 3277, v4
  v_lshrrev_b32 v5, 16, v5
  v_mul_u32_u24 v6, 20, v5
  v_sub_u32 v6, v4, v6
  v_mul_lo_u32 v5, v5, s33
  v_lshl_add_u32 v12, v6, 4, v5
  s_lshl_b32 s28, s33, 6
  s_mul_i32 s32, s24, 5120
  s_mov_b32 s29, 0
  s_add_u32 m0, s29, s32
  s_nop 0
  buffer_load_dwordx4 v8, s[12:15], s27 offen lds
  s_add_u32 m0, m0, 1024
  s_nop 0
  buffer_load_dwordx4 v9, s[12:15], s27 offen lds
  s_add_u32 m0, m0, 1024
  s_nop 0
  buffer_load_dwordx4 v10, s[12:15], s27 offen lds
  s_add_u32 m0, m0, 1024
  s_nop 0
  buffer_load_dwordx4 v11, s[12:15], s27 offen lds
  s_add_u32 m0, m0, 1024
  s_nop 0
  buffer_load_dwordx4 v12, s[12:15], s27 offen lds
  s_add_u32 s27, s27, s28
  s_add_u32 s29, s29, 24576
  s_cmp_eq_u32 s29, 98304
  s_cselect_b32 s29, 0, s29
  s_add_u32 m0, s52, 0
  s_nop 0
  buffer_load_dwordx4 v24, s[8:11], s26 offen lds
  s_add_u32 m0, s52, 1024
  s_nop 0
  buffer_load_dwordx4 v25, s[8:11], s26 offen lds
  s_add_u32 m0, s52, 2048
  s_nop 0
  buffer_load_dwordx4 v26, s[8:11], s26 offen lds
  s_add_u32 m0, s52, 3072
  s_nop 0
  buffer_load_dwordx4 v27, s[8:11], s26 offen lds
  s_add_u32 m0, s52, 4096
  s_nop 0
  buffer_load_dwordx4 v28, s[8:11], s26 offen lds
  s_add_u32 m0, s52, 5120
  s_nop 0
  buffer_load_dwordx4 v29, s[8:11], s26 offen lds
  s_add_u32 m0, s52, 6144
  s_nop 0
  buffer_load_dwordx4 v30, s[8:11], s26 offen lds
  s_add_u32 m0, s52, 7168
  s_nop 0
  buffer_load_dwordx4 v31, s[8:11], s26 offen lds
  s_add_u32 s26, s26, 128
  s_add_u32 m0, s29, s32
  s_nop 0
  buffer_load_dwordx4 v8, s[12:15], s27 offen lds
  s_add_u32 m0, m0, 1024
  s_nop 0
  buffer_load_dwordx4 v9, s[12:15], s27 offen lds
  s_add_u32 m0, m0, 1024
  s_nop 0
  buffer_load_dwordx4 v10, s[12:15], s27 offen lds
  s_add_u32 m0, m0, 1024
  s_nop 0
  buffer_load_dwordx4 v11, s[12:15], s27 offen lds
  s_add_u32 m0, m0, 1024
  s_nop 0
  buffer_load_dwordx4 v12, s[12:15], s27 offen lds
  s_add_u32 s27, s27, s28
  s_add_u32 s29, s29, 24576
  s_cmp_eq_u32 s29, 98304
  s_cselect_b32 s29, 0, s29
  s_mul_i32 s25, s24, 64
  v_and_b32 v4, 31, v1
  v_bfe_u32 v5, v1, 1, 3
  v_lshrrev_b32 v6, 5, v1
  v_lshlrev_b32 v6, 2, v6
  v_xor_b32 v5, v5, v6
  v_add_u32 v4, s25, v4
  v_lshlrev_b32 v4, 7, v4
  v_add_u32 v4, 98304, v4
  v_xor_b32 v6, 0, v5
  v_lshl_add_u32 v32, v6, 4, v4
  v_xor_b32 v6, 1, v5
  v_lshl_add_u32 v33, v6, 4, v4
  v_xor_b32 v6, 2, v5
  v_lshl_add_u32 v34, v6, 4, v4
  v_xor_b32 v6, 3, v5
  v_lshl_add_u32 v35, v6, 4, v4
  v_lshrrev_b32 v4, 5, v1
  v_bfe_u32 v5, v1, 2, 2
  v_mul_u32_u24 v4, 32, v4
  v_add_u32 v4, v4, v5
  v_mul_u32_u24 v4, 320, v4
  v_bfe_u32 v6, v1, 4, 1
  v_lshl_add_u32 v4, v6, 5, v4
  v_and_b32 v6, 3, v1
  v_lshl_add_u32 v4, v6, 3, v4
  v_mov_b32 v14, v4
  v_mov_b32 v15, v4
  v_lshlrev_b32 v36, 4, v1
  s_mov_b32 s54, 0
  s_waitcnt vmcnt(5)
  s_barrier
  v_mov_b32 v16, v14
  v_mov_b32 v17, v15
  s_mov_b32 s30, 0
  ds_read_b128 a[48:51], v32 offset:0
  ds_read_b128 a[52:55], v32 offset:4096
  ds_read_b64_tr_b16 a[0:1], v16 offset:0
  ds_read_b64_tr_b16 a[2:3], v16 offset:1280
  ds_read_b64_tr_b16 a[4:5], v17 offset:64
  ds_read_b64_tr_b16 a[6:7], v17 offset:1344
  ds_read_b64_tr_b16 a[8:9], v16 offset:128
  ds_read_b64_tr_b16 a[10:11], v16 offset:1408
  ds_read_b64_tr_b16 a[12:13], v17 offset:192
  ds_read_b64_tr_b16 a[14:15], v17 offset:1472
  ds_read_b64_tr_b16 a[16:17], v16 offset:256
  ds_read_b64_tr_b16 a[18:19], v16 offset:1536
  s_waitcnt lgkmcnt(0)
  v_mfma_f32_32x32x16_bf16 v[64:79], a[0:3], a[48:51], 0
  ds_read_b128 a[56:59], v33 offset:0
  ds_read_b128 a[60:63], v33 offset:4096
  s_add_u32 m0, s52, 32768
  s_nop 0
  buffer_load_dwordx4 v24, s[8:11], s26 offen lds
  v_mfma_f32_32x32x16_bf16 v[144:159], a[0:3], a[52:55], 0
  ds_read_b64_tr_b16 a[24:25], v16 offset:2560
  ds_read_b64_tr_b16 a[26:27], v16 offset:3840
  v_mfma_f32_32x32x16_bf16 v[80:95], a[4:7], a[48:51], 0
  ds_read_b64_tr_b16 a[28:29], v17 offset:2624
  ds_read_b64_tr_b16 a[30:31], v17 offset:3904
  s_add_u32 m0, s52, 33792
  s_nop 0
  buffer_load_dwordx4 v25, s[8:11], s26 offen lds
  v_mfma_f32_32x32x16_bf16 v[160:175], a[4:7], a[52:55], 0
  ds_read_b64_tr_b16 a[32:33], v16 offset:2688
  ds_read_b64_tr_b16 a[34:35], v16 offset:3968
  v_mfma_f32_32x32x16_bf16 v[96:111], a[8:11], a[48:51], 0
  ds_read_b64_tr_b16 a[36:37], v17 offset:2752
  ds_read_b64_tr_b16 a[38:39], v17 offset:4032
  s_add_u32 m0, s52, 34816
  s_nop 0
  buffer_load_dwordx4 v26, s[8:11], s26 offen lds
  v_mfma_f32_32x32x16_bf16 v[176:191], a[8:11], a[52:55], 0
  ds_read_b64_tr_b16 a[40:41], v16 offset:2816
  ds_read_b64_tr_b16 a[42:43], v16 offset:4096
  v_mfma_f32_32x32x16_bf16 v[112:127], a[12:15], a[48:51], 0
  s_add_u32 m0, s52, 35840
  s_nop 0
  buffer_load_dwordx4 v27, s[8:11], s26 offen lds
  v_mfma_f32_32x32x16_bf16 v[192:207], a[12:15], a[52:55], 0
  v_mfma_f32_32x32x16_bf16 v[128:143], a[16:19], a[48:51], 0
  s_add_u32 m0, s52, 36864
  s_nop 0
  buffer_load_dwordx4 v28, s[8:11], s26 offen lds
  v_mfma_f32_32x32x16_bf16 v[208:223], a[16:19], a[52:55], 0
  s_waitcnt lgkmcnt(0)
  v_mfma_f32_32x32x16_bf16 v[64:79], a[24:27], a[56:59], v[64:79]
  ds_read_b128 a[48:51], v34 offset:0
  ds_read_b128 a[52:55], v34 offset:4096
  s_add_u32 m0, s52, 37888
  s_nop 0
  buffer_load_dwordx4 v29, s[8:11], s26 offen lds
  v_mfma_f32_32x32x16_bf16 v[144:159], a[24:27], a[60:63], v[144:159]
  ds_read_b64_tr_b16 a[0:1], v16 offset:5120
  ds_read_b64_tr_b16 a[2:3], v16 offset:6400
  v_mfma_f32_32x32x16_bf16 v[80:95], a[28:31], a[56:59], v[80:95]
  ds_read_b64_tr_b16 a[4:5], v17 offset:5184
  ds_read_b64_tr_b16 a[6:7], v17 offset:6464
  s_add_u32 m0, s52, 38912
  s_nop 0
  buffer_load_dwordx4 v30, s[8:11], s26 offen lds
  v_mfma_f32_32x32x16_bf16 v[160:175], a[28:31], a[60:63], v[160:175]
  ds_read_b64_tr_b16 a[8:9], v16 offset:5248
  ds_read_b64_tr_b16 a[10:11], v16 offset:6528
  v_mfma_f32_32x32x16_bf16 v[96:111], a[32:35], a[56:59], v[96:111]
  ds_read_b64_tr_b16 a[12:13], v17 offset:5312
  ds_read_b64_tr_b16 a[14:15], v17 offset:6592
  s_add_u32 m0, s52, 39936
  s_nop 0
  buffer_load_dwordx4 v31, s[8:11], s26 offen lds
  s_add_u32 s26, s26, 128
  v_mfma_f32_32x32x16_bf16 v[176:191], a[32:35], a[60:63], v[176:191]
  ds_read_b64_tr_b16 a[16:17], v16 offset:5376
  ds_read_b64_tr_b16 a[18:19], v16 offset:6656
  v_mfma_f32_32x32x16_bf16 v[112:127], a[36:39], a[56:59], v[112:127]
  s_add_u32 m0, s29, s32
  s_nop 0
  buffer_load_dwordx4 v8, s[12:15], s27 offen lds
  v_mfma_f32_32x32x16_bf16 v[192:207], a[36:39], a[60:63], v[192:207]
  v_mfma_f32_32x32x16_bf16 v[128:143], a[40:43], a[56:59], v[128:143]
  v_mfma_f32_32x32x16_bf16 v[208:223], a[40:43], a[60:63], v[208:223]
  s_waitcnt lgkmcnt(0)
  v_mfma_f32_32x32x16_bf16 v[64:79], a[0:3], a[48:51], v[64:79]
  ds_read_b128 a[56:59], v35 offset:0
  ds_read_b128 a[60:63], v35 offset:4096
  s_add_u32 m0, m0, 1024
  s_nop 0
  buffer_load_dwordx4 v9, s[12:15], s27 offen lds
  v_mfma_f32_32x32x16_bf16 v[144:159], a[0:3], a[52:55], v[144:159]
  ds_read_b64_tr_b16 a[24:25], v16 offset:7680
  ds_read_b64_tr_b16 a[26:27], v16 offset:8960
  v_mfma_f32_32x32x16_bf16 v[80:95], a[4:7], a[48:51], v[80:95]
  ds_read_b64_tr_b16 a[28:29], v17 offset:7744
  ds_read_b64_tr_b16 a[30:31], v17 offset:9024
  v_mfma_f32_32x32x16_bf16 v[160:175], a[4:7], a[52:55], v[160:175]
  ds_read_b64_tr_b16 a[32:33], v16 offset:7808
  ds_read_b64_tr_b16 a[34:35], v16 offset:9088
  v_mfma_f32_32x32x16_bf16 v[96:111], a[8:11], a[48:51], v[96:111]
  ds_read_b64_tr_b16 a[36:37], v17 offset:7872
  ds_read_b64_tr_b16 a[38:39], v17 offset:9152
  s_add_u32 m0, m0, 1024
  s_nop 0
  buffer_load_dwordx4 v10, s[12:15], s27 offen lds
  v_mfma_f32_32x32x16_bf16 v[176:191], a[8:11], a[52:55], v[176:191]
  ds_read_b64_tr_b16 a[40:41], v16 offset:7936
  ds_read_b64_tr_b16 a[42:43], v16 offset:9216
  v_mfma_f32_32x32x16_bf16 v[112:127], a[12:15], a[48:51], v[112:127]
  v_mfma_f32_32x32x16_bf16 v[192:207], a[12:15], a[52:55], v[192:207]
  v_mfma_f32_32x32x16_bf16 v[128:143], a[16:19], a[48:51], v[128:143]
  s_add_u32 m0, m0, 1024
  s_nop 0
  buffer_load_dwordx4 v11, s[12:15], s27 offen lds
  v_mfma_f32_32x32x16_bf16 v[208:223], a[16:19], a[52:55], v[208:223]
  s_waitcnt vmcnt(4) lgkmcnt(0)
  s_barrier
  s_add_u32 s30, s30, 24576
  s_cmp_eq_u32 s30, 98304
  s_cselect_b32 s30, 0, s30
  v_add_u32 v16, s30, v14
  v_add_u32 v17, s30, v15
  v_mfma_f32_32x32x16_bf16 v[64:79], a[24:27], a[56:59], v[64:79]
  ds_read_b128 a[48:51], v32 offset:32768
  ds_read_b128 a[52:55], v32 offset:36864
  v_mfma_f32_32x32x16_bf16 v[144:159], a[24:27], a[60:63], v[144:159]
  ds_read_b64_tr_b16 a[0:1], v16 offset:0
  ds_read_b64_tr_b16 a[2:3], v16 offset:1280
  v_mfma_f32_32x32x16_bf16 v[80:95], a[28:31], a[56:59], v[80:95]
  ds_read_b64_tr_b16 a[4:5], v17 offset:64
  ds_read_b64_tr_b16 a[6:7], v17 offset:1344
  s_add_u32 m0, m0, 1024
  s_nop 0
  buffer_load_dwordx4 v12, s[12:15], s27 offen lds
  s_add_u32 s27, s27, s28
  s_add_u32 s29, s29, 24576
  s_cmp_eq_u32 s29, 98304
  s_cselect_b32 s29, 0, s29
  v_mfma_f32_32x32x16_bf16 v[160:175], a[28:31], a[60:63], v[160:175]
  ds_read_b64_tr_b16 a[8:9], v16 offset:128
  ds_read_b64_tr_b16 a[10:11], v16 offset:1408
  v_mfma_f32_32x32x16_bf16 v[96:111], a[32:35], a[56:59], v[96:111]
  ds_read_b64_tr_b16 a[12:13], v17 offset:192
  ds_read_b64_tr_b16 a[14:15], v17 offset:1472
  v_mfma_f32_32x32x16_bf16 v[176:191], a[32:35], a[60:63], v[176:191]
  ds_read_b64_tr_b16 a[16:17], v16 offset:256
  ds_read_b64_tr_b16 a[18:19], v16 offset:1536
  v_mfma_f32_32x32x16_bf16 v[112:127], a[36:39], a[56:59], v[112:127]
  v_mfma_f32_32x32x16_bf16 v[192:207], a[36:39], a[60:63], v[192:207]
  v_mfma_f32_32x32x16_bf16 v[128:143], a[40:43], a[56:59], v[128:143]
  v_mfma_f32_32x32x16_bf16 v[208:223], a[40:43], a[60:63], v[208:223]
  s_waitcnt lgkmcnt(0)
  v_mfma_f32_32x32x16_bf16 v[64:79], a[0:3], a[48:51], v[64:79]
  ds_read_b128 a[56:59], v33 offset:32768
  ds_read_b128 a[60:63], v33 offset:36864
  s_add_u32 m0, s52, 0
  s_nop 0
  buffer_load_dwordx4 v24, s[8:11], s26 offen lds
  v_mfma_f32_32x32x16_bf16 v[144:159], a[0:3], a[52:55], v[144:159]
  ds_read_b64_tr_b16 a[24:25], v16 offset:2560
  ds_read_b64_tr_b16 a[26:27], v16 offset:3840
  v_mfma_f32_32x32x16_bf16 v[80:95], a[4:7], a[48:51], v[80:95]
  ds_read_b64_tr_b16 a[28:29], v17 offset:2624
  ds_read_b64_tr_b16 a[30:31], v17 offset:3904
  s_add_u32 m0, s52, 1024
  s_nop 0
  buffer_load_dwordx4 v25, s[8:11], s26 offen lds
  v_mfma_f32_32x32x16_bf16 v[160:175], a[4:7], a[52:55], v[160:175]
  ds_read_b64_tr_b16 a[32:33], v16 offset:2688
  ds_read_b64_tr_b16 a[34:35], v16 offset:3968
  v_mfma_f32_32x32x16_bf16 v[96:111], a[8:11], a[48:51], v[96:111]
  ds_read_b64_tr_b16 a[36:37], v17 offset:2752
  ds_read_b64_tr_b16 a[38:39], v17 offset:4032
  s_add_u32 m0, s52, 2048
  s_nop 0
  buffer_load_dwordx4 v26, s[8:11], s26 offen lds
  v_mfma_f32_32x32x16_bf16 v[176:191], a[8:11], a[52:55], v[176:191]
  ds_read_b64_tr_b16 a[40:41], v16 offset:2816
  ds_read_b64_tr_b16 a[42:43], v16 offset:4096
  v_mfma_f32_32x32x16_bf16 v[112:127], a[12:15], a[48:51], v[112:127]
  s_add_u32 m0, s52, 3072
  s_nop 0
  buffer_load_dwordx4 v27, s[8:11], s26 offen lds
  v_mfma_f32_32x32x16_bf16 v[192:207], a[12:15], a[52:55], v[192:207]
  v_mfma_f32_32x32x16_bf16 v[128:143], a[16:19], a[48:51], v[128:143]
  s_add_u32 m0, s52, 4096
  s_nop 0
  buffer_load_dwordx4 v28, s[8:11], s26 offen lds
  v_mfma_f32_32x32x16_bf16 v[208:223], a[16:19], a[52:55], v[208:223]
  s_waitcnt lgkmcnt(0)
  v_mfma_f32_32x32x16_bf16 v[64:79], a[24:27], a[56:59], v[64:79]
  ds_read_b128 a[48:51], v34 offset:32768
  ds_read_b128 a[52:55], v34 offset:36864
  s_add_u32 m0, s52, 5120
  s_nop 0
  buffer_load_dwordx4 v29, s[8:11], s26 offen lds
  v_mfma_f32_32x32x16_bf16 v[144:159], a[24:27], a[60:63], v[144:159]
  ds_read_b64_tr_b16 a[0:1], v16 offset:5120
  ds_read_b64_tr_b16 a[2:3], v16 offset:6400
  v_mfma_f32_32x32x16_bf16 v[80:95], a[28:31], a[56:59], v[80:95]
  ds_read_b64_tr_b16 a[4:5], v17 offset:5184
  ds_read_b64_tr_b16 a[6:7], v17 offset:6464
  s_add_u32 m0, s52, 6144
  s_nop 0
  buffer_load_dwordx4 v30, s[8:11], s26 offen lds
  v_mfma_f32_32x32x16_bf16 v[160:175], a[28:31], a[60:63], v[160:175]
  ds_read_b64_tr_b16 a[8:9], v16 offset:5248
  ds_read_b64_tr_b16 a[10:11], v16 offset:6528
  v_mfma_f32_32x32x16_bf16 v[96:111], a[32:35], a[56:59], v[96:111]
  ds_read_b64_tr_b16 a[12:13], v17 offset:5312
  ds_read_b64_tr_b16 a[14:15], v17 offset:6592
  s_add_u32 m0, s52, 7168
  s_nop 0
  buffer_load_dwordx4 v31, s[8:11], s26 offen lds
  s_add_u32 s26, s26, 128
  v_mfma_f32_32x32x16_bf16 v[176:191], a[32:35], a[60:63], v[176:191]
  ds_read_b64_tr_b16 a[16:17], v16 offset:5376
  ds_read_b64_tr_b16 a[18:19], v16 offset:6656
  v_mfma_f32_32x32x16_bf16 v[112:127], a[36:39], a[56:59], v[112:127]
  s_add_u32 m0, s29, s32
  s_nop 0
  buffer_load_dwordx4 v8, s[12:15], s27 offen lds
  v_mfma_f32_32x32x16_bf16 v[192:207], a[36:39], a[60:63], v[192:207]
  v_mfma_f32_32x32x16_bf16 v[128:143], a[40:43], a[56:59], v[128:143]
  v_mfma_f32_32x32x16_bf16 v[208:223], a[40:43], a[60:63], v[208:223]
  s_waitcnt lgkmcnt(0)
  v_mfma_f32_32x32x16_bf16 v[64:79], a[0:3], a[48:51], v[64:79]
  ds_read_b128 a[56:59], v35 offset:32768
  ds_read_b128 a[60:63], v35 offset:36864
  s_add_u32 m0, m0, 1024
  s_nop 0
  buffer_load_dwordx4 v9, s[12:15], s27 offen lds
  v_mfma_f32_32x32x16_bf16 v[144:159], a[0:3], a[52:55], v[144:159]
  ds_read_b64_tr_b16 a[24:25], v16 offset:7680
  ds_read_b64_tr_b16 a[26:27], v16 offset:8960
  v_mfma_f32_32x32x16_bf16 v[80:95], a[4:7], a[48:51], v[80:95]
  ds_read_b64_tr_b16 a[28:29], v17 offset:7744
  ds_read_b64_tr_b16 a[30:31], v17 offset:9024
  v_mfma_f32_32x32x16_bf16 v[160:175], a[4:7], a[52:55], v[160:175]
  ds_read_b64_tr_b16 a[32:33], v16 offset:7808
  ds_read_b64_tr_b16 a[34:35], v16 offset:9088
  v_mfma_f32_32x32x16_bf16 v[96:111], a[8:11], a[48:51], v[96:111]
  ds_read_b64_tr_b16 a[36:37], v17 offset:7872
  ds_read_b64_tr_b16 a[38:39], v17 offset:9152
  s_add_u32 m0, m0, 1024
  s_nop 0
  buffer_load_dwordx4 v10, s[12:15], s27 offen lds
  v_mfma_f32_32x32x16_bf16 v[176:191], a[8:11], a[52:55], v[176:191]
  ds_read_b64_tr_b16 a[40:41], v16 offset:7936
  ds_read_b64_tr_b16 a[42:43], v16 offset:9216
  v_mfma_f32_32x32x16_bf16 v[112:127], a[12:15], a[48:51], v[112:127]
  v_mfma_f32_32x32x16_bf16 v[192:207], a[12:15], a[52:55], v[192:207]
  v_mfma_f32_32x32x16_bf16 v[128:143], a[16:19], a[48:51], v[128:143]
  s_add_u32 m0, m0, 1024
  s_nop 0
  buffer_load_dwordx4 v11, s[12:15], s27 offen lds
  v_mfma_f32_32x32x16_bf16 v[208:223], a[16:19], a[52:55], v[208:223]
  s_waitcnt vmcnt(4) lgkmcnt(0)
  s_barrier
  s_add_u32 s30, s30, 24576
  s_cmp_eq_u32 s30, 98304
  s_cselect_b32 s30, 0, s30
  v_add_u32 v16, s30, v14
  v_add_u32 v17, s30, v15
  v_mfma_f32_32x32x16_bf16 v[64:79], a[24:27], a[56:59], v[64:79]
  ds_read_b128 a[48:51], v32 offset:0
  ds_read_b128 a[52:55], v32 offset:4096
  v_mfma_f32_32x32x16_bf16 v[144:159], a[24:27], a[60:63], v[144:159]
  ds_read_b64_tr_b16 a[0:1], v16 offset:0
  ds_read_b64_tr_b16 a[2:3], v16 offset:1280
  v_mfma_f32_32x32x16_bf16 v[80:95], a[28:31], a[56:59], v[80:95]
  ds_read_b64_tr_b16 a[4:5], v17 offset:64
  ds_read_b64_tr_b16 a[6:7], v17 offset:1344
  s_add_u32 m0, m0, 1024
  s_nop 0
  buffer_load_dwordx4 v12, s[12:15], s27 offen lds
  s_add_u32 s27, s27, s28
  s_add_u32 s29, s29, 24576
  s_cmp_eq_u32 s29, 98304
  s_cselect_b32 s29, 0, s29
  v_mfma_f32_32x32x16_bf16 v[160:175], a[28:31], a[60:63], v[160:175]
  ds_read_b64_tr_b16 a[8:9], v16 offset:128
  ds_read_b64_tr_b16 a[10:11], v16 offset:1408
  v_mfma_f32_32x32x16_bf16 v[96:111], a[32:35], a[56:59], v[96:111]
  ds_read_b64_tr_b16 a[12:13], v17 offset:192
  ds_read_b64_tr_b16 a[14:15], v17 offset:1472
  v_mfma_f32_32x32x16_bf16 v[176:191], a[32:35], a[60:63], v[176:191]
  ds_read_b64_tr_b16 a[16:17], v16 offset:256
  ds_read_b64_tr_b16 a[18:19], v16 offset:1536
  v_mfma_f32_32x32x16_bf16 v[112:127], a[36:39], a[56:59], v[112:127]
  v_mfma_f32_32x32x16_bf16 v[192:207], a[36:39], a[60:63], v[192:207]
  v_mfma_f32_32x32x16_bf16 v[128:143], a[40:43], a[56:59], v[128:143]
  v_mfma_f32_32x32x16_bf16 v[208:223], a[40:43], a[60:63], v[208:223]
  s_waitcnt lgkmcnt(0)
  v_mfma_f32_32x32x16_bf16 v[64:79], a[0:3], a[48:51], v[64:79]
  ds_read_b128 a[56:59], v33 offset:0
  ds_read_b128 a[60:63], v33 offset:4096
  s_add_u32 m0, s52, 32768
  s_nop 0
  buffer_load_dwordx4 v24, s[8:11], s26 offen lds
  v_mfma_f32_32x32x16_bf16 v[144:159], a[0:3], a[52:55], v[144:159]
  ds_read_b64_tr_b16 a[24:25], v16 offset:2560
  ds_read_b64_tr_b16 a[26:27], v16 offset:3840
  v_mfma_f32_32x32x16_bf16 v[80:95], a[4:7], a[48:51], v[80:95]
  ds_read_b64_tr_b16 a[28:29], v17 offset:2624
  ds_read_b64_tr_b16 a[30:31], v17 offset:3904
  s_add_u32 m0, s52, 33792
  s_nop 0
  buffer_load_dwordx4 v25, s[8:11], s26 offen lds
  v_mfma_f32_32x32x16_bf16 v[160:175], a[4:7], a[52:55], v[160:175]
  ds_read_b64_tr_b16 a[32:33], v16 offset:2688
  ds_read_b64_tr_b16 a[34:35], v16 offset:3968
  v_mfma_f32_32x32x16_bf16 v[96:111], a[8:11], a[48:51], v[96:111]
  ds_read_b64_tr_b16 a[36:37], v17 offset:2752
  ds_read_b64_tr_b16 a[38:39], v17 offset:4032
  s_add_u32 m0, s52, 34816
  s_nop 0
  buffer_load_dwordx4 v26, s[8:11], s26 offen lds
  v_mfma_f32_32x32x16_bf16 v[176:191], a[8:11], a[52:55], v[176:191]
  ds_read_b64_tr_b16 a[40:41], v16 offset:2816
  ds_read_b64_tr_b16 a[42:43], v16 offset:4096
  v_mfma_f32_32x32x16_bf16 v[112:127], a[12:15], a[48:51], v[112:127]
  s_add_u32 m0, s52, 35840
  s_nop 0
  buffer_load_dwordx4 v27, s[8:11], s26 offen lds
  v_mfma_f32_32x32x16_bf16 v[192:207], a[12:15], a[52:55], v[192:207]
  v_mfma_f32_32x32x16_bf16 v[128:143], a[16:19], a[48:51], v[128:143]
  s_add_u32 m0, s52, 36864
  s_nop 0
  buffer_load_dwordx4 v28, s[8:11], s26 offen lds
  v_mfma_f32_32x32x16_bf16 v[208:223], a[16:19], a[52:55], v[208:223]
  s_waitcnt lgkmcnt(0)
  v_mfma_f32_32x32x16_bf16 v[64:79], a[24:27], a[56:59], v[64:79]
  ds_read_b128 a[48:51], v34 offset:0
  ds_read_b128 a[52:55], v34 offset:4096
  s_add_u32 m0, s52, 37888
  s_nop 0
  buffer_load_dwordx4 v29, s[8:11], s26 offen lds
  v_mfma_f32_32x32x16_bf16 v[144:159], a[24:27], a[60:63], v[144:159]
  ds_read_b64_tr_b16 a[0:1], v16 offset:5120
  ds_read_b64_tr_b16 a[2:3], v16 offset:6400
  v_mfma_f32_32x32x16_bf16 v[80:95], a[28:31], a[56:59], v[80:95]
  ds_read_b64_tr_b16 a[4:5], v17 offset:5184
  ds_read_b64_tr_b16 a[6:7], v17 offset:6464
  s_add_u32 m0, s52, 38912
  s_nop 0
  buffer_load_dwordx4 v30, s[8:11], s26 offen lds
  v_mfma_f32_32x32x16_bf16 v[160:175], a[28:31], a[60:63], v[160:175]
  ds_read_b64_tr_b16 a[8:9], v16 offset:5248
  ds_read_b64_tr_b16 a[10:11], v16 offset:6528
  v_mfma_f32_32x32x16_bf16 v[96:111], a[32:35], a[56:59], v[96:111]
  ds_read_b64_tr_b16 a[12:13], v17 offset:5312
  ds_read_b64_tr_b16 a[14:15], v17 offset:6592
  s_add_u32 m0, s52, 39936
  s_nop 0
  buffer_load_dwordx4 v31, s[8:11], s26 offen lds
  s_add_u32 s26, s26, 128
  v_mfma_f32_32x32x16_bf16 v[176:191], a[32:35], a[60:63], v[176:191]
  ds_read_b64_tr_b16 a[16:17], v16 offset:5376
  ds_read_b64_tr_b16 a[18:19], v16 offset:6656
  v_mfma_f32_32x32x16_bf16 v[112:127], a[36:39], a[56:59], v[112:127]
  s_add_u32 m0, s29, s32
  s_nop 0
  buffer_load_dwordx4 v8, s[12:15], s27 offen lds
  v_mfma_f32_32x32x16_bf16 v[192:207], a[36:39], a[60:63], v[192:207]
  v_mfma_f32_32x32x16_bf16 v[128:143], a[40:43], a[56:59], v[128:143]
  v_mfma_f32_32x32x16_bf16 v[208:223], a[40:43], a[60:63], v[208:223]
  s_waitcnt lgkmcnt(0)
  v_mfma_f32_32x32x16_bf16 v[64:79], a[0:3], a[48:51], v[64:79]
  ds_read_b128 a[56:59], v35 offset:0
  ds_read_b128 a[60:63], v35 offset:4096
  s_add_u32 m0, m0, 1024
  s_nop 0
  buffer_load_dwordx4 v9, s[12:15], s27 offen lds
  v_mfma_f32_32x32x16_bf16 v[144:159], a[0:3], a[52:55], v[144:159]
  ds_read_b64_tr_b16 a[24:25], v16 offset:7680
  ds_read_b64_tr_b16 a[26:27], v16 offset:8960
  v_mfma_f32_32x32x16_bf16 v[80:95], a[4:7], a[48:51], v[80:95]
  ds_read_b64_tr_b16 a[28:29], v17 offset:7744
  ds_read_b64_tr_b16 a[30:31], v17 offset:9024
  v_mfma_f32_32x32x16_bf16 v[160:175], a[4:7], a[52:55], v[160:175]
  ds_read_b64_tr_b16 a[32:33], v16 offset:7808
  ds_read_b64_tr_b16 a[34:35], v16 offset:9088
  v_mfma_f32_32x32x16_bf16 v[96:111], a[8:11], a[48:51], v[96:111]
  ds_read_b64_tr_b16 a[36:37], v17 offset:7872
  ds_read_b64_tr_b16 a[38:39], v17 offset:9152
  s_add_u32 m0, m0, 1024
  s_nop 0
  buffer_load_dwordx4 v10, s[12:15], s27 offen lds
  v_mfma_f32_32x32x16_bf16 v[176:191], a[8:11], a[52:55], v[176:191]
  ds_read_b64_tr_b16 a[40:41], v16 offset:7936
  ds_read_b64_tr_b16 a[42:43], v16 offset:9216
  v_mfma_f32_32x32x16_bf16 v[112:127], a[12:15], a[48:51], v[112:127]
  v_mfma_f32_32x32x16_bf16 v[192:207], a[12:15], a[52:55], v[192:207]
  v_mfma_f32_32x32x16_bf16 v[128:143], a[16:19], a[48:51], v[128:143]
  s_add_u32 m0, m0, 1024
  s_nop 0
  buffer_load_dwordx4 v11, s[12:15], s27 offen lds
  v_mfma_f32_32x32x16_bf16 v[208:223], a[16:19], a[52:55], v[208:223]
  s_waitcnt vmcnt(4) lgkmcnt(0)
  s_barrier
  s_add_u32 s30, s30, 24576
  s_cmp_eq_u32 s30, 98304
  s_cselect_b32 s30, 0, s30
  v_add_u32 v16, s30, v14
  v_add_u32 v17, s30, v15
  v_mfma_f32_32x32x16_bf16 v[64:79], a[24:27], a[56:59], v[64:79]
  ds_read_b128 a[48:51], v32 offset:32768
  ds_read_b128 a[52:55], v32 offset:36864
  v_mfma_f32_32x32x16_bf16 v[144:159], a[24:27], a[60:63], v[144:159]
  ds_read_b64_tr_b16 a[0:1], v16 offset:0
  ds_read_b64_tr_b16 a[2:3], v16 offset:1280
  v_mfma_f32_32x32x16_bf16 v[80:95], a[28:31], a[56:59], v[80:95]
  ds_read_b64_tr_b16 a[4:5], v17 offset:64
  ds_read_b64_tr_b16 a[6:7], v17 offset:1344
  s_add_u32 m0, m0, 1024
  s_nop 0
  buffer_load_dwordx4 v12, s[12:15], s27 offen lds
  s_add_u32 s27, s27, s28
  s_add_u32 s29, s29, 24576
  s_cmp_eq_u32 s29, 98304
  s_cselect_b32 s29, 0, s29
  v_mfma_f32_32x32x16_bf16 v[160:175], a[28:31], a[60:63], v[160:175]
  ds_read_b64_tr_b16 a[8:9], v16 offset:128
  ds_read_b64_tr_b16 a[10:11], v16 offset:1408
  v_mfma_f32_32x32x16_bf16 v[96:111], a[32:35], a[56:59], v[96:111]
  ds_read_b64_tr_b16 a[12:13], v17 offset:192
  ds_read_b64_tr_b16 a[14:15], v17 offset:1472
  v_mfma_f32_32x32x16_bf16 v[176:191], a[32:35], a[60:63], v[176:191]
  ds_read_b64_tr_b16 a[16:17], v16 offset:256
  ds_read_b64_tr_b16 a[18:19], v16 offset:1536
  v_mfma_f32_32x32x16_bf16 v[112:127], a[36:39], a[56:59], v[112:127]
  v_mfma_f32_32x32x16_bf16 v[192:207], a[36:39], a[60:63], v[192:207]
  v_mfma_f32_32x32x16_bf16 v[128:143], a[40:43], a[56:59], v[128:143]
  v_mfma_f32_32x32x16_bf16 v[208:223], a[40:43], a[60:63], v[208:223]
  s_waitcnt lgkmcnt(0)
  v_mfma_f32_32x32x16_bf16 v[64:79], a[0:3], a[48:51], v[64:79]
  ds_read_b128 a[56:59], v33 offset:32768
  ds_read_b128 a[60:63], v33 offset:36864
  s_add_u32 m0, s52, 0
  s_nop 0
  buffer_load_dwordx4 v24, s[8:11], s26 offen lds
  v_mfma_f32_32x32x16_bf16 v[144:159], a[0:3], a[52:55], v[144:159]
  ds_read_b64_tr_b16 a[24:25], v16 offset:2560
  ds_read_b64_tr_b16 a[26:27], v16 offset:3840
  v_mfma_f32_32x32x16_bf16 v[80:95], a[4:7], a[48:51], v[80:95]
  ds_read_b64_tr_b16 a[28:29], v17 offset:2624
  ds_read_b64_tr_b16 a[30:31], v17 offset:3904
  s_add_u32 m0, s52, 1024
  s_nop 0
  buffer_load_dwordx4 v25, s[8:11], s26 offen lds
  v_mfma_f32_32x32x16_bf16 v[160:175], a[4:7], a[52:55], v[160:175]
  ds_read_b64_tr_b16 a[32:33], v16 offset:2688
  ds_read_b64_tr_b16 a[34:35], v16 offset:3968
  v_mfma_f32_32x32x16_bf16 v[96:111], a[8:11], a[48:51], v[96:111]
  ds_read_b64_tr_b16 a[36:37], v17 offset:2752
  ds_read_b64_tr_b16 a[38:39], v17 offset:4032
  s_add_u32 m0, s52, 2048
  s_nop 0
  buffer_load_dwordx4 v26, s[8:11], s26 offen lds
  v_mfma_f32_32x32x16_bf16 v[176:191], a[8:11], a[52:55], v[176:191]
  ds_read_b64_tr_b16 a[40:41], v16 offset:2816
  ds_read_b64_tr_b16 a[42:43], v16 offset:4096
  v_mfma_f32_32x32x16_bf16 v[112:127], a[12:15], a[48:51], v[112:127]
  s_add_u32 m0, s52, 3072
  s_nop 0
  buffer_load_dwordx4 v27, s[8:11], s26 offen lds
  v_mfma_f32_32x32x16_bf16 v[192:207], a[12:15], a[52:55], v[192:207]
  v_mfma_f32_32x32x16_bf16 v[128:143], a[16:19], a[48:51], v[128:143]
  s_add_u32 m0, s52, 4096
  s_nop 0
  buffer_load_dwordx4 v28, s[8:11], s26 offen lds
  v_mfma_f32_32x32x16_bf16 v[208:223], a[16:19], a[52:55], v[208:223]
  s_waitcnt lgkmcnt(0)
  v_mfma_f32_32x32x16_bf16 v[64:79], a[24:27], a[56:59], v[64:79]
  ds_read_b128 a[48:51], v34 offset:32768
  ds_read_b128 a[52:55], v34 offset:36864
  s_add_u32 m0, s52, 5120
  s_nop 0
  buffer_load_dwordx4 v29, s[8:11], s26 offen lds
  v_mfma_f32_32x32x16_bf16 v[144:159], a[24:27], a[60:63], v[144:159]
  ds_read_b64_tr_b16 a[0:1], v16 offset:5120
  ds_read_b64_tr_b16 a[2:3], v16 offset:6400
  v_mfma_f32_32x32x16_bf16 v[80:95], a[28:31], a[56:59], v[80:95]
  ds_read_b64_tr_b16 a[4:5], v17 offset:5184
  ds_read_b64_tr_b16 a[6:7], v17 offset:6464
  s_add_u32 m0, s52, 6144
  s_nop 0
  buffer_load_dwordx4 v30, s[8:11], s26 offen lds
  v_mfma_f32_32x32x16_bf16 v[160:175], a[28:31], a[60:63], v[160:175]
  ds_read_b64_tr_b16 a[8:9], v16 offset:5248
  ds_read_b64_tr_b16 a[10:11], v16 offset:6528
  v_mfma_f32_32x32x16_bf16 v[96:111], a[32:35], a[56:59], v[96:111]
  ds_read_b64_tr_b16 a[12:13], v17 offset:5312
  ds_read_b64_tr_b16 a[14:15], v17 offset:6592
  s_add_u32 m0, s52, 7168
  s_nop 0
  buffer_load_dwordx4 v31, s[8:11], s26 offen lds
  s_add_u32 s26, s26, 128
  v_mfma_f32_32x32x16_bf16 v[176:191], a[32:35], a[60:63], v[176:191]
  ds_read_b64_tr_b16 a[16:17], v16 offset:5376
  ds_read_b64_tr_b16 a[18:19], v16 offset:6656
  v_mfma_f32_32x32x16_bf16 v[112:127], a[36:39], a[56:59], v[112:127]
  s_add_u32 m0, s29, s32
  s_nop 0
  buffer_load_dwordx4 v8, s[12:15], s27 offen lds
  v_mfma_f32_32x32x16_bf16 v[192:207], a[36:39], a[60:63], v[192:207]
  v_mfma_f32_32x32x16_bf16 v[128:143], a[40:43], a[56:59], v[128:143]
  v_mfma_f32_32x32x16_bf16 v[208:223], a[40:43], a[60:63], v[208:223]
  s_waitcnt lgkmcnt(0)
  v_mfma_f32_32x32x16_bf16 v[64:79], a[0:3], a[48:51], v[64:79]
  ds_read_b128 a[56:59], v35 offset:32768
  ds_read_b128 a[60:63], v35 offset:36864
  s_add_u32 m0, m0, 1024
  s_nop 0
  buffer_load_dwordx4 v9, s[12:15], s27 offen lds
  v_mfma_f32_32x32x16_bf16 v[144:159], a[0:3], a[52:55], v[144:159]
  ds_read_b64_tr_b16 a[24:25], v16 offset:7680
  ds_read_b64_tr_b16 a[26:27], v16 offset:8960
  v_mfma_f32_32x32x16_bf16 v[80:95], a[4:7], a[48:51], v[80:95]
  ds_read_b64_tr_b16 a[28:29], v17 offset:7744
  ds_read_b64_tr_b16 a[30:31], v17 offset:9024
  v_mfma_f32_32x32x16_bf16 v[160:175], a[4:7], a[52:55], v[160:175]
  ds_read_b64_tr_b16 a[32:33], v16 offset:7808
  ds_read_b64_tr_b16 a[34:35], v16 offset:9088
  v_mfma_f32_32x32x16_bf16 v[96:111], a[8:11], a[48:51], v[96:111]
  ds_read_b64_tr_b16 a[36:37], v17 offset:7872
  ds_read_b64_tr_b16 a[38:39], v17 offset:9152
  s_add_u32 m0, m0, 1024
  s_nop 0
  buffer_load_dwordx4 v10, s[12:15], s27 offen lds
  v_mfma_f32_32x32x16_bf16 v[176:191], a[8:11], a[52:55], v[176:191]
  ds_read_b64_tr_b16 a[40:41], v16 offset:7936
  ds_read_b64_tr_b16 a[42:43], v16 offset:9216
  v_mfma_f32_32x32x16_bf16 v[112:127], a[12:15], a[48:51], v[112:127]
  v_mfma_f32_32x32x16_bf16 v[192:207], a[12:15], a[52:55], v[192:207]
  v_mfma_f32_32x32x16_bf16 v[128:143], a[16:19], a[48:51], v[128:143]
  s_add_u32 m0, m0, 1024
  s_nop 0
  buffer_load_dwordx4 v11, s[12:15], s27 offen lds
  v_mfma_f32_32x32x16_bf16 v[208:223], a[16:19], a[52:55], v[208:223]
  s_waitcnt vmcnt(4) lgkmcnt(0)
  s_barrier
  s_add_u32 s30, s30, 24576
  s_cmp_eq_u32 s30, 98304
  s_cselect_b32 s30, 0, s30
  v_add_u32 v16, s30, v14
  v_add_u32 v17, s30, v15
  v_mfma_f32_32x32x16_bf16 v[64:79], a[24:27], a[56:59], v[64:79]
  ds_read_b128 a[48:51], v32 offset:0
  ds_read_b128 a[52:55], v32 offset:4096
  v_mfma_f32_32x32x16_bf16 v[144:159], a[24:27], a[60:63], v[144:159]
  ds_read_b64_tr_b16 a[0:1], v16 offset:0
  ds_read_b64_tr_b16 a[2:3], v16 offset:1280
  v_mfma_f32_32x32x16_bf16 v[80:95], a[28:31], a[56:59], v[80:95]
  ds_read_b64_tr_b16 a[4:5], v17 offset:64
  ds_read_b64_tr_b16 a[6:7], v17 offset:1344
  s_add_u32 m0, m0, 1024
  s_nop 0
  buffer_load_dwordx4 v12, s[12:15], s27 offen lds
  s_add_u32 s27, s27, s28
  s_add_u32 s29, s29, 24576
  s_cmp_eq_u32 s29, 98304
  s_cselect_b32 s29, 0, s29
  v_mfma_f32_32x32x16_bf16 v[160:175], a[28:31], a[60:63], v[160:175]
  ds_read_b64_tr_b16 a[8:9], v16 offset:128
  ds_read_b64_tr_b16 a[10:11], v16 offset:1408
  v_mfma_f32_32x32x16_bf16 v[96:111], a[32:35], a[56:59], v[96:111]
  ds_read_b64_tr_b16 a[12:13], v17 offset:192
  ds_read_b64_tr_b16 a[14:15], v17 offset:1472
  v_mfma_f32_32x32x16_bf16 v[176:191], a[32:35], a[60:63], v[176:191]
  ds_read_b64_tr_b16 a[16:17], v16 offset:256
  ds_read_b64_tr_b16 a[18:19], v16 offset:1536
  v_mfma_f32_32x32x16_bf16 v[112:127], a[36:39], a[56:59], v[112:127]
  v_mfma_f32_32x32x16_bf16 v[192:207], a[36:39], a[60:63], v[192:207]
  v_mfma_f32_32x32x16_bf16 v[128:143], a[40:43], a[56:59], v[128:143]
  v_mfma_f32_32x32x16_bf16 v[208:223], a[40:43], a[60:63], v[208:223]
  s_waitcnt lgkmcnt(0)
  v_mfma_f32_32x32x16_bf16 v[64:79], a[0:3], a[48:51], v[64:79]
  ds_read_b128 a[56:59], v33 offset:0
  ds_read_b128 a[60:63], v33 offset:4096
  s_add_u32 m0, s52, 32768
  s_nop 0
  buffer_load_dwordx4 v24, s[8:11], s26 offen lds
  v_mfma_f32_32x32x16_bf16 v[144:159], a[0:3], a[52:55], v[144:159]
  ds_read_b64_tr_b16 a[24:25], v16 offset:2560
  ds_read_b64_tr_b16 a[26:27], v16 offset:3840
  v_mfma_f32_32x32x16_bf16 v[80:95], a[4:7], a[48:51], v[80:95]
  ds_read_b64_tr_b16 a[28:29], v17 offset:2624
  ds_read_b64_tr_b16 a[30:31], v17 offset:3904
  s_add_u32 m0, s52, 33792
  s_nop 0
  buffer_load_dwordx4 v25, s[8:11], s26 offen lds
  v_mfma_f32_32x32x16_bf16 v[160:175], a[4:7], a[52:55], v[160:175]
  ds_read_b64_tr_b16 a[32:33], v16 offset:2688
  ds_read_b64_tr_b16 a[34:35], v16 offset:3968
  v_mfma_f32_32x32x16_bf16 v[96:111], a[8:11], a[48:51], v[96:111]
  ds_read_b64_tr_b16 a[36:37], v17 offset:2752
  ds_read_b64_tr_b16 a[38:39], v17 offset:4032
  s_add_u32 m0, s52, 34816
  s_nop 0
  buffer_load_dwordx4 v26, s[8:11], s26 offen lds
  v_mfma_f32_32x32x16_bf16 v[176:191], a[8:11], a[52:55], v[176:191]
  ds_read_b64_tr_b16 a[40:41], v16 offset:2816
  ds_read_b64_tr_b16 a[42:43], v16 offset:4096
  v_mfma_f32_32x32x16_bf16 v[112:127], a[12:15], a[48:51], v[112:127]
  s_add_u32 m0, s52, 35840
  s_nop 0
  buffer_load_dwordx4 v27, s[8:11], s26 offen lds
  v_mfma_f32_32x32x16_bf16 v[192:207], a[12:15], a[52:55], v[192:207]
  v_mfma_f32_32x32x16_bf16 v[128:143], a[16:19], a[48:51], v[128:143]
  s_add_u32 m0, s52, 36864
  s_nop 0
  buffer_load_dwordx4 v28, s[8:11], s26 offen lds
  v_mfma_f32_32x32x16_bf16 v[208:223], a[16:19], a[52:55], v[208:223]
  s_waitcnt lgkmcnt(0)
  v_mfma_f32_32x32x16_bf16 v[64:79], a[24:27], a[56:59], v[64:79]
  ds_read_b128 a[48:51], v34 offset:0
  ds_read_b128 a[52:55], v34 offset:4096
  s_add_u32 m0, s52, 37888
  s_nop 0
  buffer_load_dwordx4 v29, s[8:11], s26 offen lds
  v_mfma_f32_32x32x16_bf16 v[144:159], a[24:27], a[60:63], v[144:159]
  ds_read_b64_tr_b16 a[0:1], v16 offset:5120
  ds_read_b64_tr_b16 a[2:3], v16 offset:6400
  v_mfma_f32_32x32x16_bf16 v[80:95], a[28:31], a[56:59], v[80:95]
  ds_read_b64_tr_b16 a[4:5], v17 offset:5184
  ds_read_b64_tr_b16 a[6:7], v17 offset:6464
  s_add_u32 m0, s52, 38912
  s_nop 0
  buffer_load_dwordx4 v30, s[8:11], s26 offen lds
  v_mfma_f32_32x32x16_bf16 v[160:175], a[28:31], a[60:63], v[160:175]
  ds_read_b64_tr_b16 a[8:9], v16 offset:5248
  ds_read_b64_tr_b16 a[10:11], v16 offset:6528
  v_mfma_f32_32x32x16_bf16 v[96:111], a[32:35], a[56:59], v[96:111]
  ds_read_b64_tr_b16 a[12:13], v17 offset:5312
  ds_read_b64_tr_b16 a[14:15], v17 offset:6592
  s_add_u32 m0, s52, 39936
  s_nop 0
  buffer_load_dwordx4 v31, s[8:11], s26 offen lds
  s_add_u32 s26, s26, 128
  v_mfma_f32_32x32x16_bf16 v[176:191], a[32:35], a[60:63], v[176:191]
  ds_read_b64_tr_b16 a[16:17], v16 offset:5376
  ds_read_b64_tr_b16 a[18:19], v16 offset:6656
  v_mfma_f32_32x32x16_bf16 v[112:127], a[36:39], a[56:59], v[112:127]
  s_add_u32 m0, s29, s32
  s_nop 0
  buffer_load_dwordx4 v8, s[12:15], s27 offen lds
  v_mfma_f32_32x32x16_bf16 v[192:207], a[36:39], a[60:63], v[192:207]
  v_mfma_f32_32x32x16_bf16 v[128:143], a[40:43], a[56:59], v[128:143]
  v_mfma_f32_32x32x16_bf16 v[208:223], a[40:43], a[60:63], v[208:223]
  s_waitcnt lgkmcnt(0)
  v_mfma_f32_32x32x16_bf16 v[64:79], a[0:3], a[48:51], v[64:79]
  ds_read_b128 a[56:59], v35 offset:0
  ds_read_b128 a[60:63], v35 offset:4096
  s_add_u32 m0, m0, 1024
  s_nop 0
  buffer_load_dwordx4 v9, s[12:15], s27 offen lds
  v_mfma_f32_32x32x16_bf16 v[144:159], a[0:3], a[52:55], v[144:159]
  ds_read_b64_tr_b16 a[24:25], v16 offset:7680
  ds_read_b64_tr_b16 a[26:27], v16 offset:8960
  v_mfma_f32_32x32x16_bf16 v[80:95], a[4:7], a[48:51], v[80:95]
  ds_read_b64_tr_b16 a[28:29], v17 offset:7744
  ds_read_b64_tr_b16 a[30:31], v17 offset:9024
  v_mfma_f32_32x32x16_bf16 v[160:175], a[4:7], a[52:55], v[160:175]
  ds_read_b64_tr_b16 a[32:33], v16 offset:7808
  ds_read_b64_tr_b16 a[34:35], v16 offset:9088
  v_mfma_f32_32x32x16_bf16 v[96:111], a[8:11], a[48:51], v[96:111]
  ds_read_b64_tr_b16 a[36:37], v17 offset:7872
  ds_read_b64_tr_b16 a[38:39], v17 offset:9152
  s_add_u32 m0, m0, 1024
  s_nop 0
  buffer_load_dwordx4 v10, s[12:15], s27 offen lds
  v_mfma_f32_32x32x16_bf16 v[176:191], a[8:11], a[52:55], v[176:191]
  ds_read_b64_tr_b16 a[40:41], v16 offset:7936
  ds_read_b64_tr_b16 a[42:43], v16 offset:9216
  v_mfma_f32_32x32x16_bf16 v[112:127], a[12:15], a[48:51], v[112:127]
  v_mfma_f32_32x32x16_bf16 v[192:207], a[12:15], a[52:55], v[192:207]
  v_mfma_f32_32x32x16_bf16 v[128:143], a[16:19], a[48:51], v[128:143]
  s_add_u32 m0, m0, 1024
  s_nop 0
  buffer_load_dwordx4 v11, s[12:15], s27 offen lds
  v_mfma_f32_32x32x16_bf16 v[208:223], a[16:19], a[52:55], v[208:223]
  s_waitcnt vmcnt(4) lgkmcnt(0)
  s_barrier
  s_add_u32 s30, s30, 24576
  s_cmp_eq_u32 s30, 98304
  s_cselect_b32 s30, 0, s30
  v_add_u32 v16, s30, v14
  v_add_u32 v17, s30, v15
  v_mfma_f32_32x32x16_bf16 v[64:79], a[24:27], a[56:59], v[64:79]
  ds_read_b128 a[48:51], v32 offset:32768
  ds_read_b128 a[52:55], v32 offset:36864
  v_mfma_f32_32x32x16_bf16 v[144:159], a[24:27], a[60:63], v[144:159]
  ds_read_b64_tr_b16 a[0:1], v16 offset:0
  ds_read_b64_tr_b16 a[2:3], v16 offset:1280
  v_mfma_f32_32x32x16_bf16 v[80:95], a[28:31], a[56:59], v[80:95]
  ds_read_b64_tr_b16 a[4:5], v17 offset:64
  ds_read_b64_tr_b16 a[6:7], v17 offset:1344
  s_add_u32 m0, m0, 1024
  s_nop 0
  buffer_load_dwordx4 v12, s[12:15], s27 offen lds
  s_add_u32 s27, s27, s28
  s_add_u32 s29, s29, 24576
  s_cmp_eq_u32 s29, 98304
  s_cselect_b32 s29, 0, s29
  v_mfma_f32_32x32x16_bf16 v[160:175], a[28:31], a[60:63], v[160:175]
  ds_read_b64_tr_b16 a[8:9], v16 offset:128
  ds_read_b64_tr_b16 a[10:11], v16 offset:1408
  v_mfma_f32_32x32x16_bf16 v[96:111], a[32:35], a[56:59], v[96:111]
  ds_read_b64_tr_b16 a[12:13], v17 offset:192
  ds_read_b64_tr_b16 a[14:15], v17 offset:1472
  v_mfma_f32_32x32x16_bf16 v[176:191], a[32:35], a[60:63], v[176:191]
  ds_read_b64_tr_b16 a[16:17], v16 offset:256
  ds_read_b64_tr_b16 a[18:19], v16 offset:1536
  v_mfma_f32_32x32x16_bf16 v[112:127], a[36:39], a[56:59], v[112:127]
  v_mfma_f32_32x32x16_bf16 v[192:207], a[36:39], a[60:63], v[192:207]
  v_mfma_f32_32x32x16_bf16 v[128:143], a[40:43], a[56:59], v[128:143]
  v_mfma_f32_32x32x16_bf16 v[208:223], a[40:43], a[60:63], v[208:223]
  s_waitcnt lgkmcnt(0)
  v_mfma_f32_32x32x16_bf16 v[64:79], a[0:3], a[48:51], v[64:79]
  ds_read_b128 a[56:59], v33 offset:32768
  ds_read_b128 a[60:63], v33 offset:36864
  s_add_u32 m0, s52, 0
  s_nop 0
  buffer_load_dwordx4 v24, s[8:11], s26 offen lds
  v_mfma_f32_32x32x16_bf16 v[144:159], a[0:3], a[52:55], v[144:159]
  ds_read_b64_tr_b16 a[24:25], v16 offset:2560
  ds_read_b64_tr_b16 a[26:27], v16 offset:3840
  v_mfma_f32_32x32x16_bf16 v[80:95], a[4:7], a[48:51], v[80:95]
  ds_read_b64_tr_b16 a[28:29], v17 offset:2624
  ds_read_b64_tr_b16 a[30:31], v17 offset:3904
  s_add_u32 m0, s52, 1024
  s_nop 0
  buffer_load_dwordx4 v25, s[8:11], s26 offen lds
  v_mfma_f32_32x32x16_bf16 v[160:175], a[4:7], a[52:55], v[160:175]
  ds_read_b64_tr_b16 a[32:33], v16 offset:2688
  ds_read_b64_tr_b16 a[34:35], v16 offset:3968
  v_mfma_f32_32x32x16_bf16 v[96:111], a[8:11], a[48:51], v[96:111]
  ds_read_b64_tr_b16 a[36:37], v17 offset:2752
  ds_read_b64_tr_b16 a[38:39], v17 offset:4032
  s_add_u32 m0, s52, 2048
  s_nop 0
  buffer_load_dwordx4 v26, s[8:11], s26 offen lds
  v_mfma_f32_32x32x16_bf16 v[176:191], a[8:11], a[52:55], v[176:191]
  ds_read_b64_tr_b16 a[40:41], v16 offset:2816
  ds_read_b64_tr_b16 a[42:43], v16 offset:4096
  v_mfma_f32_32x32x16_bf16 v[112:127], a[12:15], a[48:51], v[112:127]
  s_add_u32 m0, s52, 3072
  s_nop 0
  buffer_load_dwordx4 v27, s[8:11], s26 offen lds
  v_mfma_f32_32x32x16_bf16 v[192:207], a[12:15], a[52:55], v[192:207]
  v_mfma_f32_32x32x16_bf16 v[128:143], a[16:19], a[48:51], v[128:143]
  s_add_u32 m0, s52, 4096
  s_nop 0
  buffer_load_dwordx4 v28, s[8:11], s26 offen lds
  v_mfma_f32_32x32x16_bf16 v[208:223], a[16:19], a[52:55], v[208:223]
  s_waitcnt lgkmcnt(0)
  v_mfma_f32_32x32x16_bf16 v[64:79], a[24:27], a[56:59], v[64:79]
  ds_read_b128 a[48:51], v34 offset:32768
  ds_read_b128 a[52:55], v34 offset:36864
  s_add_u32 m0, s52, 5120
  s_nop 0
  buffer_load_dwordx4 v29, s[8:11], s26 offen lds
  v_mfma_f32_32x32x16_bf16 v[144:159], a[24:27], a[60:63], v[144:159]
  ds_read_b64_tr_b16 a[0:1], v16 offset:5120
  ds_read_b64_tr_b16 a[2:3], v16 offset:6400
  v_mfma_f32_32x32x16_bf16 v[80:95], a[28:31], a[56:59], v[80:95]
  ds_read_b64_tr_b16 a[4:5], v17 offset:5184
  ds_read_b64_tr_b16 a[6:7], v17 offset:6464
  s_add_u32 m0, s52, 6144
  s_nop 0
  buffer_load_dwordx4 v30, s[8:11], s26 offen lds
  v_mfma_f32_32x32x16_bf16 v[160:175], a[28:31], a[60:63], v[160:175]
  ds_read_b64_tr_b16 a[8:9], v16 offset:5248
  ds_read_b64_tr_b16 a[10:11], v16 offset:6528
  v_mfma_f32_32x32x16_bf16 v[96:111], a[32:35], a[56:59], v[96:111]
  ds_read_b64_tr_b16 a[12:13], v17 offset:5312
  ds_read_b64_tr_b16 a[14:15], v17 offset:6592
  s_add_u32 m0, s52, 7168
  s_nop 0
  buffer_load_dwordx4 v31, s[8:11], s26 offen lds
  s_add_u32 s26, s26, 128
  v_mfma_f32_32x32x16_bf16 v[176:191], a[32:35], a[60:63], v[176:191]
  ds_read_b64_tr_b16 a[16:17], v16 offset:5376
  ds_read_b64_tr_b16 a[18:19], v16 offset:6656
  v_mfma_f32_32x32x16_bf16 v[112:127], a[36:39], a[56:59], v[112:127]
  s_add_u32 m0, s29, s32
  s_nop 0
  buffer_load_dwordx4 v8, s[12:15], s27 offen lds
  v_mfma_f32_32x32x16_bf16 v[192:207], a[36:39], a[60:63], v[192:207]
  v_mfma_f32_32x32x16_bf16 v[128:143], a[40:43], a[56:59], v[128:143]
  v_mfma_f32_32x32x16_bf16 v[208:223], a[40:43], a[60:63], v[208:223]
  s_waitcnt lgkmcnt(0)
  v_mfma_f32_32x32x16_bf16 v[64:79], a[0:3], a[48:51], v[64:79]
  ds_read_b128 a[56:59], v35 offset:32768
  ds_read_b128 a[60:63], v35 offset:36864
  s_add_u32 m0, m0, 1024
  s_nop 0
  buffer_load_dwordx4 v9, s[12:15], s27 offen lds
  v_mfma_f32_32x32x16_bf16 v[144:159], a[0:3], a[52:55], v[144:159]
  ds_read_b64_tr_b16 a[24:25], v16 offset:7680
  ds_read_b64_tr_b16 a[26:27], v16 offset:8960
  v_mfma_f32_32x32x16_bf16 v[80:95], a[4:7], a[48:51], v[80:95]
  ds_read_b64_tr_b16 a[28:29], v17 offset:7744
  ds_read_b64_tr_b16 a[30:31], v17 offset:9024
  v_mfma_f32_32x32x16_bf16 v[160:175], a[4:7], a[52:55], v[160:175]
  ds_read_b64_tr_b16 a[32:33], v16 offset:7808
  ds_read_b64_tr_b16 a[34:35], v16 offset:9088
  v_mfma_f32_32x32x16_bf16 v[96:111], a[8:11], a[48:51], v[96:111]
  ds_read_b64_tr_b16 a[36:37], v17 offset:7872
  ds_read_b64_tr_b16 a[38:39], v17 offset:9152
  s_add_u32 m0, m0, 1024
  s_nop 0
  buffer_load_dwordx4 v10, s[12:15], s27 offen lds
  v_mfma_f32_32x32x16_bf16 v[176:191], a[8:11], a[52:55], v[176:191]
  ds_read_b64_tr_b16 a[40:41], v16 offset:7936
  ds_read_b64_tr_b16 a[42:43], v16 offset:9216
  v_mfma_f32_32x32x16_bf16 v[112:127], a[12:15], a[48:51], v[112:127]
  v_mfma_f32_32x32x16_bf16 v[192:207], a[12:15], a[52:55], v[192:207]
  v_mfma_f32_32x32x16_bf16 v[128:143], a[16:19], a[48:51], v[128:143]
  s_add_u32 m0, m0, 1024
  s_nop 0
  buffer_load_dwordx4 v11, s[12:15], s27 offen lds
  v_mfma_f32_32x32x16_bf16 v[208:223], a[16:19], a[52:55], v[208:223]
  s_waitcnt vmcnt(4) lgkmcnt(0)
  s_barrier
  s_add_u32 s30, s30, 24576
  s_cmp_eq_u32 s30, 98304
  s_cselect_b32 s30, 0, s30
  v_add_u32 v16, s30, v14
  v_add_u32 v17, s30, v15
  v_mfma_f32_32x32x16_bf16 v[64:79], a[24:27], a[56:59], v[64:79]
  ds_read_b128 a[48:51], v32 offset:0
  ds_read_b128 a[52:55], v32 offset:4096
  v_mfma_f32_32x32x16_bf16 v[144:159], a[24:27], a[60:63], v[144:159]
  ds_read_b64_tr_b16 a[0:1], v16 offset:0
  ds_read_b64_tr_b16 a[2:3], v16 offset:1280
  v_mfma_f32_32x32x16_bf16 v[80:95], a[28:31], a[56:59], v[80:95]
  ds_read_b64_tr_b16 a[4:5], v17 offset:64
  ds_read_b64_tr_b16 a[6:7], v17 offset:1344
  s_add_u32 m0, m0, 1024
  s_nop 0
  buffer_load_dwordx4 v12, s[12:15], s27 offen lds
  s_add_u32 s27, s27, s28
  s_add_u32 s29, s29, 24576
  s_cmp_eq_u32 s29, 98304
  s_cselect_b32 s29, 0, s29
  v_mfma_f32_32x32x16_bf16 v[160:175], a[28:31], a[60:63], v[160:175]
  ds_read_b64_tr_b16 a[8:9], v16 offset:128
  ds_read_b64_tr_b16 a[10:11], v16 offset:1408
  v_mfma_f32_32x32x16_bf16 v[96:111], a[32:35], a[56:59], v[96:111]
  ds_read_b64_tr_b16 a[12:13], v17 offset:192
  ds_read_b64_tr_b16 a[14:15], v17 offset:1472
  v_mfma_f32_32x32x16_bf16 v[176:191], a[32:35], a[60:63], v[176:191]
  ds_read_b64_tr_b16 a[16:17], v16 offset:256
  ds_read_b64_tr_b16 a[18:19], v16 offset:1536
  v_mfma_f32_32x32x16_bf16 v[112:127], a[36:39], a[56:59], v[112:127]
  v_mfma_f32_32x32x16_bf16 v[192:207], a[36:39], a[60:63], v[192:207]
  v_mfma_f32_32x32x16_bf16 v[128:143], a[40:43], a[56:59], v[128:143]
  v_mfma_f32_32x32x16_bf16 v[208:223], a[40:43], a[60:63], v[208:223]
  s_waitcnt lgkmcnt(0)
  v_mfma_f32_32x32x16_bf16 v[64:79], a[0:3], a[48:51], v[64:79]
  ds_read_b128 a[56:59], v33 offset:0
  ds_read_b128 a[60:63], v33 offset:4096
  s_add_u32 m0, s52, 32768
  s_nop 0
  buffer_load_dwordx4 v24, s[8:11], s26 offen lds
  v_mfma_f32_32x32x16_bf16 v[144:159], a[0:3], a[52:55], v[144:159]
  ds_read_b64_tr_b16 a[24:25], v16 offset:2560
  ds_read_b64_tr_b16 a[26:27], v16 offset:3840
  v_mfma_f32_32x32x16_bf16 v[80:95], a[4:7], a[48:51], v[80:95]
  ds_read_b64_tr_b16 a[28:29], v17 offset:2624
  ds_read_b64_tr_b16 a[30:31], v17 offset:3904
  s_add_u32 m0, s52, 33792
  s_nop 0
  buffer_load_dwordx4 v25, s[8:11], s26 offen lds
  v_mfma_f32_32x32x16_bf16 v[160:175], a[4:7], a[52:55], v[160:175]
  ds_read_b64_tr_b16 a[32:33], v16 offset:2688
  ds_read_b64_tr_b16 a[34:35], v16 offset:3968
  v_mfma_f32_32x32x16_bf16 v[96:111], a[8:11], a[48:51], v[96:111]
  ds_read_b64_tr_b16 a[36:37], v17 offset:2752
  ds_read_b64_tr_b16 a[38:39], v17 offset:4032
  s_add_u32 m0, s52, 34816
  s_nop 0
  buffer_load_dwordx4 v26, s[8:11], s26 offen lds
  v_mfma_f32_32x32x16_bf16 v[176:191], a[8:11], a[52:55], v[176:191]
  ds_read_b64_tr_b16 a[40:41], v16 offset:2816
  ds_read_b64_tr_b16 a[42:43], v16 offset:4096
  v_mfma_f32_32x32x16_bf16 v[112:127], a[12:15], a[48:51], v[112:127]
  s_add_u32 m0, s52, 35840
  s_nop 0
  buffer_load_dwordx4 v27, s[8:11], s26 offen lds
  v_mfma_f32_32x32x16_bf16 v[192:207], a[12:15], a[52:55], v[192:207]
  v_mfma_f32_32x32x16_bf16 v[128:143], a[16:19], a[48:51], v[128:143]
  s_add_u32 m0, s52, 36864
  s_nop 0
  buffer_load_dwordx4 v28, s[8:11], s26 offen lds
  v_mfma_f32_32x32x16_bf16 v[208:223], a[16:19], a[52:55], v[208:223]
  s_waitcnt lgkmcnt(0)
  v_mfma_f32_32x32x16_bf16 v[64:79], a[24:27], a[56:59], v[64:79]
  ds_read_b128 a[48:51], v34 offset:0
  ds_read_b128 a[52:55], v34 offset:4096
  s_add_u32 m0, s52, 37888
  s_nop 0
  buffer_load_dwordx4 v29, s[8:11], s26 offen lds
  v_mfma_f32_32x32x16_bf16 v[144:159], a[24:27], a[60:63], v[144:159]
  ds_read_b64_tr_b16 a[0:1], v16 offset:5120
  ds_read_b64_tr_b16 a[2:3], v16 offset:6400
  v_mfma_f32_32x32x16_bf16 v[80:95], a[28:31], a[56:59], v[80:95]
  ds_read_b64_tr_b16 a[4:5], v17 offset:5184
  ds_read_b64_tr_b16 a[6:7], v17 offset:6464
  s_add_u32 m0, s52, 38912
  s_nop 0
  buffer_load_dwordx4 v30, s[8:11], s26 offen lds
  v_mfma_f32_32x32x16_bf16 v[160:175], a[28:31], a[60:63], v[160:175]
  ds_read_b64_tr_b16 a[8:9], v16 offset:5248
  ds_read_b64_tr_b16 a[10:11], v16 offset:6528
  v_mfma_f32_32x32x16_bf16 v[96:111], a[32:35], a[56:59], v[96:111]
  ds_read_b64_tr_b16 a[12:13], v17 offset:5312
  ds_read_b64_tr_b16 a[14:15], v17 offset:6592
  s_add_u32 m0, s52, 39936
  s_nop 0
  buffer_load_dwordx4 v31, s[8:11], s26 offen lds
  s_add_u32 s26, s26, 128
  v_mfma_f32_32x32x16_bf16 v[176:191], a[32:35], a[60:63], v[176:191]
  ds_read_b64_tr_b16 a[16:17], v16 offset:5376
  ds_read_b64_tr_b16 a[18:19], v16 offset:6656
  v_mfma_f32_32x32x16_bf16 v[112:127], a[36:39], a[56:59], v[112:127]
  s_add_u32 m0, s29, s32
  s_nop 0
  buffer_load_dwordx4 v8, s[12:15], s27 offen lds
  v_mfma_f32_32x32x16_bf16 v[192:207], a[36:39], a[60:63], v[192:207]
  v_mfma_f32_32x32x16_bf16 v[128:143], a[40:43], a[56:59], v[128:143]
  v_mfma_f32_32x32x16_bf16 v[208:223], a[40:43], a[60:63], v[208:223]
  s_waitcnt lgkmcnt(0)
  v_mfma_f32_32x32x16_bf16 v[64:79], a[0:3], a[48:51], v[64:79]
  ds_read_b128 a[56:59], v35 offset:0
  ds_read_b128 a[60:63], v35 offset:4096
  s_add_u32 m0, m0, 1024
  s_nop 0
  buffer_load_dwordx4 v9, s[12:15], s27 offen lds
  v_mfma_f32_32x32x16_bf16 v[144:159], a[0:3], a[52:55], v[144:159]
  ds_read_b64_tr_b16 a[24:25], v16 offset:7680
  ds_read_b64_tr_b16 a[26:27], v16 offset:8960
  v_mfma_f32_32x32x16_bf16 v[80:95], a[4:7], a[48:51], v[80:95]
  ds_read_b64_tr_b16 a[28:29], v17 offset:7744
  ds_read_b64_tr_b16 a[30:31], v17 offset:9024
  v_mfma_f32_32x32x16_bf16 v[160:175], a[4:7], a[52:55], v[160:175]
  ds_read_b64_tr_b16 a[32:33], v16 offset:7808
  ds_read_b64_tr_b16 a[34:35], v16 offset:9088
  v_mfma_f32_32x32x16_bf16 v[96:111], a[8:11], a[48:51], v[96:111]
  ds_read_b64_tr_b16 a[36:37], v17 offset:7872
  ds_read_b64_tr_b16 a[38:39], v17 offset:9152
  s_add_u32 m0, m0, 1024
  s_nop 0
  buffer_load_dwordx4 v10, s[12:15], s27 offen lds
  v_mfma_f32_32x32x16_bf16 v[176:191], a[8:11], a[52:55], v[176:191]
  ds_read_b64_tr_b16 a[40:41], v16 offset:7936
  ds_read_b64_tr_b16 a[42:43], v16 offset:9216
  v_mfma_f32_32x32x16_bf16 v[112:127], a[12:15], a[48:51], v[112:127]
  v_mfma_f32_32x32x16_bf16 v[192:207], a[12:15], a[52:55], v[192:207]
  v_mfma_f32_32x32x16_bf16 v[128:143], a[16:19], a[48:51], v[128:143]
  s_add_u32 m0, m0, 1024
  s_nop 0
  buffer_load_dwordx4 v11, s[12:15], s27 offen lds
  v_mfma_f32_32x32x16_bf16 v[208:223], a[16:19], a[52:55], v[208:223]
  s_waitcnt vmcnt(4) lgkmcnt(0)
  s_barrier
  s_add_u32 s30, s30, 24576
  s_cmp_eq_u32 s30, 98304
  s_cselect_b32 s30, 0, s30
  v_add_u32 v16, s30, v14
  v_add_u32 v17, s30, v15
  v_mfma_f32_32x32x16_bf16 v[64:79], a[24:27], a[56:59], v[64:79]
  ds_read_b128 a[48:51], v32 offset:32768
  ds_read_b128 a[52:55], v32 offset:36864
  v_mfma_f32_32x32x16_bf16 v[144:159], a[24:27], a[60:63], v[144:159]
  ds_read_b64_tr_b16 a[0:1], v16 offset:0
  ds_read_b64_tr_b16 a[2:3], v16 offset:1280
  v_mfma_f32_32x32x16_bf16 v[80:95], a[28:31], a[56:59], v[80:95]
  ds_read_b64_tr_b16 a[4:5], v17 offset:64
  ds_read_b64_tr_b16 a[6:7], v17 offset:1344
  s_add_u32 m0, m0, 1024
  s_nop 0
  buffer_load_dwordx4 v12, s[12:15], s27 offen lds
  s_add_u32 s27, s27, s28
  s_add_u32 s29, s29, 24576
  s_cmp_eq_u32 s29, 98304
  s_cselect_b32 s29, 0, s29
  v_mfma_f32_32x32x16_bf16 v[160:175], a[28:31], a[60:63], v[160:175]
  ds_read_b64_tr_b16 a[8:9], v16 offset:128
  ds_read_b64_tr_b16 a[10:11], v16 offset:1408
  v_mfma_f32_32x32x16_bf16 v[96:111], a[32:35], a[56:59], v[96:111]
  ds_read_b64_tr_b16 a[12:13], v17 offset:192
  ds_read_b64_tr_b16 a[14:15], v17 offset:1472
  v_mfma_f32_32x32x16_bf16 v[176:191], a[32:35], a[60:63], v[176:191]
  ds_read_b64_tr_b16 a[16:17], v16 offset:256
  ds_read_b64_tr_b16 a[18:19], v16 offset:1536
  v_mfma_f32_32x32x16_bf16 v[112:127], a[36:39], a[56:59], v[112:127]
  v_mfma_f32_32x32x16_bf16 v[192:207], a[36:39], a[60:63], v[192:207]
  v_mfma_f32_32x32x16_bf16 v[128:143], a[40:43], a[56:59], v[128:143]
  v_mfma_f32_32x32x16_bf16 v[208:223], a[40:43], a[60:63], v[208:223]
  s_waitcnt lgkmcnt(0)
  v_mfma_f32_32x32x16_bf16 v[64:79], a[0:3], a[48:51], v[64:79]
  ds_read_b128 a[56:59], v33 offset:32768
  ds_read_b128 a[60:63], v33 offset:36864
  s_add_u32 m0, s52, 0
  s_nop 0
  buffer_load_dwordx4 v24, s[8:11], s26 offen lds
  v_mfma_f32_32x32x16_bf16 v[144:159], a[0:3], a[52:55], v[144:159]
  ds_read_b64_tr_b16 a[24:25], v16 offset:2560
  ds_read_b64_tr_b16 a[26:27], v16 offset:3840
  v_mfma_f32_32x32x16_bf16 v[80:95], a[4:7], a[48:51], v[80:95]
  ds_read_b64_tr_b16 a[28:29], v17 offset:2624
  ds_read_b64_tr_b16 a[30:31], v17 offset:3904
  s_add_u32 m0, s52, 1024
  s_nop 0
  buffer_load_dwordx4 v25, s[8:11], s26 offen lds
  v_mfma_f32_32x32x16_bf16 v[160:175], a[4:7], a[52:55], v[160:175]
  ds_read_b64_tr_b16 a[32:33], v16 offset:2688
  ds_read_b64_tr_b16 a[34:35], v16 offset:3968
  v_mfma_f32_32x32x16_bf16 v[96:111], a[8:11], a[48:51], v[96:111]
  ds_read_b64_tr_b16 a[36:37], v17 offset:2752
  ds_read_b64_tr_b16 a[38:39], v17 offset:4032
  s_add_u32 m0, s52, 2048
  s_nop 0
  buffer_load_dwordx4 v26, s[8:11], s26 offen lds
  v_mfma_f32_32x32x16_bf16 v[176:191], a[8:11], a[52:55], v[176:191]
  ds_read_b64_tr_b16 a[40:41], v16 offset:2816
  ds_read_b64_tr_b16 a[42:43], v16 offset:4096
  v_mfma_f32_32x32x16_bf16 v[112:127], a[12:15], a[48:51], v[112:127]
  s_add_u32 m0, s52, 3072
  s_nop 0
  buffer_load_dwordx4 v27, s[8:11], s26 offen lds
  v_mfma_f32_32x32x16_bf16 v[192:207], a[12:15], a[52:55], v[192:207]
  v_mfma_f32_32x32x16_bf16 v[128:143], a[16:19], a[48:51], v[128:143]
  s_add_u32 m0, s52, 4096
  s_nop 0
  buffer_load_dwordx4 v28, s[8:11], s26 offen lds
  v_mfma_f32_32x32x16_bf16 v[208:223], a[16:19], a[52:55], v[208:223]
  s_waitcnt lgkmcnt(0)
  v_mfma_f32_32x32x16_bf16 v[64:79], a[24:27], a[56:59], v[64:79]
  ds_read_b128 a[48:51], v34 offset:32768
  ds_read_b128 a[52:55], v34 offset:36864
  s_add_u32 m0, s52, 5120
  s_nop 0
  buffer_load_dwordx4 v29, s[8:11], s26 offen lds
  v_mfma_f32_32x32x16_bf16 v[144:159], a[24:27], a[60:63], v[144:159]
  ds_read_b64_tr_b16 a[0:1], v16 offset:5120
  ds_read_b64_tr_b16 a[2:3], v16 offset:6400
  v_mfma_f32_32x32x16_bf16 v[80:95], a[28:31], a[56:59], v[80:95]
  ds_read_b64_tr_b16 a[4:5], v17 offset:5184
  ds_read_b64_tr_b16 a[6:7], v17 offset:6464
  s_add_u32 m0, s52, 6144
  s_nop 0
  buffer_load_dwordx4 v30, s[8:11], s26 offen lds
  v_mfma_f32_32x32x16_bf16 v[160:175], a[28:31], a[60:63], v[160:175]
  ds_read_b64_tr_b16 a[8:9], v16 offset:5248
  ds_read_b64_tr_b16 a[10:11], v16 offset:6528
  v_mfma_f32_32x32x16_bf16 v[96:111], a[32:35], a[56:59], v[96:111]
  ds_read_b64_tr_b16 a[12:13], v17 offset:5312
  ds_read_b64_tr_b16 a[14:15], v17 offset:6592
  s_add_u32 m0, s52, 7168
  s_nop 0
  buffer_load_dwordx4 v31, s[8:11], s26 offen lds
  s_add_u32 s26, s26, 128
  v_mfma_f32_32x32x16_bf16 v[176:191], a[32:35], a[60:63], v[176:191]
  ds_read_b64_tr_b16 a[16:17], v16 offset:5376
  ds_read_b64_tr_b16 a[18:19], v16 offset:6656
  v_mfma_f32_32x32x16_bf16 v[112:127], a[36:39], a[56:59], v[112:127]
  s_add_u32 m0, s29, s32
  s_nop 0
  buffer_load_dwordx4 v8, s[12:15], s27 offen lds
  v_mfma_f32_32x32x16_bf16 v[192:207], a[36:39], a[60:63], v[192:207]
  v_mfma_f32_32x32x16_bf16 v[128:143], a[40:43], a[56:59], v[128:143]
  v_mfma_f32_32x32x16_bf16 v[208:223], a[40:43], a[60:63], v[208:223]
  s_waitcnt lgkmcnt(0)
  v_mfma_f32_32x32x16_bf16 v[64:79], a[0:3], a[48:51], v[64:79]
  ds_read_b128 a[56:59], v35 offset:32768
  ds_read_b128 a[60:63], v35 offset:36864
  s_add_u32 m0, m0, 1024
  s_nop 0
  buffer_load_dwordx4 v9, s[12:15], s27 offen lds
  v_mfma_f32_32x32x16_bf16 v[144:159], a[0:3], a[52:55], v[144:159]
  ds_read_b64_tr_b16 a[24:25], v16 offset:7680
  ds_read_b64_tr_b16 a[26:27], v16 offset:8960
  v_mfma_f32_32x32x16_bf16 v[80:95], a[4:7], a[48:51], v[80:95]
  ds_read_b64_tr_b16 a[28:29], v17 offset:7744
  ds_read_b64_tr_b16 a[30:31], v17 offset:9024
  v_mfma_f32_32x32x16_bf16 v[160:175], a[4:7], a[52:55], v[160:175]
  ds_read_b64_tr_b16 a[32:33], v16 offset:7808
  ds_read_b64_tr_b16 a[34:35], v16 offset:9088
  v_mfma_f32_32x32x16_bf16 v[96:111], a[8:11], a[48:51], v[96:111]
  ds_read_b64_tr_b16 a[36:37], v17 offset:7872
  ds_read_b64_tr_b16 a[38:39], v17 offset:9152
  s_add_u32 m0, m0, 1024
  s_nop 0
  buffer_load_dwordx4 v10, s[12:15], s27 offen lds
  v_mfma_f32_32x32x16_bf16 v[176:191], a[8:11], a[52:55], v[176:191]
  ds_read_b64_tr_b16 a[40:41], v16 offset:7936
  ds_read_b64_tr_b16 a[42:43], v16 offset:9216
  v_mfma_f32_32x32x16_bf16 v[112:127], a[12:15], a[48:51], v[112:127]
  v_mfma_f32_32x32x16_bf16 v[192:207], a[12:15], a[52:55], v[192:207]
  v_mfma_f32_32x32x16_bf16 v[128:143], a[16:19], a[48:51], v[128:143]
  s_add_u32 m0, m0, 1024
  s_nop 0
  buffer_load_dwordx4 v11, s[12:15], s27 offen lds
  v_mfma_f32_32x32x16_bf16 v[208:223], a[16:19], a[52:55], v[208:223]
  s_waitcnt vmcnt(4) lgkmcnt(0)
  s_barrier
  s_add_u32 s30, s30, 24576
  s_cmp_eq_u32 s30, 98304
  s_cselect_b32 s30, 0, s30
  v_add_u32 v16, s30, v14
  v_add_u32 v17, s30, v15
  v_mfma_f32_32x32x16_bf16 v[64:79], a[24:27], a[56:59], v[64:79]
  ds_read_b128 a[48:51], v32 offset:0
  ds_read_b128 a[52:55], v32 offset:4096
  v_mfma_f32_32x32x16_bf16 v[144:159], a[24:27], a[60:63], v[144:159]
  ds_read_b64_tr_b16 a[0:1], v16 offset:0
  ds_read_b64_tr_b16 a[2:3], v16 offset:1280
  v_mfma_f32_32x32x16_bf16 v[80:95], a[28:31], a[56:59], v[80:95]
  ds_read_b64_tr_b16 a[4:5], v17 offset:64
  ds_read_b64_tr_b16 a[6:7], v17 offset:1344
  s_add_u32 m0, m0, 1024
  s_nop 0
  buffer_load_dwordx4 v12, s[12:15], s27 offen lds
  s_add_u32 s27, s27, s28
  s_add_u32 s29, s29, 24576
  s_cmp_eq_u32 s29, 98304
  s_cselect_b32 s29, 0, s29
  v_mfma_f32_32x32x16_bf16 v[160:175], a[28:31], a[60:63], v[160:175]
  ds_read_b64_tr_b16 a[8:9], v16 offset:128
  ds_read_b64_tr_b16 a[10:11], v16 offset:1408
  v_mfma_f32_32x32x16_bf16 v[96:111], a[32:35], a[56:59], v[96:111]
  ds_read_b64_tr_b16 a[12:13], v17 offset:192
  ds_read_b64_tr_b16 a[14:15], v17 offset:1472
  v_mfma_f32_32x32x16_bf16 v[176:191], a[32:35], a[60:63], v[176:191]
  ds_read_b64_tr_b16 a[16:17], v16 offset:256
  ds_read_b64_tr_b16 a[18:19], v16 offset:1536
  v_mfma_f32_32x32x16_bf16 v[112:127], a[36:39], a[56:59], v[112:127]
  v_mfma_f32_32x32x16_bf16 v[192:207], a[36:39], a[60:63], v[192:207]
  v_mfma_f32_32x32x16_bf16 v[128:143], a[40:43], a[56:59], v[128:143]
  v_mfma_f32_32x32x16_bf16 v[208:223], a[40:43], a[60:63], v[208:223]
  s_waitcnt lgkmcnt(0)
  v_mfma_f32_32x32x16_bf16 v[64:79], a[0:3], a[48:51], v[64:79]
  ds_read_b128 a[56:59], v33 offset:0
  ds_read_b128 a[60:63], v33 offset:4096
  s_add_u32 m0, s52, 32768
  s_nop 0
  buffer_load_dwordx4 v24, s[8:11], s26 offen lds
  v_mfma_f32_32x32x16_bf16 v[144:159], a[0:3], a[52:55], v[144:159]
  ds_read_b64_tr_b16 a[24:25], v16 offset:2560
  ds_read_b64_tr_b16 a[26:27], v16 offset:3840
  v_mfma_f32_32x32x16_bf16 v[80:95], a[4:7], a[48:51], v[80:95]
  ds_read_b64_tr_b16 a[28:29], v17 offset:2624
  ds_read_b64_tr_b16 a[30:31], v17 offset:3904
  s_add_u32 m0, s52, 33792
  s_nop 0
  buffer_load_dwordx4 v25, s[8:11], s26 offen lds
  v_mfma_f32_32x32x16_bf16 v[160:175], a[4:7], a[52:55], v[160:175]
  ds_read_b64_tr_b16 a[32:33], v16 offset:2688
  ds_read_b64_tr_b16 a[34:35], v16 offset:3968
  v_mfma_f32_32x32x16_bf16 v[96:111], a[8:11], a[48:51], v[96:111]
  ds_read_b64_tr_b16 a[36:37], v17 offset:2752
  ds_read_b64_tr_b16 a[38:39], v17 offset:4032
  s_add_u32 m0, s52, 34816
  s_nop 0
  buffer_load_dwordx4 v26, s[8:11], s26 offen lds
  v_mfma_f32_32x32x16_bf16 v[176:191], a[8:11], a[52:55], v[176:191]
  ds_read_b64_tr_b16 a[40:41], v16 offset:2816
  ds_read_b64_tr_b16 a[42:43], v16 offset:4096
  v_mfma_f32_32x32x16_bf16 v[112:127], a[12:15], a[48:51], v[112:127]
  s_add_u32 m0, s52, 35840
  s_nop 0
  buffer_load_dwordx4 v27, s[8:11], s26 offen lds
  v_mfma_f32_32x32x16_bf16 v[192:207], a[12:15], a[52:55], v[192:207]
  v_mfma_f32_32x32x16_bf16 v[128:143], a[16:19], a[48:51], v[128:143]
  s_add_u32 m0, s52, 36864
  s_nop 0
  buffer_load_dwordx4 v28, s[8:11], s26 offen lds
  v_mfma_f32_32x32x16_bf16 v[208:223], a[16:19], a[52:55], v[208:223]
  s_waitcnt lgkmcnt(0)
  v_mfma_f32_32x32x16_bf16 v[64:79], a[24:27], a[56:59], v[64:79]
  ds_read_b128 a[48:51], v34 offset:0
  ds_read_b128 a[52:55], v34 offset:4096
  s_add_u32 m0, s52, 37888
  s_nop 0
  buffer_load_dwordx4 v29, s[8:11], s26 offen lds
  v_mfma_f32_32x32x16_bf16 v[144:159], a[24:27], a[60:63], v[144:159]
  ds_read_b64_tr_b16 a[0:1], v16 offset:5120
  ds_read_b64_tr_b16 a[2:3], v16 offset:6400
  v_mfma_f32_32x32x16_bf16 v[80:95], a[28:31], a[56:59], v[80:95]
  ds_read_b64_tr_b16 a[4:5], v17 offset:5184
  ds_read_b64_tr_b16 a[6:7], v17 offset:6464
  s_add_u32 m0, s52, 38912
  s_nop 0
  buffer_load_dwordx4 v30, s[8:11], s26 offen lds
  v_mfma_f32_32x32x16_bf16 v[160:175], a[28:31], a[60:63], v[160:175]
  ds_read_b64_tr_b16 a[8:9], v16 offset:5248
  ds_read_b64_tr_b16 a[10:11], v16 offset:6528
  v_mfma_f32_32x32x16_bf16 v[96:111], a[32:35], a[56:59], v[96:111]
  ds_read_b64_tr_b16 a[12:13], v17 offset:5312
  ds_read_b64_tr_b16 a[14:15], v17 offset:6592
  s_add_u32 m0, s52, 39936
  s_nop 0
  buffer_load_dwordx4 v31, s[8:11], s26 offen lds
  s_add_u32 s26, s26, 128
  v_mfma_f32_32x32x16_bf16 v[176:191], a[32:35], a[60:63], v[176:191]
  ds_read_b64_tr_b16 a[16:17], v16 offset:5376
  ds_read_b64_tr_b16 a[18:19], v16 offset:6656
  v_mfma_f32_32x32x16_bf16 v[112:127], a[36:39], a[56:59], v[112:127]
  v_mfma_f32_32x32x16_bf16 v[192:207], a[36:39], a[60:63], v[192:207]
  v_mfma_f32_32x32x16_bf16 v[128:143], a[40:43], a[56:59], v[128:143]
  v_mfma_f32_32x32x16_bf16 v[208:223], a[40:43], a[60:63], v[208:223]
  s_waitcnt lgkmcnt(0)
  v_mfma_f32_32x32x16_bf16 v[64:79], a[0:3], a[48:51], v[64:79]
  ds_read_b128 a[56:59], v35 offset:0
  ds_read_b128 a[60:63], v35 offset:4096
  v_mfma_f32_32x32x16_bf16 v[144:159], a[0:3], a[52:55], v[144:159]
  ds_read_b64_tr_b16 a[24:25], v16 offset:7680
  ds_read_b64_tr_b16 a[26:27], v16 offset:8960
  v_mfma_f32_32x32x16_bf16 v[80:95], a[4:7], a[48:51], v[80:95]
  ds_read_b64_tr_b16 a[28:29], v17 offset:7744
  ds_read_b64_tr_b16 a[30:31], v17 offset:9024
  v_mfma_f32_32x32x16_bf16 v[160:175], a[4:7], a[52:55], v[160:175]
  ds_read_b64_tr_b16 a[32:33], v16 offset:7808
  ds_read_b64_tr_b16 a[34:35], v16 offset:9088
  v_mfma_f32_32x32x16_bf16 v[96:111], a[8:11], a[48:51], v[96:111]
  ds_read_b64_tr_b16 a[36:37], v17 offset:7872
  ds_read_b64_tr_b16 a[38:39], v17 offset:9152
  v_mfma_f32_32x32x16_bf16 v[176:191], a[8:11], a[52:55], v[176:191]
  ds_read_b64_tr_b16 a[40:41], v16 offset:7936
  ds_read_b64_tr_b16 a[42:43], v16 offset:9216
  v_mfma_f32_32x32x16_bf16 v[112:127], a[12:15], a[48:51], v[112:127]
  v_mfma_f32_32x32x16_bf16 v[192:207], a[12:15], a[52:55], v[192:207]
  v_mfma_f32_32x32x16_bf16 v[128:143], a[16:19], a[48:51], v[128:143]
  v_mfma_f32_32x32x16_bf16 v[208:223], a[16:19], a[52:55], v[208:223]
  s_waitcnt vmcnt(0) lgkmcnt(0)
  s_barrier
  s_add_u32 s30, s30, 24576
  s_cmp_eq_u32 s30, 98304
  s_cselect_b32 s30, 0, s30
  v_add_u32 v16, s30, v14
  v_add_u32 v17, s30, v15
  v_mfma_f32_32x32x16_bf16 v[64:79], a[24:27], a[56:59], v[64:79]
  ds_read_b128 a[48:51], v32 offset:32768
  ds_read_b128 a[52:55], v32 offset:36864
  v_mfma_f32_32x32x16_bf16 v[144:159], a[24:27], a[60:63], v[144:159]
  ds_read_b64_tr_b16 a[0:1], v16 offset:0
  ds_read_b64_tr_b16 a[2:3], v16 offset:1280
  v_mfma_f32_32x32x16_bf16 v[80:95], a[28:31], a[56:59], v[80:95]
  ds_read_b64_tr_b16 a[4:5], v17 offset:64
  ds_read_b64_tr_b16 a[6:7], v17 offset:1344
  v_mfma_f32_32x32x16_bf16 v[160:175], a[28:31], a[60:63], v[160:175]
  ds_read_b64_tr_b16 a[8:9], v16 offset:128
  ds_read_b64_tr_b16 a[10:11], v16 offset:1408
  v_mfma_f32_32x32x16_bf16 v[96:111], a[32:35], a[56:59], v[96:111]
  ds_read_b64_tr_b16 a[12:13], v17 offset:192
  ds_read_b64_tr_b16 a[14:15], v17 offset:1472
  v_mfma_f32_32x32x16_bf16 v[176:191], a[32:35], a[60:63], v[176:191]
  ds_read_b64_tr_b16 a[16:17], v16 offset:256
  ds_read_b64_tr_b16 a[18:19], v16 offset:1536
  v_mfma_f32_32x32x16_bf16 v[112:127], a[36:39], a[56:59], v[112:127]
  v_mfma_f32_32x32x16_bf16 v[192:207], a[36:39], a[60:63], v[192:207]
  v_mfma_f32_32x32x16_bf16 v[128:143], a[40:43], a[56:59], v[128:143]
  v_mfma_f32_32x32x16_bf16 v[208:223], a[40:43], a[60:63], v[208:223]
  s_waitcnt lgkmcnt(0)
  v_mfma_f32_32x32x16_bf16 v[64:79], a[0:3], a[48:51], v[64:79]
  ds_read_b128 a[56:59], v33 offset:32768
  ds_read_b128 a[60:63], v33 offset:36864
  v_mfma_f32_32x32x16_bf16 v[144:159], a[0:3], a[52:55], v[144:159]
  ds_read_b64_tr_b16 a[24:25], v16 offset:2560
  ds_read_b64_tr_b16 a[26:27], v16 offset:3840
  v_mfma_f32_32x32x16_bf16 v[80:95], a[4:7], a[48:51], v[80:95]
  ds_read_b64_tr_b16 a[28:29], v17 offset:2624
  ds_read_b64_tr_b16 a[30:31], v17 offset:3904
  v_mfma_f32_32x32x16_bf16 v[160:175], a[4:7], a[52:55], v[160:175]
  ds_read_b64_tr_b16 a[32:33], v16 offset:2688
  ds_read_b64_tr_b16 a[34:35], v16 offset:3968
  v_mfma_f32_32x32x16_bf16 v[96:111], a[8:11], a[48:51], v[96:111]
  ds_read_b64_tr_b16 a[36:37], v17 offset:2752
  ds_read_b64_tr_b16 a[38:39], v17 offset:4032
  v_mfma_f32_32x32x16_bf16 v[176:191], a[8:11], a[52:55], v[176:191]
  ds_read_b64_tr_b16 a[40:41], v16 offset:2816
  ds_read_b64_tr_b16 a[42:43], v16 offset:4096
  v_mfma_f32_32x32x16_bf16 v[112:127], a[12:15], a[48:51], v[112:127]
  v_mfma_f32_32x32x16_bf16 v[192:207], a[12:15], a[52:55], v[192:207]
  v_mfma_f32_32x32x16_bf16 v[128:143], a[16:19], a[48:51], v[128:143]
  v_mfma_f32_32x32x16_bf16 v[208:223], a[16:19], a[52:55], v[208:223]
  s_waitcnt lgkmcnt(0)
  v_mfma_f32_32x32x16_bf16 v[64:79], a[24:27], a[56:59], v[64:79]
  ds_read_b128 a[48:51], v34 offset:32768
  ds_read_b128 a[52:55], v34 offset:36864
  v_mfma_f32_32x32x16_bf16 v[144:159], a[24:27], a[60:63], v[144:159]
  ds_read_b64_tr_b16 a[0:1], v16 offset:5120
  ds_read_b64_tr_b16 a[2:3], v16 offset:6400
  v_mfma_f32_32x32x16_bf16 v[80:95], a[28:31], a[56:59], v[80:95]
  ds_read_b64_tr_b16 a[4:5], v17 offset:5184
  ds_read_b64_tr_b16 a[6:7], v17 offset:6464
  v_mfma_f32_32x32x16_bf16 v[160:175], a[28:31], a[60:63], v[160:175]
  ds_read_b64_tr_b16 a[8:9], v16 offset:5248
  ds_read_b64_tr_b16 a[10:11], v16 offset:6528
  v_mfma_f32_32x32x16_bf16 v[96:111], a[32:35], a[56:59], v[96:111]
  ds_read_b64_tr_b16 a[12:13], v17 offset:5312
  ds_read_b64_tr_b16 a[14:15], v17 offset:6592
  v_mfma_f32_32x32x16_bf16 v[176:191], a[32:35], a[60:63], v[176:191]
  ds_read_b64_tr_b16 a[16:17], v16 offset:5376
  ds_read_b64_tr_b16 a[18:19], v16 offset:6656
  v_mfma_f32_32x32x16_bf16 v[112:127], a[36:39], a[56:59], v[112:127]
  v_mfma_f32_32x32x16_bf16 v[192:207], a[36:39], a[60:63], v[192:207]
  v_mfma_f32_32x32x16_bf16 v[128:143], a[40:43], a[56:59], v[128:143]
  v_mfma_f32_32x32x16_bf16 v[208:223], a[40:43], a[60:63], v[208:223]
  s_waitcnt lgkmcnt(0)
  v_mfma_f32_32x32x16_bf16 v[64:79], a[0:3], a[48:51], v[64:79]
  ds_read_b128 a[56:59], v35 offset:32768
  ds_read_b128 a[60:63], v35 offset:36864
  v_mfma_f32_32x32x16_bf16 v[144:159], a[0:3], a[52:55], v[144:159]
  ds_read_b64_tr_b16 a[24:25], v16 offset:7680
  ds_read_b64_tr_b16 a[26:27], v16 offset:8960
  v_mfma_f32_32x32x16_bf16 v[80:95], a[4:7], a[48:51], v[80:95]
  ds_read_b64_tr_b16 a[28:29], v17 offset:7744
  ds_read_b64_tr_b16 a[30:31], v17 offset:9024
  v_mfma_f32_32x32x16_bf16 v[160:175], a[4:7], a[52:55], v[160:175]
  ds_read_b64_tr_b16 a[32:33], v16 offset:7808
  ds_read_b64_tr_b16 a[34:35], v16 offset:9088
  v_mfma_f32_32x32x16_bf16 v[96:111], a[8:11], a[48:51], v[96:111]
  ds_read_b64_tr_b16 a[36:37], v17 offset:7872
  ds_read_b64_tr_b16 a[38:39], v17 offset:9152
  v_mfma_f32_32x32x16_bf16 v[176:191], a[8:11], a[52:55], v[176:191]
  ds_read_b64_tr_b16 a[40:41], v16 offset:7936
  ds_read_b64_tr_b16 a[42:43], v16 offset:9216
  v_mfma_f32_32x32x16_bf16 v[112:127], a[12:15], a[48:51], v[112:127]
  v_mfma_f32_32x32x16_bf16 v[192:207], a[12:15], a[52:55], v[192:207]
  v_mfma_f32_32x32x16_bf16 v[128:143], a[16:19], a[48:51], v[128:143]
  v_mfma_f32_32x32x16_bf16 v[208:223], a[16:19], a[52:55], v[208:223]
  s_waitcnt lgkmcnt(0)
  v_mfma_f32_32x32x16_bf16 v[64:79], a[24:27], a[56:59], v[64:79]
  v_mfma_f32_32x32x16_bf16 v[144:159], a[24:27], a[60:63], v[144:159]
  v_mfma_f32_32x32x16_bf16 v[80:95], a[28:31], a[56:59], v[80:95]
  v_mfma_f32_32x32x16_bf16 v[160:175], a[28:31], a[60:63], v[160:175]
  v_mfma_f32_32x32x16_bf16 v[96:111], a[32:35], a[56:59], v[96:111]
  v_mfma_f32_32x32x16_bf16 v[176:191], a[32:35], a[60:63], v[176:191]
  v_mfma_f32_32x32x16_bf16 v[112:127], a[36:39], a[56:59], v[112:127]
  v_mfma_f32_32x32x16_bf16 v[192:207], a[36:39], a[60:63], v[192:207]
  v_mfma_f32_32x32x16_bf16 v[128:143], a[40:43], a[56:59], v[128:143]
  v_mfma_f32_32x32x16_bf16 v[208:223], a[40:43], a[60:63], v[208:223]
  v_and_b32 v4, 31, v1
  s_lshl_b32 s25, s24, 6
  v_add_u32 v4, s25, v4
  v_mul_u32_u24 v4, 2560, v4
  v_lshrrev_b32 v5, 5, v1
  v_lshl_add_u32 v4, v5, 4, v4
  v_add_u32 v5, 81920, v4
  s_nop 3
  v_cvt_pk_bf16_f32 v40, v64, v65
  v_cvt_pk_bf16_f32 v41, v66, v67
  v_cvt_pk_bf16_f32 v42, v68, v69
  v_cvt_pk_bf16_f32 v43, v70, v71
  s_nop 1
  v_permlane32_swap_b32 v40, v42
  v_permlane32_swap_b32 v41, v43
  buffer_store_dwordx4 v[40:43], v4, s[20:23], s31 offen offset:0
  v_cvt_pk_bf16_f32 v44, v72, v73
  v_cvt_pk_bf16_f32 v45, v74, v75
  v_cvt_pk_bf16_f32 v46, v76, v77
  v_cvt_pk_bf16_f32 v47, v78, v79
  s_nop 1
  v_permlane32_swap_b32 v44, v46
  v_permlane32_swap_b32 v45, v47
  buffer_store_dwordx4 v[44:47], v4, s[20:23], s31 offen offset:32
  v_cvt_pk_bf16_f32 v48, v80, v81
  v_cvt_pk_bf16_f32 v49, v82, v83
  v_cvt_pk_bf16_f32 v50, v84, v85
  v_cvt_pk_bf16_f32 v51, v86, v87
  s_nop 1
  v_permlane32_swap_b32 v48, v50
  v_permlane32_swap_b32 v49, v51
  buffer_store_dwordx4 v[48:51], v4, s[20:23], s31 offen offset:64
  v_cvt_pk_bf16_f32 v52, v88, v89
  v_cvt_pk_bf16_f32 v53, v90, v91
  v_cvt_pk_bf16_f32 v54, v92, v93
  v_cvt_pk_bf16_f32 v55, v94, v95
  s_nop 1
  v_permlane32_swap_b32 v52, v54
  v_permlane32_swap_b32 v53, v55
  buffer_store_dwordx4 v[52:55], v4, s[20:23], s31 offen offset:96
  v_cvt_pk_bf16_f32 v56, v96, v97
  v_cvt_pk_bf16_f32 v57, v98, v99
  v_cvt_pk_bf16_f32 v58, v100, v101
  v_cvt_pk_bf16_f32 v59, v102, v103
  s_nop 1
  v_permlane32_swap_b32 v56, v58
  v_permlane32_swap_b32 v57, v59
  buffer_store_dwordx4 v[56:59], v4, s[20:23], s31 offen offset:128
  v_cvt_pk_bf16_f32 v60, v104, v105
  v_cvt_pk_bf16_f32 v61, v106, v107
  v_cvt_pk_bf16_f32 v62, v108, v109
  v_cvt_pk_bf16_f32 v63, v110, v111
  s_nop 1
  v_permlane32_swap_b32 v60, v62
  v_permlane32_swap_b32 v61, v63
  buffer_store_dwordx4 v[60:63], v4, s[20:23], s31 offen offset:160
  v_cvt_pk_bf16_f32 v40, v112, v113
  v_cvt_pk_bf16_f32 v41, v114, v115
  v_cvt_pk_bf16_f32 v42, v116, v117
  v_cvt_pk_bf16_f32 v43, v118, v119
  s_nop 1
  v_permlane32_swap_b32 v40, v42
  v_permlane32_swap_b32 v41, v43
  buffer_store_dwordx4 v[40:43], v4, s[20:23], s31 offen offset:192
  v_cvt_pk_bf16_f32 v44, v120, v121
  v_cvt_pk_bf16_f32 v45, v122, v123
  v_cvt_pk_bf16_f32 v46, v124, v125
  v_cvt_pk_bf16_f32 v47, v126, v127
  s_nop 1
  v_permlane32_swap_b32 v44, v46
  v_permlane32_swap_b32 v45, v47
  buffer_store_dwordx4 v[44:47], v4, s[20:23], s31 offen offset:224
  v_cvt_pk_bf16_f32 v48, v128, v129
  v_cvt_pk_bf16_f32 v49, v130, v131
  v_cvt_pk_bf16_f32 v50, v132, v133
  v_cvt_pk_bf16_f32 v51, v134, v135
  s_nop 1
  v_permlane32_swap_b32 v48, v50
  v_permlane32_swap_b32 v49, v51
  buffer_store_dwordx4 v[48:51], v4, s[20:23], s31 offen offset:256
  v_cvt_pk_bf16_f32 v52, v136, v137
  v_cvt_pk_bf16_f32 v53, v138, v139
  v_cvt_pk_bf16_f32 v54, v140, v141
  v_cvt_pk_bf16_f32 v55, v142, v143
  s_nop 1
  v_permlane32_swap_b32 v52, v54
  v_permlane32_swap_b32 v53, v55
  buffer_store_dwordx4 v[52:55], v4, s[20:23], s31 offen offset:288
  v_cvt_pk_bf16_f32 v56, v144, v145
  v_cvt_pk_bf16_f32 v57, v146, v147
  v_cvt_pk_bf16_f32 v58, v148, v149
  v_cvt_pk_bf16_f32 v59, v150, v151
  s_nop 1
  v_permlane32_swap_b32 v56, v58
  v_permlane32_swap_b32 v57, v59
  buffer_store_dwordx4 v[56:59], v5, s[20:23], s31 offen offset:0
  v_cvt_pk_bf16_f32 v60, v152, v153
  v_cvt_pk_bf16_f32 v61, v154, v155
  v_cvt_pk_bf16_f32 v62, v156, v157
  v_cvt_pk_bf16_f32 v63, v158, v159
  s_nop 1
  v_permlane32_swap_b32 v60, v62
  v_permlane32_swap_b32 v61, v63
  buffer_store_dwordx4 v[60:63], v5, s[20:23], s31 offen offset:32
  v_cvt_pk_bf16_f32 v40, v160, v161
  v_cvt_pk_bf16_f32 v41, v162, v163
  v_cvt_pk_bf16_f32 v42, v164, v165
  v_cvt_pk_bf16_f32 v43, v166, v167
  s_nop 1
  v_permlane32_swap_b32 v40, v42
  v_permlane32_swap_b32 v41, v43
  buffer_store_dwordx4 v[40:43], v5, s[20:23], s31 offen offset:64
  v_cvt_pk_bf16_f32 v44, v168, v169
  v_cvt_pk_bf16_f32 v45, v170, v171
  v_cvt_pk_bf16_f32 v46, v172, v173
  v_cvt_pk_bf16_f32 v47, v174, v175
  s_nop 1
  v_permlane32_swap_b32 v44, v46
  v_permlane32_swap_b32 v45, v47
  buffer_store_dwordx4 v[44:47], v5, s[20:23], s31 offen offset:96
  v_cvt_pk_bf16_f32 v48, v176, v177
  v_cvt_pk_bf16_f32 v49, v178, v179
  v_cvt_pk_bf16_f32 v50, v180, v181
  v_cvt_pk_bf16_f32 v51, v182, v183
  s_nop 1
  v_permlane32_swap_b32 v48, v50
  v_permlane32_swap_b32 v49, v51
  buffer_store_dwordx4 v[48:51], v5, s[20:23], s31 offen offset:128
  v_cvt_pk_bf16_f32 v52, v184, v185
  v_cvt_pk_bf16_f32 v53, v186, v187
  v_cvt_pk_bf16_f32 v54, v188, v189
  v_cvt_pk_bf16_f32 v55, v190, v191
  s_nop 1
  v_permlane32_swap_b32 v52, v54
  v_permlane32_swap_b32 v53, v55
  buffer_store_dwordx4 v[52:55], v5, s[20:23], s31 offen offset:160
  v_cvt_pk_bf16_f32 v56, v192, v193
  v_cvt_pk_bf16_f32 v57, v194, v195
  v_cvt_pk_bf16_f32 v58, v196, v197
  v_cvt_pk_bf16_f32 v59, v198, v199
  s_nop 1
  v_permlane32_swap_b32 v56, v58
  v_permlane32_swap_b32 v57, v59
  buffer_store_dwordx4 v[56:59], v5, s[20:23], s31 offen offset:192
  v_cvt_pk_bf16_f32 v60, v200, v201
  v_cvt_pk_bf16_f32 v61, v202, v203
  v_cvt_pk_bf16_f32 v62, v204, v205
  v_cvt_pk_bf16_f32 v63, v206, v207
  s_nop 1
  v_permlane32_swap_b32 v60, v62
  v_permlane32_swap_b32 v61, v63
  buffer_store_dwordx4 v[60:63], v5, s[20:23], s31 offen offset:224
  v_cvt_pk_bf16_f32 v40, v208, v209
  v_cvt_pk_bf16_f32 v41, v210, v211
  v_cvt_pk_bf16_f32 v42, v212, v213
  v_cvt_pk_bf16_f32 v43, v214, v215
  s_nop 1
  v_permlane32_swap_b32 v40, v42
  v_permlane32_swap_b32 v41, v43
  buffer_store_dwordx4 v[40:43], v5, s[20:23], s31 offen offset:256
  v_cvt_pk_bf16_f32 v44, v216, v217
  v_cvt_pk_bf16_f32 v45, v218, v219
  v_cvt_pk_bf16_f32 v46, v220, v221
  v_cvt_pk_bf16_f32 v47, v222, v223
  s_nop 1
  v_permlane32_swap_b32 v44, v46
  v_permlane32_swap_b32 v45, v47
  buffer_store_dwordx4 v[44:47], v5, s[20:23], s31 offen offset:288
  s_barrier
  s_branch W_next
W_w:
  s_lshl_b32 s25, s45, 7
  s_add_u32 s25, s25, 6324224
  s_mov_b64 exec, 1
W_wp:
  buffer_load_dword v2, off, s[8:11], s25 sc1
  s_sub_u32 s82, s82, 1
  s_cbranch_scc1 W_abort
  s_waitcnt vmcnt(0)
  v_readfirstlane_b32 s30, v2
  s_add_u32 s30, s30, 1
  s_cmp_ge_u32 s30, s44
  s_cbranch_scc1 W_wp_ok
  s_add_u32 s30, s30, 1
  s_sleep 16
  s_cmp_ge_u32 s30, s44
  s_cbranch_scc1 W_wp
  s_sleep 48
  s_branch W_wp
W_wp_ok:
  s_mov_b64 exec, -1
  s_branch W_next
W_tp:
  s_lshl_b32 s46, s45, 2
  s_add_u32 s46, s46, s24
  s_lshl_b32 s47, s44, 5
  s_add_u32 s47, s47, s46
  s_lshr_b32 s25, s44, 3
  s_lshl_b32 s25, s25, 5
  s_add_u32 s25, s25, s46
  s_lshl_b32 s25, s25, 4
  s_add_u32 s26, s25, 6344704
  s_add_u32 s25, s25, 6336512
  v_min_u32 v3, 1, v1
  v_lshlrev_b32 v3, 2, v3
W_k_61:
  buffer_load_dword v2, v3, s[8:11], s25 offen offset:0 sc1
  s_sub_u32 s82, s82, 1
  s_cbranch_scc1 W_abort
  s_waitcnt vmcnt(0)
  v_cmp_gt_u32 vcc, 1, v2
  s_cbranch_vccz W_k_61_ok
  s_sleep 16
  s_branch W_k_61
W_k_61_ok:
  v_min_u32 v3, 1, v1
  v_lshlrev_b32 v3, 2, v3
W_q_62:
  buffer_load_dword v2, v3, s[8:11], s26 offen offset:0 sc1
  s_sub_u32 s82, s82, 1
  s_cbranch_scc1 W_abort
  s_waitcnt vmcnt(0)
  v_cmp_gt_u32 vcc, 1, v2
  s_cbranch_vccz W_q_62_ok
  s_sleep 16
  s_branch W_q_62
W_q_62_ok:
  v_lshlrev_b32 v4, 4, v1
  s_mul_i32 s26, s47, 12288
  s_add_u32 s27, s26, 33554432
  s_add_u32 s26, s26, 8388608
  buffer_load_dwordx4 v[64:67], v4, s[8:11], s26 offen offset:0
  buffer_load_dwordx4 v[112:115], v4, s[8:11], s27 offen offset:0
  buffer_load_dwordx4 v[68:71], v4, s[8:11], s26 offen offset:1024
  buffer_load_dwordx4 v[116:119], v4, s[8:11], s27 offen offset:1024
  buffer_load_dwordx4 v[72:75], v4, s[8:11], s26 offen offset:2048
  buffer_load_dwordx4 v[120:123], v4, s[8:11], s27 offen offset:2048
  buffer_load_dwordx4 v[76:79], v4, s[8:11], s26 offen offset:3072
  buffer_load_dwordx4 v[124:127], v4, s[8:11], s27 offen offset:3072
  s_add_u32 s26, s26, 4096
  s_add_u32 s27, s27, 4096
  buffer_load_dwordx4 v[80:83], v4, s[8:11], s26 offen offset:0
  buffer_load_dwordx4 v[128:131], v4, s[8:11], s27 offen offset:0
  buffer_load_dwordx4 v[84:87], v4, s[8:11], s26 offen offset:1024
  buffer_load_dwordx4 v[132:135], v4, s[8:11], s27 offen offset:1024
  buffer_load_dwordx4 v[88:91], v4, s[8:11], s26 offen offset:2048
  buffer_load_dwordx4 v[136:139], v4, s[8:11], s27 offen offset:2048
  buffer_load_dwordx4 v[92:95], v4, s[8:11], s26 offen offset:3072
  buffer_load_dwordx4 v[140:143], v4, s[8:11], s27 offen offset:3072
  s_add_u32 s26, s26, 4096
  s_add_u32 s27, s27, 4096
  buffer_load_dwordx4 v[96:99], v4, s[8:11], s26 offen offset:0
  buffer_load_dwordx4 v[144:147], v4, s[8:11], s27 offen offset:0
  buffer_load_dwordx4 v[100:103], v4, s[8:11], s26 offen offset:1024
  buffer_load_dwordx4 v[148:151], v4, s[8:11], s27 offen offset:1024
  buffer_load_dwordx4 v[104:107], v4, s[8:11], s26 offen offset:2048
  buffer_load_dwordx4 v[152:155], v4, s[8:11], s27 offen offset:2048
  buffer_load_dwordx4 v[108:111], v4, s[8:11], s26 offen offset:3072
  buffer_load_dwordx4 v[156:159], v4, s[8:11], s27 offen offset:3072
  v_and_b32 v5, 31, v1
  v_lshrrev_b32 v6, 5, v1
  v_lshlrev_b32 v7, 2, v6
  v_sub_u32 v8, v5, v7
  v_and_b32 v7, 7, v1
  v_lshlrev_b32 v7, 4, v7
  v_lshl_add_u32 v7, v6, 7, v7
  s_mul_i32 s25, s24, 3072
  v_add_u32 v9, s25, v7
  v_lshlrev_b32 v10, 4, v5
  v_lshl_add_u32 v10, v6, 3, v10
  v_mov_b32 v11, 4286578688
  s_waitcnt vmcnt(22)
  v_mfma_f32_32x32x16_bf16 v[16:31], v[64:67], v[112:115], 0
  s_waitcnt vmcnt(20)
  v_mfma_f32_32x32x16_bf16 v[16:31], v[68:71], v[116:119], v[16:31]
  s_waitcnt vmcnt(18)
  v_mfma_f32_32x32x16_bf16 v[16:31], v[72:75], v[120:123], v[16:31]
  s_waitcnt vmcnt(16)
  v_mfma_f32_32x32x16_bf16 v[16:31], v[76:79], v[124:127], v[16:31]
  s_waitcnt vmcnt(14)
  v_mfma_f32_32x32x16_bf16 v[16:31], v[80:83], v[128:131], v[16:31]
  s_waitcnt vmcnt(12)
  v_mfma_f32_32x32x16_bf16 v[16:31], v[84:87], v[132:135], v[16:31]
  s_waitcnt vmcnt(10)
  v_mfma_f32_32x32x16_bf16 v[16:31], v[88:91], v[136:139], v[16:31]
  s_waitcnt vmcnt(8)
  v_mfma_f32_32x32x16_bf16 v[16:31], v[92:95], v[140:143], v[16:31]
  s_waitcnt vmcnt(6)
  v_mfma_f32_32x32x16_bf16 v[16:31], v[96:99], v[144:147], v[16:31]
  s_waitcnt vmcnt(4)
  v_mfma_f32_32x32x16_bf16 v[16:31], v[100:103], v[148:151], v[16:31]
  s_waitcnt vmcnt(2)
  v_mfma_f32_32x32x16_bf16 v[16:31], v[104:107], v[152:155], v[16:31]
  s_waitcnt vmcnt(0)
  v_mfma_f32_32x32x16_bf16 v[16:31], v[108:111], v[156:159], v[16:31]
  s_lshl_b32 s25, s46, 7
  s_add_u32 s25, s25, 6324224
  s_add_u32 s28, s44, 1
  s_nop 7
  v_cmp_le_i32 vcc, 0, v8
  s_nop 1
  v_cndmask_b32 v16, v11, v16, vcc
  v_cmp_le_i32 vcc, 1, v8
  s_nop 1
  v_cndmask_b32 v17, v11, v17, vcc
  v_cmp_le_i32 vcc, 2, v8
  s_nop 1
  v_cndmask_b32 v18, v11, v18, vcc
  v_cmp_le_i32 vcc, 3, v8
  s_nop 1
  v_cndmask_b32 v19, v11, v19, vcc
  v_cmp_le_i32 vcc, 8, v8
  s_nop 1
  v_cndmask_b32 v20, v11, v20, vcc
  v_cmp_le_i32 vcc, 9, v8
  s_nop 1
  v_cndmask_b32 v21, v11, v21, vcc
  v_cmp_le_i32 vcc, 10, v8
  s_nop 1
  v_cndmask_b32 v22, v11, v22, vcc
  v_cmp_le_i32 vcc, 11, v8
  s_nop 1
  v_cndmask_b32 v23, v11, v23, vcc
  v_cmp_le_i32 vcc, 16, v8
  s_nop 1
  v_cndmask_b32 v24, v11, v24, vcc
  v_cmp_le_i32 vcc, 17, v8
  s_nop 1
  v_cndmask_b32 v25, v11, v25, vcc
  v_cmp_le_i32 vcc, 18, v8
  s_nop 1
  v_cndmask_b32 v26, v11, v26, vcc
  v_cmp_le_i32 vcc, 19, v8
  s_nop 1
  v_cndmask_b32 v27, v11, v27, vcc
  v_cmp_le_i32 vcc, 24, v8
  s_nop 1
  v_cndmask_b32 v28, v11, v28, vcc
  v_cmp_le_i32 vcc, 25, v8
  s_nop 1
  v_cndmask_b32 v29, v11, v29, vcc
  v_cmp_le_i32 vcc, 26, v8
  s_nop 1
  v_cndmask_b32 v30, v11, v30, vcc
  v_cmp_le_i32 vcc, 27, v8
  s_nop 1
  v_cndmask_b32 v31, v11, v31, vcc
  v_max3_f32 v12, v16, v17, v18
  v_max3_f32 v12, v19, v20, v12
  v_max3_f32 v12, v21, v22, v12
  v_max3_f32 v12, v23, v24, v12
  v_max3_f32 v12, v25, v26, v12
  v_max3_f32 v12, v27, v28, v12
  v_max3_f32 v12, v29, v30, v12
  v_max_f32 v12, v31, v12
  s_min_u32 s29, s28, 63
  s_mov_b64 exec, 1
W_kp_63:
  buffer_load_dword v2, off, s[8:11], s25 sc1
  s_sub_u32 s82, s82, 1
  s_cbranch_scc1 W_abort
  s_waitcnt vmcnt(0)
  v_readfirstlane_b32 s30, v2
  s_add_u32 s30, s30, 1
  s_cmp_ge_u32 s30, s29
  s_cbranch_scc1 W_kp_63_ok
  s_add_u32 s30, s30, 1
  s_sleep 16
  s_cmp_ge_u32 s30, s29
  s_cbranch_scc1 W_kp_63
  s_sleep 48
  s_branch W_kp_63
W_kp_63_ok:
  s_mov_b64 exec, -1
  v_min_u32 v3, 0, v1
  v_lshlrev_b32 v3, 2, v3
W_km_64:
  buffer_load_dword v2, v3, s[8:11], s25 offen offset:0 sc1
  s_sub_u32 s82, s82, 1
  s_cbranch_scc1 W_abort
  s_waitcnt vmcnt(0)
  v_cmp_gt_u32 vcc, s28, v2
  s_cbranch_vccz W_km_64_ok
  s_sleep 2
  s_branch W_km_64
W_km_64_ok:
  s_mul_i32 s26, s47, 3072
  s_add_u32 s26, s26, 163577856
  s_mul_i32 s25, s24, 3072
  s_add_u32 m0, s25, 0
  s_nop 0
  buffer_load_dwordx4 v4, s[8:11], s26 offen sc1 lds
  s_add_u32 s26, s26, 1024
  s_add_u32 m0, s25, 1024
  s_nop 0
  buffer_load_dwordx4 v4, s[8:11], s26 offen sc1 lds
  s_add_u32 s26, s26, 1024
  s_add_u32 m0, s25, 2048
  s_nop 0
  buffer_load_dwordx4 v4, s[8:11], s26 offen sc1 lds
  s_add_u32 s26, s26, 1024
  s_waitcnt vmcnt(0)
  ds_read_b128 v[160:163], v9 offset:0
  ds_read_b128 v[164:167], v9 offset:256
  ds_read_b128 v[168:171], v9 offset:512
  ds_read_b128 v[172:175], v9 offset:768
  ds_read_b128 v[176:179], v9 offset:1024
  ds_read_b128 v[180:183], v9 offset:1280
  ds_read_b128 v[184:187], v9 offset:1536
  ds_read_b128 v[188:191], v9 offset:1792
  ds_read_b128 v[192:195], v9 offset:2048
  ds_read_b128 v[196:199], v9 offset:2304
  ds_read_b128 v[200:203], v9 offset:2560
  ds_read_b128 v[204:207], v9 offset:2816
  s_waitcnt lgkmcnt(11)
  v_mfma_f32_32x32x16_bf16 v[32:47], v[160:163], v[112:115], 0
  s_waitcnt lgkmcnt(10)
  v_mfma_f32_32x32x16_bf16 v[32:47], v[164:167], v[116:119], v[32:47]
  s_waitcnt lgkmcnt(9)
  v_mfma_f32_32x32x16_bf16 v[32:47], v[168:171], v[120:123], v[32:47]
  s_waitcnt lgkmcnt(8)
  v_mfma_f32_32x32x16_bf16 v[32:47], v[172:175], v[124:127], v[32:47]
  s_waitcnt lgkmcnt(7)
  v_mfma_f32_32x32x16_bf16 v[32:47], v[176:179], v[128:131], v[32:47]
  s_waitcnt lgkmcnt(6)
  v_mfma_f32_32x32x16_bf16 v[32:47], v[180:183], v[132:135], v[32:47]
  s_waitcnt lgkmcnt(5)
  v_mfma_f32_32x32x16_bf16 v[32:47], v[184:187], v[136:139], v[32:47]
  s_waitcnt lgkmcnt(4)
  v_mfma_f32_32x32x16_bf16 v[32:47], v[188:191], v[140:143], v[32:47]
  s_waitcnt lgkmcnt(3)
  v_mfma_f32_32x32x16_bf16 v[32:47], v[192:195], v[144:147], v[32:47]
  s_waitcnt lgkmcnt(2)
  v_mfma_f32_32x32x16_bf16 v[32:47], v[196:199], v[148:151], v[32:47]
  s_waitcnt lgkmcnt(1)
  v_mfma_f32_32x32x16_bf16 v[32:47], v[200:203], v[152:155], v[32:47]
  s_waitcnt lgkmcnt(0)
  v_mfma_f32_32x32x16_bf16 v[32:47], v[204:207], v[156:159], v[32:47]
  s_mul_i32 s26, s47, 2560
  s_add_u32 s26, s26, 169869312
  s_lshl_b32 s27, s44, 3
  s_add_u32 s27, s27, s45
  s_lshl_b32 s27, s27, 7
  s_add_u32 s27, s27, 6356992
  s_mov_b32 s28, 1037384597
  s_nop 11
  v_max3_f32 v12, v32, v33, v12
  v_max3_f32 v12, v34, v35, v12
  v_mov_b32 v13, v12
  s_nop 1
  v_permlane32_swap_b32 v12, v13
  s_nop 0
  v_max_f32 v12, v12, v13
  v_mul_f32 v12, s28, v12
  v_fma_f32 v16, v16, s28, -v12
  v_fma_f32 v17, v17, s28, -v12
  v_fma_f32 v18, v18, s28, -v12
  v_fma_f32 v19, v19, s28, -v12
  v_fma_f32 v20, v20, s28, -v12
  v_fma_f32 v21, v21, s28, -v12
  v_fma_f32 v22, v22, s28, -v12
  v_fma_f32 v23, v23, s28, -v12
  v_fma_f32 v24, v24, s28, -v12
  v_fma_f32 v25, v25, s28, -v12
  v_fma_f32 v26, v26, s28, -v12
  v_fma_f32 v27, v27, s28, -v12
  v_fma_f32 v28, v28, s28, -v12
  v_fma_f32 v29, v29, s28, -v12
  v_fma_f32 v30, v30, s28, -v12
  v_fma_f32 v31, v31, s28, -v12
  v_fma_f32 v32, v32, s28, -v12
  v_fma_f32 v33, v33, s28, -v12
  v_fma_f32 v34, v34, s28, -v12
  v_fma_f32 v35, v35, s28, -v12
  v_exp_f32 v16, v16
  v_exp_f32 v17, v17
  v_exp_f32 v18, v18
  v_exp_f32 v19, v19
  v_exp_f32 v20, v20
  v_exp_f32 v21, v21
  v_exp_f32 v22, v22
  v_exp_f32 v23, v23
  v_exp_f32 v24, v24
  v_exp_f32 v25, v25
  v_exp_f32 v26, v26
  v_exp_f32 v27, v27
  v_exp_f32 v28, v28
  v_exp_f32 v29, v29
  v_exp_f32 v30, v30
  v_exp_f32 v31, v31
  v_exp_f32 v32, v32
  v_exp_f32 v33, v33
  v_exp_f32 v34, v34
  v_exp_f32 v35, v35
  v_add_f32 v13, v16, v17
  v_add_f32 v13, v13, v18
  v_add_f32 v13, v13, v19
  v_add_f32 v13, v13, v20
  v_add_f32 v13, v13, v21
  v_add_f32 v13, v13, v22
  v_add_f32 v13, v13, v23
  v_add_f32 v13, v13, v24
  v_add_f32 v13, v13, v25
  v_add_f32 v13, v13, v26
  v_add_f32 v13, v13, v27
  v_add_f32 v13, v13, v28
  v_add_f32 v13, v13, v29
  v_add_f32 v13, v13, v30
  v_add_f32 v13, v13, v31
  v_add_f32 v13, v13, v32
  v_add_f32 v13, v13, v33
  v_add_f32 v13, v13, v34
  v_add_f32 v13, v13, v35
  v_mov_b32 v14, v13
  s_nop 1
  v_permlane32_swap_b32 v13, v14
  s_nop 0
  v_add_f32 v13, v13, v14
  v_rcp_f32 v13, v13
  s_nop 0
  v_mul_f32 v16, v16, v13
  v_mul_f32 v17, v17, v13
  v_mul_f32 v18, v18, v13
  v_mul_f32 v19, v19, v13
  v_mul_f32 v20, v20, v13
  v_mul_f32 v21, v21, v13
  v_mul_f32 v22, v22, v13
  v_mul_f32 v23, v23, v13
  v_mul_f32 v24, v24, v13
  v_mul_f32 v25, v25, v13
  v_mul_f32 v26, v26, v13
  v_mul_f32 v27, v27, v13
  v_mul_f32 v28, v28, v13
  v_mul_f32 v29, v29, v13
  v_mul_f32 v30, v30, v13
  v_mul_f32 v31, v31, v13
  v_mul_f32 v32, v32, v13
  v_mul_f32 v33, v33, v13
  v_mul_f32 v34, v34, v13
  v_mul_f32 v35, v35, v13
  v_cvt_pk_bf16_f32 v48, v16, v17
  v_cvt_pk_bf16_f32 v49, v18, v19
  v_cvt_pk_bf16_f32 v50, v20, v21
  v_cvt_pk_bf16_f32 v51, v22, v23
  v_cvt_pk_bf16_f32 v52, v24, v25
  v_cvt_pk_bf16_f32 v53, v26, v27
  v_cvt_pk_bf16_f32 v54, v28, v29
  v_cvt_pk_bf16_f32 v55, v30, v31
  v_cvt_pk_bf16_f32 v56, v32, v33
  v_cvt_pk_bf16_f32 v57, v34, v35
  buffer_store_dwordx4 v[48:51], v4, s[8:11], s26 offen sc1
  buffer_store_dwordx4 v[52:55], v4, s[8:11], s26 offen offset:1024 sc1
  buffer_store_dwordx2 v[56:57], v10, s[8:11], s26 offen offset:2048 sc1
  s_waitcnt vmcnt(0)
  s_barrier
  s_cmp_lg_u32 s24, 0
  s_cbranch_scc1 W_fl_65
  v_mov_b32 v2, 1
  v_mov_b32 v3, 0
  s_mov_b64 exec, 1
  buffer_store_dword v2, v3, s[8:11], s27 offen sc1
  s_mov_b64 exec, -1
W_fl_65:
  s_branch W_next
W_pz:
  s_lshr_b32 s25, s44, 3
  s_lshl_b32 s25, s25, 9
  s_lshl_b32 s26, s24, 7
  s_add_u32 s25, s25, s26
  s_add_u32 s25, s25, 6340608
  v_min_u32 v3, 31, v1
  v_lshlrev_b32 v3, 2, v3
W_u_66:
  buffer_load_dword v2, v3, s[8:11], s25 offen offset:0 sc1
  s_sub_u32 s82, s82, 1
  s_cbranch_scc1 W_abort
  s_waitcnt vmcnt(0)
  v_cmp_gt_u32 vcc, 1, v2
  s_cbranch_vccz W_u_66_ok
  s_sleep 16
  s_branch W_u_66
W_u_66_ok:
  s_lshl_b32 s46, s44, 5
  s_lshl_b32 s25, s24, 3
  s_add_u32 s46, s46, s25
  v_and_b32 v5, 31, v1
  v_lshrrev_b32 v6, 5, v1
  v_lshlrev_b32 v4, 4, v1
  v_lshlrev_b32 v7, 4, v1
  v_mul_u32_u24 v8, 2560, v6
  v_lshl_add_u32 v8, v5, 4, v8
  v_mul_u32_u24 v9, 10240, v6
  v_lshl_add_u32 v9, v5, 4, v9
  s_mul_i32 s26, s46, 40960
  s_lshl_b32 s25, s45, 12
  s_add_u32 s26, s26, s25
  s_add_u32 s26, s26, 58720256
  buffer_load_dwordx4 a[0:3], v4, s[8:11], s26 offen offset:0
  buffer_load_dwordx4 a[4:7], v4, s[8:11], s26 offen offset:1024
  buffer_load_dwordx4 a[8:11], v4, s[8:11], s26 offen offset:2048
  buffer_load_dwordx4 a[12:15], v4, s[8:11], s26 offen offset:3072
  s_add_u32 s26, s26, 40960
  buffer_load_dwordx4 a[16:19], v4, s[8:11], s26 offen offset:0
  buffer_load_dwordx4 a[20:23], v4, s[8:11], s26 offen offset:1024
  buffer_load_dwordx4 a[24:27], v4, s[8:11], s26 offen offset:2048
  buffer_load_dwordx4 a[28:31], v4, s[8:11], s26 offen offset:3072
  s_add_u32 s26, s26, 40960
  buffer_load_dwordx4 a[32:35], v4, s[8:11], s26 offen offset:0
  buffer_load_dwordx4 a[36:39], v4, s[8:11], s26 offen offset:1024
  buffer_load_dwordx4 a[40:43], v4, s[8:11], s26 offen offset:2048
  buffer_load_dwordx4 a[44:47], v4, s[8:11], s26 offen offset:3072
  s_add_u32 s26, s26, 40960
  buffer_load_dwordx4 a[48:51], v4, s[8:11], s26 offen offset:0
  buffer_load_dwordx4 a[52:55], v4, s[8:11], s26 offen offset:1024
  buffer_load_dwordx4 a[56:59], v4, s[8:11], s26 offen offset:2048
  buffer_load_dwordx4 a[60:63], v4, s[8:11], s26 offen offset:3072
  s_add_u32 s26, s26, 40960
  buffer_load_dwordx4 a[64:67], v4, s[8:11], s26 offen offset:0
  buffer_load_dwordx4 a[68:71], v4, s[8:11], s26 offen offset:1024
  buffer_load_dwordx4 a[72:75], v4, s[8:11], s26 offen offset:2048
  buffer_load_dwordx4 a[76:79], v4, s[8:11], s26 offen offset:3072
  s_add_u32 s26, s26, 40960
  buffer_load_dwordx4 a[80:83], v4, s[8:11], s26 offen offset:0
  buffer_load_dwordx4 a[84:87], v4, s[8:11], s26 offen offset:1024
  buffer_load_dwordx4 a[88:91], v4, s[8:11], s26 offen offset:2048
  buffer_load_dwordx4 a[92:95], v4, s[8:11], s26 offen offset:3072
  s_add_u32 s26, s26, 40960
  buffer_load_dwordx4 a[96:99], v4, s[8:11], s26 offen offset:0
  buffer_load_dwordx4 a[100:103], v4, s[8:11], s26 offen offset:1024
  buffer_load_dwordx4 a[104:107], v4, s[8:11], s26 offen offset:2048
  buffer_load_dwordx4 a[108:111], v4, s[8:11], s26 offen offset:3072
  s_add_u32 s26, s26, 40960
  buffer_load_dwordx4 a[112:115], v4, s[8:11], s26 offen offset:0
  buffer_load_dwordx4 a[116:119], v4, s[8:11], s26 offen offset:1024
  buffer_load_dwordx4 a[120:123], v4, s[8:11], s26 offen offset:2048
  buffer_load_dwordx4 a[124:127], v4, s[8:11], s26 offen offset:3072
  s_add_u32 s26, s26, 40960
  s_lshl_b32 s25, s24, 13
  v_add_u32 v10, s25, v7
  v_and_b32 v11, 7, v0
  v_lshrrev_b32 v12, 3, v0
  v_lshlrev_b32 v13, 10, v11
  v_lshl_add_u32 v13, v12, 4, v13
  v_mul_u32_u24 v14, 2560, v12
  v_lshl_add_u32 v14, v11, 4, v14
  s_lshl_b32 s27, s44, 10
  s_lshl_b32 s25, s24, 8
  s_add_u32 s27, s27, s25
  s_add_u32 s27, s27, 6356992
  s_add_u32 s28, s44, 1
  s_lshl_b32 s25, s24, 10
  s_add_u32 s25, s25, 6328320
  s_min_u32 s28, s28, 63
  s_min_u32 s29, s28, 62
  s_mov_b64 exec, 1
W_yp_67:
  buffer_load_dword v2, off, s[8:11], s25 sc1
  s_sub_u32 s82, s82, 1
  s_cbranch_scc1 W_abort
  s_waitcnt vmcnt(0)
  v_readfirstlane_b32 s30, v2
  s_add_u32 s30, s30, 1
  s_cmp_ge_u32 s30, s29
  s_cbranch_scc1 W_yp_67_ok
  s_add_u32 s30, s30, 1
  s_sleep 16
  s_cmp_ge_u32 s30, s29
  s_cbranch_scc1 W_yp_67
  s_sleep 48
  s_branch W_yp_67
W_yp_67_ok:
  s_mov_b64 exec, -1
  v_min_u32 v3, 7, v1
  v_lshlrev_b32 v3, 7, v3
W_y_68:
  buffer_load_dword v2, v3, s[8:11], s25 offen offset:0 sc1
  s_sub_u32 s82, s82, 1
  s_cbranch_scc1 W_abort
  s_waitcnt vmcnt(0)
  v_cmp_gt_u32 vcc, s28, v2
  s_cbranch_vccz W_y_68_ok
  s_sleep 2
  s_branch W_y_68
W_y_68_ok:
  s_cmp_lg_u32 s44, 63
  s_cbranch_scc1 W_pz_nf
  v_min_u32 v3, 7, v1
  v_lshlrev_b32 v3, 7, v3
W_yf_69:
  buffer_load_dword v2, v3, s[8:11], s25 offen offset:4 sc1
  s_sub_u32 s82, s82, 1
  s_cbranch_scc1 W_abort
  s_waitcnt vmcnt(0)
  v_cmp_gt_u32 vcc, 1, v2
  s_cbranch_vccz W_yf_69_ok
  s_sleep 2
  s_branch W_yf_69
W_yf_69_ok:
W_pz_nf:
  s_mul_i32 s29, s46, 10240
  s_lshl_b32 s25, s45, 10
  s_add_u32 s29, s29, s25
  s_add_u32 s29, s29, 142606336
  buffer_load_dwordx4 v[144:147], v9, s[8:11], s29 offen offset:0 sc1
  buffer_load_dwordx4 v[148:151], v9, s[8:11], s29 offen offset:512 sc1
  s_add_u32 s29, s29, 20480
  buffer_load_dwordx4 v[152:155], v9, s[8:11], s29 offen offset:0 sc1
  buffer_load_dwordx4 v[156:159], v9, s[8:11], s29 offen offset:512 sc1
  s_add_u32 s29, s29, 20480
  buffer_load_dwordx4 v[160:163], v9, s[8:11], s29 offen offset:0 sc1
  buffer_load_dwordx4 v[164:167], v9, s[8:11], s29 offen offset:512 sc1
  s_add_u32 s29, s29, 20480
  buffer_load_dwordx4 v[168:171], v9, s[8:11], s29 offen offset:0 sc1
  buffer_load_dwordx4 v[172:175], v9, s[8:11], s29 offen offset:512 sc1
  s_add_u32 s29, s29, 20480
  v_min_u32 v3, 1, v1
  v_lshlrev_b32 v3, 7, v3
W_p_70:
  buffer_load_dword v2, v3, s[8:11], s27 offen offset:0 sc1
  s_sub_u32 s82, s82, 1
  s_cbranch_scc1 W_abort
  s_waitcnt vmcnt(0)
  v_cmp_gt_u32 vcc, 1, v2
  s_cbranch_vccz W_p_70_ok
  s_sleep 2
  s_branch W_p_70
W_p_70_ok:
  s_mul_i32 s26, s46, 2560
  s_add_u32 s26, s26, 169869312
  s_add_u32 s25, s26, 2560
  buffer_load_dwordx4 v[64:67], v7, s[8:11], s26 offen offset:0 sc1
  buffer_load_dwordx4 v[68:71], v7, s[8:11], s26 offen offset:1024 sc1
  buffer_load_dwordx4 v[72:75], v7, s[8:11], s25 offen offset:0 sc1
  buffer_load_dwordx4 v[76:79], v7, s[8:11], s25 offen offset:1024 sc1
  buffer_load_dwordx4 v[128:131], v8, s[8:11], s26 offen offset:2048 sc1
  s_add_u32 s26, s26, 5120
  s_add_u32 s25, s26, 2560
  buffer_load_dwordx4 v[80:83], v7, s[8:11], s26 offen offset:0 sc1
  buffer_load_dwordx4 v[84:87], v7, s[8:11], s26 offen offset:1024 sc1
  buffer_load_dwordx4 v[88:91], v7, s[8:11], s25 offen offset:0 sc1
  buffer_load_dwordx4 v[92:95], v7, s[8:11], s25 offen offset:1024 sc1
  buffer_load_dwordx4 v[132:135], v8, s[8:11], s26 offen offset:2048 sc1
  s_add_u32 s26, s26, 5120
  s_add_u32 s25, s26, 2560
  buffer_load_dwordx4 v[96:99], v7, s[8:11], s26 offen offset:0 sc1
  buffer_load_dwordx4 v[100:103], v7, s[8:11], s26 offen offset:1024 sc1
  buffer_load_dwordx4 v[104:107], v7, s[8:11], s25 offen offset:0 sc1
  buffer_load_dwordx4 v[108:111], v7, s[8:11], s25 offen offset:1024 sc1
  buffer_load_dwordx4 v[136:139], v8, s[8:11], s26 offen offset:2048 sc1
  s_add_u32 s26, s26, 5120
  s_add_u32 s25, s26, 2560
  buffer_load_dwordx4 v[112:115], v7, s[8:11], s26 offen offset:0 sc1
  buffer_load_dwordx4 v[116:119], v7, s[8:11], s26 offen offset:1024 sc1
  buffer_load_dwordx4 v[120:123], v7, s[8:11], s25 offen offset:0 sc1
  buffer_load_dwordx4 v[124:127], v7, s[8:11], s25 offen offset:1024 sc1
  buffer_load_dwordx4 v[140:143], v8, s[8:11], s26 offen offset:2048 sc1
  s_add_u32 s26, s26, 5120
  s_waitcnt vmcnt(19)
  v_mfma_f32_32x32x16_bf16 v[16:31], a[0:3], v[64:67], 0
  v_mfma_f32_32x32x16_bf16 v[32:47], a[8:11], v[64:67], 0
  s_waitcnt vmcnt(18)
  v_mfma_f32_32x32x16_bf16 v[16:31], a[4:7], v[68:71], v[16:31]
  v_mfma_f32_32x32x16_bf16 v[32:47], a[12:15], v[68:71], v[32:47]
  s_waitcnt vmcnt(17)
  v_mfma_f32_32x32x16_bf16 v[16:31], a[16:19], v[72:75], v[16:31]
  v_mfma_f32_32x32x16_bf16 v[32:47], a[24:27], v[72:75], v[32:47]
  s_waitcnt vmcnt(16)
  v_mfma_f32_32x32x16_bf16 v[16:31], a[20:23], v[76:79], v[16:31]
  v_mfma_f32_32x32x16_bf16 v[32:47], a[28:31], v[76:79], v[32:47]
  s_waitcnt vmcnt(15)
  v_mfma_f32_32x32x16_bf16 v[16:31], v[144:147], v[128:131], v[16:31]
  v_mfma_f32_32x32x16_bf16 v[32:47], v[148:151], v[128:131], v[32:47]
  s_waitcnt vmcnt(14)
  v_mfma_f32_32x32x16_bf16 v[16:31], a[32:35], v[80:83], v[16:31]
  v_mfma_f32_32x32x16_bf16 v[32:47], a[40:43], v[80:83], v[32:47]
  s_waitcnt vmcnt(13)
  v_mfma_f32_32x32x16_bf16 v[16:31], a[36:39], v[84:87], v[16:31]
  v_mfma_f32_32x32x16_bf16 v[32:47], a[44:47], v[84:87], v[32:47]
  s_waitcnt vmcnt(12)
  v_mfma_f32_32x32x16_bf16 v[16:31], a[48:51], v[88:91], v[16:31]
  v_mfma_f32_32x32x16_bf16 v[32:47], a[56:59], v[88:91], v[32:47]
  s_waitcnt vmcnt(11)
  v_mfma_f32_32x32x16_bf16 v[16:31], a[52:55], v[92:95], v[16:31]
  v_mfma_f32_32x32x16_bf16 v[32:47], a[60:63], v[92:95], v[32:47]
  s_waitcnt vmcnt(10)
  v_mfma_f32_32x32x16_bf16 v[16:31], v[152:155], v[132:135], v[16:31]
  v_mfma_f32_32x32x16_bf16 v[32:47], v[156:159], v[132:135], v[32:47]
  s_waitcnt vmcnt(9)
  v_mfma_f32_32x32x16_bf16 v[16:31], a[64:67], v[96:99], v[16:31]
  v_mfma_f32_32x32x16_bf16 v[32:47], a[72:75], v[96:99], v[32:47]
  s_waitcnt vmcnt(8)
  v_mfma_f32_32x32x16_bf16 v[16:31], a[68:71], v[100:103], v[16:31]
  v_mfma_f32_32x32x16_bf16 v[32:47], a[76:79], v[100:103], v[32:47]
  s_waitcnt vmcnt(7)
  v_mfma_f32_32x32x16_bf16 v[16:31], a[80:83], v[104:107], v[16:31]
  v_mfma_f32_32x32x16_bf16 v[32:47], a[88:91], v[104:107], v[32:47]
  s_waitcnt vmcnt(6)
  v_mfma_f32_32x32x16_bf16 v[16:31], a[84:87], v[108:111], v[16:31]
  v_mfma_f32_32x32x16_bf16 v[32:47], a[92:95], v[108:111], v[32:47]
  s_waitcnt vmcnt(5)
  v_mfma_f32_32x32x16_bf16 v[16:31], v[160:163], v[136:139], v[16:31]
  v_mfma_f32_32x32x16_bf16 v[32:47], v[164:167], v[136:139], v[32:47]
  s_waitcnt vmcnt(4)
  v_mfma_f32_32x32x16_bf16 v[16:31], a[96:99], v[112:115], v[16:31]
  v_mfma_f32_32x32x16_bf16 v[32:47], a[104:107], v[112:115], v[32:47]
  s_waitcnt vmcnt(3)
  v_mfma_f32_32x32x16_bf16 v[16:31], a[100:103], v[116:119], v[16:31]
  v_mfma_f32_32x32x16_bf16 v[32:47], a[108:111], v[116:119], v[32:47]
  s_waitcnt vmcnt(2)
  v_mfma_f32_32x32x16_bf16 v[16:31], a[112:115], v[120:123], v[16:31]
  v_mfma_f32_32x32x16_bf16 v[32:47], a[120:123], v[120:123], v[32:47]
  s_waitcnt vmcnt(1)
  v_mfma_f32_32x32x16_bf16 v[16:31], a[116:119], v[124:127], v[16:31]
  v_mfma_f32_32x32x16_bf16 v[32:47], a[124:127], v[124:127], v[32:47]
  s_waitcnt vmcnt(0)
  v_mfma_f32_32x32x16_bf16 v[16:31], v[168:171], v[140:143], v[16:31]
  v_mfma_f32_32x32x16_bf16 v[32:47], v[172:175], v[140:143], v[32:47]
  s_mul_i32 s26, s44, 81920
  s_lshl_b32 s25, s45, 7
  s_add_u32 s26, s26, s25
  s_nop 9
  ds_write_b128 v10, v[16:19] offset:0
  ds_write_b128 v10, v[20:23] offset:1024
  ds_write_b128 v10, v[24:27] offset:2048
  ds_write_b128 v10, v[28:31] offset:3072
  s_nop 3
  ds_write_b128 v10, v[32:35] offset:4096
  ds_write_b128 v10, v[36:39] offset:5120
  ds_write_b128 v10, v[40:43] offset:6144
  ds_write_b128 v10, v[44:47] offset:7168
  s_waitcnt lgkmcnt(0)
  s_barrier
  ds_read_b128 v[64:67], v13 offset:0
  ds_read_b128 v[68:71], v13 offset:512
  ds_read_b128 v[72:75], v13 offset:8192
  ds_read_b128 v[76:79], v13 offset:8704
  ds_read_b128 v[80:83], v13 offset:16384
  ds_read_b128 v[84:87], v13 offset:16896
  ds_read_b128 v[88:91], v13 offset:24576
  ds_read_b128 v[92:95], v13 offset:25088
  s_waitcnt lgkmcnt(0)
  v_pk_add_f32 v[64:65], v[64:65], v[72:73]
  v_pk_add_f32 v[80:81], v[80:81], v[88:89]
  v_pk_add_f32 v[66:67], v[66:67], v[74:75]
  v_pk_add_f32 v[82:83], v[82:83], v[90:91]
  v_pk_add_f32 v[68:69], v[68:69], v[76:77]
  v_pk_add_f32 v[84:85], v[84:85], v[92:93]
  v_pk_add_f32 v[70:71], v[70:71], v[78:79]
  v_pk_add_f32 v[86:87], v[86:87], v[94:95]
  v_pk_add_f32 v[64:65], v[64:65], v[80:81]
  v_pk_add_f32 v[66:67], v[66:67], v[82:83]
  v_pk_add_f32 v[68:69], v[68:69], v[84:85]
  v_pk_add_f32 v[70:71], v[70:71], v[86:87]
  v_cvt_pk_bf16_f32 v48, v64, v65
  v_cvt_pk_bf16_f32 v49, v66, v67
  v_cvt_pk_bf16_f32 v50, v68, v69
  v_cvt_pk_bf16_f32 v51, v70, v71
  buffer_store_dwordx4 v[48:51], v14, s[20:23], s26 offen
  s_barrier
  s_branch W_next
W_ba:
  s_lshr_b32 s26, s44, 1
  s_max_u32 s27, s26, 1
  s_sub_u32 s27, s27, 1
  s_lshl_b32 s26, s26, 6
  s_lshl_b32 s27, s27, 6
  s_add_u32 s26, s26, 6307840
  s_add_u32 s27, s27, 6307840
  v_min_u32 v3, 9, v1
  v_lshlrev_b32 v3, 2, v3
W_b1_71:
  buffer_load_dword v2, v3, s[8:11], s26 offen offset:0 sc1
  s_sub_u32 s82, s82, 1
  s_cbranch_scc1 W_abort
  s_waitcnt vmcnt(0)
  v_cmp_gt_u32 vcc, 1, v2
  s_cbranch_vccz W_b1_71_ok
  s_sleep 16
  s_branch W_b1_71
W_b1_71_ok:
  v_min_u32 v3, 9, v1
  v_lshlrev_b32 v3, 2, v3
W_b2_72:
  buffer_load_dword v2, v3, s[8:11], s27 offen offset:0 sc1
  s_sub_u32 s82, s82, 1
  s_cbranch_scc1 W_abort
  s_waitcnt vmcnt(0)
  v_cmp_gt_u32 vcc, 1, v2
  s_cbranch_vccz W_b2_72_ok
  s_sleep 16
  s_branch W_b2_72
W_b2_72_ok:
  s_mul_i32 s28, s45, 20
  s_add_u32 s29, s28, 0
  s_lshr_b32 s25, s29, 4
  s_lshl_b32 s48, s25, 10
  s_bfe_u32 s25, s29, 0x10002
  s_lshl_b32 s25, s25, 9
  s_add_u32 s48, s48, s25
  s_and_b32 s25, s29, 8
  s_add_u32 s48, s48, s25
  s_add_u32 s29, s28, 4
  s_lshr_b32 s25, s29, 4
  s_lshl_b32 s49, s25, 10
  s_bfe_u32 s25, s29, 0x10002
  s_lshl_b32 s25, s25, 9
  s_add_u32 s49, s49, s25
  s_and_b32 s25, s29, 8
  s_add_u32 s49, s49, s25
  s_add_u32 s29, s28, 8
  s_lshr_b32 s25, s29, 4
  s_lshl_b32 s50, s25, 10
  s_bfe_u32 s25, s29, 0x10002
  s_lshl_b32 s25, s25, 9
  s_add_u32 s50, s50, s25
  s_and_b32 s25, s29, 8
  s_add_u32 s50, s50, s25
  s_add_u32 s29, s28, 12
  s_lshr_b32 s25, s29, 4
  s_lshl_b32 s51, s25, 10
  s_bfe_u32 s25, s29, 0x10002
  s_lshl_b32 s25, s25, 9
  s_add_u32 s51, s51, s25
  s_and_b32 s25, s29, 8
  s_add_u32 s51, s51, s25
  s_add_u32 s29, s28, 16
  s_lshr_b32 s25, s29, 4
  s_lshl_b32 s52, s25, 10
  s_bfe_u32 s25, s29, 0x10002
  s_lshl_b32 s25, s25, 9
  s_add_u32 s52, s52, s25
  s_and_b32 s25, s29, 8
  s_add_u32 s52, s52, s25
  s_add_u32 s29, s28, 640
  s_lshr_b32 s25, s29, 4
  s_lshl_b32 s53, s25, 10
  s_bfe_u32 s25, s29, 0x10002
  s_lshl_b32 s25, s25, 9
  s_add_u32 s53, s53, s25
  s_and_b32 s25, s29, 8
  s_add_u32 s53, s53, s25
  s_add_u32 s29, s28, 644
  s_lshr_b32 s25, s29, 4
  s_lshl_b32 s54, s25, 10
  s_bfe_u32 s25, s29, 0x10002
  s_lshl_b32 s25, s25, 9
  s_add_u32 s54, s54, s25
  s_and_b32 s25, s29, 8
  s_add_u32 s54, s54, s25
  s_add_u32 s29, s28, 648
  s_lshr_b32 s25, s29, 4
  s_lshl_b32 s55, s25, 10
  s_bfe_u32 s25, s29, 0x10002
  s_lshl_b32 s25, s25, 9
  s_add_u32 s55, s55, s25
  s_and_b32 s25, s29, 8
  s_add_u32 s55, s55, s25
  s_add_u32 s29, s28, 652
  s_lshr_b32 s25, s29, 4
  s_lshl_b32 s56, s25, 10
  s_bfe_u32 s25, s29, 0x10002
  s_lshl_b32 s25, s25, 9
  s_add_u32 s56, s56, s25
  s_and_b32 s25, s29, 8
  s_add_u32 s56, s56, s25
  s_add_u32 s29, s28, 656
  s_lshr_b32 s25, s29, 4
  s_lshl_b32 s57, s25, 10
  s_bfe_u32 s25, s29, 0x10002
  s_lshl_b32 s25, s25, 9
  s_add_u32 s57, s57, s25
  s_and_b32 s25, s29, 8
  s_add_u32 s57, s57, s25
  s_add_u32 s29, s28, 1280
  s_lshr_b32 s25, s29, 4
  s_lshl_b32 s58, s25, 10
  s_bfe_u32 s25, s29, 0x10002
  s_lshl_b32 s25, s25, 9
  s_add_u32 s58, s58, s25
  s_and_b32 s25, s29, 8
  s_add_u32 s58, s58, s25
  s_add_u32 s29, s28, 1284
  s_lshr_b32 s25, s29, 4
  s_lshl_b32 s59, s25, 10
  s_bfe_u32 s25, s29, 0x10002
  s_lshl_b32 s25, s25, 9
  s_add_u32 s59, s59, s25
  s_and_b32 s25, s29, 8
  s_add_u32 s59, s59, s25
  s_add_u32 s29, s28, 1288
  s_lshr_b32 s25, s29, 4
  s_lshl_b32 s60, s25, 10
  s_bfe_u32 s25, s29, 0x10002
  s_lshl_b32 s25, s25, 9
  s_add_u32 s60, s60, s25
  s_and_b32 s25, s29, 8
  s_add_u32 s60, s60, s25
  s_add_u32 s29, s28, 1292
  s_lshr_b32 s25, s29, 4
  s_lshl_b32 s61, s25, 10
  s_bfe_u32 s25, s29, 0x10002
  s_lshl_b32 s25, s25, 9
  s_add_u32 s61, s61, s25
  s_and_b32 s25, s29, 8
  s_add_u32 s61, s61, s25
  s_add_u32 s29, s28, 1296
  s_lshr_b32 s25, s29, 4
  s_lshl_b32 s62, s25, 10
  s_bfe_u32 s25, s29, 0x10002
  s_lshl_b32 s25, s25, 9
  s_add_u32 s62, s62, s25
  s_and_b32 s25, s29, 8
  s_add_u32 s62, s62, s25
  v_and_b32 v5, 31, v1
  v_lshrrev_b32 v6, 5, v1
  v_mul_u32_u24 v4, 122880, v6
  v_lshl_add_u32 v4, v5, 4, v4
  v_mul_u32_u24 v7, 48, v1
  s_mul_i32 s29, s24, 3
  s_add_u32 s29, s29, 0
  s_cmp_ge_u32 s29, 6
  s_cselect_b32 s30, 6, 0
  s_cselect_b32 s33, 1, 0
  s_sub_u32 s29, s29, s30
  s_lshl_b32 s30, s44, 1
  s_add_u32 s30, s30, s29
  s_max_u32 s30, s30, 4
  s_sub_u32 s30, s30, 4
  s_mul_i32 s30, s30, 245760
  s_add_u32 s30, s30, 182452224
  s_mul_i32 s29, s29, 3072
  s_mul_i32 s34, s33, 18432
  s_add_u32 s29, s29, s34
  v_add_u32 v8, s29, v7
  s_cmp_eq_u32 s33, 1
  s_cselect_b32 s31, s58, s53
  s_mov_b32 s35, s31
  s_cselect_b32 s31, s59, s54
  s_mov_b32 s36, s31
  s_cselect_b32 s31, s60, s55
  s_mov_b32 s37, s31
  s_cselect_b32 s31, s61, s56
  s_mov_b32 s38, s31
  s_cselect_b32 s31, s62, s57
  s_mov_b32 s39, s31
  s_add_u32 s31, s35, s30
  buffer_load_dwordx2 v[208:209], v4, s[8:11], s31 offen
  s_add_u32 s31, s36, s30
  buffer_load_dwordx2 v[210:211], v4, s[8:11], s31 offen
  s_add_u32 s31, s37, s30
  buffer_load_dwordx2 v[212:213], v4, s[8:11], s31 offen
  s_add_u32 s31, s38, s30
  buffer_load_dwordx2 v[214:215], v4, s[8:11], s31 offen
  s_add_u32 s31, s39, s30
  buffer_load_dwordx2 v[216:217], v4, s[8:11], s31 offen
  s_mul_i32 s29, s24, 3
  s_add_u32 s29, s29, 1
  s_cmp_ge_u32 s29, 6
  s_cselect_b32 s30, 6, 0
  s_cselect_b32 s33, 1, 0
  s_sub_u32 s29, s29, s30
  s_lshl_b32 s30, s44, 1
  s_add_u32 s30, s30, s29
  s_max_u32 s30, s30, 4
  s_sub_u32 s30, s30, 4
  s_mul_i32 s30, s30, 245760
  s_add_u32 s30, s30, 182452224
  s_mul_i32 s29, s29, 3072
  s_mul_i32 s34, s33, 18432
  s_add_u32 s29, s29, s34
  v_add_u32 v9, s29, v7
  s_cmp_eq_u32 s33, 1
  s_cselect_b32 s31, s58, s53
  s_mov_b32 s35, s31
  s_cselect_b32 s31, s59, s54
  s_mov_b32 s36, s31
  s_cselect_b32 s31, s60, s55
  s_mov_b32 s37, s31
  s_cselect_b32 s31, s61, s56
  s_mov_b32 s38, s31
  s_cselect_b32 s31, s62, s57
  s_mov_b32 s39, s31
  s_add_u32 s31, s35, s30
  buffer_load_dwordx2 v[218:219], v4, s[8:11], s31 offen
  s_add_u32 s31, s36, s30
  buffer_load_dwordx2 v[220:221], v4, s[8:11], s31 offen
  s_add_u32 s31, s37, s30
  buffer_load_dwordx2 v[222:223], v4, s[8:11], s31 offen
  s_add_u32 s31, s38, s30
  buffer_load_dwordx2 v[224:225], v4, s[8:11], s31 offen
  s_add_u32 s31, s39, s30
  buffer_load_dwordx2 v[226:227], v4, s[8:11], s31 offen
  s_mul_i32 s29, s24, 3
  s_add_u32 s29, s29, 2
  s_cmp_ge_u32 s29, 6
  s_cselect_b32 s30, 6, 0
  s_cselect_b32 s33, 1, 0
  s_sub_u32 s29, s29, s30
  s_lshl_b32 s30, s44, 1
  s_add_u32 s30, s30, s29
  s_max_u32 s30, s30, 4
  s_sub_u32 s30, s30, 4
  s_mul_i32 s30, s30, 245760
  s_add_u32 s30, s30, 182452224
  s_mul_i32 s29, s29, 3072
  s_mul_i32 s34, s33, 18432
  s_add_u32 s29, s29, s34
  v_add_u32 v10, s29, v7
  s_cmp_eq_u32 s33, 1
  s_cselect_b32 s31, s58, s53
  s_mov_b32 s35, s31
  s_cselect_b32 s31, s59, s54
  s_mov_b32 s36, s31
  s_cselect_b32 s31, s60, s55
  s_mov_b32 s37, s31
  s_cselect_b32 s31, s61, s56
  s_mov_b32 s38, s31
  s_cselect_b32 s31, s62, s57
  s_mov_b32 s39, s31
  s_add_u32 s31, s35, s30
  buffer_load_dwordx2 v[228:229], v4, s[8:11], s31 offen
  s_add_u32 s31, s36, s30
  buffer_load_dwordx2 v[230:231], v4, s[8:11], s31 offen
  s_add_u32 s31, s37, s30
  buffer_load_dwordx2 v[232:233], v4, s[8:11], s31 offen
  s_add_u32 s31, s38, s30
  buffer_load_dwordx2 v[234:235], v4, s[8:11], s31 offen
  s_add_u32 s31, s39, s30
  buffer_load_dwordx2 v[236:237], v4, s[8:11], s31 offen
  s_lshl_b32 s30, s44, 2
  s_add_u32 s30, s30, s24
  s_mul_i32 s30, s30, 122880
  s_add_u32 s30, s30, 182452224
  v_cmp_eq_u32 vcc, 0, v6
  v_lshlrev_b32 v11, 4, v5
  v_mov_b32 v12, s50
  v_mov_b32 v13, s48
  v_cndmask_b32 v12, v12, v13, vcc
  v_add_u32 v12, v12, v11
  buffer_load_dwordx2 v[16:17], v12, s[8:11], s30 offen
  v_mov_b32 v12, s51
  v_mov_b32 v13, s49
  v_cndmask_b32 v12, v12, v13, vcc
  v_add_u32 v12, v12, v11
  buffer_load_dwordx2 v[18:19], v12, s[8:11], s30 offen
  s_add_u32 s30, s30, s52
  buffer_load_dwordx2 v[20:21], v11, s[8:11], s30 offen
  v_mov_b32 v14, 0x3f80
  v_mov_b32 v15, 0
  v_mul_u32_u24 v12, 48, v0
  v_and_b32 v13, 127, v0
  v_mul_u32_u24 v13, 48, v13
  ds_write_b64 v12, v[14:15] offset:18472
  ds_write_b64 v13, v[14:15] offset:30760
  s_waitcnt vmcnt(17)
  ds_write_b64 v8, v[208:209] offset:0
  s_waitcnt vmcnt(16)
  ds_write_b64 v8, v[210:211] offset:8
  s_waitcnt vmcnt(15)
  ds_write_b64 v8, v[212:213] offset:16
  s_waitcnt vmcnt(14)
  ds_write_b64 v8, v[214:215] offset:24
  s_waitcnt vmcnt(13)
  ds_write_b64 v8, v[216:217] offset:32
  s_waitcnt vmcnt(12)
  ds_write_b64 v9, v[218:219] offset:0
  s_waitcnt vmcnt(11)
  ds_write_b64 v9, v[220:221] offset:8
  s_waitcnt vmcnt(10)
  ds_write_b64 v9, v[222:223] offset:16
  s_waitcnt vmcnt(9)
  ds_write_b64 v9, v[224:225] offset:24
  s_waitcnt vmcnt(8)
  ds_write_b64 v9, v[226:227] offset:32
  s_waitcnt vmcnt(7)
  ds_write_b64 v10, v[228:229] offset:0
  s_waitcnt vmcnt(6)
  ds_write_b64 v10, v[230:231] offset:8
  s_waitcnt vmcnt(5)
  ds_write_b64 v10, v[232:233] offset:16
  s_waitcnt vmcnt(4)
  ds_write_b64 v10, v[234:235] offset:24
  s_waitcnt vmcnt(3)
  ds_write_b64 v10, v[236:237] offset:32
  s_mul_i32 s29, s24, 1536
  v_mul_u32_u24 v8, 48, v5
  v_add_u32 v8, s29, v8
  v_lshl_add_u32 v9, v6, 4, v8
  v_bfe_u32 v10, v1, 2, 2
  v_lshl_add_u32 v10, v6, 2, v10
  v_mul_u32_u24 v10, 48, v10
  v_bfe_u32 v12, v1, 4, 1
  v_and_b32 v13, 3, v1
  v_lshl_add_u32 v12, v12, 2, v13
  v_min_u32 v12, 5, v12
  v_lshl_add_u32 v10, v12, 3, v10
  s_add_u32 s29, s29, 18432
  v_add_u32 v10, s29, v10
  v_lshlrev_b32 v12, 2, v6
  v_sub_u32 v12, v5, v12
  v_mov_b32 v13, 4286578688
  s_waitcnt vmcnt(0)
  v_cndmask_b32 v20, 0, v20, vcc
  v_cndmask_b32 v21, 0, v21, vcc
  s_lshl_b32 s33, s44, 2
  s_add_u32 s33, s33, s24
  s_waitcnt lgkmcnt(0)
  s_barrier
  ds_read_b128 v[24:27], v9 offset:0
  ds_read_b64 v[28:29], v8 offset:32
  ds_read_b128 v[30:33], v9 offset:1536
  ds_read_b64 v[34:35], v8 offset:1568
  s_waitcnt lgkmcnt(2)
  v_mfma_f32_32x32x16_bf16 v[64:79], v[24:27], v[16:19], 0
  ds_read_b128 v[36:39], v9 offset:3072
  ds_read_b64 v[40:41], v8 offset:3104
  s_waitcnt lgkmcnt(2)
  v_mfma_f32_32x32x16_bf16 v[80:95], v[30:33], v[16:19], 0
  s_nop 3
  v_mfma_f32_32x32x8_bf16 v[64:79], v[28:29], v[20:21], v[64:79]
  ds_read_b128 v[24:27], v9 offset:4608
  ds_read_b64 v[28:29], v8 offset:4640
  s_waitcnt lgkmcnt(2)
  v_mfma_f32_32x32x16_bf16 v[96:111], v[36:39], v[16:19], 0
  v_mfma_f32_32x32x8_bf16 v[80:95], v[34:35], v[20:21], v[80:95]
  ds_read_b128 v[30:33], v9 offset:6144
  ds_read_b64 v[34:35], v8 offset:6176
  s_waitcnt lgkmcnt(2)
  v_mfma_f32_32x32x16_bf16 v[112:127], v[24:27], v[16:19], 0
  v_mfma_f32_32x32x8_bf16 v[96:111], v[40:41], v[20:21], v[96:111]
  ds_read_b128 v[36:39], v9 offset:7680
  ds_read_b64 v[40:41], v8 offset:7712
  s_waitcnt lgkmcnt(2)
  v_mfma_f32_32x32x16_bf16 v[128:143], v[30:33], v[16:19], 0
  v_mfma_f32_32x32x8_bf16 v[112:127], v[28:29], v[20:21], v[112:127]
  ds_read_b128 v[24:27], v9 offset:9216
  ds_read_b64 v[28:29], v8 offset:9248
  s_waitcnt lgkmcnt(2)
  v_mfma_f32_32x32x16_bf16 v[144:159], v[36:39], v[16:19], 0
  v_mfma_f32_32x32x8_bf16 v[128:143], v[34:35], v[20:21], v[128:143]
  ds_read_b128 v[30:33], v9 offset:10752
  ds_read_b64 v[34:35], v8 offset:10784
  s_waitcnt lgkmcnt(2)
  v_mfma_f32_32x32x16_bf16 v[160:175], v[24:27], v[16:19], 0
  v_mfma_f32_32x32x8_bf16 v[144:159], v[40:41], v[20:21], v[144:159]
  ds_read_b128 v[36:39], v9 offset:12288
  ds_read_b64 v[40:41], v8 offset:12320
  s_waitcnt lgkmcnt(2)
  v_mfma_f32_32x32x16_bf16 v[176:191], v[30:33], v[16:19], 0
  v_mfma_f32_32x32x8_bf16 v[160:175], v[28:29], v[20:21], v[160:175]
  s_waitcnt lgkmcnt(0)
  v_mfma_f32_32x32x16_bf16 v[192:207], v[36:39], v[16:19], 0
  v_mfma_f32_32x32x8_bf16 v[176:191], v[34:35], v[20:21], v[176:191]
  s_nop 3
  v_mfma_f32_32x32x8_bf16 v[192:207], v[40:41], v[20:21], v[192:207]
  s_nop 15
  s_cmp_ge_u32 s33, 8
  s_cbranch_scc1 W_neg_73
  v_mov_b32 v64, v13
  v_mov_b32 v65, v13
  v_mov_b32 v66, v13
  v_mov_b32 v67, v13
  v_mov_b32 v68, v13
  v_mov_b32 v69, v13
  v_mov_b32 v70, v13
  v_mov_b32 v71, v13
  v_mov_b32 v72, v13
  v_mov_b32 v73, v13
  v_mov_b32 v74, v13
  v_mov_b32 v75, v13
  v_mov_b32 v76, v13
  v_mov_b32 v77, v13
  v_mov_b32 v78, v13
  v_mov_b32 v79, v13
  s_cmp_ge_u32 s33, 7
  s_cbranch_scc1 W_neg_73
  v_mov_b32 v80, v13
  v_mov_b32 v81, v13
  v_mov_b32 v82, v13
  v_mov_b32 v83, v13
  v_mov_b32 v84, v13
  v_mov_b32 v85, v13
  v_mov_b32 v86, v13
  v_mov_b32 v87, v13
  v_mov_b32 v88, v13
  v_mov_b32 v89, v13
  v_mov_b32 v90, v13
  v_mov_b32 v91, v13
  v_mov_b32 v92, v13
  v_mov_b32 v93, v13
  v_mov_b32 v94, v13
  v_mov_b32 v95, v13
  s_cmp_ge_u32 s33, 6
  s_cbranch_scc1 W_neg_73
  v_mov_b32 v96, v13
  v_mov_b32 v97, v13
  v_mov_b32 v98, v13
  v_mov_b32 v99, v13
  v_mov_b32 v100, v13
  v_mov_b32 v101, v13
  v_mov_b32 v102, v13
  v_mov_b32 v103, v13
  v_mov_b32 v104, v13
  v_mov_b32 v105, v13
  v_mov_b32 v106, v13
  v_mov_b32 v107, v13
  v_mov_b32 v108, v13
  v_mov_b32 v109, v13
  v_mov_b32 v110, v13
  v_mov_b32 v111, v13
  s_cmp_ge_u32 s33, 5
  s_cbranch_scc1 W_neg_73
  v_mov_b32 v112, v13
  v_mov_b32 v113, v13
  v_mov_b32 v114, v13
  v_mov_b32 v115, v13
  v_mov_b32 v116, v13
  v_mov_b32 v117, v13
  v_mov_b32 v118, v13
  v_mov_b32 v119, v13
  v_mov_b32 v120, v13
  v_mov_b32 v121, v13
  v_mov_b32 v122, v13
  v_mov_b32 v123, v13
  v_mov_b32 v124, v13
  v_mov_b32 v125, v13
  v_mov_b32 v126, v13
  v_mov_b32 v127, v13
  s_cmp_ge_u32 s33, 4
  s_cbranch_scc1 W_neg_73
  v_mov_b32 v128, v13
  v_mov_b32 v129, v13
  v_mov_b32 v130, v13
  v_mov_b32 v131, v13
  v_mov_b32 v132, v13
  v_mov_b32 v133, v13
  v_mov_b32 v134, v13
  v_mov_b32 v135, v13
  v_mov_b32 v136, v13
  v_mov_b32 v137, v13
  v_mov_b32 v138, v13
  v_mov_b32 v139, v13
  v_mov_b32 v140, v13
  v_mov_b32 v141, v13
  v_mov_b32 v142, v13
  v_mov_b32 v143, v13
  s_cmp_ge_u32 s33, 3
  s_cbranch_scc1 W_neg_73
  v_mov_b32 v144, v13
  v_mov_b32 v145, v13
  v_mov_b32 v146, v13
  v_mov_b32 v147, v13
  v_mov_b32 v148, v13
  v_mov_b32 v149, v13
  v_mov_b32 v150, v13
  v_mov_b32 v151, v13
  v_mov_b32 v152, v13
  v_mov_b32 v153, v13
  v_mov_b32 v154, v13
  v_mov_b32 v155, v13
  v_mov_b32 v156, v13
  v_mov_b32 v157, v13
  v_mov_b32 v158, v13
  v_mov_b32 v159, v13
  s_cmp_ge_u32 s33, 2
  s_cbranch_scc1 W_neg_73
  v_mov_b32 v160, v13
  v_mov_b32 v161, v13
  v_mov_b32 v162, v13
  v_mov_b32 v163, v13
  v_mov_b32 v164, v13
  v_mov_b32 v165, v13
  v_mov_b32 v166, v13
  v_mov_b32 v167, v13
  v_mov_b32 v168, v13
  v_mov_b32 v169, v13
  v_mov_b32 v170, v13
  v_mov_b32 v171, v13
  v_mov_b32 v172, v13
  v_mov_b32 v173, v13
  v_mov_b32 v174, v13
  v_mov_b32 v175, v13
  s_cmp_ge_u32 s33, 1
  s_cbranch_scc1 W_neg_73
  v_mov_b32 v176, v13
  v_mov_b32 v177, v13
  v_mov_b32 v178, v13
  v_mov_b32 v179, v13
  v_mov_b32 v180, v13
  v_mov_b32 v181, v13
  v_mov_b32 v182, v13
  v_mov_b32 v183, v13
  v_mov_b32 v184, v13
  v_mov_b32 v185, v13
  v_mov_b32 v186, v13
  v_mov_b32 v187, v13
  v_mov_b32 v188, v13
  v_mov_b32 v189, v13
  v_mov_b32 v190, v13
  v_mov_b32 v191, v13
W_neg_73:
  v_cmp_le_i32 vcc, 0, v12
  s_nop 1
  v_cndmask_b32 v192, v13, v192, vcc
  v_cndmask_b32 v64, v64, v13, vcc
  v_cmp_le_i32 vcc, 1, v12
  s_nop 1
  v_cndmask_b32 v193, v13, v193, vcc
  v_cndmask_b32 v65, v65, v13, vcc
  v_cmp_le_i32 vcc, 2, v12
  s_nop 1
  v_cndmask_b32 v194, v13, v194, vcc
  v_cndmask_b32 v66, v66, v13, vcc
  v_cmp_le_i32 vcc, 3, v12
  s_nop 1
  v_cndmask_b32 v195, v13, v195, vcc
  v_cndmask_b32 v67, v67, v13, vcc
  v_cmp_le_i32 vcc, 8, v12
  s_nop 1
  v_cndmask_b32 v196, v13, v196, vcc
  v_cndmask_b32 v68, v68, v13, vcc
  v_cmp_le_i32 vcc, 9, v12
  s_nop 1
  v_cndmask_b32 v197, v13, v197, vcc
  v_cndmask_b32 v69, v69, v13, vcc
  v_cmp_le_i32 vcc, 10, v12
  s_nop 1
  v_cndmask_b32 v198, v13, v198, vcc
  v_cndmask_b32 v70, v70, v13, vcc
  v_cmp_le_i32 vcc, 11, v12
  s_nop 1
  v_cndmask_b32 v199, v13, v199, vcc
  v_cndmask_b32 v71, v71, v13, vcc
  v_cmp_le_i32 vcc, 16, v12
  s_nop 1
  v_cndmask_b32 v200, v13, v200, vcc
  v_cndmask_b32 v72, v72, v13, vcc
  v_cmp_le_i32 vcc, 17, v12
  s_nop 1
  v_cndmask_b32 v201, v13, v201, vcc
  v_cndmask_b32 v73, v73, v13, vcc
  v_cmp_le_i32 vcc, 18, v12
  s_nop 1
  v_cndmask_b32 v202, v13, v202, vcc
  v_cndmask_b32 v74, v74, v13, vcc
  v_cmp_le_i32 vcc, 19, v12
  s_nop 1
  v_cndmask_b32 v203, v13, v203, vcc
  v_cndmask_b32 v75, v75, v13, vcc
  v_cmp_le_i32 vcc, 24, v12
  s_nop 1
  v_cndmask_b32 v204, v13, v204, vcc
  v_cndmask_b32 v76, v76, v13, vcc
  v_cmp_le_i32 vcc, 25, v12
  s_nop 1
  v_cndmask_b32 v205, v13, v205, vcc
  v_cndmask_b32 v77, v77, v13, vcc
  v_cmp_le_i32 vcc, 26, v12
  s_nop 1
  v_cndmask_b32 v206, v13, v206, vcc
  v_cndmask_b32 v78, v78, v13, vcc
  v_cmp_le_i32 vcc, 27, v12
  s_nop 1
  v_cndmask_b32 v207, v13, v207, vcc
  v_cndmask_b32 v79, v79, v13, vcc
  v_max3_f32 v14, v64, v65, v66
  v_max3_f32 v15, v67, v68, v69
  v_max3_f32 v14, v70, v71, v14
  v_max3_f32 v15, v72, v73, v15
  v_max3_f32 v14, v74, v75, v14
  v_max3_f32 v15, v76, v77, v15
  v_max3_f32 v14, v78, v79, v14
  v_max3_f32 v15, v80, v81, v15
  v_max3_f32 v14, v82, v83, v14
  v_max3_f32 v15, v84, v85, v15
  v_max3_f32 v14, v86, v87, v14
  v_max3_f32 v15, v88, v89, v15
  v_max3_f32 v14, v90, v91, v14
  v_max3_f32 v15, v92, v93, v15
  v_max3_f32 v14, v94, v95, v14
  v_max3_f32 v15, v96, v97, v15
  v_max3_f32 v14, v98, v99, v14
  v_max3_f32 v15, v100, v101, v15
  v_max3_f32 v14, v102, v103, v14
  v_max3_f32 v15, v104, v105, v15
  v_max3_f32 v14, v106, v107, v14
  v_max3_f32 v15, v108, v109, v15
  v_max3_f32 v14, v110, v111, v14
  v_max3_f32 v15, v112, v113, v15
  v_max3_f32 v14, v114, v115, v14
  v_max3_f32 v15, v116, v117, v15
  v_max3_f32 v14, v118, v119, v14
  v_max3_f32 v15, v120, v121, v15
  v_max3_f32 v14, v122, v123, v14
  v_max3_f32 v15, v124, v125, v15
  v_max3_f32 v14, v126, v127, v14
  v_max3_f32 v15, v128, v129, v15
  v_max3_f32 v14, v130, v131, v14
  v_max3_f32 v15, v132, v133, v15
  v_max3_f32 v14, v134, v135, v14
  v_max3_f32 v15, v136, v137, v15
  v_max3_f32 v14, v138, v139, v14
  v_max3_f32 v15, v140, v141, v15
  v_max3_f32 v14, v142, v143, v14
  v_max3_f32 v15, v144, v145, v15
  v_max3_f32 v14, v146, v147, v14
  v_max3_f32 v15, v148, v149, v15
  v_max3_f32 v14, v150, v151, v14
  v_max3_f32 v15, v152, v153, v15
  v_max3_f32 v14, v154, v155, v14
  v_max3_f32 v15, v156, v157, v15
  v_max3_f32 v14, v158, v159, v14
  v_max3_f32 v15, v160, v161, v15
  v_max3_f32 v14, v162, v163, v14
  v_max3_f32 v15, v164, v165, v15
  v_max3_f32 v14, v166, v167, v14
  v_max3_f32 v15, v168, v169, v15
  v_max3_f32 v14, v170, v171, v14
  v_max3_f32 v15, v172, v173, v15
  v_max3_f32 v14, v174, v175, v14
  v_max3_f32 v15, v176, v177, v15
  v_max3_f32 v14, v178, v179, v14
  v_max3_f32 v15, v180, v181, v15
  v_max3_f32 v14, v182, v183, v14
  v_max3_f32 v15, v184, v185, v15
  v_max3_f32 v14, v186, v187, v14
  v_max3_f32 v15, v188, v189, v15
  v_max3_f32 v14, v190, v191, v14
  v_max3_f32 v15, v192, v193, v15
  v_max3_f32 v14, v194, v195, v14
  v_max3_f32 v15, v196, v197, v15
  v_max3_f32 v14, v198, v199, v14
  v_max3_f32 v15, v200, v201, v15
  v_max3_f32 v14, v202, v203, v14
  v_max3_f32 v15, v204, v205, v15
  v_max3_f32 v14, v206, v207, v14
  v_max_f32 v14, v14, v15
  v_mov_b32 v15, v14
  s_mov_b32 s28, 1051011932
  s_nop 0
  v_permlane32_swap_b32 v14, v15
  s_nop 0
  v_max_f32 v14, v14, v15
  v_mul_f32 v14, s28, v14
  ds_read_b64_tr_b16 v[24:25], v10 offset:0
  ds_read_b64_tr_b16 v[26:27], v10 offset:384
  ds_read_b64_tr_b16 v[28:29], v10 offset:768
  ds_read_b64_tr_b16 v[30:31], v10 offset:1152
  v_fma_f32 v64, v64, s28, -v14
  v_fma_f32 v65, v65, s28, -v14
  v_fma_f32 v66, v66, s28, -v14
  v_fma_f32 v67, v67, s28, -v14
  v_fma_f32 v68, v68, s28, -v14
  v_fma_f32 v69, v69, s28, -v14
  v_fma_f32 v70, v70, s28, -v14
  v_fma_f32 v71, v71, s28, -v14
  v_fma_f32 v72, v72, s28, -v14
  v_fma_f32 v73, v73, s28, -v14
  v_fma_f32 v74, v74, s28, -v14
  v_fma_f32 v75, v75, s28, -v14
  v_fma_f32 v76, v76, s28, -v14
  v_fma_f32 v77, v77, s28, -v14
  v_fma_f32 v78, v78, s28, -v14
  v_fma_f32 v79, v79, s28, -v14
  v_exp_f32 v64, v64
  v_exp_f32 v65, v65
  v_exp_f32 v66, v66
  v_exp_f32 v67, v67
  v_exp_f32 v68, v68
  v_exp_f32 v69, v69
  v_exp_f32 v70, v70
  v_exp_f32 v71, v71
  v_exp_f32 v72, v72
  v_exp_f32 v73, v73
  v_exp_f32 v74, v74
  v_exp_f32 v75, v75
  v_exp_f32 v76, v76
  v_exp_f32 v77, v77
  v_exp_f32 v78, v78
  v_exp_f32 v79, v79
  v_cvt_pk_bf16_f32 v64, v64, v65
  v_cvt_pk_bf16_f32 v65, v66, v67
  v_cvt_pk_bf16_f32 v66, v68, v69
  v_cvt_pk_bf16_f32 v67, v70, v71
  v_cvt_pk_bf16_f32 v68, v72, v73
  v_cvt_pk_bf16_f32 v69, v74, v75
  v_cvt_pk_bf16_f32 v70, v76, v77
  v_cvt_pk_bf16_f32 v71, v78, v79
  ds_read_b64_tr_b16 v[32:33], v10 offset:1536
  ds_read_b64_tr_b16 v[34:35], v10 offset:1920
  ds_read_b64_tr_b16 v[36:37], v10 offset:2304
  ds_read_b64_tr_b16 v[38:39], v10 offset:2688
  s_waitcnt lgkmcnt(4)
  v_mfma_f32_32x32x16_bf16 v[40:55], v[24:27], v[64:67], 0
  v_mfma_f32_32x32x16_bf16 v[40:55], v[28:31], v[68:71], v[40:55]
  v_fma_f32 v80, v80, s28, -v14
  v_fma_f32 v81, v81, s28, -v14
  v_fma_f32 v82, v82, s28, -v14
  v_fma_f32 v83, v83, s28, -v14
  v_fma_f32 v84, v84, s28, -v14
  v_fma_f32 v85, v85, s28, -v14
  v_fma_f32 v86, v86, s28, -v14
  v_fma_f32 v87, v87, s28, -v14
  v_fma_f32 v88, v88, s28, -v14
  v_fma_f32 v89, v89, s28, -v14
  v_fma_f32 v90, v90, s28, -v14
  v_fma_f32 v91, v91, s28, -v14
  v_fma_f32 v92, v92, s28, -v14
  v_fma_f32 v93, v93, s28, -v14
  v_fma_f32 v94, v94, s28, -v14
  v_fma_f32 v95, v95, s28, -v14
  v_exp_f32 v80, v80
  v_exp_f32 v81, v81
  v_exp_f32 v82, v82
  v_exp_f32 v83, v83
  v_exp_f32 v84, v84
  v_exp_f32 v85, v85
  v_exp_f32 v86, v86
  v_exp_f32 v87, v87
  v_exp_f32 v88, v88
  v_exp_f32 v89, v89
  v_exp_f32 v90, v90
  v_exp_f32 v91, v91
  v_exp_f32 v92, v92
  v_exp_f32 v93, v93
  v_exp_f32 v94, v94
  v_exp_f32 v95, v95
  v_cvt_pk_bf16_f32 v80, v80, v81
  v_cvt_pk_bf16_f32 v81, v82, v83
  v_cvt_pk_bf16_f32 v82, v84, v85
  v_cvt_pk_bf16_f32 v83, v86, v87
  v_cvt_pk_bf16_f32 v84, v88, v89
  v_cvt_pk_bf16_f32 v85, v90, v91
  v_cvt_pk_bf16_f32 v86, v92, v93
  v_cvt_pk_bf16_f32 v87, v94, v95
  ds_read_b64_tr_b16 v[24:25], v10 offset:3072
  ds_read_b64_tr_b16 v[26:27], v10 offset:3456
  ds_read_b64_tr_b16 v[28:29], v10 offset:3840
  ds_read_b64_tr_b16 v[30:31], v10 offset:4224
  s_waitcnt lgkmcnt(4)
  v_mfma_f32_32x32x16_bf16 v[40:55], v[32:35], v[80:83], v[40:55]
  v_mfma_f32_32x32x16_bf16 v[40:55], v[36:39], v[84:87], v[40:55]
  v_fma_f32 v96, v96, s28, -v14
  v_fma_f32 v97, v97, s28, -v14
  v_fma_f32 v98, v98, s28, -v14
  v_fma_f32 v99, v99, s28, -v14
  v_fma_f32 v100, v100, s28, -v14
  v_fma_f32 v101, v101, s28, -v14
  v_fma_f32 v102, v102, s28, -v14
  v_fma_f32 v103, v103, s28, -v14
  v_fma_f32 v104, v104, s28, -v14
  v_fma_f32 v105, v105, s28, -v14
  v_fma_f32 v106, v106, s28, -v14
  v_fma_f32 v107, v107, s28, -v14
  v_fma_f32 v108, v108, s28, -v14
  v_fma_f32 v109, v109, s28, -v14
  v_fma_f32 v110, v110, s28, -v14
  v_fma_f32 v111, v111, s28, -v14
  v_exp_f32 v96, v96
  v_exp_f32 v97, v97
  v_exp_f32 v98, v98
  v_exp_f32 v99, v99
  v_exp_f32 v100, v100
  v_exp_f32 v101, v101
  v_exp_f32 v102, v102
  v_exp_f32 v103, v103
  v_exp_f32 v104, v104
  v_exp_f32 v105, v105
  v_exp_f32 v106, v106
  v_exp_f32 v107, v107
  v_exp_f32 v108, v108
  v_exp_f32 v109, v109
  v_exp_f32 v110, v110
  v_exp_f32 v111, v111
  v_cvt_pk_bf16_f32 v96, v96, v97
  v_cvt_pk_bf16_f32 v97, v98, v99
  v_cvt_pk_bf16_f32 v98, v100, v101
  v_cvt_pk_bf16_f32 v99, v102, v103
  v_cvt_pk_bf16_f32 v100, v104, v105
  v_cvt_pk_bf16_f32 v101, v106, v107
  v_cvt_pk_bf16_f32 v102, v108, v109
  v_cvt_pk_bf16_f32 v103, v110, v111
  ds_read_b64_tr_b16 v[32:33], v10 offset:4608
  ds_read_b64_tr_b16 v[34:35], v10 offset:4992
  ds_read_b64_tr_b16 v[36:37], v10 offset:5376
  ds_read_b64_tr_b16 v[38:39], v10 offset:5760
  s_waitcnt lgkmcnt(4)
  v_mfma_f32_32x32x16_bf16 v[40:55], v[24:27], v[96:99], v[40:55]
  v_mfma_f32_32x32x16_bf16 v[40:55], v[28:31], v[100:103], v[40:55]
  v_fma_f32 v112, v112, s28, -v14
  v_fma_f32 v113, v113, s28, -v14
  v_fma_f32 v114, v114, s28, -v14
  v_fma_f32 v115, v115, s28, -v14
  v_fma_f32 v116, v116, s28, -v14
  v_fma_f32 v117, v117, s28, -v14
  v_fma_f32 v118, v118, s28, -v14
  v_fma_f32 v119, v119, s28, -v14
  v_fma_f32 v120, v120, s28, -v14
  v_fma_f32 v121, v121, s28, -v14
  v_fma_f32 v122, v122, s28, -v14
  v_fma_f32 v123, v123, s28, -v14
  v_fma_f32 v124, v124, s28, -v14
  v_fma_f32 v125, v125, s28, -v14
  v_fma_f32 v126, v126, s28, -v14
  v_fma_f32 v127, v127, s28, -v14
  v_exp_f32 v112, v112
  v_exp_f32 v113, v113
  v_exp_f32 v114, v114
  v_exp_f32 v115, v115
  v_exp_f32 v116, v116
  v_exp_f32 v117, v117
  v_exp_f32 v118, v118
  v_exp_f32 v119, v119
  v_exp_f32 v120, v120
  v_exp_f32 v121, v121
  v_exp_f32 v122, v122
  v_exp_f32 v123, v123
  v_exp_f32 v124, v124
  v_exp_f32 v125, v125
  v_exp_f32 v126, v126
  v_exp_f32 v127, v127
  v_cvt_pk_bf16_f32 v112, v112, v113
  v_cvt_pk_bf16_f32 v113, v114, v115
  v_cvt_pk_bf16_f32 v114, v116, v117
  v_cvt_pk_bf16_f32 v115, v118, v119
  v_cvt_pk_bf16_f32 v116, v120, v121
  v_cvt_pk_bf16_f32 v117, v122, v123
  v_cvt_pk_bf16_f32 v118, v124, v125
  v_cvt_pk_bf16_f32 v119, v126, v127
  ds_read_b64_tr_b16 v[24:25], v10 offset:6144
  ds_read_b64_tr_b16 v[26:27], v10 offset:6528
  ds_read_b64_tr_b16 v[28:29], v10 offset:6912
  ds_read_b64_tr_b16 v[30:31], v10 offset:7296
  s_waitcnt lgkmcnt(4)
  v_mfma_f32_32x32x16_bf16 v[40:55], v[32:35], v[112:115], v[40:55]
  v_mfma_f32_32x32x16_bf16 v[40:55], v[36:39], v[116:119], v[40:55]
  v_fma_f32 v128, v128, s28, -v14
  v_fma_f32 v129, v129, s28, -v14
  v_fma_f32 v130, v130, s28, -v14
  v_fma_f32 v131, v131, s28, -v14
  v_fma_f32 v132, v132, s28, -v14
  v_fma_f32 v133, v133, s28, -v14
  v_fma_f32 v134, v134, s28, -v14
  v_fma_f32 v135, v135, s28, -v14
  v_fma_f32 v136, v136, s28, -v14
  v_fma_f32 v137, v137, s28, -v14
  v_fma_f32 v138, v138, s28, -v14
  v_fma_f32 v139, v139, s28, -v14
  v_fma_f32 v140, v140, s28, -v14
  v_fma_f32 v141, v141, s28, -v14
  v_fma_f32 v142, v142, s28, -v14
  v_fma_f32 v143, v143, s28, -v14
  v_exp_f32 v128, v128
  v_exp_f32 v129, v129
  v_exp_f32 v130, v130
  v_exp_f32 v131, v131
  v_exp_f32 v132, v132
  v_exp_f32 v133, v133
  v_exp_f32 v134, v134
  v_exp_f32 v135, v135
  v_exp_f32 v136, v136
  v_exp_f32 v137, v137
  v_exp_f32 v138, v138
  v_exp_f32 v139, v139
  v_exp_f32 v140, v140
  v_exp_f32 v141, v141
  v_exp_f32 v142, v142
  v_exp_f32 v143, v143
  v_cvt_pk_bf16_f32 v128, v128, v129
  v_cvt_pk_bf16_f32 v129, v130, v131
  v_cvt_pk_bf16_f32 v130, v132, v133
  v_cvt_pk_bf16_f32 v131, v134, v135
  v_cvt_pk_bf16_f32 v132, v136, v137
  v_cvt_pk_bf16_f32 v133, v138, v139
  v_cvt_pk_bf16_f32 v134, v140, v141
  v_cvt_pk_bf16_f32 v135, v142, v143
  ds_read_b64_tr_b16 v[32:33], v10 offset:7680
  ds_read_b64_tr_b16 v[34:35], v10 offset:8064
  ds_read_b64_tr_b16 v[36:37], v10 offset:8448
  ds_read_b64_tr_b16 v[38:39], v10 offset:8832
  s_waitcnt lgkmcnt(4)
  v_mfma_f32_32x32x16_bf16 v[40:55], v[24:27], v[128:131], v[40:55]
  v_mfma_f32_32x32x16_bf16 v[40:55], v[28:31], v[132:135], v[40:55]
  v_fma_f32 v144, v144, s28, -v14
  v_fma_f32 v145, v145, s28, -v14
  v_fma_f32 v146, v146, s28, -v14
  v_fma_f32 v147, v147, s28, -v14
  v_fma_f32 v148, v148, s28, -v14
  v_fma_f32 v149, v149, s28, -v14
  v_fma_f32 v150, v150, s28, -v14
  v_fma_f32 v151, v151, s28, -v14
  v_fma_f32 v152, v152, s28, -v14
  v_fma_f32 v153, v153, s28, -v14
  v_fma_f32 v154, v154, s28, -v14
  v_fma_f32 v155, v155, s28, -v14
  v_fma_f32 v156, v156, s28, -v14
  v_fma_f32 v157, v157, s28, -v14
  v_fma_f32 v158, v158, s28, -v14
  v_fma_f32 v159, v159, s28, -v14
  v_exp_f32 v144, v144
  v_exp_f32 v145, v145
  v_exp_f32 v146, v146
  v_exp_f32 v147, v147
  v_exp_f32 v148, v148
  v_exp_f32 v149, v149
  v_exp_f32 v150, v150
  v_exp_f32 v151, v151
  v_exp_f32 v152, v152
  v_exp_f32 v153, v153
  v_exp_f32 v154, v154
  v_exp_f32 v155, v155
  v_exp_f32 v156, v156
  v_exp_f32 v157, v157
  v_exp_f32 v158, v158
  v_exp_f32 v159, v159
  v_cvt_pk_bf16_f32 v144, v144, v145
  v_cvt_pk_bf16_f32 v145, v146, v147
  v_cvt_pk_bf16_f32 v146, v148, v149
  v_cvt_pk_bf16_f32 v147, v150, v151
  v_cvt_pk_bf16_f32 v148, v152, v153
  v_cvt_pk_bf16_f32 v149, v154, v155
  v_cvt_pk_bf16_f32 v150, v156, v157
  v_cvt_pk_bf16_f32 v151, v158, v159
  ds_read_b64_tr_b16 v[24:25], v10 offset:9216
  ds_read_b64_tr_b16 v[26:27], v10 offset:9600
  ds_read_b64_tr_b16 v[28:29], v10 offset:9984
  ds_read_b64_tr_b16 v[30:31], v10 offset:10368
  s_waitcnt lgkmcnt(4)
  v_mfma_f32_32x32x16_bf16 v[40:55], v[32:35], v[144:147], v[40:55]
  v_mfma_f32_32x32x16_bf16 v[40:55], v[36:39], v[148:151], v[40:55]
  v_fma_f32 v160, v160, s28, -v14
  v_fma_f32 v161, v161, s28, -v14
  v_fma_f32 v162, v162, s28, -v14
  v_fma_f32 v163, v163, s28, -v14
  v_fma_f32 v164, v164, s28, -v14
  v_fma_f32 v165, v165, s28, -v14
  v_fma_f32 v166, v166, s28, -v14
  v_fma_f32 v167, v167, s28, -v14
  v_fma_f32 v168, v168, s28, -v14
  v_fma_f32 v169, v169, s28, -v14
  v_fma_f32 v170, v170, s28, -v14
  v_fma_f32 v171, v171, s28, -v14
  v_fma_f32 v172, v172, s28, -v14
  v_fma_f32 v173, v173, s28, -v14
  v_fma_f32 v174, v174, s28, -v14
  v_fma_f32 v175, v175, s28, -v14
  v_exp_f32 v160, v160
  v_exp_f32 v161, v161
  v_exp_f32 v162, v162
  v_exp_f32 v163, v163
  v_exp_f32 v164, v164
  v_exp_f32 v165, v165
  v_exp_f32 v166, v166
  v_exp_f32 v167, v167
  v_exp_f32 v168, v168
  v_exp_f32 v169, v169
  v_exp_f32 v170, v170
  v_exp_f32 v171, v171
  v_exp_f32 v172, v172
  v_exp_f32 v173, v173
  v_exp_f32 v174, v174
  v_exp_f32 v175, v175
  v_cvt_pk_bf16_f32 v160, v160, v161
  v_cvt_pk_bf16_f32 v161, v162, v163
  v_cvt_pk_bf16_f32 v162, v164, v165
  v_cvt_pk_bf16_f32 v163, v166, v167
  v_cvt_pk_bf16_f32 v164, v168, v169
  v_cvt_pk_bf16_f32 v165, v170, v171
  v_cvt_pk_bf16_f32 v166, v172, v173
  v_cvt_pk_bf16_f32 v167, v174, v175
  ds_read_b64_tr_b16 v[32:33], v10 offset:10752
  ds_read_b64_tr_b16 v[34:35], v10 offset:11136
  ds_read_b64_tr_b16 v[36:37], v10 offset:11520
  ds_read_b64_tr_b16 v[38:39], v10 offset:11904
  s_waitcnt lgkmcnt(4)
  v_mfma_f32_32x32x16_bf16 v[40:55], v[24:27], v[160:163], v[40:55]
  v_mfma_f32_32x32x16_bf16 v[40:55], v[28:31], v[164:167], v[40:55]
  v_fma_f32 v176, v176, s28, -v14
  v_fma_f32 v177, v177, s28, -v14
  v_fma_f32 v178, v178, s28, -v14
  v_fma_f32 v179, v179, s28, -v14
  v_fma_f32 v180, v180, s28, -v14
  v_fma_f32 v181, v181, s28, -v14
  v_fma_f32 v182, v182, s28, -v14
  v_fma_f32 v183, v183, s28, -v14
  v_fma_f32 v184, v184, s28, -v14
  v_fma_f32 v185, v185, s28, -v14
  v_fma_f32 v186, v186, s28, -v14
  v_fma_f32 v187, v187, s28, -v14
  v_fma_f32 v188, v188, s28, -v14
  v_fma_f32 v189, v189, s28, -v14
  v_fma_f32 v190, v190, s28, -v14
  v_fma_f32 v191, v191, s28, -v14
  v_exp_f32 v176, v176
  v_exp_f32 v177, v177
  v_exp_f32 v178, v178
  v_exp_f32 v179, v179
  v_exp_f32 v180, v180
  v_exp_f32 v181, v181
  v_exp_f32 v182, v182
  v_exp_f32 v183, v183
  v_exp_f32 v184, v184
  v_exp_f32 v185, v185
  v_exp_f32 v186, v186
  v_exp_f32 v187, v187
  v_exp_f32 v188, v188
  v_exp_f32 v189, v189
  v_exp_f32 v190, v190
  v_exp_f32 v191, v191
  v_cvt_pk_bf16_f32 v176, v176, v177
  v_cvt_pk_bf16_f32 v177, v178, v179
  v_cvt_pk_bf16_f32 v178, v180, v181
  v_cvt_pk_bf16_f32 v179, v182, v183
  v_cvt_pk_bf16_f32 v180, v184, v185
  v_cvt_pk_bf16_f32 v181, v186, v187
  v_cvt_pk_bf16_f32 v182, v188, v189
  v_cvt_pk_bf16_f32 v183, v190, v191
  ds_read_b64_tr_b16 v[24:25], v10 offset:12288
  ds_read_b64_tr_b16 v[26:27], v10 offset:12672
  ds_read_b64_tr_b16 v[28:29], v10 offset:13056
  ds_read_b64_tr_b16 v[30:31], v10 offset:13440
  s_waitcnt lgkmcnt(4)
  v_mfma_f32_32x32x16_bf16 v[40:55], v[32:35], v[176:179], v[40:55]
  v_mfma_f32_32x32x16_bf16 v[40:55], v[36:39], v[180:183], v[40:55]
  v_fma_f32 v192, v192, s28, -v14
  v_fma_f32 v193, v193, s28, -v14
  v_fma_f32 v194, v194, s28, -v14
  v_fma_f32 v195, v195, s28, -v14
  v_fma_f32 v196, v196, s28, -v14
  v_fma_f32 v197, v197, s28, -v14
  v_fma_f32 v198, v198, s28, -v14
  v_fma_f32 v199, v199, s28, -v14
  v_fma_f32 v200, v200, s28, -v14
  v_fma_f32 v201, v201, s28, -v14
  v_fma_f32 v202, v202, s28, -v14
  v_fma_f32 v203, v203, s28, -v14
  v_fma_f32 v204, v204, s28, -v14
  v_fma_f32 v205, v205, s28, -v14
  v_fma_f32 v206, v206, s28, -v14
  v_fma_f32 v207, v207, s28, -v14
  v_exp_f32 v192, v192
  v_exp_f32 v193, v193
  v_exp_f32 v194, v194
  v_exp_f32 v195, v195
  v_exp_f32 v196, v196
  v_exp_f32 v197, v197
  v_exp_f32 v198, v198
  v_exp_f32 v199, v199
  v_exp_f32 v200, v200
  v_exp_f32 v201, v201
  v_exp_f32 v202, v202
  v_exp_f32 v203, v203
  v_exp_f32 v204, v204
  v_exp_f32 v205, v205
  v_exp_f32 v206, v206
  v_exp_f32 v207, v207
  v_cvt_pk_bf16_f32 v192, v192, v193
  v_cvt_pk_bf16_f32 v193, v194, v195
  v_cvt_pk_bf16_f32 v194, v196, v197
  v_cvt_pk_bf16_f32 v195, v198, v199
  v_cvt_pk_bf16_f32 v196, v200, v201
  v_cvt_pk_bf16_f32 v197, v202, v203
  v_cvt_pk_bf16_f32 v198, v204, v205
  v_cvt_pk_bf16_f32 v199, v206, v207
  s_waitcnt lgkmcnt(0)
  s_nop 0
  v_mfma_f32_32x32x16_bf16 v[40:55], v[24:27], v[192:195], v[40:55]
  v_mfma_f32_32x32x16_bf16 v[40:55], v[28:31], v[196:199], v[40:55]
  s_mul_i32 s30, s33, 40960
  s_add_u32 s30, s30, 190840832
  s_mul_i32 s28, s45, 40
  s_add_u32 s30, s30, s28
  v_mul_u32_u24 v16, 1280, v5
  v_lshl_add_u32 v16, v6, 3, v16
  s_nop 11
  v_mov_b32 v8, v48
  v_mov_b32 v9, v48
  s_nop 0
  v_permlane32_swap_b32 v8, v9
  s_nop 0
  v_rcp_f32 v9, v9
  s_nop 0
  v_mul_f32 v40, v40, v9
  v_mul_f32 v41, v41, v9
  v_mul_f32 v42, v42, v9
  v_mul_f32 v43, v43, v9
  v_mul_f32 v44, v44, v9
  v_mul_f32 v45, v45, v9
  v_mul_f32 v46, v46, v9
  v_mul_f32 v47, v47, v9
  v_mul_f32 v48, v48, v9
  v_mul_f32 v49, v49, v9
  v_mul_f32 v50, v50, v9
  v_mul_f32 v51, v51, v9
  v_cvt_pk_bf16_f32 v24, v40, v41
  v_cvt_pk_bf16_f32 v25, v42, v43
  v_cvt_pk_bf16_f32 v26, v44, v45
  v_cvt_pk_bf16_f32 v27, v46, v47
  v_cvt_pk_bf16_f32 v28, v48, v49
  v_cvt_pk_bf16_f32 v29, v50, v51
  buffer_store_dwordx2 v[24:25], v16, s[8:11], s30 offen sc1
  buffer_store_dwordx2 v[26:27], v16, s[8:11], s30 offen offset:16 sc1
  s_mov_b32 exec_hi, 0
  buffer_store_dwordx2 v[28:29], v16, s[8:11], s30 offen offset:32 sc1
  s_mov_b64 exec, -1
  s_lshr_b32 s26, s44, 1
  s_lshl_b32 s26, s26, 7
  s_add_u32 s26, s26, 6308864
  s_waitcnt vmcnt(0)
  s_barrier
  s_cmp_lg_u32 s24, 0
  s_cbranch_scc1 W_fl_74
  v_mov_b32 v2, 1
  v_mov_b32 v3, 0
  s_mov_b64 exec, 1
  buffer_atomic_add v2, v3, s[8:11], s26 offen sc1
  s_mov_b64 exec, -1
W_fl_74:
  s_branch W_next
W_done:
  s_branch L_fin
M_chain:
  s_mov_b32 s47, 201326592
  s_cmp_ge_u32 s26, 16
  s_cbranch_scc1 M_vo
  s_lshl_b32 s27, s25, 4
  s_add_u32 s27, s27, s26
  v_and_b32 v1, 63, v0
  s_load_dwordx4 s[32:35], s[0:1], 16
  s_load_dwordx2 s[20:21], s[0:1], 8
  s_waitcnt lgkmcnt(0)
  s_cmp_lt_u32 s24, 2
  s_cselect_b32 s12, s32, s34
  s_cselect_b32 s13, s33, s35
  s_mov_b32 s14, 7864320
  s_mov_b32 s15, 0x20000
  s_mov_b32 s22, 10240
  s_mov_b32 s23, 0x20000
  s_and_b32 s30, s24, 1
  s_mul_i32 s30, s30, 384
  s_add_u32 s30, s30, 0
  v_add_u32 v2, s30, v1
  v_mul_u32_u24 v3, 2731, v2
  v_lshrrev_b32 v3, 16, v3
  v_mul_u32_u24 v4, 24, v3
  v_sub_u32 v4, v2, v4
  v_mul_u32_u24 v3, 12288, v3
  v_lshl_add_u32 v40, v4, 4, v3
  s_and_b32 s30, s24, 1
  s_mul_i32 s30, s30, 384
  s_add_u32 s30, s30, 64
  v_add_u32 v2, s30, v1
  v_mul_u32_u24 v3, 2731, v2
  v_lshrrev_b32 v3, 16, v3
  v_mul_u32_u24 v4, 24, v3
  v_sub_u32 v4, v2, v4
  v_mul_u32_u24 v3, 12288, v3
  v_lshl_add_u32 v41, v4, 4, v3
  s_and_b32 s30, s24, 1
  s_mul_i32 s30, s30, 384
  s_add_u32 s30, s30, 128
  v_add_u32 v2, s30, v1
  v_mul_u32_u24 v3, 2731, v2
  v_lshrrev_b32 v3, 16, v3
  v_mul_u32_u24 v4, 24, v3
  v_sub_u32 v4, v2, v4
  v_mul_u32_u24 v3, 12288, v3
  v_lshl_add_u32 v42, v4, 4, v3
  s_and_b32 s30, s24, 1
  s_mul_i32 s30, s30, 384
  s_add_u32 s30, s30, 192
  v_add_u32 v2, s30, v1
  v_mul_u32_u24 v3, 2731, v2
  v_lshrrev_b32 v3, 16, v3
  v_mul_u32_u24 v4, 24, v3
  v_sub_u32 v4, v2, v4
  v_mul_u32_u24 v3, 12288, v3
  v_lshl_add_u32 v43, v4, 4, v3
  s_and_b32 s30, s24, 1
  s_mul_i32 s30, s30, 384
  s_add_u32 s30, s30, 256
  v_add_u32 v2, s30, v1
  v_mul_u32_u24 v3, 2731, v2
  v_lshrrev_b32 v3, 16, v3
  v_mul_u32_u24 v4, 24, v3
  v_sub_u32 v4, v2, v4
  v_mul_u32_u24 v3, 12288, v3
  v_lshl_add_u32 v44, v4, 4, v3
  s_and_b32 s30, s24, 1
  s_mul_i32 s30, s30, 384
  s_add_u32 s30, s30, 320
  v_add_u32 v2, s30, v1
  v_mul_u32_u24 v3, 2731, v2
  v_lshrrev_b32 v3, 16, v3
  v_mul_u32_u24 v4, 24, v3
  v_sub_u32 v4, v2, v4
  v_mul_u32_u24 v3, 12288, v3
  v_lshl_add_u32 v45, v4, 4, v3
  v_bfe_u32 v2, v1, 3, 1
  v_mul_u32_u24 v2, 12288, v2
  v_lshrrev_b32 v3, 4, v1
  v_lshlrev_b32 v3, 2, v3
  v_bfe_u32 v4, v1, 2, 1
  v_add_u32 v3, v3, v4
  v_mul_u32_u24 v3, 384, v3
  v_add_u32 v2, v2, v3
  s_mul_i32 s30, s24, 48
  s_and_b32 s31, s24, 1
  s_lshl_b32 s32, s31, 4
  s_add_u32 s32, s32, s30
  s_xor_b32 s31, s31, 1
  s_lshl_b32 s33, s31, 5
  s_add_u32 s33, s33, s30
  v_bfe_u32 v3, v1, 1, 1
  v_and_b32 v4, 1, v1
  v_lshlrev_b32 v3, 4, v3
  v_lshl_add_u32 v3, v4, 2, v3
  v_add_u32 v3, s32, v3
  v_lshl_add_u32 v46, v3, 1, v2
  v_add_u32 v47, 16, v46
  v_and_b32 v3, 3, v1
  v_lshlrev_b32 v3, 2, v3
  v_add_u32 v3, s33, v3
  v_lshl_add_u32 v48, v3, 1, v2
  v_lshlrev_b32 v31, 4, v1
  s_mul_i32 s34, s27, 384
  s_mul_i32 s35, s24, 6144
  v_add_u32 v52, s35, v31
  s_add_u32 m0, s35, 49152
  s_add_u32 s36, s34, 0
  buffer_load_dwordx4 v40, s[12:15], s36 offen  lds
  s_add_u32 m0, m0, 1024
  s_nop 0
  buffer_load_dwordx4 v41, s[12:15], s36 offen  lds
  s_add_u32 m0, m0, 1024
  s_nop 0
  buffer_load_dwordx4 v42, s[12:15], s36 offen  lds
  s_add_u32 m0, m0, 1024
  s_nop 0
  buffer_load_dwordx4 v43, s[12:15], s36 offen  lds
  s_add_u32 m0, m0, 1024
  s_nop 0
  buffer_load_dwordx4 v44, s[12:15], s36 offen  lds
  s_add_u32 m0, m0, 1024
  s_nop 0
  buffer_load_dwordx4 v45, s[12:15], s36 offen  lds
  s_add_u32 m0, s35, 73728
  s_add_u32 s36, s34, 393216
  buffer_load_dwordx4 v40, s[12:15], s36 offen  lds
  s_add_u32 m0, m0, 1024
  s_nop 0
  buffer_load_dwordx4 v41, s[12:15], s36 offen  lds
  s_add_u32 m0, m0, 1024
  s_nop 0
  buffer_load_dwordx4 v42, s[12:15], s36 offen  lds
  s_add_u32 m0, m0, 1024
  s_nop 0
  buffer_load_dwordx4 v43, s[12:15], s36 offen  lds
  s_add_u32 m0, m0, 1024
  s_nop 0
  buffer_load_dwordx4 v44, s[12:15], s36 offen  lds
  s_add_u32 m0, m0, 1024
  s_nop 0
  buffer_load_dwordx4 v45, s[12:15], s36 offen  lds
  s_add_u32 m0, s35, 98304
  s_add_u32 s36, s34, 786432
  buffer_load_dwordx4 v40, s[12:15], s36 offen  lds
  s_add_u32 m0, m0, 1024
  s_nop 0
  buffer_load_dwordx4 v41, s[12:15], s36 offen  lds
  s_add_u32 m0, m0, 1024
  s_nop 0
  buffer_load_dwordx4 v42, s[12:15], s36 offen  lds
  s_add_u32 m0, m0, 1024
  s_nop 0
  buffer_load_dwordx4 v43, s[12:15], s36 offen  lds
  s_add_u32 m0, m0, 1024
  s_nop 0
  buffer_load_dwordx4 v44, s[12:15], s36 offen  lds
  s_add_u32 m0, m0, 1024
  s_nop 0
  buffer_load_dwordx4 v45, s[12:15], s36 offen  lds
  s_add_u32 m0, s35, 122880
  s_add_u32 s36, s34, 1179648
  buffer_load_dwordx4 v40, s[12:15], s36 offen  lds
  s_add_u32 m0, m0, 1024
  s_nop 0
  buffer_load_dwordx4 v41, s[12:15], s36 offen  lds
  s_add_u32 m0, m0, 1024
  s_nop 0
  buffer_load_dwordx4 v42, s[12:15], s36 offen  lds
  s_add_u32 m0, m0, 1024
  s_nop 0
  buffer_load_dwordx4 v43, s[12:15], s36 offen  lds
  s_add_u32 m0, m0, 1024
  s_nop 0
  buffer_load_dwordx4 v44, s[12:15], s36 offen  lds
  s_add_u32 m0, m0, 1024
  s_nop 0
  buffer_load_dwordx4 v45, s[12:15], s36 offen  lds
  s_cmp_eq_u32 s81, 0
  s_cbranch_scc1 C_in_75x
  v_and_b32 v1, 63, v0
  v_lshlrev_b32 v60, 4, v1
  v_mov_b32 v62, -1
  v_mov_b32 v66, 0
  v_mov_b32 v63, -1
  v_mov_b32 v67, 0
  v_mov_b32 v64, -1
  v_mov_b32 v68, 0
  v_mov_b32 v65, -1
  v_mov_b32 v69, 0
  s_lshr_b32 s60, s2, 2
  s_lshl_b32 s61, s60, 17
  s_and_b32 s60, s2, 1
  s_lshl_b32 s60, s60, 13
  s_add_u32 s61, s61, s60
  s_add_u32 s61, s61, 201326592
  s_and_b32 s60, s2, 2
  s_lshl_b32 s60, s60, 14
  s_add_u32 s62, s61, s60
  s_lshl_b32 s60, s24, 11
  s_add_u32 s62, s62, s60
  buffer_store_dwordx4 v[62:65], v60, s[8:11], s62 offen offset:0 sc1
  buffer_store_dwordx4 v[62:65], v60, s[8:11], s62 offen offset:1024 sc1
  s_lshr_b32 s60, s24, 1
  s_lshl_b32 s60, s60, 12
  s_add_u32 s61, s61, s60
  s_and_b32 s60, s24, 1
  s_lshl_b32 s60, s60, 10
  s_add_u32 s61, s61, s60
  s_add_u32 s61, s61, 65536
  buffer_store_dwordx4 v[62:65], v60, s[8:11], s61 offen sc1
  s_cmp_eq_u32 s24, 3
  s_cbranch_scc1 C_in_75_w3
  s_mul_i32 s60, s2, 3
  s_add_u32 s60, s60, s24
  s_cmp_ge_u32 s60, 384
  s_cselect_b32 s61, 384, 0
  s_cselect_b32 s62, 1048576, 0
  s_add_u32 s62, s62, 4194304
  s_sub_u32 s60, s60, s61
  s_lshl_b32 s61, s60, 10
  s_add_u32 s61, s61, s62
  s_lshr_b32 s60, s60, 3
  s_cmp_eq_u32 s60, 2
  s_cbranch_scc1 C_in_75_z
  buffer_store_dwordx4 v[62:65], v60, s[8:11], s61 offen sc1
  s_branch C_in_75_d
C_in_75_w3:
  s_cmp_ge_u32 s2, 128
  s_cbranch_scc1 C_in_75_d
  s_lshl_b32 s61, s2, 10
  s_add_u32 s61, s61, 6291456
C_in_75_z:
  buffer_store_dwordx4 v[66:69], v60, s[8:11], s61 offen sc1
C_in_75_d:
C_in_75x:
  s_cmp_eq_u32 s81, 0
  s_cbranch_scc1 C_w_76a
  s_waitcnt vmcnt(21)
  s_branch C_w_76b
C_w_76a:
  s_waitcnt vmcnt(18)
C_w_76b:
  s_barrier
  s_nop 0
  v_add_u32 v49, 49152, v46
  v_add_u32 v50, 49152, v47
  v_add_u32 v51, 49152, v48
  ds_read_b64_tr_b16 a[0:1], v49 offset:0
  ds_read_b64_tr_b16 a[2:3], v49 offset:768
  ds_read_b64_tr_b16 a[4:5], v49 offset:6144
  ds_read_b64_tr_b16 a[6:7], v49 offset:6912
  ds_read_b64_tr_b16 a[8:9], v50 offset:0
  ds_read_b64_tr_b16 a[10:11], v50 offset:768
  ds_read_b64_tr_b16 a[12:13], v50 offset:6144
  ds_read_b64_tr_b16 a[14:15], v50 offset:6912
  ds_read_b64_tr_b16 a[16:17], v51 offset:0
  ds_read_b64_tr_b16 a[18:19], v51 offset:768
  ds_read_b64_tr_b16 a[20:21], v51 offset:6144
  ds_read_b64_tr_b16 a[22:23], v51 offset:6912
  s_waitcnt lgkmcnt(4)
  s_waitcnt lgkmcnt(0)
  s_cmp_eq_u32 s81, 0
  s_cbranch_scc1 C_w_77a
  s_waitcnt vmcnt(15)
  s_branch C_w_77b
C_w_77a:
  s_waitcnt vmcnt(12)
C_w_77b:
  s_barrier
  s_add_u32 m0, s35, 0
  s_add_u32 s36, s34, 1966080
  buffer_load_dwordx4 v40, s[12:15], s36 offen  lds
  s_add_u32 m0, m0, 1024
  s_nop 0
  buffer_load_dwordx4 v41, s[12:15], s36 offen  lds
  s_add_u32 m0, m0, 1024
  s_nop 0
  buffer_load_dwordx4 v42, s[12:15], s36 offen  lds
  s_add_u32 m0, m0, 1024
  s_nop 0
  buffer_load_dwordx4 v43, s[12:15], s36 offen  lds
  s_add_u32 m0, m0, 1024
  s_nop 0
  buffer_load_dwordx4 v44, s[12:15], s36 offen  lds
  s_add_u32 m0, m0, 1024
  s_nop 0
  buffer_load_dwordx4 v45, s[12:15], s36 offen  lds
  v_add_u32 v49, 73728, v46
  v_add_u32 v50, 73728, v47
  v_add_u32 v51, 73728, v48
  ds_read_b64_tr_b16 a[24:25], v49 offset:0
  ds_read_b64_tr_b16 a[26:27], v49 offset:768
  ds_read_b64_tr_b16 a[28:29], v49 offset:6144
  ds_read_b64_tr_b16 a[30:31], v49 offset:6912
  ds_read_b64_tr_b16 a[32:33], v50 offset:0
  ds_read_b64_tr_b16 a[34:35], v50 offset:768
  ds_read_b64_tr_b16 a[36:37], v50 offset:6144
  ds_read_b64_tr_b16 a[38:39], v50 offset:6912
  ds_read_b64_tr_b16 a[40:41], v51 offset:0
  ds_read_b64_tr_b16 a[42:43], v51 offset:768
  ds_read_b64_tr_b16 a[44:45], v51 offset:6144
  ds_read_b64_tr_b16 a[46:47], v51 offset:6912
  s_waitcnt lgkmcnt(4)
  s_waitcnt lgkmcnt(0)
  s_cmp_eq_u32 s81, 0
  s_cbranch_scc1 C_w_78a
  s_waitcnt vmcnt(15)
  s_branch C_w_78b
C_w_78a:
  s_waitcnt vmcnt(12)
C_w_78b:
  s_barrier
  s_add_u32 m0, s35, 24576
  s_add_u32 s36, s34, 2359296
  buffer_load_dwordx4 v40, s[12:15], s36 offen  lds
  s_add_u32 m0, m0, 1024
  s_nop 0
  buffer_load_dwordx4 v41, s[12:15], s36 offen  lds
  s_add_u32 m0, m0, 1024
  s_nop 0
  buffer_load_dwordx4 v42, s[12:15], s36 offen  lds
  s_add_u32 m0, m0, 1024
  s_nop 0
  buffer_load_dwordx4 v43, s[12:15], s36 offen  lds
  s_add_u32 m0, m0, 1024
  s_nop 0
  buffer_load_dwordx4 v44, s[12:15], s36 offen  lds
  s_add_u32 m0, m0, 1024
  s_nop 0
  buffer_load_dwordx4 v45, s[12:15], s36 offen  lds
  v_add_u32 v49, 98304, v46
  v_add_u32 v50, 98304, v47
  v_add_u32 v51, 98304, v48
  ds_read_b64_tr_b16 a[48:49], v49 offset:0
  ds_read_b64_tr_b16 a[50:51], v49 offset:768
  ds_read_b64_tr_b16 a[52:53], v49 offset:6144
  ds_read_b64_tr_b16 a[54:55], v49 offset:6912
  ds_read_b64_tr_b16 a[56:57], v50 offset:0
  ds_read_b64_tr_b16 a[58:59], v50 offset:768
  ds_read_b64_tr_b16 a[60:61], v50 offset:6144
  ds_read_b64_tr_b16 a[62:63], v50 offset:6912
  ds_read_b64_tr_b16 a[64:65], v51 offset:0
  ds_read_b64_tr_b16 a[66:67], v51 offset:768
  ds_read_b64_tr_b16 a[68:69], v51 offset:6144
  ds_read_b64_tr_b16 a[70:71], v51 offset:6912
  s_waitcnt lgkmcnt(4)
  s_waitcnt lgkmcnt(0)
  s_cmp_eq_u32 s81, 0
  s_cbranch_scc1 C_w_79a
  s_waitcnt vmcnt(15)
  s_branch C_w_79b
C_w_79a:
  s_waitcnt vmcnt(12)
C_w_79b:
  s_barrier
  s_add_u32 m0, s35, 49152
  s_add_u32 s36, s34, 2752512
  buffer_load_dwordx4 v40, s[12:15], s36 offen  lds
  s_add_u32 m0, m0, 1024
  s_nop 0
  buffer_load_dwordx4 v41, s[12:15], s36 offen  lds
  s_add_u32 m0, m0, 1024
  s_nop 0
  buffer_load_dwordx4 v42, s[12:15], s36 offen  lds
  s_add_u32 m0, m0, 1024
  s_nop 0
  buffer_load_dwordx4 v43, s[12:15], s36 offen  lds
  s_add_u32 m0, m0, 1024
  s_nop 0
  buffer_load_dwordx4 v44, s[12:15], s36 offen  lds
  s_add_u32 m0, m0, 1024
  s_nop 0
  buffer_load_dwordx4 v45, s[12:15], s36 offen  lds
  v_add_u32 v49, 122880, v46
  v_add_u32 v50, 122880, v47
  v_add_u32 v51, 122880, v48
  ds_read_b64_tr_b16 a[72:73], v49 offset:0
  ds_read_b64_tr_b16 a[74:75], v49 offset:768
  ds_read_b64_tr_b16 a[76:77], v49 offset:6144
  ds_read_b64_tr_b16 a[78:79], v49 offset:6912
  ds_read_b64_tr_b16 a[80:81], v50 offset:0
  ds_read_b64_tr_b16 a[82:83], v50 offset:768
  ds_read_b64_tr_b16 a[84:85], v50 offset:6144
  ds_read_b64_tr_b16 a[86:87], v50 offset:6912
  ds_read_b64_tr_b16 a[88:89], v51 offset:0
  ds_read_b64_tr_b16 a[90:91], v51 offset:768
  ds_read_b64_tr_b16 a[92:93], v51 offset:6144
  ds_read_b64_tr_b16 a[94:95], v51 offset:6912
  s_waitcnt lgkmcnt(4)
  s_waitcnt lgkmcnt(0)
  s_waitcnt vmcnt(12)
  s_barrier
  s_cmp_eq_u32 s81, 0
  s_cbranch_scc1 C_ar_80x
  s_cmp_lg_u32 s24, 1
  s_cbranch_scc1 C_ar_80
  v_mov_b32 v5, 1
  s_mov_b64 exec, 1
  buffer_atomic_add v5, off, s[4:7], 0 offset:32 sc1
  s_mov_b64 exec, -1
C_ar_80:
C_ar_80x:
  s_add_u32 m0, s35, 73728
  s_add_u32 s36, s34, 3145728
  buffer_load_dwordx4 v40, s[12:15], s36 offen  lds
  s_add_u32 m0, m0, 1024
  s_nop 0
  buffer_load_dwordx4 v41, s[12:15], s36 offen  lds
  s_add_u32 m0, m0, 1024
  s_nop 0
  buffer_load_dwordx4 v42, s[12:15], s36 offen  lds
  s_add_u32 m0, m0, 1024
  s_nop 0
  buffer_load_dwordx4 v43, s[12:15], s36 offen  lds
  s_add_u32 m0, m0, 1024
  s_nop 0
  buffer_load_dwordx4 v44, s[12:15], s36 offen  lds
  s_add_u32 m0, m0, 1024
  s_nop 0
  buffer_load_dwordx4 v45, s[12:15], s36 offen  lds
  v_add_u32 v49, 0, v46
  v_add_u32 v50, 0, v47
  v_add_u32 v51, 0, v48
  ds_read_b64_tr_b16 a[96:97], v49 offset:0
  ds_read_b64_tr_b16 a[98:99], v49 offset:768
  ds_read_b64_tr_b16 a[100:101], v49 offset:6144
  ds_read_b64_tr_b16 a[102:103], v49 offset:6912
  ds_read_b64_tr_b16 a[104:105], v50 offset:0
  ds_read_b64_tr_b16 a[106:107], v50 offset:768
  ds_read_b64_tr_b16 a[108:109], v50 offset:6144
  ds_read_b64_tr_b16 a[110:111], v50 offset:6912
  ds_read_b64_tr_b16 a[112:113], v51 offset:0
  ds_read_b64_tr_b16 a[114:115], v51 offset:768
  ds_read_b64_tr_b16 a[116:117], v51 offset:6144
  ds_read_b64_tr_b16 a[118:119], v51 offset:6912
  s_waitcnt lgkmcnt(4)
  s_waitcnt lgkmcnt(0)
  s_waitcnt vmcnt(12)
  s_barrier
  s_add_u32 m0, s35, 98304
  s_add_u32 s36, s34, 3932160
  buffer_load_dwordx4 v40, s[12:15], s36 offen  lds
  s_add_u32 m0, m0, 1024
  s_nop 0
  buffer_load_dwordx4 v41, s[12:15], s36 offen  lds
  s_add_u32 m0, m0, 1024
  s_nop 0
  buffer_load_dwordx4 v42, s[12:15], s36 offen  lds
  s_add_u32 m0, m0, 1024
  s_nop 0
  buffer_load_dwordx4 v43, s[12:15], s36 offen  lds
  s_add_u32 m0, m0, 1024
  s_nop 0
  buffer_load_dwordx4 v44, s[12:15], s36 offen  lds
  s_add_u32 m0, m0, 1024
  s_nop 0
  buffer_load_dwordx4 v45, s[12:15], s36 offen  lds
  v_add_u32 v49, 24576, v46
  v_add_u32 v50, 24576, v47
  v_add_u32 v51, 24576, v48
  ds_read_b64_tr_b16 a[120:121], v49 offset:0
  ds_read_b64_tr_b16 a[122:123], v49 offset:768
  ds_read_b64_tr_b16 a[124:125], v49 offset:6144
  ds_read_b64_tr_b16 a[126:127], v49 offset:6912
  ds_read_b64_tr_b16 a[128:129], v50 offset:0
  ds_read_b64_tr_b16 a[130:131], v50 offset:768
  ds_read_b64_tr_b16 a[132:133], v50 offset:6144
  ds_read_b64_tr_b16 a[134:135], v50 offset:6912
  ds_read_b64_tr_b16 a[136:137], v51 offset:0
  ds_read_b64_tr_b16 a[138:139], v51 offset:768
  ds_read_b64_tr_b16 a[140:141], v51 offset:6144
  ds_read_b64_tr_b16 a[142:143], v51 offset:6912
  s_waitcnt lgkmcnt(4)
  s_waitcnt lgkmcnt(0)
  s_waitcnt vmcnt(12)
  s_barrier
  s_nop 0
  s_add_u32 m0, s35, 122880
  s_add_u32 s36, s34, 4325376
  buffer_load_dwordx4 v40, s[12:15], s36 offen  lds
  s_add_u32 m0, m0, 1024
  s_nop 0
  buffer_load_dwordx4 v41, s[12:15], s36 offen  lds
  s_add_u32 m0, m0, 1024
  s_nop 0
  buffer_load_dwordx4 v42, s[12:15], s36 offen  lds
  s_add_u32 m0, m0, 1024
  s_nop 0
  buffer_load_dwordx4 v43, s[12:15], s36 offen  lds
  s_add_u32 m0, m0, 1024
  s_nop 0
  buffer_load_dwordx4 v44, s[12:15], s36 offen  lds
  s_add_u32 m0, m0, 1024
  s_nop 0
  buffer_load_dwordx4 v45, s[12:15], s36 offen  lds
  v_add_u32 v49, 49152, v46
  v_add_u32 v50, 49152, v47
  v_add_u32 v51, 49152, v48
  ds_read_b64_tr_b16 a[144:145], v49 offset:0
  ds_read_b64_tr_b16 a[146:147], v49 offset:768
  ds_read_b64_tr_b16 a[148:149], v49 offset:6144
  ds_read_b64_tr_b16 a[150:151], v49 offset:6912
  ds_read_b64_tr_b16 a[152:153], v50 offset:0
  ds_read_b64_tr_b16 a[154:155], v50 offset:768
  ds_read_b64_tr_b16 a[156:157], v50 offset:6144
  ds_read_b64_tr_b16 a[158:159], v50 offset:6912
  ds_read_b64_tr_b16 a[160:161], v51 offset:0
  ds_read_b64_tr_b16 a[162:163], v51 offset:768
  ds_read_b64_tr_b16 a[164:165], v51 offset:6144
  ds_read_b64_tr_b16 a[166:167], v51 offset:6912
  s_waitcnt lgkmcnt(4)
  s_waitcnt lgkmcnt(0)
  s_waitcnt vmcnt(12)
  s_barrier
  s_add_u32 m0, s35, 0
  s_add_u32 s36, s34, 4718592
  buffer_load_dwordx4 v40, s[12:15], s36 offen  lds
  s_add_u32 m0, m0, 1024
  s_nop 0
  buffer_load_dwordx4 v41, s[12:15], s36 offen  lds
  s_add_u32 m0, m0, 1024
  s_nop 0
  buffer_load_dwordx4 v42, s[12:15], s36 offen  lds
  s_add_u32 m0, m0, 1024
  s_nop 0
  buffer_load_dwordx4 v43, s[12:15], s36 offen  lds
  s_add_u32 m0, m0, 1024
  s_nop 0
  buffer_load_dwordx4 v44, s[12:15], s36 offen  lds
  s_add_u32 m0, m0, 1024
  s_nop 0
  buffer_load_dwordx4 v45, s[12:15], s36 offen  lds
  v_add_u32 v49, 73728, v46
  v_add_u32 v50, 73728, v47
  v_add_u32 v51, 73728, v48
  ds_read_b64_tr_b16 a[168:169], v49 offset:0
  ds_read_b64_tr_b16 a[170:171], v49 offset:768
  ds_read_b64_tr_b16 a[172:173], v49 offset:6144
  ds_read_b64_tr_b16 a[174:175], v49 offset:6912
  ds_read_b64_tr_b16 a[176:177], v50 offset:0
  ds_read_b64_tr_b16 a[178:179], v50 offset:768
  ds_read_b64_tr_b16 a[180:181], v50 offset:6144
  ds_read_b64_tr_b16 a[182:183], v50 offset:6912
  ds_read_b64_tr_b16 a[184:185], v51 offset:0
  ds_read_b64_tr_b16 a[186:187], v51 offset:768
  ds_read_b64_tr_b16 a[188:189], v51 offset:6144
  ds_read_b64_tr_b16 a[190:191], v51 offset:6912
  s_waitcnt lgkmcnt(4)
  s_waitcnt lgkmcnt(0)
  s_waitcnt vmcnt(12)
  s_barrier
  s_add_u32 m0, s35, 24576
  s_add_u32 s36, s34, 5111808
  buffer_load_dwordx4 v40, s[12:15], s36 offen  lds
  s_add_u32 m0, m0, 1024
  s_nop 0
  buffer_load_dwordx4 v41, s[12:15], s36 offen  lds
  s_add_u32 m0, m0, 1024
  s_nop 0
  buffer_load_dwordx4 v42, s[12:15], s36 offen  lds
  s_add_u32 m0, m0, 1024
  s_nop 0
  buffer_load_dwordx4 v43, s[12:15], s36 offen  lds
  s_add_u32 m0, m0, 1024
  s_nop 0
  buffer_load_dwordx4 v44, s[12:15], s36 offen  lds
  s_add_u32 m0, m0, 1024
  s_nop 0
  buffer_load_dwordx4 v45, s[12:15], s36 offen  lds
  v_add_u32 v49, 98304, v46
  v_add_u32 v50, 98304, v47
  v_add_u32 v51, 98304, v48
  ds_read_b64_tr_b16 a[192:193], v49 offset:0
  ds_read_b64_tr_b16 a[194:195], v49 offset:768
  ds_read_b64_tr_b16 a[196:197], v49 offset:6144
  ds_read_b64_tr_b16 a[198:199], v49 offset:6912
  ds_read_b64_tr_b16 a[200:201], v50 offset:0
  ds_read_b64_tr_b16 a[202:203], v50 offset:768
  ds_read_b64_tr_b16 a[204:205], v50 offset:6144
  ds_read_b64_tr_b16 a[206:207], v50 offset:6912
  ds_read_b64_tr_b16 a[208:209], v51 offset:0
  ds_read_b64_tr_b16 a[210:211], v51 offset:768
  ds_read_b64_tr_b16 a[212:213], v51 offset:6144
  ds_read_b64_tr_b16 a[214:215], v51 offset:6912
  s_waitcnt lgkmcnt(4)
  s_waitcnt lgkmcnt(0)
  s_waitcnt vmcnt(12)
  s_barrier
  s_add_u32 m0, s35, 49152
  s_add_u32 s36, s34, 5898240
  buffer_load_dwordx4 v40, s[12:15], s36 offen  lds
  s_add_u32 m0, m0, 1024
  s_nop 0
  buffer_load_dwordx4 v41, s[12:15], s36 offen  lds
  s_add_u32 m0, m0, 1024
  s_nop 0
  buffer_load_dwordx4 v42, s[12:15], s36 offen  lds
  s_add_u32 m0, m0, 1024
  s_nop 0
  buffer_load_dwordx4 v43, s[12:15], s36 offen  lds
  s_add_u32 m0, m0, 1024
  s_nop 0
  buffer_load_dwordx4 v44, s[12:15], s36 offen  lds
  s_add_u32 m0, m0, 1024
  s_nop 0
  buffer_load_dwordx4 v45, s[12:15], s36 offen  lds
  v_add_u32 v49, 122880, v46
  v_add_u32 v50, 122880, v47
  v_add_u32 v51, 122880, v48
  ds_read_b64_tr_b16 a[216:217], v49 offset:0
  ds_read_b64_tr_b16 a[218:219], v49 offset:768
  ds_read_b64_tr_b16 a[220:221], v49 offset:6144
  ds_read_b64_tr_b16 a[222:223], v49 offset:6912
  ds_read_b64_tr_b16 a[224:225], v50 offset:0
  ds_read_b64_tr_b16 a[226:227], v50 offset:768
  ds_read_b64_tr_b16 a[228:229], v50 offset:6144
  ds_read_b64_tr_b16 a[230:231], v50 offset:6912
  ds_read_b64_tr_b16 a[232:233], v51 offset:0
  ds_read_b64_tr_b16 a[234:235], v51 offset:768
  ds_read_b64_tr_b16 a[236:237], v51 offset:6144
  ds_read_b64_tr_b16 a[238:239], v51 offset:6912
  s_waitcnt lgkmcnt(4)
  s_waitcnt lgkmcnt(0)
  s_waitcnt vmcnt(12)
  s_barrier
  s_add_u32 m0, s35, 73728
  s_add_u32 s36, s34, 6291456
  buffer_load_dwordx4 v40, s[12:15], s36 offen  lds
  s_add_u32 m0, m0, 1024
  s_nop 0
  buffer_load_dwordx4 v41, s[12:15], s36 offen  lds
  s_add_u32 m0, m0, 1024
  s_nop 0
  buffer_load_dwordx4 v42, s[12:15], s36 offen  lds
  s_add_u32 m0, m0, 1024
  s_nop 0
  buffer_load_dwordx4 v43, s[12:15], s36 offen  lds
  s_add_u32 m0, m0, 1024
  s_nop 0
  buffer_load_dwordx4 v44, s[12:15], s36 offen  lds
  s_add_u32 m0, m0, 1024
  s_nop 0
  buffer_load_dwordx4 v45, s[12:15], s36 offen  lds
  v_add_u32 v49, 0, v46
  v_add_u32 v50, 0, v47
  v_add_u32 v51, 0, v48
  ds_read_b64_tr_b16 a[240:241], v49 offset:0
  ds_read_b64_tr_b16 a[242:243], v49 offset:768
  ds_read_b64_tr_b16 a[244:245], v49 offset:6144
  ds_read_b64_tr_b16 a[246:247], v49 offset:6912
  ds_read_b64_tr_b16 a[248:249], v50 offset:0
  ds_read_b64_tr_b16 a[250:251], v50 offset:768
  ds_read_b64_tr_b16 a[252:253], v50 offset:6144
  ds_read_b64_tr_b16 a[254:255], v50 offset:6912
  ds_read_b64_tr_b16 v[128:129], v51 offset:0
  ds_read_b64_tr_b16 v[130:131], v51 offset:768
  ds_read_b64_tr_b16 v[132:133], v51 offset:6144
  ds_read_b64_tr_b16 v[134:135], v51 offset:6912
  s_waitcnt lgkmcnt(4)
  s_waitcnt lgkmcnt(0)
  s_waitcnt vmcnt(12)
  s_barrier
  s_add_u32 m0, s35, 98304
  s_add_u32 s36, s34, 6684672
  buffer_load_dwordx4 v40, s[12:15], s36 offen  lds
  s_add_u32 m0, m0, 1024
  s_nop 0
  buffer_load_dwordx4 v41, s[12:15], s36 offen  lds
  s_add_u32 m0, m0, 1024
  s_nop 0
  buffer_load_dwordx4 v42, s[12:15], s36 offen  lds
  s_add_u32 m0, m0, 1024
  s_nop 0
  buffer_load_dwordx4 v43, s[12:15], s36 offen  lds
  s_add_u32 m0, m0, 1024
  s_nop 0
  buffer_load_dwordx4 v44, s[12:15], s36 offen  lds
  s_add_u32 m0, m0, 1024
  s_nop 0
  buffer_load_dwordx4 v45, s[12:15], s36 offen  lds
  v_add_u32 v49, 24576, v46
  v_add_u32 v50, 24576, v47
  v_add_u32 v51, 24576, v48
  ds_read_b64_tr_b16 v[136:137], v49 offset:0
  ds_read_b64_tr_b16 v[138:139], v49 offset:768
  ds_read_b64_tr_b16 v[140:141], v49 offset:6144
  ds_read_b64_tr_b16 v[142:143], v49 offset:6912
  ds_read_b64_tr_b16 v[144:145], v50 offset:0
  ds_read_b64_tr_b16 v[146:147], v50 offset:768
  ds_read_b64_tr_b16 v[148:149], v50 offset:6144
  ds_read_b64_tr_b16 v[150:151], v50 offset:6912
  ds_read_b64_tr_b16 v[152:153], v51 offset:0
  ds_read_b64_tr_b16 v[154:155], v51 offset:768
  ds_read_b64_tr_b16 v[156:157], v51 offset:6144
  ds_read_b64_tr_b16 v[158:159], v51 offset:6912
  s_waitcnt lgkmcnt(4)
  s_waitcnt lgkmcnt(0)
  s_waitcnt vmcnt(12)
  s_barrier
  s_add_u32 m0, s35, 122880
  s_add_u32 s36, s34, 7077888
  buffer_load_dwordx4 v40, s[12:15], s36 offen  lds
  s_add_u32 m0, m0, 1024
  s_nop 0
  buffer_load_dwordx4 v41, s[12:15], s36 offen  lds
  s_add_u32 m0, m0, 1024
  s_nop 0
  buffer_load_dwordx4 v42, s[12:15], s36 offen  lds
  s_add_u32 m0, m0, 1024
  s_nop 0
  buffer_load_dwordx4 v43, s[12:15], s36 offen  lds
  s_add_u32 m0, m0, 1024
  s_nop 0
  buffer_load_dwordx4 v44, s[12:15], s36 offen  lds
  s_add_u32 m0, m0, 1024
  s_nop 0
  buffer_load_dwordx4 v45, s[12:15], s36 offen  lds
  v_add_u32 v49, 49152, v46
  v_add_u32 v50, 49152, v47
  v_add_u32 v51, 49152, v48
  ds_read_b64_tr_b16 v[160:161], v49 offset:0
  ds_read_b64_tr_b16 v[162:163], v49 offset:768
  ds_read_b64_tr_b16 v[164:165], v49 offset:6144
  ds_read_b64_tr_b16 v[166:167], v49 offset:6912
  ds_read_b64_tr_b16 v[168:169], v50 offset:0
  ds_read_b64_tr_b16 v[170:171], v50 offset:768
  ds_read_b64_tr_b16 v[172:173], v50 offset:6144
  ds_read_b64_tr_b16 v[174:175], v50 offset:6912
  ds_read_b64_tr_b16 v[176:177], v51 offset:0
  ds_read_b64_tr_b16 v[178:179], v51 offset:768
  ds_read_b64_tr_b16 v[180:181], v51 offset:6144
  ds_read_b64_tr_b16 v[182:183], v51 offset:6912
  s_waitcnt lgkmcnt(4)
  s_waitcnt lgkmcnt(0)
  s_waitcnt vmcnt(12)
  s_barrier
  s_nop 0
  s_add_u32 m0, s35, 0
  s_add_u32 s36, s34, 1572864
  buffer_load_dwordx4 v40, s[12:15], s36 offen  lds
  s_add_u32 m0, m0, 1024
  s_nop 0
  buffer_load_dwordx4 v41, s[12:15], s36 offen  lds
  s_add_u32 m0, m0, 1024
  s_nop 0
  buffer_load_dwordx4 v42, s[12:15], s36 offen  lds
  s_add_u32 m0, m0, 1024
  s_nop 0
  buffer_load_dwordx4 v43, s[12:15], s36 offen  lds
  s_add_u32 m0, m0, 1024
  s_nop 0
  buffer_load_dwordx4 v44, s[12:15], s36 offen  lds
  s_add_u32 m0, m0, 1024
  s_nop 0
  buffer_load_dwordx4 v45, s[12:15], s36 offen  lds
  v_add_u32 v49, 73728, v46
  v_add_u32 v50, 73728, v47
  v_add_u32 v51, 73728, v48
  ds_read_b64_tr_b16 v[184:185], v49 offset:0
  ds_read_b64_tr_b16 v[186:187], v49 offset:768
  ds_read_b64_tr_b16 v[188:189], v49 offset:6144
  ds_read_b64_tr_b16 v[190:191], v49 offset:6912
  ds_read_b64_tr_b16 v[192:193], v50 offset:0
  ds_read_b64_tr_b16 v[194:195], v50 offset:768
  ds_read_b64_tr_b16 v[196:197], v50 offset:6144
  ds_read_b64_tr_b16 v[198:199], v50 offset:6912
  ds_read_b64_tr_b16 v[200:201], v51 offset:0
  ds_read_b64_tr_b16 v[202:203], v51 offset:768
  ds_read_b64_tr_b16 v[204:205], v51 offset:6144
  ds_read_b64_tr_b16 v[206:207], v51 offset:6912
  s_waitcnt lgkmcnt(4)
  s_waitcnt lgkmcnt(0)
  s_waitcnt vmcnt(12)
  s_barrier
  s_add_u32 m0, s35, 24576
  s_add_u32 s36, s34, 3538944
  buffer_load_dwordx4 v40, s[12:15], s36 offen  lds
  s_add_u32 m0, m0, 1024
  s_nop 0
  buffer_load_dwordx4 v41, s[12:15], s36 offen  lds
  s_add_u32 m0, m0, 1024
  s_nop 0
  buffer_load_dwordx4 v42, s[12:15], s36 offen  lds
  s_add_u32 m0, m0, 1024
  s_nop 0
  buffer_load_dwordx4 v43, s[12:15], s36 offen  lds
  s_add_u32 m0, m0, 1024
  s_nop 0
  buffer_load_dwordx4 v44, s[12:15], s36 offen  lds
  s_add_u32 m0, m0, 1024
  s_nop 0
  buffer_load_dwordx4 v45, s[12:15], s36 offen  lds
  v_add_u32 v49, 98304, v46
  v_add_u32 v50, 98304, v47
  v_add_u32 v51, 98304, v48
  ds_read_b64_tr_b16 v[208:209], v49 offset:0
  ds_read_b64_tr_b16 v[210:211], v49 offset:768
  ds_read_b64_tr_b16 v[212:213], v49 offset:6144
  ds_read_b64_tr_b16 v[214:215], v49 offset:6912
  ds_read_b64_tr_b16 v[216:217], v50 offset:0
  ds_read_b64_tr_b16 v[218:219], v50 offset:768
  ds_read_b64_tr_b16 v[220:221], v50 offset:6144
  ds_read_b64_tr_b16 v[222:223], v50 offset:6912
  ds_read_b64_tr_b16 v[224:225], v51 offset:0
  ds_read_b64_tr_b16 v[226:227], v51 offset:768
  ds_read_b64_tr_b16 v[228:229], v51 offset:6144
  ds_read_b64_tr_b16 v[230:231], v51 offset:6912
  s_waitcnt lgkmcnt(4)
  s_waitcnt lgkmcnt(0)
  s_waitcnt vmcnt(12)
  s_barrier
  s_add_u32 m0, s35, 49152
  s_add_u32 s36, s34, 5505024
  buffer_load_dwordx4 v40, s[12:15], s36 offen  lds
  s_add_u32 m0, m0, 1024
  s_nop 0
  buffer_load_dwordx4 v41, s[12:15], s36 offen  lds
  s_add_u32 m0, m0, 1024
  s_nop 0
  buffer_load_dwordx4 v42, s[12:15], s36 offen  lds
  s_add_u32 m0, m0, 1024
  s_nop 0
  buffer_load_dwordx4 v43, s[12:15], s36 offen  lds
  s_add_u32 m0, m0, 1024
  s_nop 0
  buffer_load_dwordx4 v44, s[12:15], s36 offen  lds
  s_add_u32 m0, m0, 1024
  s_nop 0
  buffer_load_dwordx4 v45, s[12:15], s36 offen  lds
  v_add_u32 v49, 122880, v46
  v_add_u32 v50, 122880, v47
  v_add_u32 v51, 122880, v48
  ds_read_b64_tr_b16 v[232:233], v49 offset:0
  ds_read_b64_tr_b16 v[234:235], v49 offset:768
  ds_read_b64_tr_b16 v[236:237], v49 offset:6144
  ds_read_b64_tr_b16 v[238:239], v49 offset:6912
  ds_read_b64_tr_b16 v[240:241], v50 offset:0
  ds_read_b64_tr_b16 v[242:243], v50 offset:768
  ds_read_b64_tr_b16 v[244:245], v50 offset:6144
  ds_read_b64_tr_b16 v[246:247], v50 offset:6912
  ds_read_b64_tr_b16 v[248:249], v51 offset:0
  ds_read_b64_tr_b16 v[250:251], v51 offset:768
  ds_read_b64_tr_b16 v[252:253], v51 offset:6144
  ds_read_b64_tr_b16 v[254:255], v51 offset:6912
  s_waitcnt lgkmcnt(4)
  s_waitcnt lgkmcnt(0)
  s_waitcnt vmcnt(12)
  s_barrier
  s_add_u32 m0, s35, 73728
  s_add_u32 s36, s34, 7471104
  buffer_load_dwordx4 v40, s[12:15], s36 offen  lds
  s_add_u32 m0, m0, 1024
  s_nop 0
  buffer_load_dwordx4 v41, s[12:15], s36 offen  lds
  s_add_u32 m0, m0, 1024
  s_nop 0
  buffer_load_dwordx4 v42, s[12:15], s36 offen  lds
  s_add_u32 m0, m0, 1024
  s_nop 0
  buffer_load_dwordx4 v43, s[12:15], s36 offen  lds
  s_add_u32 m0, m0, 1024
  s_nop 0
  buffer_load_dwordx4 v44, s[12:15], s36 offen  lds
  s_add_u32 m0, m0, 1024
  s_nop 0
  buffer_load_dwordx4 v45, s[12:15], s36 offen  lds
  v_add_u32 v49, 0, v46
  v_add_u32 v50, 0, v47
  v_add_u32 v51, 0, v48
  ds_read_b64_tr_b16 v[80:81], v49 offset:0
  ds_read_b64_tr_b16 v[82:83], v49 offset:768
  ds_read_b64_tr_b16 v[84:85], v49 offset:6144
  ds_read_b64_tr_b16 v[86:87], v49 offset:6912
  ds_read_b64_tr_b16 v[88:89], v50 offset:0
  ds_read_b64_tr_b16 v[90:91], v50 offset:768
  ds_read_b64_tr_b16 v[92:93], v50 offset:6144
  ds_read_b64_tr_b16 v[94:95], v50 offset:6912
  ds_read_b64_tr_b16 v[96:97], v51 offset:0
  ds_read_b64_tr_b16 v[98:99], v51 offset:768
  ds_read_b64_tr_b16 v[100:101], v51 offset:6144
  ds_read_b64_tr_b16 v[102:103], v51 offset:6912
  s_waitcnt lgkmcnt(4)
  s_waitcnt lgkmcnt(0)
  s_barrier
  v_add_u32 v2, 0, v52
  ds_write_b128 v2, v[80:83] offset:0
  ds_write_b128 v2, v[84:87] offset:1024
  ds_write_b128 v2, v[88:91] offset:2048
  ds_write_b128 v2, v[92:95] offset:3072
  ds_write_b128 v2, v[96:99] offset:4096
  ds_write_b128 v2, v[100:103] offset:5120
  s_waitcnt lgkmcnt(0)
  s_waitcnt vmcnt(12)
  s_barrier
  v_add_u32 v49, 24576, v46
  v_add_u32 v50, 24576, v47
  v_add_u32 v51, 24576, v48
  ds_read_b64_tr_b16 v[80:81], v49 offset:0
  ds_read_b64_tr_b16 v[82:83], v49 offset:768
  ds_read_b64_tr_b16 v[84:85], v49 offset:6144
  ds_read_b64_tr_b16 v[86:87], v49 offset:6912
  ds_read_b64_tr_b16 v[88:89], v50 offset:0
  ds_read_b64_tr_b16 v[90:91], v50 offset:768
  ds_read_b64_tr_b16 v[92:93], v50 offset:6144
  ds_read_b64_tr_b16 v[94:95], v50 offset:6912
  ds_read_b64_tr_b16 v[96:97], v51 offset:0
  ds_read_b64_tr_b16 v[98:99], v51 offset:768
  ds_read_b64_tr_b16 v[100:101], v51 offset:6144
  ds_read_b64_tr_b16 v[102:103], v51 offset:6912
  s_waitcnt lgkmcnt(4)
  s_waitcnt lgkmcnt(0)
  s_barrier
  v_add_u32 v2, 24576, v52
  ds_write_b128 v2, v[80:83] offset:0
  ds_write_b128 v2, v[84:87] offset:1024
  ds_write_b128 v2, v[88:91] offset:2048
  ds_write_b128 v2, v[92:95] offset:3072
  ds_write_b128 v2, v[96:99] offset:4096
  ds_write_b128 v2, v[100:103] offset:5120
  s_waitcnt lgkmcnt(0)
  s_waitcnt vmcnt(6)
  s_barrier
  v_min_u32 v59, 9, v1
  v_and_b32 v58, 1, v59
  v_lshlrev_b32 v58, 7, v58
  v_lshl_add_u32 v58, v59, 2, v58
  v_cmp_eq_u32 vcc, 9, v59
  v_mov_b32 v57, 64
  s_nop 0
  v_cndmask_b32 v59, v58, v57, vcc
  buffer_load_dword v58, v59, s[4:7], 0 offen sc1
  v_add_u32 v49, 49152, v46
  v_add_u32 v50, 49152, v47
  v_add_u32 v51, 49152, v48
  ds_read_b64_tr_b16 v[80:81], v49 offset:0
  ds_read_b64_tr_b16 v[82:83], v49 offset:768
  ds_read_b64_tr_b16 v[84:85], v49 offset:6144
  ds_read_b64_tr_b16 v[86:87], v49 offset:6912
  ds_read_b64_tr_b16 v[88:89], v50 offset:0
  ds_read_b64_tr_b16 v[90:91], v50 offset:768
  ds_read_b64_tr_b16 v[92:93], v50 offset:6144
  ds_read_b64_tr_b16 v[94:95], v50 offset:6912
  ds_read_b64_tr_b16 v[96:97], v51 offset:0
  ds_read_b64_tr_b16 v[98:99], v51 offset:768
  ds_read_b64_tr_b16 v[100:101], v51 offset:6144
  ds_read_b64_tr_b16 v[102:103], v51 offset:6912
  s_waitcnt lgkmcnt(4)
  s_waitcnt lgkmcnt(0)
  s_barrier
  v_add_u32 v2, 49152, v52
  ds_write_b128 v2, v[80:83] offset:0
  ds_write_b128 v2, v[84:87] offset:1024
  ds_write_b128 v2, v[88:91] offset:2048
  ds_write_b128 v2, v[92:95] offset:3072
  ds_write_b128 v2, v[96:99] offset:4096
  ds_write_b128 v2, v[100:103] offset:5120
  s_waitcnt lgkmcnt(0)
  s_waitcnt vmcnt(0)
  s_barrier
  v_add_u32 v49, 73728, v46
  v_add_u32 v50, 73728, v47
  v_add_u32 v51, 73728, v48
  ds_read_b64_tr_b16 v[80:81], v49 offset:0
  ds_read_b64_tr_b16 v[82:83], v49 offset:768
  ds_read_b64_tr_b16 v[84:85], v49 offset:6144
  ds_read_b64_tr_b16 v[86:87], v49 offset:6912
  ds_read_b64_tr_b16 v[88:89], v50 offset:0
  ds_read_b64_tr_b16 v[90:91], v50 offset:768
  ds_read_b64_tr_b16 v[92:93], v50 offset:6144
  ds_read_b64_tr_b16 v[94:95], v50 offset:6912
  ds_read_b64_tr_b16 v[96:97], v51 offset:0
  ds_read_b64_tr_b16 v[98:99], v51 offset:768
  ds_read_b64_tr_b16 v[100:101], v51 offset:6144
  ds_read_b64_tr_b16 v[102:103], v51 offset:6912
  s_waitcnt lgkmcnt(4)
  s_waitcnt lgkmcnt(0)
  s_barrier
  v_add_u32 v2, 73728, v52
  ds_write_b128 v2, v[80:83] offset:0
  ds_write_b128 v2, v[84:87] offset:1024
  ds_write_b128 v2, v[88:91] offset:2048
  ds_write_b128 v2, v[92:95] offset:3072
  ds_write_b128 v2, v[96:99] offset:4096
  ds_write_b128 v2, v[100:103] offset:5120
  s_waitcnt lgkmcnt(0)
  s_barrier
  s_nop 0
  s_branch C_cw_81c
C_cw_81:
  s_sleep 4
  buffer_load_dword v58, v59, s[4:7], 0 offen sc1
  s_sub_u32 s82, s82, 1
  s_cbranch_scc1 L_abort
C_cw_81c:
  s_waitcnt vmcnt(0)
  v_readlane_b32 s84, v58, 0
  v_readlane_b32 s85, v58, 1
  v_readlane_b32 s86, v58, 2
  v_readlane_b32 s87, v58, 3
  v_readlane_b32 s88, v58, 4
  v_readlane_b32 s89, v58, 5
  v_readlane_b32 s90, v58, 6
  v_readlane_b32 s91, v58, 7
  v_readlane_b32 s92, v58, 8
  v_readlane_b32 s93, v58, 9
  s_cmp_lg_u32 s92, 256
  s_cbranch_scc1 C_cw_81
  s_min_u32 s81, s84, s85
  s_and_b32 s30, s84, s85
  s_and_b32 s30, s30, s86
  s_and_b32 s30, s30, s87
  s_and_b32 s30, s30, s88
  s_and_b32 s30, s30, s89
  s_and_b32 s30, s30, s90
  s_and_b32 s30, s30, s91
  s_cmp_lg_u32 s30, 32
  s_cbranch_scc1 C_cw_81d
  s_cmp_eq_u32 s93, 0
  s_cbranch_scc1 C_cw_81
  s_and_b32 s30, s93, 0x6000
  s_or_b32 s47, s47, s30
C_cw_81d:
  v_add_u32 v2, 0, v0
  v_min_u32 v2, 639, v2
  v_and_b32 v3, 7, v2
  v_mul_u32_u24 v3, 1280, v3
  v_lshrrev_b32 v4, 3, v2
  v_lshl_add_u32 v3, v4, 4, v3
  buffer_load_dwordx4 v[32:35], v3, s[20:23], 0 offen
  v_lshlrev_b32 v44, 4, v2
  v_add_u32 v2, 256, v0
  v_min_u32 v2, 639, v2
  v_and_b32 v3, 7, v2
  v_mul_u32_u24 v3, 1280, v3
  v_lshrrev_b32 v4, 3, v2
  v_lshl_add_u32 v3, v4, 4, v3
  buffer_load_dwordx4 v[36:39], v3, s[20:23], 0 offen
  v_lshlrev_b32 v45, 4, v2
  v_add_u32 v2, 512, v0
  v_min_u32 v2, 639, v2
  v_and_b32 v3, 7, v2
  v_mul_u32_u24 v3, 1280, v3
  v_lshrrev_b32 v4, 3, v2
  v_lshl_add_u32 v3, v4, 4, v3
  buffer_load_dwordx4 v[40:43], v3, s[20:23], 0 offen
  v_lshlrev_b32 v46, 4, v2
  v_and_b32 v2, 8, v1
  v_cmp_eq_u32 vcc, 0, v2
  v_mov_b32 v3, 0xeeee
  v_mov_b32 v4, 0x4444
  v_cndmask_b32 v8, v3, v4, vcc
  v_and_b32 v2, 1, v1
  v_cmp_eq_u32 vcc, 0, v2
  s_nop 1
  v_cndmask_b32 v2, v3, v4, vcc
  v_lshl_or_b32 v8, v2, 16, v8
  v_lshrrev_b32 v2, 5, v1
  v_bfe_u32 v3, v1, 3, 1
  v_cmp_eq_u32 s[30:31], v2, v3
  v_and_b32 v2, 1, v1
  v_lshlrev_b32 v2, 4, v2
  v_mov_b32 v3, 0x3f80
  v_lshlrev_b32 v3, v2, v3
  v_bfe_u32 v4, v1, 1, 2
  v_cmp_eq_u32 vcc, 0, v4
  s_and_b64 vcc, vcc, s[30:31]
  v_cndmask_b32 v12, 0, v3, vcc
  v_cmp_eq_u32 vcc, 1, v4
  s_and_b64 vcc, vcc, s[30:31]
  v_cndmask_b32 v13, 0, v3, vcc
  v_cmp_eq_u32 vcc, 2, v4
  s_and_b64 vcc, vcc, s[30:31]
  v_cndmask_b32 v14, 0, v3, vcc
  v_cmp_eq_u32 vcc, 3, v4
  s_and_b64 vcc, vcc, s[30:31]
  v_cndmask_b32 v15, 0, v3, vcc
  v_lshrrev_b32 v2, 4, v1
  s_mul_i32 s30, s24, 20
  v_add_u32 v2, s30, v2
  v_lshlrev_b32 v2, 7, v2
  v_and_b32 v3, 7, v1
  v_lshl_add_u32 v2, v3, 4, v2
  v_bfe_u32 v3, v1, 3, 1
  v_lshl_add_u32 v2, v3, 3, v2
  v_add_u32 v17, 98304, v2
  v_bfe_u32 v2, v1, 4, 1
  v_lshlrev_b32 v2, 12, v2
  v_bfe_u32 v3, v1, 2, 2
  v_lshl_add_u32 v2, v3, 7, v2
  v_lshrrev_b32 v3, 5, v1
  v_lshl_add_u32 v2, v3, 6, v2
  v_and_b32 v3, 3, v1
  v_lshl_add_u32 v18, v3, 4, v2
  v_and_b32 v2, 15, v1
  v_mul_u32_u24 v19, 128, v2
  s_mul_i32 s30, s24, 5
  s_add_u32 s30, s30, 0
  s_lshr_b32 s31, s30, 3
  s_lshl_b32 s31, s31, 15
  s_and_b32 s30, s30, 7
  s_lshl_b32 s30, s30, 9
  s_add_u32 s40, s30, s31
  s_mul_i32 s30, s24, 5
  s_add_u32 s30, s30, 1
  s_lshr_b32 s31, s30, 3
  s_lshl_b32 s31, s31, 15
  s_and_b32 s30, s30, 7
  s_lshl_b32 s30, s30, 9
  s_add_u32 s41, s30, s31
  s_mul_i32 s30, s24, 5
  s_add_u32 s30, s30, 2
  s_lshr_b32 s31, s30, 3
  s_lshl_b32 s31, s31, 15
  s_and_b32 s30, s30, 7
  s_lshl_b32 s30, s30, 9
  s_add_u32 s42, s30, s31
  s_mul_i32 s30, s24, 5
  s_add_u32 s30, s30, 3
  s_lshr_b32 s31, s30, 3
  s_lshl_b32 s31, s31, 15
  s_and_b32 s30, s30, 7
  s_lshl_b32 s30, s30, 9
  s_add_u32 s43, s30, s31
  s_mul_i32 s30, s24, 5
  s_add_u32 s30, s30, 4
  s_lshr_b32 s31, s30, 3
  s_lshl_b32 s31, s31, 15
  s_and_b32 s30, s30, 7
  s_lshl_b32 s30, s30, 9
  s_add_u32 s44, s30, s31
  s_mul_i32 s46, s25, 1048576
  s_add_u32 s46, s46, 4194304
  s_add_u32 s45, s46, 16384
  v_lshrrev_b32 v2, 4, v1
  v_bfe_u32 v3, v1, 2, 2
  v_cmp_eq_u32 s[30:31], v2, v3
  v_and_b32 v2, 1, v1
  v_lshlrev_b32 v2, 4, v2
  v_mov_b32 v3, 0x3f80
  v_lshlrev_b32 v3, v2, v3
  v_bfe_u32 v4, v1, 1, 1
  v_cmp_eq_u32 vcc, 0, v4
  s_and_b64 vcc, vcc, s[30:31]
  v_cndmask_b32 v10, 0, v3, vcc
  v_cmp_eq_u32 vcc, 1, v4
  s_and_b64 vcc, vcc, s[30:31]
  v_cndmask_b32 v11, 0, v3, vcc
  v_mov_b32 v9, 0x7fff7fff
  v_lshrrev_b32 v2, 4, v1
  v_and_b32 v3, 7, v1
  v_lshlrev_b32 v2, 7, v2
  v_lshl_add_u32 v2, v3, 4, v2
  v_add_u32 v16, 98304, v2
  v_bfe_u32 v2, v1, 2, 1
  v_lshlrev_b32 v2, 2, v2
  v_bfe_u32 v3, v1, 3, 1
  v_lshl_add_u32 v2, v3, 1, v2
  v_and_b32 v3, 1, v1
  v_add_u32 v2, v2, v3
  v_bfe_u32 v3, v1, 1, 1
  v_lshl_add_u32 v2, v3, 3, v2
  v_bfe_u32 v3, v1, 4, 1
  v_lshl_add_u32 v2, v3, 5, v2
  v_lshlrev_b32 v2, 4, v2
  v_lshrrev_b32 v3, 5, v1
  s_lshl_b32 s30, s32, 6
  s_lshl_b32 s31, s33, 6
  v_lshl_add_u32 v4, v3, 10, v2
  v_add_u32 v20, s30, v4
  v_lshl_add_u32 v4, v3, 3, v2
  v_add_u32 v21, s31, v4
  v_and_b32 v2, 7, v1
  v_lshlrev_b32 v2, 4, v2
  v_lshrrev_b32 v3, 4, v1
  v_lshl_add_u32 v4, v3, 7, v2
  s_lshl_b32 s30, s32, 4
  v_add_u32 v29, s30, v4
  v_bfe_u32 v3, v1, 4, 1
  v_lshl_add_u32 v4, v3, 7, v2
  v_lshrrev_b32 v3, 5, v1
  v_lshl_add_u32 v4, v3, 3, v4
  s_lshl_b32 s30, s33, 4
  v_add_u32 v30, s30, v4
  s_mul_i32 s30, s24, 1536
  s_add_u32 s30, s30, 108544
  v_and_b32 v2, 7, v1
  v_lshrrev_b32 v3, 4, v1
  v_xor_b32 v4, v3, v2
  v_lshl_add_u32 v4, v2, 3, v4
  v_lshlrev_b32 v4, 4, v4
  v_add_u32 v22, s30, v4
  v_xor_b32 v4, 64, v4
  v_add_u32 v23, s30, v4
  v_bfe_u32 v3, v1, 4, 1
  v_lshl_add_u32 v4, v2, 1, v3
  v_lshrrev_b32 v3, 5, v1
  v_xor_b32 v3, 1, v3
  v_lshl_add_u32 v4, v3, 4, v4
  v_lshlrev_b32 v4, 4, v4
  v_add_u32 v4, 1024, v4
  v_add_u32 v24, s30, v4
  v_lshrrev_b32 v2, 4, v1
  v_bfe_u32 v3, v1, 2, 1
  v_lshl_add_u32 v2, v2, 1, v3
  v_bfe_u32 v5, v1, 3, 1
  v_and_b32 v3, 3, v1
  v_lshl_add_u32 v3, v5, 2, v3
  v_xor_b32 v3, v3, v2
  v_lshl_add_u32 v3, v2, 3, v3
  v_lshlrev_b32 v3, 4, v3
  v_add_u32 v25, 108544, v3
  v_bfe_u32 v4, v1, 1, 1
  v_and_b32 v3, 1, v1
  v_lshl_add_u32 v3, v5, 1, v3
  v_lshl_add_u32 v3, v4, 2, v3
  v_lshl_add_u32 v3, v2, 3, v3
  v_lshlrev_b32 v3, 2, v3
  v_add_u32 v26, 109568, v3
  v_lshlrev_b32 v27, 3, v1
  v_lshl_add_u32 v3, v5, 1, v4
  v_lshl_add_u32 v3, v2, 2, v3
  v_lshlrev_b32 v3, 2, v3
  v_add_u32 v28, 512, v3
  s_mul_i32 s37, s26, 640
  s_add_u32 s37, s37, s46
  s_mul_i32 s38, s27, 12288
  s_add_u32 s38, s38, 8388608
  s_mul_i32 s54, s27, 3072
  s_add_u32 s54, s54, 163577856
  s_lshl_b32 s55, s27, 4
  s_add_u32 s55, s55, 6336512
  s_lshl_b32 s34, s27, 7
  s_add_u32 s34, s34, 6324224
  s_lshl_b32 s84, s26, 7
  s_add_u32 s84, s84, s45
  s_add_u32 s84, s84, 2048
  s_mov_b32 s28, 0
  s_mov_b32 s29, 0
  s_mov_b32 s36, 1037384597
  s_add_u32 s30, s24, 0
  s_and_b32 s30, s30, 3
  s_mul_i32 s30, s30, 24576
  s_add_u32 s30, s30, s35
  v_add_u32 v6, s30, v31
  s_add_u32 s30, s24, 1
  s_and_b32 s30, s30, 3
  s_mul_i32 s30, s30, 24576
  s_add_u32 s30, s30, s35
  v_add_u32 v7, s30, v31
  s_add_u32 s30, s24, 2
  s_and_b32 s30, s30, 3
  s_mul_i32 s30, s30, 24576
  s_add_u32 s30, s30, s35
  v_add_u32 v54, s30, v31
  s_add_u32 s30, s24, 3
  s_and_b32 s30, s30, 3
  s_mul_i32 s30, s30, 24576
  s_add_u32 s30, s30, s35
  v_add_u32 v55, s30, v31
  s_lshr_b32 s30, s28, 3
  s_lshl_b32 s30, s30, 9
  s_add_u32 s30, s30, s55
  v_and_b32 v3, 4, v28
QK_kf0:
  buffer_load_dword v2, v3, s[8:11], s30 offen sc1
  s_sub_u32 s82, s82, 1
  s_cbranch_scc1 L_abort
  s_waitcnt vmcnt(0)
  v_cmp_eq_u32 vcc, 0, v2
  s_cbranch_vccnz QK_kf0
  s_waitcnt vmcnt(0)
  v_add_u32 v44, 98304, v44
  ds_write_b128 v44, v[32:35]
  v_add_u32 v45, 98304, v45
  ds_write_b128 v45, v[36:39]
  v_add_u32 v46, 98304, v46
  ds_write_b128 v46, v[40:43]
  s_waitcnt lgkmcnt(0)
  buffer_load_dwordx4 v[68:71], v20, s[8:11], s38 offen offset:0 sc1
  buffer_load_dwordx4 v[72:75], v20, s[8:11], s38 offen offset:256 sc1
  buffer_load_dwordx2 v[76:77], v21, s[8:11], s38 offen offset:0 sc1
  buffer_load_dwordx2 v[78:79], v21, s[8:11], s38 offen offset:256 sc1
  s_add_u32 s38, s38, 393216
  s_mul_i32 s30, s24, 2560
  s_mul_i32 s85, s26, 10240
  s_add_u32 s85, s85, s30
  s_add_u32 s85, s85, s46
  s_add_u32 s85, s85, 229376
  s_mul_i32 s87, s27, 10240
  s_add_u32 s87, s87, s30
  s_add_u32 s87, s87, 142606336
  s_add_u32 s86, s46, s30
  s_add_u32 s86, s86, 32768
  s_mov_b32 s88, 4294803456
  v_mov_b32 v0, 1
  ds_read_b128 v[80:83], v6 offset:0
  ds_read_b128 v[84:87], v6 offset:1024
  ds_read_b128 v[88:91], v6 offset:2048
  ds_read_b128 v[92:95], v6 offset:3072
  ds_read_b128 v[96:99], v6 offset:4096
  ds_read_b128 v[100:103], v6 offset:5120
  ds_read_b128 v[104:107], v7 offset:0
  ds_read_b128 v[108:111], v7 offset:1024
  ds_read_b128 v[112:115], v7 offset:2048
  ds_read_b128 v[116:119], v7 offset:3072
  ds_read_b128 v[120:123], v7 offset:4096
  ds_read_b128 v[124:127], v7 offset:5120
  v_mov_b32 v56, 0
  v_mov_b32 v57, 0
  v_mov_b32 v58, 0
  v_mov_b32 v59, 0
  v_mov_b32 v60, 0
  v_mov_b32 v61, 0
  v_mov_b32 v62, 0
  v_mov_b32 v63, 0
  v_mov_b32 v64, 0
  v_mov_b32 v65, 0
  v_mov_b32 v66, 0
  v_mov_b32 v67, 0
  s_waitcnt lgkmcnt(0)
  s_barrier
  s_nop 0
  s_cmp_lt_u32 s81, 32
  s_cbranch_scc1 QKS_loop
QK_loop:
  s_cmp_eq_u32 s24, 0
  s_cbranch_scc1 QK_s1w0
  s_cmp_eq_u32 s24, 1
  s_cbranch_scc1 QK_s1w1
  s_cmp_eq_u32 s24, 2
  s_cbranch_scc1 QK_s1w2
QK_s1w3:
  ds_read_b128 v[32:35], v16 offset:7680
  ds_read_b128 v[36:39], v16 offset:8192
  ds_read_b128 v[40:43], v16 offset:8704
  s_waitcnt lgkmcnt(2)
  v_smfmac_f32_16x16x64_bf16 v[56:59], v[32:35], v[160:167], v8
  ds_read_b128 v[44:47], v16 offset:9216
  v_smfmac_f32_16x16x64_bf16 v[60:63], v[32:35], v[168:175], v8
  v_smfmac_f32_16x16x64_bf16 v[64:67], v[32:35], v[176:183], v8
  s_waitcnt lgkmcnt(2)
  v_smfmac_f32_16x16x64_bf16 v[56:59], v[36:39], v[184:191], v8
  ds_read_b128 v[32:35], v16 offset:9728
  v_smfmac_f32_16x16x64_bf16 v[60:63], v[36:39], v[192:199], v8
  v_smfmac_f32_16x16x64_bf16 v[64:67], v[36:39], v[200:207], v8
  s_waitcnt lgkmcnt(2)
  v_smfmac_f32_16x16x64_bf16 v[56:59], v[40:43], v[208:215], v8
  v_smfmac_f32_16x16x64_bf16 v[60:63], v[40:43], v[216:223], v8
  v_smfmac_f32_16x16x64_bf16 v[64:67], v[40:43], v[224:231], v8
  s_waitcnt lgkmcnt(1)
  s_barrier
  v_smfmac_f32_16x16x64_bf16 v[56:59], v[44:47], v[232:239], v8
  ds_read_b128 v[36:39], v16 offset:0
  v_smfmac_f32_16x16x64_bf16 v[60:63], v[44:47], v[240:247], v8
  ds_read_b128 v[40:43], v16 offset:512
  v_smfmac_f32_16x16x64_bf16 v[64:67], v[44:47], v[248:255], v8
  s_waitcnt lgkmcnt(2)
  v_smfmac_f32_16x16x64_bf16 v[56:59], v[32:35], v[80:87], v8
  ds_read_b128 v[44:47], v16 offset:1024
  v_smfmac_f32_16x16x64_bf16 v[60:63], v[32:35], v[88:95], v8
  v_smfmac_f32_16x16x64_bf16 v[64:67], v[32:35], v[96:103], v8
QK_s1t3:
  s_waitcnt lgkmcnt(2)
  v_smfmac_f32_16x16x64_bf16 v[56:59], v[36:39], a[0:7], v8
  ds_read_b128 v[32:35], v16 offset:1536
  v_smfmac_f32_16x16x64_bf16 v[60:63], v[36:39], a[8:15], v8
  ds_read_b128 v[80:83], v54 offset:0
  v_smfmac_f32_16x16x64_bf16 v[64:67], v[36:39], a[16:23], v8
  ds_read_b128 v[84:87], v54 offset:1024
  s_waitcnt lgkmcnt(4)
  v_smfmac_f32_16x16x64_bf16 v[56:59], v[40:43], a[24:31], v8
  ds_read_b128 v[36:39], v16 offset:2048
  buffer_load_dwordx4 v[2:5], v31, s[8:11], s85 offen sc1
  v_smfmac_f32_16x16x64_bf16 v[60:63], v[40:43], a[32:39], v8
  ds_read_b128 v[88:91], v54 offset:2048
  v_smfmac_f32_16x16x64_bf16 v[64:67], v[40:43], a[40:47], v8
  ds_read_b128 v[92:95], v54 offset:3072
  s_waitcnt lgkmcnt(6)
  v_smfmac_f32_16x16x64_bf16 v[56:59], v[44:47], a[48:55], v8
  ds_read_b128 v[40:43], v16 offset:2560
  v_smfmac_f32_16x16x64_bf16 v[60:63], v[44:47], a[56:63], v8
  ds_read_b128 v[96:99], v54 offset:4096
  buffer_load_dwordx4 v[48:51], v31, s[8:11], s85 offen offset:1024 sc1
  v_smfmac_f32_16x16x64_bf16 v[64:67], v[44:47], a[64:71], v8
  ds_read_b128 v[100:103], v54 offset:5120
  s_waitcnt lgkmcnt(8)
  v_smfmac_f32_16x16x64_bf16 v[56:59], v[32:35], a[72:79], v8
  ds_read_b128 v[44:47], v16 offset:3072
  v_smfmac_f32_16x16x64_bf16 v[60:63], v[32:35], a[80:87], v8
  v_smfmac_f32_16x16x64_bf16 v[64:67], v[32:35], a[88:95], v8
  buffer_load_dwordx2 v[52:53], v27, s[8:11], s85 offen offset:2048 sc1
  s_waitcnt lgkmcnt(6)
  v_smfmac_f32_16x16x64_bf16 v[56:59], v[36:39], v[104:111], v8
  ds_read_b128 v[32:35], v16 offset:3584
  v_smfmac_f32_16x16x64_bf16 v[60:63], v[36:39], v[112:119], v8
  v_smfmac_f32_16x16x64_bf16 v[64:67], v[36:39], v[120:127], v8
  s_waitcnt lgkmcnt(4)
  v_smfmac_f32_16x16x64_bf16 v[56:59], v[40:43], a[96:103], v8
  ds_read_b128 v[36:39], v16 offset:4096
  v_smfmac_f32_16x16x64_bf16 v[60:63], v[40:43], a[104:111], v8
  ds_read_b128 v[104:107], v55 offset:0
  v_smfmac_f32_16x16x64_bf16 v[64:67], v[40:43], a[112:119], v8
  ds_read_b128 v[108:111], v55 offset:1024
  s_waitcnt lgkmcnt(4)
  v_smfmac_f32_16x16x64_bf16 v[56:59], v[44:47], a[120:127], v8
  ds_read_b128 v[40:43], v16 offset:4608
  v_smfmac_f32_16x16x64_bf16 v[60:63], v[44:47], a[128:135], v8
  ds_read_b128 v[112:115], v55 offset:2048
  v_smfmac_f32_16x16x64_bf16 v[64:67], v[44:47], a[136:143], v8
  ds_read_b128 v[116:119], v55 offset:3072
  s_waitcnt lgkmcnt(6)
  v_smfmac_f32_16x16x64_bf16 v[56:59], v[32:35], a[144:151], v8
  ds_read_b128 v[44:47], v16 offset:5120
  v_smfmac_f32_16x16x64_bf16 v[60:63], v[32:35], a[152:159], v8
  ds_read_b128 v[120:123], v55 offset:4096
  v_smfmac_f32_16x16x64_bf16 v[64:67], v[32:35], a[160:167], v8
  ds_read_b128 v[124:127], v55 offset:5120
  s_waitcnt lgkmcnt(8)
  v_smfmac_f32_16x16x64_bf16 v[56:59], v[36:39], a[168:175], v8
  ds_read_b128 v[32:35], v16 offset:5632
  v_smfmac_f32_16x16x64_bf16 v[60:63], v[36:39], a[176:183], v8
  v_smfmac_f32_16x16x64_bf16 v[64:67], v[36:39], a[184:191], v8
  s_waitcnt lgkmcnt(6)
  v_smfmac_f32_16x16x64_bf16 v[56:59], v[40:43], v[80:87], v8
  ds_read_b128 v[36:39], v16 offset:6144
  v_smfmac_f32_16x16x64_bf16 v[60:63], v[40:43], v[88:95], v8
  v_smfmac_f32_16x16x64_bf16 v[64:67], v[40:43], v[96:103], v8
  s_waitcnt lgkmcnt(4)
  v_smfmac_f32_16x16x64_bf16 v[56:59], v[44:47], a[192:199], v8
  ds_read_b128 v[40:43], v16 offset:6656
  s_waitcnt vmcnt(2)
  buffer_store_dwordx4 v[2:5], v31, s[8:11], s86 offen sc1
  v_smfmac_f32_16x16x64_bf16 v[60:63], v[44:47], a[200:207], v8
  v_smfmac_f32_16x16x64_bf16 v[64:67], v[44:47], a[208:215], v8
  s_waitcnt lgkmcnt(2)
  v_smfmac_f32_16x16x64_bf16 v[56:59], v[32:35], a[216:223], v8
  ds_read_b128 v[44:47], v16 offset:7168
  v_smfmac_f32_16x16x64_bf16 v[60:63], v[32:35], a[224:231], v8
  s_waitcnt vmcnt(2)
  buffer_store_dwordx4 v[48:51], v31, s[8:11], s86 offen offset:1024 sc1
  v_smfmac_f32_16x16x64_bf16 v[64:67], v[32:35], a[232:239], v8
  s_waitcnt lgkmcnt(2)
  v_smfmac_f32_16x16x64_bf16 v[56:59], v[36:39], a[240:247], v8
  s_waitcnt lgkmcnt(1)
  v_smfmac_f32_16x16x64_bf16 v[56:59], v[40:43], v[136:143], v8
  s_waitcnt lgkmcnt(0)
  v_smfmac_f32_16x16x64_bf16 v[56:59], v[44:47], v[104:111], v8
  s_waitcnt vmcnt(2)
  buffer_store_dwordx2 v[52:53], v27, s[8:11], s86 offen offset:2048 sc1
  v_smfmac_f32_16x16x64_bf16 v[60:63], v[36:39], a[248:255], v8
  v_smfmac_f32_16x16x64_bf16 v[60:63], v[40:43], v[144:151], v8
  v_cvt_pk_bf16_f32 v48, v56, v57
  v_cvt_pk_bf16_f32 v49, v58, v59
  v_smfmac_f32_16x16x64_bf16 v[60:63], v[44:47], v[112:119], v8
  v_mfma_f32_16x16x16_bf16 v[104:107], v[48:49], v[10:11], 0
  v_smfmac_f32_16x16x64_bf16 v[64:67], v[36:39], v[128:135], v8
  v_smfmac_f32_16x16x64_bf16 v[64:67], v[40:43], v[152:159], v8
  v_cvt_pk_bf16_f32 v50, v60, v61
  v_cvt_pk_bf16_f32 v51, v62, v63
  v_smfmac_f32_16x16x64_bf16 v[64:67], v[44:47], v[120:127], v8
  s_branch QK_post
QK_s1w0:
  ds_read_b128 v[32:35], v16 offset:0
  ds_read_b128 v[36:39], v16 offset:512
  ds_read_b128 v[40:43], v16 offset:1024
  s_waitcnt lgkmcnt(2)
  v_smfmac_f32_16x16x64_bf16 v[56:59], v[32:35], a[0:7], v8
  ds_read_b128 v[44:47], v16 offset:1536
  v_smfmac_f32_16x16x64_bf16 v[60:63], v[32:35], a[8:15], v8
  v_smfmac_f32_16x16x64_bf16 v[64:67], v[32:35], a[16:23], v8
  s_waitcnt lgkmcnt(2)
  v_smfmac_f32_16x16x64_bf16 v[56:59], v[36:39], a[24:31], v8
  ds_read_b128 v[32:35], v16 offset:2048
  v_smfmac_f32_16x16x64_bf16 v[60:63], v[36:39], a[32:39], v8
  v_smfmac_f32_16x16x64_bf16 v[64:67], v[36:39], a[40:47], v8
  s_waitcnt lgkmcnt(2)
  v_smfmac_f32_16x16x64_bf16 v[56:59], v[40:43], a[48:55], v8
  v_smfmac_f32_16x16x64_bf16 v[60:63], v[40:43], a[56:63], v8
  v_smfmac_f32_16x16x64_bf16 v[64:67], v[40:43], a[64:71], v8
  s_waitcnt lgkmcnt(1)
  s_barrier
  v_smfmac_f32_16x16x64_bf16 v[56:59], v[44:47], a[72:79], v8
  ds_read_b128 v[36:39], v16 offset:2560
  v_smfmac_f32_16x16x64_bf16 v[60:63], v[44:47], a[80:87], v8
  ds_read_b128 v[40:43], v16 offset:3072
  v_smfmac_f32_16x16x64_bf16 v[64:67], v[44:47], a[88:95], v8
  s_waitcnt lgkmcnt(2)
  v_smfmac_f32_16x16x64_bf16 v[56:59], v[32:35], v[80:87], v8
  ds_read_b128 v[44:47], v16 offset:3584
  v_smfmac_f32_16x16x64_bf16 v[60:63], v[32:35], v[88:95], v8
  v_smfmac_f32_16x16x64_bf16 v[64:67], v[32:35], v[96:103], v8
QK_s1t0:
  s_waitcnt lgkmcnt(2)
  v_smfmac_f32_16x16x64_bf16 v[56:59], v[36:39], a[96:103], v8
  ds_read_b128 v[32:35], v16 offset:4096
  buffer_load_dwordx4 v[2:5], v31, s[8:11], s85 offen sc1
  v_smfmac_f32_16x16x64_bf16 v[60:63], v[36:39], a[104:111], v8
  ds_read_b128 v[80:83], v54 offset:0
  v_smfmac_f32_16x16x64_bf16 v[64:67], v[36:39], a[112:119], v8
  ds_read_b128 v[84:87], v54 offset:1024
  s_waitcnt lgkmcnt(4)
  v_smfmac_f32_16x16x64_bf16 v[56:59], v[40:43], a[120:127], v8
  ds_read_b128 v[36:39], v16 offset:4608
  v_smfmac_f32_16x16x64_bf16 v[60:63], v[40:43], a[128:135], v8
  ds_read_b128 v[88:91], v54 offset:2048
  buffer_load_dwordx4 v[48:51], v31, s[8:11], s85 offen offset:1024 sc1
  v_smfmac_f32_16x16x64_bf16 v[64:67], v[40:43], a[136:143], v8
  ds_read_b128 v[92:95], v54 offset:3072
  s_waitcnt lgkmcnt(6)
  v_smfmac_f32_16x16x64_bf16 v[56:59], v[44:47], a[144:151], v8
  ds_read_b128 v[40:43], v16 offset:5120
  v_smfmac_f32_16x16x64_bf16 v[60:63], v[44:47], a[152:159], v8
  ds_read_b128 v[96:99], v54 offset:4096
  v_smfmac_f32_16x16x64_bf16 v[64:67], v[44:47], a[160:167], v8
  ds_read_b128 v[100:103], v54 offset:5120
  buffer_load_dwordx2 v[52:53], v27, s[8:11], s85 offen offset:2048 sc1
  s_waitcnt lgkmcnt(8)
  v_smfmac_f32_16x16x64_bf16 v[56:59], v[32:35], a[168:175], v8
  ds_read_b128 v[44:47], v16 offset:5632
  v_smfmac_f32_16x16x64_bf16 v[60:63], v[32:35], a[176:183], v8
  v_smfmac_f32_16x16x64_bf16 v[64:67], v[32:35], a[184:191], v8
  s_waitcnt lgkmcnt(6)
  v_smfmac_f32_16x16x64_bf16 v[56:59], v[36:39], v[104:111], v8
  ds_read_b128 v[32:35], v16 offset:6144
  v_smfmac_f32_16x16x64_bf16 v[60:63], v[36:39], v[112:119], v8
  v_smfmac_f32_16x16x64_bf16 v[64:67], v[36:39], v[120:127], v8
  s_waitcnt lgkmcnt(4)
  v_smfmac_f32_16x16x64_bf16 v[56:59], v[40:43], a[192:199], v8
  ds_read_b128 v[36:39], v16 offset:6656
  v_smfmac_f32_16x16x64_bf16 v[60:63], v[40:43], a[200:207], v8
  ds_read_b128 v[104:107], v55 offset:0
  v_smfmac_f32_16x16x64_bf16 v[64:67], v[40:43], a[208:215], v8
  ds_read_b128 v[108:111], v55 offset:1024
  s_waitcnt lgkmcnt(4)
  v_smfmac_f32_16x16x64_bf16 v[56:59], v[44:47], a[216:223], v8
  ds_read_b128 v[40:43], v16 offset:7168
  v_smfmac_f32_16x16x64_bf16 v[60:63], v[44:47], a[224:231], v8
  ds_read_b128 v[112:115], v55 offset:2048
  v_smfmac_f32_16x16x64_bf16 v[64:67], v[44:47], a[232:239], v8
  ds_read_b128 v[116:119], v55 offset:3072
  s_waitcnt lgkmcnt(6)
  v_smfmac_f32_16x16x64_bf16 v[56:59], v[32:35], a[240:247], v8
  ds_read_b128 v[44:47], v16 offset:7680
  v_smfmac_f32_16x16x64_bf16 v[60:63], v[32:35], a[248:255], v8
  ds_read_b128 v[120:123], v55 offset:4096
  v_smfmac_f32_16x16x64_bf16 v[64:67], v[32:35], v[128:135], v8
  ds_read_b128 v[124:127], v55 offset:5120
  s_waitcnt lgkmcnt(8)
  v_smfmac_f32_16x16x64_bf16 v[56:59], v[36:39], v[136:143], v8
  ds_read_b128 v[32:35], v16 offset:8192
  v_smfmac_f32_16x16x64_bf16 v[60:63], v[36:39], v[144:151], v8
  v_smfmac_f32_16x16x64_bf16 v[64:67], v[36:39], v[152:159], v8
  s_waitcnt lgkmcnt(6)
  v_smfmac_f32_16x16x64_bf16 v[56:59], v[40:43], v[80:87], v8
  ds_read_b128 v[36:39], v16 offset:8704
  s_waitcnt vmcnt(2)
  buffer_store_dwordx4 v[2:5], v31, s[8:11], s86 offen sc1
  v_smfmac_f32_16x16x64_bf16 v[60:63], v[40:43], v[88:95], v8
  v_smfmac_f32_16x16x64_bf16 v[64:67], v[40:43], v[96:103], v8
  s_waitcnt lgkmcnt(4)
  v_smfmac_f32_16x16x64_bf16 v[56:59], v[44:47], v[160:167], v8
  ds_read_b128 v[40:43], v16 offset:9216
  v_smfmac_f32_16x16x64_bf16 v[60:63], v[44:47], v[168:175], v8
  s_waitcnt vmcnt(2)
  buffer_store_dwordx4 v[48:51], v31, s[8:11], s86 offen offset:1024 sc1
  v_smfmac_f32_16x16x64_bf16 v[64:67], v[44:47], v[176:183], v8
  s_waitcnt lgkmcnt(2)
  v_smfmac_f32_16x16x64_bf16 v[56:59], v[32:35], v[184:191], v8
  ds_read_b128 v[44:47], v16 offset:9728
  v_smfmac_f32_16x16x64_bf16 v[60:63], v[32:35], v[192:199], v8
  v_smfmac_f32_16x16x64_bf16 v[64:67], v[32:35], v[200:207], v8
  s_waitcnt vmcnt(2)
  buffer_store_dwordx2 v[52:53], v27, s[8:11], s86 offen offset:2048 sc1
  s_waitcnt lgkmcnt(2)
  v_smfmac_f32_16x16x64_bf16 v[56:59], v[36:39], v[208:215], v8
  s_waitcnt lgkmcnt(1)
  v_smfmac_f32_16x16x64_bf16 v[56:59], v[40:43], v[232:239], v8
  s_waitcnt lgkmcnt(0)
  v_smfmac_f32_16x16x64_bf16 v[56:59], v[44:47], v[104:111], v8
  v_smfmac_f32_16x16x64_bf16 v[60:63], v[36:39], v[216:223], v8
  v_smfmac_f32_16x16x64_bf16 v[60:63], v[40:43], v[240:247], v8
  v_cvt_pk_bf16_f32 v48, v56, v57
  v_cvt_pk_bf16_f32 v49, v58, v59
  v_smfmac_f32_16x16x64_bf16 v[60:63], v[44:47], v[112:119], v8
  v_mfma_f32_16x16x16_bf16 v[104:107], v[48:49], v[10:11], 0
  v_smfmac_f32_16x16x64_bf16 v[64:67], v[36:39], v[224:231], v8
  v_smfmac_f32_16x16x64_bf16 v[64:67], v[40:43], v[248:255], v8
  v_cvt_pk_bf16_f32 v50, v60, v61
  v_cvt_pk_bf16_f32 v51, v62, v63
  v_smfmac_f32_16x16x64_bf16 v[64:67], v[44:47], v[120:127], v8
  s_branch QK_post
QK_s1w1:
  ds_read_b128 v[32:35], v16 offset:2560
  ds_read_b128 v[36:39], v16 offset:3072
  ds_read_b128 v[40:43], v16 offset:3584
  s_waitcnt lgkmcnt(2)
  v_smfmac_f32_16x16x64_bf16 v[56:59], v[32:35], a[96:103], v8
  ds_read_b128 v[44:47], v16 offset:4096
  v_smfmac_f32_16x16x64_bf16 v[60:63], v[32:35], a[104:111], v8
  v_smfmac_f32_16x16x64_bf16 v[64:67], v[32:35], a[112:119], v8
  s_waitcnt lgkmcnt(2)
  v_smfmac_f32_16x16x64_bf16 v[56:59], v[36:39], a[120:127], v8
  ds_read_b128 v[32:35], v16 offset:4608
  v_smfmac_f32_16x16x64_bf16 v[60:63], v[36:39], a[128:135], v8
  v_smfmac_f32_16x16x64_bf16 v[64:67], v[36:39], a[136:143], v8
  s_waitcnt lgkmcnt(2)
  v_smfmac_f32_16x16x64_bf16 v[56:59], v[40:43], a[144:151], v8
  v_smfmac_f32_16x16x64_bf16 v[60:63], v[40:43], a[152:159], v8
  v_smfmac_f32_16x16x64_bf16 v[64:67], v[40:43], a[160:167], v8
  s_waitcnt lgkmcnt(1)
  s_barrier
  v_smfmac_f32_16x16x64_bf16 v[56:59], v[44:47], a[168:175], v8
  ds_read_b128 v[36:39], v16 offset:5120
  v_smfmac_f32_16x16x64_bf16 v[60:63], v[44:47], a[176:183], v8
  ds_read_b128 v[40:43], v16 offset:5632
  v_smfmac_f32_16x16x64_bf16 v[64:67], v[44:47], a[184:191], v8
  s_waitcnt lgkmcnt(2)
  v_smfmac_f32_16x16x64_bf16 v[56:59], v[32:35], v[80:87], v8
  ds_read_b128 v[44:47], v16 offset:6144
  v_smfmac_f32_16x16x64_bf16 v[60:63], v[32:35], v[88:95], v8
  v_smfmac_f32_16x16x64_bf16 v[64:67], v[32:35], v[96:103], v8
QK_s1t1:
  s_waitcnt lgkmcnt(2)
  v_smfmac_f32_16x16x64_bf16 v[56:59], v[36:39], a[192:199], v8
  ds_read_b128 v[32:35], v16 offset:6656
  v_smfmac_f32_16x16x64_bf16 v[60:63], v[36:39], a[200:207], v8
  ds_read_b128 v[80:83], v54 offset:0
  buffer_load_dwordx4 v[2:5], v31, s[8:11], s85 offen sc1
  v_smfmac_f32_16x16x64_bf16 v[64:67], v[36:39], a[208:215], v8
  ds_read_b128 v[84:87], v54 offset:1024
  s_waitcnt lgkmcnt(4)
  v_smfmac_f32_16x16x64_bf16 v[56:59], v[40:43], a[216:223], v8
  ds_read_b128 v[36:39], v16 offset:7168
  v_smfmac_f32_16x16x64_bf16 v[60:63], v[40:43], a[224:231], v8
  ds_read_b128 v[88:91], v54 offset:2048
  v_smfmac_f32_16x16x64_bf16 v[64:67], v[40:43], a[232:239], v8
  ds_read_b128 v[92:95], v54 offset:3072
  buffer_load_dwordx4 v[48:51], v31, s[8:11], s85 offen offset:1024 sc1
  s_waitcnt lgkmcnt(6)
  v_smfmac_f32_16x16x64_bf16 v[56:59], v[44:47], a[240:247], v8
  ds_read_b128 v[40:43], v16 offset:7680
  v_smfmac_f32_16x16x64_bf16 v[60:63], v[44:47], a[248:255], v8
  ds_read_b128 v[96:99], v54 offset:4096
  v_smfmac_f32_16x16x64_bf16 v[64:67], v[44:47], v[128:135], v8
  ds_read_b128 v[100:103], v54 offset:5120
  s_waitcnt lgkmcnt(8)
  v_smfmac_f32_16x16x64_bf16 v[56:59], v[32:35], v[136:143], v8
  ds_read_b128 v[44:47], v16 offset:8192
  buffer_load_dwordx2 v[52:53], v27, s[8:11], s85 offen offset:2048 sc1
  v_smfmac_f32_16x16x64_bf16 v[60:63], v[32:35], v[144:151], v8
  v_smfmac_f32_16x16x64_bf16 v[64:67], v[32:35], v[152:159], v8
  s_waitcnt lgkmcnt(6)
  v_smfmac_f32_16x16x64_bf16 v[56:59], v[36:39], v[104:111], v8
  ds_read_b128 v[32:35], v16 offset:8704
  v_smfmac_f32_16x16x64_bf16 v[60:63], v[36:39], v[112:119], v8
  v_smfmac_f32_16x16x64_bf16 v[64:67], v[36:39], v[120:127], v8
  s_waitcnt lgkmcnt(4)
  v_smfmac_f32_16x16x64_bf16 v[56:59], v[40:43], v[160:167], v8
  ds_read_b128 v[36:39], v16 offset:9216
  v_smfmac_f32_16x16x64_bf16 v[60:63], v[40:43], v[168:175], v8
  ds_read_b128 v[104:107], v55 offset:0
  v_smfmac_f32_16x16x64_bf16 v[64:67], v[40:43], v[176:183], v8
  ds_read_b128 v[108:111], v55 offset:1024
  s_waitcnt lgkmcnt(4)
  v_smfmac_f32_16x16x64_bf16 v[56:59], v[44:47], v[184:191], v8
  ds_read_b128 v[40:43], v16 offset:9728
  v_smfmac_f32_16x16x64_bf16 v[60:63], v[44:47], v[192:199], v8
  ds_read_b128 v[112:115], v55 offset:2048
  v_smfmac_f32_16x16x64_bf16 v[64:67], v[44:47], v[200:207], v8
  ds_read_b128 v[116:119], v55 offset:3072
  s_waitcnt lgkmcnt(6)
  v_smfmac_f32_16x16x64_bf16 v[56:59], v[32:35], v[208:215], v8
  ds_read_b128 v[44:47], v16 offset:0
  v_smfmac_f32_16x16x64_bf16 v[60:63], v[32:35], v[216:223], v8
  ds_read_b128 v[120:123], v55 offset:4096
  v_smfmac_f32_16x16x64_bf16 v[64:67], v[32:35], v[224:231], v8
  ds_read_b128 v[124:127], v55 offset:5120
  s_waitcnt lgkmcnt(8)
  v_smfmac_f32_16x16x64_bf16 v[56:59], v[36:39], v[232:239], v8
  ds_read_b128 v[32:35], v16 offset:512
  v_smfmac_f32_16x16x64_bf16 v[60:63], v[36:39], v[240:247], v8
  v_smfmac_f32_16x16x64_bf16 v[64:67], v[36:39], v[248:255], v8
  s_waitcnt lgkmcnt(6)
  v_smfmac_f32_16x16x64_bf16 v[56:59], v[40:43], v[80:87], v8
  ds_read_b128 v[36:39], v16 offset:1024
  v_smfmac_f32_16x16x64_bf16 v[60:63], v[40:43], v[88:95], v8
  s_waitcnt vmcnt(2)
  buffer_store_dwordx4 v[2:5], v31, s[8:11], s86 offen sc1
  v_smfmac_f32_16x16x64_bf16 v[64:67], v[40:43], v[96:103], v8
  s_waitcnt lgkmcnt(4)
  v_smfmac_f32_16x16x64_bf16 v[56:59], v[44:47], a[0:7], v8
  ds_read_b128 v[40:43], v16 offset:1536
  v_smfmac_f32_16x16x64_bf16 v[60:63], v[44:47], a[8:15], v8
  v_smfmac_f32_16x16x64_bf16 v[64:67], v[44:47], a[16:23], v8
  s_waitcnt vmcnt(2)
  buffer_store_dwordx4 v[48:51], v31, s[8:11], s86 offen offset:1024 sc1
  s_waitcnt lgkmcnt(2)
  v_smfmac_f32_16x16x64_bf16 v[56:59], v[32:35], a[24:31], v8
  ds_read_b128 v[44:47], v16 offset:2048
  v_smfmac_f32_16x16x64_bf16 v[60:63], v[32:35], a[32:39], v8
  v_smfmac_f32_16x16x64_bf16 v[64:67], v[32:35], a[40:47], v8
  s_waitcnt lgkmcnt(2)
  v_smfmac_f32_16x16x64_bf16 v[56:59], v[36:39], a[48:55], v8
  s_waitcnt vmcnt(2)
  buffer_store_dwordx2 v[52:53], v27, s[8:11], s86 offen offset:2048 sc1
  s_waitcnt lgkmcnt(1)
  v_smfmac_f32_16x16x64_bf16 v[56:59], v[40:43], a[72:79], v8
  s_waitcnt lgkmcnt(0)
  v_smfmac_f32_16x16x64_bf16 v[56:59], v[44:47], v[104:111], v8
  v_smfmac_f32_16x16x64_bf16 v[60:63], v[36:39], a[56:63], v8
  v_smfmac_f32_16x16x64_bf16 v[60:63], v[40:43], a[80:87], v8
  v_cvt_pk_bf16_f32 v48, v56, v57
  v_cvt_pk_bf16_f32 v49, v58, v59
  v_smfmac_f32_16x16x64_bf16 v[60:63], v[44:47], v[112:119], v8
  v_mfma_f32_16x16x16_bf16 v[104:107], v[48:49], v[10:11], 0
  v_smfmac_f32_16x16x64_bf16 v[64:67], v[36:39], a[64:71], v8
  v_smfmac_f32_16x16x64_bf16 v[64:67], v[40:43], a[88:95], v8
  v_cvt_pk_bf16_f32 v50, v60, v61
  v_cvt_pk_bf16_f32 v51, v62, v63
  v_smfmac_f32_16x16x64_bf16 v[64:67], v[44:47], v[120:127], v8
  s_branch QK_post
QK_s1w2:
  ds_read_b128 v[32:35], v16 offset:5120
  ds_read_b128 v[36:39], v16 offset:5632
  ds_read_b128 v[40:43], v16 offset:6144
  s_waitcnt lgkmcnt(2)
  v_smfmac_f32_16x16x64_bf16 v[56:59], v[32:35], a[192:199], v8
  ds_read_b128 v[44:47], v16 offset:6656
  v_smfmac_f32_16x16x64_bf16 v[60:63], v[32:35], a[200:207], v8
  v_smfmac_f32_16x16x64_bf16 v[64:67], v[32:35], a[208:215], v8
  s_waitcnt lgkmcnt(2)
  v_smfmac_f32_16x16x64_bf16 v[56:59], v[36:39], a[216:223], v8
  ds_read_b128 v[32:35], v16 offset:7168
  v_smfmac_f32_16x16x64_bf16 v[60:63], v[36:39], a[224:231], v8
  v_smfmac_f32_16x16x64_bf16 v[64:67], v[36:39], a[232:239], v8
  s_waitcnt lgkmcnt(2)
  v_smfmac_f32_16x16x64_bf16 v[56:59], v[40:43], a[240:247], v8
  v_smfmac_f32_16x16x64_bf16 v[60:63], v[40:43], a[248:255], v8
  v_smfmac_f32_16x16x64_bf16 v[64:67], v[40:43], v[128:135], v8
  s_waitcnt lgkmcnt(1)
  s_barrier
  v_smfmac_f32_16x16x64_bf16 v[56:59], v[44:47], v[136:143], v8
  ds_read_b128 v[36:39], v16 offset:7680
  v_smfmac_f32_16x16x64_bf16 v[60:63], v[44:47], v[144:151], v8
  ds_read_b128 v[40:43], v16 offset:8192
  v_smfmac_f32_16x16x64_bf16 v[64:67], v[44:47], v[152:159], v8
  s_waitcnt lgkmcnt(2)
  v_smfmac_f32_16x16x64_bf16 v[56:59], v[32:35], v[80:87], v8
  ds_read_b128 v[44:47], v16 offset:8704
  v_smfmac_f32_16x16x64_bf16 v[60:63], v[32:35], v[88:95], v8
  v_smfmac_f32_16x16x64_bf16 v[64:67], v[32:35], v[96:103], v8
QK_s1t2:
  s_waitcnt lgkmcnt(2)
  v_smfmac_f32_16x16x64_bf16 v[56:59], v[36:39], v[160:167], v8
  ds_read_b128 v[32:35], v16 offset:9216
  v_smfmac_f32_16x16x64_bf16 v[60:63], v[36:39], v[168:175], v8
  ds_read_b128 v[80:83], v54 offset:0
  v_smfmac_f32_16x16x64_bf16 v[64:67], v[36:39], v[176:183], v8
  ds_read_b128 v[84:87], v54 offset:1024
  buffer_load_dwordx4 v[2:5], v31, s[8:11], s85 offen sc1
  s_waitcnt lgkmcnt(4)
  v_smfmac_f32_16x16x64_bf16 v[56:59], v[40:43], v[184:191], v8
  ds_read_b128 v[36:39], v16 offset:9728
  v_smfmac_f32_16x16x64_bf16 v[60:63], v[40:43], v[192:199], v8
  ds_read_b128 v[88:91], v54 offset:2048
  v_smfmac_f32_16x16x64_bf16 v[64:67], v[40:43], v[200:207], v8
  ds_read_b128 v[92:95], v54 offset:3072
  s_waitcnt lgkmcnt(6)
  v_smfmac_f32_16x16x64_bf16 v[56:59], v[44:47], v[208:215], v8
  ds_read_b128 v[40:43], v16 offset:0
  buffer_load_dwordx4 v[48:51], v31, s[8:11], s85 offen offset:1024 sc1
  v_smfmac_f32_16x16x64_bf16 v[60:63], v[44:47], v[216:223], v8
  ds_read_b128 v[96:99], v54 offset:4096
  v_smfmac_f32_16x16x64_bf16 v[64:67], v[44:47], v[224:231], v8
  ds_read_b128 v[100:103], v54 offset:5120
  s_waitcnt lgkmcnt(8)
  v_smfmac_f32_16x16x64_bf16 v[56:59], v[32:35], v[232:239], v8
  ds_read_b128 v[44:47], v16 offset:512
  v_smfmac_f32_16x16x64_bf16 v[60:63], v[32:35], v[240:247], v8
  buffer_load_dwordx2 v[52:53], v27, s[8:11], s85 offen offset:2048 sc1
  v_smfmac_f32_16x16x64_bf16 v[64:67], v[32:35], v[248:255], v8
  s_waitcnt lgkmcnt(6)
  v_smfmac_f32_16x16x64_bf16 v[56:59], v[36:39], v[104:111], v8
  ds_read_b128 v[32:35], v16 offset:1024
  v_smfmac_f32_16x16x64_bf16 v[60:63], v[36:39], v[112:119], v8
  v_smfmac_f32_16x16x64_bf16 v[64:67], v[36:39], v[120:127], v8
  s_waitcnt lgkmcnt(4)
  v_smfmac_f32_16x16x64_bf16 v[56:59], v[40:43], a[0:7], v8
  ds_read_b128 v[36:39], v16 offset:1536
  v_smfmac_f32_16x16x64_bf16 v[60:63], v[40:43], a[8:15], v8
  ds_read_b128 v[104:107], v55 offset:0
  v_smfmac_f32_16x16x64_bf16 v[64:67], v[40:43], a[16:23], v8
  ds_read_b128 v[108:111], v55 offset:1024
  s_waitcnt lgkmcnt(4)
  v_smfmac_f32_16x16x64_bf16 v[56:59], v[44:47], a[24:31], v8
  ds_read_b128 v[40:43], v16 offset:2048
  v_smfmac_f32_16x16x64_bf16 v[60:63], v[44:47], a[32:39], v8
  ds_read_b128 v[112:115], v55 offset:2048
  v_smfmac_f32_16x16x64_bf16 v[64:67], v[44:47], a[40:47], v8
  ds_read_b128 v[116:119], v55 offset:3072
  s_waitcnt lgkmcnt(6)
  v_smfmac_f32_16x16x64_bf16 v[56:59], v[32:35], a[48:55], v8
  ds_read_b128 v[44:47], v16 offset:2560
  v_smfmac_f32_16x16x64_bf16 v[60:63], v[32:35], a[56:63], v8
  ds_read_b128 v[120:123], v55 offset:4096
  v_smfmac_f32_16x16x64_bf16 v[64:67], v[32:35], a[64:71], v8
  ds_read_b128 v[124:127], v55 offset:5120
  s_waitcnt lgkmcnt(8)
  v_smfmac_f32_16x16x64_bf16 v[56:59], v[36:39], a[72:79], v8
  ds_read_b128 v[32:35], v16 offset:3072
  v_smfmac_f32_16x16x64_bf16 v[60:63], v[36:39], a[80:87], v8
  v_smfmac_f32_16x16x64_bf16 v[64:67], v[36:39], a[88:95], v8
  s_waitcnt lgkmcnt(6)
  v_smfmac_f32_16x16x64_bf16 v[56:59], v[40:43], v[80:87], v8
  ds_read_b128 v[36:39], v16 offset:3584
  v_smfmac_f32_16x16x64_bf16 v[60:63], v[40:43], v[88:95], v8
  v_smfmac_f32_16x16x64_bf16 v[64:67], v[40:43], v[96:103], v8
  s_waitcnt vmcnt(2)
  buffer_store_dwordx4 v[2:5], v31, s[8:11], s86 offen sc1
  s_waitcnt lgkmcnt(4)
  v_smfmac_f32_16x16x64_bf16 v[56:59], v[44:47], a[96:103], v8
  ds_read_b128 v[40:43], v16 offset:4096
  v_smfmac_f32_16x16x64_bf16 v[60:63], v[44:47], a[104:111], v8
  v_smfmac_f32_16x16x64_bf16 v[64:67], v[44:47], a[112:119], v8
  s_waitcnt lgkmcnt(2)
  v_smfmac_f32_16x16x64_bf16 v[56:59], v[32:35], a[120:127], v8
  ds_read_b128 v[44:47], v16 offset:4608
  s_waitcnt vmcnt(2)
  buffer_store_dwordx4 v[48:51], v31, s[8:11], s86 offen offset:1024 sc1
  v_smfmac_f32_16x16x64_bf16 v[60:63], v[32:35], a[128:135], v8
  v_smfmac_f32_16x16x64_bf16 v[64:67], v[32:35], a[136:143], v8
  s_waitcnt lgkmcnt(2)
  v_smfmac_f32_16x16x64_bf16 v[56:59], v[36:39], a[144:151], v8
  s_waitcnt lgkmcnt(1)
  v_smfmac_f32_16x16x64_bf16 v[56:59], v[40:43], a[168:175], v8
  s_waitcnt vmcnt(2)
  buffer_store_dwordx2 v[52:53], v27, s[8:11], s86 offen offset:2048 sc1
  s_waitcnt lgkmcnt(0)
  v_smfmac_f32_16x16x64_bf16 v[56:59], v[44:47], v[104:111], v8
  v_smfmac_f32_16x16x64_bf16 v[60:63], v[36:39], a[152:159], v8
  v_smfmac_f32_16x16x64_bf16 v[60:63], v[40:43], a[176:183], v8
  v_cvt_pk_bf16_f32 v48, v56, v57
  v_cvt_pk_bf16_f32 v49, v58, v59
  v_smfmac_f32_16x16x64_bf16 v[60:63], v[44:47], v[112:119], v8
  v_mfma_f32_16x16x16_bf16 v[104:107], v[48:49], v[10:11], 0
  v_smfmac_f32_16x16x64_bf16 v[64:67], v[36:39], a[160:167], v8
  v_smfmac_f32_16x16x64_bf16 v[64:67], v[40:43], a[184:191], v8
  v_cvt_pk_bf16_f32 v50, v60, v61
  v_cvt_pk_bf16_f32 v51, v62, v63
  v_smfmac_f32_16x16x64_bf16 v[64:67], v[44:47], v[120:127], v8
QK_post:
  v_mfma_f32_16x16x16_bf16 v[108:111], v[50:51], v[10:11], 0
  v_cvt_pk_bf16_f32 v80, v104, v105
  v_cvt_pk_bf16_f32 v81, v106, v107
  s_waitcnt vmcnt(3)
  s_nop 0
  v_cvt_pk_bf16_f32 v52, v64, v65
  v_cvt_pk_bf16_f32 v53, v66, v67
  s_nop 1
  v_mfma_f32_16x16x16_bf16 v[112:115], v[52:53], v[10:11], 0
  v_cvt_pk_bf16_f32 v82, v108, v109
  v_cvt_pk_bf16_f32 v83, v110, v111
  s_nop 1
  v_mfma_f32_16x16x32_bf16 v[88:91], v[68:71], v[80:83], 0
  v_mfma_f32_16x16x32_bf16 v[92:95], v[72:75], v[80:83], 0
  v_cvt_pk_bf16_f32 v84, v112, v113
  v_cvt_pk_bf16_f32 v85, v114, v115
  v_mfma_f32_16x16x32_bf16 v[96:99], v[80:83], v[80:83], 0
  v_mfma_f32_16x16x16_bf16 v[88:91], v[76:77], v[84:85], v[88:91]
  v_mfma_f32_16x16x16_bf16 v[92:95], v[78:79], v[84:85], v[92:95]
  v_mfma_f32_16x16x16_bf16 v[96:99], v[84:85], v[84:85], v[96:99]
  s_mov_b32 exec_lo, 0x00ff00ff
  s_mov_b32 exec_hi, 0x00ff00ff
  ds_write_b128 v22, v[88:91]
  s_nop 0
  ds_write_b128 v23, v[92:95]
  s_nop 2
  ds_write_b128 v24, v[96:99]
  s_mov_b64 exec, -1
  s_cmp_eq_u32 s28, 63
  s_cbranch_scc1 QK_last
  s_cmp_lg_u32 s24, 0
  s_waitcnt lgkmcnt(0)
  s_barrier
  s_cbranch_scc1 QK_nosm
  ds_read_b128 v[104:107], v25 offset:0
  ds_read_b32 v120, v26 offset:0
  ds_read_b128 v[108:111], v25 offset:1536
  ds_read_b32 v121, v26 offset:1536
  ds_read_b128 v[112:115], v25 offset:3072
  ds_read_b32 v122, v26 offset:3072
  ds_read_b128 v[116:119], v25 offset:4608
  ds_read_b32 v123, v26 offset:4608
  s_waitcnt lgkmcnt(4)
  v_pk_add_f32 v[104:105], v[104:105], v[108:109]
  v_pk_add_f32 v[106:107], v[106:107], v[110:111]
  v_add_f32 v120, v120, v121
  s_waitcnt lgkmcnt(0)
  v_pk_add_f32 v[112:113], v[112:113], v[116:117]
  v_pk_add_f32 v[114:115], v[114:115], v[118:119]
  v_add_f32 v122, v122, v123
  v_pk_add_f32 v[104:105], v[104:105], v[112:113]
  v_pk_add_f32 v[106:107], v[106:107], v[114:115]
  v_add_f32 v120, v120, v122
  v_max3_f32 v32, v104, v105, v106
  v_max3_f32 v32, v32, v107, v120
  s_nop 1
  v_max_f32_dpp v32, v32, v32 quad_perm:[1,0,3,2] row_mask:0xf bank_mask:0xf
  s_nop 1
  v_max_f32_dpp v32, v32, v32 quad_perm:[2,3,0,1] row_mask:0xf bank_mask:0xf
  s_nop 1
  v_max_f32_dpp v32, v32, v32 row_ror:8 row_mask:0xf bank_mask:0xf
  v_mul_f32 v32, s36, v32
  v_fma_f32 v120, v120, s36, -v32
  v_fma_f32 v104, v104, s36, -v32
  v_fma_f32 v105, v105, s36, -v32
  v_fma_f32 v106, v106, s36, -v32
  v_fma_f32 v107, v107, s36, -v32
  v_exp_f32 v104, v104
  v_exp_f32 v105, v105
  v_exp_f32 v106, v106
  v_exp_f32 v107, v107
  v_exp_f32 v120, v120
  v_add_f32 v32, v104, v105
  v_add_f32 v33, v106, v107
  v_add_f32 v32, v32, v120
  v_add_f32 v32, v32, v33
  s_nop 1
  v_add_f32_dpp v32, v32, v32 quad_perm:[1,0,3,2] row_mask:0xf bank_mask:0xf
  s_nop 1
  v_add_f32_dpp v32, v32, v32 quad_perm:[2,3,0,1] row_mask:0xf bank_mask:0xf
  s_nop 1
  v_add_f32_dpp v32, v32, v32 row_ror:8 row_mask:0xf bank_mask:0xf
  v_rcp_f32 v32, v32
  s_nop 0
  v_mul_f32 v120, v120, v32
  v_mul_f32 v104, v104, v32
  v_mul_f32 v105, v105, v32
  v_mul_f32 v106, v106, v32
  v_mul_f32 v107, v107, v32
  v_mov_b32_dpp v34, v120 quad_perm:[0,0,2,2] row_mask:0xf bank_mask:0xf
  v_mov_b32_dpp v35, v120 quad_perm:[1,1,3,3] row_mask:0xf bank_mask:0xf
  v_cvt_pk_bf16_f32 v36, v104, v105
  v_cvt_pk_bf16_f32 v37, v106, v107
  v_cvt_pk_bf16_f32 v38, v34, v35
  v_bfi_b32 v36, v9, v36, s29
  v_bfi_b32 v37, v9, v37, s29
  buffer_store_dwordx2 v[36:37], v27, s[8:11], s37 offen
  v_bfi_b32 v38, v9, v38, s29
  buffer_store_dword v38, v28, s[8:11], s37 offen
QK_nosm:
  s_barrier
  s_sleep 1
  s_sleep 1
  s_sleep 1
  s_sleep 1
  s_sleep 1
  s_sleep 1
  s_sleep 1
  s_sleep 1
  s_sleep 1
  s_sleep 1
  v_cmp_eq_u32 vcc, 0, v0
  s_add_u32 s31, s28, 1
  s_cbranch_vccz QK_nokf
  s_lshr_b32 s30, s31, 3
  s_lshl_b32 s30, s30, 9
  s_add_u32 s30, s30, s55
  v_and_b32 v3, 4, v28
QK_kf:
  buffer_load_dword v2, v3, s[8:11], s30 offen sc1
  s_sub_u32 s82, s82, 1
  s_cbranch_scc1 L_abort
  s_waitcnt vmcnt(0)
  v_cmp_eq_u32 vcc, 0, v2
  s_cbranch_vccnz QK_kf
QK_nokf:
  buffer_load_dwordx4 v[68:71], v20, s[8:11], s38 offen offset:0 sc1
  buffer_load_dwordx4 v[72:75], v20, s[8:11], s38 offen offset:256 sc1
  buffer_load_dwordx2 v[76:77], v21, s[8:11], s38 offen offset:0 sc1
  buffer_load_dwordx2 v[78:79], v21, s[8:11], s38 offen offset:256 sc1
  s_add_u32 s38, s38, 393216
  s_add_u32 s85, s85, s88
  s_sub_u32 s88, 0, s88
  s_mov_b32 s86, s87
  s_add_u32 s87, s87, 327680
  s_add_u32 s30, s28, 2
  s_min_u32 s30, s30, 63
  s_lshr_b32 s30, s30, 3
  s_lshl_b32 s30, s30, 9
  s_add_u32 s30, s30, s55
  v_and_b32 v3, 4, v28
  buffer_load_dword v0, v3, s[8:11], s30 offen sc1
  s_mov_b32 exec_lo, 0xff00ff00
  s_mov_b32 exec_hi, 0xff00ff00
  buffer_store_dwordx4 v[80:83], v29, s[8:11], s54 offen sc1
  buffer_store_dwordx2 v[84:85], v30, s[8:11], s54 offen sc1
  s_mov_b64 exec, -1
  s_add_u32 s54, s54, 98304
  s_cmp_lg_u32 s24, 3
  s_cbranch_scc1 QK_nofl
  v_mov_b32 v2, s28
  s_mov_b64 exec, 1
  buffer_store_dword v2, off, s[8:11], s34 sc1
  s_max_u32 s30, s28, 1
  s_sub_u32 s30, s30, 1
  v_mov_b32 v4, s30
  s_add_u32 s30, s34, 4096
  buffer_store_dword v4, off, s[8:11], s30 sc1
  s_mov_b64 exec, -1
QK_nofl:
  s_add_u32 s30, s28, 1
  s_lshl_b32 s53, s30, 17
  s_lshl_b32 s30, s30, 9
  s_and_b32 s30, s30, 0x2000
  s_xor_b32 s30, s30, s47
  s_add_u32 s53, s53, s30
  s_add_u32 s48, s53, s40
  s_add_u32 s49, s53, s41
  s_add_u32 s50, s53, s42
  s_add_u32 s51, s53, s43
  s_add_u32 s52, s53, s44
  s_add_u32 s30, s28, 1
  s_cmp_lg_u32 s24, 1
  s_cbranch_scc1 QK_mkb
  s_sleep 1
  s_sleep 1
  s_sleep 1
  s_sleep 1
  s_mov_b64 exec, 65535
  buffer_load_dword v1, v19, s[8:11], s45 offen sc1
  s_nop 15
  s_nop 7
QK_mk:
  buffer_load_dword v2, v19, s[8:11], s45 offen sc1
  s_waitcnt vmcnt(1)
  v_cmp_gt_i32 vcc, s30, v1
  s_cbranch_vccz QK_mkok
  buffer_load_dword v1, v19, s[8:11], s45 offen sc1
  s_sub_u32 s82, s82, 1
  s_cbranch_scc1 L_abort
  s_waitcnt vmcnt(1)
  v_cmp_gt_i32 vcc, s30, v2
  s_cbranch_vccnz QK_mk
QK_mkok:
  s_mov_b64 exec, -1
QK_mkb:
  s_barrier
  buffer_load_dwordx4 v[32:35], v18, s[8:11], s48 offen sc1
  buffer_load_dwordx4 v[36:39], v18, s[8:11], s49 offen sc1
  buffer_load_dwordx4 v[40:43], v18, s[8:11], s50 offen sc1
  buffer_load_dwordx4 v[44:47], v18, s[8:11], s51 offen sc1
  buffer_load_dwordx4 v[48:51], v18, s[8:11], s52 offen sc1
  ds_read_b128 v[80:83], v6 offset:0
  ds_read_b128 v[84:87], v6 offset:1024
  ds_read_b128 v[88:91], v6 offset:2048
  ds_read_b128 v[92:95], v6 offset:3072
  ds_read_b128 v[96:99], v6 offset:4096
  ds_read_b128 v[100:103], v6 offset:5120
  ds_read_b128 v[104:107], v7 offset:0
  ds_read_b128 v[108:111], v7 offset:1024
  ds_read_b128 v[112:115], v7 offset:2048
  ds_read_b128 v[116:119], v7 offset:3072
  ds_read_b128 v[120:123], v7 offset:4096
  ds_read_b128 v[124:127], v7 offset:5120
  v_mov_b32 v56, 0
  v_mov_b32 v57, 0
  v_mov_b32 v58, 0
  v_mov_b32 v59, 0
  v_mov_b32 v60, 0
  v_mov_b32 v61, 0
  v_mov_b32 v62, 0
  v_mov_b32 v63, 0
  v_mov_b32 v64, 0
  v_mov_b32 v65, 0
  v_mov_b32 v66, 0
  v_mov_b32 v67, 0
  s_add_u32 s28, s28, 1
  s_xor_b32 s29, s29, 0x80008000
  s_cmp_eq_u32 s24, 0
  s_cbranch_scc1 QK_fz0
  s_cmp_eq_u32 s24, 1
  s_cbranch_scc1 QK_fz1
  s_cmp_eq_u32 s24, 2
  s_cbranch_scc1 QK_fz2
QK_fz3:
  s_waitcnt vmcnt(4)
  v_max3_u32 v3, v32, v33, v34
  v_max_u32 v3, v3, v35
  v_mfma_f32_16x16x32_bf16 v[32:35], v[32:35], v[12:15], 0
  s_waitcnt vmcnt(3)
  v_max3_u32 v3, v36, v37, v3
  v_max3_u32 v3, v38, v39, v3
  v_mfma_f32_16x16x32_bf16 v[36:39], v[36:39], v[12:15], 0
  s_waitcnt vmcnt(2)
  v_max3_u32 v3, v40, v41, v3
  v_max3_u32 v3, v42, v43, v3
  v_mfma_f32_16x16x32_bf16 v[40:43], v[40:43], v[12:15], 0
  v_cvt_pk_bf16_f32 v32, v32, v33
  v_cvt_pk_bf16_f32 v33, v34, v35
  ds_write_b64 v17, v[32:33] offset:0
  ds_read_b128 v[32:35], v16 offset:7680
  s_waitcnt vmcnt(1)
  v_max3_u32 v3, v44, v45, v3
  v_max3_u32 v3, v46, v47, v3
  v_mfma_f32_16x16x32_bf16 v[44:47], v[44:47], v[12:15], 0
  v_cvt_pk_bf16_f32 v36, v36, v37
  v_cvt_pk_bf16_f32 v37, v38, v39
  ds_write_b64 v17, v[36:37] offset:512
  ds_read_b128 v[36:39], v16 offset:8192
  s_waitcnt vmcnt(0)
  v_max3_u32 v3, v48, v49, v3
  v_max3_u32 v3, v50, v51, v3
  v_mfma_f32_16x16x32_bf16 v[48:51], v[48:51], v[12:15], 0
  v_cmp_eq_u32 vcc, -1, v3
  v_cvt_pk_bf16_f32 v40, v40, v41
  v_cvt_pk_bf16_f32 v41, v42, v43
  ds_write_b64 v17, v[40:41] offset:1024
  ds_read_b128 v[40:43], v16 offset:8704
  s_waitcnt lgkmcnt(4)
  v_smfmac_f32_16x16x64_bf16 v[56:59], v[32:35], v[160:167], v8
  v_cvt_pk_bf16_f32 v44, v44, v45
  v_cvt_pk_bf16_f32 v45, v46, v47
  ds_write_b64 v17, v[44:45] offset:1536
  ds_read_b128 v[44:47], v16 offset:9216
  v_smfmac_f32_16x16x64_bf16 v[60:63], v[32:35], v[168:175], v8
  v_smfmac_f32_16x16x64_bf16 v[64:67], v[32:35], v[176:183], v8
  v_cvt_pk_bf16_f32 v48, v48, v49
  v_cvt_pk_bf16_f32 v49, v50, v51
  ds_write_b64 v17, v[48:49] offset:2048
  ds_read_b128 v[48:51], v16 offset:9728
  s_cbranch_vccnz QK_h2r0
  s_waitcnt lgkmcnt(6)
  v_smfmac_f32_16x16x64_bf16 v[56:59], v[36:39], v[184:191], v8
  v_smfmac_f32_16x16x64_bf16 v[60:63], v[36:39], v[192:199], v8
  v_smfmac_f32_16x16x64_bf16 v[64:67], v[36:39], v[200:207], v8
  s_waitcnt lgkmcnt(1)
  s_barrier
  v_smfmac_f32_16x16x64_bf16 v[56:59], v[40:43], v[208:215], v8
  ds_read_b128 v[36:39], v16 offset:0
  v_smfmac_f32_16x16x64_bf16 v[60:63], v[40:43], v[216:223], v8
  v_smfmac_f32_16x16x64_bf16 v[64:67], v[40:43], v[224:231], v8
  v_smfmac_f32_16x16x64_bf16 v[56:59], v[44:47], v[232:239], v8
  ds_read_b128 v[40:43], v16 offset:512
  v_smfmac_f32_16x16x64_bf16 v[60:63], v[44:47], v[240:247], v8
  v_smfmac_f32_16x16x64_bf16 v[64:67], v[44:47], v[248:255], v8
  s_waitcnt lgkmcnt(2)
  v_smfmac_f32_16x16x64_bf16 v[56:59], v[48:51], v[80:87], v8
  ds_read_b128 v[44:47], v16 offset:1024
  v_smfmac_f32_16x16x64_bf16 v[60:63], v[48:51], v[88:95], v8
  v_smfmac_f32_16x16x64_bf16 v[64:67], v[48:51], v[96:103], v8
  s_branch QK_s1t3
QK_fz0:
  s_waitcnt vmcnt(4)
  v_max3_u32 v3, v32, v33, v34
  v_max_u32 v3, v3, v35
  v_mfma_f32_16x16x32_bf16 v[32:35], v[32:35], v[12:15], 0
  s_waitcnt vmcnt(3)
  v_max3_u32 v3, v36, v37, v3
  v_max3_u32 v3, v38, v39, v3
  v_mfma_f32_16x16x32_bf16 v[36:39], v[36:39], v[12:15], 0
  s_waitcnt vmcnt(2)
  v_max3_u32 v3, v40, v41, v3
  v_max3_u32 v3, v42, v43, v3
  v_mfma_f32_16x16x32_bf16 v[40:43], v[40:43], v[12:15], 0
  v_cvt_pk_bf16_f32 v32, v32, v33
  v_cvt_pk_bf16_f32 v33, v34, v35
  ds_write_b64 v17, v[32:33] offset:0
  ds_read_b128 v[32:35], v16 offset:0
  s_waitcnt vmcnt(1)
  v_max3_u32 v3, v44, v45, v3
  v_max3_u32 v3, v46, v47, v3
  v_mfma_f32_16x16x32_bf16 v[44:47], v[44:47], v[12:15], 0
  v_cvt_pk_bf16_f32 v36, v36, v37
  v_cvt_pk_bf16_f32 v37, v38, v39
  ds_write_b64 v17, v[36:37] offset:512
  ds_read_b128 v[36:39], v16 offset:512
  s_waitcnt vmcnt(0)
  v_max3_u32 v3, v48, v49, v3
  v_max3_u32 v3, v50, v51, v3
  v_mfma_f32_16x16x32_bf16 v[48:51], v[48:51], v[12:15], 0
  v_cmp_eq_u32 vcc, -1, v3
  v_cvt_pk_bf16_f32 v40, v40, v41
  v_cvt_pk_bf16_f32 v41, v42, v43
  ds_write_b64 v17, v[40:41] offset:1024
  ds_read_b128 v[40:43], v16 offset:1024
  s_waitcnt lgkmcnt(4)
  v_smfmac_f32_16x16x64_bf16 v[56:59], v[32:35], a[0:7], v8
  v_cvt_pk_bf16_f32 v44, v44, v45
  v_cvt_pk_bf16_f32 v45, v46, v47
  ds_write_b64 v17, v[44:45] offset:1536
  ds_read_b128 v[44:47], v16 offset:1536
  v_smfmac_f32_16x16x64_bf16 v[60:63], v[32:35], a[8:15], v8
  v_smfmac_f32_16x16x64_bf16 v[64:67], v[32:35], a[16:23], v8
  v_cvt_pk_bf16_f32 v48, v48, v49
  v_cvt_pk_bf16_f32 v49, v50, v51
  ds_write_b64 v17, v[48:49] offset:2048
  ds_read_b128 v[48:51], v16 offset:2048
  s_cbranch_vccnz QK_h2r0
  s_waitcnt lgkmcnt(6)
  v_smfmac_f32_16x16x64_bf16 v[56:59], v[36:39], a[24:31], v8
  v_smfmac_f32_16x16x64_bf16 v[60:63], v[36:39], a[32:39], v8
  v_smfmac_f32_16x16x64_bf16 v[64:67], v[36:39], a[40:47], v8
  s_waitcnt lgkmcnt(1)
  s_barrier
  v_smfmac_f32_16x16x64_bf16 v[56:59], v[40:43], a[48:55], v8
  ds_read_b128 v[36:39], v16 offset:2560
  v_smfmac_f32_16x16x64_bf16 v[60:63], v[40:43], a[56:63], v8
  v_smfmac_f32_16x16x64_bf16 v[64:67], v[40:43], a[64:71], v8
  v_smfmac_f32_16x16x64_bf16 v[56:59], v[44:47], a[72:79], v8
  ds_read_b128 v[40:43], v16 offset:3072
  v_smfmac_f32_16x16x64_bf16 v[60:63], v[44:47], a[80:87], v8
  v_smfmac_f32_16x16x64_bf16 v[64:67], v[44:47], a[88:95], v8
  s_waitcnt lgkmcnt(2)
  v_smfmac_f32_16x16x64_bf16 v[56:59], v[48:51], v[80:87], v8
  ds_read_b128 v[44:47], v16 offset:3584
  v_smfmac_f32_16x16x64_bf16 v[60:63], v[48:51], v[88:95], v8
  v_smfmac_f32_16x16x64_bf16 v[64:67], v[48:51], v[96:103], v8
  s_branch QK_s1t0
QK_fz1:
  s_waitcnt vmcnt(4)
  v_max3_u32 v3, v32, v33, v34
  v_max_u32 v3, v3, v35
  v_mfma_f32_16x16x32_bf16 v[32:35], v[32:35], v[12:15], 0
  s_waitcnt vmcnt(3)
  v_max3_u32 v3, v36, v37, v3
  v_max3_u32 v3, v38, v39, v3
  v_mfma_f32_16x16x32_bf16 v[36:39], v[36:39], v[12:15], 0
  s_waitcnt vmcnt(2)
  v_max3_u32 v3, v40, v41, v3
  v_max3_u32 v3, v42, v43, v3
  v_mfma_f32_16x16x32_bf16 v[40:43], v[40:43], v[12:15], 0
  v_cvt_pk_bf16_f32 v32, v32, v33
  v_cvt_pk_bf16_f32 v33, v34, v35
  ds_write_b64 v17, v[32:33] offset:0
  ds_read_b128 v[32:35], v16 offset:2560
  s_waitcnt vmcnt(1)
  v_max3_u32 v3, v44, v45, v3
  v_max3_u32 v3, v46, v47, v3
  v_mfma_f32_16x16x32_bf16 v[44:47], v[44:47], v[12:15], 0
  v_cvt_pk_bf16_f32 v36, v36, v37
  v_cvt_pk_bf16_f32 v37, v38, v39
  ds_write_b64 v17, v[36:37] offset:512
  ds_read_b128 v[36:39], v16 offset:3072
  s_waitcnt vmcnt(0)
  v_max3_u32 v3, v48, v49, v3
  v_max3_u32 v3, v50, v51, v3
  v_mfma_f32_16x16x32_bf16 v[48:51], v[48:51], v[12:15], 0
  v_cmp_eq_u32 vcc, -1, v3
  v_cvt_pk_bf16_f32 v40, v40, v41
  v_cvt_pk_bf16_f32 v41, v42, v43
  ds_write_b64 v17, v[40:41] offset:1024
  ds_read_b128 v[40:43], v16 offset:3584
  s_waitcnt lgkmcnt(4)
  v_smfmac_f32_16x16x64_bf16 v[56:59], v[32:35], a[96:103], v8
  v_cvt_pk_bf16_f32 v44, v44, v45
  v_cvt_pk_bf16_f32 v45, v46, v47
  ds_write_b64 v17, v[44:45] offset:1536
  ds_read_b128 v[44:47], v16 offset:4096
  v_smfmac_f32_16x16x64_bf16 v[60:63], v[32:35], a[104:111], v8
  v_smfmac_f32_16x16x64_bf16 v[64:67], v[32:35], a[112:119], v8
  v_cvt_pk_bf16_f32 v48, v48, v49
  v_cvt_pk_bf16_f32 v49, v50, v51
  ds_write_b64 v17, v[48:49] offset:2048
  ds_read_b128 v[48:51], v16 offset:4608
  s_cbranch_vccnz QK_h2r0
  s_waitcnt lgkmcnt(6)
  v_smfmac_f32_16x16x64_bf16 v[56:59], v[36:39], a[120:127], v8
  v_smfmac_f32_16x16x64_bf16 v[60:63], v[36:39], a[128:135], v8
  v_smfmac_f32_16x16x64_bf16 v[64:67], v[36:39], a[136:143], v8
  s_waitcnt lgkmcnt(1)
  s_barrier
  v_smfmac_f32_16x16x64_bf16 v[56:59], v[40:43], a[144:151], v8
  ds_read_b128 v[36:39], v16 offset:5120
  v_smfmac_f32_16x16x64_bf16 v[60:63], v[40:43], a[152:159], v8
  v_smfmac_f32_16x16x64_bf16 v[64:67], v[40:43], a[160:167], v8
  v_smfmac_f32_16x16x64_bf16 v[56:59], v[44:47], a[168:175], v8
  ds_read_b128 v[40:43], v16 offset:5632
  v_smfmac_f32_16x16x64_bf16 v[60:63], v[44:47], a[176:183], v8
  v_smfmac_f32_16x16x64_bf16 v[64:67], v[44:47], a[184:191], v8
  s_waitcnt lgkmcnt(2)
  v_smfmac_f32_16x16x64_bf16 v[56:59], v[48:51], v[80:87], v8
  ds_read_b128 v[44:47], v16 offset:6144
  v_smfmac_f32_16x16x64_bf16 v[60:63], v[48:51], v[88:95], v8
  v_smfmac_f32_16x16x64_bf16 v[64:67], v[48:51], v[96:103], v8
  s_branch QK_s1t1
QK_fz2:
  s_waitcnt vmcnt(4)
  v_max3_u32 v3, v32, v33, v34
  v_max_u32 v3, v3, v35
  v_mfma_f32_16x16x32_bf16 v[32:35], v[32:35], v[12:15], 0
  s_waitcnt vmcnt(3)
  v_max3_u32 v3, v36, v37, v3
  v_max3_u32 v3, v38, v39, v3
  v_mfma_f32_16x16x32_bf16 v[36:39], v[36:39], v[12:15], 0
  s_waitcnt vmcnt(2)
  v_max3_u32 v3, v40, v41, v3
  v_max3_u32 v3, v42, v43, v3
  v_mfma_f32_16x16x32_bf16 v[40:43], v[40:43], v[12:15], 0
  v_cvt_pk_bf16_f32 v32, v32, v33
  v_cvt_pk_bf16_f32 v33, v34, v35
  ds_write_b64 v17, v[32:33] offset:0
  ds_read_b128 v[32:35], v16 offset:5120
  s_waitcnt vmcnt(1)
  v_max3_u32 v3, v44, v45, v3
  v_max3_u32 v3, v46, v47, v3
  v_mfma_f32_16x16x32_bf16 v[44:47], v[44:47], v[12:15], 0
  v_cvt_pk_bf16_f32 v36, v36, v37
  v_cvt_pk_bf16_f32 v37, v38, v39
  ds_write_b64 v17, v[36:37] offset:512
  ds_read_b128 v[36:39], v16 offset:5632
  s_waitcnt vmcnt(0)
  v_max3_u32 v3, v48, v49, v3
  v_max3_u32 v3, v50, v51, v3
  v_mfma_f32_16x16x32_bf16 v[48:51], v[48:51], v[12:15], 0
  v_cmp_eq_u32 vcc, -1, v3
  v_cvt_pk_bf16_f32 v40, v40, v41
  v_cvt_pk_bf16_f32 v41, v42, v43
  ds_write_b64 v17, v[40:41] offset:1024
  ds_read_b128 v[40:43], v16 offset:6144
  s_waitcnt lgkmcnt(4)
  v_smfmac_f32_16x16x64_bf16 v[56:59], v[32:35], a[192:199], v8
  v_cvt_pk_bf16_f32 v44, v44, v45
  v_cvt_pk_bf16_f32 v45, v46, v47
  ds_write_b64 v17, v[44:45] offset:1536
  ds_read_b128 v[44:47], v16 offset:6656
  v_smfmac_f32_16x16x64_bf16 v[60:63], v[32:35], a[200:207], v8
  v_smfmac_f32_16x16x64_bf16 v[64:67], v[32:35], a[208:215], v8
  v_cvt_pk_bf16_f32 v48, v48, v49
  v_cvt_pk_bf16_f32 v49, v50, v51
  ds_write_b64 v17, v[48:49] offset:2048
  ds_read_b128 v[48:51], v16 offset:7168
  s_cbranch_vccnz QK_h2r0
  s_waitcnt lgkmcnt(6)
  v_smfmac_f32_16x16x64_bf16 v[56:59], v[36:39], a[216:223], v8
  v_smfmac_f32_16x16x64_bf16 v[60:63], v[36:39], a[224:231], v8
  v_smfmac_f32_16x16x64_bf16 v[64:67], v[36:39], a[232:239], v8
  s_waitcnt lgkmcnt(1)
  s_barrier
  v_smfmac_f32_16x16x64_bf16 v[56:59], v[40:43], a[240:247], v8
  ds_read_b128 v[36:39], v16 offset:7680
  v_smfmac_f32_16x16x64_bf16 v[60:63], v[40:43], a[248:255], v8
  v_smfmac_f32_16x16x64_bf16 v[64:67], v[40:43], v[128:135], v8
  v_smfmac_f32_16x16x64_bf16 v[56:59], v[44:47], v[136:143], v8
  ds_read_b128 v[40:43], v16 offset:8192
  v_smfmac_f32_16x16x64_bf16 v[60:63], v[44:47], v[144:151], v8
  v_smfmac_f32_16x16x64_bf16 v[64:67], v[44:47], v[152:159], v8
  s_waitcnt lgkmcnt(2)
  v_smfmac_f32_16x16x64_bf16 v[56:59], v[48:51], v[80:87], v8
  ds_read_b128 v[44:47], v16 offset:8704
  v_smfmac_f32_16x16x64_bf16 v[60:63], v[48:51], v[88:95], v8
  v_smfmac_f32_16x16x64_bf16 v[64:67], v[48:51], v[96:103], v8
  s_branch QK_s1t2
QK_h2r0:
  s_waitcnt lgkmcnt(0)
  s_nop 7
  v_mov_b32 v56, 0
  v_mov_b32 v57, 0
  v_mov_b32 v58, 0
  v_mov_b32 v59, 0
  v_mov_b32 v60, 0
  v_mov_b32 v61, 0
  v_mov_b32 v62, 0
  v_mov_b32 v63, 0
  v_mov_b32 v64, 0
  v_mov_b32 v65, 0
  v_mov_b32 v66, 0
  v_mov_b32 v67, 0
QK_h2r:
  buffer_load_dwordx4 v[32:35], v18, s[8:11], s48 offen sc1
  buffer_load_dwordx4 v[36:39], v18, s[8:11], s49 offen sc1
  buffer_load_dwordx4 v[40:43], v18, s[8:11], s50 offen sc1
  buffer_load_dwordx4 v[44:47], v18, s[8:11], s51 offen sc1
  buffer_load_dwordx4 v[48:51], v18, s[8:11], s52 offen sc1
  s_sub_u32 s82, s82, 1
  s_cbranch_scc1 L_abort
  s_waitcnt vmcnt(4)
  v_max3_u32 v3, v32, v33, v34
  v_max_u32 v3, v3, v35
  v_mfma_f32_16x16x32_bf16 v[32:35], v[32:35], v[12:15], 0
  s_waitcnt vmcnt(3)
  v_max3_u32 v3, v36, v37, v3
  v_max3_u32 v3, v38, v39, v3
  v_mfma_f32_16x16x32_bf16 v[36:39], v[36:39], v[12:15], 0
  s_waitcnt vmcnt(2)
  v_max3_u32 v3, v40, v41, v3
  v_max3_u32 v3, v42, v43, v3
  v_mfma_f32_16x16x32_bf16 v[40:43], v[40:43], v[12:15], 0
  s_waitcnt vmcnt(1)
  v_max3_u32 v3, v44, v45, v3
  v_max3_u32 v3, v46, v47, v3
  v_mfma_f32_16x16x32_bf16 v[44:47], v[44:47], v[12:15], 0
  v_cvt_pk_bf16_f32 v32, v32, v33
  v_cvt_pk_bf16_f32 v33, v34, v35
  ds_write_b64 v17, v[32:33] offset:0
  s_waitcnt vmcnt(0)
  v_max3_u32 v3, v48, v49, v3
  v_max3_u32 v3, v50, v51, v3
  v_mfma_f32_16x16x32_bf16 v[48:51], v[48:51], v[12:15], 0
  v_cvt_pk_bf16_f32 v36, v36, v37
  v_cvt_pk_bf16_f32 v37, v38, v39
  ds_write_b64 v17, v[36:37] offset:512
  v_cmp_eq_u32 vcc, -1, v3
  v_cvt_pk_bf16_f32 v40, v40, v41
  v_cvt_pk_bf16_f32 v41, v42, v43
  ds_write_b64 v17, v[40:41] offset:1024
  v_cvt_pk_bf16_f32 v44, v44, v45
  v_cvt_pk_bf16_f32 v45, v46, v47
  ds_write_b64 v17, v[44:45] offset:1536
  s_nop 0
  v_cvt_pk_bf16_f32 v48, v48, v49
  v_cvt_pk_bf16_f32 v49, v50, v51
  ds_write_b64 v17, v[48:49] offset:2048
  s_cbranch_vccnz QK_h2r
  s_branch QK_loop
QK_last:
  s_mov_b32 exec_lo, 0xff00ff00
  s_mov_b32 exec_hi, 0xff00ff00
  buffer_store_dwordx4 v[80:83], v29, s[8:11], s54 offen sc1
  buffer_store_dwordx2 v[84:85], v30, s[8:11], s54 offen sc1
  s_mov_b64 exec, -1
  s_add_u32 s54, s54, 98304
  s_waitcnt vmcnt(0)
  s_barrier
  v_mov_b32 v2, 64
  v_mov_b32 v3, 0
  s_mov_b64 exec, 1
  buffer_store_dword v2, v3, s[8:11], s34 offen sc1
  v_mov_b32 v4, 63
  s_add_u32 s30, s34, 4096
  buffer_store_dword v4, off, s[8:11], s30 sc1
  s_waitcnt vmcnt(0)
  s_mov_b64 exec, -1
  s_branch QK_end
QKS_loop:
  s_cmp_eq_u32 s24, 0
  s_cbranch_scc1 QKS_s1w0
  s_cmp_eq_u32 s24, 1
  s_cbranch_scc1 QKS_s1w1
  s_cmp_eq_u32 s24, 2
  s_cbranch_scc1 QKS_s1w2
QKS_s1w3:
  ds_read_b128 v[32:35], v16 offset:7680
  ds_read_b128 v[36:39], v16 offset:8192
  ds_read_b128 v[40:43], v16 offset:8704
  s_waitcnt lgkmcnt(2)
  v_smfmac_f32_16x16x64_bf16 v[56:59], v[32:35], v[160:167], v8
  ds_read_b128 v[44:47], v16 offset:9216
  v_smfmac_f32_16x16x64_bf16 v[60:63], v[32:35], v[168:175], v8
  v_smfmac_f32_16x16x64_bf16 v[64:67], v[32:35], v[176:183], v8
  s_waitcnt lgkmcnt(2)
  v_smfmac_f32_16x16x64_bf16 v[56:59], v[36:39], v[184:191], v8
  ds_read_b128 v[32:35], v16 offset:9728
  v_smfmac_f32_16x16x64_bf16 v[60:63], v[36:39], v[192:199], v8
  v_smfmac_f32_16x16x64_bf16 v[64:67], v[36:39], v[200:207], v8
  s_waitcnt lgkmcnt(2)
  v_smfmac_f32_16x16x64_bf16 v[56:59], v[40:43], v[208:215], v8
  v_smfmac_f32_16x16x64_bf16 v[60:63], v[40:43], v[216:223], v8
  v_smfmac_f32_16x16x64_bf16 v[64:67], v[40:43], v[224:231], v8
  s_waitcnt lgkmcnt(1)
  s_barrier
  v_smfmac_f32_16x16x64_bf16 v[56:59], v[44:47], v[232:239], v8
  ds_read_b128 v[36:39], v16 offset:0
  v_smfmac_f32_16x16x64_bf16 v[60:63], v[44:47], v[240:247], v8
  ds_read_b128 v[40:43], v16 offset:512
  v_smfmac_f32_16x16x64_bf16 v[64:67], v[44:47], v[248:255], v8
  s_waitcnt lgkmcnt(2)
  v_smfmac_f32_16x16x64_bf16 v[56:59], v[32:35], v[80:87], v8
  ds_read_b128 v[44:47], v16 offset:1024
  v_smfmac_f32_16x16x64_bf16 v[60:63], v[32:35], v[88:95], v8
  v_smfmac_f32_16x16x64_bf16 v[64:67], v[32:35], v[96:103], v8
QKS_s1t3:
  s_waitcnt lgkmcnt(2)
  v_smfmac_f32_16x16x64_bf16 v[56:59], v[36:39], a[0:7], v8
  ds_read_b128 v[32:35], v16 offset:1536
  v_smfmac_f32_16x16x64_bf16 v[60:63], v[36:39], a[8:15], v8
  ds_read_b128 v[80:83], v54 offset:0
  v_smfmac_f32_16x16x64_bf16 v[64:67], v[36:39], a[16:23], v8
  ds_read_b128 v[84:87], v54 offset:1024
  s_waitcnt lgkmcnt(4)
  v_smfmac_f32_16x16x64_bf16 v[56:59], v[40:43], a[24:31], v8
  ds_read_b128 v[36:39], v16 offset:2048
  buffer_load_dwordx4 v[2:5], v31, s[8:11], s85 offen sc1
  v_smfmac_f32_16x16x64_bf16 v[60:63], v[40:43], a[32:39], v8
  ds_read_b128 v[88:91], v54 offset:2048
  v_smfmac_f32_16x16x64_bf16 v[64:67], v[40:43], a[40:47], v8
  ds_read_b128 v[92:95], v54 offset:3072
  s_waitcnt lgkmcnt(6)
  v_smfmac_f32_16x16x64_bf16 v[56:59], v[44:47], a[48:55], v8
  ds_read_b128 v[40:43], v16 offset:2560
  v_smfmac_f32_16x16x64_bf16 v[60:63], v[44:47], a[56:63], v8
  ds_read_b128 v[96:99], v54 offset:4096
  buffer_load_dwordx4 v[48:51], v31, s[8:11], s85 offen offset:1024 sc1
  v_smfmac_f32_16x16x64_bf16 v[64:67], v[44:47], a[64:71], v8
  ds_read_b128 v[100:103], v54 offset:5120
  s_waitcnt lgkmcnt(8)
  v_smfmac_f32_16x16x64_bf16 v[56:59], v[32:35], a[72:79], v8
  ds_read_b128 v[44:47], v16 offset:3072
  v_smfmac_f32_16x16x64_bf16 v[60:63], v[32:35], a[80:87], v8
  v_smfmac_f32_16x16x64_bf16 v[64:67], v[32:35], a[88:95], v8
  buffer_load_dwordx2 v[52:53], v27, s[8:11], s85 offen offset:2048 sc1
  s_waitcnt lgkmcnt(6)
  v_smfmac_f32_16x16x64_bf16 v[56:59], v[36:39], v[104:111], v8
  ds_read_b128 v[32:35], v16 offset:3584
  v_smfmac_f32_16x16x64_bf16 v[60:63], v[36:39], v[112:119], v8
  v_smfmac_f32_16x16x64_bf16 v[64:67], v[36:39], v[120:127], v8
  s_waitcnt lgkmcnt(4)
  v_smfmac_f32_16x16x64_bf16 v[56:59], v[40:43], a[96:103], v8
  ds_read_b128 v[36:39], v16 offset:4096
  v_smfmac_f32_16x16x64_bf16 v[60:63], v[40:43], a[104:111], v8
  ds_read_b128 v[104:107], v55 offset:0
  v_smfmac_f32_16x16x64_bf16 v[64:67], v[40:43], a[112:119], v8
  ds_read_b128 v[108:111], v55 offset:1024
  s_waitcnt lgkmcnt(4)
  v_smfmac_f32_16x16x64_bf16 v[56:59], v[44:47], a[120:127], v8
  ds_read_b128 v[40:43], v16 offset:4608
  v_smfmac_f32_16x16x64_bf16 v[60:63], v[44:47], a[128:135], v8
  ds_read_b128 v[112:115], v55 offset:2048
  v_smfmac_f32_16x16x64_bf16 v[64:67], v[44:47], a[136:143], v8
  ds_read_b128 v[116:119], v55 offset:3072
  s_waitcnt lgkmcnt(6)
  v_smfmac_f32_16x16x64_bf16 v[56:59], v[32:35], a[144:151], v8
  ds_read_b128 v[44:47], v16 offset:5120
  v_smfmac_f32_16x16x64_bf16 v[60:63], v[32:35], a[152:159], v8
  ds_read_b128 v[120:123], v55 offset:4096
  v_smfmac_f32_16x16x64_bf16 v[64:67], v[32:35], a[160:167], v8
  ds_read_b128 v[124:127], v55 offset:5120
  s_waitcnt lgkmcnt(8)
  v_smfmac_f32_16x16x64_bf16 v[56:59], v[36:39], a[168:175], v8
  ds_read_b128 v[32:35], v16 offset:5632
  v_smfmac_f32_16x16x64_bf16 v[60:63], v[36:39], a[176:183], v8
  v_smfmac_f32_16x16x64_bf16 v[64:67], v[36:39], a[184:191], v8
  s_waitcnt lgkmcnt(6)
  v_smfmac_f32_16x16x64_bf16 v[56:59], v[40:43], v[80:87], v8
  ds_read_b128 v[36:39], v16 offset:6144
  v_smfmac_f32_16x16x64_bf16 v[60:63], v[40:43], v[88:95], v8
  v_smfmac_f32_16x16x64_bf16 v[64:67], v[40:43], v[96:103], v8
  s_waitcnt lgkmcnt(4)
  v_smfmac_f32_16x16x64_bf16 v[56:59], v[44:47], a[192:199], v8
  ds_read_b128 v[40:43], v16 offset:6656
  s_waitcnt vmcnt(2)
  buffer_store_dwordx4 v[2:5], v31, s[8:11], s86 offen sc1
  v_smfmac_f32_16x16x64_bf16 v[60:63], v[44:47], a[200:207], v8
  v_smfmac_f32_16x16x64_bf16 v[64:67], v[44:47], a[208:215], v8
  s_waitcnt lgkmcnt(2)
  v_smfmac_f32_16x16x64_bf16 v[56:59], v[32:35], a[216:223], v8
  ds_read_b128 v[44:47], v16 offset:7168
  v_smfmac_f32_16x16x64_bf16 v[60:63], v[32:35], a[224:231], v8
  s_waitcnt vmcnt(2)
  buffer_store_dwordx4 v[48:51], v31, s[8:11], s86 offen offset:1024 sc1
  v_smfmac_f32_16x16x64_bf16 v[64:67], v[32:35], a[232:239], v8
  s_waitcnt lgkmcnt(2)
  v_smfmac_f32_16x16x64_bf16 v[56:59], v[36:39], a[240:247], v8
  s_waitcnt lgkmcnt(1)
  v_smfmac_f32_16x16x64_bf16 v[56:59], v[40:43], v[136:143], v8
  s_waitcnt lgkmcnt(0)
  v_smfmac_f32_16x16x64_bf16 v[56:59], v[44:47], v[104:111], v8
  s_waitcnt vmcnt(2)
  buffer_store_dwordx2 v[52:53], v27, s[8:11], s86 offen offset:2048 sc1
  v_smfmac_f32_16x16x64_bf16 v[60:63], v[36:39], a[248:255], v8
  v_smfmac_f32_16x16x64_bf16 v[60:63], v[40:43], v[144:151], v8
  v_cvt_pk_bf16_f32 v48, v56, v57
  v_cvt_pk_bf16_f32 v49, v58, v59
  v_smfmac_f32_16x16x64_bf16 v[60:63], v[44:47], v[112:119], v8
  v_mfma_f32_16x16x16_bf16 v[104:107], v[48:49], v[10:11], 0
  v_smfmac_f32_16x16x64_bf16 v[64:67], v[36:39], v[128:135], v8
  v_smfmac_f32_16x16x64_bf16 v[64:67], v[40:43], v[152:159], v8
  v_cvt_pk_bf16_f32 v50, v60, v61
  v_cvt_pk_bf16_f32 v51, v62, v63
  v_smfmac_f32_16x16x64_bf16 v[64:67], v[44:47], v[120:127], v8
  s_branch QKS_post
QKS_s1w0:
  ds_read_b128 v[32:35], v16 offset:0
  ds_read_b128 v[36:39], v16 offset:512
  ds_read_b128 v[40:43], v16 offset:1024
  s_waitcnt lgkmcnt(2)
  v_smfmac_f32_16x16x64_bf16 v[56:59], v[32:35], a[0:7], v8
  ds_read_b128 v[44:47], v16 offset:1536
  v_smfmac_f32_16x16x64_bf16 v[60:63], v[32:35], a[8:15], v8
  v_smfmac_f32_16x16x64_bf16 v[64:67], v[32:35], a[16:23], v8
  s_waitcnt lgkmcnt(2)
  v_smfmac_f32_16x16x64_bf16 v[56:59], v[36:39], a[24:31], v8
  ds_read_b128 v[32:35], v16 offset:2048
  v_smfmac_f32_16x16x64_bf16 v[60:63], v[36:39], a[32:39], v8
  v_smfmac_f32_16x16x64_bf16 v[64:67], v[36:39], a[40:47], v8
  s_waitcnt lgkmcnt(2)
  v_smfmac_f32_16x16x64_bf16 v[56:59], v[40:43], a[48:55], v8
  v_smfmac_f32_16x16x64_bf16 v[60:63], v[40:43], a[56:63], v8
  v_smfmac_f32_16x16x64_bf16 v[64:67], v[40:43], a[64:71], v8
  s_waitcnt lgkmcnt(1)
  s_barrier
  v_smfmac_f32_16x16x64_bf16 v[56:59], v[44:47], a[72:79], v8
  ds_read_b128 v[36:39], v16 offset:2560
  v_smfmac_f32_16x16x64_bf16 v[60:63], v[44:47], a[80:87], v8
  ds_read_b128 v[40:43], v16 offset:3072
  v_smfmac_f32_16x16x64_bf16 v[64:67], v[44:47], a[88:95], v8
  s_waitcnt lgkmcnt(2)
  v_smfmac_f32_16x16x64_bf16 v[56:59], v[32:35], v[80:87], v8
  ds_read_b128 v[44:47], v16 offset:3584
  v_smfmac_f32_16x16x64_bf16 v[60:63], v[32:35], v[88:95], v8
  v_smfmac_f32_16x16x64_bf16 v[64:67], v[32:35], v[96:103], v8
QKS_s1t0:
  s_waitcnt lgkmcnt(2)
  v_smfmac_f32_16x16x64_bf16 v[56:59], v[36:39], a[96:103], v8
  ds_read_b128 v[32:35], v16 offset:4096
  buffer_load_dwordx4 v[2:5], v31, s[8:11], s85 offen sc1
  v_smfmac_f32_16x16x64_bf16 v[60:63], v[36:39], a[104:111], v8
  ds_read_b128 v[80:83], v54 offset:0
  v_smfmac_f32_16x16x64_bf16 v[64:67], v[36:39], a[112:119], v8
  ds_read_b128 v[84:87], v54 offset:1024
  s_waitcnt lgkmcnt(4)
  v_smfmac_f32_16x16x64_bf16 v[56:59], v[40:43], a[120:127], v8
  ds_read_b128 v[36:39], v16 offset:4608
  v_smfmac_f32_16x16x64_bf16 v[60:63], v[40:43], a[128:135], v8
  ds_read_b128 v[88:91], v54 offset:2048
  buffer_load_dwordx4 v[48:51], v31, s[8:11], s85 offen offset:1024 sc1
  v_smfmac_f32_16x16x64_bf16 v[64:67], v[40:43], a[136:143], v8
  ds_read_b128 v[92:95], v54 offset:3072
  s_waitcnt lgkmcnt(6)
  v_smfmac_f32_16x16x64_bf16 v[56:59], v[44:47], a[144:151], v8
  ds_read_b128 v[40:43], v16 offset:5120
  v_smfmac_f32_16x16x64_bf16 v[60:63], v[44:47], a[152:159], v8
  ds_read_b128 v[96:99], v54 offset:4096
  v_smfmac_f32_16x16x64_bf16 v[64:67], v[44:47], a[160:167], v8
  ds_read_b128 v[100:103], v54 offset:5120
  buffer_load_dwordx2 v[52:53], v27, s[8:11], s85 offen offset:2048 sc1
  s_waitcnt lgkmcnt(8)
  v_smfmac_f32_16x16x64_bf16 v[56:59], v[32:35], a[168:175], v8
  ds_read_b128 v[44:47], v16 offset:5632
  v_smfmac_f32_16x16x64_bf16 v[60:63], v[32:35], a[176:183], v8
  v_smfmac_f32_16x16x64_bf16 v[64:67], v[32:35], a[184:191], v8
  s_waitcnt lgkmcnt(6)
  v_smfmac_f32_16x16x64_bf16 v[56:59], v[36:39], v[104:111], v8
  ds_read_b128 v[32:35], v16 offset:6144
  v_smfmac_f32_16x16x64_bf16 v[60:63], v[36:39], v[112:119], v8
  v_smfmac_f32_16x16x64_bf16 v[64:67], v[36:39], v[120:127], v8
  s_waitcnt lgkmcnt(4)
  v_smfmac_f32_16x16x64_bf16 v[56:59], v[40:43], a[192:199], v8
  ds_read_b128 v[36:39], v16 offset:6656
  v_smfmac_f32_16x16x64_bf16 v[60:63], v[40:43], a[200:207], v8
  ds_read_b128 v[104:107], v55 offset:0
  v_smfmac_f32_16x16x64_bf16 v[64:67], v[40:43], a[208:215], v8
  ds_read_b128 v[108:111], v55 offset:1024
  s_waitcnt lgkmcnt(4)
  v_smfmac_f32_16x16x64_bf16 v[56:59], v[44:47], a[216:223], v8
  ds_read_b128 v[40:43], v16 offset:7168
  v_smfmac_f32_16x16x64_bf16 v[60:63], v[44:47], a[224:231], v8
  ds_read_b128 v[112:115], v55 offset:2048
  v_smfmac_f32_16x16x64_bf16 v[64:67], v[44:47], a[232:239], v8
  ds_read_b128 v[116:119], v55 offset:3072
  s_waitcnt lgkmcnt(6)
  v_smfmac_f32_16x16x64_bf16 v[56:59], v[32:35], a[240:247], v8
  ds_read_b128 v[44:47], v16 offset:7680
  v_smfmac_f32_16x16x64_bf16 v[60:63], v[32:35], a[248:255], v8
  ds_read_b128 v[120:123], v55 offset:4096
  v_smfmac_f32_16x16x64_bf16 v[64:67], v[32:35], v[128:135], v8
  ds_read_b128 v[124:127], v55 offset:5120
  s_waitcnt lgkmcnt(8)
  v_smfmac_f32_16x16x64_bf16 v[56:59], v[36:39], v[136:143], v8
  ds_read_b128 v[32:35], v16 offset:8192
  v_smfmac_f32_16x16x64_bf16 v[60:63], v[36:39], v[144:151], v8
  v_smfmac_f32_16x16x64_bf16 v[64:67], v[36:39], v[152:159], v8
  s_waitcnt lgkmcnt(6)
  v_smfmac_f32_16x16x64_bf16 v[56:59], v[40:43], v[80:87], v8
  ds_read_b128 v[36:39], v16 offset:8704
  s_waitcnt vmcnt(2)
  buffer_store_dwordx4 v[2:5], v31, s[8:11], s86 offen sc1
  v_smfmac_f32_16x16x64_bf16 v[60:63], v[40:43], v[88:95], v8
  v_smfmac_f32_16x16x64_bf16 v[64:67], v[40:43], v[96:103], v8
  s_waitcnt lgkmcnt(4)
  v_smfmac_f32_16x16x64_bf16 v[56:59], v[44:47], v[160:167], v8
  ds_read_b128 v[40:43], v16 offset:9216
  v_smfmac_f32_16x16x64_bf16 v[60:63], v[44:47], v[168:175], v8
  s_waitcnt vmcnt(2)
  buffer_store_dwordx4 v[48:51], v31, s[8:11], s86 offen offset:1024 sc1
  v_smfmac_f32_16x16x64_bf16 v[64:67], v[44:47], v[176:183], v8
  s_waitcnt lgkmcnt(2)
  v_smfmac_f32_16x16x64_bf16 v[56:59], v[32:35], v[184:191], v8
  ds_read_b128 v[44:47], v16 offset:9728
  v_smfmac_f32_16x16x64_bf16 v[60:63], v[32:35], v[192:199], v8
  v_smfmac_f32_16x16x64_bf16 v[64:67], v[32:35], v[200:207], v8
  s_waitcnt vmcnt(2)
  buffer_store_dwordx2 v[52:53], v27, s[8:11], s86 offen offset:2048 sc1
  s_waitcnt lgkmcnt(2)
  v_smfmac_f32_16x16x64_bf16 v[56:59], v[36:39], v[208:215], v8
  s_waitcnt lgkmcnt(1)
  v_smfmac_f32_16x16x64_bf16 v[56:59], v[40:43], v[232:239], v8
  s_waitcnt lgkmcnt(0)
  v_smfmac_f32_16x16x64_bf16 v[56:59], v[44:47], v[104:111], v8
  v_smfmac_f32_16x16x64_bf16 v[60:63], v[36:39], v[216:223], v8
  v_smfmac_f32_16x16x64_bf16 v[60:63], v[40:43], v[240:247], v8
  v_cvt_pk_bf16_f32 v48, v56, v57
  v_cvt_pk_bf16_f32 v49, v58, v59
  v_smfmac_f32_16x16x64_bf16 v[60:63], v[44:47], v[112:119], v8
  v_mfma_f32_16x16x16_bf16 v[104:107], v[48:49], v[10:11], 0
  v_smfmac_f32_16x16x64_bf16 v[64:67], v[36:39], v[224:231], v8
  v_smfmac_f32_16x16x64_bf16 v[64:67], v[40:43], v[248:255], v8
  v_cvt_pk_bf16_f32 v50, v60, v61
  v_cvt_pk_bf16_f32 v51, v62, v63
  v_smfmac_f32_16x16x64_bf16 v[64:67], v[44:47], v[120:127], v8
  s_branch QKS_post
QKS_s1w1:
  ds_read_b128 v[32:35], v16 offset:2560
  ds_read_b128 v[36:39], v16 offset:3072
  ds_read_b128 v[40:43], v16 offset:3584
  s_waitcnt lgkmcnt(2)
  v_smfmac_f32_16x16x64_bf16 v[56:59], v[32:35], a[96:103], v8
  ds_read_b128 v[44:47], v16 offset:4096
  v_smfmac_f32_16x16x64_bf16 v[60:63], v[32:35], a[104:111], v8
  v_smfmac_f32_16x16x64_bf16 v[64:67], v[32:35], a[112:119], v8
  s_waitcnt lgkmcnt(2)
  v_smfmac_f32_16x16x64_bf16 v[56:59], v[36:39], a[120:127], v8
  ds_read_b128 v[32:35], v16 offset:4608
  v_smfmac_f32_16x16x64_bf16 v[60:63], v[36:39], a[128:135], v8
  v_smfmac_f32_16x16x64_bf16 v[64:67], v[36:39], a[136:143], v8
  s_waitcnt lgkmcnt(2)
  v_smfmac_f32_16x16x64_bf16 v[56:59], v[40:43], a[144:151], v8
  v_smfmac_f32_16x16x64_bf16 v[60:63], v[40:43], a[152:159], v8
  v_smfmac_f32_16x16x64_bf16 v[64:67], v[40:43], a[160:167], v8
  s_waitcnt lgkmcnt(1)
  s_barrier
  v_smfmac_f32_16x16x64_bf16 v[56:59], v[44:47], a[168:175], v8
  ds_read_b128 v[36:39], v16 offset:5120
  v_smfmac_f32_16x16x64_bf16 v[60:63], v[44:47], a[176:183], v8
  ds_read_b128 v[40:43], v16 offset:5632
  v_smfmac_f32_16x16x64_bf16 v[64:67], v[44:47], a[184:191], v8
  s_waitcnt lgkmcnt(2)
  v_smfmac_f32_16x16x64_bf16 v[56:59], v[32:35], v[80:87], v8
  ds_read_b128 v[44:47], v16 offset:6144
  v_smfmac_f32_16x16x64_bf16 v[60:63], v[32:35], v[88:95], v8
  v_smfmac_f32_16x16x64_bf16 v[64:67], v[32:35], v[96:103], v8
QKS_s1t1:
  s_waitcnt lgkmcnt(2)
  v_smfmac_f32_16x16x64_bf16 v[56:59], v[36:39], a[192:199], v8
  ds_read_b128 v[32:35], v16 offset:6656
  v_smfmac_f32_16x16x64_bf16 v[60:63], v[36:39], a[200:207], v8
  ds_read_b128 v[80:83], v54 offset:0
  buffer_load_dwordx4 v[2:5], v31, s[8:11], s85 offen sc1
  v_smfmac_f32_16x16x64_bf16 v[64:67], v[36:39], a[208:215], v8
  ds_read_b128 v[84:87], v54 offset:1024
  s_waitcnt lgkmcnt(4)
  v_smfmac_f32_16x16x64_bf16 v[56:59], v[40:43], a[216:223], v8
  ds_read_b128 v[36:39], v16 offset:7168
  v_smfmac_f32_16x16x64_bf16 v[60:63], v[40:43], a[224:231], v8
  ds_read_b128 v[88:91], v54 offset:2048
  v_smfmac_f32_16x16x64_bf16 v[64:67], v[40:43], a[232:239], v8
  ds_read_b128 v[92:95], v54 offset:3072
  buffer_load_dwordx4 v[48:51], v31, s[8:11], s85 offen offset:1024 sc1
  s_waitcnt lgkmcnt(6)
  v_smfmac_f32_16x16x64_bf16 v[56:59], v[44:47], a[240:247], v8
  ds_read_b128 v[40:43], v16 offset:7680
  v_smfmac_f32_16x16x64_bf16 v[60:63], v[44:47], a[248:255], v8
  ds_read_b128 v[96:99], v54 offset:4096
  v_smfmac_f32_16x16x64_bf16 v[64:67], v[44:47], v[128:135], v8
  ds_read_b128 v[100:103], v54 offset:5120
  s_waitcnt lgkmcnt(8)
  v_smfmac_f32_16x16x64_bf16 v[56:59], v[32:35], v[136:143], v8
  ds_read_b128 v[44:47], v16 offset:8192
  buffer_load_dwordx2 v[52:53], v27, s[8:11], s85 offen offset:2048 sc1
  v_smfmac_f32_16x16x64_bf16 v[60:63], v[32:35], v[144:151], v8
  v_smfmac_f32_16x16x64_bf16 v[64:67], v[32:35], v[152:159], v8
  s_waitcnt lgkmcnt(6)
  v_smfmac_f32_16x16x64_bf16 v[56:59], v[36:39], v[104:111], v8
  ds_read_b128 v[32:35], v16 offset:8704
  v_smfmac_f32_16x16x64_bf16 v[60:63], v[36:39], v[112:119], v8
  v_smfmac_f32_16x16x64_bf16 v[64:67], v[36:39], v[120:127], v8
  s_waitcnt lgkmcnt(4)
  v_smfmac_f32_16x16x64_bf16 v[56:59], v[40:43], v[160:167], v8
  ds_read_b128 v[36:39], v16 offset:9216
  v_smfmac_f32_16x16x64_bf16 v[60:63], v[40:43], v[168:175], v8
  ds_read_b128 v[104:107], v55 offset:0
  v_smfmac_f32_16x16x64_bf16 v[64:67], v[40:43], v[176:183], v8
  ds_read_b128 v[108:111], v55 offset:1024
  s_waitcnt lgkmcnt(4)
  v_smfmac_f32_16x16x64_bf16 v[56:59], v[44:47], v[184:191], v8
  ds_read_b128 v[40:43], v16 offset:9728
  v_smfmac_f32_16x16x64_bf16 v[60:63], v[44:47], v[192:199], v8
  ds_read_b128 v[112:115], v55 offset:2048
  v_smfmac_f32_16x16x64_bf16 v[64:67], v[44:47], v[200:207], v8
  ds_read_b128 v[116:119], v55 offset:3072
  s_waitcnt lgkmcnt(6)
  v_smfmac_f32_16x16x64_bf16 v[56:59], v[32:35], v[208:215], v8
  ds_read_b128 v[44:47], v16 offset:0
  v_smfmac_f32_16x16x64_bf16 v[60:63], v[32:35], v[216:223], v8
  ds_read_b128 v[120:123], v55 offset:4096
  v_smfmac_f32_16x16x64_bf16 v[64:67], v[32:35], v[224:231], v8
  ds_read_b128 v[124:127], v55 offset:5120
  s_waitcnt lgkmcnt(8)
  v_smfmac_f32_16x16x64_bf16 v[56:59], v[36:39], v[232:239], v8
  ds_read_b128 v[32:35], v16 offset:512
  v_smfmac_f32_16x16x64_bf16 v[60:63], v[36:39], v[240:247], v8
  v_smfmac_f32_16x16x64_bf16 v[64:67], v[36:39], v[248:255], v8
  s_waitcnt lgkmcnt(6)
  v_smfmac_f32_16x16x64_bf16 v[56:59], v[40:43], v[80:87], v8
  ds_read_b128 v[36:39], v16 offset:1024
  v_smfmac_f32_16x16x64_bf16 v[60:63], v[40:43], v[88:95], v8
  s_waitcnt vmcnt(2)
  buffer_store_dwordx4 v[2:5], v31, s[8:11], s86 offen sc1
  v_smfmac_f32_16x16x64_bf16 v[64:67], v[40:43], v[96:103], v8
  s_waitcnt lgkmcnt(4)
  v_smfmac_f32_16x16x64_bf16 v[56:59], v[44:47], a[0:7], v8
  ds_read_b128 v[40:43], v16 offset:1536
  v_smfmac_f32_16x16x64_bf16 v[60:63], v[44:47], a[8:15], v8
  v_smfmac_f32_16x16x64_bf16 v[64:67], v[44:47], a[16:23], v8
  s_waitcnt vmcnt(2)
  buffer_store_dwordx4 v[48:51], v31, s[8:11], s86 offen offset:1024 sc1
  s_waitcnt lgkmcnt(2)
  v_smfmac_f32_16x16x64_bf16 v[56:59], v[32:35], a[24:31], v8
  ds_read_b128 v[44:47], v16 offset:2048
  v_smfmac_f32_16x16x64_bf16 v[60:63], v[32:35], a[32:39], v8
  v_smfmac_f32_16x16x64_bf16 v[64:67], v[32:35], a[40:47], v8
  s_waitcnt lgkmcnt(2)
  v_smfmac_f32_16x16x64_bf16 v[56:59], v[36:39], a[48:55], v8
  s_waitcnt vmcnt(2)
  buffer_store_dwordx2 v[52:53], v27, s[8:11], s86 offen offset:2048 sc1
  s_waitcnt lgkmcnt(1)
  v_smfmac_f32_16x16x64_bf16 v[56:59], v[40:43], a[72:79], v8
  s_waitcnt lgkmcnt(0)
  v_smfmac_f32_16x16x64_bf16 v[56:59], v[44:47], v[104:111], v8
  v_smfmac_f32_16x16x64_bf16 v[60:63], v[36:39], a[56:63], v8
  v_smfmac_f32_16x16x64_bf16 v[60:63], v[40:43], a[80:87], v8
  v_cvt_pk_bf16_f32 v48, v56, v57
  v_cvt_pk_bf16_f32 v49, v58, v59
  v_smfmac_f32_16x16x64_bf16 v[60:63], v[44:47], v[112:119], v8
  v_mfma_f32_16x16x16_bf16 v[104:107], v[48:49], v[10:11], 0
  v_smfmac_f32_16x16x64_bf16 v[64:67], v[36:39], a[64:71], v8
  v_smfmac_f32_16x16x64_bf16 v[64:67], v[40:43], a[88:95], v8
  v_cvt_pk_bf16_f32 v50, v60, v61
  v_cvt_pk_bf16_f32 v51, v62, v63
  v_smfmac_f32_16x16x64_bf16 v[64:67], v[44:47], v[120:127], v8
  s_branch QKS_post
QKS_s1w2:
  ds_read_b128 v[32:35], v16 offset:5120
  ds_read_b128 v[36:39], v16 offset:5632
  ds_read_b128 v[40:43], v16 offset:6144
  s_waitcnt lgkmcnt(2)
  v_smfmac_f32_16x16x64_bf16 v[56:59], v[32:35], a[192:199], v8
  ds_read_b128 v[44:47], v16 offset:6656
  v_smfmac_f32_16x16x64_bf16 v[60:63], v[32:35], a[200:207], v8
  v_smfmac_f32_16x16x64_bf16 v[64:67], v[32:35], a[208:215], v8
  s_waitcnt lgkmcnt(2)
  v_smfmac_f32_16x16x64_bf16 v[56:59], v[36:39], a[216:223], v8
  ds_read_b128 v[32:35], v16 offset:7168
  v_smfmac_f32_16x16x64_bf16 v[60:63], v[36:39], a[224:231], v8
  v_smfmac_f32_16x16x64_bf16 v[64:67], v[36:39], a[232:239], v8
  s_waitcnt lgkmcnt(2)
  v_smfmac_f32_16x16x64_bf16 v[56:59], v[40:43], a[240:247], v8
  v_smfmac_f32_16x16x64_bf16 v[60:63], v[40:43], a[248:255], v8
  v_smfmac_f32_16x16x64_bf16 v[64:67], v[40:43], v[128:135], v8
  s_waitcnt lgkmcnt(1)
  s_barrier
  v_smfmac_f32_16x16x64_bf16 v[56:59], v[44:47], v[136:143], v8
  ds_read_b128 v[36:39], v16 offset:7680
  v_smfmac_f32_16x16x64_bf16 v[60:63], v[44:47], v[144:151], v8
  ds_read_b128 v[40:43], v16 offset:8192
  v_smfmac_f32_16x16x64_bf16 v[64:67], v[44:47], v[152:159], v8
  s_waitcnt lgkmcnt(2)
  v_smfmac_f32_16x16x64_bf16 v[56:59], v[32:35], v[80:87], v8
  ds_read_b128 v[44:47], v16 offset:8704
  v_smfmac_f32_16x16x64_bf16 v[60:63], v[32:35], v[88:95], v8
  v_smfmac_f32_16x16x64_bf16 v[64:67], v[32:35], v[96:103], v8
QKS_s1t2:
  s_waitcnt lgkmcnt(2)
  v_smfmac_f32_16x16x64_bf16 v[56:59], v[36:39], v[160:167], v8
  ds_read_b128 v[32:35], v16 offset:9216
  v_smfmac_f32_16x16x64_bf16 v[60:63], v[36:39], v[168:175], v8
  ds_read_b128 v[80:83], v54 offset:0
  v_smfmac_f32_16x16x64_bf16 v[64:67], v[36:39], v[176:183], v8
  ds_read_b128 v[84:87], v54 offset:1024
  buffer_load_dwordx4 v[2:5], v31, s[8:11], s85 offen sc1
  s_waitcnt lgkmcnt(4)
  v_smfmac_f32_16x16x64_bf16 v[56:59], v[40:43], v[184:191], v8
  ds_read_b128 v[36:39], v16 offset:9728
  v_smfmac_f32_16x16x64_bf16 v[60:63], v[40:43], v[192:199], v8
  ds_read_b128 v[88:91], v54 offset:2048
  v_smfmac_f32_16x16x64_bf16 v[64:67], v[40:43], v[200:207], v8
  ds_read_b128 v[92:95], v54 offset:3072
  s_waitcnt lgkmcnt(6)
  v_smfmac_f32_16x16x64_bf16 v[56:59], v[44:47], v[208:215], v8
  ds_read_b128 v[40:43], v16 offset:0
  buffer_load_dwordx4 v[48:51], v31, s[8:11], s85 offen offset:1024 sc1
  v_smfmac_f32_16x16x64_bf16 v[60:63], v[44:47], v[216:223], v8
  ds_read_b128 v[96:99], v54 offset:4096
  v_smfmac_f32_16x16x64_bf16 v[64:67], v[44:47], v[224:231], v8
  ds_read_b128 v[100:103], v54 offset:5120
  s_waitcnt lgkmcnt(8)
  v_smfmac_f32_16x16x64_bf16 v[56:59], v[32:35], v[232:239], v8
  ds_read_b128 v[44:47], v16 offset:512
  v_smfmac_f32_16x16x64_bf16 v[60:63], v[32:35], v[240:247], v8
  buffer_load_dwordx2 v[52:53], v27, s[8:11], s85 offen offset:2048 sc1
  v_smfmac_f32_16x16x64_bf16 v[64:67], v[32:35], v[248:255], v8
  s_waitcnt lgkmcnt(6)
  v_smfmac_f32_16x16x64_bf16 v[56:59], v[36:39], v[104:111], v8
  ds_read_b128 v[32:35], v16 offset:1024
  v_smfmac_f32_16x16x64_bf16 v[60:63], v[36:39], v[112:119], v8
  v_smfmac_f32_16x16x64_bf16 v[64:67], v[36:39], v[120:127], v8
  s_waitcnt lgkmcnt(4)
  v_smfmac_f32_16x16x64_bf16 v[56:59], v[40:43], a[0:7], v8
  ds_read_b128 v[36:39], v16 offset:1536
  v_smfmac_f32_16x16x64_bf16 v[60:63], v[40:43], a[8:15], v8
  ds_read_b128 v[104:107], v55 offset:0
  v_smfmac_f32_16x16x64_bf16 v[64:67], v[40:43], a[16:23], v8
  ds_read_b128 v[108:111], v55 offset:1024
  s_waitcnt lgkmcnt(4)
  v_smfmac_f32_16x16x64_bf16 v[56:59], v[44:47], a[24:31], v8
  ds_read_b128 v[40:43], v16 offset:2048
  v_smfmac_f32_16x16x64_bf16 v[60:63], v[44:47], a[32:39], v8
  ds_read_b128 v[112:115], v55 offset:2048
  v_smfmac_f32_16x16x64_bf16 v[64:67], v[44:47], a[40:47], v8
  ds_read_b128 v[116:119], v55 offset:3072
  s_waitcnt lgkmcnt(6)
  v_smfmac_f32_16x16x64_bf16 v[56:59], v[32:35], a[48:55], v8
  ds_read_b128 v[44:47], v16 offset:2560
  v_smfmac_f32_16x16x64_bf16 v[60:63], v[32:35], a[56:63], v8
  ds_read_b128 v[120:123], v55 offset:4096
  v_smfmac_f32_16x16x64_bf16 v[64:67], v[32:35], a[64:71], v8
  ds_read_b128 v[124:127], v55 offset:5120
  s_waitcnt lgkmcnt(8)
  v_smfmac_f32_16x16x64_bf16 v[56:59], v[36:39], a[72:79], v8
  ds_read_b128 v[32:35], v16 offset:3072
  v_smfmac_f32_16x16x64_bf16 v[60:63], v[36:39], a[80:87], v8
  v_smfmac_f32_16x16x64_bf16 v[64:67], v[36:39], a[88:95], v8
  s_waitcnt lgkmcnt(6)
  v_smfmac_f32_16x16x64_bf16 v[56:59], v[40:43], v[80:87], v8
  ds_read_b128 v[36:39], v16 offset:3584
  v_smfmac_f32_16x16x64_bf16 v[60:63], v[40:43], v[88:95], v8
  v_smfmac_f32_16x16x64_bf16 v[64:67], v[40:43], v[96:103], v8
  s_waitcnt vmcnt(2)
  buffer_store_dwordx4 v[2:5], v31, s[8:11], s86 offen sc1
  s_waitcnt lgkmcnt(4)
  v_smfmac_f32_16x16x64_bf16 v[56:59], v[44:47], a[96:103], v8
  ds_read_b128 v[40:43], v16 offset:4096
  v_smfmac_f32_16x16x64_bf16 v[60:63], v[44:47], a[104:111], v8
  v_smfmac_f32_16x16x64_bf16 v[64:67], v[44:47], a[112:119], v8
  s_waitcnt lgkmcnt(2)
  v_smfmac_f32_16x16x64_bf16 v[56:59], v[32:35], a[120:127], v8
  ds_read_b128 v[44:47], v16 offset:4608
  s_waitcnt vmcnt(2)
  buffer_store_dwordx4 v[48:51], v31, s[8:11], s86 offen offset:1024 sc1
  v_smfmac_f32_16x16x64_bf16 v[60:63], v[32:35], a[128:135], v8
  v_smfmac_f32_16x16x64_bf16 v[64:67], v[32:35], a[136:143], v8
  s_waitcnt lgkmcnt(2)
  v_smfmac_f32_16x16x64_bf16 v[56:59], v[36:39], a[144:151], v8
  s_waitcnt lgkmcnt(1)
  v_smfmac_f32_16x16x64_bf16 v[56:59], v[40:43], a[168:175], v8
  s_waitcnt vmcnt(2)
  buffer_store_dwordx2 v[52:53], v27, s[8:11], s86 offen offset:2048 sc1
  s_waitcnt lgkmcnt(0)
  v_smfmac_f32_16x16x64_bf16 v[56:59], v[44:47], v[104:111], v8
  v_smfmac_f32_16x16x64_bf16 v[60:63], v[36:39], a[152:159], v8
  v_smfmac_f32_16x16x64_bf16 v[60:63], v[40:43], a[176:183], v8
  v_cvt_pk_bf16_f32 v48, v56, v57
  v_cvt_pk_bf16_f32 v49, v58, v59
  v_smfmac_f32_16x16x64_bf16 v[60:63], v[44:47], v[112:119], v8
  v_mfma_f32_16x16x16_bf16 v[104:107], v[48:49], v[10:11], 0
  v_smfmac_f32_16x16x64_bf16 v[64:67], v[36:39], a[160:167], v8
  v_smfmac_f32_16x16x64_bf16 v[64:67], v[40:43], a[184:191], v8
  v_cvt_pk_bf16_f32 v50, v60, v61
  v_cvt_pk_bf16_f32 v51, v62, v63
  v_smfmac_f32_16x16x64_bf16 v[64:67], v[44:47], v[120:127], v8
QKS_post:
  v_mfma_f32_16x16x16_bf16 v[108:111], v[50:51], v[10:11], 0
  v_cvt_pk_bf16_f32 v80, v104, v105
  v_cvt_pk_bf16_f32 v81, v106, v107
  s_waitcnt vmcnt(3)
  s_nop 0
  v_cvt_pk_bf16_f32 v52, v64, v65
  v_cvt_pk_bf16_f32 v53, v66, v67
  s_nop 1
  v_mfma_f32_16x16x16_bf16 v[112:115], v[52:53], v[10:11], 0
  v_cvt_pk_bf16_f32 v82, v108, v109
  v_cvt_pk_bf16_f32 v83, v110, v111
  s_nop 1
  v_mfma_f32_16x16x32_bf16 v[88:91], v[68:71], v[80:83], 0
  v_mfma_f32_16x16x32_bf16 v[92:95], v[72:75], v[80:83], 0
  v_cvt_pk_bf16_f32 v84, v112, v113
  v_cvt_pk_bf16_f32 v85, v114, v115
  v_mfma_f32_16x16x32_bf16 v[96:99], v[80:83], v[80:83], 0
  v_mfma_f32_16x16x16_bf16 v[88:91], v[76:77], v[84:85], v[88:91]
  v_mfma_f32_16x16x16_bf16 v[92:95], v[78:79], v[84:85], v[92:95]
  v_mfma_f32_16x16x16_bf16 v[96:99], v[84:85], v[84:85], v[96:99]
  s_mov_b32 exec_lo, 0x00ff00ff
  s_mov_b32 exec_hi, 0x00ff00ff
  ds_write_b128 v22, v[88:91]
  s_nop 0
  ds_write_b128 v23, v[92:95]
  s_nop 2
  ds_write_b128 v24, v[96:99]
  s_mov_b64 exec, -1
  s_cmp_eq_u32 s28, 63
  s_cbranch_scc1 QKS_last
  s_cmp_lg_u32 s24, 0
  s_waitcnt lgkmcnt(0)
  s_barrier
  s_cbranch_scc1 QKS_nosm
  ds_read_b128 v[104:107], v25 offset:0
  ds_read_b32 v120, v26 offset:0
  ds_read_b128 v[108:111], v25 offset:1536
  ds_read_b32 v121, v26 offset:1536
  ds_read_b128 v[112:115], v25 offset:3072
  ds_read_b32 v122, v26 offset:3072
  ds_read_b128 v[116:119], v25 offset:4608
  ds_read_b32 v123, v26 offset:4608
  s_waitcnt lgkmcnt(4)
  v_pk_add_f32 v[104:105], v[104:105], v[108:109]
  v_pk_add_f32 v[106:107], v[106:107], v[110:111]
  v_add_f32 v120, v120, v121
  s_waitcnt lgkmcnt(0)
  v_pk_add_f32 v[112:113], v[112:113], v[116:117]
  v_pk_add_f32 v[114:115], v[114:115], v[118:119]
  v_add_f32 v122, v122, v123
  v_pk_add_f32 v[104:105], v[104:105], v[112:113]
  v_pk_add_f32 v[106:107], v[106:107], v[114:115]
  v_add_f32 v120, v120, v122
  v_max3_f32 v32, v104, v105, v106
  v_max3_f32 v32, v32, v107, v120
  s_nop 1
  v_max_f32_dpp v32, v32, v32 quad_perm:[1,0,3,2] row_mask:0xf bank_mask:0xf
  s_nop 1
  v_max_f32_dpp v32, v32, v32 quad_perm:[2,3,0,1] row_mask:0xf bank_mask:0xf
  s_nop 1
  v_max_f32_dpp v32, v32, v32 row_ror:8 row_mask:0xf bank_mask:0xf
  v_mul_f32 v32, s36, v32
  v_fma_f32 v120, v120, s36, -v32
  v_fma_f32 v104, v104, s36, -v32
  v_fma_f32 v105, v105, s36, -v32
  v_fma_f32 v106, v106, s36, -v32
  v_fma_f32 v107, v107, s36, -v32
  v_exp_f32 v104, v104
  v_exp_f32 v105, v105
  v_exp_f32 v106, v106
  v_exp_f32 v107, v107
  v_exp_f32 v120, v120
  v_add_f32 v32, v104, v105
  v_add_f32 v33, v106, v107
  v_add_f32 v32, v32, v120
  v_add_f32 v32, v32, v33
  s_nop 1
  v_add_f32_dpp v32, v32, v32 quad_perm:[1,0,3,2] row_mask:0xf bank_mask:0xf
  s_nop 1
  v_add_f32_dpp v32, v32, v32 quad_perm:[2,3,0,1] row_mask:0xf bank_mask:0xf
  s_nop 1
  v_add_f32_dpp v32, v32, v32 row_ror:8 row_mask:0xf bank_mask:0xf
  v_rcp_f32 v32, v32
  s_nop 0
  v_mul_f32 v120, v120, v32
  v_mul_f32 v104, v104, v32
  v_mul_f32 v105, v105, v32
  v_mul_f32 v106, v106, v32
  v_mul_f32 v107, v107, v32
  v_mov_b32_dpp v34, v120 quad_perm:[0,0,2,2] row_mask:0xf bank_mask:0xf
  v_mov_b32_dpp v35, v120 quad_perm:[1,1,3,3] row_mask:0xf bank_mask:0xf
  v_cvt_pk_bf16_f32 v36, v104, v105
  v_cvt_pk_bf16_f32 v37, v106, v107
  v_cvt_pk_bf16_f32 v38, v34, v35
  v_bfi_b32 v36, v9, v36, s29
  v_bfi_b32 v37, v9, v37, s29
  buffer_store_dwordx2 v[36:37], v27, s[8:11], s37 offen sc1
  v_bfi_b32 v38, v9, v38, s29
  buffer_store_dword v38, v28, s[8:11], s37 offen sc1
QKS_nosm:
  s_barrier
  s_sleep 1
  s_sleep 1
  s_sleep 1
  s_sleep 1
  s_sleep 1
  s_sleep 1
  s_sleep 1
  s_sleep 1
  s_sleep 1
  s_sleep 1
  v_cmp_eq_u32 vcc, 0, v0
  s_add_u32 s31, s28, 1
  s_cbranch_vccz QKS_nokf
  s_lshr_b32 s30, s31, 3
  s_lshl_b32 s30, s30, 9
  s_add_u32 s30, s30, s55
  v_and_b32 v3, 4, v28
QKS_kf:
  buffer_load_dword v2, v3, s[8:11], s30 offen sc1
  s_sub_u32 s82, s82, 1
  s_cbranch_scc1 L_abort
  s_waitcnt vmcnt(0)
  v_cmp_eq_u32 vcc, 0, v2
  s_cbranch_vccnz QKS_kf
QKS_nokf:
  buffer_load_dwordx4 v[68:71], v20, s[8:11], s38 offen offset:0 sc1
  buffer_load_dwordx4 v[72:75], v20, s[8:11], s38 offen offset:256 sc1
  buffer_load_dwordx2 v[76:77], v21, s[8:11], s38 offen offset:0 sc1
  buffer_load_dwordx2 v[78:79], v21, s[8:11], s38 offen offset:256 sc1
  s_add_u32 s38, s38, 393216
  s_add_u32 s85, s85, s88
  s_sub_u32 s88, 0, s88
  s_mov_b32 s86, s87
  s_add_u32 s87, s87, 327680
  s_add_u32 s30, s28, 2
  s_min_u32 s30, s30, 63
  s_lshr_b32 s30, s30, 3
  s_lshl_b32 s30, s30, 9
  s_add_u32 s30, s30, s55
  v_and_b32 v3, 4, v28
  buffer_load_dword v0, v3, s[8:11], s30 offen sc1
  s_mov_b32 exec_lo, 0xff00ff00
  s_mov_b32 exec_hi, 0xff00ff00
  buffer_store_dwordx4 v[80:83], v29, s[8:11], s54 offen sc1
  buffer_store_dwordx2 v[84:85], v30, s[8:11], s54 offen sc1
  s_mov_b64 exec, -1
  s_add_u32 s54, s54, 98304
  s_cmp_lg_u32 s24, 3
  s_cbranch_scc1 QKS_nofl
  v_mov_b32 v2, s28
  s_mov_b64 exec, 1
  buffer_store_dword v2, off, s[8:11], s34 sc1
  s_max_u32 s30, s28, 1
  s_sub_u32 s30, s30, 1
  v_mov_b32 v4, s30
  s_add_u32 s30, s34, 4096
  buffer_store_dword v4, off, s[8:11], s30 sc1
  s_mov_b64 exec, -1
QKS_nofl:
  s_add_u32 s30, s28, 1
  s_lshl_b32 s53, s30, 17
  s_lshl_b32 s30, s30, 9
  s_and_b32 s30, s30, 0x2000
  s_xor_b32 s30, s30, s47
  s_add_u32 s53, s53, s30
  s_add_u32 s48, s53, s40
  s_add_u32 s49, s53, s41
  s_add_u32 s50, s53, s42
  s_add_u32 s51, s53, s43
  s_add_u32 s52, s53, s44
  s_add_u32 s30, s28, 1
  s_cmp_lg_u32 s24, 1
  s_cbranch_scc1 QKS_mkb
  s_sleep 1
  s_sleep 1
  s_sleep 1
  s_sleep 1
  s_mov_b64 exec, 65535
  buffer_load_dword v1, v19, s[8:11], s45 offen sc1
  s_nop 15
  s_nop 7
QKS_mk:
  buffer_load_dword v2, v19, s[8:11], s45 offen sc1
  s_waitcnt vmcnt(1)
  v_cmp_gt_i32 vcc, s30, v1
  s_cbranch_vccz QKS_mkok
  buffer_load_dword v1, v19, s[8:11], s45 offen sc1
  s_sub_u32 s82, s82, 1
  s_cbranch_scc1 L_abort
  s_waitcnt vmcnt(1)
  v_cmp_gt_i32 vcc, s30, v2
  s_cbranch_vccnz QKS_mk
QKS_mkok:
  s_mov_b64 exec, -1
QKS_mkb:
  s_barrier
  buffer_load_dwordx4 v[32:35], v18, s[8:11], s48 offen sc1
  buffer_load_dwordx4 v[36:39], v18, s[8:11], s49 offen sc1
  buffer_load_dwordx4 v[40:43], v18, s[8:11], s50 offen sc1
  buffer_load_dwordx4 v[44:47], v18, s[8:11], s51 offen sc1
  buffer_load_dwordx4 v[48:51], v18, s[8:11], s52 offen sc1
  ds_read_b128 v[80:83], v6 offset:0
  ds_read_b128 v[84:87], v6 offset:1024
  ds_read_b128 v[88:91], v6 offset:2048
  ds_read_b128 v[92:95], v6 offset:3072
  ds_read_b128 v[96:99], v6 offset:4096
  ds_read_b128 v[100:103], v6 offset:5120
  ds_read_b128 v[104:107], v7 offset:0
  ds_read_b128 v[108:111], v7 offset:1024
  ds_read_b128 v[112:115], v7 offset:2048
  ds_read_b128 v[116:119], v7 offset:3072
  ds_read_b128 v[120:123], v7 offset:4096
  ds_read_b128 v[124:127], v7 offset:5120
  v_mov_b32 v56, 0
  v_mov_b32 v57, 0
  v_mov_b32 v58, 0
  v_mov_b32 v59, 0
  v_mov_b32 v60, 0
  v_mov_b32 v61, 0
  v_mov_b32 v62, 0
  v_mov_b32 v63, 0
  v_mov_b32 v64, 0
  v_mov_b32 v65, 0
  v_mov_b32 v66, 0
  v_mov_b32 v67, 0
  s_add_u32 s28, s28, 1
  s_xor_b32 s29, s29, 0x80008000
  s_cmp_eq_u32 s24, 0
  s_cbranch_scc1 QKS_fz0
  s_cmp_eq_u32 s24, 1
  s_cbranch_scc1 QKS_fz1
  s_cmp_eq_u32 s24, 2
  s_cbranch_scc1 QKS_fz2
QKS_fz3:
  s_waitcnt vmcnt(4)
  v_max3_u32 v3, v32, v33, v34
  v_max_u32 v3, v3, v35
  v_mfma_f32_16x16x32_bf16 v[32:35], v[32:35], v[12:15], 0
  s_waitcnt vmcnt(3)
  v_max3_u32 v3, v36, v37, v3
  v_max3_u32 v3, v38, v39, v3
  v_mfma_f32_16x16x32_bf16 v[36:39], v[36:39], v[12:15], 0
  s_waitcnt vmcnt(2)
  v_max3_u32 v3, v40, v41, v3
  v_max3_u32 v3, v42, v43, v3
  v_mfma_f32_16x16x32_bf16 v[40:43], v[40:43], v[12:15], 0
  v_cvt_pk_bf16_f32 v32, v32, v33
  v_cvt_pk_bf16_f32 v33, v34, v35
  ds_write_b64 v17, v[32:33] offset:0
  ds_read_b128 v[32:35], v16 offset:7680
  s_waitcnt vmcnt(1)
  v_max3_u32 v3, v44, v45, v3
  v_max3_u32 v3, v46, v47, v3
  v_mfma_f32_16x16x32_bf16 v[44:47], v[44:47], v[12:15], 0
  v_cvt_pk_bf16_f32 v36, v36, v37
  v_cvt_pk_bf16_f32 v37, v38, v39
  ds_write_b64 v17, v[36:37] offset:512
  ds_read_b128 v[36:39], v16 offset:8192
  s_waitcnt vmcnt(0)
  v_max3_u32 v3, v48, v49, v3
  v_max3_u32 v3, v50, v51, v3
  v_mfma_f32_16x16x32_bf16 v[48:51], v[48:51], v[12:15], 0
  v_cmp_eq_u32 vcc, -1, v3
  v_cvt_pk_bf16_f32 v40, v40, v41
  v_cvt_pk_bf16_f32 v41, v42, v43
  ds_write_b64 v17, v[40:41] offset:1024
  ds_read_b128 v[40:43], v16 offset:8704
  s_waitcnt lgkmcnt(4)
  v_smfmac_f32_16x16x64_bf16 v[56:59], v[32:35], v[160:167], v8
  v_cvt_pk_bf16_f32 v44, v44, v45
  v_cvt_pk_bf16_f32 v45, v46, v47
  ds_write_b64 v17, v[44:45] offset:1536
  ds_read_b128 v[44:47], v16 offset:9216
  v_smfmac_f32_16x16x64_bf16 v[60:63], v[32:35], v[168:175], v8
  v_smfmac_f32_16x16x64_bf16 v[64:67], v[32:35], v[176:183], v8
  v_cvt_pk_bf16_f32 v48, v48, v49
  v_cvt_pk_bf16_f32 v49, v50, v51
  ds_write_b64 v17, v[48:49] offset:2048
  ds_read_b128 v[48:51], v16 offset:9728
  s_cbranch_vccnz QKS_h2r0
  s_waitcnt lgkmcnt(6)
  v_smfmac_f32_16x16x64_bf16 v[56:59], v[36:39], v[184:191], v8
  v_smfmac_f32_16x16x64_bf16 v[60:63], v[36:39], v[192:199], v8
  v_smfmac_f32_16x16x64_bf16 v[64:67], v[36:39], v[200:207], v8
  s_waitcnt lgkmcnt(1)
  s_barrier
  v_smfmac_f32_16x16x64_bf16 v[56:59], v[40:43], v[208:215], v8
  ds_read_b128 v[36:39], v16 offset:0
  v_smfmac_f32_16x16x64_bf16 v[60:63], v[40:43], v[216:223], v8
  v_smfmac_f32_16x16x64_bf16 v[64:67], v[40:43], v[224:231], v8
  v_smfmac_f32_16x16x64_bf16 v[56:59], v[44:47], v[232:239], v8
  ds_read_b128 v[40:43], v16 offset:512
  v_smfmac_f32_16x16x64_bf16 v[60:63], v[44:47], v[240:247], v8
  v_smfmac_f32_16x16x64_bf16 v[64:67], v[44:47], v[248:255], v8
  s_waitcnt lgkmcnt(2)
  v_smfmac_f32_16x16x64_bf16 v[56:59], v[48:51], v[80:87], v8
  ds_read_b128 v[44:47], v16 offset:1024
  v_smfmac_f32_16x16x64_bf16 v[60:63], v[48:51], v[88:95], v8
  v_smfmac_f32_16x16x64_bf16 v[64:67], v[48:51], v[96:103], v8
  s_branch QKS_s1t3
QKS_fz0:
  s_waitcnt vmcnt(4)
  v_max3_u32 v3, v32, v33, v34
  v_max_u32 v3, v3, v35
  v_mfma_f32_16x16x32_bf16 v[32:35], v[32:35], v[12:15], 0
  s_waitcnt vmcnt(3)
  v_max3_u32 v3, v36, v37, v3
  v_max3_u32 v3, v38, v39, v3
  v_mfma_f32_16x16x32_bf16 v[36:39], v[36:39], v[12:15], 0
  s_waitcnt vmcnt(2)
  v_max3_u32 v3, v40, v41, v3
  v_max3_u32 v3, v42, v43, v3
  v_mfma_f32_16x16x32_bf16 v[40:43], v[40:43], v[12:15], 0
  v_cvt_pk_bf16_f32 v32, v32, v33
  v_cvt_pk_bf16_f32 v33, v34, v35
  ds_write_b64 v17, v[32:33] offset:0
  ds_read_b128 v[32:35], v16 offset:0
  s_waitcnt vmcnt(1)
  v_max3_u32 v3, v44, v45, v3
  v_max3_u32 v3, v46, v47, v3
  v_mfma_f32_16x16x32_bf16 v[44:47], v[44:47], v[12:15], 0
  v_cvt_pk_bf16_f32 v36, v36, v37
  v_cvt_pk_bf16_f32 v37, v38, v39
  ds_write_b64 v17, v[36:37] offset:512
  ds_read_b128 v[36:39], v16 offset:512
  s_waitcnt vmcnt(0)
  v_max3_u32 v3, v48, v49, v3
  v_max3_u32 v3, v50, v51, v3
  v_mfma_f32_16x16x32_bf16 v[48:51], v[48:51], v[12:15], 0
  v_cmp_eq_u32 vcc, -1, v3
  v_cvt_pk_bf16_f32 v40, v40, v41
  v_cvt_pk_bf16_f32 v41, v42, v43
  ds_write_b64 v17, v[40:41] offset:1024
  ds_read_b128 v[40:43], v16 offset:1024
  s_waitcnt lgkmcnt(4)
  v_smfmac_f32_16x16x64_bf16 v[56:59], v[32:35], a[0:7], v8
  v_cvt_pk_bf16_f32 v44, v44, v45
  v_cvt_pk_bf16_f32 v45, v46, v47
  ds_write_b64 v17, v[44:45] offset:1536
  ds_read_b128 v[44:47], v16 offset:1536
  v_smfmac_f32_16x16x64_bf16 v[60:63], v[32:35], a[8:15], v8
  v_smfmac_f32_16x16x64_bf16 v[64:67], v[32:35], a[16:23], v8
  v_cvt_pk_bf16_f32 v48, v48, v49
  v_cvt_pk_bf16_f32 v49, v50, v51
  ds_write_b64 v17, v[48:49] offset:2048
  ds_read_b128 v[48:51], v16 offset:2048
  s_cbranch_vccnz QKS_h2r0
  s_waitcnt lgkmcnt(6)
  v_smfmac_f32_16x16x64_bf16 v[56:59], v[36:39], a[24:31], v8
  v_smfmac_f32_16x16x64_bf16 v[60:63], v[36:39], a[32:39], v8
  v_smfmac_f32_16x16x64_bf16 v[64:67], v[36:39], a[40:47], v8
  s_waitcnt lgkmcnt(1)
  s_barrier
  v_smfmac_f32_16x16x64_bf16 v[56:59], v[40:43], a[48:55], v8
  ds_read_b128 v[36:39], v16 offset:2560
  v_smfmac_f32_16x16x64_bf16 v[60:63], v[40:43], a[56:63], v8
  v_smfmac_f32_16x16x64_bf16 v[64:67], v[40:43], a[64:71], v8
  v_smfmac_f32_16x16x64_bf16 v[56:59], v[44:47], a[72:79], v8
  ds_read_b128 v[40:43], v16 offset:3072
  v_smfmac_f32_16x16x64_bf16 v[60:63], v[44:47], a[80:87], v8
  v_smfmac_f32_16x16x64_bf16 v[64:67], v[44:47], a[88:95], v8
  s_waitcnt lgkmcnt(2)
  v_smfmac_f32_16x16x64_bf16 v[56:59], v[48:51], v[80:87], v8
  ds_read_b128 v[44:47], v16 offset:3584
  v_smfmac_f32_16x16x64_bf16 v[60:63], v[48:51], v[88:95], v8
  v_smfmac_f32_16x16x64_bf16 v[64:67], v[48:51], v[96:103], v8
  s_branch QKS_s1t0
QKS_fz1:
  s_waitcnt vmcnt(4)
  v_max3_u32 v3, v32, v33, v34
  v_max_u32 v3, v3, v35
  v_mfma_f32_16x16x32_bf16 v[32:35], v[32:35], v[12:15], 0
  s_waitcnt vmcnt(3)
  v_max3_u32 v3, v36, v37, v3
  v_max3_u32 v3, v38, v39, v3
  v_mfma_f32_16x16x32_bf16 v[36:39], v[36:39], v[12:15], 0
  s_waitcnt vmcnt(2)
  v_max3_u32 v3, v40, v41, v3
  v_max3_u32 v3, v42, v43, v3
  v_mfma_f32_16x16x32_bf16 v[40:43], v[40:43], v[12:15], 0
  v_cvt_pk_bf16_f32 v32, v32, v33
  v_cvt_pk_bf16_f32 v33, v34, v35
  ds_write_b64 v17, v[32:33] offset:0
  ds_read_b128 v[32:35], v16 offset:2560
  s_waitcnt vmcnt(1)
  v_max3_u32 v3, v44, v45, v3
  v_max3_u32 v3, v46, v47, v3
  v_mfma_f32_16x16x32_bf16 v[44:47], v[44:47], v[12:15], 0
  v_cvt_pk_bf16_f32 v36, v36, v37
  v_cvt_pk_bf16_f32 v37, v38, v39
  ds_write_b64 v17, v[36:37] offset:512
  ds_read_b128 v[36:39], v16 offset:3072
  s_waitcnt vmcnt(0)
  v_max3_u32 v3, v48, v49, v3
  v_max3_u32 v3, v50, v51, v3
  v_mfma_f32_16x16x32_bf16 v[48:51], v[48:51], v[12:15], 0
  v_cmp_eq_u32 vcc, -1, v3
  v_cvt_pk_bf16_f32 v40, v40, v41
  v_cvt_pk_bf16_f32 v41, v42, v43
  ds_write_b64 v17, v[40:41] offset:1024
  ds_read_b128 v[40:43], v16 offset:3584
  s_waitcnt lgkmcnt(4)
  v_smfmac_f32_16x16x64_bf16 v[56:59], v[32:35], a[96:103], v8
  v_cvt_pk_bf16_f32 v44, v44, v45
  v_cvt_pk_bf16_f32 v45, v46, v47
  ds_write_b64 v17, v[44:45] offset:1536
  ds_read_b128 v[44:47], v16 offset:4096
  v_smfmac_f32_16x16x64_bf16 v[60:63], v[32:35], a[104:111], v8
  v_smfmac_f32_16x16x64_bf16 v[64:67], v[32:35], a[112:119], v8
  v_cvt_pk_bf16_f32 v48, v48, v49
  v_cvt_pk_bf16_f32 v49, v50, v51
  ds_write_b64 v17, v[48:49] offset:2048
  ds_read_b128 v[48:51], v16 offset:4608
  s_cbranch_vccnz QKS_h2r0
  s_waitcnt lgkmcnt(6)
  v_smfmac_f32_16x16x64_bf16 v[56:59], v[36:39], a[120:127], v8
  v_smfmac_f32_16x16x64_bf16 v[60:63], v[36:39], a[128:135], v8
  v_smfmac_f32_16x16x64_bf16 v[64:67], v[36:39], a[136:143], v8
  s_waitcnt lgkmcnt(1)
  s_barrier
  v_smfmac_f32_16x16x64_bf16 v[56:59], v[40:43], a[144:151], v8
  ds_read_b128 v[36:39], v16 offset:5120
  v_smfmac_f32_16x16x64_bf16 v[60:63], v[40:43], a[152:159], v8
  v_smfmac_f32_16x16x64_bf16 v[64:67], v[40:43], a[160:167], v8
  v_smfmac_f32_16x16x64_bf16 v[56:59], v[44:47], a[168:175], v8
  ds_read_b128 v[40:43], v16 offset:5632
  v_smfmac_f32_16x16x64_bf16 v[60:63], v[44:47], a[176:183], v8
  v_smfmac_f32_16x16x64_bf16 v[64:67], v[44:47], a[184:191], v8
  s_waitcnt lgkmcnt(2)
  v_smfmac_f32_16x16x64_bf16 v[56:59], v[48:51], v[80:87], v8
  ds_read_b128 v[44:47], v16 offset:6144
  v_smfmac_f32_16x16x64_bf16 v[60:63], v[48:51], v[88:95], v8
  v_smfmac_f32_16x16x64_bf16 v[64:67], v[48:51], v[96:103], v8
  s_branch QKS_s1t1
QKS_fz2:
  s_waitcnt vmcnt(4)
  v_max3_u32 v3, v32, v33, v34
  v_max_u32 v3, v3, v35
  v_mfma_f32_16x16x32_bf16 v[32:35], v[32:35], v[12:15], 0
  s_waitcnt vmcnt(3)
  v_max3_u32 v3, v36, v37, v3
  v_max3_u32 v3, v38, v39, v3
  v_mfma_f32_16x16x32_bf16 v[36:39], v[36:39], v[12:15], 0
  s_waitcnt vmcnt(2)
  v_max3_u32 v3, v40, v41, v3
  v_max3_u32 v3, v42, v43, v3
  v_mfma_f32_16x16x32_bf16 v[40:43], v[40:43], v[12:15], 0
  v_cvt_pk_bf16_f32 v32, v32, v33
  v_cvt_pk_bf16_f32 v33, v34, v35
  ds_write_b64 v17, v[32:33] offset:0
  ds_read_b128 v[32:35], v16 offset:5120
  s_waitcnt vmcnt(1)
  v_max3_u32 v3, v44, v45, v3
  v_max3_u32 v3, v46, v47, v3
  v_mfma_f32_16x16x32_bf16 v[44:47], v[44:47], v[12:15], 0
  v_cvt_pk_bf16_f32 v36, v36, v37
  v_cvt_pk_bf16_f32 v37, v38, v39
  ds_write_b64 v17, v[36:37] offset:512
  ds_read_b128 v[36:39], v16 offset:5632
  s_waitcnt vmcnt(0)
  v_max3_u32 v3, v48, v49, v3
  v_max3_u32 v3, v50, v51, v3
  v_mfma_f32_16x16x32_bf16 v[48:51], v[48:51], v[12:15], 0
  v_cmp_eq_u32 vcc, -1, v3
  v_cvt_pk_bf16_f32 v40, v40, v41
  v_cvt_pk_bf16_f32 v41, v42, v43
  ds_write_b64 v17, v[40:41] offset:1024
  ds_read_b128 v[40:43], v16 offset:6144
  s_waitcnt lgkmcnt(4)
  v_smfmac_f32_16x16x64_bf16 v[56:59], v[32:35], a[192:199], v8
  v_cvt_pk_bf16_f32 v44, v44, v45
  v_cvt_pk_bf16_f32 v45, v46, v47
  ds_write_b64 v17, v[44:45] offset:1536
  ds_read_b128 v[44:47], v16 offset:6656
  v_smfmac_f32_16x16x64_bf16 v[60:63], v[32:35], a[200:207], v8
  v_smfmac_f32_16x16x64_bf16 v[64:67], v[32:35], a[208:215], v8
  v_cvt_pk_bf16_f32 v48, v48, v49
  v_cvt_pk_bf16_f32 v49, v50, v51
  ds_write_b64 v17, v[48:49] offset:2048
  ds_read_b128 v[48:51], v16 offset:7168
  s_cbranch_vccnz QKS_h2r0
  s_waitcnt lgkmcnt(6)
  v_smfmac_f32_16x16x64_bf16 v[56:59], v[36:39], a[216:223], v8
  v_smfmac_f32_16x16x64_bf16 v[60:63], v[36:39], a[224:231], v8
  v_smfmac_f32_16x16x64_bf16 v[64:67], v[36:39], a[232:239], v8
  s_waitcnt lgkmcnt(1)
  s_barrier
  v_smfmac_f32_16x16x64_bf16 v[56:59], v[40:43], a[240:247], v8
  ds_read_b128 v[36:39], v16 offset:7680
  v_smfmac_f32_16x16x64_bf16 v[60:63], v[40:43], a[248:255], v8
  v_smfmac_f32_16x16x64_bf16 v[64:67], v[40:43], v[128:135], v8
  v_smfmac_f32_16x16x64_bf16 v[56:59], v[44:47], v[136:143], v8
  ds_read_b128 v[40:43], v16 offset:8192
  v_smfmac_f32_16x16x64_bf16 v[60:63], v[44:47], v[144:151], v8
  v_smfmac_f32_16x16x64_bf16 v[64:67], v[44:47], v[152:159], v8
  s_waitcnt lgkmcnt(2)
  v_smfmac_f32_16x16x64_bf16 v[56:59], v[48:51], v[80:87], v8
  ds_read_b128 v[44:47], v16 offset:8704
  v_smfmac_f32_16x16x64_bf16 v[60:63], v[48:51], v[88:95], v8
  v_smfmac_f32_16x16x64_bf16 v[64:67], v[48:51], v[96:103], v8
  s_branch QKS_s1t2
QKS_h2r0:
  s_waitcnt lgkmcnt(0)
  s_nop 7
  v_mov_b32 v56, 0
  v_mov_b32 v57, 0
  v_mov_b32 v58, 0
  v_mov_b32 v59, 0
  v_mov_b32 v60, 0
  v_mov_b32 v61, 0
  v_mov_b32 v62, 0
  v_mov_b32 v63, 0
  v_mov_b32 v64, 0
  v_mov_b32 v65, 0
  v_mov_b32 v66, 0
  v_mov_b32 v67, 0
QKS_h2r:
  buffer_load_dwordx4 v[32:35], v18, s[8:11], s48 offen sc1
  buffer_load_dwordx4 v[36:39], v18, s[8:11], s49 offen sc1
  buffer_load_dwordx4 v[40:43], v18, s[8:11], s50 offen sc1
  buffer_load_dwordx4 v[44:47], v18, s[8:11], s51 offen sc1
  buffer_load_dwordx4 v[48:51], v18, s[8:11], s52 offen sc1
  s_sub_u32 s82, s82, 1
  s_cbranch_scc1 L_abort
  s_waitcnt vmcnt(4)
  v_max3_u32 v3, v32, v33, v34
  v_max_u32 v3, v3, v35
  v_mfma_f32_16x16x32_bf16 v[32:35], v[32:35], v[12:15], 0
  s_waitcnt vmcnt(3)
  v_max3_u32 v3, v36, v37, v3
  v_max3_u32 v3, v38, v39, v3
  v_mfma_f32_16x16x32_bf16 v[36:39], v[36:39], v[12:15], 0
  s_waitcnt vmcnt(2)
  v_max3_u32 v3, v40, v41, v3
  v_max3_u32 v3, v42, v43, v3
  v_mfma_f32_16x16x32_bf16 v[40:43], v[40:43], v[12:15], 0
  s_waitcnt vmcnt(1)
  v_max3_u32 v3, v44, v45, v3
  v_max3_u32 v3, v46, v47, v3
  v_mfma_f32_16x16x32_bf16 v[44:47], v[44:47], v[12:15], 0
  v_cvt_pk_bf16_f32 v32, v32, v33
  v_cvt_pk_bf16_f32 v33, v34, v35
  ds_write_b64 v17, v[32:33] offset:0
  s_waitcnt vmcnt(0)
  v_max3_u32 v3, v48, v49, v3
  v_max3_u32 v3, v50, v51, v3
  v_mfma_f32_16x16x32_bf16 v[48:51], v[48:51], v[12:15], 0
  v_cvt_pk_bf16_f32 v36, v36, v37
  v_cvt_pk_bf16_f32 v37, v38, v39
  ds_write_b64 v17, v[36:37] offset:512
  v_cmp_eq_u32 vcc, -1, v3
  v_cvt_pk_bf16_f32 v40, v40, v41
  v_cvt_pk_bf16_f32 v41, v42, v43
  ds_write_b64 v17, v[40:41] offset:1024
  v_cvt_pk_bf16_f32 v44, v44, v45
  v_cvt_pk_bf16_f32 v45, v46, v47
  ds_write_b64 v17, v[44:45] offset:1536
  s_nop 0
  v_cvt_pk_bf16_f32 v48, v48, v49
  v_cvt_pk_bf16_f32 v49, v50, v51
  ds_write_b64 v17, v[48:49] offset:2048
  s_cbranch_vccnz QKS_h2r
  s_branch QKS_loop
QKS_last:
  s_mov_b32 exec_lo, 0xff00ff00
  s_mov_b32 exec_hi, 0xff00ff00
  buffer_store_dwordx4 v[80:83], v29, s[8:11], s54 offen sc1
  buffer_store_dwordx2 v[84:85], v30, s[8:11], s54 offen sc1
  s_mov_b64 exec, -1
  s_add_u32 s54, s54, 98304
  s_waitcnt vmcnt(0)
  s_barrier
  v_mov_b32 v2, 64
  v_mov_b32 v3, 0
  s_mov_b64 exec, 1
  buffer_store_dword v2, v3, s[8:11], s34 offen sc1
  v_mov_b32 v4, 63
  s_add_u32 s30, s34, 4096
  buffer_store_dword v4, off, s[8:11], s30 sc1
  s_waitcnt vmcnt(0)
  s_mov_b64 exec, -1
  s_branch QK_end
QK_end:
  s_branch L_cfin
M_vo:
  s_sub_u32 s26, s26, 16
  s_lshl_b32 s27, s25, 4
  s_add_u32 s27, s27, s26
  v_and_b32 v1, 63, v0
  s_load_dwordx4 s[32:35], s[0:1], 32
  s_load_dwordx2 s[20:21], s[0:1], 8
  s_waitcnt lgkmcnt(0)
  s_mov_b32 s12, s32
  s_mov_b32 s13, s33
  s_mov_b32 s14, 7864320
  s_mov_b32 s15, 0x20000
  s_mov_b32 s16, s34
  s_mov_b32 s17, s35
  s_mov_b32 s18, 7864320
  s_mov_b32 s19, 0x20000
  s_mov_b32 s22, 10240
  s_mov_b32 s23, 0x20000
  s_lshr_b32 s31, s24, 1
  s_mul_i32 s31, s31, 393216
  s_and_b32 s30, s24, 1
  s_mul_i32 s30, s30, 384
  s_add_u32 s30, s30, 0
  v_add_u32 v2, s30, v1
  v_mul_u32_u24 v3, 2731, v2
  v_lshrrev_b32 v3, 16, v3
  v_mul_u32_u24 v4, 24, v3
  v_sub_u32 v4, v2, v4
  v_mul_u32_u24 v3, 12288, v3
  v_lshl_add_u32 v3, v4, 4, v3
  v_add_u32 v72, s31, v3
  s_and_b32 s30, s24, 1
  s_mul_i32 s30, s30, 384
  s_add_u32 s30, s30, 64
  v_add_u32 v2, s30, v1
  v_mul_u32_u24 v3, 2731, v2
  v_lshrrev_b32 v3, 16, v3
  v_mul_u32_u24 v4, 24, v3
  v_sub_u32 v4, v2, v4
  v_mul_u32_u24 v3, 12288, v3
  v_lshl_add_u32 v3, v4, 4, v3
  v_add_u32 v73, s31, v3
  s_and_b32 s30, s24, 1
  s_mul_i32 s30, s30, 384
  s_add_u32 s30, s30, 128
  v_add_u32 v2, s30, v1
  v_mul_u32_u24 v3, 2731, v2
  v_lshrrev_b32 v3, 16, v3
  v_mul_u32_u24 v4, 24, v3
  v_sub_u32 v4, v2, v4
  v_mul_u32_u24 v3, 12288, v3
  v_lshl_add_u32 v3, v4, 4, v3
  v_add_u32 v74, s31, v3
  s_and_b32 s30, s24, 1
  s_mul_i32 s30, s30, 384
  s_add_u32 s30, s30, 192
  v_add_u32 v2, s30, v1
  v_mul_u32_u24 v3, 2731, v2
  v_lshrrev_b32 v3, 16, v3
  v_mul_u32_u24 v4, 24, v3
  v_sub_u32 v4, v2, v4
  v_mul_u32_u24 v3, 12288, v3
  v_lshl_add_u32 v3, v4, 4, v3
  v_add_u32 v75, s31, v3
  s_and_b32 s30, s24, 1
  s_mul_i32 s30, s30, 384
  s_add_u32 s30, s30, 256
  v_add_u32 v2, s30, v1
  v_mul_u32_u24 v3, 2731, v2
  v_lshrrev_b32 v3, 16, v3
  v_mul_u32_u24 v4, 24, v3
  v_sub_u32 v4, v2, v4
  v_mul_u32_u24 v3, 12288, v3
  v_lshl_add_u32 v3, v4, 4, v3
  v_add_u32 v76, s31, v3
  s_and_b32 s30, s24, 1
  s_mul_i32 s30, s30, 384
  s_add_u32 s30, s30, 320
  v_add_u32 v2, s30, v1
  v_mul_u32_u24 v3, 2731, v2
  v_lshrrev_b32 v3, 16, v3
  v_mul_u32_u24 v4, 24, v3
  v_sub_u32 v4, v2, v4
  v_mul_u32_u24 v3, 12288, v3
  v_lshl_add_u32 v3, v4, 4, v3
  v_add_u32 v77, s31, v3
  v_lshlrev_b32 v9, 4, v1
  v_lshrrev_b32 v3, 4, v1
  v_lshlrev_b32 v3, 2, v3
  v_bfe_u32 v4, v1, 2, 1
  v_add_u32 v5, v3, v4
  v_bfe_u32 v2, v1, 3, 1
  v_mul_u32_u24 v3, 12288, v2
  v_mul_u32_u24 v4, 384, v5
  v_add_u32 v3, v3, v4
  v_and_b32 v4, 3, v1
  v_lshl_add_u32 v3, v4, 3, v3
  s_mul_i32 s30, s24, 96
  v_add_u32 v78, s30, v3
  v_mul_u32_u24 v3, 1280, v5
  v_lshl_add_u32 v3, v2, 5, v3
  v_lshl_add_u32 v3, v4, 3, v3
  s_mul_i32 s30, s24, 320
  v_add_u32 v79, s30, v3
  s_mul_i32 s34, s27, 384
  s_mul_i32 s35, s24, 6144
  s_mul_i32 s37, s24, 5120
  s_mul_i32 s38, s27, 245760
  v_add_u32 v6, s35, v9
  v_add_u32 v81, s37, v9
  v_add_u32 v7, 49152, v81
  s_add_u32 m0, s35, 49152
  s_add_u32 s36, s34, 0
  buffer_load_dwordx4 v72, s[12:15], s36 offen  lds
  s_add_u32 m0, m0, 1024
  s_nop 0
  buffer_load_dwordx4 v73, s[12:15], s36 offen  lds
  s_add_u32 m0, m0, 1024
  s_nop 0
  buffer_load_dwordx4 v74, s[12:15], s36 offen  lds
  s_add_u32 m0, m0, 1024
  s_nop 0
  buffer_load_dwordx4 v75, s[12:15], s36 offen  lds
  s_add_u32 m0, m0, 1024
  s_nop 0
  buffer_load_dwordx4 v76, s[12:15], s36 offen  lds
  s_add_u32 m0, m0, 1024
  s_nop 0
  buffer_load_dwordx4 v77, s[12:15], s36 offen  lds
  s_add_u32 m0, s35, 73728
  s_add_u32 s36, s34, 786432
  buffer_load_dwordx4 v72, s[12:15], s36 offen  lds
  s_add_u32 m0, m0, 1024
  s_nop 0
  buffer_load_dwordx4 v73, s[12:15], s36 offen  lds
  s_add_u32 m0, m0, 1024
  s_nop 0
  buffer_load_dwordx4 v74, s[12:15], s36 offen  lds
  s_add_u32 m0, m0, 1024
  s_nop 0
  buffer_load_dwordx4 v75, s[12:15], s36 offen  lds
  s_add_u32 m0, m0, 1024
  s_nop 0
  buffer_load_dwordx4 v76, s[12:15], s36 offen  lds
  s_add_u32 m0, m0, 1024
  s_nop 0
  buffer_load_dwordx4 v77, s[12:15], s36 offen  lds
  s_add_u32 m0, s35, 98304
  s_add_u32 s36, s34, 1572864
  buffer_load_dwordx4 v72, s[12:15], s36 offen  lds
  s_add_u32 m0, m0, 1024
  s_nop 0
  buffer_load_dwordx4 v73, s[12:15], s36 offen  lds
  s_add_u32 m0, m0, 1024
  s_nop 0
  buffer_load_dwordx4 v74, s[12:15], s36 offen  lds
  s_add_u32 m0, m0, 1024
  s_nop 0
  buffer_load_dwordx4 v75, s[12:15], s36 offen  lds
  s_add_u32 m0, m0, 1024
  s_nop 0
  buffer_load_dwordx4 v76, s[12:15], s36 offen  lds
  s_add_u32 m0, m0, 1024
  s_nop 0
  buffer_load_dwordx4 v77, s[12:15], s36 offen  lds
  s_add_u32 m0, s35, 122880
  s_add_u32 s36, s34, 2359296
  buffer_load_dwordx4 v72, s[12:15], s36 offen  lds
  s_add_u32 m0, m0, 1024
  s_nop 0
  buffer_load_dwordx4 v73, s[12:15], s36 offen  lds
  s_add_u32 m0, m0, 1024
  s_nop 0
  buffer_load_dwordx4 v74, s[12:15], s36 offen  lds
  s_add_u32 m0, m0, 1024
  s_nop 0
  buffer_load_dwordx4 v75, s[12:15], s36 offen  lds
  s_add_u32 m0, m0, 1024
  s_nop 0
  buffer_load_dwordx4 v76, s[12:15], s36 offen  lds
  s_add_u32 m0, m0, 1024
  s_nop 0
  buffer_load_dwordx4 v77, s[12:15], s36 offen  lds
  s_cmp_eq_u32 s81, 0
  s_cbranch_scc1 C_in_82x
  v_and_b32 v1, 63, v0
  v_lshlrev_b32 v60, 4, v1
  v_mov_b32 v62, -1
  v_mov_b32 v66, 0
  v_mov_b32 v63, -1
  v_mov_b32 v67, 0
  v_mov_b32 v64, -1
  v_mov_b32 v68, 0
  v_mov_b32 v65, -1
  v_mov_b32 v69, 0
  s_lshr_b32 s60, s2, 2
  s_lshl_b32 s61, s60, 17
  s_and_b32 s60, s2, 1
  s_lshl_b32 s60, s60, 13
  s_add_u32 s61, s61, s60
  s_add_u32 s61, s61, 201326592
  s_and_b32 s60, s2, 2
  s_lshl_b32 s60, s60, 14
  s_add_u32 s62, s61, s60
  s_lshl_b32 s60, s24, 11
  s_add_u32 s62, s62, s60
  buffer_store_dwordx4 v[62:65], v60, s[8:11], s62 offen offset:0 sc1
  buffer_store_dwordx4 v[62:65], v60, s[8:11], s62 offen offset:1024 sc1
  s_lshr_b32 s60, s24, 1
  s_lshl_b32 s60, s60, 12
  s_add_u32 s61, s61, s60
  s_and_b32 s60, s24, 1
  s_lshl_b32 s60, s60, 10
  s_add_u32 s61, s61, s60
  s_add_u32 s61, s61, 65536
  buffer_store_dwordx4 v[62:65], v60, s[8:11], s61 offen sc1
  s_cmp_eq_u32 s24, 3
  s_cbranch_scc1 C_in_82_w3
  s_mul_i32 s60, s2, 3
  s_add_u32 s60, s60, s24
  s_cmp_ge_u32 s60, 384
  s_cselect_b32 s61, 384, 0
  s_cselect_b32 s62, 1048576, 0
  s_add_u32 s62, s62, 4194304
  s_sub_u32 s60, s60, s61
  s_lshl_b32 s61, s60, 10
  s_add_u32 s61, s61, s62
  s_lshr_b32 s60, s60, 3
  s_cmp_eq_u32 s60, 2
  s_cbranch_scc1 C_in_82_z
  buffer_store_dwordx4 v[62:65], v60, s[8:11], s61 offen sc1
  s_branch C_in_82_d
C_in_82_w3:
  s_cmp_ge_u32 s2, 128
  s_cbranch_scc1 C_in_82_d
  s_lshl_b32 s61, s2, 10
  s_add_u32 s61, s61, 6291456
C_in_82_z:
  buffer_store_dwordx4 v[66:69], v60, s[8:11], s61 offen sc1
C_in_82_d:
C_in_82x:
  s_cmp_eq_u32 s81, 0
  s_cbranch_scc1 C_w_83a
  s_waitcnt vmcnt(21)
  s_branch C_w_83b
C_w_83a:
  s_waitcnt vmcnt(18)
C_w_83b:
  s_barrier
  s_nop 0
  v_add_u32 v80, 49152, v78
  ds_read_b64_tr_b16 a[0:1], v80 offset:0
  ds_read_b64_tr_b16 a[2:3], v80 offset:768
  ds_read_b64_tr_b16 a[4:5], v80 offset:6144
  ds_read_b64_tr_b16 a[6:7], v80 offset:6912
  ds_read_b64_tr_b16 a[8:9], v80 offset:32
  ds_read_b64_tr_b16 a[10:11], v80 offset:800
  ds_read_b64_tr_b16 a[12:13], v80 offset:6176
  ds_read_b64_tr_b16 a[14:15], v80 offset:6944
  ds_read_b64_tr_b16 a[16:17], v80 offset:64
  ds_read_b64_tr_b16 a[18:19], v80 offset:832
  ds_read_b64_tr_b16 a[20:21], v80 offset:6208
  ds_read_b64_tr_b16 a[22:23], v80 offset:6976
  s_waitcnt lgkmcnt(4)
  s_waitcnt lgkmcnt(0)
  s_cmp_eq_u32 s81, 0
  s_cbranch_scc1 C_w_84a
  s_waitcnt vmcnt(15)
  s_branch C_w_84b
C_w_84a:
  s_waitcnt vmcnt(12)
C_w_84b:
  s_barrier
  s_add_u32 m0, s35, 0
  s_add_u32 s36, s34, 3145728
  buffer_load_dwordx4 v72, s[12:15], s36 offen  lds
  s_add_u32 m0, m0, 1024
  s_nop 0
  buffer_load_dwordx4 v73, s[12:15], s36 offen  lds
  s_add_u32 m0, m0, 1024
  s_nop 0
  buffer_load_dwordx4 v74, s[12:15], s36 offen  lds
  s_add_u32 m0, m0, 1024
  s_nop 0
  buffer_load_dwordx4 v75, s[12:15], s36 offen  lds
  s_add_u32 m0, m0, 1024
  s_nop 0
  buffer_load_dwordx4 v76, s[12:15], s36 offen  lds
  s_add_u32 m0, m0, 1024
  s_nop 0
  buffer_load_dwordx4 v77, s[12:15], s36 offen  lds
  v_add_u32 v80, 73728, v78
  ds_read_b64_tr_b16 a[24:25], v80 offset:0
  ds_read_b64_tr_b16 a[26:27], v80 offset:768
  ds_read_b64_tr_b16 a[28:29], v80 offset:6144
  ds_read_b64_tr_b16 a[30:31], v80 offset:6912
  ds_read_b64_tr_b16 a[32:33], v80 offset:32
  ds_read_b64_tr_b16 a[34:35], v80 offset:800
  ds_read_b64_tr_b16 a[36:37], v80 offset:6176
  ds_read_b64_tr_b16 a[38:39], v80 offset:6944
  ds_read_b64_tr_b16 a[40:41], v80 offset:64
  ds_read_b64_tr_b16 a[42:43], v80 offset:832
  ds_read_b64_tr_b16 a[44:45], v80 offset:6208
  ds_read_b64_tr_b16 a[46:47], v80 offset:6976
  s_waitcnt lgkmcnt(4)
  s_waitcnt lgkmcnt(0)
  s_cmp_eq_u32 s81, 0
  s_cbranch_scc1 C_w_85a
  s_waitcnt vmcnt(15)
  s_branch C_w_85b
C_w_85a:
  s_waitcnt vmcnt(12)
C_w_85b:
  s_barrier
  s_add_u32 m0, s35, 24576
  s_add_u32 s36, s34, 3932160
  buffer_load_dwordx4 v72, s[12:15], s36 offen  lds
  s_add_u32 m0, m0, 1024
  s_nop 0
  buffer_load_dwordx4 v73, s[12:15], s36 offen  lds
  s_add_u32 m0, m0, 1024
  s_nop 0
  buffer_load_dwordx4 v74, s[12:15], s36 offen  lds
  s_add_u32 m0, m0, 1024
  s_nop 0
  buffer_load_dwordx4 v75, s[12:15], s36 offen  lds
  s_add_u32 m0, m0, 1024
  s_nop 0
  buffer_load_dwordx4 v76, s[12:15], s36 offen  lds
  s_add_u32 m0, m0, 1024
  s_nop 0
  buffer_load_dwordx4 v77, s[12:15], s36 offen  lds
  v_add_u32 v80, 98304, v78
  ds_read_b64_tr_b16 a[48:49], v80 offset:0
  ds_read_b64_tr_b16 a[50:51], v80 offset:768
  ds_read_b64_tr_b16 a[52:53], v80 offset:6144
  ds_read_b64_tr_b16 a[54:55], v80 offset:6912
  ds_read_b64_tr_b16 a[56:57], v80 offset:32
  ds_read_b64_tr_b16 a[58:59], v80 offset:800
  ds_read_b64_tr_b16 a[60:61], v80 offset:6176
  ds_read_b64_tr_b16 a[62:63], v80 offset:6944
  ds_read_b64_tr_b16 a[64:65], v80 offset:64
  ds_read_b64_tr_b16 a[66:67], v80 offset:832
  ds_read_b64_tr_b16 a[68:69], v80 offset:6208
  ds_read_b64_tr_b16 a[70:71], v80 offset:6976
  s_waitcnt lgkmcnt(4)
  s_waitcnt lgkmcnt(0)
  s_cmp_eq_u32 s81, 0
  s_cbranch_scc1 C_w_86a
  s_waitcnt vmcnt(15)
  s_branch C_w_86b
C_w_86a:
  s_waitcnt vmcnt(12)
C_w_86b:
  s_barrier
  s_add_u32 m0, s35, 49152
  s_add_u32 s36, s34, 4718592
  buffer_load_dwordx4 v72, s[12:15], s36 offen  lds
  s_add_u32 m0, m0, 1024
  s_nop 0
  buffer_load_dwordx4 v73, s[12:15], s36 offen  lds
  s_add_u32 m0, m0, 1024
  s_nop 0
  buffer_load_dwordx4 v74, s[12:15], s36 offen  lds
  s_add_u32 m0, m0, 1024
  s_nop 0
  buffer_load_dwordx4 v75, s[12:15], s36 offen  lds
  s_add_u32 m0, m0, 1024
  s_nop 0
  buffer_load_dwordx4 v76, s[12:15], s36 offen  lds
  s_add_u32 m0, m0, 1024
  s_nop 0
  buffer_load_dwordx4 v77, s[12:15], s36 offen  lds
  v_add_u32 v80, 122880, v78
  ds_read_b64_tr_b16 a[72:73], v80 offset:0
  ds_read_b64_tr_b16 a[74:75], v80 offset:768
  ds_read_b64_tr_b16 a[76:77], v80 offset:6144
  ds_read_b64_tr_b16 a[78:79], v80 offset:6912
  ds_read_b64_tr_b16 a[80:81], v80 offset:32
  ds_read_b64_tr_b16 a[82:83], v80 offset:800
  ds_read_b64_tr_b16 a[84:85], v80 offset:6176
  ds_read_b64_tr_b16 a[86:87], v80 offset:6944
  ds_read_b64_tr_b16 a[88:89], v80 offset:64
  ds_read_b64_tr_b16 a[90:91], v80 offset:832
  ds_read_b64_tr_b16 a[92:93], v80 offset:6208
  ds_read_b64_tr_b16 a[94:95], v80 offset:6976
  s_waitcnt lgkmcnt(4)
  s_waitcnt lgkmcnt(0)
  s_waitcnt vmcnt(12)
  s_barrier
  s_cmp_eq_u32 s81, 0
  s_cbranch_scc1 C_ar_87x
  s_cmp_lg_u32 s24, 1
  s_cbranch_scc1 C_ar_87
  v_mov_b32 v5, 1
  s_mov_b64 exec, 1
  buffer_atomic_add v5, off, s[4:7], 0 offset:32 sc1
  s_mov_b64 exec, -1
C_ar_87:
C_ar_87x:
  s_add_u32 m0, s35, 73728
  s_add_u32 s36, s34, 5505024
  buffer_load_dwordx4 v72, s[12:15], s36 offen  lds
  s_add_u32 m0, m0, 1024
  s_nop 0
  buffer_load_dwordx4 v73, s[12:15], s36 offen  lds
  s_add_u32 m0, m0, 1024
  s_nop 0
  buffer_load_dwordx4 v74, s[12:15], s36 offen  lds
  s_add_u32 m0, m0, 1024
  s_nop 0
  buffer_load_dwordx4 v75, s[12:15], s36 offen  lds
  s_add_u32 m0, m0, 1024
  s_nop 0
  buffer_load_dwordx4 v76, s[12:15], s36 offen  lds
  s_add_u32 m0, m0, 1024
  s_nop 0
  buffer_load_dwordx4 v77, s[12:15], s36 offen  lds
  v_add_u32 v80, 0, v78
  ds_read_b64_tr_b16 a[96:97], v80 offset:0
  ds_read_b64_tr_b16 a[98:99], v80 offset:768
  ds_read_b64_tr_b16 a[100:101], v80 offset:6144
  ds_read_b64_tr_b16 a[102:103], v80 offset:6912
  ds_read_b64_tr_b16 a[104:105], v80 offset:32
  ds_read_b64_tr_b16 a[106:107], v80 offset:800
  ds_read_b64_tr_b16 a[108:109], v80 offset:6176
  ds_read_b64_tr_b16 a[110:111], v80 offset:6944
  ds_read_b64_tr_b16 a[112:113], v80 offset:64
  ds_read_b64_tr_b16 a[114:115], v80 offset:832
  ds_read_b64_tr_b16 a[116:117], v80 offset:6208
  ds_read_b64_tr_b16 a[118:119], v80 offset:6976
  s_waitcnt lgkmcnt(4)
  s_waitcnt lgkmcnt(0)
  s_waitcnt vmcnt(12)
  s_barrier
  s_add_u32 m0, s37, 98304
  s_add_u32 s36, s38, 0
  buffer_load_dwordx4 v81, s[16:19], s36 offen  lds
  s_add_u32 m0, m0, 1024
  s_add_u32 s36, s36, 1024
  buffer_load_dwordx4 v81, s[16:19], s36 offen  lds
  s_add_u32 m0, m0, 1024
  s_add_u32 s36, s36, 1024
  buffer_load_dwordx4 v81, s[16:19], s36 offen  lds
  s_add_u32 m0, m0, 1024
  s_add_u32 s36, s36, 1024
  buffer_load_dwordx4 v81, s[16:19], s36 offen  lds
  s_add_u32 m0, m0, 1024
  s_add_u32 s36, s36, 1024
  buffer_load_dwordx4 v81, s[16:19], s36 offen  lds
  v_add_u32 v80, 24576, v78
  ds_read_b64_tr_b16 a[120:121], v80 offset:0
  ds_read_b64_tr_b16 a[122:123], v80 offset:768
  ds_read_b64_tr_b16 a[124:125], v80 offset:6144
  ds_read_b64_tr_b16 a[126:127], v80 offset:6912
  ds_read_b64_tr_b16 a[128:129], v80 offset:32
  ds_read_b64_tr_b16 a[130:131], v80 offset:800
  ds_read_b64_tr_b16 a[132:133], v80 offset:6176
  ds_read_b64_tr_b16 a[134:135], v80 offset:6944
  ds_read_b64_tr_b16 a[136:137], v80 offset:64
  ds_read_b64_tr_b16 a[138:139], v80 offset:832
  ds_read_b64_tr_b16 a[140:141], v80 offset:6208
  ds_read_b64_tr_b16 a[142:143], v80 offset:6976
  s_waitcnt lgkmcnt(4)
  s_waitcnt lgkmcnt(0)
  s_waitcnt vmcnt(11)
  s_barrier
  s_nop 0
  s_add_u32 m0, s37, 122880
  s_add_u32 s36, s38, 20480
  buffer_load_dwordx4 v81, s[16:19], s36 offen  lds
  s_add_u32 m0, m0, 1024
  s_add_u32 s36, s36, 1024
  buffer_load_dwordx4 v81, s[16:19], s36 offen  lds
  s_add_u32 m0, m0, 1024
  s_add_u32 s36, s36, 1024
  buffer_load_dwordx4 v81, s[16:19], s36 offen  lds
  s_add_u32 m0, m0, 1024
  s_add_u32 s36, s36, 1024
  buffer_load_dwordx4 v81, s[16:19], s36 offen  lds
  s_add_u32 m0, m0, 1024
  s_add_u32 s36, s36, 1024
  buffer_load_dwordx4 v81, s[16:19], s36 offen  lds
  v_add_u32 v80, 49152, v78
  ds_read_b64_tr_b16 a[144:145], v80 offset:0
  ds_read_b64_tr_b16 a[146:147], v80 offset:768
  ds_read_b64_tr_b16 a[148:149], v80 offset:6144
  ds_read_b64_tr_b16 a[150:151], v80 offset:6912
  ds_read_b64_tr_b16 a[152:153], v80 offset:32
  ds_read_b64_tr_b16 a[154:155], v80 offset:800
  ds_read_b64_tr_b16 a[156:157], v80 offset:6176
  ds_read_b64_tr_b16 a[158:159], v80 offset:6944
  ds_read_b64_tr_b16 a[160:161], v80 offset:64
  ds_read_b64_tr_b16 a[162:163], v80 offset:832
  ds_read_b64_tr_b16 a[164:165], v80 offset:6208
  ds_read_b64_tr_b16 a[166:167], v80 offset:6976
  s_waitcnt lgkmcnt(4)
  s_waitcnt lgkmcnt(0)
  s_waitcnt vmcnt(10)
  s_barrier
  s_add_u32 m0, s37, 0
  s_add_u32 s36, s38, 40960
  buffer_load_dwordx4 v81, s[16:19], s36 offen  lds
  s_add_u32 m0, m0, 1024
  s_add_u32 s36, s36, 1024
  buffer_load_dwordx4 v81, s[16:19], s36 offen  lds
  s_add_u32 m0, m0, 1024
  s_add_u32 s36, s36, 1024
  buffer_load_dwordx4 v81, s[16:19], s36 offen  lds
  s_add_u32 m0, m0, 1024
  s_add_u32 s36, s36, 1024
  buffer_load_dwordx4 v81, s[16:19], s36 offen  lds
  s_add_u32 m0, m0, 1024
  s_add_u32 s36, s36, 1024
  buffer_load_dwordx4 v81, s[16:19], s36 offen  lds
  v_add_u32 v80, 73728, v78
  ds_read_b64_tr_b16 a[168:169], v80 offset:0
  ds_read_b64_tr_b16 a[170:171], v80 offset:768
  ds_read_b64_tr_b16 a[172:173], v80 offset:6144
  ds_read_b64_tr_b16 a[174:175], v80 offset:6912
  ds_read_b64_tr_b16 a[176:177], v80 offset:32
  ds_read_b64_tr_b16 a[178:179], v80 offset:800
  ds_read_b64_tr_b16 a[180:181], v80 offset:6176
  ds_read_b64_tr_b16 a[182:183], v80 offset:6944
  ds_read_b64_tr_b16 a[184:185], v80 offset:64
  ds_read_b64_tr_b16 a[186:187], v80 offset:832
  ds_read_b64_tr_b16 a[188:189], v80 offset:6208
  ds_read_b64_tr_b16 a[190:191], v80 offset:6976
  s_waitcnt lgkmcnt(4)
  s_waitcnt lgkmcnt(0)
  s_waitcnt vmcnt(10)
  s_barrier
  s_add_u32 m0, s37, 24576
  s_add_u32 s36, s38, 61440
  buffer_load_dwordx4 v81, s[16:19], s36 offen  lds
  s_add_u32 m0, m0, 1024
  s_add_u32 s36, s36, 1024
  buffer_load_dwordx4 v81, s[16:19], s36 offen  lds
  s_add_u32 m0, m0, 1024
  s_add_u32 s36, s36, 1024
  buffer_load_dwordx4 v81, s[16:19], s36 offen  lds
  s_add_u32 m0, m0, 1024
  s_add_u32 s36, s36, 1024
  buffer_load_dwordx4 v81, s[16:19], s36 offen  lds
  s_add_u32 m0, m0, 1024
  s_add_u32 s36, s36, 1024
  buffer_load_dwordx4 v81, s[16:19], s36 offen  lds
  v_add_u32 v80, 98304, v79
  ds_read_b64_tr_b16 a[192:193], v80 offset:0
  ds_read_b64_tr_b16 a[194:195], v80 offset:2560
  ds_read_b64_tr_b16 a[200:201], v80 offset:64
  ds_read_b64_tr_b16 a[202:203], v80 offset:2624
  ds_read_b64_tr_b16 a[208:209], v80 offset:128
  ds_read_b64_tr_b16 a[210:211], v80 offset:2688
  ds_read_b64_tr_b16 a[216:217], v80 offset:192
  ds_read_b64_tr_b16 a[218:219], v80 offset:2752
  ds_read_b64_tr_b16 a[224:225], v80 offset:256
  ds_read_b64_tr_b16 a[226:227], v80 offset:2816
  s_waitcnt lgkmcnt(0)
  s_waitcnt vmcnt(10)
  s_barrier
  s_add_u32 m0, s37, 49152
  s_add_u32 s36, s38, 81920
  buffer_load_dwordx4 v81, s[16:19], s36 offen  lds
  s_add_u32 m0, m0, 1024
  s_add_u32 s36, s36, 1024
  buffer_load_dwordx4 v81, s[16:19], s36 offen  lds
  s_add_u32 m0, m0, 1024
  s_add_u32 s36, s36, 1024
  buffer_load_dwordx4 v81, s[16:19], s36 offen  lds
  s_add_u32 m0, m0, 1024
  s_add_u32 s36, s36, 1024
  buffer_load_dwordx4 v81, s[16:19], s36 offen  lds
  s_add_u32 m0, m0, 1024
  s_add_u32 s36, s36, 1024
  buffer_load_dwordx4 v81, s[16:19], s36 offen  lds
  v_add_u32 v80, 122880, v79
  ds_read_b64_tr_b16 a[196:197], v80 offset:0
  ds_read_b64_tr_b16 a[198:199], v80 offset:2560
  ds_read_b64_tr_b16 a[204:205], v80 offset:64
  ds_read_b64_tr_b16 a[206:207], v80 offset:2624
  ds_read_b64_tr_b16 a[212:213], v80 offset:128
  ds_read_b64_tr_b16 a[214:215], v80 offset:2688
  ds_read_b64_tr_b16 a[220:221], v80 offset:192
  ds_read_b64_tr_b16 a[222:223], v80 offset:2752
  ds_read_b64_tr_b16 a[228:229], v80 offset:256
  ds_read_b64_tr_b16 a[230:231], v80 offset:2816
  s_waitcnt lgkmcnt(0)
  s_waitcnt vmcnt(10)
  s_barrier
  s_add_u32 m0, s37, 73728
  s_add_u32 s36, s38, 102400
  buffer_load_dwordx4 v81, s[16:19], s36 offen  lds
  s_add_u32 m0, m0, 1024
  s_add_u32 s36, s36, 1024
  buffer_load_dwordx4 v81, s[16:19], s36 offen  lds
  s_add_u32 m0, m0, 1024
  s_add_u32 s36, s36, 1024
  buffer_load_dwordx4 v81, s[16:19], s36 offen  lds
  s_add_u32 m0, m0, 1024
  s_add_u32 s36, s36, 1024
  buffer_load_dwordx4 v81, s[16:19], s36 offen  lds
  s_add_u32 m0, m0, 1024
  s_add_u32 s36, s36, 1024
  buffer_load_dwordx4 v81, s[16:19], s36 offen  lds
  v_add_u32 v80, 0, v79
  ds_read_b64_tr_b16 a[232:233], v80 offset:0
  ds_read_b64_tr_b16 a[234:235], v80 offset:2560
  ds_read_b64_tr_b16 a[240:241], v80 offset:64
  ds_read_b64_tr_b16 a[242:243], v80 offset:2624
  ds_read_b64_tr_b16 a[248:249], v80 offset:128
  ds_read_b64_tr_b16 a[250:251], v80 offset:2688
  ds_read_b64_tr_b16 v[160:161], v80 offset:192
  ds_read_b64_tr_b16 v[162:163], v80 offset:2752
  ds_read_b64_tr_b16 v[168:169], v80 offset:256
  ds_read_b64_tr_b16 v[170:171], v80 offset:2816
  s_waitcnt lgkmcnt(0)
  s_waitcnt vmcnt(10)
  s_barrier
  s_add_u32 m0, s37, 98304
  s_add_u32 s36, s38, 122880
  buffer_load_dwordx4 v81, s[16:19], s36 offen  lds
  s_add_u32 m0, m0, 1024
  s_add_u32 s36, s36, 1024
  buffer_load_dwordx4 v81, s[16:19], s36 offen  lds
  s_add_u32 m0, m0, 1024
  s_add_u32 s36, s36, 1024
  buffer_load_dwordx4 v81, s[16:19], s36 offen  lds
  s_add_u32 m0, m0, 1024
  s_add_u32 s36, s36, 1024
  buffer_load_dwordx4 v81, s[16:19], s36 offen  lds
  s_add_u32 m0, m0, 1024
  s_add_u32 s36, s36, 1024
  buffer_load_dwordx4 v81, s[16:19], s36 offen  lds
  v_add_u32 v80, 24576, v79
  ds_read_b64_tr_b16 a[236:237], v80 offset:0
  ds_read_b64_tr_b16 a[238:239], v80 offset:2560
  ds_read_b64_tr_b16 a[244:245], v80 offset:64
  ds_read_b64_tr_b16 a[246:247], v80 offset:2624
  ds_read_b64_tr_b16 a[252:253], v80 offset:128
  ds_read_b64_tr_b16 a[254:255], v80 offset:2688
  ds_read_b64_tr_b16 v[164:165], v80 offset:192
  ds_read_b64_tr_b16 v[166:167], v80 offset:2752
  ds_read_b64_tr_b16 v[172:173], v80 offset:256
  ds_read_b64_tr_b16 v[174:175], v80 offset:2816
  s_waitcnt lgkmcnt(0)
  s_waitcnt vmcnt(10)
  s_barrier
  s_add_u32 m0, s37, 122880
  s_add_u32 s36, s38, 143360
  buffer_load_dwordx4 v81, s[16:19], s36 offen  lds
  s_add_u32 m0, m0, 1024
  s_add_u32 s36, s36, 1024
  buffer_load_dwordx4 v81, s[16:19], s36 offen  lds
  s_add_u32 m0, m0, 1024
  s_add_u32 s36, s36, 1024
  buffer_load_dwordx4 v81, s[16:19], s36 offen  lds
  s_add_u32 m0, m0, 1024
  s_add_u32 s36, s36, 1024
  buffer_load_dwordx4 v81, s[16:19], s36 offen  lds
  s_add_u32 m0, m0, 1024
  s_add_u32 s36, s36, 1024
  buffer_load_dwordx4 v81, s[16:19], s36 offen  lds
  v_add_u32 v80, 49152, v79
  ds_read_b64_tr_b16 v[176:177], v80 offset:0
  ds_read_b64_tr_b16 v[178:179], v80 offset:2560
  ds_read_b64_tr_b16 v[184:185], v80 offset:64
  ds_read_b64_tr_b16 v[186:187], v80 offset:2624
  ds_read_b64_tr_b16 v[192:193], v80 offset:128
  ds_read_b64_tr_b16 v[194:195], v80 offset:2688
  ds_read_b64_tr_b16 v[200:201], v80 offset:192
  ds_read_b64_tr_b16 v[202:203], v80 offset:2752
  ds_read_b64_tr_b16 v[208:209], v80 offset:256
  ds_read_b64_tr_b16 v[210:211], v80 offset:2816
  s_waitcnt lgkmcnt(0)
  s_waitcnt vmcnt(10)
  s_barrier
  s_nop 0
  s_add_u32 m0, s35, 0
  s_add_u32 s36, s34, 6291456
  buffer_load_dwordx4 v72, s[12:15], s36 offen  lds
  s_add_u32 m0, m0, 1024
  s_nop 0
  buffer_load_dwordx4 v73, s[12:15], s36 offen  lds
  s_add_u32 m0, m0, 1024
  s_nop 0
  buffer_load_dwordx4 v74, s[12:15], s36 offen  lds
  s_add_u32 m0, m0, 1024
  s_nop 0
  buffer_load_dwordx4 v75, s[12:15], s36 offen  lds
  s_add_u32 m0, m0, 1024
  s_nop 0
  buffer_load_dwordx4 v76, s[12:15], s36 offen  lds
  s_add_u32 m0, m0, 1024
  s_nop 0
  buffer_load_dwordx4 v77, s[12:15], s36 offen  lds
  v_add_u32 v80, 73728, v79
  ds_read_b64_tr_b16 v[180:181], v80 offset:0
  ds_read_b64_tr_b16 v[182:183], v80 offset:2560
  ds_read_b64_tr_b16 v[188:189], v80 offset:64
  ds_read_b64_tr_b16 v[190:191], v80 offset:2624
  ds_read_b64_tr_b16 v[196:197], v80 offset:128
  ds_read_b64_tr_b16 v[198:199], v80 offset:2688
  ds_read_b64_tr_b16 v[204:205], v80 offset:192
  ds_read_b64_tr_b16 v[206:207], v80 offset:2752
  ds_read_b64_tr_b16 v[212:213], v80 offset:256
  ds_read_b64_tr_b16 v[214:215], v80 offset:2816
  s_waitcnt lgkmcnt(0)
  s_waitcnt vmcnt(11)
  s_barrier
  s_add_u32 m0, s35, 24576
  s_add_u32 s36, s34, 7077888
  buffer_load_dwordx4 v72, s[12:15], s36 offen  lds
  s_add_u32 m0, m0, 1024
  s_nop 0
  buffer_load_dwordx4 v73, s[12:15], s36 offen  lds
  s_add_u32 m0, m0, 1024
  s_nop 0
  buffer_load_dwordx4 v74, s[12:15], s36 offen  lds
  s_add_u32 m0, m0, 1024
  s_nop 0
  buffer_load_dwordx4 v75, s[12:15], s36 offen  lds
  s_add_u32 m0, m0, 1024
  s_nop 0
  buffer_load_dwordx4 v76, s[12:15], s36 offen  lds
  s_add_u32 m0, m0, 1024
  s_nop 0
  buffer_load_dwordx4 v77, s[12:15], s36 offen  lds
  v_add_u32 v80, 98304, v79
  ds_read_b64_tr_b16 v[216:217], v80 offset:0
  ds_read_b64_tr_b16 v[218:219], v80 offset:2560
  ds_read_b64_tr_b16 v[224:225], v80 offset:64
  ds_read_b64_tr_b16 v[226:227], v80 offset:2624
  ds_read_b64_tr_b16 v[232:233], v80 offset:128
  ds_read_b64_tr_b16 v[234:235], v80 offset:2688
  ds_read_b64_tr_b16 v[240:241], v80 offset:192
  ds_read_b64_tr_b16 v[242:243], v80 offset:2752
  ds_read_b64_tr_b16 v[248:249], v80 offset:256
  ds_read_b64_tr_b16 v[250:251], v80 offset:2816
  s_waitcnt lgkmcnt(0)
  s_waitcnt vmcnt(12)
  s_barrier
  s_add_u32 m0, s37, 49152
  s_add_u32 s36, s38, 163840
  buffer_load_dwordx4 v81, s[16:19], s36 offen  lds
  s_add_u32 m0, m0, 1024
  s_add_u32 s36, s36, 1024
  buffer_load_dwordx4 v81, s[16:19], s36 offen  lds
  s_add_u32 m0, m0, 1024
  s_add_u32 s36, s36, 1024
  buffer_load_dwordx4 v81, s[16:19], s36 offen  lds
  s_add_u32 m0, m0, 1024
  s_add_u32 s36, s36, 1024
  buffer_load_dwordx4 v81, s[16:19], s36 offen  lds
  s_add_u32 m0, m0, 1024
  s_add_u32 s36, s36, 1024
  buffer_load_dwordx4 v81, s[16:19], s36 offen  lds
  v_add_u32 v80, 122880, v79
  ds_read_b64_tr_b16 v[220:221], v80 offset:0
  ds_read_b64_tr_b16 v[222:223], v80 offset:2560
  ds_read_b64_tr_b16 v[228:229], v80 offset:64
  ds_read_b64_tr_b16 v[230:231], v80 offset:2624
  ds_read_b64_tr_b16 v[236:237], v80 offset:128
  ds_read_b64_tr_b16 v[238:239], v80 offset:2688
  ds_read_b64_tr_b16 v[244:245], v80 offset:192
  ds_read_b64_tr_b16 v[246:247], v80 offset:2752
  ds_read_b64_tr_b16 v[252:253], v80 offset:256
  ds_read_b64_tr_b16 v[254:255], v80 offset:2816
  s_waitcnt lgkmcnt(0)
  s_waitcnt vmcnt(11)
  s_barrier
  s_add_u32 m0, s37, 69632
  s_add_u32 s36, s38, 184320
  buffer_load_dwordx4 v81, s[16:19], s36 offen  lds
  s_add_u32 m0, m0, 1024
  s_add_u32 s36, s36, 1024
  buffer_load_dwordx4 v81, s[16:19], s36 offen  lds
  s_add_u32 m0, m0, 1024
  s_add_u32 s36, s36, 1024
  buffer_load_dwordx4 v81, s[16:19], s36 offen  lds
  s_add_u32 m0, m0, 1024
  s_add_u32 s36, s36, 1024
  buffer_load_dwordx4 v81, s[16:19], s36 offen  lds
  s_add_u32 m0, m0, 1024
  s_add_u32 s36, s36, 1024
  buffer_load_dwordx4 v81, s[16:19], s36 offen  lds
  v_add_u32 v80, 0, v78
  ds_read_b64_tr_b16 v[120:121], v80 offset:0
  ds_read_b64_tr_b16 v[122:123], v80 offset:768
  ds_read_b64_tr_b16 v[124:125], v80 offset:6144
  ds_read_b64_tr_b16 v[126:127], v80 offset:6912
  ds_read_b64_tr_b16 v[128:129], v80 offset:32
  ds_read_b64_tr_b16 v[130:131], v80 offset:800
  ds_read_b64_tr_b16 v[132:133], v80 offset:6176
  ds_read_b64_tr_b16 v[134:135], v80 offset:6944
  ds_read_b64_tr_b16 v[136:137], v80 offset:64
  ds_read_b64_tr_b16 v[138:139], v80 offset:832
  ds_read_b64_tr_b16 v[140:141], v80 offset:6208
  ds_read_b64_tr_b16 v[142:143], v80 offset:6976
  s_waitcnt lgkmcnt(4)
  s_waitcnt lgkmcnt(0)
  s_barrier
  ds_write_b128 v6, v[120:123] offset:0
  ds_write_b128 v6, v[124:127] offset:1024
  ds_write_b128 v6, v[128:131] offset:2048
  ds_write_b128 v6, v[132:135] offset:3072
  ds_write_b128 v6, v[136:139] offset:4096
  ds_write_b128 v6, v[140:143] offset:5120
  s_waitcnt lgkmcnt(0)
  s_waitcnt vmcnt(10)
  s_barrier
  s_add_u32 m0, s37, 90112
  s_add_u32 s36, s38, 204800
  buffer_load_dwordx4 v81, s[16:19], s36 offen  lds
  s_add_u32 m0, m0, 1024
  s_add_u32 s36, s36, 1024
  buffer_load_dwordx4 v81, s[16:19], s36 offen  lds
  s_add_u32 m0, m0, 1024
  s_add_u32 s36, s36, 1024
  buffer_load_dwordx4 v81, s[16:19], s36 offen  lds
  s_add_u32 m0, m0, 1024
  s_add_u32 s36, s36, 1024
  buffer_load_dwordx4 v81, s[16:19], s36 offen  lds
  s_add_u32 m0, m0, 1024
  s_add_u32 s36, s36, 1024
  buffer_load_dwordx4 v81, s[16:19], s36 offen  lds
  v_add_u32 v80, 24576, v78
  ds_read_b64_tr_b16 v[120:121], v80 offset:0
  ds_read_b64_tr_b16 v[122:123], v80 offset:768
  ds_read_b64_tr_b16 v[124:125], v80 offset:6144
  ds_read_b64_tr_b16 v[126:127], v80 offset:6912
  ds_read_b64_tr_b16 v[128:129], v80 offset:32
  ds_read_b64_tr_b16 v[130:131], v80 offset:800
  ds_read_b64_tr_b16 v[132:133], v80 offset:6176
  ds_read_b64_tr_b16 v[134:135], v80 offset:6944
  ds_read_b64_tr_b16 v[136:137], v80 offset:64
  ds_read_b64_tr_b16 v[138:139], v80 offset:832
  ds_read_b64_tr_b16 v[140:141], v80 offset:6208
  ds_read_b64_tr_b16 v[142:143], v80 offset:6976
  s_waitcnt lgkmcnt(4)
  s_waitcnt lgkmcnt(0)
  s_barrier
  ds_write_b128 v6, v[120:123] offset:24576
  ds_write_b128 v6, v[124:127] offset:25600
  ds_write_b128 v6, v[128:131] offset:26624
  ds_write_b128 v6, v[132:135] offset:27648
  ds_write_b128 v6, v[136:139] offset:28672
  ds_write_b128 v6, v[140:143] offset:29696
  s_waitcnt lgkmcnt(0)
  s_waitcnt vmcnt(10)
  s_barrier
  s_add_u32 m0, s37, 110592
  s_add_u32 s36, s38, 225280
  buffer_load_dwordx4 v81, s[16:19], s36 offen  lds
  s_add_u32 m0, m0, 1024
  s_add_u32 s36, s36, 1024
  buffer_load_dwordx4 v81, s[16:19], s36 offen  lds
  s_add_u32 m0, m0, 1024
  s_add_u32 s36, s36, 1024
  buffer_load_dwordx4 v81, s[16:19], s36 offen  lds
  s_add_u32 m0, m0, 1024
  s_add_u32 s36, s36, 1024
  buffer_load_dwordx4 v81, s[16:19], s36 offen  lds
  s_add_u32 m0, m0, 1024
  s_add_u32 s36, s36, 1024
  buffer_load_dwordx4 v81, s[16:19], s36 offen  lds
  v_add_u32 v80, 49152, v79
  ds_read_b64_tr_b16 v[120:121], v80 offset:0
  ds_read_b64_tr_b16 v[122:123], v80 offset:2560
  ds_read_b64_tr_b16 v[124:125], v80 offset:64
  ds_read_b64_tr_b16 v[126:127], v80 offset:2624
  ds_read_b64_tr_b16 v[128:129], v80 offset:128
  ds_read_b64_tr_b16 v[130:131], v80 offset:2688
  ds_read_b64_tr_b16 v[132:133], v80 offset:192
  ds_read_b64_tr_b16 v[134:135], v80 offset:2752
  ds_read_b64_tr_b16 v[136:137], v80 offset:256
  ds_read_b64_tr_b16 v[138:139], v80 offset:2816
  s_waitcnt lgkmcnt(0)
  s_barrier
  v_add_u32 v2, 49152, v81
  ds_write_b128 v2, v[120:123] offset:0
  ds_write_b128 v2, v[124:127] offset:1024
  ds_write_b128 v2, v[128:131] offset:2048
  ds_write_b128 v2, v[132:135] offset:3072
  ds_write_b128 v2, v[136:139] offset:4096
  s_waitcnt lgkmcnt(0)
  s_waitcnt vmcnt(10)
  s_barrier
  v_add_u32 v80, 69632, v79
  ds_read_b64_tr_b16 v[120:121], v80 offset:0
  ds_read_b64_tr_b16 v[122:123], v80 offset:2560
  ds_read_b64_tr_b16 v[124:125], v80 offset:64
  ds_read_b64_tr_b16 v[126:127], v80 offset:2624
  ds_read_b64_tr_b16 v[128:129], v80 offset:128
  ds_read_b64_tr_b16 v[130:131], v80 offset:2688
  ds_read_b64_tr_b16 v[132:133], v80 offset:192
  ds_read_b64_tr_b16 v[134:135], v80 offset:2752
  ds_read_b64_tr_b16 v[136:137], v80 offset:256
  ds_read_b64_tr_b16 v[138:139], v80 offset:2816
  s_waitcnt lgkmcnt(0)
  s_barrier
  v_add_u32 v2, 69632, v81
  ds_write_b128 v2, v[120:123] offset:0
  ds_write_b128 v2, v[124:127] offset:1024
  ds_write_b128 v2, v[128:131] offset:2048
  ds_write_b128 v2, v[132:135] offset:3072
  ds_write_b128 v2, v[136:139] offset:4096
  s_waitcnt lgkmcnt(0)
  s_waitcnt vmcnt(5)
  s_barrier
  v_min_u32 v59, 9, v1
  v_and_b32 v58, 1, v59
  v_lshlrev_b32 v58, 7, v58
  v_lshl_add_u32 v58, v59, 2, v58
  v_cmp_eq_u32 vcc, 9, v59
  v_mov_b32 v57, 64
  s_nop 0
  v_cndmask_b32 v59, v58, v57, vcc
  buffer_load_dword v58, v59, s[4:7], 0 offen sc1
  v_add_u32 v80, 90112, v79
  ds_read_b64_tr_b16 v[120:121], v80 offset:0
  ds_read_b64_tr_b16 v[122:123], v80 offset:2560
  ds_read_b64_tr_b16 v[124:125], v80 offset:64
  ds_read_b64_tr_b16 v[126:127], v80 offset:2624
  ds_read_b64_tr_b16 v[128:129], v80 offset:128
  ds_read_b64_tr_b16 v[130:131], v80 offset:2688
  ds_read_b64_tr_b16 v[132:133], v80 offset:192
  ds_read_b64_tr_b16 v[134:135], v80 offset:2752
  ds_read_b64_tr_b16 v[136:137], v80 offset:256
  ds_read_b64_tr_b16 v[138:139], v80 offset:2816
  s_waitcnt lgkmcnt(0)
  s_barrier
  v_add_u32 v2, 90112, v81
  ds_write_b128 v2, v[120:123] offset:0
  ds_write_b128 v2, v[124:127] offset:1024
  ds_write_b128 v2, v[128:131] offset:2048
  ds_write_b128 v2, v[132:135] offset:3072
  ds_write_b128 v2, v[136:139] offset:4096
  s_waitcnt lgkmcnt(0)
  s_waitcnt vmcnt(0)
  s_barrier
  v_add_u32 v80, 110592, v79
  ds_read_b64_tr_b16 v[120:121], v80 offset:0
  ds_read_b64_tr_b16 v[122:123], v80 offset:2560
  ds_read_b64_tr_b16 v[124:125], v80 offset:64
  ds_read_b64_tr_b16 v[126:127], v80 offset:2624
  ds_read_b64_tr_b16 v[128:129], v80 offset:128
  ds_read_b64_tr_b16 v[130:131], v80 offset:2688
  ds_read_b64_tr_b16 v[132:133], v80 offset:192
  ds_read_b64_tr_b16 v[134:135], v80 offset:2752
  ds_read_b64_tr_b16 v[136:137], v80 offset:256
  ds_read_b64_tr_b16 v[138:139], v80 offset:2816
  s_waitcnt lgkmcnt(0)
  s_barrier
  v_add_u32 v2, 110592, v81
  ds_write_b128 v2, v[120:123] offset:0
  ds_write_b128 v2, v[124:127] offset:1024
  ds_write_b128 v2, v[128:131] offset:2048
  ds_write_b128 v2, v[132:135] offset:3072
  ds_write_b128 v2, v[136:139] offset:4096
  s_waitcnt lgkmcnt(0)
  s_barrier
  s_nop 0
  s_branch C_cw_88c
C_cw_88:
  s_sleep 4
  buffer_load_dword v58, v59, s[4:7], 0 offen sc1
  s_sub_u32 s82, s82, 1
  s_cbranch_scc1 L_abort
C_cw_88c:
  s_waitcnt vmcnt(0)
  v_readlane_b32 s84, v58, 0
  v_readlane_b32 s85, v58, 1
  v_readlane_b32 s86, v58, 2
  v_readlane_b32 s87, v58, 3
  v_readlane_b32 s88, v58, 4
  v_readlane_b32 s89, v58, 5
  v_readlane_b32 s90, v58, 6
  v_readlane_b32 s91, v58, 7
  v_readlane_b32 s92, v58, 8
  v_readlane_b32 s93, v58, 9
  s_cmp_lg_u32 s92, 256
  s_cbranch_scc1 C_cw_88
  s_min_u32 s81, s84, s85
  s_and_b32 s30, s84, s85
  s_and_b32 s30, s30, s86
  s_and_b32 s30, s30, s87
  s_and_b32 s30, s30, s88
  s_and_b32 s30, s30, s89
  s_and_b32 s30, s30, s90
  s_and_b32 s30, s30, s91
  s_cmp_lg_u32 s30, 32
  s_cbranch_scc1 C_cw_88d
  s_cmp_eq_u32 s93, 0
  s_cbranch_scc1 C_cw_88
  s_and_b32 s30, s93, 0x6000
  s_or_b32 s47, s47, s30
C_cw_88d:
  v_add_u32 v2, 0, v0
  v_min_u32 v2, 639, v2
  v_and_b32 v3, 7, v2
  v_mul_u32_u24 v3, 1280, v3
  v_lshrrev_b32 v4, 3, v2
  v_lshl_add_u32 v3, v4, 4, v3
  buffer_load_dwordx4 v[32:35], v3, s[20:23], 0 offen
  v_lshlrev_b32 v44, 4, v2
  v_add_u32 v2, 256, v0
  v_min_u32 v2, 639, v2
  v_and_b32 v3, 7, v2
  v_mul_u32_u24 v3, 1280, v3
  v_lshrrev_b32 v4, 3, v2
  v_lshl_add_u32 v3, v4, 4, v3
  buffer_load_dwordx4 v[36:39], v3, s[20:23], 0 offen
  v_lshlrev_b32 v45, 4, v2
  v_add_u32 v2, 512, v0
  v_min_u32 v2, 639, v2
  v_and_b32 v3, 7, v2
  v_mul_u32_u24 v3, 1280, v3
  v_lshrrev_b32 v4, 3, v2
  v_lshl_add_u32 v3, v4, 4, v3
  buffer_load_dwordx4 v[40:43], v3, s[20:23], 0 offen
  v_lshlrev_b32 v46, 4, v2
  v_and_b32 v2, 8, v1
  v_cmp_eq_u32 vcc, 0, v2
  v_mov_b32 v3, 0xeeee
  v_mov_b32 v4, 0x4444
  v_cndmask_b32 v8, v3, v4, vcc
  v_and_b32 v2, 1, v1
  v_cmp_eq_u32 vcc, 0, v2
  s_nop 1
  v_cndmask_b32 v2, v3, v4, vcc
  v_lshl_or_b32 v8, v2, 16, v8
  v_lshrrev_b32 v2, 5, v1
  v_bfe_u32 v3, v1, 3, 1
  v_cmp_eq_u32 s[30:31], v2, v3
  v_and_b32 v2, 1, v1
  v_lshlrev_b32 v2, 4, v2
  v_mov_b32 v3, 0x3f80
  v_lshlrev_b32 v3, v2, v3
  v_bfe_u32 v4, v1, 1, 2
  v_cmp_eq_u32 vcc, 0, v4
  s_and_b64 vcc, vcc, s[30:31]
  v_cndmask_b32 v10, 0, v3, vcc
  v_cmp_eq_u32 vcc, 1, v4
  s_and_b64 vcc, vcc, s[30:31]
  v_cndmask_b32 v11, 0, v3, vcc
  v_cmp_eq_u32 vcc, 2, v4
  s_and_b64 vcc, vcc, s[30:31]
  v_cndmask_b32 v12, 0, v3, vcc
  v_cmp_eq_u32 vcc, 3, v4
  s_and_b64 vcc, vcc, s[30:31]
  v_cndmask_b32 v13, 0, v3, vcc
  v_lshrrev_b32 v2, 4, v1
  s_mul_i32 s30, s24, 16
  v_add_u32 v2, s30, v2
  v_lshlrev_b32 v2, 7, v2
  v_and_b32 v3, 7, v1
  v_lshl_add_u32 v2, v3, 4, v2
  v_bfe_u32 v3, v1, 3, 1
  v_lshl_add_u32 v2, v3, 3, v2
  v_add_u32 v15, 131072, v2
  v_bfe_u32 v2, v1, 4, 1
  v_lshlrev_b32 v2, 12, v2
  v_bfe_u32 v3, v1, 2, 2
  v_lshl_add_u32 v2, v3, 7, v2
  v_lshrrev_b32 v3, 5, v1
  v_lshl_add_u32 v2, v3, 6, v2
  v_and_b32 v3, 3, v1
  v_lshl_add_u32 v16, v3, 4, v2
  v_and_b32 v2, 15, v1
  v_mul_u32_u24 v17, 128, v2
  s_mul_i32 s30, s24, 4
  s_add_u32 s30, s30, 0
  s_lshr_b32 s31, s30, 3
  s_lshl_b32 s31, s31, 15
  s_and_b32 s30, s30, 7
  s_lshl_b32 s30, s30, 9
  s_add_u32 s40, s30, s31
  s_mul_i32 s30, s24, 4
  s_add_u32 s30, s30, 1
  s_lshr_b32 s31, s30, 3
  s_lshl_b32 s31, s31, 15
  s_and_b32 s30, s30, 7
  s_lshl_b32 s30, s30, 9
  s_add_u32 s41, s30, s31
  s_mul_i32 s30, s24, 4
  s_add_u32 s30, s30, 2
  s_lshr_b32 s31, s30, 3
  s_lshl_b32 s31, s31, 15
  s_and_b32 s30, s30, 7
  s_lshl_b32 s30, s30, 9
  s_add_u32 s42, s30, s31
  s_mul_i32 s30, s24, 4
  s_add_u32 s30, s30, 3
  s_lshr_b32 s31, s30, 3
  s_lshl_b32 s31, s31, 15
  s_and_b32 s30, s30, 7
  s_lshl_b32 s30, s30, 9
  s_add_u32 s43, s30, s31
  s_add_u32 s30, s24, 16
  s_lshr_b32 s31, s30, 3
  s_lshl_b32 s31, s31, 15
  s_and_b32 s30, s30, 7
  s_lshl_b32 s30, s30, 9
  s_add_u32 s44, s30, s31
  s_mul_i32 s46, s25, 1048576
  s_add_u32 s46, s46, 4194304
  s_add_u32 s45, s46, 16384
  s_mul_i32 s85, s24, 1536
  s_sub_u32 s85, 8192, s85
  v_lshrrev_b32 v2, 4, v1
  v_bfe_u32 v3, v1, 3, 1
  v_lshl_add_u32 v2, v3, 2, v2
  v_lshlrev_b32 v2, 7, v2
  v_and_b32 v3, 7, v1
  v_lshl_add_u32 v2, v3, 4, v2
  v_add_u32 v14, 131072, v2
  v_and_b32 v2, 15, v1
  v_lshlrev_b32 v2, 4, v2
  v_bfe_u32 v3, v1, 4, 1
  v_lshl_add_u32 v2, v3, 3, v2
  s_mul_i32 s30, s24, 768
  s_add_u32 s30, s30, 141312
  v_add_u32 v2, s30, v2
  v_add_u32 v19, 512, v2
  v_lshrrev_b32 v3, 5, v1
  v_mul_u32_u24 v3, 4096, v3
  v_add_u32 v19, v3, v19
  v_lshrrev_b32 v3, 5, v1
  v_lshl_add_u32 v18, v3, 8, v2
  v_lshrrev_b32 v2, 4, v1
  v_bfe_u32 v3, v1, 2, 2
  v_lshl_add_u32 v2, v2, 3, v3
  v_lshlrev_b32 v2, 4, v2
  v_and_b32 v3, 1, v1
  v_lshl_add_u32 v2, v3, 3, v2
  v_add_u32 v20, 141312, v2
  v_and_b32 v2, 15, v1
  v_lshrrev_b32 v3, 5, v1
  v_lshl_add_u32 v2, v3, 4, v2
  v_lshlrev_b32 v2, 4, v2
  v_bfe_u32 v3, v1, 4, 1
  v_lshl_add_u32 v2, v3, 3, v2
  s_mul_i32 s30, s24, 2560
  v_add_u32 v21, s30, v2
  v_lshrrev_b32 v2, 4, v1
  s_lshl_b32 s30, s24, 2
  v_add_u32 v2, s30, v2
  v_mul_u32_u24 v2, 10240, v2
  s_mul_i32 s30, s26, 640
  v_add_u32 v2, s30, v2
  v_and_b32 v3, 15, v1
  v_lshl_add_u32 v22, v3, 4, v2
  v_and_b32 v3, 7, v1
  v_add_u32 v3, 32, v3
  v_lshl_add_u32 v23, v3, 4, v2
  v_lshrrev_b32 v4, 4, v1
  v_lshlrev_b32 v4, 9, v4
  s_mul_i32 s30, s26, 40
  v_and_b32 v2, 15, v1
  v_add_u32 v2, 0, v2
  v_add_u32 v2, s30, v2
  v_lshrrev_b32 v3, 5, v2
  v_lshl_add_u32 v3, v3, 11, v4
  v_and_b32 v2, 31, v2
  v_lshl_add_u32 v24, v2, 4, v3
  v_and_b32 v2, 15, v1
  v_add_u32 v2, 16, v2
  v_add_u32 v2, s30, v2
  v_lshrrev_b32 v3, 5, v2
  v_lshl_add_u32 v3, v3, 11, v4
  v_and_b32 v2, 31, v2
  v_lshl_add_u32 v25, v2, 4, v3
  v_and_b32 v2, 7, v1
  v_add_u32 v2, 32, v2
  v_add_u32 v2, s30, v2
  v_lshrrev_b32 v3, 5, v2
  v_lshl_add_u32 v3, v3, 11, v4
  v_and_b32 v2, 31, v2
  v_lshl_add_u32 v26, v2, 4, v3
  s_mul_i32 s30, s24, 2560
  v_lshrrev_b32 v2, 5, v1
  v_mul_u32_u24 v2, 640, v2
  v_bfe_u32 v3, v1, 2, 2
  v_lshl_add_u32 v2, v3, 7, v2
  v_bfe_u32 v4, v1, 4, 1
  v_lshl_add_u32 v2, v4, 6, v2
  v_and_b32 v4, 3, v1
  v_lshl_add_u32 v2, v4, 4, v2
  v_add_u32 v27, s30, v2
  v_lshrrev_b32 v2, 4, v1
  v_mul_u32_u24 v2, 640, v2
  v_and_b32 v3, 15, v1
  v_lshl_add_u32 v2, v3, 3, v2
  v_add_u32 v2, 512, v2
  v_add_u32 v28, s30, v2
  s_mul_i32 s30, s24, 1536
  s_add_u32 s30, s30, 144384
  v_and_b32 v2, 15, v1
  v_lshlrev_b32 v2, 5, v2
  v_lshrrev_b32 v3, 5, v1
  v_bfe_u32 v4, v1, 2, 1
  v_xor_b32 v3, v3, v4
  v_lshl_add_u32 v2, v3, 4, v2
  v_bfe_u32 v3, v1, 4, 1
  v_lshl_add_u32 v2, v3, 3, v2
  v_add_u32 v29, s30, v2
  s_and_b32 s30, s24, 1
  s_lshl_b32 s31, s30, 4
  s_sub_u32 s31, 47, s31
  v_min_u32 v2, s31, v1
  v_lshrrev_b32 v3, 1, v2
  s_mul_i32 s30, s30, 24
  v_add_u32 v3, s30, v3
  v_and_b32 v2, 1, v2
  v_bfe_u32 v4, v3, 2, 1
  v_xor_b32 v4, v4, v2
  v_lshlrev_b32 v4, 4, v4
  v_lshl_add_u32 v4, v3, 5, v4
  v_add_u32 v30, 144384, v4
  s_mul_i32 s30, s26, 40
  v_add_u32 v3, s30, v3
  v_lshrrev_b32 v4, 8, v3
  v_lshlrev_b32 v4, 15, v4
  v_and_b32 v3, 255, v3
  v_lshl_add_u32 v4, v3, 4, v4
  v_lshl_add_u32 v4, v2, 3, v4
  s_lshl_b32 s30, s25, 12
  v_add_u32 v31, s30, v4
  s_add_u32 s32, s46, 65536
  s_mul_i32 s33, s26, 10240
  s_add_u32 s33, s33, s32
  s_lshl_b32 s30, s25, 4
  s_lshl_b32 s31, s24, 2
  s_add_u32 s30, s30, s31
  s_mul_i32 s38, s30, 40960
  s_add_u32 s38, s38, 58720256
  s_mul_i32 s54, s27, 10240
  s_add_u32 s54, s54, 142606336
  s_add_u32 s88, s46, 32768
  s_lshl_b32 s84, s26, 7
  s_add_u32 s84, s84, s45
  s_add_u32 s84, s84, 4096
  s_lshl_b32 s34, s27, 7
  s_add_u32 s34, s34, 6328320
  s_lshl_b32 s55, s25, 8
  s_add_u32 s55, s55, 6340608
  s_mul_i32 s35, s26, 128
  s_add_u32 s35, s35, s45
  s_mov_b32 s28, 0
  s_mov_b32 s29, 0
  s_mov_b32 s37, 0
  s_mov_b32 s91, 0
  v_and_b32 v2, 15, v1
  v_bfe_u32 v3, v1, 4, 1
  v_lshl_add_u32 v2, v3, 5, v2
  v_lshrrev_b32 v3, 5, v1
  v_lshl_add_u32 v2, v3, 4, v2
  v_lshlrev_b32 v2, 4, v2
  s_mul_i32 s30, s24, 2560
  v_add_u32 v9, s30, v2
  v_mov_b32 v104, -1
  v_mov_b32 v105, -1
  v_mov_b32 v106, -1
  v_mov_b32 v107, -1
  s_add_u32 s36, s32, 163840
  s_lshr_b32 s30, s28, 3
  s_lshl_b32 s30, s30, 9
  s_add_u32 s30, s30, s55
  v_mbcnt_lo_u32_b32 v3, -1, 0
  v_mbcnt_hi_u32_b32 v3, -1, v3
  v_and_b32 v2, 0, v3
  v_add_lshl_u32 v3, v3, v2, 2
VO_uf0:
  buffer_load_dword v2, v3, s[8:11], s30 offen sc1
  s_sub_u32 s82, s82, 1
  s_cbranch_scc1 L_abort
  s_waitcnt vmcnt(0)
  v_cmp_eq_u32 vcc, 0, v2
  s_cbranch_vccnz VO_uf0
  s_waitcnt vmcnt(0)
  v_add_u32 v44, 131072, v44
  ds_write_b128 v44, v[32:35]
  v_add_u32 v45, 131072, v45
  ds_write_b128 v45, v[36:39]
  v_add_u32 v46, 131072, v46
  ds_write_b128 v46, v[40:43]
  s_waitcnt lgkmcnt(0)
  ds_read_b128 v[120:123], v6 offset:0
  ds_read_b128 v[124:127], v6 offset:1024
  ds_read_b128 v[128:131], v6 offset:2048
  ds_read_b128 v[132:135], v6 offset:3072
  ds_read_b128 v[136:139], v6 offset:4096
  ds_read_b128 v[140:143], v6 offset:5120
  v_mov_b32 v144, 0
  v_mov_b32 v145, 0
  v_mov_b32 v146, 0
  v_mov_b32 v147, 0
  v_mov_b32 v148, 0
  v_mov_b32 v149, 0
  v_mov_b32 v150, 0
  v_mov_b32 v151, 0
  v_mov_b32 v152, 0
  v_mov_b32 v153, 0
  v_mov_b32 v154, 0
  v_mov_b32 v155, 0
  v_mov_b32 v52, 0
  v_mov_b32 v53, 0
  v_mov_b32 v54, 0
  v_mov_b32 v55, 0
  v_mov_b32 v56, 0
  v_mov_b32 v57, 0
  v_mov_b32 v58, 0
  v_mov_b32 v59, 0
  v_mov_b32 v60, 0
  v_mov_b32 v61, 0
  v_mov_b32 v62, 0
  v_mov_b32 v63, 0
  v_mov_b32 v64, 0
  v_mov_b32 v65, 0
  v_mov_b32 v66, 0
  v_mov_b32 v67, 0
  v_mov_b32 v68, 0
  v_mov_b32 v69, 0
  v_mov_b32 v70, 0
  v_mov_b32 v71, 0
  v_add_u32 v5, 40960, v7
  s_add_u32 s92, s38, 0
  s_add_u32 s93, s38, 40960
  s_add_u32 s94, s38, 81920
  s_add_u32 s95, s38, 122880
  s_add_u32 s38, s38, 1310720
  s_add_u32 s89, s28, 1
  s_min_u32 s89, s89, 63
  s_lshr_b32 s89, s89, 3
  s_lshl_b32 s89, s89, 9
  s_add_u32 s89, s89, s55
  buffer_load_dwordx4 v[72:75], v24, s[8:11], s92 offen
  buffer_load_dwordx4 v[88:91], v25, s[8:11], s92 offen
  buffer_load_dwordx4 v[104:107], v26, s[8:11], s92 offen
  s_waitcnt lgkmcnt(0)
  s_barrier
  s_nop 0
  s_cmp_lt_u32 s81, 32
  s_cbranch_scc1 VOS_loop
VO_loop:
  s_waitcnt lgkmcnt(0)
  s_barrier
  s_cmp_eq_u32 s24, 0
  s_cbranch_scc1 VO_vw0
  s_cmp_eq_u32 s24, 1
  s_cbranch_scc1 VO_vw1
  s_cmp_eq_u32 s24, 2
  s_cbranch_scc1 VO_vw2
VO_vw3:
  ds_read_b128 v[32:35], v14 offset:6144
  ds_read_b128 v[36:39], v14 offset:7168
  ds_read_b128 v[40:43], v14 offset:8192
  s_waitcnt lgkmcnt(2)
  v_smfmac_f32_16x16x64_bf16 v[144:147], v[32:35], a[144:151], v8
  ds_read_b128 v[44:47], v14 offset:0
  v_smfmac_f32_16x16x64_bf16 v[148:151], v[32:35], a[152:159], v8
  v_smfmac_f32_16x16x64_bf16 v[152:155], v[32:35], a[160:167], v8
  s_waitcnt lgkmcnt(2)
  v_smfmac_f32_16x16x64_bf16 v[144:147], v[36:39], a[168:175], v8
  ds_read_b128 v[32:35], v14 offset:1024
  v_smfmac_f32_16x16x64_bf16 v[148:151], v[36:39], a[176:183], v8
  v_smfmac_f32_16x16x64_bf16 v[152:155], v[36:39], a[184:191], v8
VO_vt3:
  buffer_load_dwordx4 v[76:79], v24, s[8:11], s93 offen
  s_waitcnt lgkmcnt(2)
  v_smfmac_f32_16x16x64_bf16 v[144:147], v[40:43], v[120:127], v8
  ds_read_b128 v[36:39], v14 offset:2048
  v_smfmac_f32_16x16x64_bf16 v[148:151], v[40:43], v[128:135], v8
  v_smfmac_f32_16x16x64_bf16 v[152:155], v[40:43], v[136:143], v8
  buffer_load_dwordx4 v[92:95], v25, s[8:11], s93 offen
  s_waitcnt lgkmcnt(2)
  v_smfmac_f32_16x16x64_bf16 v[144:147], v[44:47], a[0:7], v8
  ds_read_b128 v[40:43], v14 offset:3072
  v_smfmac_f32_16x16x64_bf16 v[148:151], v[44:47], a[8:15], v8
  ds_read_b128 v[120:123], v6 offset:24576
  v_smfmac_f32_16x16x64_bf16 v[152:155], v[44:47], a[16:23], v8
  ds_read_b128 v[124:127], v6 offset:25600
  buffer_load_dwordx4 v[108:111], v26, s[8:11], s93 offen
  s_waitcnt lgkmcnt(4)
  v_smfmac_f32_16x16x64_bf16 v[144:147], v[32:35], a[24:31], v8
  ds_read_b128 v[44:47], v14 offset:9216
  v_smfmac_f32_16x16x64_bf16 v[148:151], v[32:35], a[32:39], v8
  ds_read_b128 v[128:131], v6 offset:26624
  v_smfmac_f32_16x16x64_bf16 v[152:155], v[32:35], a[40:47], v8
  ds_read_b128 v[132:135], v6 offset:27648
  buffer_load_dwordx4 v[80:83], v24, s[8:11], s94 offen
  s_waitcnt lgkmcnt(6)
  v_smfmac_f32_16x16x64_bf16 v[144:147], v[36:39], a[48:55], v8
  ds_read_b128 v[32:35], v14 offset:4096
  v_smfmac_f32_16x16x64_bf16 v[148:151], v[36:39], a[56:63], v8
  ds_read_b128 v[136:139], v6 offset:28672
  v_smfmac_f32_16x16x64_bf16 v[152:155], v[36:39], a[64:71], v8
  ds_read_b128 v[140:143], v6 offset:29696
  buffer_load_dwordx4 v[96:99], v25, s[8:11], s94 offen
  s_waitcnt lgkmcnt(8)
  v_smfmac_f32_16x16x64_bf16 v[144:147], v[40:43], a[72:79], v8
  ds_read_b128 v[36:39], v14 offset:5120
  v_smfmac_f32_16x16x64_bf16 v[148:151], v[40:43], a[80:87], v8
  v_smfmac_f32_16x16x64_bf16 v[152:155], v[40:43], a[88:95], v8
  buffer_load_dwordx4 v[112:115], v26, s[8:11], s94 offen
  s_waitcnt lgkmcnt(1)
  v_smfmac_f32_16x16x64_bf16 v[144:147], v[44:47], v[120:127], v8
  v_smfmac_f32_16x16x64_bf16 v[148:151], v[44:47], v[128:135], v8
  v_smfmac_f32_16x16x64_bf16 v[152:155], v[44:47], v[136:143], v8
  buffer_load_dwordx4 v[84:87], v24, s[8:11], s95 offen
  v_smfmac_f32_16x16x64_bf16 v[144:147], v[32:35], a[96:103], v8
  ds_read_b128 v[120:123], v7 offset:0
  v_smfmac_f32_16x16x64_bf16 v[148:151], v[32:35], a[104:111], v8
  ds_read_b128 v[124:127], v7 offset:20480
  v_smfmac_f32_16x16x64_bf16 v[152:155], v[32:35], a[112:119], v8
  ds_read_b128 v[128:131], v7 offset:1024
  buffer_load_dwordx4 v[100:103], v25, s[8:11], s95 offen
  s_waitcnt lgkmcnt(3)
  v_smfmac_f32_16x16x64_bf16 v[144:147], v[36:39], a[120:127], v8
  ds_read_b128 v[132:135], v7 offset:21504
  v_smfmac_f32_16x16x64_bf16 v[148:151], v[36:39], a[128:135], v8
  ds_read_b128 v[136:139], v7 offset:2048
  v_smfmac_f32_16x16x64_bf16 v[152:155], v[36:39], a[136:143], v8
  ds_read_b128 v[140:143], v7 offset:22528
  buffer_load_dwordx4 v[116:119], v26, s[8:11], s95 offen
  s_branch VO_vpost
VO_vw0:
  ds_read_b128 v[32:35], v14 offset:0
  ds_read_b128 v[36:39], v14 offset:1024
  ds_read_b128 v[40:43], v14 offset:8192
  s_waitcnt lgkmcnt(2)
  v_smfmac_f32_16x16x64_bf16 v[144:147], v[32:35], a[0:7], v8
  ds_read_b128 v[44:47], v14 offset:2048
  v_smfmac_f32_16x16x64_bf16 v[148:151], v[32:35], a[8:15], v8
  v_smfmac_f32_16x16x64_bf16 v[152:155], v[32:35], a[16:23], v8
  s_waitcnt lgkmcnt(2)
  v_smfmac_f32_16x16x64_bf16 v[144:147], v[36:39], a[24:31], v8
  ds_read_b128 v[32:35], v14 offset:3072
  v_smfmac_f32_16x16x64_bf16 v[148:151], v[36:39], a[32:39], v8
  v_smfmac_f32_16x16x64_bf16 v[152:155], v[36:39], a[40:47], v8
VO_vt0:
  buffer_load_dwordx4 v[76:79], v24, s[8:11], s93 offen
  s_waitcnt lgkmcnt(2)
  v_smfmac_f32_16x16x64_bf16 v[144:147], v[40:43], v[120:127], v8
  ds_read_b128 v[36:39], v14 offset:4096
  v_smfmac_f32_16x16x64_bf16 v[148:151], v[40:43], v[128:135], v8
  v_smfmac_f32_16x16x64_bf16 v[152:155], v[40:43], v[136:143], v8
  buffer_load_dwordx4 v[92:95], v25, s[8:11], s93 offen
  s_waitcnt lgkmcnt(2)
  v_smfmac_f32_16x16x64_bf16 v[144:147], v[44:47], a[48:55], v8
  ds_read_b128 v[40:43], v14 offset:5120
  v_smfmac_f32_16x16x64_bf16 v[148:151], v[44:47], a[56:63], v8
  ds_read_b128 v[120:123], v6 offset:24576
  v_smfmac_f32_16x16x64_bf16 v[152:155], v[44:47], a[64:71], v8
  ds_read_b128 v[124:127], v6 offset:25600
  buffer_load_dwordx4 v[108:111], v26, s[8:11], s93 offen
  s_waitcnt lgkmcnt(4)
  v_smfmac_f32_16x16x64_bf16 v[144:147], v[32:35], a[72:79], v8
  ds_read_b128 v[44:47], v14 offset:9216
  v_smfmac_f32_16x16x64_bf16 v[148:151], v[32:35], a[80:87], v8
  ds_read_b128 v[128:131], v6 offset:26624
  v_smfmac_f32_16x16x64_bf16 v[152:155], v[32:35], a[88:95], v8
  ds_read_b128 v[132:135], v6 offset:27648
  buffer_load_dwordx4 v[80:83], v24, s[8:11], s94 offen
  s_waitcnt lgkmcnt(6)
  v_smfmac_f32_16x16x64_bf16 v[144:147], v[36:39], a[96:103], v8
  ds_read_b128 v[32:35], v14 offset:6144
  v_smfmac_f32_16x16x64_bf16 v[148:151], v[36:39], a[104:111], v8
  ds_read_b128 v[136:139], v6 offset:28672
  v_smfmac_f32_16x16x64_bf16 v[152:155], v[36:39], a[112:119], v8
  ds_read_b128 v[140:143], v6 offset:29696
  buffer_load_dwordx4 v[96:99], v25, s[8:11], s94 offen
  s_waitcnt lgkmcnt(8)
  v_smfmac_f32_16x16x64_bf16 v[144:147], v[40:43], a[120:127], v8
  ds_read_b128 v[36:39], v14 offset:7168
  v_smfmac_f32_16x16x64_bf16 v[148:151], v[40:43], a[128:135], v8
  v_smfmac_f32_16x16x64_bf16 v[152:155], v[40:43], a[136:143], v8
  buffer_load_dwordx4 v[112:115], v26, s[8:11], s94 offen
  s_waitcnt lgkmcnt(1)
  v_smfmac_f32_16x16x64_bf16 v[144:147], v[44:47], v[120:127], v8
  v_smfmac_f32_16x16x64_bf16 v[148:151], v[44:47], v[128:135], v8
  v_smfmac_f32_16x16x64_bf16 v[152:155], v[44:47], v[136:143], v8
  buffer_load_dwordx4 v[84:87], v24, s[8:11], s95 offen
  v_smfmac_f32_16x16x64_bf16 v[144:147], v[32:35], a[144:151], v8
  ds_read_b128 v[120:123], v7 offset:0
  v_smfmac_f32_16x16x64_bf16 v[148:151], v[32:35], a[152:159], v8
  ds_read_b128 v[124:127], v7 offset:20480
  v_smfmac_f32_16x16x64_bf16 v[152:155], v[32:35], a[160:167], v8
  ds_read_b128 v[128:131], v7 offset:1024
  buffer_load_dwordx4 v[100:103], v25, s[8:11], s95 offen
  s_waitcnt lgkmcnt(3)
  v_smfmac_f32_16x16x64_bf16 v[144:147], v[36:39], a[168:175], v8
  ds_read_b128 v[132:135], v7 offset:21504
  v_smfmac_f32_16x16x64_bf16 v[148:151], v[36:39], a[176:183], v8
  ds_read_b128 v[136:139], v7 offset:2048
  v_smfmac_f32_16x16x64_bf16 v[152:155], v[36:39], a[184:191], v8
  ds_read_b128 v[140:143], v7 offset:22528
  buffer_load_dwordx4 v[116:119], v26, s[8:11], s95 offen
  s_branch VO_vpost
VO_vw1:
  ds_read_b128 v[32:35], v14 offset:2048
  ds_read_b128 v[36:39], v14 offset:3072
  ds_read_b128 v[40:43], v14 offset:8192
  s_waitcnt lgkmcnt(2)
  v_smfmac_f32_16x16x64_bf16 v[144:147], v[32:35], a[48:55], v8
  ds_read_b128 v[44:47], v14 offset:4096
  v_smfmac_f32_16x16x64_bf16 v[148:151], v[32:35], a[56:63], v8
  v_smfmac_f32_16x16x64_bf16 v[152:155], v[32:35], a[64:71], v8
  s_waitcnt lgkmcnt(2)
  v_smfmac_f32_16x16x64_bf16 v[144:147], v[36:39], a[72:79], v8
  ds_read_b128 v[32:35], v14 offset:5120
  v_smfmac_f32_16x16x64_bf16 v[148:151], v[36:39], a[80:87], v8
  v_smfmac_f32_16x16x64_bf16 v[152:155], v[36:39], a[88:95], v8
VO_vt1:
  buffer_load_dwordx4 v[76:79], v24, s[8:11], s93 offen
  s_waitcnt lgkmcnt(2)
  v_smfmac_f32_16x16x64_bf16 v[144:147], v[40:43], v[120:127], v8
  ds_read_b128 v[36:39], v14 offset:6144
  v_smfmac_f32_16x16x64_bf16 v[148:151], v[40:43], v[128:135], v8
  v_smfmac_f32_16x16x64_bf16 v[152:155], v[40:43], v[136:143], v8
  buffer_load_dwordx4 v[92:95], v25, s[8:11], s93 offen
  s_waitcnt lgkmcnt(2)
  v_smfmac_f32_16x16x64_bf16 v[144:147], v[44:47], a[96:103], v8
  ds_read_b128 v[40:43], v14 offset:7168
  v_smfmac_f32_16x16x64_bf16 v[148:151], v[44:47], a[104:111], v8
  ds_read_b128 v[120:123], v6 offset:24576
  v_smfmac_f32_16x16x64_bf16 v[152:155], v[44:47], a[112:119], v8
  ds_read_b128 v[124:127], v6 offset:25600
  buffer_load_dwordx4 v[108:111], v26, s[8:11], s93 offen
  s_waitcnt lgkmcnt(4)
  v_smfmac_f32_16x16x64_bf16 v[144:147], v[32:35], a[120:127], v8
  ds_read_b128 v[44:47], v14 offset:9216
  v_smfmac_f32_16x16x64_bf16 v[148:151], v[32:35], a[128:135], v8
  ds_read_b128 v[128:131], v6 offset:26624
  v_smfmac_f32_16x16x64_bf16 v[152:155], v[32:35], a[136:143], v8
  ds_read_b128 v[132:135], v6 offset:27648
  buffer_load_dwordx4 v[80:83], v24, s[8:11], s94 offen
  s_waitcnt lgkmcnt(6)
  v_smfmac_f32_16x16x64_bf16 v[144:147], v[36:39], a[144:151], v8
  ds_read_b128 v[32:35], v14 offset:0
  v_smfmac_f32_16x16x64_bf16 v[148:151], v[36:39], a[152:159], v8
  ds_read_b128 v[136:139], v6 offset:28672
  v_smfmac_f32_16x16x64_bf16 v[152:155], v[36:39], a[160:167], v8
  ds_read_b128 v[140:143], v6 offset:29696
  buffer_load_dwordx4 v[96:99], v25, s[8:11], s94 offen
  s_waitcnt lgkmcnt(8)
  v_smfmac_f32_16x16x64_bf16 v[144:147], v[40:43], a[168:175], v8
  ds_read_b128 v[36:39], v14 offset:1024
  v_smfmac_f32_16x16x64_bf16 v[148:151], v[40:43], a[176:183], v8
  v_smfmac_f32_16x16x64_bf16 v[152:155], v[40:43], a[184:191], v8
  buffer_load_dwordx4 v[112:115], v26, s[8:11], s94 offen
  s_waitcnt lgkmcnt(1)
  v_smfmac_f32_16x16x64_bf16 v[144:147], v[44:47], v[120:127], v8
  v_smfmac_f32_16x16x64_bf16 v[148:151], v[44:47], v[128:135], v8
  v_smfmac_f32_16x16x64_bf16 v[152:155], v[44:47], v[136:143], v8
  buffer_load_dwordx4 v[84:87], v24, s[8:11], s95 offen
  v_smfmac_f32_16x16x64_bf16 v[144:147], v[32:35], a[0:7], v8
  ds_read_b128 v[120:123], v7 offset:0
  v_smfmac_f32_16x16x64_bf16 v[148:151], v[32:35], a[8:15], v8
  ds_read_b128 v[124:127], v7 offset:20480
  v_smfmac_f32_16x16x64_bf16 v[152:155], v[32:35], a[16:23], v8
  ds_read_b128 v[128:131], v7 offset:1024
  buffer_load_dwordx4 v[100:103], v25, s[8:11], s95 offen
  s_waitcnt lgkmcnt(3)
  v_smfmac_f32_16x16x64_bf16 v[144:147], v[36:39], a[24:31], v8
  ds_read_b128 v[132:135], v7 offset:21504
  v_smfmac_f32_16x16x64_bf16 v[148:151], v[36:39], a[32:39], v8
  ds_read_b128 v[136:139], v7 offset:2048
  v_smfmac_f32_16x16x64_bf16 v[152:155], v[36:39], a[40:47], v8
  ds_read_b128 v[140:143], v7 offset:22528
  buffer_load_dwordx4 v[116:119], v26, s[8:11], s95 offen
  s_branch VO_vpost
VO_vw2:
  ds_read_b128 v[32:35], v14 offset:4096
  ds_read_b128 v[36:39], v14 offset:5120
  ds_read_b128 v[40:43], v14 offset:8192
  s_waitcnt lgkmcnt(2)
  v_smfmac_f32_16x16x64_bf16 v[144:147], v[32:35], a[96:103], v8
  ds_read_b128 v[44:47], v14 offset:6144
  v_smfmac_f32_16x16x64_bf16 v[148:151], v[32:35], a[104:111], v8
  v_smfmac_f32_16x16x64_bf16 v[152:155], v[32:35], a[112:119], v8
  s_waitcnt lgkmcnt(2)
  v_smfmac_f32_16x16x64_bf16 v[144:147], v[36:39], a[120:127], v8
  ds_read_b128 v[32:35], v14 offset:7168
  v_smfmac_f32_16x16x64_bf16 v[148:151], v[36:39], a[128:135], v8
  v_smfmac_f32_16x16x64_bf16 v[152:155], v[36:39], a[136:143], v8
VO_vt2:
  buffer_load_dwordx4 v[76:79], v24, s[8:11], s93 offen
  s_waitcnt lgkmcnt(2)
  v_smfmac_f32_16x16x64_bf16 v[144:147], v[40:43], v[120:127], v8
  ds_read_b128 v[36:39], v14 offset:0
  v_smfmac_f32_16x16x64_bf16 v[148:151], v[40:43], v[128:135], v8
  v_smfmac_f32_16x16x64_bf16 v[152:155], v[40:43], v[136:143], v8
  buffer_load_dwordx4 v[92:95], v25, s[8:11], s93 offen
  s_waitcnt lgkmcnt(2)
  v_smfmac_f32_16x16x64_bf16 v[144:147], v[44:47], a[144:151], v8
  ds_read_b128 v[40:43], v14 offset:1024
  v_smfmac_f32_16x16x64_bf16 v[148:151], v[44:47], a[152:159], v8
  ds_read_b128 v[120:123], v6 offset:24576
  v_smfmac_f32_16x16x64_bf16 v[152:155], v[44:47], a[160:167], v8
  ds_read_b128 v[124:127], v6 offset:25600
  buffer_load_dwordx4 v[108:111], v26, s[8:11], s93 offen
  s_waitcnt lgkmcnt(4)
  v_smfmac_f32_16x16x64_bf16 v[144:147], v[32:35], a[168:175], v8
  ds_read_b128 v[44:47], v14 offset:9216
  v_smfmac_f32_16x16x64_bf16 v[148:151], v[32:35], a[176:183], v8
  ds_read_b128 v[128:131], v6 offset:26624
  v_smfmac_f32_16x16x64_bf16 v[152:155], v[32:35], a[184:191], v8
  ds_read_b128 v[132:135], v6 offset:27648
  buffer_load_dwordx4 v[80:83], v24, s[8:11], s94 offen
  s_waitcnt lgkmcnt(6)
  v_smfmac_f32_16x16x64_bf16 v[144:147], v[36:39], a[0:7], v8
  ds_read_b128 v[32:35], v14 offset:2048
  v_smfmac_f32_16x16x64_bf16 v[148:151], v[36:39], a[8:15], v8
  ds_read_b128 v[136:139], v6 offset:28672
  v_smfmac_f32_16x16x64_bf16 v[152:155], v[36:39], a[16:23], v8
  ds_read_b128 v[140:143], v6 offset:29696
  buffer_load_dwordx4 v[96:99], v25, s[8:11], s94 offen
  s_waitcnt lgkmcnt(8)
  v_smfmac_f32_16x16x64_bf16 v[144:147], v[40:43], a[24:31], v8
  ds_read_b128 v[36:39], v14 offset:3072
  v_smfmac_f32_16x16x64_bf16 v[148:151], v[40:43], a[32:39], v8
  v_smfmac_f32_16x16x64_bf16 v[152:155], v[40:43], a[40:47], v8
  buffer_load_dwordx4 v[112:115], v26, s[8:11], s94 offen
  s_waitcnt lgkmcnt(1)
  v_smfmac_f32_16x16x64_bf16 v[144:147], v[44:47], v[120:127], v8
  v_smfmac_f32_16x16x64_bf16 v[148:151], v[44:47], v[128:135], v8
  v_smfmac_f32_16x16x64_bf16 v[152:155], v[44:47], v[136:143], v8
  buffer_load_dwordx4 v[84:87], v24, s[8:11], s95 offen
  v_smfmac_f32_16x16x64_bf16 v[144:147], v[32:35], a[48:55], v8
  ds_read_b128 v[120:123], v7 offset:0
  v_smfmac_f32_16x16x64_bf16 v[148:151], v[32:35], a[56:63], v8
  ds_read_b128 v[124:127], v7 offset:20480
  v_smfmac_f32_16x16x64_bf16 v[152:155], v[32:35], a[64:71], v8
  ds_read_b128 v[128:131], v7 offset:1024
  buffer_load_dwordx4 v[100:103], v25, s[8:11], s95 offen
  s_waitcnt lgkmcnt(3)
  v_smfmac_f32_16x16x64_bf16 v[144:147], v[36:39], a[72:79], v8
  ds_read_b128 v[132:135], v7 offset:21504
  v_smfmac_f32_16x16x64_bf16 v[148:151], v[36:39], a[80:87], v8
  ds_read_b128 v[136:139], v7 offset:2048
  v_smfmac_f32_16x16x64_bf16 v[152:155], v[36:39], a[88:95], v8
  ds_read_b128 v[140:143], v7 offset:22528
  buffer_load_dwordx4 v[116:119], v26, s[8:11], s95 offen
VO_vpost:
  s_nop 3
  v_permlane32_swap_b32 v144, v148
  v_permlane32_swap_b32 v145, v149
  v_permlane32_swap_b32 v146, v150
  v_permlane32_swap_b32 v147, v151
  v_permlane32_swap_b32 v152, v36
  v_permlane32_swap_b32 v153, v37
  v_permlane32_swap_b32 v154, v38
  v_permlane32_swap_b32 v155, v39
  v_pk_add_f32 v[32:33], v[144:145], v[148:149]
  v_pk_add_f32 v[34:35], v[146:147], v[150:151]
  v_cvt_pk_bf16_f32 v32, v32, v33
  v_cvt_pk_bf16_f32 v33, v34, v35
  v_pk_add_f32 v[36:37], v[152:153], v[36:37]
  v_pk_add_f32 v[38:39], v[154:155], v[38:39]
  ds_write_b64 v18, v[32:33]
  v_cvt_pk_bf16_f32 v36, v36, v37
  v_cvt_pk_bf16_f32 v37, v38, v39
  ds_write_b64 v19, v[36:37]
  v_mbcnt_lo_u32_b32 v4, -1, 0
  v_mbcnt_hi_u32_b32 v4, -1, v4
  v_and_b32 v0, 0, v4
  v_add_lshl_u32 v4, v4, v0, 2
  buffer_load_dword v0, v4, s[8:11], s89 offen sc1
  s_waitcnt lgkmcnt(0)
  s_barrier
  ds_read_b64_tr_b16 v[32:33], v20 offset:0
  ds_read_b64_tr_b16 v[34:35], v20 offset:64
  ds_read_b64_tr_b16 v[44:45], v20 offset:2048
  ds_read_b64_tr_b16 v[46:47], v20 offset:2112
  ds_read_b64_tr_b16 v[36:37], v20 offset:512
  ds_read_b64_tr_b16 v[38:39], v20 offset:576
  s_waitcnt lgkmcnt(4)
  v_smfmac_f32_16x16x64_bf16 v[52:55], v[32:35], a[192:199], v8
  ds_read_b128 v[144:147], v7 offset:3072
  v_smfmac_f32_16x16x64_bf16 v[56:59], v[32:35], a[200:207], v8
  ds_read_b128 v[148:151], v7 offset:23552
  s_waitcnt lgkmcnt(4)
  v_smfmac_f32_16x16x64_bf16 v[52:55], v[44:47], v[120:127], v8
  ds_read_b64_tr_b16 v[40:41], v20 offset:1024
  v_smfmac_f32_16x16x64_bf16 v[60:63], v[32:35], a[208:215], v8
  ds_read_b64_tr_b16 v[42:43], v20 offset:1088
  v_smfmac_f32_16x16x64_bf16 v[64:67], v[32:35], a[216:223], v8
  ds_read_b128 v[152:155], v7 offset:4096
  v_smfmac_f32_16x16x64_bf16 v[56:59], v[44:47], v[128:135], v8
  ds_read_b128 v[156:159], v7 offset:24576
  v_smfmac_f32_16x16x64_bf16 v[68:71], v[32:35], a[224:231], v8
  ds_read_b128 v[120:123], v5 offset:0
  s_waitcnt lgkmcnt(7)
  v_smfmac_f32_16x16x64_bf16 v[52:55], v[36:39], a[232:239], v8
  ds_read_b128 v[124:127], v5 offset:20480
  v_smfmac_f32_16x16x64_bf16 v[60:63], v[44:47], v[136:143], v8
  ds_read_b64_tr_b16 v[48:49], v20 offset:2560
  v_smfmac_f32_16x16x64_bf16 v[56:59], v[36:39], a[240:247], v8
  ds_read_b64_tr_b16 v[50:51], v20 offset:2624
  v_smfmac_f32_16x16x64_bf16 v[60:63], v[36:39], a[248:255], v8
  ds_read_b128 v[128:131], v5 offset:1024
  s_waitcnt lgkmcnt(9)
  v_smfmac_f32_16x16x64_bf16 v[64:67], v[44:47], v[144:151], v8
  ds_read_b128 v[132:135], v5 offset:21504
  v_smfmac_f32_16x16x64_bf16 v[64:67], v[36:39], v[160:167], v8
  ds_read_b64_tr_b16 v[32:33], v20 offset:1536
  v_smfmac_f32_16x16x64_bf16 v[68:71], v[36:39], v[168:175], v8
  ds_read_b64_tr_b16 v[34:35], v20 offset:1600
  s_waitcnt lgkmcnt(8)
  v_smfmac_f32_16x16x64_bf16 v[68:71], v[44:47], v[152:159], v8
  ds_read_b128 v[136:139], v5 offset:2048
  v_smfmac_f32_16x16x64_bf16 v[52:55], v[40:43], v[176:183], v8
  ds_read_b128 v[140:143], v5 offset:22528
  v_smfmac_f32_16x16x64_bf16 v[56:59], v[40:43], v[184:191], v8
  ds_read_b128 v[144:147], v5 offset:3072
  s_waitcnt lgkmcnt(7)
  v_smfmac_f32_16x16x64_bf16 v[52:55], v[48:51], v[120:127], v8
  ds_read_b128 v[148:151], v5 offset:23552
  v_smfmac_f32_16x16x64_bf16 v[60:63], v[40:43], v[192:199], v8
  ds_read_b128 v[152:155], v5 offset:4096
  v_smfmac_f32_16x16x64_bf16 v[64:67], v[40:43], v[200:207], v8
  ds_read_b128 v[156:159], v5 offset:24576
  s_waitcnt lgkmcnt(8)
  v_smfmac_f32_16x16x64_bf16 v[56:59], v[48:51], v[128:135], v8
  v_smfmac_f32_16x16x64_bf16 v[68:71], v[40:43], v[208:215], v8
  s_waitcnt lgkmcnt(6)
  v_smfmac_f32_16x16x64_bf16 v[52:55], v[32:35], v[216:223], v8
  s_waitcnt lgkmcnt(4)
  v_smfmac_f32_16x16x64_bf16 v[60:63], v[48:51], v[136:143], v8
  v_smfmac_f32_16x16x64_bf16 v[56:59], v[32:35], v[224:231], v8
  v_smfmac_f32_16x16x64_bf16 v[60:63], v[32:35], v[232:239], v8
  s_waitcnt lgkmcnt(2)
  v_smfmac_f32_16x16x64_bf16 v[64:67], v[48:51], v[144:151], v8
  v_smfmac_f32_16x16x64_bf16 v[64:67], v[32:35], v[240:247], v8
  v_smfmac_f32_16x16x64_bf16 v[68:71], v[32:35], v[248:255], v8
  s_waitcnt lgkmcnt(0)
  v_smfmac_f32_16x16x64_bf16 v[68:71], v[48:51], v[152:159], v8
  s_cmp_eq_u32 s28, 63
  s_cbranch_scc1 VO_last
  s_add_u32 s31, s33, s37
  v_cvt_pk_bf16_f32 v32, v52, v53
  v_cvt_pk_bf16_f32 v33, v54, v55
  v_cvt_pk_bf16_f32 v34, v56, v57
  v_cvt_pk_bf16_f32 v35, v58, v59
  v_and_or_b32 v32, v32, -2, s91
  v_and_or_b32 v33, v33, -2, s91
  v_and_or_b32 v34, v34, -2, s91
  v_and_or_b32 v35, v35, -2, s91
  v_cvt_pk_bf16_f32 v36, v60, v61
  v_cvt_pk_bf16_f32 v37, v62, v63
  v_permlane16_swap_b32 v32, v34
  v_permlane16_swap_b32 v33, v35
  v_cvt_pk_bf16_f32 v38, v64, v65
  v_cvt_pk_bf16_f32 v39, v66, v67
  buffer_store_dwordx4 v[32:35], v9, s[8:11], s31 offen
  v_and_or_b32 v36, v36, -2, s91
  v_and_or_b32 v37, v37, -2, s91
  v_and_or_b32 v38, v38, -2, s91
  v_and_or_b32 v39, v39, -2, s91
  v_cvt_pk_bf16_f32 v40, v68, v69
  v_cvt_pk_bf16_f32 v41, v70, v71
  v_permlane16_swap_b32 v36, v38
  v_permlane16_swap_b32 v37, v39
  v_and_or_b32 v40, v40, -2, s91
  v_and_or_b32 v41, v41, -2, s91
  buffer_store_dwordx4 v[36:39], v9, s[8:11], s31 offen offset:1024
  buffer_store_dwordx2 v[40:41], v21, s[8:11], s31 offen offset:2048
  v_mov_b32 v144, 0
  v_mov_b32 v145, 0
  v_mov_b32 v146, 0
  v_mov_b32 v147, 0
  v_mov_b32 v148, 0
  v_mov_b32 v149, 0
  v_mov_b32 v150, 0
  v_mov_b32 v151, 0
  v_mov_b32 v152, 0
  v_mov_b32 v153, 0
  v_mov_b32 v154, 0
  v_mov_b32 v155, 0
  s_add_u32 s30, s28, 1
  v_mov_b32 v42, s30
  s_add_u32 s90, s32, s37
  s_add_u32 s30, s28, 1
  s_lshl_b32 s53, s30, 17
  s_lshl_b32 s30, s30, 9
  s_and_b32 s30, s30, 0x2000
  s_xor_b32 s30, s30, s47
  s_add_u32 s53, s53, s30
  s_sleep 1
  s_sleep 1
  s_sleep 1
  s_sleep 1
  s_sleep 1
  buffer_load_dwordx4 v[132:135], v27, s[8:11], s46 offen sc1
  buffer_load_dwordx4 v[136:139], v27, s[8:11], s46 offen offset:1280 sc1
  buffer_load_dwordx2 v[140:141], v28, s[8:11], s46 offen sc1
  buffer_load_dwordx4 v[120:123], v22, s[8:11], s90 offen sc1
  buffer_load_dwordx4 v[124:127], v22, s[8:11], s90 offen offset:256 sc1
  buffer_load_dwordx4 v[128:131], v23, s[8:11], s90 offen sc1
  s_waitcnt vmcnt(5)
  v_smfmac_f32_16x16x64_bf16 v[144:147], v[132:135], v[72:79], v8 abid:1
  v_bitop3_b32 v1, v132, v133, s29 bitop3:126
  v_smfmac_f32_16x16x64_bf16 v[148:151], v[132:135], v[88:95], v8 abid:1
  v_bitop3_b32 v2, v134, v135, s29 bitop3:126
  v_smfmac_f32_16x16x64_bf16 v[152:155], v[132:135], v[104:111], v8 abid:1
  s_waitcnt vmcnt(4)
  v_smfmac_f32_16x16x64_bf16 v[144:147], v[136:139], v[80:87], v8 abid:1
  v_bitop3_b32 v3, v136, v137, s29 bitop3:126
  v_smfmac_f32_16x16x64_bf16 v[148:151], v[136:139], v[96:103], v8 abid:1
  v_bitop3_b32 v4, v138, v139, s29 bitop3:126
  v_smfmac_f32_16x16x64_bf16 v[152:155], v[136:139], v[112:119], v8 abid:1
  v_or3_b32 v1, v1, v2, v3
  v_or_b32 v1, v1, v4
  v_cmp_gt_i32 vcc, 0, v1
  s_cbranch_vccnz VO_pe
  s_waitcnt vmcnt(2)
  v_smfmac_f32_16x16x32_bf16 v[144:147], v[140:141], v[120:123], v8 abid:2
  v_bitop3_b32 v2, v140, v141, s29 bitop3:126
  v_or3_b32 v1, v1, v4, v2
  v_bitop3_b32 v2, v120, v121, s91 bitop3:126
  v_bitop3_b32 v3, v122, v123, s91 bitop3:126
  s_waitcnt vmcnt(1)
  v_smfmac_f32_16x16x32_bf16 v[148:151], v[140:141], v[124:127], v8 abid:2
  v_bitop3_b32 v4, v124, v125, s91 bitop3:126
  v_or3_b32 v2, v2, v3, v4
  v_bitop3_b32 v3, v126, v127, s91 bitop3:126
  s_waitcnt vmcnt(0)
  v_smfmac_f32_16x16x32_bf16 v[152:155], v[140:141], v[128:131], v8 abid:2
  v_bitop3_b32 v4, v128, v129, s91 bitop3:126
  v_or3_b32 v2, v2, v3, v4
  v_bitop3_b32 v3, v130, v131, s91 bitop3:126
  v_or_b32 v2, v2, v3
  v_lshl_or_b32 v1, v2, 31, v1
  v_cmp_gt_i32 vcc, 0, v1
  s_cbranch_vccnz VO_pbad
VO_pok:
  s_cmp_ge_u32 s24, 2
  v_add_f32 v144, v144, v145
  v_add_f32 v145, v146, v147
  ds_write_b64 v29, v[144:145] offset:0
  v_add_f32 v148, v148, v149
  v_add_f32 v149, v150, v151
  ds_write_b64 v29, v[148:149] offset:512
  v_add_f32 v152, v152, v153
  v_add_f32 v153, v154, v155
  ds_write_b64 v29, v[152:153] offset:1024
  s_waitcnt lgkmcnt(0)
  s_barrier
  s_cbranch_scc1 VO_nopub
  ds_read_b128 v[72:75], v30 offset:0
  ds_read_b128 v[76:79], v30 offset:1536
  ds_read_b128 v[80:83], v30 offset:3072
  ds_read_b128 v[84:87], v30 offset:4608
  s_waitcnt lgkmcnt(2)
  v_pk_add_f32 v[72:73], v[72:73], v[76:77]
  v_pk_add_f32 v[74:75], v[74:75], v[78:79]
  s_waitcnt lgkmcnt(0)
  v_pk_add_f32 v[80:81], v[80:81], v[84:85]
  v_pk_add_f32 v[82:83], v[82:83], v[86:87]
  v_pk_add_f32 v[72:73], v[72:73], v[80:81]
  v_pk_add_f32 v[74:75], v[74:75], v[82:83]
  v_cvt_pk_bf16_f32 v72, v72, v73
  v_cvt_pk_bf16_f32 v73, v74, v75
  v_xor_b32 v72, s29, v72
  v_xor_b32 v73, s29, v73
  v_min_u32 v72, -2, v72
  v_min_u32 v73, -2, v73
  buffer_store_dwordx2 v[72:73], v31, s[8:11], s53 offen sc1
  s_branch VO_pubd
VO_nopub:
  s_nop 15
  s_cmp_eq_u32 s24, 3
  s_cbranch_scc1 VO_nomk
  s_mov_b64 exec, 1
  buffer_store_dword v42, off, s[8:11], s35
  s_branch VO_mkd
VO_nomk:
VO_mkd:
  s_mov_b64 exec, -1
VO_pubd:
  s_mov_b32 s88, s54
  s_add_u32 s54, s54, 327680
  s_mov_b32 s36, s90
  s_xor_b32 s37, s37, 163840
  s_and_b32 s30, s28, 1
  s_xor_b32 s91, s91, s30
  v_cmp_eq_u32 vcc, 0, v0
  s_add_u32 s31, s28, 1
  s_cbranch_vccz VO_nouf
  s_lshr_b32 s30, s31, 3
  s_lshl_b32 s30, s30, 9
  s_add_u32 s30, s30, s55
  v_mbcnt_lo_u32_b32 v3, -1, 0
  v_mbcnt_hi_u32_b32 v3, -1, v3
  v_and_b32 v2, 0, v3
  v_add_lshl_u32 v3, v3, v2, 2
VO_uf:
  buffer_load_dword v2, v3, s[8:11], s30 offen sc1
  s_sub_u32 s82, s82, 1
  s_cbranch_scc1 L_abort
  s_waitcnt vmcnt(0)
  v_cmp_eq_u32 vcc, 0, v2
  s_cbranch_vccnz VO_uf
VO_nouf:
  s_add_u32 s30, s28, 1
  s_lshl_b32 s53, s30, 17
  s_lshl_b32 s30, s30, 9
  s_and_b32 s30, s30, 0x2000
  s_xor_b32 s30, s30, s47
  s_add_u32 s53, s53, s30
  s_add_u32 s48, s53, s40
  s_add_u32 s49, s53, s41
  s_add_u32 s50, s53, s42
  s_add_u32 s51, s53, s43
  s_add_u32 s52, s53, s44
  s_add_u32 s30, s28, 1
  s_cmp_lg_u32 s24, 2
  s_cbranch_scc1 VO_mkb
  s_mov_b64 exec, 65535
  buffer_load_dword v1, v17, s[8:11], s45 offen sc1
  s_nop 15
  s_nop 7
VO_mk:
  buffer_load_dword v2, v17, s[8:11], s45 offen sc1
  s_waitcnt vmcnt(1)
  v_cmp_gt_i32 vcc, s30, v1
  s_cbranch_vccz VO_mkok
  buffer_load_dword v1, v17, s[8:11], s45 offen sc1
  s_sub_u32 s82, s82, 1
  s_cbranch_scc1 L_abort
  s_waitcnt vmcnt(1)
  v_cmp_gt_i32 vcc, s30, v2
  s_cbranch_vccnz VO_mk
VO_mkok:
  s_mov_b64 exec, -1
VO_mkb:
  s_barrier
  buffer_load_dwordx4 v[32:35], v16, s[8:11], s48 offen sc1
  buffer_load_dwordx4 v[36:39], v16, s[8:11], s49 offen sc1
  buffer_load_dwordx4 v[40:43], v16, s[8:11], s50 offen sc1
  buffer_load_dwordx4 v[44:47], v16, s[8:11], s51 offen sc1
  buffer_load_dwordx4 v[48:51], v16, s[8:11], s52 offen sc1
  ds_read_b128 v[120:123], v6 offset:0
  ds_read_b128 v[124:127], v6 offset:1024
  ds_read_b128 v[128:131], v6 offset:2048
  ds_read_b128 v[132:135], v6 offset:3072
  ds_read_b128 v[136:139], v6 offset:4096
  ds_read_b128 v[140:143], v6 offset:5120
  v_mov_b32 v144, 0
  v_mov_b32 v145, 0
  v_mov_b32 v146, 0
  v_mov_b32 v147, 0
  v_mov_b32 v148, 0
  v_mov_b32 v149, 0
  v_mov_b32 v150, 0
  v_mov_b32 v151, 0
  v_mov_b32 v152, 0
  v_mov_b32 v153, 0
  v_mov_b32 v154, 0
  v_mov_b32 v155, 0
  v_mov_b32 v52, 0
  v_mov_b32 v53, 0
  v_mov_b32 v54, 0
  v_mov_b32 v55, 0
  v_mov_b32 v56, 0
  v_mov_b32 v57, 0
  v_mov_b32 v58, 0
  v_mov_b32 v59, 0
  v_mov_b32 v60, 0
  v_mov_b32 v61, 0
  v_mov_b32 v62, 0
  v_mov_b32 v63, 0
  v_mov_b32 v64, 0
  v_mov_b32 v65, 0
  v_mov_b32 v66, 0
  v_mov_b32 v67, 0
  v_mov_b32 v68, 0
  v_mov_b32 v69, 0
  v_mov_b32 v70, 0
  v_mov_b32 v71, 0
  v_add_u32 v5, 40960, v7
  s_add_u32 s92, s38, 0
  s_add_u32 s93, s38, 40960
  s_add_u32 s94, s38, 81920
  s_add_u32 s95, s38, 122880
  s_add_u32 s38, s38, 1310720
  s_add_u32 s89, s28, 2
  s_min_u32 s89, s89, 63
  s_lshr_b32 s89, s89, 3
  s_lshl_b32 s89, s89, 9
  s_add_u32 s89, s89, s55
  buffer_load_dwordx4 v[72:75], v24, s[8:11], s92 offen
  buffer_load_dwordx4 v[88:91], v25, s[8:11], s92 offen
  buffer_load_dwordx4 v[104:107], v26, s[8:11], s92 offen
  s_add_u32 s28, s28, 1
  s_xor_b32 s29, s29, 0x80008000
  s_cmp_eq_u32 s24, 0
  s_cbranch_scc1 VO_fz0
  s_cmp_eq_u32 s24, 1
  s_cbranch_scc1 VO_fz1
  s_cmp_eq_u32 s24, 2
  s_cbranch_scc1 VO_fz2
VO_fz3:
  s_waitcnt vmcnt(7)
  v_max3_u32 v3, v32, v33, v34
  v_max_u32 v3, v3, v35
  v_mfma_f32_16x16x32_bf16 v[32:35], v[32:35], v[10:13], 0
  s_waitcnt vmcnt(6)
  v_max3_u32 v3, v36, v37, v3
  v_max3_u32 v3, v38, v39, v3
  v_mfma_f32_16x16x32_bf16 v[36:39], v[36:39], v[10:13], 0
  s_waitcnt vmcnt(5)
  v_max3_u32 v3, v40, v41, v3
  v_max3_u32 v3, v42, v43, v3
  v_mfma_f32_16x16x32_bf16 v[40:43], v[40:43], v[10:13], 0
  v_cvt_pk_bf16_f32 v32, v32, v33
  v_cvt_pk_bf16_f32 v33, v34, v35
  ds_write_b64 v15, v[32:33] offset:0
  s_waitcnt vmcnt(4)
  v_max3_u32 v3, v44, v45, v3
  v_max3_u32 v3, v46, v47, v3
  v_mfma_f32_16x16x32_bf16 v[44:47], v[44:47], v[10:13], 0
  v_cvt_pk_bf16_f32 v36, v36, v37
  v_cvt_pk_bf16_f32 v37, v38, v39
  ds_write_b64 v15, v[36:37] offset:512
  ds_read_b128 v[32:35], v14 offset:6144
  s_waitcnt vmcnt(3)
  v_max3_u32 v3, v48, v49, v3
  v_max3_u32 v3, v50, v51, v3
  v_mfma_f32_16x16x32_bf16 v[48:51], v[48:51], v[10:13], 0
  v_cmp_eq_u32 vcc, -1, v3
  v_cvt_pk_bf16_f32 v40, v40, v41
  v_cvt_pk_bf16_f32 v41, v42, v43
  ds_write_b64 v15, v[40:41] offset:1024
  v_cvt_pk_bf16_f32 v44, v44, v45
  v_cvt_pk_bf16_f32 v45, v46, v47
  ds_write_b64 v15, v[44:45] offset:1536
  ds_read_b128 v[36:39], v14 offset:7168
  v_cvt_pk_bf16_f32 v48, v48, v49
  v_cvt_pk_bf16_f32 v49, v50, v51
  ds_write_b64 v15, v[48:49] offset:3584
  s_cbranch_vccnz VO_h2r0
  s_waitcnt lgkmcnt(4)
  v_smfmac_f32_16x16x64_bf16 v[144:147], v[32:35], a[144:151], v8
  v_smfmac_f32_16x16x64_bf16 v[148:151], v[32:35], a[152:159], v8
  v_smfmac_f32_16x16x64_bf16 v[152:155], v[32:35], a[160:167], v8
  s_waitcnt lgkmcnt(0)
  s_barrier
  ds_read_b128 v[40:43], v14 offset:8192
  ds_read_b128 v[44:47], v14 offset:0
  v_smfmac_f32_16x16x64_bf16 v[144:147], v[36:39], a[168:175], v8
  ds_read_b128 v[32:35], v14 offset:1024
  v_smfmac_f32_16x16x64_bf16 v[148:151], v[36:39], a[176:183], v8
  v_smfmac_f32_16x16x64_bf16 v[152:155], v[36:39], a[184:191], v8
  s_branch VO_vt3
VO_fz0:
  s_waitcnt vmcnt(7)
  v_max3_u32 v3, v32, v33, v34
  v_max_u32 v3, v3, v35
  v_mfma_f32_16x16x32_bf16 v[32:35], v[32:35], v[10:13], 0
  s_waitcnt vmcnt(6)
  v_max3_u32 v3, v36, v37, v3
  v_max3_u32 v3, v38, v39, v3
  v_mfma_f32_16x16x32_bf16 v[36:39], v[36:39], v[10:13], 0
  s_waitcnt vmcnt(5)
  v_max3_u32 v3, v40, v41, v3
  v_max3_u32 v3, v42, v43, v3
  v_mfma_f32_16x16x32_bf16 v[40:43], v[40:43], v[10:13], 0
  v_cvt_pk_bf16_f32 v32, v32, v33
  v_cvt_pk_bf16_f32 v33, v34, v35
  ds_write_b64 v15, v[32:33] offset:0
  s_waitcnt vmcnt(4)
  v_max3_u32 v3, v44, v45, v3
  v_max3_u32 v3, v46, v47, v3
  v_mfma_f32_16x16x32_bf16 v[44:47], v[44:47], v[10:13], 0
  v_cvt_pk_bf16_f32 v36, v36, v37
  v_cvt_pk_bf16_f32 v37, v38, v39
  ds_write_b64 v15, v[36:37] offset:512
  ds_read_b128 v[32:35], v14 offset:0
  s_waitcnt vmcnt(3)
  v_max3_u32 v3, v48, v49, v3
  v_max3_u32 v3, v50, v51, v3
  v_mfma_f32_16x16x32_bf16 v[48:51], v[48:51], v[10:13], 0
  v_cmp_eq_u32 vcc, -1, v3
  v_cvt_pk_bf16_f32 v40, v40, v41
  v_cvt_pk_bf16_f32 v41, v42, v43
  ds_write_b64 v15, v[40:41] offset:1024
  v_cvt_pk_bf16_f32 v44, v44, v45
  v_cvt_pk_bf16_f32 v45, v46, v47
  ds_write_b64 v15, v[44:45] offset:1536
  ds_read_b128 v[36:39], v14 offset:1024
  v_cvt_pk_bf16_f32 v48, v48, v49
  v_cvt_pk_bf16_f32 v49, v50, v51
  ds_write_b64 v15, v[48:49] offset:8192
  s_cbranch_vccnz VO_h2r0
  s_waitcnt lgkmcnt(4)
  v_smfmac_f32_16x16x64_bf16 v[144:147], v[32:35], a[0:7], v8
  v_smfmac_f32_16x16x64_bf16 v[148:151], v[32:35], a[8:15], v8
  v_smfmac_f32_16x16x64_bf16 v[152:155], v[32:35], a[16:23], v8
  s_waitcnt lgkmcnt(0)
  s_barrier
  ds_read_b128 v[40:43], v14 offset:8192
  ds_read_b128 v[44:47], v14 offset:2048
  v_smfmac_f32_16x16x64_bf16 v[144:147], v[36:39], a[24:31], v8
  ds_read_b128 v[32:35], v14 offset:3072
  v_smfmac_f32_16x16x64_bf16 v[148:151], v[36:39], a[32:39], v8
  v_smfmac_f32_16x16x64_bf16 v[152:155], v[36:39], a[40:47], v8
  s_branch VO_vt0
VO_fz1:
  s_waitcnt vmcnt(7)
  v_max3_u32 v3, v32, v33, v34
  v_max_u32 v3, v3, v35
  v_mfma_f32_16x16x32_bf16 v[32:35], v[32:35], v[10:13], 0
  s_waitcnt vmcnt(6)
  v_max3_u32 v3, v36, v37, v3
  v_max3_u32 v3, v38, v39, v3
  v_mfma_f32_16x16x32_bf16 v[36:39], v[36:39], v[10:13], 0
  s_waitcnt vmcnt(5)
  v_max3_u32 v3, v40, v41, v3
  v_max3_u32 v3, v42, v43, v3
  v_mfma_f32_16x16x32_bf16 v[40:43], v[40:43], v[10:13], 0
  v_cvt_pk_bf16_f32 v32, v32, v33
  v_cvt_pk_bf16_f32 v33, v34, v35
  ds_write_b64 v15, v[32:33] offset:0
  s_waitcnt vmcnt(4)
  v_max3_u32 v3, v44, v45, v3
  v_max3_u32 v3, v46, v47, v3
  v_mfma_f32_16x16x32_bf16 v[44:47], v[44:47], v[10:13], 0
  v_cvt_pk_bf16_f32 v36, v36, v37
  v_cvt_pk_bf16_f32 v37, v38, v39
  ds_write_b64 v15, v[36:37] offset:512
  ds_read_b128 v[32:35], v14 offset:2048
  s_waitcnt vmcnt(3)
  v_max3_u32 v3, v48, v49, v3
  v_max3_u32 v3, v50, v51, v3
  v_mfma_f32_16x16x32_bf16 v[48:51], v[48:51], v[10:13], 0
  v_cmp_eq_u32 vcc, -1, v3
  v_cvt_pk_bf16_f32 v40, v40, v41
  v_cvt_pk_bf16_f32 v41, v42, v43
  ds_write_b64 v15, v[40:41] offset:1024
  v_cvt_pk_bf16_f32 v44, v44, v45
  v_cvt_pk_bf16_f32 v45, v46, v47
  ds_write_b64 v15, v[44:45] offset:1536
  ds_read_b128 v[36:39], v14 offset:3072
  v_cvt_pk_bf16_f32 v48, v48, v49
  v_cvt_pk_bf16_f32 v49, v50, v51
  ds_write_b64 v15, v[48:49] offset:6656
  s_cbranch_vccnz VO_h2r0
  s_waitcnt lgkmcnt(4)
  v_smfmac_f32_16x16x64_bf16 v[144:147], v[32:35], a[48:55], v8
  v_smfmac_f32_16x16x64_bf16 v[148:151], v[32:35], a[56:63], v8
  v_smfmac_f32_16x16x64_bf16 v[152:155], v[32:35], a[64:71], v8
  s_waitcnt lgkmcnt(0)
  s_barrier
  ds_read_b128 v[40:43], v14 offset:8192
  ds_read_b128 v[44:47], v14 offset:4096
  v_smfmac_f32_16x16x64_bf16 v[144:147], v[36:39], a[72:79], v8
  ds_read_b128 v[32:35], v14 offset:5120
  v_smfmac_f32_16x16x64_bf16 v[148:151], v[36:39], a[80:87], v8
  v_smfmac_f32_16x16x64_bf16 v[152:155], v[36:39], a[88:95], v8
  s_branch VO_vt1
VO_fz2:
  s_waitcnt vmcnt(7)
  v_max3_u32 v3, v32, v33, v34
  v_max_u32 v3, v3, v35
  v_mfma_f32_16x16x32_bf16 v[32:35], v[32:35], v[10:13], 0
  s_waitcnt vmcnt(6)
  v_max3_u32 v3, v36, v37, v3
  v_max3_u32 v3, v38, v39, v3
  v_mfma_f32_16x16x32_bf16 v[36:39], v[36:39], v[10:13], 0
  s_waitcnt vmcnt(5)
  v_max3_u32 v3, v40, v41, v3
  v_max3_u32 v3, v42, v43, v3
  v_mfma_f32_16x16x32_bf16 v[40:43], v[40:43], v[10:13], 0
  v_cvt_pk_bf16_f32 v32, v32, v33
  v_cvt_pk_bf16_f32 v33, v34, v35
  ds_write_b64 v15, v[32:33] offset:0
  s_waitcnt vmcnt(4)
  v_max3_u32 v3, v44, v45, v3
  v_max3_u32 v3, v46, v47, v3
  v_mfma_f32_16x16x32_bf16 v[44:47], v[44:47], v[10:13], 0
  v_cvt_pk_bf16_f32 v36, v36, v37
  v_cvt_pk_bf16_f32 v37, v38, v39
  ds_write_b64 v15, v[36:37] offset:512
  ds_read_b128 v[32:35], v14 offset:4096
  s_waitcnt vmcnt(3)
  v_max3_u32 v3, v48, v49, v3
  v_max3_u32 v3, v50, v51, v3
  v_mfma_f32_16x16x32_bf16 v[48:51], v[48:51], v[10:13], 0
  v_cmp_eq_u32 vcc, -1, v3
  v_cvt_pk_bf16_f32 v40, v40, v41
  v_cvt_pk_bf16_f32 v41, v42, v43
  ds_write_b64 v15, v[40:41] offset:1024
  v_cvt_pk_bf16_f32 v44, v44, v45
  v_cvt_pk_bf16_f32 v45, v46, v47
  ds_write_b64 v15, v[44:45] offset:1536
  ds_read_b128 v[36:39], v14 offset:5120
  v_cvt_pk_bf16_f32 v48, v48, v49
  v_cvt_pk_bf16_f32 v49, v50, v51
  ds_write_b64 v15, v[48:49] offset:5120
  s_cbranch_vccnz VO_h2r0
  s_waitcnt lgkmcnt(4)
  v_smfmac_f32_16x16x64_bf16 v[144:147], v[32:35], a[96:103], v8
  v_smfmac_f32_16x16x64_bf16 v[148:151], v[32:35], a[104:111], v8
  v_smfmac_f32_16x16x64_bf16 v[152:155], v[32:35], a[112:119], v8
  s_waitcnt lgkmcnt(0)
  s_barrier
  ds_read_b128 v[40:43], v14 offset:8192
  ds_read_b128 v[44:47], v14 offset:6144
  v_smfmac_f32_16x16x64_bf16 v[144:147], v[36:39], a[120:127], v8
  ds_read_b128 v[32:35], v14 offset:7168
  v_smfmac_f32_16x16x64_bf16 v[148:151], v[36:39], a[128:135], v8
  v_smfmac_f32_16x16x64_bf16 v[152:155], v[36:39], a[136:143], v8
  s_branch VO_vt2
VO_h2r0:
  s_waitcnt lgkmcnt(0)
VO_h2r:
  buffer_load_dwordx4 v[32:35], v16, s[8:11], s48 offen sc1
  buffer_load_dwordx4 v[36:39], v16, s[8:11], s49 offen sc1
  buffer_load_dwordx4 v[40:43], v16, s[8:11], s50 offen sc1
  buffer_load_dwordx4 v[44:47], v16, s[8:11], s51 offen sc1
  buffer_load_dwordx4 v[48:51], v16, s[8:11], s52 offen sc1
  s_sub_u32 s82, s82, 1
  s_cbranch_scc1 L_abort
  s_waitcnt vmcnt(4)
  v_max3_u32 v3, v32, v33, v34
  v_max_u32 v3, v3, v35
  v_mfma_f32_16x16x32_bf16 v[32:35], v[32:35], v[10:13], 0
  s_waitcnt vmcnt(3)
  v_max3_u32 v3, v36, v37, v3
  v_max3_u32 v3, v38, v39, v3
  v_mfma_f32_16x16x32_bf16 v[36:39], v[36:39], v[10:13], 0
  s_waitcnt vmcnt(2)
  v_max3_u32 v3, v40, v41, v3
  v_max3_u32 v3, v42, v43, v3
  v_mfma_f32_16x16x32_bf16 v[40:43], v[40:43], v[10:13], 0
  s_waitcnt vmcnt(1)
  v_max3_u32 v3, v44, v45, v3
  v_max3_u32 v3, v46, v47, v3
  v_mfma_f32_16x16x32_bf16 v[44:47], v[44:47], v[10:13], 0
  v_cvt_pk_bf16_f32 v32, v32, v33
  v_cvt_pk_bf16_f32 v33, v34, v35
  ds_write_b64 v15, v[32:33] offset:0
  s_waitcnt vmcnt(0)
  v_max3_u32 v3, v48, v49, v3
  v_max3_u32 v3, v50, v51, v3
  v_mfma_f32_16x16x32_bf16 v[48:51], v[48:51], v[10:13], 0
  v_cvt_pk_bf16_f32 v36, v36, v37
  v_cvt_pk_bf16_f32 v37, v38, v39
  ds_write_b64 v15, v[36:37] offset:512
  v_cmp_eq_u32 vcc, -1, v3
  v_cvt_pk_bf16_f32 v40, v40, v41
  v_cvt_pk_bf16_f32 v41, v42, v43
  ds_write_b64 v15, v[40:41] offset:1024
  v_cvt_pk_bf16_f32 v44, v44, v45
  v_cvt_pk_bf16_f32 v45, v46, v47
  ds_write_b64 v15, v[44:45] offset:1536
  s_nop 0
  v_cvt_pk_bf16_f32 v48, v48, v49
  v_cvt_pk_bf16_f32 v49, v50, v51
  v_add_u32 v4, s85, v15
  ds_write_b64 v4, v[48:49]
  s_cbranch_vccnz VO_h2r
  s_branch VO_loop
VO_pe:
  buffer_load_dwordx4 v[132:135], v27, s[8:11], s46 offen sc1
  buffer_load_dwordx4 v[136:139], v27, s[8:11], s46 offen offset:1280 sc1
  buffer_load_dwordx2 v[140:141], v28, s[8:11], s46 offen sc1
  s_waitcnt vmcnt(3)
  v_bitop3_b32 v2, v120, v121, s91 bitop3:126
  v_bitop3_b32 v3, v122, v123, s91 bitop3:126
  v_bitop3_b32 v4, v124, v125, s91 bitop3:126
  v_or3_b32 v2, v2, v3, v4
  v_bitop3_b32 v3, v126, v127, s91 bitop3:126
  v_bitop3_b32 v4, v128, v129, s91 bitop3:126
  v_or3_b32 v2, v2, v3, v4
  v_bitop3_b32 v3, v130, v131, s91 bitop3:126
  v_or_b32 v2, v2, v3
  v_and_b32 v2, 1, v2
  v_cmp_ne_u32 vcc, 0, v2
  s_cbranch_vccnz VO_ybad
  s_branch VO_pbad2
VO_pbad:
  buffer_load_dwordx4 v[132:135], v27, s[8:11], s46 offen sc1
  buffer_load_dwordx4 v[136:139], v27, s[8:11], s46 offen offset:1280 sc1
  buffer_load_dwordx2 v[140:141], v28, s[8:11], s46 offen sc1
  v_and_b32 v2, 1, v2
  v_cmp_ne_u32 vcc, 0, v2
  s_cbranch_vccnz VO_ybad
VO_pbad2:
  s_sub_u32 s82, s82, 1
  s_cbranch_scc1 L_abort
  v_mov_b32 v144, 0
  v_mov_b32 v145, 0
  v_mov_b32 v146, 0
  v_mov_b32 v147, 0
  v_mov_b32 v148, 0
  v_mov_b32 v149, 0
  v_mov_b32 v150, 0
  v_mov_b32 v151, 0
  v_mov_b32 v152, 0
  v_mov_b32 v153, 0
  v_mov_b32 v154, 0
  v_mov_b32 v155, 0
  s_waitcnt vmcnt(2)
  v_smfmac_f32_16x16x64_bf16 v[144:147], v[132:135], v[72:79], v8 abid:1
  v_bitop3_b32 v1, v132, v133, s29 bitop3:126
  v_smfmac_f32_16x16x64_bf16 v[148:151], v[132:135], v[88:95], v8 abid:1
  v_bitop3_b32 v2, v134, v135, s29 bitop3:126
  v_smfmac_f32_16x16x64_bf16 v[152:155], v[132:135], v[104:111], v8 abid:1
  s_waitcnt vmcnt(1)
  v_smfmac_f32_16x16x64_bf16 v[144:147], v[136:139], v[80:87], v8 abid:1
  v_bitop3_b32 v3, v136, v137, s29 bitop3:126
  v_smfmac_f32_16x16x64_bf16 v[148:151], v[136:139], v[96:103], v8 abid:1
  v_bitop3_b32 v4, v138, v139, s29 bitop3:126
  v_smfmac_f32_16x16x64_bf16 v[152:155], v[136:139], v[112:119], v8 abid:1
  v_or3_b32 v1, v1, v2, v3
  s_waitcnt vmcnt(0)
  v_smfmac_f32_16x16x32_bf16 v[144:147], v[140:141], v[120:123], v8 abid:2
  v_bitop3_b32 v2, v140, v141, s29 bitop3:126
  v_smfmac_f32_16x16x32_bf16 v[148:151], v[140:141], v[124:127], v8 abid:2
  v_or3_b32 v1, v1, v4, v2
  v_smfmac_f32_16x16x32_bf16 v[152:155], v[140:141], v[128:131], v8 abid:2
  v_cmp_gt_i32 vcc, 0, v1
  s_cbranch_vccz VO_pok
  buffer_load_dwordx4 v[132:135], v27, s[8:11], s46 offen sc1
  buffer_load_dwordx4 v[136:139], v27, s[8:11], s46 offen offset:1280 sc1
  buffer_load_dwordx2 v[140:141], v28, s[8:11], s46 offen sc1
  s_branch VO_pbad2
VO_ybad:
  buffer_load_dwordx4 v[120:123], v22, s[8:11], s90 offen sc1
  buffer_load_dwordx4 v[124:127], v22, s[8:11], s90 offen offset:256 sc1
  buffer_load_dwordx4 v[128:131], v23, s[8:11], s90 offen sc1
  s_sub_u32 s82, s82, 1
  s_cbranch_scc1 L_abort
  v_mov_b32 v144, 0
  v_mov_b32 v145, 0
  v_mov_b32 v146, 0
  v_mov_b32 v147, 0
  v_mov_b32 v148, 0
  v_mov_b32 v149, 0
  v_mov_b32 v150, 0
  v_mov_b32 v151, 0
  v_mov_b32 v152, 0
  v_mov_b32 v153, 0
  v_mov_b32 v154, 0
  v_mov_b32 v155, 0
  s_waitcnt vmcnt(5)
  v_smfmac_f32_16x16x64_bf16 v[144:147], v[132:135], v[72:79], v8 abid:1
  v_bitop3_b32 v1, v132, v133, s29 bitop3:126
  v_smfmac_f32_16x16x64_bf16 v[148:151], v[132:135], v[88:95], v8 abid:1
  v_bitop3_b32 v2, v134, v135, s29 bitop3:126
  v_smfmac_f32_16x16x64_bf16 v[152:155], v[132:135], v[104:111], v8 abid:1
  s_waitcnt vmcnt(4)
  v_smfmac_f32_16x16x64_bf16 v[144:147], v[136:139], v[80:87], v8 abid:1
  v_bitop3_b32 v3, v136, v137, s29 bitop3:126
  v_smfmac_f32_16x16x64_bf16 v[148:151], v[136:139], v[96:103], v8 abid:1
  v_bitop3_b32 v4, v138, v139, s29 bitop3:126
  v_smfmac_f32_16x16x64_bf16 v[152:155], v[136:139], v[112:119], v8 abid:1
  v_or3_b32 v1, v1, v2, v3
  s_waitcnt vmcnt(2)
  v_smfmac_f32_16x16x32_bf16 v[144:147], v[140:141], v[120:123], v8 abid:2
  v_bitop3_b32 v2, v140, v141, s29 bitop3:126
  v_or3_b32 v1, v1, v4, v2
  v_bitop3_b32 v2, v120, v121, s91 bitop3:126
  v_bitop3_b32 v3, v122, v123, s91 bitop3:126
  s_waitcnt vmcnt(1)
  v_smfmac_f32_16x16x32_bf16 v[148:151], v[140:141], v[124:127], v8 abid:2
  v_bitop3_b32 v4, v124, v125, s91 bitop3:126
  v_or3_b32 v2, v2, v3, v4
  v_bitop3_b32 v3, v126, v127, s91 bitop3:126
  s_waitcnt vmcnt(0)
  v_smfmac_f32_16x16x32_bf16 v[152:155], v[140:141], v[128:131], v8 abid:2
  v_bitop3_b32 v4, v128, v129, s91 bitop3:126
  v_or3_b32 v2, v2, v3, v4
  v_bitop3_b32 v3, v130, v131, s91 bitop3:126
  v_or_b32 v2, v2, v3
  v_lshl_or_b32 v1, v2, 31, v1
  v_cmp_gt_i32 vcc, 0, v1
  s_cbranch_vccnz VO_pbad
  s_branch VO_pok
VO_last:
  v_cvt_pk_bf16_f32 v32, v52, v53
  v_cvt_pk_bf16_f32 v33, v54, v55
  v_cvt_pk_bf16_f32 v34, v56, v57
  v_cvt_pk_bf16_f32 v35, v58, v59
  v_and_or_b32 v32, v32, -2, s91
  v_and_or_b32 v33, v33, -2, s91
  v_and_or_b32 v34, v34, -2, s91
  v_and_or_b32 v35, v35, -2, s91
  v_cvt_pk_bf16_f32 v36, v60, v61
  v_cvt_pk_bf16_f32 v37, v62, v63
  v_permlane16_swap_b32 v32, v34
  v_permlane16_swap_b32 v33, v35
  v_cvt_pk_bf16_f32 v38, v64, v65
  v_cvt_pk_bf16_f32 v39, v66, v67
  buffer_store_dwordx4 v[32:35], v9, s[8:11], s54 offen sc1
  v_and_or_b32 v36, v36, -2, s91
  v_and_or_b32 v37, v37, -2, s91
  v_and_or_b32 v38, v38, -2, s91
  v_and_or_b32 v39, v39, -2, s91
  v_cvt_pk_bf16_f32 v40, v68, v69
  v_cvt_pk_bf16_f32 v41, v70, v71
  v_permlane16_swap_b32 v36, v38
  v_permlane16_swap_b32 v37, v39
  v_and_or_b32 v40, v40, -2, s91
  v_and_or_b32 v41, v41, -2, s91
  buffer_store_dwordx4 v[36:39], v9, s[8:11], s54 offen offset:1024 sc1
  buffer_store_dwordx2 v[40:41], v21, s[8:11], s54 offen offset:2048 sc1
  s_waitcnt vmcnt(0)
  s_barrier
  v_mov_b32 v2, 64
  v_mov_b32 v3, 0
  s_mov_b64 exec, 1
  buffer_store_dword v2, v3, s[8:11], s34 offen offset:4 sc1
  s_waitcnt vmcnt(0)
  s_mov_b64 exec, -1
  s_branch VO_end
VOS_loop:
  s_waitcnt lgkmcnt(0)
  s_barrier
  s_cmp_eq_u32 s24, 0
  s_cbranch_scc1 VOS_vw0
  s_cmp_eq_u32 s24, 1
  s_cbranch_scc1 VOS_vw1
  s_cmp_eq_u32 s24, 2
  s_cbranch_scc1 VOS_vw2
VOS_vw3:
  ds_read_b128 v[32:35], v14 offset:6144
  ds_read_b128 v[36:39], v14 offset:7168
  ds_read_b128 v[40:43], v14 offset:8192
  s_waitcnt lgkmcnt(2)
  v_smfmac_f32_16x16x64_bf16 v[144:147], v[32:35], a[144:151], v8
  ds_read_b128 v[44:47], v14 offset:0
  v_smfmac_f32_16x16x64_bf16 v[148:151], v[32:35], a[152:159], v8
  v_smfmac_f32_16x16x64_bf16 v[152:155], v[32:35], a[160:167], v8
  s_waitcnt lgkmcnt(2)
  v_smfmac_f32_16x16x64_bf16 v[144:147], v[36:39], a[168:175], v8
  ds_read_b128 v[32:35], v14 offset:1024
  v_smfmac_f32_16x16x64_bf16 v[148:151], v[36:39], a[176:183], v8
  v_smfmac_f32_16x16x64_bf16 v[152:155], v[36:39], a[184:191], v8
VOS_vt3:
  buffer_load_dwordx4 v[76:79], v24, s[8:11], s93 offen
  s_waitcnt lgkmcnt(2)
  v_smfmac_f32_16x16x64_bf16 v[144:147], v[40:43], v[120:127], v8
  ds_read_b128 v[36:39], v14 offset:2048
  v_smfmac_f32_16x16x64_bf16 v[148:151], v[40:43], v[128:135], v8
  v_smfmac_f32_16x16x64_bf16 v[152:155], v[40:43], v[136:143], v8
  buffer_load_dwordx4 v[92:95], v25, s[8:11], s93 offen
  s_waitcnt lgkmcnt(2)
  v_smfmac_f32_16x16x64_bf16 v[144:147], v[44:47], a[0:7], v8
  ds_read_b128 v[40:43], v14 offset:3072
  v_smfmac_f32_16x16x64_bf16 v[148:151], v[44:47], a[8:15], v8
  ds_read_b128 v[120:123], v6 offset:24576
  v_smfmac_f32_16x16x64_bf16 v[152:155], v[44:47], a[16:23], v8
  ds_read_b128 v[124:127], v6 offset:25600
  buffer_load_dwordx4 v[108:111], v26, s[8:11], s93 offen
  s_waitcnt lgkmcnt(4)
  v_smfmac_f32_16x16x64_bf16 v[144:147], v[32:35], a[24:31], v8
  ds_read_b128 v[44:47], v14 offset:9216
  v_smfmac_f32_16x16x64_bf16 v[148:151], v[32:35], a[32:39], v8
  ds_read_b128 v[128:131], v6 offset:26624
  v_smfmac_f32_16x16x64_bf16 v[152:155], v[32:35], a[40:47], v8
  ds_read_b128 v[132:135], v6 offset:27648
  buffer_load_dwordx4 v[80:83], v24, s[8:11], s94 offen
  s_waitcnt lgkmcnt(6)
  v_smfmac_f32_16x16x64_bf16 v[144:147], v[36:39], a[48:55], v8
  ds_read_b128 v[32:35], v14 offset:4096
  v_smfmac_f32_16x16x64_bf16 v[148:151], v[36:39], a[56:63], v8
  ds_read_b128 v[136:139], v6 offset:28672
  v_smfmac_f32_16x16x64_bf16 v[152:155], v[36:39], a[64:71], v8
  ds_read_b128 v[140:143], v6 offset:29696
  buffer_load_dwordx4 v[96:99], v25, s[8:11], s94 offen
  s_waitcnt lgkmcnt(8)
  v_smfmac_f32_16x16x64_bf16 v[144:147], v[40:43], a[72:79], v8
  ds_read_b128 v[36:39], v14 offset:5120
  v_smfmac_f32_16x16x64_bf16 v[148:151], v[40:43], a[80:87], v8
  v_smfmac_f32_16x16x64_bf16 v[152:155], v[40:43], a[88:95], v8
  buffer_load_dwordx4 v[112:115], v26, s[8:11], s94 offen
  s_waitcnt lgkmcnt(1)
  v_smfmac_f32_16x16x64_bf16 v[144:147], v[44:47], v[120:127], v8
  v_smfmac_f32_16x16x64_bf16 v[148:151], v[44:47], v[128:135], v8
  v_smfmac_f32_16x16x64_bf16 v[152:155], v[44:47], v[136:143], v8
  buffer_load_dwordx4 v[84:87], v24, s[8:11], s95 offen
  v_smfmac_f32_16x16x64_bf16 v[144:147], v[32:35], a[96:103], v8
  ds_read_b128 v[120:123], v7 offset:0
  v_smfmac_f32_16x16x64_bf16 v[148:151], v[32:35], a[104:111], v8
  ds_read_b128 v[124:127], v7 offset:20480
  v_smfmac_f32_16x16x64_bf16 v[152:155], v[32:35], a[112:119], v8
  ds_read_b128 v[128:131], v7 offset:1024
  buffer_load_dwordx4 v[100:103], v25, s[8:11], s95 offen
  s_waitcnt lgkmcnt(3)
  v_smfmac_f32_16x16x64_bf16 v[144:147], v[36:39], a[120:127], v8
  ds_read_b128 v[132:135], v7 offset:21504
  v_smfmac_f32_16x16x64_bf16 v[148:151], v[36:39], a[128:135], v8
  ds_read_b128 v[136:139], v7 offset:2048
  v_smfmac_f32_16x16x64_bf16 v[152:155], v[36:39], a[136:143], v8
  ds_read_b128 v[140:143], v7 offset:22528
  buffer_load_dwordx4 v[116:119], v26, s[8:11], s95 offen
  s_branch VOS_vpost
VOS_vw0:
  ds_read_b128 v[32:35], v14 offset:0
  ds_read_b128 v[36:39], v14 offset:1024
  ds_read_b128 v[40:43], v14 offset:8192
  s_waitcnt lgkmcnt(2)
  v_smfmac_f32_16x16x64_bf16 v[144:147], v[32:35], a[0:7], v8
  ds_read_b128 v[44:47], v14 offset:2048
  v_smfmac_f32_16x16x64_bf16 v[148:151], v[32:35], a[8:15], v8
  v_smfmac_f32_16x16x64_bf16 v[152:155], v[32:35], a[16:23], v8
  s_waitcnt lgkmcnt(2)
  v_smfmac_f32_16x16x64_bf16 v[144:147], v[36:39], a[24:31], v8
  ds_read_b128 v[32:35], v14 offset:3072
  v_smfmac_f32_16x16x64_bf16 v[148:151], v[36:39], a[32:39], v8
  v_smfmac_f32_16x16x64_bf16 v[152:155], v[36:39], a[40:47], v8
VOS_vt0:
  buffer_load_dwordx4 v[76:79], v24, s[8:11], s93 offen
  s_waitcnt lgkmcnt(2)
  v_smfmac_f32_16x16x64_bf16 v[144:147], v[40:43], v[120:127], v8
  ds_read_b128 v[36:39], v14 offset:4096
  v_smfmac_f32_16x16x64_bf16 v[148:151], v[40:43], v[128:135], v8
  v_smfmac_f32_16x16x64_bf16 v[152:155], v[40:43], v[136:143], v8
  buffer_load_dwordx4 v[92:95], v25, s[8:11], s93 offen
  s_waitcnt lgkmcnt(2)
  v_smfmac_f32_16x16x64_bf16 v[144:147], v[44:47], a[48:55], v8
  ds_read_b128 v[40:43], v14 offset:5120
  v_smfmac_f32_16x16x64_bf16 v[148:151], v[44:47], a[56:63], v8
  ds_read_b128 v[120:123], v6 offset:24576
  v_smfmac_f32_16x16x64_bf16 v[152:155], v[44:47], a[64:71], v8
  ds_read_b128 v[124:127], v6 offset:25600
  buffer_load_dwordx4 v[108:111], v26, s[8:11], s93 offen
  s_waitcnt lgkmcnt(4)
  v_smfmac_f32_16x16x64_bf16 v[144:147], v[32:35], a[72:79], v8
  ds_read_b128 v[44:47], v14 offset:9216
  v_smfmac_f32_16x16x64_bf16 v[148:151], v[32:35], a[80:87], v8
  ds_read_b128 v[128:131], v6 offset:26624
  v_smfmac_f32_16x16x64_bf16 v[152:155], v[32:35], a[88:95], v8
  ds_read_b128 v[132:135], v6 offset:27648
  buffer_load_dwordx4 v[80:83], v24, s[8:11], s94 offen
  s_waitcnt lgkmcnt(6)
  v_smfmac_f32_16x16x64_bf16 v[144:147], v[36:39], a[96:103], v8
  ds_read_b128 v[32:35], v14 offset:6144
  v_smfmac_f32_16x16x64_bf16 v[148:151], v[36:39], a[104:111], v8
  ds_read_b128 v[136:139], v6 offset:28672
  v_smfmac_f32_16x16x64_bf16 v[152:155], v[36:39], a[112:119], v8
  ds_read_b128 v[140:143], v6 offset:29696
  buffer_load_dwordx4 v[96:99], v25, s[8:11], s94 offen
  s_waitcnt lgkmcnt(8)
  v_smfmac_f32_16x16x64_bf16 v[144:147], v[40:43], a[120:127], v8
  ds_read_b128 v[36:39], v14 offset:7168
  v_smfmac_f32_16x16x64_bf16 v[148:151], v[40:43], a[128:135], v8
  v_smfmac_f32_16x16x64_bf16 v[152:155], v[40:43], a[136:143], v8
  buffer_load_dwordx4 v[112:115], v26, s[8:11], s94 offen
  s_waitcnt lgkmcnt(1)
  v_smfmac_f32_16x16x64_bf16 v[144:147], v[44:47], v[120:127], v8
  v_smfmac_f32_16x16x64_bf16 v[148:151], v[44:47], v[128:135], v8
  v_smfmac_f32_16x16x64_bf16 v[152:155], v[44:47], v[136:143], v8
  buffer_load_dwordx4 v[84:87], v24, s[8:11], s95 offen
  v_smfmac_f32_16x16x64_bf16 v[144:147], v[32:35], a[144:151], v8
  ds_read_b128 v[120:123], v7 offset:0
  v_smfmac_f32_16x16x64_bf16 v[148:151], v[32:35], a[152:159], v8
  ds_read_b128 v[124:127], v7 offset:20480
  v_smfmac_f32_16x16x64_bf16 v[152:155], v[32:35], a[160:167], v8
  ds_read_b128 v[128:131], v7 offset:1024
  buffer_load_dwordx4 v[100:103], v25, s[8:11], s95 offen
  s_waitcnt lgkmcnt(3)
  v_smfmac_f32_16x16x64_bf16 v[144:147], v[36:39], a[168:175], v8
  ds_read_b128 v[132:135], v7 offset:21504
  v_smfmac_f32_16x16x64_bf16 v[148:151], v[36:39], a[176:183], v8
  ds_read_b128 v[136:139], v7 offset:2048
  v_smfmac_f32_16x16x64_bf16 v[152:155], v[36:39], a[184:191], v8
  ds_read_b128 v[140:143], v7 offset:22528
  buffer_load_dwordx4 v[116:119], v26, s[8:11], s95 offen
  s_branch VOS_vpost
VOS_vw1:
  ds_read_b128 v[32:35], v14 offset:2048
  ds_read_b128 v[36:39], v14 offset:3072
  ds_read_b128 v[40:43], v14 offset:8192
  s_waitcnt lgkmcnt(2)
  v_smfmac_f32_16x16x64_bf16 v[144:147], v[32:35], a[48:55], v8
  ds_read_b128 v[44:47], v14 offset:4096
  v_smfmac_f32_16x16x64_bf16 v[148:151], v[32:35], a[56:63], v8
  v_smfmac_f32_16x16x64_bf16 v[152:155], v[32:35], a[64:71], v8
  s_waitcnt lgkmcnt(2)
  v_smfmac_f32_16x16x64_bf16 v[144:147], v[36:39], a[72:79], v8
  ds_read_b128 v[32:35], v14 offset:5120
  v_smfmac_f32_16x16x64_bf16 v[148:151], v[36:39], a[80:87], v8
  v_smfmac_f32_16x16x64_bf16 v[152:155], v[36:39], a[88:95], v8
VOS_vt1:
  buffer_load_dwordx4 v[76:79], v24, s[8:11], s93 offen
  s_waitcnt lgkmcnt(2)
  v_smfmac_f32_16x16x64_bf16 v[144:147], v[40:43], v[120:127], v8
  ds_read_b128 v[36:39], v14 offset:6144
  v_smfmac_f32_16x16x64_bf16 v[148:151], v[40:43], v[128:135], v8
  v_smfmac_f32_16x16x64_bf16 v[152:155], v[40:43], v[136:143], v8
  buffer_load_dwordx4 v[92:95], v25, s[8:11], s93 offen
  s_waitcnt lgkmcnt(2)
  v_smfmac_f32_16x16x64_bf16 v[144:147], v[44:47], a[96:103], v8
  ds_read_b128 v[40:43], v14 offset:7168
  v_smfmac_f32_16x16x64_bf16 v[148:151], v[44:47], a[104:111], v8
  ds_read_b128 v[120:123], v6 offset:24576
  v_smfmac_f32_16x16x64_bf16 v[152:155], v[44:47], a[112:119], v8
  ds_read_b128 v[124:127], v6 offset:25600
  buffer_load_dwordx4 v[108:111], v26, s[8:11], s93 offen
  s_waitcnt lgkmcnt(4)
  v_smfmac_f32_16x16x64_bf16 v[144:147], v[32:35], a[120:127], v8
  ds_read_b128 v[44:47], v14 offset:9216
  v_smfmac_f32_16x16x64_bf16 v[148:151], v[32:35], a[128:135], v8
  ds_read_b128 v[128:131], v6 offset:26624
  v_smfmac_f32_16x16x64_bf16 v[152:155], v[32:35], a[136:143], v8
  ds_read_b128 v[132:135], v6 offset:27648
  buffer_load_dwordx4 v[80:83], v24, s[8:11], s94 offen
  s_waitcnt lgkmcnt(6)
  v_smfmac_f32_16x16x64_bf16 v[144:147], v[36:39], a[144:151], v8
  ds_read_b128 v[32:35], v14 offset:0
  v_smfmac_f32_16x16x64_bf16 v[148:151], v[36:39], a[152:159], v8
  ds_read_b128 v[136:139], v6 offset:28672
  v_smfmac_f32_16x16x64_bf16 v[152:155], v[36:39], a[160:167], v8
  ds_read_b128 v[140:143], v6 offset:29696
  buffer_load_dwordx4 v[96:99], v25, s[8:11], s94 offen
  s_waitcnt lgkmcnt(8)
  v_smfmac_f32_16x16x64_bf16 v[144:147], v[40:43], a[168:175], v8
  ds_read_b128 v[36:39], v14 offset:1024
  v_smfmac_f32_16x16x64_bf16 v[148:151], v[40:43], a[176:183], v8
  v_smfmac_f32_16x16x64_bf16 v[152:155], v[40:43], a[184:191], v8
  buffer_load_dwordx4 v[112:115], v26, s[8:11], s94 offen
  s_waitcnt lgkmcnt(1)
  v_smfmac_f32_16x16x64_bf16 v[144:147], v[44:47], v[120:127], v8
  v_smfmac_f32_16x16x64_bf16 v[148:151], v[44:47], v[128:135], v8
  v_smfmac_f32_16x16x64_bf16 v[152:155], v[44:47], v[136:143], v8
  buffer_load_dwordx4 v[84:87], v24, s[8:11], s95 offen
  v_smfmac_f32_16x16x64_bf16 v[144:147], v[32:35], a[0:7], v8
  ds_read_b128 v[120:123], v7 offset:0
  v_smfmac_f32_16x16x64_bf16 v[148:151], v[32:35], a[8:15], v8
  ds_read_b128 v[124:127], v7 offset:20480
  v_smfmac_f32_16x16x64_bf16 v[152:155], v[32:35], a[16:23], v8
  ds_read_b128 v[128:131], v7 offset:1024
  buffer_load_dwordx4 v[100:103], v25, s[8:11], s95 offen
  s_waitcnt lgkmcnt(3)
  v_smfmac_f32_16x16x64_bf16 v[144:147], v[36:39], a[24:31], v8
  ds_read_b128 v[132:135], v7 offset:21504
  v_smfmac_f32_16x16x64_bf16 v[148:151], v[36:39], a[32:39], v8
  ds_read_b128 v[136:139], v7 offset:2048
  v_smfmac_f32_16x16x64_bf16 v[152:155], v[36:39], a[40:47], v8
  ds_read_b128 v[140:143], v7 offset:22528
  buffer_load_dwordx4 v[116:119], v26, s[8:11], s95 offen
  s_branch VOS_vpost
VOS_vw2:
  ds_read_b128 v[32:35], v14 offset:4096
  ds_read_b128 v[36:39], v14 offset:5120
  ds_read_b128 v[40:43], v14 offset:8192
  s_waitcnt lgkmcnt(2)
  v_smfmac_f32_16x16x64_bf16 v[144:147], v[32:35], a[96:103], v8
  ds_read_b128 v[44:47], v14 offset:6144
  v_smfmac_f32_16x16x64_bf16 v[148:151], v[32:35], a[104:111], v8
  v_smfmac_f32_16x16x64_bf16 v[152:155], v[32:35], a[112:119], v8
  s_waitcnt lgkmcnt(2)
  v_smfmac_f32_16x16x64_bf16 v[144:147], v[36:39], a[120:127], v8
  ds_read_b128 v[32:35], v14 offset:7168
  v_smfmac_f32_16x16x64_bf16 v[148:151], v[36:39], a[128:135], v8
  v_smfmac_f32_16x16x64_bf16 v[152:155], v[36:39], a[136:143], v8
VOS_vt2:
  buffer_load_dwordx4 v[76:79], v24, s[8:11], s93 offen
  s_waitcnt lgkmcnt(2)
  v_smfmac_f32_16x16x64_bf16 v[144:147], v[40:43], v[120:127], v8
  ds_read_b128 v[36:39], v14 offset:0
  v_smfmac_f32_16x16x64_bf16 v[148:151], v[40:43], v[128:135], v8
  v_smfmac_f32_16x16x64_bf16 v[152:155], v[40:43], v[136:143], v8
  buffer_load_dwordx4 v[92:95], v25, s[8:11], s93 offen
  s_waitcnt lgkmcnt(2)
  v_smfmac_f32_16x16x64_bf16 v[144:147], v[44:47], a[144:151], v8
  ds_read_b128 v[40:43], v14 offset:1024
  v_smfmac_f32_16x16x64_bf16 v[148:151], v[44:47], a[152:159], v8
  ds_read_b128 v[120:123], v6 offset:24576
  v_smfmac_f32_16x16x64_bf16 v[152:155], v[44:47], a[160:167], v8
  ds_read_b128 v[124:127], v6 offset:25600
  buffer_load_dwordx4 v[108:111], v26, s[8:11], s93 offen
  s_waitcnt lgkmcnt(4)
  v_smfmac_f32_16x16x64_bf16 v[144:147], v[32:35], a[168:175], v8
  ds_read_b128 v[44:47], v14 offset:9216
  v_smfmac_f32_16x16x64_bf16 v[148:151], v[32:35], a[176:183], v8
  ds_read_b128 v[128:131], v6 offset:26624
  v_smfmac_f32_16x16x64_bf16 v[152:155], v[32:35], a[184:191], v8
  ds_read_b128 v[132:135], v6 offset:27648
  buffer_load_dwordx4 v[80:83], v24, s[8:11], s94 offen
  s_waitcnt lgkmcnt(6)
  v_smfmac_f32_16x16x64_bf16 v[144:147], v[36:39], a[0:7], v8
  ds_read_b128 v[32:35], v14 offset:2048
  v_smfmac_f32_16x16x64_bf16 v[148:151], v[36:39], a[8:15], v8
  ds_read_b128 v[136:139], v6 offset:28672
  v_smfmac_f32_16x16x64_bf16 v[152:155], v[36:39], a[16:23], v8
  ds_read_b128 v[140:143], v6 offset:29696
  buffer_load_dwordx4 v[96:99], v25, s[8:11], s94 offen
  s_waitcnt lgkmcnt(8)
  v_smfmac_f32_16x16x64_bf16 v[144:147], v[40:43], a[24:31], v8
  ds_read_b128 v[36:39], v14 offset:3072
  v_smfmac_f32_16x16x64_bf16 v[148:151], v[40:43], a[32:39], v8
  v_smfmac_f32_16x16x64_bf16 v[152:155], v[40:43], a[40:47], v8
  buffer_load_dwordx4 v[112:115], v26, s[8:11], s94 offen
  s_waitcnt lgkmcnt(1)
  v_smfmac_f32_16x16x64_bf16 v[144:147], v[44:47], v[120:127], v8
  v_smfmac_f32_16x16x64_bf16 v[148:151], v[44:47], v[128:135], v8
  v_smfmac_f32_16x16x64_bf16 v[152:155], v[44:47], v[136:143], v8
  buffer_load_dwordx4 v[84:87], v24, s[8:11], s95 offen
  v_smfmac_f32_16x16x64_bf16 v[144:147], v[32:35], a[48:55], v8
  ds_read_b128 v[120:123], v7 offset:0
  v_smfmac_f32_16x16x64_bf16 v[148:151], v[32:35], a[56:63], v8
  ds_read_b128 v[124:127], v7 offset:20480
  v_smfmac_f32_16x16x64_bf16 v[152:155], v[32:35], a[64:71], v8
  ds_read_b128 v[128:131], v7 offset:1024
  buffer_load_dwordx4 v[100:103], v25, s[8:11], s95 offen
  s_waitcnt lgkmcnt(3)
  v_smfmac_f32_16x16x64_bf16 v[144:147], v[36:39], a[72:79], v8
  ds_read_b128 v[132:135], v7 offset:21504
  v_smfmac_f32_16x16x64_bf16 v[148:151], v[36:39], a[80:87], v8
  ds_read_b128 v[136:139], v7 offset:2048
  v_smfmac_f32_16x16x64_bf16 v[152:155], v[36:39], a[88:95], v8
  ds_read_b128 v[140:143], v7 offset:22528
  buffer_load_dwordx4 v[116:119], v26, s[8:11], s95 offen
VOS_vpost:
  s_nop 3
  v_permlane32_swap_b32 v144, v148
  v_permlane32_swap_b32 v145, v149
  v_permlane32_swap_b32 v146, v150
  v_permlane32_swap_b32 v147, v151
  v_permlane32_swap_b32 v152, v36
  v_permlane32_swap_b32 v153, v37
  v_permlane32_swap_b32 v154, v38
  v_permlane32_swap_b32 v155, v39
  v_pk_add_f32 v[32:33], v[144:145], v[148:149]
  v_pk_add_f32 v[34:35], v[146:147], v[150:151]
  v_cvt_pk_bf16_f32 v32, v32, v33
  v_cvt_pk_bf16_f32 v33, v34, v35
  v_pk_add_f32 v[36:37], v[152:153], v[36:37]
  v_pk_add_f32 v[38:39], v[154:155], v[38:39]
  ds_write_b64 v18, v[32:33]
  v_cvt_pk_bf16_f32 v36, v36, v37
  v_cvt_pk_bf16_f32 v37, v38, v39
  ds_write_b64 v19, v[36:37]
  v_mbcnt_lo_u32_b32 v4, -1, 0
  v_mbcnt_hi_u32_b32 v4, -1, v4
  v_and_b32 v0, 0, v4
  v_add_lshl_u32 v4, v4, v0, 2
  buffer_load_dword v0, v4, s[8:11], s89 offen sc1
  s_waitcnt lgkmcnt(0)
  s_barrier
  ds_read_b64_tr_b16 v[32:33], v20 offset:0
  ds_read_b64_tr_b16 v[34:35], v20 offset:64
  ds_read_b64_tr_b16 v[44:45], v20 offset:2048
  ds_read_b64_tr_b16 v[46:47], v20 offset:2112
  ds_read_b64_tr_b16 v[36:37], v20 offset:512
  ds_read_b64_tr_b16 v[38:39], v20 offset:576
  s_waitcnt lgkmcnt(4)
  v_smfmac_f32_16x16x64_bf16 v[52:55], v[32:35], a[192:199], v8
  ds_read_b128 v[144:147], v7 offset:3072
  v_smfmac_f32_16x16x64_bf16 v[56:59], v[32:35], a[200:207], v8
  ds_read_b128 v[148:151], v7 offset:23552
  s_waitcnt lgkmcnt(4)
  v_smfmac_f32_16x16x64_bf16 v[52:55], v[44:47], v[120:127], v8
  ds_read_b64_tr_b16 v[40:41], v20 offset:1024
  v_smfmac_f32_16x16x64_bf16 v[60:63], v[32:35], a[208:215], v8
  ds_read_b64_tr_b16 v[42:43], v20 offset:1088
  v_smfmac_f32_16x16x64_bf16 v[64:67], v[32:35], a[216:223], v8
  ds_read_b128 v[152:155], v7 offset:4096
  v_smfmac_f32_16x16x64_bf16 v[56:59], v[44:47], v[128:135], v8
  ds_read_b128 v[156:159], v7 offset:24576
  v_smfmac_f32_16x16x64_bf16 v[68:71], v[32:35], a[224:231], v8
  ds_read_b128 v[120:123], v5 offset:0
  s_waitcnt lgkmcnt(7)
  v_smfmac_f32_16x16x64_bf16 v[52:55], v[36:39], a[232:239], v8
  ds_read_b128 v[124:127], v5 offset:20480
  v_smfmac_f32_16x16x64_bf16 v[60:63], v[44:47], v[136:143], v8
  ds_read_b64_tr_b16 v[48:49], v20 offset:2560
  v_smfmac_f32_16x16x64_bf16 v[56:59], v[36:39], a[240:247], v8
  ds_read_b64_tr_b16 v[50:51], v20 offset:2624
  v_smfmac_f32_16x16x64_bf16 v[60:63], v[36:39], a[248:255], v8
  ds_read_b128 v[128:131], v5 offset:1024
  s_waitcnt lgkmcnt(9)
  v_smfmac_f32_16x16x64_bf16 v[64:67], v[44:47], v[144:151], v8
  ds_read_b128 v[132:135], v5 offset:21504
  v_smfmac_f32_16x16x64_bf16 v[64:67], v[36:39], v[160:167], v8
  ds_read_b64_tr_b16 v[32:33], v20 offset:1536
  v_smfmac_f32_16x16x64_bf16 v[68:71], v[36:39], v[168:175], v8
  ds_read_b64_tr_b16 v[34:35], v20 offset:1600
  s_waitcnt lgkmcnt(8)
  v_smfmac_f32_16x16x64_bf16 v[68:71], v[44:47], v[152:159], v8
  ds_read_b128 v[136:139], v5 offset:2048
  v_smfmac_f32_16x16x64_bf16 v[52:55], v[40:43], v[176:183], v8
  ds_read_b128 v[140:143], v5 offset:22528
  v_smfmac_f32_16x16x64_bf16 v[56:59], v[40:43], v[184:191], v8
  ds_read_b128 v[144:147], v5 offset:3072
  s_waitcnt lgkmcnt(7)
  v_smfmac_f32_16x16x64_bf16 v[52:55], v[48:51], v[120:127], v8
  ds_read_b128 v[148:151], v5 offset:23552
  v_smfmac_f32_16x16x64_bf16 v[60:63], v[40:43], v[192:199], v8
  ds_read_b128 v[152:155], v5 offset:4096
  v_smfmac_f32_16x16x64_bf16 v[64:67], v[40:43], v[200:207], v8
  ds_read_b128 v[156:159], v5 offset:24576
  s_waitcnt lgkmcnt(8)
  v_smfmac_f32_16x16x64_bf16 v[56:59], v[48:51], v[128:135], v8
  v_smfmac_f32_16x16x64_bf16 v[68:71], v[40:43], v[208:215], v8
  s_waitcnt lgkmcnt(6)
  v_smfmac_f32_16x16x64_bf16 v[52:55], v[32:35], v[216:223], v8
  s_waitcnt lgkmcnt(4)
  v_smfmac_f32_16x16x64_bf16 v[60:63], v[48:51], v[136:143], v8
  v_smfmac_f32_16x16x64_bf16 v[56:59], v[32:35], v[224:231], v8
  v_smfmac_f32_16x16x64_bf16 v[60:63], v[32:35], v[232:239], v8
  s_waitcnt lgkmcnt(2)
  v_smfmac_f32_16x16x64_bf16 v[64:67], v[48:51], v[144:151], v8
  v_smfmac_f32_16x16x64_bf16 v[64:67], v[32:35], v[240:247], v8
  v_smfmac_f32_16x16x64_bf16 v[68:71], v[32:35], v[248:255], v8
  s_waitcnt lgkmcnt(0)
  v_smfmac_f32_16x16x64_bf16 v[68:71], v[48:51], v[152:159], v8
  s_cmp_eq_u32 s28, 63
  s_cbranch_scc1 VOS_last
  s_add_u32 s31, s33, s37
  v_cvt_pk_bf16_f32 v32, v52, v53
  v_cvt_pk_bf16_f32 v33, v54, v55
  v_cvt_pk_bf16_f32 v34, v56, v57
  v_cvt_pk_bf16_f32 v35, v58, v59
  v_and_or_b32 v32, v32, -2, s91
  v_and_or_b32 v33, v33, -2, s91
  v_and_or_b32 v34, v34, -2, s91
  v_and_or_b32 v35, v35, -2, s91
  v_cvt_pk_bf16_f32 v36, v60, v61
  v_cvt_pk_bf16_f32 v37, v62, v63
  v_permlane16_swap_b32 v32, v34
  v_permlane16_swap_b32 v33, v35
  v_cvt_pk_bf16_f32 v38, v64, v65
  v_cvt_pk_bf16_f32 v39, v66, v67
  buffer_store_dwordx4 v[32:35], v9, s[8:11], s31 offen sc1
  v_and_or_b32 v36, v36, -2, s91
  v_and_or_b32 v37, v37, -2, s91
  v_and_or_b32 v38, v38, -2, s91
  v_and_or_b32 v39, v39, -2, s91
  v_cvt_pk_bf16_f32 v40, v68, v69
  v_cvt_pk_bf16_f32 v41, v70, v71
  v_permlane16_swap_b32 v36, v38
  v_permlane16_swap_b32 v37, v39
  v_and_or_b32 v40, v40, -2, s91
  v_and_or_b32 v41, v41, -2, s91
  buffer_store_dwordx4 v[36:39], v9, s[8:11], s31 offen offset:1024 sc1
  buffer_store_dwordx2 v[40:41], v21, s[8:11], s31 offen offset:2048 sc1
  v_mov_b32 v144, 0
  v_mov_b32 v145, 0
  v_mov_b32 v146, 0
  v_mov_b32 v147, 0
  v_mov_b32 v148, 0
  v_mov_b32 v149, 0
  v_mov_b32 v150, 0
  v_mov_b32 v151, 0
  v_mov_b32 v152, 0
  v_mov_b32 v153, 0
  v_mov_b32 v154, 0
  v_mov_b32 v155, 0
  s_add_u32 s30, s28, 1
  v_mov_b32 v42, s30
  s_add_u32 s90, s32, s37
  s_add_u32 s30, s28, 1
  s_lshl_b32 s53, s30, 17
  s_lshl_b32 s30, s30, 9
  s_and_b32 s30, s30, 0x2000
  s_xor_b32 s30, s30, s47
  s_add_u32 s53, s53, s30
  s_sleep 1
  s_sleep 1
  s_sleep 1
  s_sleep 1
  s_sleep 1
  buffer_load_dwordx4 v[132:135], v27, s[8:11], s46 offen sc1
  buffer_load_dwordx4 v[136:139], v27, s[8:11], s46 offen offset:1280 sc1
  buffer_load_dwordx2 v[140:141], v28, s[8:11], s46 offen sc1
  buffer_load_dwordx4 v[120:123], v22, s[8:11], s90 offen sc1
  buffer_load_dwordx4 v[124:127], v22, s[8:11], s90 offen offset:256 sc1
  buffer_load_dwordx4 v[128:131], v23, s[8:11], s90 offen sc1
  s_waitcnt vmcnt(5)
  v_smfmac_f32_16x16x64_bf16 v[144:147], v[132:135], v[72:79], v8 abid:1
  v_bitop3_b32 v1, v132, v133, s29 bitop3:126
  v_smfmac_f32_16x16x64_bf16 v[148:151], v[132:135], v[88:95], v8 abid:1
  v_bitop3_b32 v2, v134, v135, s29 bitop3:126
  v_smfmac_f32_16x16x64_bf16 v[152:155], v[132:135], v[104:111], v8 abid:1
  s_waitcnt vmcnt(4)
  v_smfmac_f32_16x16x64_bf16 v[144:147], v[136:139], v[80:87], v8 abid:1
  v_bitop3_b32 v3, v136, v137, s29 bitop3:126
  v_smfmac_f32_16x16x64_bf16 v[148:151], v[136:139], v[96:103], v8 abid:1
  v_bitop3_b32 v4, v138, v139, s29 bitop3:126
  v_smfmac_f32_16x16x64_bf16 v[152:155], v[136:139], v[112:119], v8 abid:1
  v_or3_b32 v1, v1, v2, v3
  v_or_b32 v1, v1, v4
  v_cmp_gt_i32 vcc, 0, v1
  s_cbranch_vccnz VOS_pe
  s_waitcnt vmcnt(2)
  v_smfmac_f32_16x16x32_bf16 v[144:147], v[140:141], v[120:123], v8 abid:2
  v_bitop3_b32 v2, v140, v141, s29 bitop3:126
  v_or3_b32 v1, v1, v4, v2
  v_bitop3_b32 v2, v120, v121, s91 bitop3:126
  v_bitop3_b32 v3, v122, v123, s91 bitop3:126
  s_waitcnt vmcnt(1)
  v_smfmac_f32_16x16x32_bf16 v[148:151], v[140:141], v[124:127], v8 abid:2
  v_bitop3_b32 v4, v124, v125, s91 bitop3:126
  v_or3_b32 v2, v2, v3, v4
  v_bitop3_b32 v3, v126, v127, s91 bitop3:126
  s_waitcnt vmcnt(0)
  v_smfmac_f32_16x16x32_bf16 v[152:155], v[140:141], v[128:131], v8 abid:2
  v_bitop3_b32 v4, v128, v129, s91 bitop3:126
  v_or3_b32 v2, v2, v3, v4
  v_bitop3_b32 v3, v130, v131, s91 bitop3:126
  v_or_b32 v2, v2, v3
  v_lshl_or_b32 v1, v2, 31, v1
  v_cmp_gt_i32 vcc, 0, v1
  s_cbranch_vccnz VOS_pbad
VOS_pok:
  s_cmp_ge_u32 s24, 2
  v_add_f32 v144, v144, v145
  v_add_f32 v145, v146, v147
  ds_write_b64 v29, v[144:145] offset:0
  v_add_f32 v148, v148, v149
  v_add_f32 v149, v150, v151
  ds_write_b64 v29, v[148:149] offset:512
  v_add_f32 v152, v152, v153
  v_add_f32 v153, v154, v155
  ds_write_b64 v29, v[152:153] offset:1024
  s_waitcnt lgkmcnt(0)
  s_barrier
  s_cbranch_scc1 VOS_nopub
  ds_read_b128 v[72:75], v30 offset:0
  ds_read_b128 v[76:79], v30 offset:1536
  ds_read_b128 v[80:83], v30 offset:3072
  ds_read_b128 v[84:87], v30 offset:4608
  s_waitcnt lgkmcnt(2)
  v_pk_add_f32 v[72:73], v[72:73], v[76:77]
  v_pk_add_f32 v[74:75], v[74:75], v[78:79]
  s_waitcnt lgkmcnt(0)
  v_pk_add_f32 v[80:81], v[80:81], v[84:85]
  v_pk_add_f32 v[82:83], v[82:83], v[86:87]
  v_pk_add_f32 v[72:73], v[72:73], v[80:81]
  v_pk_add_f32 v[74:75], v[74:75], v[82:83]
  v_cvt_pk_bf16_f32 v72, v72, v73
  v_cvt_pk_bf16_f32 v73, v74, v75
  v_xor_b32 v72, s29, v72
  v_xor_b32 v73, s29, v73
  v_min_u32 v72, -2, v72
  v_min_u32 v73, -2, v73
  buffer_store_dwordx2 v[72:73], v31, s[8:11], s53 offen sc1
  s_branch VOS_pubd
VOS_nopub:
  s_nop 15
  s_cmp_eq_u32 s24, 3
  s_cbranch_scc1 VOS_nomk
  s_mov_b64 exec, 1
  buffer_store_dword v42, off, s[8:11], s35 sc1
  s_branch VOS_mkd
VOS_nomk:
VOS_mkd:
  s_mov_b64 exec, -1
VOS_pubd:
  s_mov_b32 s88, s54
  s_add_u32 s54, s54, 327680
  s_mov_b32 s36, s90
  s_xor_b32 s37, s37, 163840
  s_and_b32 s30, s28, 1
  s_xor_b32 s91, s91, s30
  v_cmp_eq_u32 vcc, 0, v0
  s_add_u32 s31, s28, 1
  s_cbranch_vccz VOS_nouf
  s_lshr_b32 s30, s31, 3
  s_lshl_b32 s30, s30, 9
  s_add_u32 s30, s30, s55
  v_mbcnt_lo_u32_b32 v3, -1, 0
  v_mbcnt_hi_u32_b32 v3, -1, v3
  v_and_b32 v2, 0, v3
  v_add_lshl_u32 v3, v3, v2, 2
VOS_uf:
  buffer_load_dword v2, v3, s[8:11], s30 offen sc1
  s_sub_u32 s82, s82, 1
  s_cbranch_scc1 L_abort
  s_waitcnt vmcnt(0)
  v_cmp_eq_u32 vcc, 0, v2
  s_cbranch_vccnz VOS_uf
VOS_nouf:
  s_add_u32 s30, s28, 1
  s_lshl_b32 s53, s30, 17
  s_lshl_b32 s30, s30, 9
  s_and_b32 s30, s30, 0x2000
  s_xor_b32 s30, s30, s47
  s_add_u32 s53, s53, s30
  s_add_u32 s48, s53, s40
  s_add_u32 s49, s53, s41
  s_add_u32 s50, s53, s42
  s_add_u32 s51, s53, s43
  s_add_u32 s52, s53, s44
  s_add_u32 s30, s28, 1
  s_cmp_lg_u32 s24, 2
  s_cbranch_scc1 VOS_mkb
  s_mov_b64 exec, 65535
  buffer_load_dword v1, v17, s[8:11], s45 offen sc1
  s_nop 15
  s_nop 7
VOS_mk:
  buffer_load_dword v2, v17, s[8:11], s45 offen sc1
  s_waitcnt vmcnt(1)
  v_cmp_gt_i32 vcc, s30, v1
  s_cbranch_vccz VOS_mkok
  buffer_load_dword v1, v17, s[8:11], s45 offen sc1
  s_sub_u32 s82, s82, 1
  s_cbranch_scc1 L_abort
  s_waitcnt vmcnt(1)
  v_cmp_gt_i32 vcc, s30, v2
  s_cbranch_vccnz VOS_mk
VOS_mkok:
  s_mov_b64 exec, -1
VOS_mkb:
  s_barrier
  buffer_load_dwordx4 v[32:35], v16, s[8:11], s48 offen sc1
  buffer_load_dwordx4 v[36:39], v16, s[8:11], s49 offen sc1
  buffer_load_dwordx4 v[40:43], v16, s[8:11], s50 offen sc1
  buffer_load_dwordx4 v[44:47], v16, s[8:11], s51 offen sc1
  buffer_load_dwordx4 v[48:51], v16, s[8:11], s52 offen sc1
  ds_read_b128 v[120:123], v6 offset:0
  ds_read_b128 v[124:127], v6 offset:1024
  ds_read_b128 v[128:131], v6 offset:2048
  ds_read_b128 v[132:135], v6 offset:3072
  ds_read_b128 v[136:139], v6 offset:4096
  ds_read_b128 v[140:143], v6 offset:5120
  v_mov_b32 v144, 0
  v_mov_b32 v145, 0
  v_mov_b32 v146, 0
  v_mov_b32 v147, 0
  v_mov_b32 v148, 0
  v_mov_b32 v149, 0
  v_mov_b32 v150, 0
  v_mov_b32 v151, 0
  v_mov_b32 v152, 0
  v_mov_b32 v153, 0
  v_mov_b32 v154, 0
  v_mov_b32 v155, 0
  v_mov_b32 v52, 0
  v_mov_b32 v53, 0
  v_mov_b32 v54, 0
  v_mov_b32 v55, 0
  v_mov_b32 v56, 0
  v_mov_b32 v57, 0
  v_mov_b32 v58, 0
  v_mov_b32 v59, 0
  v_mov_b32 v60, 0
  v_mov_b32 v61, 0
  v_mov_b32 v62, 0
  v_mov_b32 v63, 0
  v_mov_b32 v64, 0
  v_mov_b32 v65, 0
  v_mov_b32 v66, 0
  v_mov_b32 v67, 0
  v_mov_b32 v68, 0
  v_mov_b32 v69, 0
  v_mov_b32 v70, 0
  v_mov_b32 v71, 0
  v_add_u32 v5, 40960, v7
  s_add_u32 s92, s38, 0
  s_add_u32 s93, s38, 40960
  s_add_u32 s94, s38, 81920
  s_add_u32 s95, s38, 122880
  s_add_u32 s38, s38, 1310720
  s_add_u32 s89, s28, 2
  s_min_u32 s89, s89, 63
  s_lshr_b32 s89, s89, 3
  s_lshl_b32 s89, s89, 9
  s_add_u32 s89, s89, s55
  buffer_load_dwordx4 v[72:75], v24, s[8:11], s92 offen
  buffer_load_dwordx4 v[88:91], v25, s[8:11], s92 offen
  buffer_load_dwordx4 v[104:107], v26, s[8:11], s92 offen
  s_add_u32 s28, s28, 1
  s_xor_b32 s29, s29, 0x80008000
  s_cmp_eq_u32 s24, 0
  s_cbranch_scc1 VOS_fz0
  s_cmp_eq_u32 s24, 1
  s_cbranch_scc1 VOS_fz1
  s_cmp_eq_u32 s24, 2
  s_cbranch_scc1 VOS_fz2
VOS_fz3:
  s_waitcnt vmcnt(7)
  v_max3_u32 v3, v32, v33, v34
  v_max_u32 v3, v3, v35
  v_mfma_f32_16x16x32_bf16 v[32:35], v[32:35], v[10:13], 0
  s_waitcnt vmcnt(6)
  v_max3_u32 v3, v36, v37, v3
  v_max3_u32 v3, v38, v39, v3
  v_mfma_f32_16x16x32_bf16 v[36:39], v[36:39], v[10:13], 0
  s_waitcnt vmcnt(5)
  v_max3_u32 v3, v40, v41, v3
  v_max3_u32 v3, v42, v43, v3
  v_mfma_f32_16x16x32_bf16 v[40:43], v[40:43], v[10:13], 0
  v_cvt_pk_bf16_f32 v32, v32, v33
  v_cvt_pk_bf16_f32 v33, v34, v35
  ds_write_b64 v15, v[32:33] offset:0
  s_waitcnt vmcnt(4)
  v_max3_u32 v3, v44, v45, v3
  v_max3_u32 v3, v46, v47, v3
  v_mfma_f32_16x16x32_bf16 v[44:47], v[44:47], v[10:13], 0
  v_cvt_pk_bf16_f32 v36, v36, v37
  v_cvt_pk_bf16_f32 v37, v38, v39
  ds_write_b64 v15, v[36:37] offset:512
  ds_read_b128 v[32:35], v14 offset:6144
  s_waitcnt vmcnt(3)
  v_max3_u32 v3, v48, v49, v3
  v_max3_u32 v3, v50, v51, v3
  v_mfma_f32_16x16x32_bf16 v[48:51], v[48:51], v[10:13], 0
  v_cmp_eq_u32 vcc, -1, v3
  v_cvt_pk_bf16_f32 v40, v40, v41
  v_cvt_pk_bf16_f32 v41, v42, v43
  ds_write_b64 v15, v[40:41] offset:1024
  v_cvt_pk_bf16_f32 v44, v44, v45
  v_cvt_pk_bf16_f32 v45, v46, v47
  ds_write_b64 v15, v[44:45] offset:1536
  ds_read_b128 v[36:39], v14 offset:7168
  v_cvt_pk_bf16_f32 v48, v48, v49
  v_cvt_pk_bf16_f32 v49, v50, v51
  ds_write_b64 v15, v[48:49] offset:3584
  s_cbranch_vccnz VOS_h2r0
  s_waitcnt lgkmcnt(4)
  v_smfmac_f32_16x16x64_bf16 v[144:147], v[32:35], a[144:151], v8
  v_smfmac_f32_16x16x64_bf16 v[148:151], v[32:35], a[152:159], v8
  v_smfmac_f32_16x16x64_bf16 v[152:155], v[32:35], a[160:167], v8
  s_waitcnt lgkmcnt(0)
  s_barrier
  ds_read_b128 v[40:43], v14 offset:8192
  ds_read_b128 v[44:47], v14 offset:0
  v_smfmac_f32_16x16x64_bf16 v[144:147], v[36:39], a[168:175], v8
  ds_read_b128 v[32:35], v14 offset:1024
  v_smfmac_f32_16x16x64_bf16 v[148:151], v[36:39], a[176:183], v8
  v_smfmac_f32_16x16x64_bf16 v[152:155], v[36:39], a[184:191], v8
  s_branch VOS_vt3
VOS_fz0:
  s_waitcnt vmcnt(7)
  v_max3_u32 v3, v32, v33, v34
  v_max_u32 v3, v3, v35
  v_mfma_f32_16x16x32_bf16 v[32:35], v[32:35], v[10:13], 0
  s_waitcnt vmcnt(6)
  v_max3_u32 v3, v36, v37, v3
  v_max3_u32 v3, v38, v39, v3
  v_mfma_f32_16x16x32_bf16 v[36:39], v[36:39], v[10:13], 0
  s_waitcnt vmcnt(5)
  v_max3_u32 v3, v40, v41, v3
  v_max3_u32 v3, v42, v43, v3
  v_mfma_f32_16x16x32_bf16 v[40:43], v[40:43], v[10:13], 0
  v_cvt_pk_bf16_f32 v32, v32, v33
  v_cvt_pk_bf16_f32 v33, v34, v35
  ds_write_b64 v15, v[32:33] offset:0
  s_waitcnt vmcnt(4)
  v_max3_u32 v3, v44, v45, v3
  v_max3_u32 v3, v46, v47, v3
  v_mfma_f32_16x16x32_bf16 v[44:47], v[44:47], v[10:13], 0
  v_cvt_pk_bf16_f32 v36, v36, v37
  v_cvt_pk_bf16_f32 v37, v38, v39
  ds_write_b64 v15, v[36:37] offset:512
  ds_read_b128 v[32:35], v14 offset:0
  s_waitcnt vmcnt(3)
  v_max3_u32 v3, v48, v49, v3
  v_max3_u32 v3, v50, v51, v3
  v_mfma_f32_16x16x32_bf16 v[48:51], v[48:51], v[10:13], 0
  v_cmp_eq_u32 vcc, -1, v3
  v_cvt_pk_bf16_f32 v40, v40, v41
  v_cvt_pk_bf16_f32 v41, v42, v43
  ds_write_b64 v15, v[40:41] offset:1024
  v_cvt_pk_bf16_f32 v44, v44, v45
  v_cvt_pk_bf16_f32 v45, v46, v47
  ds_write_b64 v15, v[44:45] offset:1536
  ds_read_b128 v[36:39], v14 offset:1024
  v_cvt_pk_bf16_f32 v48, v48, v49
  v_cvt_pk_bf16_f32 v49, v50, v51
  ds_write_b64 v15, v[48:49] offset:8192
  s_cbranch_vccnz VOS_h2r0
  s_waitcnt lgkmcnt(4)
  v_smfmac_f32_16x16x64_bf16 v[144:147], v[32:35], a[0:7], v8
  v_smfmac_f32_16x16x64_bf16 v[148:151], v[32:35], a[8:15], v8
  v_smfmac_f32_16x16x64_bf16 v[152:155], v[32:35], a[16:23], v8
  s_waitcnt lgkmcnt(0)
  s_barrier
  ds_read_b128 v[40:43], v14 offset:8192
  ds_read_b128 v[44:47], v14 offset:2048
  v_smfmac_f32_16x16x64_bf16 v[144:147], v[36:39], a[24:31], v8
  ds_read_b128 v[32:35], v14 offset:3072
  v_smfmac_f32_16x16x64_bf16 v[148:151], v[36:39], a[32:39], v8
  v_smfmac_f32_16x16x64_bf16 v[152:155], v[36:39], a[40:47], v8
  s_branch VOS_vt0
VOS_fz1:
  s_waitcnt vmcnt(7)
  v_max3_u32 v3, v32, v33, v34
  v_max_u32 v3, v3, v35
  v_mfma_f32_16x16x32_bf16 v[32:35], v[32:35], v[10:13], 0
  s_waitcnt vmcnt(6)
  v_max3_u32 v3, v36, v37, v3
  v_max3_u32 v3, v38, v39, v3
  v_mfma_f32_16x16x32_bf16 v[36:39], v[36:39], v[10:13], 0
  s_waitcnt vmcnt(5)
  v_max3_u32 v3, v40, v41, v3
  v_max3_u32 v3, v42, v43, v3
  v_mfma_f32_16x16x32_bf16 v[40:43], v[40:43], v[10:13], 0
  v_cvt_pk_bf16_f32 v32, v32, v33
  v_cvt_pk_bf16_f32 v33, v34, v35
  ds_write_b64 v15, v[32:33] offset:0
  s_waitcnt vmcnt(4)
  v_max3_u32 v3, v44, v45, v3
  v_max3_u32 v3, v46, v47, v3
  v_mfma_f32_16x16x32_bf16 v[44:47], v[44:47], v[10:13], 0
  v_cvt_pk_bf16_f32 v36, v36, v37
  v_cvt_pk_bf16_f32 v37, v38, v39
  ds_write_b64 v15, v[36:37] offset:512
  ds_read_b128 v[32:35], v14 offset:2048
  s_waitcnt vmcnt(3)
  v_max3_u32 v3, v48, v49, v3
  v_max3_u32 v3, v50, v51, v3
  v_mfma_f32_16x16x32_bf16 v[48:51], v[48:51], v[10:13], 0
  v_cmp_eq_u32 vcc, -1, v3
  v_cvt_pk_bf16_f32 v40, v40, v41
  v_cvt_pk_bf16_f32 v41, v42, v43
  ds_write_b64 v15, v[40:41] offset:1024
  v_cvt_pk_bf16_f32 v44, v44, v45
  v_cvt_pk_bf16_f32 v45, v46, v47
  ds_write_b64 v15, v[44:45] offset:1536
  ds_read_b128 v[36:39], v14 offset:3072
  v_cvt_pk_bf16_f32 v48, v48, v49
  v_cvt_pk_bf16_f32 v49, v50, v51
  ds_write_b64 v15, v[48:49] offset:6656
  s_cbranch_vccnz VOS_h2r0
  s_waitcnt lgkmcnt(4)
  v_smfmac_f32_16x16x64_bf16 v[144:147], v[32:35], a[48:55], v8
  v_smfmac_f32_16x16x64_bf16 v[148:151], v[32:35], a[56:63], v8
  v_smfmac_f32_16x16x64_bf16 v[152:155], v[32:35], a[64:71], v8
  s_waitcnt lgkmcnt(0)
  s_barrier
  ds_read_b128 v[40:43], v14 offset:8192
  ds_read_b128 v[44:47], v14 offset:4096
  v_smfmac_f32_16x16x64_bf16 v[144:147], v[36:39], a[72:79], v8
  ds_read_b128 v[32:35], v14 offset:5120
  v_smfmac_f32_16x16x64_bf16 v[148:151], v[36:39], a[80:87], v8
  v_smfmac_f32_16x16x64_bf16 v[152:155], v[36:39], a[88:95], v8
  s_branch VOS_vt1
VOS_fz2:
  s_waitcnt vmcnt(7)
  v_max3_u32 v3, v32, v33, v34
  v_max_u32 v3, v3, v35
  v_mfma_f32_16x16x32_bf16 v[32:35], v[32:35], v[10:13], 0
  s_waitcnt vmcnt(6)
  v_max3_u32 v3, v36, v37, v3
  v_max3_u32 v3, v38, v39, v3
  v_mfma_f32_16x16x32_bf16 v[36:39], v[36:39], v[10:13], 0
  s_waitcnt vmcnt(5)
  v_max3_u32 v3, v40, v41, v3
  v_max3_u32 v3, v42, v43, v3
  v_mfma_f32_16x16x32_bf16 v[40:43], v[40:43], v[10:13], 0
  v_cvt_pk_bf16_f32 v32, v32, v33
  v_cvt_pk_bf16_f32 v33, v34, v35
  ds_write_b64 v15, v[32:33] offset:0
  s_waitcnt vmcnt(4)
  v_max3_u32 v3, v44, v45, v3
  v_max3_u32 v3, v46, v47, v3
  v_mfma_f32_16x16x32_bf16 v[44:47], v[44:47], v[10:13], 0
  v_cvt_pk_bf16_f32 v36, v36, v37
  v_cvt_pk_bf16_f32 v37, v38, v39
  ds_write_b64 v15, v[36:37] offset:512
  ds_read_b128 v[32:35], v14 offset:4096
  s_waitcnt vmcnt(3)
  v_max3_u32 v3, v48, v49, v3
  v_max3_u32 v3, v50, v51, v3
  v_mfma_f32_16x16x32_bf16 v[48:51], v[48:51], v[10:13], 0
  v_cmp_eq_u32 vcc, -1, v3
  v_cvt_pk_bf16_f32 v40, v40, v41
  v_cvt_pk_bf16_f32 v41, v42, v43
  ds_write_b64 v15, v[40:41] offset:1024
  v_cvt_pk_bf16_f32 v44, v44, v45
  v_cvt_pk_bf16_f32 v45, v46, v47
  ds_write_b64 v15, v[44:45] offset:1536
  ds_read_b128 v[36:39], v14 offset:5120
  v_cvt_pk_bf16_f32 v48, v48, v49
  v_cvt_pk_bf16_f32 v49, v50, v51
  ds_write_b64 v15, v[48:49] offset:5120
  s_cbranch_vccnz VOS_h2r0
  s_waitcnt lgkmcnt(4)
  v_smfmac_f32_16x16x64_bf16 v[144:147], v[32:35], a[96:103], v8
  v_smfmac_f32_16x16x64_bf16 v[148:151], v[32:35], a[104:111], v8
  v_smfmac_f32_16x16x64_bf16 v[152:155], v[32:35], a[112:119], v8
  s_waitcnt lgkmcnt(0)
  s_barrier
  ds_read_b128 v[40:43], v14 offset:8192
  ds_read_b128 v[44:47], v14 offset:6144
  v_smfmac_f32_16x16x64_bf16 v[144:147], v[36:39], a[120:127], v8
  ds_read_b128 v[32:35], v14 offset:7168
  v_smfmac_f32_16x16x64_bf16 v[148:151], v[36:39], a[128:135], v8
  v_smfmac_f32_16x16x64_bf16 v[152:155], v[36:39], a[136:143], v8
  s_branch VOS_vt2
VOS_h2r0:
  s_waitcnt lgkmcnt(0)
VOS_h2r:
  buffer_load_dwordx4 v[32:35], v16, s[8:11], s48 offen sc1
  buffer_load_dwordx4 v[36:39], v16, s[8:11], s49 offen sc1
  buffer_load_dwordx4 v[40:43], v16, s[8:11], s50 offen sc1
  buffer_load_dwordx4 v[44:47], v16, s[8:11], s51 offen sc1
  buffer_load_dwordx4 v[48:51], v16, s[8:11], s52 offen sc1
  s_sub_u32 s82, s82, 1
  s_cbranch_scc1 L_abort
  s_waitcnt vmcnt(4)
  v_max3_u32 v3, v32, v33, v34
  v_max_u32 v3, v3, v35
  v_mfma_f32_16x16x32_bf16 v[32:35], v[32:35], v[10:13], 0
  s_waitcnt vmcnt(3)
  v_max3_u32 v3, v36, v37, v3
  v_max3_u32 v3, v38, v39, v3
  v_mfma_f32_16x16x32_bf16 v[36:39], v[36:39], v[10:13], 0
  s_waitcnt vmcnt(2)
  v_max3_u32 v3, v40, v41, v3
  v_max3_u32 v3, v42, v43, v3
  v_mfma_f32_16x16x32_bf16 v[40:43], v[40:43], v[10:13], 0
  s_waitcnt vmcnt(1)
  v_max3_u32 v3, v44, v45, v3
  v_max3_u32 v3, v46, v47, v3
  v_mfma_f32_16x16x32_bf16 v[44:47], v[44:47], v[10:13], 0
  v_cvt_pk_bf16_f32 v32, v32, v33
  v_cvt_pk_bf16_f32 v33, v34, v35
  ds_write_b64 v15, v[32:33] offset:0
  s_waitcnt vmcnt(0)
  v_max3_u32 v3, v48, v49, v3
  v_max3_u32 v3, v50, v51, v3
  v_mfma_f32_16x16x32_bf16 v[48:51], v[48:51], v[10:13], 0
  v_cvt_pk_bf16_f32 v36, v36, v37
  v_cvt_pk_bf16_f32 v37, v38, v39
  ds_write_b64 v15, v[36:37] offset:512
  v_cmp_eq_u32 vcc, -1, v3
  v_cvt_pk_bf16_f32 v40, v40, v41
  v_cvt_pk_bf16_f32 v41, v42, v43
  ds_write_b64 v15, v[40:41] offset:1024
  v_cvt_pk_bf16_f32 v44, v44, v45
  v_cvt_pk_bf16_f32 v45, v46, v47
  ds_write_b64 v15, v[44:45] offset:1536
  s_nop 0
  v_cvt_pk_bf16_f32 v48, v48, v49
  v_cvt_pk_bf16_f32 v49, v50, v51
  v_add_u32 v4, s85, v15
  ds_write_b64 v4, v[48:49]
  s_cbranch_vccnz VOS_h2r
  s_branch VOS_loop
VOS_pe:
  buffer_load_dwordx4 v[132:135], v27, s[8:11], s46 offen sc1
  buffer_load_dwordx4 v[136:139], v27, s[8:11], s46 offen offset:1280 sc1
  buffer_load_dwordx2 v[140:141], v28, s[8:11], s46 offen sc1
  s_waitcnt vmcnt(3)
  v_bitop3_b32 v2, v120, v121, s91 bitop3:126
  v_bitop3_b32 v3, v122, v123, s91 bitop3:126
  v_bitop3_b32 v4, v124, v125, s91 bitop3:126
  v_or3_b32 v2, v2, v3, v4
  v_bitop3_b32 v3, v126, v127, s91 bitop3:126
  v_bitop3_b32 v4, v128, v129, s91 bitop3:126
  v_or3_b32 v2, v2, v3, v4
  v_bitop3_b32 v3, v130, v131, s91 bitop3:126
  v_or_b32 v2, v2, v3
  v_and_b32 v2, 1, v2
  v_cmp_ne_u32 vcc, 0, v2
  s_cbranch_vccnz VOS_ybad
  s_branch VOS_pbad2
VOS_pbad:
  buffer_load_dwordx4 v[132:135], v27, s[8:11], s46 offen sc1
  buffer_load_dwordx4 v[136:139], v27, s[8:11], s46 offen offset:1280 sc1
  buffer_load_dwordx2 v[140:141], v28, s[8:11], s46 offen sc1
  v_and_b32 v2, 1, v2
  v_cmp_ne_u32 vcc, 0, v2
  s_cbranch_vccnz VOS_ybad
VOS_pbad2:
  s_sub_u32 s82, s82, 1
  s_cbranch_scc1 L_abort
  v_mov_b32 v144, 0
  v_mov_b32 v145, 0
  v_mov_b32 v146, 0
  v_mov_b32 v147, 0
  v_mov_b32 v148, 0
  v_mov_b32 v149, 0
  v_mov_b32 v150, 0
  v_mov_b32 v151, 0
  v_mov_b32 v152, 0
  v_mov_b32 v153, 0
  v_mov_b32 v154, 0
  v_mov_b32 v155, 0
  s_waitcnt vmcnt(2)
  v_smfmac_f32_16x16x64_bf16 v[144:147], v[132:135], v[72:79], v8 abid:1
  v_bitop3_b32 v1, v132, v133, s29 bitop3:126
  v_smfmac_f32_16x16x64_bf16 v[148:151], v[132:135], v[88:95], v8 abid:1
  v_bitop3_b32 v2, v134, v135, s29 bitop3:126
  v_smfmac_f32_16x16x64_bf16 v[152:155], v[132:135], v[104:111], v8 abid:1
  s_waitcnt vmcnt(1)
  v_smfmac_f32_16x16x64_bf16 v[144:147], v[136:139], v[80:87], v8 abid:1
  v_bitop3_b32 v3, v136, v137, s29 bitop3:126
  v_smfmac_f32_16x16x64_bf16 v[148:151], v[136:139], v[96:103], v8 abid:1
  v_bitop3_b32 v4, v138, v139, s29 bitop3:126
  v_smfmac_f32_16x16x64_bf16 v[152:155], v[136:139], v[112:119], v8 abid:1
  v_or3_b32 v1, v1, v2, v3
  s_waitcnt vmcnt(0)
  v_smfmac_f32_16x16x32_bf16 v[144:147], v[140:141], v[120:123], v8 abid:2
  v_bitop3_b32 v2, v140, v141, s29 bitop3:126
  v_smfmac_f32_16x16x32_bf16 v[148:151], v[140:141], v[124:127], v8 abid:2
  v_or3_b32 v1, v1, v4, v2
  v_smfmac_f32_16x16x32_bf16 v[152:155], v[140:141], v[128:131], v8 abid:2
  v_cmp_gt_i32 vcc, 0, v1
  s_cbranch_vccz VOS_pok
  buffer_load_dwordx4 v[132:135], v27, s[8:11], s46 offen sc1
  buffer_load_dwordx4 v[136:139], v27, s[8:11], s46 offen offset:1280 sc1
  buffer_load_dwordx2 v[140:141], v28, s[8:11], s46 offen sc1
  s_branch VOS_pbad2
VOS_ybad:
  buffer_load_dwordx4 v[120:123], v22, s[8:11], s90 offen sc1
  buffer_load_dwordx4 v[124:127], v22, s[8:11], s90 offen offset:256 sc1
  buffer_load_dwordx4 v[128:131], v23, s[8:11], s90 offen sc1
  s_sub_u32 s82, s82, 1
  s_cbranch_scc1 L_abort
  v_mov_b32 v144, 0
  v_mov_b32 v145, 0
  v_mov_b32 v146, 0
  v_mov_b32 v147, 0
  v_mov_b32 v148, 0
  v_mov_b32 v149, 0
  v_mov_b32 v150, 0
  v_mov_b32 v151, 0
  v_mov_b32 v152, 0
  v_mov_b32 v153, 0
  v_mov_b32 v154, 0
  v_mov_b32 v155, 0
  s_waitcnt vmcnt(5)
  v_smfmac_f32_16x16x64_bf16 v[144:147], v[132:135], v[72:79], v8 abid:1
  v_bitop3_b32 v1, v132, v133, s29 bitop3:126
  v_smfmac_f32_16x16x64_bf16 v[148:151], v[132:135], v[88:95], v8 abid:1
  v_bitop3_b32 v2, v134, v135, s29 bitop3:126
  v_smfmac_f32_16x16x64_bf16 v[152:155], v[132:135], v[104:111], v8 abid:1
  s_waitcnt vmcnt(4)
  v_smfmac_f32_16x16x64_bf16 v[144:147], v[136:139], v[80:87], v8 abid:1
  v_bitop3_b32 v3, v136, v137, s29 bitop3:126
  v_smfmac_f32_16x16x64_bf16 v[148:151], v[136:139], v[96:103], v8 abid:1
  v_bitop3_b32 v4, v138, v139, s29 bitop3:126
  v_smfmac_f32_16x16x64_bf16 v[152:155], v[136:139], v[112:119], v8 abid:1
  v_or3_b32 v1, v1, v2, v3
  s_waitcnt vmcnt(2)
  v_smfmac_f32_16x16x32_bf16 v[144:147], v[140:141], v[120:123], v8 abid:2
  v_bitop3_b32 v2, v140, v141, s29 bitop3:126
  v_or3_b32 v1, v1, v4, v2
  v_bitop3_b32 v2, v120, v121, s91 bitop3:126
  v_bitop3_b32 v3, v122, v123, s91 bitop3:126
  s_waitcnt vmcnt(1)
  v_smfmac_f32_16x16x32_bf16 v[148:151], v[140:141], v[124:127], v8 abid:2
  v_bitop3_b32 v4, v124, v125, s91 bitop3:126
  v_or3_b32 v2, v2, v3, v4
  v_bitop3_b32 v3, v126, v127, s91 bitop3:126
  s_waitcnt vmcnt(0)
  v_smfmac_f32_16x16x32_bf16 v[152:155], v[140:141], v[128:131], v8 abid:2
  v_bitop3_b32 v4, v128, v129, s91 bitop3:126
  v_or3_b32 v2, v2, v3, v4
  v_bitop3_b32 v3, v130, v131, s91 bitop3:126
  v_or_b32 v2, v2, v3
  v_lshl_or_b32 v1, v2, 31, v1
  v_cmp_gt_i32 vcc, 0, v1
  s_cbranch_vccnz VOS_pbad
  s_branch VOS_pok
VOS_last:
  v_cvt_pk_bf16_f32 v32, v52, v53
  v_cvt_pk_bf16_f32 v33, v54, v55
  v_cvt_pk_bf16_f32 v34, v56, v57
  v_cvt_pk_bf16_f32 v35, v58, v59
  v_and_or_b32 v32, v32, -2, s91
  v_and_or_b32 v33, v33, -2, s91
  v_and_or_b32 v34, v34, -2, s91
  v_and_or_b32 v35, v35, -2, s91
  v_cvt_pk_bf16_f32 v36, v60, v61
  v_cvt_pk_bf16_f32 v37, v62, v63
  v_permlane16_swap_b32 v32, v34
  v_permlane16_swap_b32 v33, v35
  v_cvt_pk_bf16_f32 v38, v64, v65
  v_cvt_pk_bf16_f32 v39, v66, v67
  buffer_store_dwordx4 v[32:35], v9, s[8:11], s54 offen sc1
  v_and_or_b32 v36, v36, -2, s91
  v_and_or_b32 v37, v37, -2, s91
  v_and_or_b32 v38, v38, -2, s91
  v_and_or_b32 v39, v39, -2, s91
  v_cvt_pk_bf16_f32 v40, v68, v69
  v_cvt_pk_bf16_f32 v41, v70, v71
  v_permlane16_swap_b32 v36, v38
  v_permlane16_swap_b32 v37, v39
  v_and_or_b32 v40, v40, -2, s91
  v_and_or_b32 v41, v41, -2, s91
  buffer_store_dwordx4 v[36:39], v9, s[8:11], s54 offen offset:1024 sc1
  buffer_store_dwordx2 v[40:41], v21, s[8:11], s54 offen offset:2048 sc1
  s_waitcnt vmcnt(0)
  s_barrier
  v_mov_b32 v2, 64
  v_mov_b32 v3, 0
  s_mov_b64 exec, 1
  buffer_store_dword v2, v3, s[8:11], s34 offen offset:4 sc1
  s_waitcnt vmcnt(0)
  s_mov_b64 exec, -1
  s_branch VO_end
VO_end:
L_cfin:
L_abort:
L_fin:
L_end:
  s_endpgm
  .p2align 2
W_table:
  .long 83886083,218235139,769,4105,66306,6153,524296,7433,131336,67329,262920,132869,592901,329480,398343,333832,141063,404743,145159,0,0,0,0
  .long 100663299,235012355,66049,69641,131586,71689,589832,72969,196872,132609,328456,198405,658437,395016,463879,399368,206599,470279,210695,0,0,0,0
  .long 218103811,84082947,66305,135177,131842,137225,263,329219,393992,263941,723973,460552,5128,598280,273928,145672,0,0,0,0,0,0,0
  .long 234881027,100860163,131585,200713,197122,202761,65799,329475,459528,329477,789509,526088,70664,8711,272136,406535,146951,0,0,0,0,0,0
  .long 83951619,218300675,131841,266249,197378,268297,131335,269577,1026,1538,6,266247,136200,74247,337672,472071,212487,0,0,0,0,0,0
  .long 100728835,235077891,197121,331785,1025,333833,196871,335113,1282,1794,65542,331783,201736,139783,403208,13320,147208,0,0,0,0,0,0
  .long 218169347,84148483,197377,397321,1281,399369,262407,400649,66562,67074,131078,397319,267272,205319,468744,78856,212744,0,0,0,0,0,0
  .long 234946563,100925699,262657,462857,66561,464905,327943,466185,66818,67330,196614,462855,332808,270855,534280,144392,278280,0,0,0,0,0,0
  .long 84017155,218366211,262913,528393,66817,530441,393479,531721,132098,132610,1443589,262,136712,271367,11015,274695,146183,0,0,0,0,0,0
  .long 100794371,235143427,328193,593929,132097,595977,459015,597257,132354,132866,1509125,65798,202248,336903,76551,340231,211719,0,0,0,0,0,0
  .long 218234883,84214019,328449,659465,132353,661513,131844,132865,525064,395013,855045,591624,398344,336391,599816,209928,343816,0,0,0,0,0,0
  .long 235012099,257,131074,132099,65540,262408,198145,1442565,1574661,131334,267784,402439,142087,405767,277255,0,0,0,0,0,0,0,0
  .long 84082691,65793,131330,132355,131076,327944,198401,1508101,1640197,196870,333320,467975,207623,471303,342791,0,0,0,0,0,0,0,0
  .long 100859907,131329,196610,197635,196612,393480,263681,1573637,1705733,3333,2311,4104,203783,401927,10247,273672,145416,0,0,0,0,0,0
  .long 218300419,196865,196866,197891,262148,459016,263937,1639173,1771269,68869,67847,69640,269319,467463,75783,339208,210952,0,0,0,0,0,0
  .long 235077635,262401,513,263171,327684,524552,329217,1704709,1836805,134405,133383,135176,334855,8712,143368,146184,0,0,0,0,0,0,0
  .long 84148227,515,263427,393220,590088,329473,1770245,1902341,199941,198919,200712,400391,74248,208904,211720,0,0,0,0,0,0,0,0
  .long 100925443,771,328707,458756,519,1537,776,1967621,789253,132614,402440,274951,146439,0,0,0,0,0,0,0,0,0,0
  .long 218365955,66051,328963,1186057,263939,197125,1115397,2033925,1249029,331527,594696,401160,404744,276488,0,0,0,0,0,0,0,0,0
  .long 235143171,66307,1248777,514,7,1251337,8,1252617,197890,198402,66568,396549,395527,397320,465927,139784,274440,277256,0,0,0,0,0
  .long 84213763,131587,1314313,770,65543,1316873,65544,1318153,264,1793,66312,2033157,199685,460551,526856,529928,9224,340487,211975,0,0,0,0
  .long 100990979,131843,1379849,66050,131079,1382409,131080,1383689,65800,67073,131848,1797,265221,1800,463880,205320,339976,342792,0,0,0,0,0
  .long 67108865,83886339,197123,197633,4,197634,198146,1032,331013,329991,331784,7176,403975,405512,408328,0,0,0,0,0,0,0,0
  .long 201326593,100663555,197379,197889,1513737,1539,1114117,2032389,460805,1772805,3079,397831,399112,468231,207879,537352,146952,0,0,0,0,0,0
  .long 67174401,218104067,262659,263169,1579273,1795,1179653,1029,526341,1838341,68615,463367,464648,9480,406024,146696,0,0,0,0,0,0,0
  .long 201392129,234881283,262915,263425,1644809,67075,1245189,66565,591877,1903877,134151,4616,466696,470280,342024,0,0,0,0,0,0,0,0
  .long 67239937,83951875,328195,328705,1710345,67331,1310725,132101,657413,1969413,199687,70152,532232,535816,407560,0,0,0,0,0,0,0,0
  .long 201457665,100729091,328451,328961,1775881,132611,1376261,197637,722949,2034949,265223,135688,597768,601352,473096,0,0,0,0,0,0,0,0
  .long 67305473,218169603,2,1027,1841417,132867,1441797,263173,788485,3589,330759,201224,8199,9735,273415,602888,212488,0,0,0,0,0,0
  .long 201523201,234946819,258,1283,1906953,198147,1507333,328709,854021,69125,396295,266760,73735,75271,338951,13319,278023,0,0,0,0,0,0
  .long 67371009,84017411,65538,66563,1972489,198403,1572869,394245,919557,134661,461831,332296,139271,140807,404487,78855,343559,0,0,0,0,0,0
  .long 201588737,100794627,65794,66819,2038025,263683,1638405,459781,985093,200197,3080,203016,141319,11783,145415,0,0,0,0,0,0,0,0
  .long 218431491,235340035,393729,4105,262914,6153,197380,591617,590600,460549,920581,2055,592392,595464,74760,406023,277511,0,0,0,0,0,0
  .long 235208707,84410627,393985,69641,328194,71689,262916,656897,1031,1312005,133637,1445637,3848,334599,205064,339464,211208,0,0,0,0,0,0
  .long 84279299,101187843,459265,135177,328450,137225,328452,657153,66567,1377541,199173,1511173,69384,400135,270600,405000,276744,0,0,0,0,0,0
  .long 101056515,218628355,459521,200713,393730,202761,393988,722433,132103,1443077,264709,1576709,134920,465671,336136,470536,342280,0,0,0,0,0,0
  .long 218497027,235405571,524801,266249,393986,268297,459524,722689,197639,1508613,330245,1642245,200456,6920,10504,13576,0,0,0,0,0,0,0
  .long 235274243,84476163,525057,331785,459266,333833,525060,336393,459272,395010,986117,67591,396808,268552,206855,77319,210951,0,0,0,0,0,0
  .long 84344835,101253379,590337,397321,459522,399369,590596,401929,524808,460290,1051653,133127,462344,334088,272391,142855,276487,0,0,0,0,0,0
  .long 101122051,218693891,590593,462857,394241,464905,1028,467465,590344,460546,1117189,198663,527880,399624,337927,208391,342023,0,0,0,0,0,0
  .long 218562563,235471107,655873,528393,394497,530441,66564,533001,775,263938,854789,198150,467976,471559,343047,0,0,0,0,0,0,0,0
  .long 235339779,84541699,656129,593929,459777,595977,132100,598537,66311,329218,920325,1798,534024,406279,146695,0,0,0,0,0,0,0,0
  .long 84410371,101318915,721409,659465,460033,661513,197636,664073,131847,329474,985861,67334,599560,471815,212231,0,0,0,0,0,0,0,0
  .long 101187587,218759427,721665,725001,525313,727049,263172,729609,197383,394754,1051397,132870,9991,273671,276231,0,0,0,0,0,0,0,0
  .long 218628099,327937,327938,460035,792841,722435,262661,1180933,2565,1314565,397063,5127,399367,269832,470023,144391,409095,0,0,0,0,0,0
  .long 235405315,393473,393218,525315,858377,722691,328197,1246469,68101,1380101,462599,70663,464903,335368,11272,145160,0,0,0,0,0,0,0
  .long 84475907,459009,393474,525571,923913,263170,394753,393733,1574149,395781,1707781,265992,72456,76040,79112,0,0,0,0,0,0,0,0
  .long 101253123,524545,458754,590851,989449,263426,395009,459269,1639685,461317,1773317,331528,137992,141576,144648,0,0,0,0,0,0,0,0
  .long 218693635,590081,459010,591107,1054985,328706,460289,524805,1705221,526853,1838853,397064,203528,207112,210184,0,0,0,0,0,0,0,0
  .long 235470851,393731,656387,1120521,328962,460545,590341,1770757,592389,1904389,462600,269064,272648,275720,0,0,0,0,0,0,0,0,0
  .long 84541443,393987,656643,1186057,394242,525825,655877,1836293,657925,1969925,528136,334600,338184,341256,0,0,0,0,0,0,0,0,0
  .long 101318659,459267,721923,1251593,394498,526081,721413,1901829,723461,2035461,593672,400136,403720,406792,0,0,0,0,0,0,0,0,0
  .long 218759171,459523,722179,1317129,459778,591361,786949,1967365,788997,774,269575,8967,272647,12295,145927,0,0,0,0,0,0,0,0
  .long 235536387,524803,1379849,262658,196615,1382409,196616,1383689,460034,263682,132104,462085,461063,462856,72712,469511,471048,473864,0,0,0,0,0
  .long 67436545,100991235,525059,525569,1448201,394755,1703941,525317,1050629,265733,68616,465160,403463,273927,407559,0,0,0,0,0,0,0,0
  .long 201654273,218431747,590339,590849,1513737,395011,1769477,590853,1116165,331269,134152,530696,468999,339463,473095,0,0,0,0,0,0,0,0
  .long 67502081,235208963,590595,591105,1579273,460291,1835013,656389,1181701,396805,199688,596232,10248,537608,409352,0,0,0,0,0,0,0,0
  .long 201719809,84279555,655875,656385,1644809,460547,1900549,721925,1247237,462341,265224,6663,204807,206343,76808,210696,0,0,0,0,0,0,0
  .long 67567617,101056771,656131,656641,1710345,525827,1966085,787461,1312773,527877,330760,72199,270343,271879,142344,276232,0,0,0,0,0,0,0
  .long 201785345,218497283,721411,721921,1775881,526083,2031621,852997,1378309,593413,396296,137735,335879,337415,207880,341768,0,0,0,0,0,0,0
  .long 67633153,235274499,721667,722177,1841417,591363,261,918533,1443845,658949,461832,203271,401415,402951,273416,407304,0,0,0,0,0,0,0
  .long 201850881,84345091,262146,394243,1906953,591619,65797,984069,1509381,724485,527368,268807,466951,468487,338952,472840,0,0,0,0,0,0,0
  .long 67698689,101122307,262402,394499,1972489,656899,131333,1049605,1574917,790021,592904,334343,8200,536072,407816,0,0,0,0,0,0,0,0
  .long 201916417,218562819,327682,459779,2038025,657155,196869,1115141,1640453,855557,3335,397832,73736,601608,473352,0,0,0,0,0,0,0,0
  .long 84606979,235733251,787201,4105,786946,6153,328708,984577,263175,2032901,854533,66310,335111,74503,338183,77831,211463,0,0,0,0,0,0
  .long 101384195,84803843,852481,69641,787202,71689,394244,984833,328711,1541,920069,131846,400647,140039,403719,143367,276999,0,0,0,0,0,0
  .long 218824707,101581059,852737,135177,852482,137225,459780,1050113,394247,67077,985605,197382,466183,205575,469255,208903,342535,0,0,0,0,0,0
  .long 235601923,219021571,918017,200713,852738,202761,525316,1050369,459783,132613,1051141,1030,7432,273159,12552,146440,0,0,0,0,0,0,0
  .long 84672515,235798787,918273,266249,787457,268297,590852,270857,262919,656898,1116933,198406,75527,339207,341767,0,0,0,0,0,0,0,0
  .long 101449731,84869379,983553,331785,787713,333833,1284,336393,328455,657154,1182469,1544,397575,398856,140296,12808,212232,0,0,0,0,0,0
  .long 218890243,101646595,983809,397321,852993,399369,66820,401929,393991,722434,1248005,67080,463111,464392,205832,78344,277768,0,0,0,0,0,0
  .long 235667459,219087107,1049089,462857,853249,464905,132356,467465,459527,722690,1313541,132616,4360,466440,404488,538376,0,0,0,0,0,0,0
  .long 84738051,235864323,1049345,528393,918529,530441,197892,533001,65541,1769989,1115653,2034181,67079,133639,4359,267528,271111,469256,472328,0,0,0,0
  .long 101515267,655617,721154,984323,596233,590850,853505,852485,198149,1116677,66566,72968,338695,78088,211976,0,0,0,0,0,0,0,0
  .long 218955779,721153,786434,1049603,661769,591106,853761,918021,263685,1182213,132102,138504,404231,143624,277512,0,0,0,0,0,0,0,0
  .long 235732995,786689,786690,1049859,727305,656386,919041,983557,329221,1247749,197638,204040,469767,209160,343048,0,0,0,0,0,0,0,0
  .long 84803587,852225,851970,790025,524802,262151,792585,262152,793865,656642,525826,197640,527621,2312,5639,400392,10760,13831,0,0,0,0,0
  .long 101580803,917761,852226,855561,525058,327687,858121,327688,859401,721922,526082,263176,593157,67848,71175,465928,76296,79367,0,0,0,0,0
  .long 219021315,983297,786945,921097,590338,393223,923657,393224,924937,722178,591362,328712,658693,133384,136711,531464,141832,144903,0,0,0,0,0
  .long 235798531,786947,986633,590594,458759,989193,458760,990473,787458,591618,394248,724229,198920,202247,597000,207368,210439,0,0,0,0,0,0
  .long 84869123,787203,1052169,655874,1054473,524292,787714,787970,66823,789765,264456,267783,7431,401928,536584,539400,0,0,0,0,0,0,0
  .long 101646339,852483,1117705,656130,1120009,589828,852994,788226,132359,855301,329992,333319,72967,467464,602120,604936,0,0,0,0,0,0,0
  .long 219086851,852739,1183241,721410,1185545,260,853250,853506,197895,920837,395528,398855,138503,533000,12551,408327,0,0,0,0,0,0,0
  .long 235864067,918019,1248777,721666,1251081,65796,66055,919297,197384,67333,330757,67336,529416,270856,78087,473863,0,0,0,0,0,0,0
  .long 67764225,235536643,918275,918785,1317129,787971,853762,1379077,198152,69896,531976,470024,603912,0,0,0,0,0,0,0,0,0,0
  .long 201981953,84607235,983555,984065,1382665,788227,262405,1180677,1705989,921093,68871,463368,139272,12039,145671,0,0,0,0,0,0,0,0
  .long 67829761,101384451,983811,984321,1448201,853507,327941,1246213,1771525,986629,134407,528904,204808,77575,211207,0,0,0,0,0,0,0,0
  .long 202047489,218824963,1049091,1049601,1513737,853763,393477,1311749,1837061,1052165,199943,594440,270344,143111,276743,0,0,0,0,0,0,0,0
  .long 67895297,235602179,1049347,1049857,1579273,919043,459013,1377285,1902597,1117701,265479,4871,530184,75016,471560,343304,0,0,0,0,0,0,0
  .long 202113025,84672771,524290,787459,1644809,919299,524549,1442821,1968133,1183237,331015,70407,595720,140552,537096,408840,0,0,0,0,0,0,0
  .long 67960833,101449987,524546,787715,1710345,984579,590085,1508357,2033669,1248773,396551,135943,6151,400903,140295,535048,275975,0,0,0,0,0,0
  .long 202178561,218890499,589826,852995,1775881,984835,655621,1573893,2309,1314309,462087,201479,71687,466439,205831,600584,341511,0,0,0,0,0,0
  .long 68026369,235667715,590082,853251,1841417,1050115,721157,1639429,67845,1379845,3336,399879,335880,208647,342279,0,0,0,0,0,0,0,0
  .long 202244097,84738307,655362,918531,1906953,1050371,786693,1704965,133381,1445381,68872,465415,401416,274183,407815,0,0,0,0,0,0,0,0
  .long 68091905,101515523,655618,918787,1972489,525314,787969,852229,1770501,198917,1510917,134408,6664,272392,603144,474888,0,0,0,0,0,0,0
  .long 202309633,218956035,720898,984067,2038025,525570,788225,917765,1836037,264453,1576453,199944,72200,337928,13575,147207,0,0,0,0,0,0,0
  .long 84934659,219283715,1245442,4105,1114882,6153,263428,1181441,525061,526085,1182725,264199,4103,136199,6152,272135,11528,538632,0,0,0,0,0
  .long 101711875,236060931,1114625,69641,1180162,71689,328964,1246721,590597,591621,1248261,329735,69639,201735,71688,337671,77064,604168,0,0,0,0,0
  .long 219152387,85131523,1114881,135177,1180418,137225,394500,1246977,656133,657157,1313797,395271,135175,267271,137224,403207,142600,14599,0,0,0,0,0
  .long 235929603,101908739,1180161,200713,1245698,202761,460036,1312257,721669,722693,1379333,460807,200711,332807,202760,468743,208136,80135,0,0,0,0,0
  .long 85000195,219349251,1180417,266249,1245954,268297,525572,1312513,787205,788229,1444869,2056,136455,465672,534792,537864,0,0,0,0,0,0,0
  .long 101777411,236126467,1245697,331785,1115137,333833,591108,1377793,852741,853765,1510405,67592,201991,531208,600328,603400,0,0,0,0,0,0,0
  .long 219217923,85197059,1245953,397321,1115393,399369,1540,1378049,918277,919301,1575941,133128,267527,596744,10759,274439,408071,0,0,0,0,0,0
  .long 235995139,101974275,1311233,462857,1180673,464905,67076,467465,131077,1835525,1181189,2821,132615,199175,69895,333064,336647,76295,339975,473607,0,0,0
  .long 85065731,219414787,1311489,528393,1180929,530441,132612,533001,196613,1901061,1246725,68357,198151,264711,135431,398600,402183,141831,405511,14856,0,0,0
  .long 101842947,236192003,1376769,593929,1246209,595977,198148,598537,262149,1966597,1312261,133893,263687,330247,200967,464136,467719,207367,471047,80392,0,0,0
  .long 219283459,85262595,1377025,659465,1246465,661513,263684,664073,327685,2032133,1377797,199429,329223,395783,266503,529672,8968,274696,408584,0,0,0,0
  .long 236060675,1048833,1114114,1311747,727305,918530,1246466,1049093,394757,1313285,1288,2823,528648,597512,535560,14343,0,0,0,0,0,0,0
  .long 85131267,1114369,1114370,1312003,792841,918786,1115649,1114629,460293,1378821,66824,68359,594184,7943,9479,404232,144904,0,0,0,0,0,0
  .long 101908483,1179905,1179650,1377283,858377,984066,1115905,1180165,525829,1444357,132360,133895,4615,5895,531720,11016,210440,0,0,0,0,0,0
  .long 219348995,1245441,1179906,1377539,923913,984322,1181185,1245701,591365,1509893,197896,199431,70151,71431,597256,76552,275976,0,0,0,0,0,0
  .long 236126211,1310977,1245186,986633,918018,988937,131332,1049602,919042,263431,986373,461064,464391,204039,598536,143623,15112,0,0,0,0,0,0
  .long 85196803,1114627,1052169,918274,1054473,196868,1049858,919298,328967,1051909,526600,5640,271368,143880,474376,0,0,0,0,0,0,0,0
  .long 101974019,1114883,1117705,983554,1120009,262404,1115138,984578,394503,1117445,592136,71176,336904,209416,539912,0,0,0,0,0,0,0,0
  .long 219414531,1180163,1183241,983810,1185545,327940,1115394,984834,460039,1182981,2567,528392,138248,272904,407047,0,0,0,0,0,0,0,0
  .long 236191747,1180419,1248777,1049090,1251081,393476,1180674,1050114,1967877,197126,334856,338440,472583,0,0,0,0,0,0,0,0,0,0
  .long 85262339,1245699,1314313,1049346,1316617,459012,1180930,1050370,2033413,1248517,133896,71943,466695,206088,602632,605448,0,0,0,0,0,0,0
  .long 102039555,1245955,1379849,1114626,1382153,524548,1246210,1115650,2053,1314053,199432,137479,7944,404999,14344,0,0,0,0,0,0,0,0
  .long 68157441,84934915,1311235,1311745,1448201,1115651,1115906,1444613,263688,135432,73479,75015,469768,341512,0,0,0,0,0,0,0,0,0
  .long 202375169,101712131,1311491,1312001,1513737,1115907,1181186,1510149,329224,200968,139015,140551,535304,407048,0,0,0,0,0,0,0,0,0
  .long 68222977,219152643,1376771,1377281,1579273,1181187,1181442,1575685,394760,266504,204551,206087,600840,472584,0,0,0,0,0,0,0,0,0
  .long 202440705,235929859,1377027,1377537,1644809,1181443,1246722,1641221,460296,332040,270087,271623,11271,209927,474631,0,0,0,0,0,0,0,0
  .long 68288513,85000451,917506,1115139,1710345,1246723,1246978,1706757,525832,397576,335623,337159,76807,275463,15880,0,0,0,0,0,0,0,0
  .long 202506241,101777667,917762,1115395,1775881,1246979,983301,1901573,329989,1641989,265480,137736,403464,79111,212743,0,0,0,0,0,0,0,0
  .long 68354049,219218179,983042,1180675,1841417,1312259,1048837,1967109,395525,1707525,331016,203272,469000,144647,278279,0,0,0,0,0,0,0,0
  .long 202571777,235995395,983298,1180931,1906953,1312515,1114373,2032645,461061,1773061,396552,268808,534536,210183,343815,0,0,0,0,0,0,0,0
  .long 68419585,85065987,1048578,1246211,1972489,1377795,1179909,1285,526597,1838597,462088,334344,600072,275719,409351,0,0,0,0,0,0,0,0
  .long 202637313,101843203,1048834,1246467,2038025,1378051,1245445,66821,592133,1904133,527624,399880,10503,339719,473351,0,0,0,0,0,0,0,0
  .long 219480067,236388611,1638402,4105,1442562,6153,329220,1509121,983813,984837,1641477,198664,333063,7175,401672,405255,14600,0,0,0,0,0,0
  .long 236257283,85459203,1638658,69641,1507842,71689,394756,1574401,1049349,1050373,1707013,264200,398599,72711,467208,470791,80136,0,0,0,0,0,0
  .long 85327875,102236419,1442305,135177,1508098,137225,460292,1574657,1114885,1115909,1772549,329736,464135,138247,532744,12040,145928,0,0,0,0,0,0
  .long 102105091,219676931,1442561,200713,1573378,202761,525828,1639937,1180421,1181445,1838085,395272,5384,74504,340232,474120,0,0,0,0,0,0,0
  .long 219545603,236454147,1507841,266249,1573634,268297,591364,1640193,1245957,1246981,1903621,460808,70920,140040,405768,539656,0,0,0,0,0,0,0
  .long 236322819,85524739,1508097,331785,1638914,333833,1796,1705473,1311493,1312517,1969157,526344,136456,205576,471304,605192,0,0,0,0,0,0,0
  .long 85393411,102301955,1573377,397321,1639170,399369,67332,1705729,1377029,1378053,2034693,591880,201992,271112,536840,15623,0,0,0,0,0,0,0
  .long 102170627,219742467,1573633,462857,1442817,464905,132868,467465,393221,773,1443333,264965,394759,461319,332039,595208,336648,602376,81159,0,0,0,0
  .long 219611139,236519683,1638913,528393,1443073,530441,198404,533001,458757,66309,1508869,330501,460295,2568,136967,7687,402184,12807,408583,0,0,0,0
  .long 236388355,85590275,1639169,593929,1508353,595977,263940,598537,524293,131845,1574405,396037,1286,269576,142088,538120,0,0,0,0,0,0,0
  .long 85458947,102367491,1704449,659465,1508609,661513,329476,664073,589829,197381,1639941,461573,66822,335112,207624,603656,0,0,0,0,0,0,0
  .long 102236163,219808003,1704705,725001,1573889,727049,395012,729609,655365,262917,1705477,527109,132358,400648,273160,14087,0,0,0,0,0,0,0
  .long 219676675,1376513,1442050,1574147,792841,1311746,1639426,1311237,656901,1575429,263432,264967,135687,202503,73223,467720,78343,474119,0,0,0,0,0
  .long 236453891,1442049,1507330,1639427,858377,1312002,1639682,1376773,722437,1640965,328968,330503,201223,268039,138759,533256,143879,15368,0,0,0,0,0
  .long 85524483,1507585,1507586,1639683,923913,1377282,1443329,1442309,787973,1706501,394504,396039,266759,333575,204295,598792,209415,80904,0,0,0,0,0
  .long 102301699,1573121,1572866,1704963,989449,1377538,1443585,1507845,853509,1772037,460040,461575,332295,399111,269831,9223,272903,12296,15367,0,0,0,0
  .long 219742211,1638657,1573122,1705219,1054985,1442818,1508865,1573381,919045,1837573,525576,2824,203015,73480,470535,79880,0,0,0,0,0,0,0
  .long 236519427,1442307,1117705,1311234,1120009,590084,1443074,1312258,67589,1379589,264968,268551,139016,11784,538888,0,0,0,0,0,0,0,0
  .long 85590019,1442563,1183241,1311490,1185545,516,1508354,1312514,133125,1445125,330504,334087,204552,77320,604424,0,0,0,0,0,0,0,0
  .long 102367235,1507843,1248777,1376770,1251081,66052,1508610,1377794,198661,1510661,396040,399623,270088,142856,14855,0,0,0,0,0,0,0,0
  .long 219807747,1508099,1314313,1377026,1316617,131588,1573890,1378050,264197,1576197,461576,465159,335624,208392,80391,0,0,0,0,0,0,0,0
  .long 236584963,1573379,1379849,1442306,1382153,197124,1574146,1443330,329733,1641733,527112,6408,75784,341255,474887,0,0,0,0,0,0,0,0
  .long 68485121,102039811,1573635,1574145,1448201,1443331,1443586,1772293,591368,463112,401159,402695,142343,340999,81416,0,0,0,0,0,0,0,0
  .long 202702849,219480323,1638915,1639425,1513737,1443587,1508866,1837829,1799,68104,464647,335367,74759,338439,77832,80903,0,0,0,0,0,0,0
  .long 68550657,236257539,1639171,1639681,1579273,1508867,1509122,1903365,67335,133640,5896,271624,13063,277767,0,0,0,0,0,0,0,0,0
  .long 202768385,85328131,1704451,1704961,1644809,1509123,1574402,1968901,132871,199176,71432,337160,78599,343303,0,0,0,0,0,0,0,0,0
  .long 68616193,102105347,1704707,1705217,1710345,1574403,1574658,2034437,198407,264712,136968,402696,144135,408839,0,0,0,0,0,0,0,0,0
  .long 202833921,219545859,1310722,1442819,1775881,1574659,1639938,3077,263943,330248,202504,468232,209671,474375,0,0,0,0,0,0,0,0,0
  .long 68681729,236323075,1310978,1443075,1841417,1639939,1640194,68613,329479,395784,268040,533768,275207,15624,0,0,0,0,0,0,0,0,0
  .long 202899457,85393667,1376258,1508355,1906953,1640195,1310981,132357,657669,1969669,593160,465416,76039,77576,211464,0,0,0,0,0,0,0,0
  .long 68747265,102170883,1376514,1508611,1972489,1705475,1376517,197893,723205,2035205,3591,267015,137223,7688,601096,79879,0,0,0,0,0,0,0
  .long 202964993,219611395,1441794,1573891,2038025,1705731,1442053,263429,788741,3845,69127,332551,202759,73224,11527,407303,0,0,0,0,0,0,0
  .long 85655555,236781827,1770241,4105,1966594,6153,460548,8713,720901,328453,1771013,592645,197894,466184,338696,79623,0,0,0,0,0,0,0
  .long 102432771,85852419,1835521,69641,1966850,71689,526084,74249,786437,393989,1836549,658181,1542,533512,274952,15879,0,0,0,0,0,0,0
  .long 219873283,102629635,1835777,135177,2032130,137225,591620,139785,851973,459525,1902085,723717,67078,599048,340488,81415,0,0,0,0,0,0,0
  .long 236650499,220070147,1901057,200713,2032386,202761,1771011,1771266,1640709,855813,593416,530952,141575,143112,277000,0,0,0,0,0,0,0,0
  .long 85721091,236847363,1901313,266249,1770497,268297,1771267,1836546,1706245,921349,3847,267016,466952,208648,342536,0,0,0,0,0,0,0,0
  .long 102498307,85917955,1966593,331785,1770753,333833,1836547,1836802,1771781,986885,69383,332552,532488,274184,408072,0,0,0,0,0,0,0,0
  .long 219938819,102695171,1966849,397321,1836033,399369,1836803,1902082,1837317,1052421,134919,398088,598024,339720,473608,0,0,0,0,0,0,0,0
  .long 236716035,220135683,2032129,462857,1836289,464905,1902083,1902338,1902853,1117957,200455,463624,8455,9736,13064,278024,0,0,0,0,0,0,0
  .long 85786627,236912899,2032385,528393,1901569,530441,1902339,1967618,1968389,1183493,265991,529160,73991,75272,78600,343560,0,0,0,0,0,0,0
  .long 102563843,1704193,1900802,1967363,596233,1967106,2033153,1638917,984581,1903109,591112,68360,71944,141320,406791,16136,0,0,0,0,0,0,0
  .long 220004355,1769729,1966082,2032643,661769,1967362,2033409,1704453,1050117,1968645,1543,68103,593928,203784,403976,13832,0,0,0,0,0,0,0
  .long 236781571,1835265,1966338,2032899,727305,2032642,729609,520,1771010,134149,395015,461320,333576,599304,340743,81160,0,0,0,0,0,0,0
  .long 85852163,1900801,2031618,790025,1704450,792329,262660,2032898,1705730,395269,1707269,592648,137480,206856,472327,81672,0,0,0,0,0,0,0
  .long 102629379,1966337,2031874,855561,1704706,857865,328196,131591,860681,66056,1967874,396293,132872,594952,336392,209159,80648,0,0,0,0,0,0
  .long 220069891,2031873,1769985,921097,1769986,923401,393732,197127,926217,131592,2033154,461829,198408,5383,464904,9992,275464,540424,0,0,0,0,0
  .long 236847107,1769987,986633,1770242,988937,459268,262663,991753,197128,2033410,527365,263944,70919,530440,75528,341000,605960,0,0,0,0,0,0
  .long 85917699,1770243,1052169,1835522,1054473,524804,328199,1057289,262664,917509,1835781,525320,66054,595976,141064,406536,0,0,0,0,0,0,0
  .long 102694915,1835523,1117705,1835778,1120009,590340,393735,1122825,328200,983045,1901317,590856,131590,6407,400904,77063,472839,0,0,0,0,0,0
  .long 220135427,1835779,1183241,1901058,1185545,772,459271,1188361,393736,1048581,1966853,1287,265477,264455,266248,269320,469512,79368,0,0,0,0,0
  .long 236912643,1901059,1248777,1901314,1251081,66308,1253385,5,1705474,459784,518,268296,206600,472072,0,0,0,0,0,0,0,0,0
  .long 68812801,236585219,1901315,1901825,1317129,1967619,1507589,328965,854277,69381,134663,398087,268295,138760,142599,14088,0,0,0,0,0,0,0
  .long 203030529,85655811,1966595,1967105,1382665,1967875,1573125,394501,919813,134917,200199,463623,333831,204296,208135,79624,0,0,0,0,0,0,0
  .long 68878337,102433027,1966851,1967361,1448201,2033155,1638661,460037,985349,200453,265735,4872,139527,140808,144136,409096,0,0,0,0,0,0,0
  .long 203096065,219873539,2032131,2032641,1513737,2033411,1704197,525573,1050885,265989,331271,70408,205063,206344,209672,474632,0,0,0,0,0,0,0
  .long 68943873,236650755,2032387,2032897,1579273,1704962,1771009,1769733,591109,1116421,331525,396807,135944,270599,271880,275208,540168,0,0,0,0,0,0
  .long 203161601,85721347,1703938,1770499,1644809,1705218,1771265,1835269,656645,1181957,397061,462343,201480,336135,337416,340744,605704,0,0,0,0,0,0
  .long 69009409,102498563,1704194,1770755,1710345,1770498,1836545,1900805,722181,1247493,462597,3592,596488,207111,405256,539144,0,0,0,0,0,0,0
  .long 203227137,219939075,1769474,1836035,1775881,1770754,1836801,1966341,787717,1313029,528133,69128,6919,401671,402952,406280,16135,0,0,0,0,0,0
  .long 69074945,236716291,1769730,1836291,1841417,1836034,1902081,2031877,853253,1378565,593669,134664,72455,467207,468488,471816,81671,0,0,0,0,0,0
  .long 203292673,85786883,1835010,1901571,1906953,1836290,1902337,517,918789,1444101,659205,200200,137991,8456,470792,604680,0,0,0,0,0,0,0
  .long 69140481,102564099,1835266,1901827,1972489,1901570,1967617,66053,984325,1509637,724741,265736,203527,73992,536328,15111,0,0,0,0,0,0,0
  .long 203358209,220004611,1900546,1967107,2038025,1901826,1967873,131589,1049861,1575173,790277,331272,269063,139528,601864,80647,0,0,0,0,0,0,0
.section .rodata,"a"
.p2align 6
.amdhsa_kernel concat_heads__memory_aug_recurrent_mem_tr__sliding_block__prompt_kernel
  .amdhsa_next_free_vgpr 512
  .amdhsa_next_free_sgpr 102
  .amdhsa_accum_offset 256
  .amdhsa_group_segment_fixed_size 0
  .amdhsa_kernarg_size 104
  .amdhsa_user_sgpr_count 2
  .amdhsa_user_sgpr_kernarg_segment_ptr 1
  .amdhsa_system_sgpr_workgroup_id_x 1
  .amdhsa_float_denorm_mode_32 3
.end_amdhsa_kernel
```
